```python
import torch

def _softmax(x, axis=-1):
    return torch.softmax(x, dim=axis)

def _gelu(x):
    return torch.nn.functional.gelu(x, approximate='tanh')

def _silu(x):
    return torch.nn.functional.silu(x)

def _sigmoid(x):
    return torch.sigmoid(x)

def _layernorm(x, axis=-1, eps=1e-05):
    m = x.mean(dim=axis, keepdim=True)
    v = x.var(dim=axis, keepdim=True, unbiased=False)
    return (x - m) / torch.sqrt(v + eps)

def _scatter_add(tgt, idx, src, axis=0):
    return tgt.clone().index_add_(axis, idx, src)

def _segment_sum(src, seg, n):
    out = torch.zeros((n,) + src.shape[1:], dtype=src.dtype)
    return out.index_add_(0, seg, src)

def _pad(x, pw):
    flat = tuple((v for pair in reversed(pw) for v in pair))
    return torch.nn.functional.pad(x, flat)
kernel_name = 'interleave_layers__memory_aug_recurrent_mem_tr__glu_gated_swiglu__prompt'

def setup_inputs():

    _w = lambda a: (lambda t: t.to(torch.bfloat16) if t.is_floating_point() else t)(torch.as_tensor(a))

    def _A_setup():
        B, S, Dm = (1, 2048, 576)
        H, Dh = (32, 128)
        M, seg = (8, 32)
        seg = min(seg, S)
        S = S // seg * seg
        return {'x': _w((lambda *s: torch.randn(*s, dtype=torch.bfloat16) * 0.05)(B, S, Dm)), 'mem0': _w((lambda *s: torch.randn(*s, dtype=torch.bfloat16) * 0.2)(B, M, Dm)), 'Wq': _w((lambda *s: torch.randn(*s, dtype=torch.bfloat16) * 1.6)(Dm, H, Dh) * Dm ** (-0.5)), 'Wk': _w((lambda *s: torch.randn(*s, dtype=torch.bfloat16) * 1.6)(Dm, H, Dh) * Dm ** (-0.5)), 'Wv': _w((lambda *s: torch.randn(*s, dtype=torch.bfloat16) * 0.2)(Dm, H, Dh) * Dm ** (-0.5)), 'Wo': _w((lambda *s: torch.randn(*s, dtype=torch.bfloat16) * 0.2)(H, Dh, Dm) * (H * Dh) ** (-0.5)), 'seg_len': seg}
    _A_in = _A_setup()

    def _B_setup():
        B, S, D, F = (1, 2048, 576, 4608)
        return {'x': _w((lambda *s: torch.randn(*s, dtype=torch.bfloat16) * 0.05)(B, S, D)), 'w1': _w((lambda *s: torch.randn(*s, dtype=torch.bfloat16) * 0.2)(D, F) * (2.0 / D) ** 0.5), 'w3': _w((lambda *s: torch.randn(*s, dtype=torch.bfloat16) * 0.2)(D, F) * (2.0 / D) ** 0.5), 'w2': _w((lambda *s: torch.randn(*s, dtype=torch.bfloat16) * 0.2)(F, D) * (2.0 / F) ** 0.5)}
    _B_in = _B_setup()
    return {'A_x': _A_in['x'], 'A_mem0': _A_in['mem0'], 'A_Wq': _A_in['Wq'], 'A_Wk': _A_in['Wk'], 'A_Wv': _A_in['Wv'], 'A_Wo': _A_in['Wo'], 'A_seg_len': _A_in['seg_len'], 'B_x': _B_in['x'], 'B_w1': _B_in['w1'], 'B_w3': _B_in['w3'], 'B_w2': _B_in['w2']}

def reference(A_x, A_mem0, A_Wq, A_Wk, A_Wv, A_Wo, A_seg_len, B_x, B_w1, B_w3, B_w2):

    def _A_ref(x, mem0, Wq, Wk, Wv, Wo, seg_len):
        B, S, Dm = x.shape
        H, Dh = (Wq.shape[1], Wq.shape[2])
        M = mem0.shape[1]
        scale = Dh ** (-0.5)
        n_seg = S // seg_len
        L = M + seg_len
        idx = torch.arange(L)
        mask = (idx[:, None] < M) | (idx[:, None] >= idx[None, :])
        mem = mem0
        outs = []
        for s in range(n_seg):
            xs = x[:, s * seg_len:(s + 1) * seg_len, :].clone()
            h = torch.concatenate([mem, xs], axis=1)
            q = torch.einsum('btd,dhe->bhte', h, Wq)
            k = torch.einsum('btd,dhe->bhte', h, Wk)
            v = torch.einsum('btd,dhe->bhte', h, Wv)
            scores = torch.einsum('bhqe,bhke->bhqk', q, k) * scale
            scores = torch.where(mask[None, None], scores, -1000000000.0)
            p = _softmax(scores, axis=-1)
            o = torch.einsum('bhqk,bhke->bhqe', p, v)
            o = torch.einsum('bhte,hed->btd', o, Wo)
            mem = o[:, :M, :].clone()
            outs.append(o[:, M:, :])
        return torch.concatenate(outs, axis=1)

    def _B_ref(x, w1, w3, w2):
        gate = torch.einsum('bsd,df->bsf', x, w1)
        up = torch.einsum('bsd,df->bsf', x, w3)
        h = _silu(gate) * up
        out = torch.einsum('bsf,fd->bsd', h, w2)
        return out
    x = A_x
    x = x + _A_ref(_layernorm(x, axis=-1), A_mem0, A_Wq, A_Wk, A_Wv, A_Wo, A_seg_len)
    x = x + _B_ref(_layernorm(x, axis=-1), B_w1, B_w3, B_w2)
    x = x + _A_ref(_layernorm(x, axis=-1), A_mem0, A_Wq, A_Wk, A_Wv, A_Wo, A_seg_len)
    x = x + _B_ref(_layernorm(x, axis=-1), B_w1, B_w3, B_w2)
    return x
```

```asm
; @launch kernel=interleave_layers__memory_aug_recurrent_mem_tr__glu_gated_swiglu__prompt_kernel grid=(256,1,1) block=(256,1,1) lds=163840
.amdgcn_target "amdgcn-amd-amdhsa--gfx950"
.text
.globl interleave_layers__memory_aug_recurrent_mem_tr__glu_gated_swiglu__prompt_kernel
.p2align 8
.type interleave_layers__memory_aug_recurrent_mem_tr__glu_gated_swiglu__prompt_kernel,@function
interleave_layers__memory_aug_recurrent_mem_tr__glu_gated_swiglu__prompt_kernel:
 s_cmp_ge_u32 s2, 256
 s_cbranch_scc1 L_end
 s_load_dwordx16 s[64:79], s[0:1], 0
 s_load_dwordx8 s[80:87], s[0:1], 64
 s_load_dwordx4 s[88:91], s[0:1], 96
 s_getreg_b32 s56, hwreg(HW_REG_XCC_ID)
 v_lshrrev_b32 v1, 6, v0
 s_and_b32 s56, s56, 15
 v_readfirstlane_b32 s58, v1
 s_mov_b32 s59, 0
 s_mov_b32 s6, s56
 s_getpc_b64 s[92:93]
L_pc:
 s_lshr_b32 s63, s2, 3
 s_lshl_b32 s63, s63, 8
 v_add_u32 v2, s63, v0
 v_lshlrev_b32 v2, 5, v2
 v_min_u32 v2, L_code_end-L_pc-4, v2
 v_and_b32 v3, 3, v0
 v_cmp_eq_u32 vcc, 0, v3
 s_and_saveexec_b64 s[94:95], vcc
 global_load_dword v75, v2, s[92:93]
 s_mov_b64 exec, s[94:95]
 s_waitcnt lgkmcnt(0)
 s_mov_b32 s8, s90
 s_mov_b32 s9, s91
 s_mov_b32 s10, 268435456
 s_mov_b32 s11, 0x20000
 s_mov_b32 s12, s64
 s_mov_b32 s13, s65
 s_mov_b32 s14, 2359296
 s_mov_b32 s15, 0x20000
 s_mov_b32 s16, s86
 s_mov_b32 s17, s87
 s_mov_b32 s18, 2359296
 s_mov_b32 s19, 0x20000
 s_mov_b32 s20, s88
 s_mov_b32 s21, s89
 s_mov_b32 s22, 256
 s_mov_b32 s23, 0x20000
 s_mov_b32 s24, s66
 s_mov_b32 s25, s67
 s_mov_b32 s26, 9216
 s_mov_b32 s27, 0x20000
 s_mov_b32 s28, s68
 s_mov_b32 s29, s69
 s_mov_b32 s30, 4718592
 s_mov_b32 s31, 0x20000
 s_mov_b32 s32, s70
 s_mov_b32 s33, s71
 s_mov_b32 s34, 4718592
 s_mov_b32 s35, 0x20000
 s_mov_b32 s36, s72
 s_mov_b32 s37, s73
 s_mov_b32 s38, 4718592
 s_mov_b32 s39, 0x20000
 s_mov_b32 s40, s74
 s_mov_b32 s41, s75
 s_mov_b32 s42, 4718592
 s_mov_b32 s43, 0x20000
 s_mov_b32 s44, s80
 s_mov_b32 s45, s81
 s_mov_b32 s46, 5308416
 s_mov_b32 s47, 0x20000
 s_mov_b32 s48, s82
 s_mov_b32 s49, s83
 s_mov_b32 s50, 5308416
 s_mov_b32 s51, 0x20000
 s_mov_b32 s52, s84
 s_mov_b32 s53, s85
 s_mov_b32 s54, 5308416
 s_mov_b32 s55, 0x20000
 v_and_b32 v1, 31, v0
 v_lshrrev_b32 v2, 5, v0
 v_mul_u32_u24 v3, 1152, v2
 v_lshl_add_u32 v76, v1, 4, v3
 s_and_b32 s63, s2, 1
 s_lshl_b32 s63, s63, 2
 s_add_u32 s63, s63, s58
 v_xor_b32 v4, s63, v1
 v_lshl_add_u32 v77, v4, 4, v3
 v_cmp_gt_u32 vcc, 24, v1
 v_mov_b32 v3, 2147483632
 v_mov_b32 v4, 0xbae38e39
 v_cndmask_b32 v76, v3, v76, vcc
 v_cndmask_b32 v77, v3, v77, vcc
 v_cndmask_b32 v78, 0, v4, vcc
 s_mul_i32 s3, s2, 9216
 buffer_load_dwordx4 v[40:43], v76, s[12:15], s3 offen
 buffer_load_dwordx4 v[44:47], v76, s[12:15], s3 offen offset:384
 buffer_load_dwordx4 v[48:51], v76, s[12:15], s3 offen offset:768
 s_cmp_eq_u32 s2, 0
 s_cselect_b32 s63, 64, 0
 v_cmp_eq_u32 vcc, 0, v0
 v_mov_b32 v8, s63
 v_mov_b64 v[12:13], 0
 v_cndmask_b32 v4, 0, v8, vcc
 v_mov_b64 v[14:15], 0
 v_mov_b32 v5, v4
 v_mov_b32 v6, v4
 v_mov_b32 v7, v4
 v_mov_b32 v8, -1
 v_lshlrev_b32 v9, 4, v0
 v_lshlrev_b32 v10, 2, v0
 s_lshl_b32 s63, s2, 13
 s_add_u32 s66, s63, 4096
 s_lshl_b32 s67, s2, 10
 s_add_u32 s67, s67, 2097152
 buffer_store_dwordx4 v[4:7], v9, s[8:11], s63 offen sc1
 buffer_store_dwordx4 v[12:15], v9, s[8:11], s66 offen sc1
 buffer_store_dword v8, v10, s[8:11], s67 offen sc1
 v_mov_b32 v2, s2
 v_cmp_eq_u32 vcc, 0, v0
 s_lshr_b32 s57, s2, 3
 s_mov_b32 s7, 0
 v_cndmask_b32 v79, v3, v2, vcc
 s_cmp_ge_u32 s56, 8
 s_cbranch_scc1 L_norole
L_dispatch:
 s_lshl_b32 s63, s56, 2
 s_lshr_b32 s56, 0x73415260, s63
 s_and_b32 s56, s56, 7
 s_and_b32 s60, s56, 1
 s_lshr_b32 s63, s56, 1
 s_cmp_eq_u32 s63, 0
 s_cbranch_scc1 L_chain
 s_cmp_eq_u32 s63, 1
 s_cbranch_scc1 L_qkv
 s_cmp_eq_u32 s63, 2
 s_cbranch_scc1 L_j_rg
 s_cmp_lt_u32 s57, 24
 s_cbranch_scc1 L_up
 s_branch L_att
L_j_rg:
 s_cmp_ge_u32 s57, 24
 s_cbranch_scc1 L_red
 s_cmp_eq_u32 s60, 0
 s_cbranch_scc1 L_wo
 s_branch L_dn
L_norole:
 s_cmp_lg_u32 s7, 0
 s_cbranch_scc1 Lln_1
 s_waitcnt vmcnt(3)
 v_lshlrev_b32 v52, 16, v40
 v_and_b32 v53, 0xffff0000, v40
 v_lshlrev_b32 v54, 16, v41
 v_and_b32 v55, 0xffff0000, v41
 v_lshlrev_b32 v56, 16, v42
 v_and_b32 v57, 0xffff0000, v42
 v_lshlrev_b32 v58, 16, v43
 v_and_b32 v59, 0xffff0000, v43
 v_lshlrev_b32 v60, 16, v44
 v_and_b32 v61, 0xffff0000, v44
 v_lshlrev_b32 v62, 16, v45
 v_and_b32 v63, 0xffff0000, v45
 v_lshlrev_b32 v64, 16, v46
 v_and_b32 v65, 0xffff0000, v46
 v_lshlrev_b32 v66, 16, v47
 v_and_b32 v67, 0xffff0000, v47
 v_lshlrev_b32 v68, 16, v48
 v_and_b32 v69, 0xffff0000, v48
 v_lshlrev_b32 v70, 16, v49
 v_and_b32 v71, 0xffff0000, v49
 v_lshlrev_b32 v72, 16, v50
 v_and_b32 v73, 0xffff0000, v50
 v_lshlrev_b32 v74, 16, v51
 v_and_b32 v75, 0xffff0000, v51
 v_pk_add_f32 v[20:21], v[52:53], v[54:55]
 v_pk_add_f32 v[20:21], v[20:21], v[56:57]
 v_pk_add_f32 v[20:21], v[20:21], v[58:59]
 v_pk_add_f32 v[20:21], v[20:21], v[60:61]
 v_pk_add_f32 v[20:21], v[20:21], v[62:63]
 v_pk_add_f32 v[20:21], v[20:21], v[64:65]
 v_pk_add_f32 v[20:21], v[20:21], v[66:67]
 v_pk_add_f32 v[20:21], v[20:21], v[68:69]
 v_pk_add_f32 v[20:21], v[20:21], v[70:71]
 v_pk_add_f32 v[20:21], v[20:21], v[72:73]
 v_pk_add_f32 v[20:21], v[20:21], v[74:75]
 v_add_f32 v20, v20, v21
 s_nop 1
 v_add_f32_dpp v20, v20, v20 quad_perm:[1,0,3,2] row_mask:0xf bank_mask:0xf
 s_nop 1
 v_add_f32_dpp v20, v20, v20 quad_perm:[2,3,0,1] row_mask:0xf bank_mask:0xf
 s_nop 1
 v_add_f32_dpp v20, v20, v20 row_half_mirror row_mask:0xf bank_mask:0xf
 s_nop 1
 v_add_f32_dpp v20, v20, v20 row_mirror row_mask:0xf bank_mask:0xf
 v_mov_b32 v21, v20
 s_nop 1
 v_permlane16_swap_b32 v20, v21
 v_add_f32 v20, v20, v21
 v_mul_f32 v20, v78, v20
 v_pk_add_f32 v[52:53], v[52:53], v[20:21] op_sel_hi:[1,0]
 v_pk_add_f32 v[54:55], v[54:55], v[20:21] op_sel_hi:[1,0]
 v_pk_add_f32 v[56:57], v[56:57], v[20:21] op_sel_hi:[1,0]
 v_pk_add_f32 v[58:59], v[58:59], v[20:21] op_sel_hi:[1,0]
 v_pk_add_f32 v[60:61], v[60:61], v[20:21] op_sel_hi:[1,0]
 v_pk_add_f32 v[62:63], v[62:63], v[20:21] op_sel_hi:[1,0]
 v_pk_add_f32 v[64:65], v[64:65], v[20:21] op_sel_hi:[1,0]
 v_pk_add_f32 v[66:67], v[66:67], v[20:21] op_sel_hi:[1,0]
 v_pk_add_f32 v[68:69], v[68:69], v[20:21] op_sel_hi:[1,0]
 v_pk_add_f32 v[70:71], v[70:71], v[20:21] op_sel_hi:[1,0]
 v_pk_add_f32 v[72:73], v[72:73], v[20:21] op_sel_hi:[1,0]
 v_pk_add_f32 v[74:75], v[74:75], v[20:21] op_sel_hi:[1,0]
 v_pk_mul_f32 v[22:23], v[52:53], v[52:53]
 v_pk_fma_f32 v[22:23], v[54:55], v[54:55], v[22:23]
 v_pk_fma_f32 v[22:23], v[56:57], v[56:57], v[22:23]
 v_pk_fma_f32 v[22:23], v[58:59], v[58:59], v[22:23]
 v_pk_fma_f32 v[22:23], v[60:61], v[60:61], v[22:23]
 v_pk_fma_f32 v[22:23], v[62:63], v[62:63], v[22:23]
 v_pk_fma_f32 v[22:23], v[64:65], v[64:65], v[22:23]
 v_pk_fma_f32 v[22:23], v[66:67], v[66:67], v[22:23]
 v_pk_fma_f32 v[22:23], v[68:69], v[68:69], v[22:23]
 v_pk_fma_f32 v[22:23], v[70:71], v[70:71], v[22:23]
 v_pk_fma_f32 v[22:23], v[72:73], v[72:73], v[22:23]
 v_pk_fma_f32 v[22:23], v[74:75], v[74:75], v[22:23]
 v_add_f32 v22, v22, v23
 s_nop 1
 v_add_f32_dpp v22, v22, v22 quad_perm:[1,0,3,2] row_mask:0xf bank_mask:0xf
 s_nop 1
 v_add_f32_dpp v22, v22, v22 quad_perm:[2,3,0,1] row_mask:0xf bank_mask:0xf
 s_nop 1
 v_add_f32_dpp v22, v22, v22 row_half_mirror row_mask:0xf bank_mask:0xf
 s_nop 1
 v_add_f32_dpp v22, v22, v22 row_mirror row_mask:0xf bank_mask:0xf
 v_mov_b32 v23, v22
 s_nop 1
 v_permlane16_swap_b32 v22, v23
 v_add_f32 v22, v22, v23
 v_mov_b32 v23, 0x3727c5ac
 v_fmac_f32 v23, 0x3ae38e39, v22
 v_rsq_f32 v22, v23
 v_sub_f32 v20, 0, v20
 v_mul_f32 v21, v23, v22
 v_lshrrev_b32 v76, 2, v0
 v_and_b32 v78, 31, v0
 v_cmp_eq_u32 vcc, 0, v78
 v_mov_b32 v78, 2147483632
 s_lshl_b32 s63, s2, 6
 v_cndmask_b32 v76, v78, v76, vcc
 s_add_u32 s63, s63, 12582912
 buffer_store_dwordx2 v[20:21], v76, s[8:11], s63 offen sc1
 s_add_u32 s63, s3, 3145728
 v_pk_mul_f32 v[52:53], v[52:53], v[22:23] op_sel_hi:[1,0]
 v_pk_mul_f32 v[54:55], v[54:55], v[22:23] op_sel_hi:[1,0]
 v_pk_mul_f32 v[56:57], v[56:57], v[22:23] op_sel_hi:[1,0]
 v_pk_mul_f32 v[58:59], v[58:59], v[22:23] op_sel_hi:[1,0]
 v_pk_mul_f32 v[60:61], v[60:61], v[22:23] op_sel_hi:[1,0]
 v_pk_mul_f32 v[62:63], v[62:63], v[22:23] op_sel_hi:[1,0]
 v_pk_mul_f32 v[64:65], v[64:65], v[22:23] op_sel_hi:[1,0]
 v_pk_mul_f32 v[66:67], v[66:67], v[22:23] op_sel_hi:[1,0]
 v_pk_mul_f32 v[68:69], v[68:69], v[22:23] op_sel_hi:[1,0]
 v_pk_mul_f32 v[70:71], v[70:71], v[22:23] op_sel_hi:[1,0]
 v_pk_mul_f32 v[72:73], v[72:73], v[22:23] op_sel_hi:[1,0]
 v_pk_mul_f32 v[74:75], v[74:75], v[22:23] op_sel_hi:[1,0]
 v_cvt_pk_bf16_f32 v40, v52, v53
 v_cvt_pk_bf16_f32 v41, v54, v55
 v_cvt_pk_bf16_f32 v42, v56, v57
 v_cvt_pk_bf16_f32 v43, v58, v59
 v_cvt_pk_bf16_f32 v44, v60, v61
 v_cvt_pk_bf16_f32 v45, v62, v63
 v_cvt_pk_bf16_f32 v46, v64, v65
 v_cvt_pk_bf16_f32 v47, v66, v67
 v_cvt_pk_bf16_f32 v48, v68, v69
 v_cvt_pk_bf16_f32 v49, v70, v71
 v_cvt_pk_bf16_f32 v50, v72, v73
 v_cvt_pk_bf16_f32 v51, v74, v75
 buffer_store_dwordx4 v[40:43], v77, s[8:11], s63 offen offset:0 sc1
 buffer_store_dwordx4 v[44:47], v77, s[8:11], s63 offen offset:384 sc1
 buffer_store_dwordx4 v[48:51], v77, s[8:11], s63 offen offset:768 sc1
Lln_1:
 s_waitcnt vmcnt(0)
 s_cmp_lg_u32 s7, 0
 s_cbranch_scc1 Lar_2
 s_or_b32 s63, s6, 0x80
 v_mov_b32 v20, s63
 s_barrier
 buffer_store_byte v20, v79, s[20:23], 0 offen sc1
Lar_2:
 s_cmp_eq_u32 s7, 1
 s_cbranch_scc1 Lvalok_5
 v_mbcnt_lo_u32_b32 v1, -1, 0
 v_mbcnt_hi_u32_b32 v1, -1, v1
 v_lshlrev_b32 v1, 2, v1
 s_mov_b32 s62, 0
 s_mov_b32 s63, 0x80808080
 s_cmp_lg_u32 s58, 0
 s_cbranch_scc1 Lvald_4
Lval_3:
 buffer_load_dword v2, v1, s[20:23], 0 offen sc1
 s_waitcnt vmcnt(0)
 v_and_b32 v3, s63, v2
 v_cmp_ne_u32 vcc, s63, v3
 s_cbranch_vccz Lvald_4
 s_add_u32 s62, s62, 1
 s_cmp_lt_u32 s62, 400000
 s_cbranch_scc1 Lval_3
Lvald_4:
 s_barrier
 buffer_load_dword v2, v1, s[20:23], 0 offen sc1
 s_waitcnt vmcnt(0)
 v_and_b32 v3, s63, v2
 v_cmp_ne_u32 vcc, s63, v3
 s_mov_b32 s63, 1
 s_cbranch_vccnz L_abort
 v_lshlrev_b32 v3, v2, 1
 v_lshrrev_b32 v4, 8, v2
 v_lshl_or_b32 v3, 1, v4, v3
 v_lshrrev_b32 v4, 16, v2
 v_lshl_or_b32 v3, 1, v4, v3
 v_lshrrev_b32 v4, 24, v2
 v_lshl_or_b32 v3, 1, v4, v3
 s_nop 1
 v_or_b32_dpp v3, v3, v3 quad_perm:[1,0,3,2] row_mask:0xf bank_mask:0xf
 v_cmp_ne_u32 vcc, 255, v3
 s_cbranch_vccnz L_rerank
 s_mov_b32 s7, 1
Lvalok_5:
 s_mov_b32 s63, 2
 s_branch L_abort
L_rerank:
 s_mov_b32 s7, 1
 s_mov_b32 s64, 0
L_rr1:
 s_mov_b32 s65, 0
 s_mov_b32 s66, 0
 v_bfe_u32 v3, v2, 0, 7
 v_cmp_eq_u32 vcc, s64, v3
 v_add_u32 v4, 0, v1
 v_cmp_gt_u32 s[68:69], s2, v4
 s_bcnt1_i32_b64 s63, vcc
 s_add_u32 s65, s65, s63
 s_and_b64 s[68:69], s[68:69], vcc
 s_bcnt1_i32_b64 s63, s[68:69]
 s_add_u32 s66, s66, s63
 v_bfe_u32 v3, v2, 8, 7
 v_cmp_eq_u32 vcc, s64, v3
 v_add_u32 v4, 1, v1
 v_cmp_gt_u32 s[68:69], s2, v4
 s_bcnt1_i32_b64 s63, vcc
 s_add_u32 s65, s65, s63
 s_and_b64 s[68:69], s[68:69], vcc
 s_bcnt1_i32_b64 s63, s[68:69]
 s_add_u32 s66, s66, s63
 v_bfe_u32 v3, v2, 16, 7
 v_cmp_eq_u32 vcc, s64, v3
 v_add_u32 v4, 2, v1
 v_cmp_gt_u32 s[68:69], s2, v4
 s_bcnt1_i32_b64 s63, vcc
 s_add_u32 s65, s65, s63
 s_and_b64 s[68:69], s[68:69], vcc
 s_bcnt1_i32_b64 s63, s[68:69]
 s_add_u32 s66, s66, s63
 v_bfe_u32 v3, v2, 24, 7
 v_cmp_eq_u32 vcc, s64, v3
 v_add_u32 v4, 3, v1
 v_cmp_gt_u32 s[68:69], s2, v4
 s_bcnt1_i32_b64 s63, vcc
 s_add_u32 s65, s65, s63
 s_and_b64 s[68:69], s[68:69], vcc
 s_bcnt1_i32_b64 s63, s[68:69]
 s_add_u32 s66, s66, s63
 s_cmp_eq_u32 s64, s6
 s_cselect_b32 s57, s66, s57
 s_cmp_lg_u32 s65, 32
 s_cselect_b32 s59, 1, s59
 s_add_u32 s64, s64, 1
 s_cmp_lt_u32 s64, 8
 s_cbranch_scc1 L_rr1
 s_mov_b32 s56, s6
 s_cmp_eq_u32 s59, 0
 s_cbranch_scc1 L_rr2
 s_lshr_b32 s56, s2, 5
 s_and_b32 s57, s2, 31
L_rr2:
 s_waitcnt vmcnt(0) lgkmcnt(0)
 s_barrier
 s_branch L_dispatch
L_abort:
 s_lshl_b32 s64, s56, 8
 s_or_b32 s63, s63, s64
 s_lshl_b32 s64, s61, 16
 s_or_b32 s63, s63, s64
 s_or_b32 s63, s63, 0x80000000
 s_mov_b64 exec, 1
 v_mov_b64 v[4:5], 0
 v_mov_b64 v[6:7], 0
 ds_write_b128 v4, v[4:7]
 ds_write_b32 v4, v4 offset:4096
 v_mov_b32 v1, s63
 s_lshl_b32 s64, s56, 2
 s_add_u32 s64, s64, 251654144
 v_mov_b32 v2, s64
 buffer_store_dword v1, v2, s[8:11], 0 offen
 s_waitcnt vmcnt(0)
L_end:
 s_endpgm
L_chain:
 s_cmp_eq_u32 s60, 0
 s_cbranch_scc1 Ld1_6
 s_cmp_lg_u32 s7, 0
 s_cbranch_scc1 Ld1_6
 v_mbcnt_lo_u32_b32 v1, -1, 0
 v_mbcnt_hi_u32_b32 v1, -1, v1
 s_mov_b32 s63, 0
 s_add_u32 s63, s63, s57
 s_lshl_b32 s63, s63, 2
 s_add_u32 s63, s63, s58
 s_lshl_b32 s63, s63, 10
 v_lshl_add_u32 v10, v1, 4, s63
 s_lshl_b32 s64, s58, 10
 s_mov_b32 m0, s64
 s_mov_b32 s65, 0
 buffer_load_dwordx4 v10, s[32:35], s65 offen lds
 buffer_load_dwordx4 v10, s[28:31], s65 offen lds
 s_mov_b32 s65, 524288
 buffer_load_dwordx4 v10, s[32:35], s65 offen lds
 buffer_load_dwordx4 v10, s[28:31], s65 offen lds
 s_mov_b32 s65, 1048576
 buffer_load_dwordx4 v10, s[32:35], s65 offen lds
 buffer_load_dwordx4 v10, s[28:31], s65 offen lds
 s_mov_b32 s65, 1572864
 buffer_load_dwordx4 v10, s[32:35], s65 offen lds
 buffer_load_dwordx4 v10, s[28:31], s65 offen lds
 s_cmp_lg_u32 s7, 0
 s_cbranch_scc1 Lln_7
 s_waitcnt vmcnt(11)
 v_lshlrev_b32 v52, 16, v40
 v_and_b32 v53, 0xffff0000, v40
 v_lshlrev_b32 v54, 16, v41
 v_and_b32 v55, 0xffff0000, v41
 v_lshlrev_b32 v56, 16, v42
 v_and_b32 v57, 0xffff0000, v42
 v_lshlrev_b32 v58, 16, v43
 v_and_b32 v59, 0xffff0000, v43
 v_lshlrev_b32 v60, 16, v44
 v_and_b32 v61, 0xffff0000, v44
 v_lshlrev_b32 v62, 16, v45
 v_and_b32 v63, 0xffff0000, v45
 v_lshlrev_b32 v64, 16, v46
 v_and_b32 v65, 0xffff0000, v46
 v_lshlrev_b32 v66, 16, v47
 v_and_b32 v67, 0xffff0000, v47
 v_lshlrev_b32 v68, 16, v48
 v_and_b32 v69, 0xffff0000, v48
 v_lshlrev_b32 v70, 16, v49
 v_and_b32 v71, 0xffff0000, v49
 v_lshlrev_b32 v72, 16, v50
 v_and_b32 v73, 0xffff0000, v50
 v_lshlrev_b32 v74, 16, v51
 v_and_b32 v75, 0xffff0000, v51
 v_pk_add_f32 v[20:21], v[52:53], v[54:55]
 v_pk_add_f32 v[20:21], v[20:21], v[56:57]
 v_pk_add_f32 v[20:21], v[20:21], v[58:59]
 v_pk_add_f32 v[20:21], v[20:21], v[60:61]
 v_pk_add_f32 v[20:21], v[20:21], v[62:63]
 v_pk_add_f32 v[20:21], v[20:21], v[64:65]
 v_pk_add_f32 v[20:21], v[20:21], v[66:67]
 v_pk_add_f32 v[20:21], v[20:21], v[68:69]
 v_pk_add_f32 v[20:21], v[20:21], v[70:71]
 v_pk_add_f32 v[20:21], v[20:21], v[72:73]
 v_pk_add_f32 v[20:21], v[20:21], v[74:75]
 v_add_f32 v20, v20, v21
 s_nop 1
 v_add_f32_dpp v20, v20, v20 quad_perm:[1,0,3,2] row_mask:0xf bank_mask:0xf
 s_nop 1
 v_add_f32_dpp v20, v20, v20 quad_perm:[2,3,0,1] row_mask:0xf bank_mask:0xf
 s_nop 1
 v_add_f32_dpp v20, v20, v20 row_half_mirror row_mask:0xf bank_mask:0xf
 s_nop 1
 v_add_f32_dpp v20, v20, v20 row_mirror row_mask:0xf bank_mask:0xf
 v_mov_b32 v21, v20
 s_nop 1
 v_permlane16_swap_b32 v20, v21
 v_add_f32 v20, v20, v21
 v_mul_f32 v20, v78, v20
 v_pk_add_f32 v[52:53], v[52:53], v[20:21] op_sel_hi:[1,0]
 v_pk_add_f32 v[54:55], v[54:55], v[20:21] op_sel_hi:[1,0]
 v_pk_add_f32 v[56:57], v[56:57], v[20:21] op_sel_hi:[1,0]
 v_pk_add_f32 v[58:59], v[58:59], v[20:21] op_sel_hi:[1,0]
 v_pk_add_f32 v[60:61], v[60:61], v[20:21] op_sel_hi:[1,0]
 v_pk_add_f32 v[62:63], v[62:63], v[20:21] op_sel_hi:[1,0]
 v_pk_add_f32 v[64:65], v[64:65], v[20:21] op_sel_hi:[1,0]
 v_pk_add_f32 v[66:67], v[66:67], v[20:21] op_sel_hi:[1,0]
 v_pk_add_f32 v[68:69], v[68:69], v[20:21] op_sel_hi:[1,0]
 v_pk_add_f32 v[70:71], v[70:71], v[20:21] op_sel_hi:[1,0]
 v_pk_add_f32 v[72:73], v[72:73], v[20:21] op_sel_hi:[1,0]
 v_pk_add_f32 v[74:75], v[74:75], v[20:21] op_sel_hi:[1,0]
 v_pk_mul_f32 v[22:23], v[52:53], v[52:53]
 v_pk_fma_f32 v[22:23], v[54:55], v[54:55], v[22:23]
 v_pk_fma_f32 v[22:23], v[56:57], v[56:57], v[22:23]
 v_pk_fma_f32 v[22:23], v[58:59], v[58:59], v[22:23]
 v_pk_fma_f32 v[22:23], v[60:61], v[60:61], v[22:23]
 v_pk_fma_f32 v[22:23], v[62:63], v[62:63], v[22:23]
 v_pk_fma_f32 v[22:23], v[64:65], v[64:65], v[22:23]
 v_pk_fma_f32 v[22:23], v[66:67], v[66:67], v[22:23]
 v_pk_fma_f32 v[22:23], v[68:69], v[68:69], v[22:23]
 v_pk_fma_f32 v[22:23], v[70:71], v[70:71], v[22:23]
 v_pk_fma_f32 v[22:23], v[72:73], v[72:73], v[22:23]
 v_pk_fma_f32 v[22:23], v[74:75], v[74:75], v[22:23]
 v_add_f32 v22, v22, v23
 s_nop 1
 v_add_f32_dpp v22, v22, v22 quad_perm:[1,0,3,2] row_mask:0xf bank_mask:0xf
 s_nop 1
 v_add_f32_dpp v22, v22, v22 quad_perm:[2,3,0,1] row_mask:0xf bank_mask:0xf
 s_nop 1
 v_add_f32_dpp v22, v22, v22 row_half_mirror row_mask:0xf bank_mask:0xf
 s_nop 1
 v_add_f32_dpp v22, v22, v22 row_mirror row_mask:0xf bank_mask:0xf
 v_mov_b32 v23, v22
 s_nop 1
 v_permlane16_swap_b32 v22, v23
 v_add_f32 v22, v22, v23
 v_mov_b32 v23, 0x3727c5ac
 v_fmac_f32 v23, 0x3ae38e39, v22
 v_rsq_f32 v22, v23
 v_sub_f32 v20, 0, v20
 v_mul_f32 v21, v23, v22
 v_lshrrev_b32 v76, 2, v0
 v_and_b32 v78, 31, v0
 v_cmp_eq_u32 vcc, 0, v78
 v_mov_b32 v78, 2147483632
 s_lshl_b32 s63, s2, 6
 v_cndmask_b32 v76, v78, v76, vcc
 s_add_u32 s63, s63, 12582912
 buffer_store_dwordx2 v[20:21], v76, s[8:11], s63 offen sc1
 s_add_u32 s63, s3, 3145728
 v_pk_mul_f32 v[52:53], v[52:53], v[22:23] op_sel_hi:[1,0]
 v_pk_mul_f32 v[54:55], v[54:55], v[22:23] op_sel_hi:[1,0]
 v_pk_mul_f32 v[56:57], v[56:57], v[22:23] op_sel_hi:[1,0]
 v_pk_mul_f32 v[58:59], v[58:59], v[22:23] op_sel_hi:[1,0]
 v_pk_mul_f32 v[60:61], v[60:61], v[22:23] op_sel_hi:[1,0]
 v_pk_mul_f32 v[62:63], v[62:63], v[22:23] op_sel_hi:[1,0]
 v_pk_mul_f32 v[64:65], v[64:65], v[22:23] op_sel_hi:[1,0]
 v_pk_mul_f32 v[66:67], v[66:67], v[22:23] op_sel_hi:[1,0]
 v_pk_mul_f32 v[68:69], v[68:69], v[22:23] op_sel_hi:[1,0]
 v_pk_mul_f32 v[70:71], v[70:71], v[22:23] op_sel_hi:[1,0]
 v_pk_mul_f32 v[72:73], v[72:73], v[22:23] op_sel_hi:[1,0]
 v_pk_mul_f32 v[74:75], v[74:75], v[22:23] op_sel_hi:[1,0]
 v_cvt_pk_bf16_f32 v40, v52, v53
 v_cvt_pk_bf16_f32 v41, v54, v55
 v_cvt_pk_bf16_f32 v42, v56, v57
 v_cvt_pk_bf16_f32 v43, v58, v59
 v_cvt_pk_bf16_f32 v44, v60, v61
 v_cvt_pk_bf16_f32 v45, v62, v63
 v_cvt_pk_bf16_f32 v46, v64, v65
 v_cvt_pk_bf16_f32 v47, v66, v67
 v_cvt_pk_bf16_f32 v48, v68, v69
 v_cvt_pk_bf16_f32 v49, v70, v71
 v_cvt_pk_bf16_f32 v50, v72, v73
 v_cvt_pk_bf16_f32 v51, v74, v75
 buffer_store_dwordx4 v[40:43], v77, s[8:11], s63 offen offset:0 sc1
 buffer_store_dwordx4 v[44:47], v77, s[8:11], s63 offen offset:384 sc1
 buffer_store_dwordx4 v[48:51], v77, s[8:11], s63 offen offset:768 sc1
Lln_7:
 s_mov_b32 s65, 2097152
 buffer_load_dwordx4 v10, s[32:35], s65 offen lds
 buffer_load_dwordx4 v10, s[28:31], s65 offen lds
 s_mov_b32 s65, 2621440
 buffer_load_dwordx4 v10, s[32:35], s65 offen lds
 buffer_load_dwordx4 v10, s[28:31], s65 offen lds
 s_mov_b32 s65, 3145728
 buffer_load_dwordx4 v10, s[32:35], s65 offen lds
 buffer_load_dwordx4 v10, s[28:31], s65 offen lds
 s_waitcnt vmcnt(6)
 s_cmp_lg_u32 s7, 0
 s_cbranch_scc1 Lar_8
 s_or_b32 s63, s6, 0x80
 v_mov_b32 v20, s63
 s_barrier
 buffer_store_byte v20, v79, s[20:23], 0 offen sc1
Lar_8:
 s_mov_b32 s65, 3670016
 buffer_load_dwordx4 v10, s[32:35], s65 offen lds
 buffer_load_dwordx4 v10, s[28:31], s65 offen lds
 s_mov_b32 s65, 4194304
 buffer_load_dwordx4 v10, s[32:35], s65 offen lds
 buffer_load_dwordx4 v10, s[28:31], s65 offen lds
 s_mov_b32 s65, 0
 buffer_load_dwordx4 v10, s[36:39], s65 offen lds
 buffer_load_dwordx4 v10, s[40:43], s65 offen lds
 s_mov_b32 s65, 524288
 buffer_load_dwordx4 v10, s[36:39], s65 offen lds
 buffer_load_dwordx4 v10, s[40:43], s65 offen lds
 s_mov_b32 s65, 1048576
 buffer_load_dwordx4 v10, s[36:39], s65 offen lds
 buffer_load_dwordx4 v10, s[40:43], s65 offen lds
 s_mov_b32 s65, 1572864
 buffer_load_dwordx4 v10, s[36:39], s65 offen lds
 buffer_load_dwordx4 v10, s[40:43], s65 offen lds
 s_mov_b32 s65, 2097152
 buffer_load_dwordx4 v10, s[36:39], s65 offen lds
 buffer_load_dwordx4 v10, s[40:43], s65 offen lds
 s_mov_b32 s65, 2621440
 buffer_load_dwordx4 v10, s[36:39], s65 offen lds
 buffer_load_dwordx4 v10, s[40:43], s65 offen lds
 s_mov_b32 s65, 3145728
 buffer_load_dwordx4 v10, s[36:39], s65 offen lds
 buffer_load_dwordx4 v10, s[40:43], s65 offen lds
 s_mov_b32 s65, 3670016
 buffer_load_dwordx4 v10, s[36:39], s65 offen lds
 buffer_load_dwordx4 v10, s[40:43], s65 offen lds
 s_mov_b32 s65, 4194304
 buffer_load_dwordx4 v10, s[36:39], s65 offen lds
 buffer_load_dwordx4 v10, s[40:43], s65 offen lds
 s_waitcnt vmcnt(0)
 s_mov_b32 s7, 2
 s_barrier
Ld1_6:
 v_mbcnt_lo_u32_b32 v1, -1, 0
 v_mbcnt_hi_u32_b32 v1, -1, v1
 v_lshrrev_b32 v2, 5, v1
 v_bfe_u32 v3, v1, 4, 1
 v_bfe_u32 v4, v1, 3, 1
 v_bfe_u32 v5, v1, 2, 1
 v_and_b32 v6, 3, v1
 v_lshlrev_b32 v7, 4, v6
 v_lshl_add_u32 v8, v2, 2, v3
 v_lshl_add_u32 v8, v4, 1, v8
 v_lshlrev_b32 v8, 1, v8
 v_lshl_add_u32 v8, v5, 4, v8
 v_lshl_add_u32 v10, v8, 13, v7
 v_mul_u32_u24 v8, 144, v2
 v_lshl_add_u32 v8, v3, 2, v8
 v_lshl_add_u32 v8, v4, 3, v8
 v_add_u32 v8, v8, v5
 v_lshl_add_u32 v11, v8, 13, v7
 s_mul_i32 s67, s58, 36864
 v_lshrrev_b32 v8, 2, v1
 v_lshl_add_u32 v9, v8, 6, s67
 v_lshl_add_u32 v13, v6, 3, v9
 v_lshl_add_u32 v14, v6, 4, v9
 v_lshrrev_b32 v8, 4, v1
 v_lshl_add_u32 v8, v8, 2, v5
 v_mul_u32_u24 v8, 288, v8
 v_lshl_add_u32 v8, v6, 3, v8
 v_add_u32 v8, s67, v8
 v_lshl_add_u32 v15, v4, 5, v8
 v_mul_u32_u24 v9, 9216, v4
 v_add_u32 v12, v9, v8
 v_lshl_add_u32 v16, v1, 4, s67
 s_lshl_b32 s65, s57, 8
 s_lshl_b32 s63, s58, 6
 s_add_u32 s65, s65, s63
 s_mul_i32 s66, s57, 147456
 s_mul_i32 s63, s58, 288
 s_add_u32 s66, s66, s63
 v_add_u32 v8, 0, v1
 v_mul_u32_u24 v9, 3641, v8
 v_lshrrev_b32 v9, 16, v9
 v_mul_u32_u24 v17, 18, v9
 v_sub_u32 v8, v8, v17
 v_mul_u32_u24 v9, 1152, v9
 v_lshl_add_u32 v24, v8, 4, v9
 v_add_u32 v8, 64, v1
 v_mul_u32_u24 v9, 3641, v8
 v_lshrrev_b32 v9, 16, v9
 v_mul_u32_u24 v17, 18, v9
 v_sub_u32 v8, v8, v17
 v_mul_u32_u24 v9, 1152, v9
 v_lshl_add_u32 v25, v8, 4, v9
 v_add_u32 v8, 128, v1
 v_mul_u32_u24 v9, 3641, v8
 v_lshrrev_b32 v9, 16, v9
 v_mul_u32_u24 v17, 18, v9
 v_sub_u32 v8, v8, v17
 v_mul_u32_u24 v9, 1152, v9
 v_lshl_add_u32 v26, v8, 4, v9
 v_add_u32 v8, 192, v1
 v_mul_u32_u24 v9, 3641, v8
 v_lshrrev_b32 v9, 16, v9
 v_mul_u32_u24 v17, 18, v9
 v_sub_u32 v8, v8, v17
 v_mul_u32_u24 v9, 1152, v9
 v_lshl_add_u32 v27, v8, 4, v9
 v_add_u32 v8, 256, v1
 v_mul_u32_u24 v9, 3641, v8
 v_lshrrev_b32 v9, 16, v9
 v_mul_u32_u24 v17, 18, v9
 v_sub_u32 v8, v8, v17
 v_mul_u32_u24 v9, 1152, v9
 v_lshl_add_u32 v28, v8, 4, v9
 v_add_u32 v8, 320, v1
 v_mul_u32_u24 v9, 3641, v8
 v_lshrrev_b32 v9, 16, v9
 v_mul_u32_u24 v17, 18, v9
 v_sub_u32 v8, v8, v17
 v_mul_u32_u24 v9, 1152, v9
 v_lshl_add_u32 v29, v8, 4, v9
 v_add_u32 v8, 384, v1
 v_mul_u32_u24 v9, 3641, v8
 v_lshrrev_b32 v9, 16, v9
 v_mul_u32_u24 v17, 18, v9
 v_sub_u32 v8, v8, v17
 v_mul_u32_u24 v9, 1152, v9
 v_lshl_add_u32 v30, v8, 4, v9
 v_add_u32 v8, 448, v1
 v_mul_u32_u24 v9, 3641, v8
 v_lshrrev_b32 v9, 16, v9
 v_mul_u32_u24 v17, 18, v9
 v_sub_u32 v8, v8, v17
 v_mul_u32_u24 v9, 1152, v9
 v_lshl_add_u32 v31, v8, 4, v9
 v_add_u32 v8, 512, v1
 v_mul_u32_u24 v9, 3641, v8
 v_lshrrev_b32 v9, 16, v9
 v_mul_u32_u24 v17, 18, v9
 v_sub_u32 v8, v8, v17
 v_mul_u32_u24 v9, 1152, v9
 v_lshl_add_u32 v32, v8, 4, v9
 s_add_u32 m0, s67, 0
 s_add_u32 s69, s65, 0
 buffer_load_dwordx4 v10, s[28:31], s69 offen lds
 s_add_u32 m0, s67, 1024
 s_add_u32 s69, s65, 8192
 buffer_load_dwordx4 v10, s[28:31], s69 offen lds
 s_add_u32 m0, s67, 2048
 s_add_u32 s69, s65, 262144
 buffer_load_dwordx4 v10, s[28:31], s69 offen lds
 s_add_u32 m0, s67, 3072
 s_add_u32 s69, s65, 270336
 buffer_load_dwordx4 v10, s[28:31], s69 offen lds
 s_add_u32 m0, s67, 4096
 s_add_u32 s69, s65, 524288
 buffer_load_dwordx4 v10, s[28:31], s69 offen lds
 s_add_u32 m0, s67, 5120
 s_add_u32 s69, s65, 532480
 buffer_load_dwordx4 v10, s[28:31], s69 offen lds
 s_add_u32 m0, s67, 6144
 s_add_u32 s69, s65, 786432
 buffer_load_dwordx4 v10, s[28:31], s69 offen lds
 s_add_u32 m0, s67, 7168
 s_add_u32 s69, s65, 794624
 buffer_load_dwordx4 v10, s[28:31], s69 offen lds
 s_cmp_lg_u32 s7, 0
 s_cbranch_scc1 Lln_9
 s_waitcnt vmcnt(11)
 v_lshlrev_b32 v52, 16, v40
 v_and_b32 v53, 0xffff0000, v40
 v_lshlrev_b32 v54, 16, v41
 v_and_b32 v55, 0xffff0000, v41
 v_lshlrev_b32 v56, 16, v42
 v_and_b32 v57, 0xffff0000, v42
 v_lshlrev_b32 v58, 16, v43
 v_and_b32 v59, 0xffff0000, v43
 v_lshlrev_b32 v60, 16, v44
 v_and_b32 v61, 0xffff0000, v44
 v_lshlrev_b32 v62, 16, v45
 v_and_b32 v63, 0xffff0000, v45
 v_lshlrev_b32 v64, 16, v46
 v_and_b32 v65, 0xffff0000, v46
 v_lshlrev_b32 v66, 16, v47
 v_and_b32 v67, 0xffff0000, v47
 v_lshlrev_b32 v68, 16, v48
 v_and_b32 v69, 0xffff0000, v48
 v_lshlrev_b32 v70, 16, v49
 v_and_b32 v71, 0xffff0000, v49
 v_lshlrev_b32 v72, 16, v50
 v_and_b32 v73, 0xffff0000, v50
 v_lshlrev_b32 v74, 16, v51
 v_and_b32 v75, 0xffff0000, v51
 v_pk_add_f32 v[20:21], v[52:53], v[54:55]
 v_pk_add_f32 v[20:21], v[20:21], v[56:57]
 v_pk_add_f32 v[20:21], v[20:21], v[58:59]
 v_pk_add_f32 v[20:21], v[20:21], v[60:61]
 v_pk_add_f32 v[20:21], v[20:21], v[62:63]
 v_pk_add_f32 v[20:21], v[20:21], v[64:65]
 v_pk_add_f32 v[20:21], v[20:21], v[66:67]
 v_pk_add_f32 v[20:21], v[20:21], v[68:69]
 v_pk_add_f32 v[20:21], v[20:21], v[70:71]
 v_pk_add_f32 v[20:21], v[20:21], v[72:73]
 v_pk_add_f32 v[20:21], v[20:21], v[74:75]
 v_add_f32 v20, v20, v21
 s_nop 1
 v_add_f32_dpp v20, v20, v20 quad_perm:[1,0,3,2] row_mask:0xf bank_mask:0xf
 s_nop 1
 v_add_f32_dpp v20, v20, v20 quad_perm:[2,3,0,1] row_mask:0xf bank_mask:0xf
 s_nop 1
 v_add_f32_dpp v20, v20, v20 row_half_mirror row_mask:0xf bank_mask:0xf
 s_nop 1
 v_add_f32_dpp v20, v20, v20 row_mirror row_mask:0xf bank_mask:0xf
 v_mov_b32 v21, v20
 s_nop 1
 v_permlane16_swap_b32 v20, v21
 v_add_f32 v20, v20, v21
 v_mul_f32 v20, v78, v20
 v_pk_add_f32 v[52:53], v[52:53], v[20:21] op_sel_hi:[1,0]
 v_pk_add_f32 v[54:55], v[54:55], v[20:21] op_sel_hi:[1,0]
 v_pk_add_f32 v[56:57], v[56:57], v[20:21] op_sel_hi:[1,0]
 v_pk_add_f32 v[58:59], v[58:59], v[20:21] op_sel_hi:[1,0]
 v_pk_add_f32 v[60:61], v[60:61], v[20:21] op_sel_hi:[1,0]
 v_pk_add_f32 v[62:63], v[62:63], v[20:21] op_sel_hi:[1,0]
 v_pk_add_f32 v[64:65], v[64:65], v[20:21] op_sel_hi:[1,0]
 v_pk_add_f32 v[66:67], v[66:67], v[20:21] op_sel_hi:[1,0]
 v_pk_add_f32 v[68:69], v[68:69], v[20:21] op_sel_hi:[1,0]
 v_pk_add_f32 v[70:71], v[70:71], v[20:21] op_sel_hi:[1,0]
 v_pk_add_f32 v[72:73], v[72:73], v[20:21] op_sel_hi:[1,0]
 v_pk_add_f32 v[74:75], v[74:75], v[20:21] op_sel_hi:[1,0]
 v_pk_mul_f32 v[22:23], v[52:53], v[52:53]
 v_pk_fma_f32 v[22:23], v[54:55], v[54:55], v[22:23]
 v_pk_fma_f32 v[22:23], v[56:57], v[56:57], v[22:23]
 v_pk_fma_f32 v[22:23], v[58:59], v[58:59], v[22:23]
 v_pk_fma_f32 v[22:23], v[60:61], v[60:61], v[22:23]
 v_pk_fma_f32 v[22:23], v[62:63], v[62:63], v[22:23]
 v_pk_fma_f32 v[22:23], v[64:65], v[64:65], v[22:23]
 v_pk_fma_f32 v[22:23], v[66:67], v[66:67], v[22:23]
 v_pk_fma_f32 v[22:23], v[68:69], v[68:69], v[22:23]
 v_pk_fma_f32 v[22:23], v[70:71], v[70:71], v[22:23]
 v_pk_fma_f32 v[22:23], v[72:73], v[72:73], v[22:23]
 v_pk_fma_f32 v[22:23], v[74:75], v[74:75], v[22:23]
 v_add_f32 v22, v22, v23
 s_nop 1
 v_add_f32_dpp v22, v22, v22 quad_perm:[1,0,3,2] row_mask:0xf bank_mask:0xf
 s_nop 1
 v_add_f32_dpp v22, v22, v22 quad_perm:[2,3,0,1] row_mask:0xf bank_mask:0xf
 s_nop 1
 v_add_f32_dpp v22, v22, v22 row_half_mirror row_mask:0xf bank_mask:0xf
 s_nop 1
 v_add_f32_dpp v22, v22, v22 row_mirror row_mask:0xf bank_mask:0xf
 v_mov_b32 v23, v22
 s_nop 1
 v_permlane16_swap_b32 v22, v23
 v_add_f32 v22, v22, v23
 v_mov_b32 v23, 0x3727c5ac
 v_fmac_f32 v23, 0x3ae38e39, v22
 v_rsq_f32 v22, v23
 v_sub_f32 v20, 0, v20
 v_mul_f32 v21, v23, v22
 v_lshrrev_b32 v76, 2, v0
 v_and_b32 v78, 31, v0
 v_cmp_eq_u32 vcc, 0, v78
 v_mov_b32 v78, 2147483632
 s_lshl_b32 s63, s2, 6
 v_cndmask_b32 v76, v78, v76, vcc
 s_add_u32 s63, s63, 12582912
 buffer_store_dwordx2 v[20:21], v76, s[8:11], s63 offen sc1
 s_add_u32 s63, s3, 3145728
 v_pk_mul_f32 v[52:53], v[52:53], v[22:23] op_sel_hi:[1,0]
 v_pk_mul_f32 v[54:55], v[54:55], v[22:23] op_sel_hi:[1,0]
 v_pk_mul_f32 v[56:57], v[56:57], v[22:23] op_sel_hi:[1,0]
 v_pk_mul_f32 v[58:59], v[58:59], v[22:23] op_sel_hi:[1,0]
 v_pk_mul_f32 v[60:61], v[60:61], v[22:23] op_sel_hi:[1,0]
 v_pk_mul_f32 v[62:63], v[62:63], v[22:23] op_sel_hi:[1,0]
 v_pk_mul_f32 v[64:65], v[64:65], v[22:23] op_sel_hi:[1,0]
 v_pk_mul_f32 v[66:67], v[66:67], v[22:23] op_sel_hi:[1,0]
 v_pk_mul_f32 v[68:69], v[68:69], v[22:23] op_sel_hi:[1,0]
 v_pk_mul_f32 v[70:71], v[70:71], v[22:23] op_sel_hi:[1,0]
 v_pk_mul_f32 v[72:73], v[72:73], v[22:23] op_sel_hi:[1,0]
 v_pk_mul_f32 v[74:75], v[74:75], v[22:23] op_sel_hi:[1,0]
 v_cvt_pk_bf16_f32 v40, v52, v53
 v_cvt_pk_bf16_f32 v41, v54, v55
 v_cvt_pk_bf16_f32 v42, v56, v57
 v_cvt_pk_bf16_f32 v43, v58, v59
 v_cvt_pk_bf16_f32 v44, v60, v61
 v_cvt_pk_bf16_f32 v45, v62, v63
 v_cvt_pk_bf16_f32 v46, v64, v65
 v_cvt_pk_bf16_f32 v47, v66, v67
 v_cvt_pk_bf16_f32 v48, v68, v69
 v_cvt_pk_bf16_f32 v49, v70, v71
 v_cvt_pk_bf16_f32 v50, v72, v73
 v_cvt_pk_bf16_f32 v51, v74, v75
 buffer_store_dwordx4 v[40:43], v77, s[8:11], s63 offen offset:0 sc1
 buffer_store_dwordx4 v[44:47], v77, s[8:11], s63 offen offset:384 sc1
 buffer_store_dwordx4 v[48:51], v77, s[8:11], s63 offen offset:768 sc1
Lln_9:
 s_add_u32 m0, s67, 8192
 s_add_u32 s69, s65, 1179648
 buffer_load_dwordx4 v10, s[28:31], s69 offen lds
 s_add_u32 m0, s67, 9216
 s_add_u32 s69, s65, 1187840
 buffer_load_dwordx4 v10, s[28:31], s69 offen lds
 s_add_u32 m0, s67, 10240
 s_add_u32 s69, s65, 1441792
 buffer_load_dwordx4 v10, s[28:31], s69 offen lds
 s_add_u32 m0, s67, 11264
 s_add_u32 s69, s65, 1449984
 buffer_load_dwordx4 v10, s[28:31], s69 offen lds
 s_add_u32 m0, s67, 12288
 s_add_u32 s69, s65, 1703936
 buffer_load_dwordx4 v10, s[28:31], s69 offen lds
 s_add_u32 m0, s67, 13312
 s_add_u32 s69, s65, 1712128
 buffer_load_dwordx4 v10, s[28:31], s69 offen lds
 s_add_u32 m0, s67, 14336
 s_add_u32 s69, s65, 1966080
 buffer_load_dwordx4 v10, s[28:31], s69 offen lds
 s_add_u32 m0, s67, 15360
 s_add_u32 s69, s65, 1974272
 buffer_load_dwordx4 v10, s[28:31], s69 offen lds
 s_waitcnt vmcnt(8)
 s_cmp_lg_u32 s7, 0
 s_cbranch_scc1 Lar_10
 s_or_b32 s63, s6, 0x80
 v_mov_b32 v20, s63
 s_barrier
 buffer_store_byte v20, v79, s[20:23], 0 offen sc1
Lar_10:
 v_lshrrev_b32 v2, 4, v1
 v_bfe_u32 v3, v1, 2, 1
 v_lshl_add_u32 v2, v2, 1, v3
 v_mul_u32_u24 v2, 1152, v2
 v_bfe_u32 v3, v1, 3, 1
 v_bfe_u32 v4, v1, 1, 1
 v_lshl_add_u32 v3, v3, 1, v4
 v_and_b32 v4, 1, v1
 s_lshr_b32 s63, s58, 1
 s_lshl_b32 s63, s63, 5
 s_and_b32 s64, s58, 1
 s_lshl_b32 s64, s64, 3
 s_add_u32 s63, s63, s64
 v_lshl_add_u32 v5, v3, 1, s63
 v_add_u32 v5, v5, v4
 v_lshl_add_u32 v5, v5, 1, v2
 s_mul_i32 s63, s58, 144
 s_add_u32 s63, s63, 128
 v_lshl_add_u32 v6, v3, 2, s63
 v_lshl_add_u32 v6, v4, 1, v6
 v_lshl_add_u32 v6, v6, 1, v2
 s_lshl_b32 s63, s58, 8
 s_add_u32 s63, s63, 147456
 v_lshl_add_u32 v7, v1, 2, s63
 buffer_load_ushort v40, v5, s[24:27], 0 offen offset:0
 buffer_load_ushort v50, v5, s[24:27], 0 offen offset:32
 buffer_load_ushort v41, v5, s[24:27], 0 offen offset:128
 buffer_load_ushort v51, v5, s[24:27], 0 offen offset:160
 buffer_load_ushort v42, v5, s[24:27], 0 offen offset:288
 buffer_load_ushort v52, v5, s[24:27], 0 offen offset:320
 buffer_load_ushort v43, v5, s[24:27], 0 offen offset:416
 buffer_load_ushort v53, v5, s[24:27], 0 offen offset:448
 buffer_load_ushort v44, v5, s[24:27], 0 offen offset:576
 buffer_load_ushort v54, v5, s[24:27], 0 offen offset:608
 buffer_load_ushort v45, v5, s[24:27], 0 offen offset:704
 buffer_load_ushort v55, v5, s[24:27], 0 offen offset:736
 buffer_load_ushort v46, v5, s[24:27], 0 offen offset:864
 buffer_load_ushort v56, v5, s[24:27], 0 offen offset:896
 buffer_load_ushort v47, v5, s[24:27], 0 offen offset:992
 buffer_load_ushort v57, v5, s[24:27], 0 offen offset:1024
 buffer_load_dword v48, v6, s[24:27], 0 offen
 s_add_u32 m0, s67, 16384
 s_add_u32 s69, s65, 2359296
 buffer_load_dwordx4 v10, s[28:31], s69 offen lds
 s_add_u32 m0, s67, 17408
 s_add_u32 s69, s65, 2367488
 buffer_load_dwordx4 v10, s[28:31], s69 offen lds
 s_add_u32 m0, s67, 18432
 s_add_u32 s69, s65, 2621440
 buffer_load_dwordx4 v10, s[28:31], s69 offen lds
 s_add_u32 m0, s67, 19456
 s_add_u32 s69, s65, 2629632
 buffer_load_dwordx4 v10, s[28:31], s69 offen lds
 s_add_u32 m0, s67, 20480
 s_add_u32 s69, s65, 2883584
 buffer_load_dwordx4 v10, s[28:31], s69 offen lds
 s_add_u32 m0, s67, 21504
 s_add_u32 s69, s65, 2891776
 buffer_load_dwordx4 v10, s[28:31], s69 offen lds
 s_add_u32 m0, s67, 22528
 s_add_u32 s69, s65, 3145728
 buffer_load_dwordx4 v10, s[28:31], s69 offen lds
 s_add_u32 m0, s67, 23552
 s_add_u32 s69, s65, 3153920
 buffer_load_dwordx4 v10, s[28:31], s69 offen lds
 s_add_u32 m0, s67, 24576
 s_add_u32 s69, s65, 3538944
 buffer_load_dwordx4 v10, s[28:31], s69 offen lds
 s_add_u32 m0, s67, 25600
 s_add_u32 s69, s65, 3547136
 buffer_load_dwordx4 v10, s[28:31], s69 offen lds
 s_add_u32 m0, s67, 26624
 s_add_u32 s69, s65, 3801088
 buffer_load_dwordx4 v10, s[28:31], s69 offen lds
 s_add_u32 m0, s67, 27648
 s_add_u32 s69, s65, 3809280
 buffer_load_dwordx4 v10, s[28:31], s69 offen lds
 s_add_u32 m0, s67, 28672
 s_add_u32 s69, s65, 4063232
 buffer_load_dwordx4 v10, s[28:31], s69 offen lds
 s_add_u32 m0, s67, 29696
 s_add_u32 s69, s65, 4071424
 buffer_load_dwordx4 v10, s[28:31], s69 offen lds
 s_add_u32 m0, s67, 30720
 s_add_u32 s69, s65, 4325376
 buffer_load_dwordx4 v10, s[28:31], s69 offen lds
 s_add_u32 m0, s67, 31744
 s_add_u32 s69, s65, 4333568
 buffer_load_dwordx4 v10, s[28:31], s69 offen lds
 s_add_u32 m0, s67, 32768
 s_add_u32 s69, s65, 1048576
 buffer_load_dwordx4 v11, s[28:31], s69 offen lds
 s_add_u32 m0, s67, 33792
 s_add_u32 s69, s65, 1064960
 buffer_load_dwordx4 v11, s[28:31], s69 offen lds
 s_add_u32 m0, s67, 34816
 s_add_u32 s69, s65, 3407872
 buffer_load_dwordx4 v11, s[28:31], s69 offen lds
 s_add_u32 m0, s67, 35840
 s_add_u32 s69, s65, 3424256
 buffer_load_dwordx4 v11, s[28:31], s69 offen lds
 s_waitcnt vmcnt(32)
 ds_read_b64_tr_b16 v[80:81], v13 offset:0
 ds_read_b64_tr_b16 v[82:83], v13 offset:1024
 ds_read_b64_tr_b16 v[84:85], v13 offset:2048
 ds_read_b64_tr_b16 v[86:87], v13 offset:3072
 ds_read_b64_tr_b16 v[152:153], v13 offset:32
 ds_read_b64_tr_b16 v[154:155], v13 offset:1056
 ds_read_b64_tr_b16 v[156:157], v13 offset:2080
 ds_read_b64_tr_b16 v[158:159], v13 offset:3104
 s_waitcnt lgkmcnt(0)
 s_add_u32 m0, s67, 0
 s_add_u32 s69, s65, 1179648
 buffer_load_dwordx4 v10, s[32:35], s69 offen lds
 s_add_u32 m0, s67, 1024
 s_add_u32 s69, s65, 1187840
 buffer_load_dwordx4 v10, s[32:35], s69 offen lds
 s_add_u32 m0, s67, 2048
 s_add_u32 s69, s65, 1441792
 buffer_load_dwordx4 v10, s[32:35], s69 offen lds
 s_add_u32 m0, s67, 3072
 s_add_u32 s69, s65, 1449984
 buffer_load_dwordx4 v10, s[32:35], s69 offen lds
 s_waitcnt vmcnt(32)
 ds_read_b64_tr_b16 v[88:89], v13 offset:4096
 ds_read_b64_tr_b16 v[90:91], v13 offset:5120
 ds_read_b64_tr_b16 v[92:93], v13 offset:6144
 ds_read_b64_tr_b16 v[94:95], v13 offset:7168
 ds_read_b64_tr_b16 v[160:161], v13 offset:4128
 ds_read_b64_tr_b16 v[162:163], v13 offset:5152
 ds_read_b64_tr_b16 v[164:165], v13 offset:6176
 ds_read_b64_tr_b16 v[166:167], v13 offset:7200
 s_waitcnt lgkmcnt(0)
 s_add_u32 m0, s67, 4096
 s_add_u32 s69, s65, 2883584
 buffer_load_dwordx4 v10, s[32:35], s69 offen lds
 s_add_u32 m0, s67, 5120
 s_add_u32 s69, s65, 2891776
 buffer_load_dwordx4 v10, s[32:35], s69 offen lds
 s_add_u32 m0, s67, 6144
 s_add_u32 s69, s65, 3145728
 buffer_load_dwordx4 v10, s[32:35], s69 offen lds
 s_add_u32 m0, s67, 7168
 s_add_u32 s69, s65, 3153920
 buffer_load_dwordx4 v10, s[32:35], s69 offen lds
 s_waitcnt vmcnt(32)
 ds_read_b64_tr_b16 v[96:97], v13 offset:8192
 ds_read_b64_tr_b16 v[98:99], v13 offset:9216
 ds_read_b64_tr_b16 v[100:101], v13 offset:10240
 ds_read_b64_tr_b16 v[102:103], v13 offset:11264
 ds_read_b64_tr_b16 v[168:169], v13 offset:8224
 ds_read_b64_tr_b16 v[170:171], v13 offset:9248
 ds_read_b64_tr_b16 v[172:173], v13 offset:10272
 ds_read_b64_tr_b16 v[174:175], v13 offset:11296
 s_waitcnt lgkmcnt(0)
 s_add_u32 m0, s67, 8192
 s_add_u32 s69, s65, 1048576
 buffer_load_dwordx4 v11, s[32:35], s69 offen lds
 s_add_u32 m0, s67, 9216
 s_add_u32 s69, s65, 1064960
 buffer_load_dwordx4 v11, s[32:35], s69 offen lds
 s_add_u32 m0, s67, 10240
 s_add_u32 s69, s65, 3407872
 buffer_load_dwordx4 v11, s[32:35], s69 offen lds
 s_add_u32 m0, s67, 11264
 s_add_u32 s69, s65, 3424256
 buffer_load_dwordx4 v11, s[32:35], s69 offen lds
 s_waitcnt vmcnt(32)
 ds_read_b64_tr_b16 v[104:105], v13 offset:12288
 ds_read_b64_tr_b16 v[106:107], v13 offset:13312
 ds_read_b64_tr_b16 v[108:109], v13 offset:14336
 ds_read_b64_tr_b16 v[110:111], v13 offset:15360
 ds_read_b64_tr_b16 v[176:177], v13 offset:12320
 ds_read_b64_tr_b16 v[178:179], v13 offset:13344
 ds_read_b64_tr_b16 v[180:181], v13 offset:14368
 ds_read_b64_tr_b16 v[182:183], v13 offset:15392
 s_waitcnt lgkmcnt(0)
 s_add_u32 m0, s67, 12288
 s_add_u32 s69, s65, 1703936
 buffer_load_dwordx4 v10, s[36:39], s69 offen lds
 s_add_u32 m0, s67, 13312
 s_add_u32 s69, s65, 1712128
 buffer_load_dwordx4 v10, s[36:39], s69 offen lds
 s_add_u32 m0, s67, 14336
 s_add_u32 s69, s65, 1966080
 buffer_load_dwordx4 v10, s[36:39], s69 offen lds
 s_add_u32 m0, s67, 15360
 s_add_u32 s69, s65, 1974272
 buffer_load_dwordx4 v10, s[36:39], s69 offen lds
 s_waitcnt vmcnt(32)
 v_lshl_or_b32 v40, v50, 16, v40
 v_lshl_or_b32 v41, v51, 16, v41
 v_lshl_or_b32 v42, v52, 16, v42
 v_lshl_or_b32 v43, v53, 16, v43
 v_lshl_or_b32 v44, v54, 16, v44
 v_lshl_or_b32 v45, v55, 16, v45
 v_lshl_or_b32 v46, v56, 16, v46
 v_lshl_or_b32 v47, v57, 16, v47
 ds_write_b32 v7, v40 offset:0
 ds_write_b32 v7, v41 offset:1024
 ds_write_b32 v7, v42 offset:2048
 ds_write_b32 v7, v43 offset:3072
 ds_write_b32 v7, v44 offset:4096
 ds_write_b32 v7, v45 offset:5120
 ds_write_b32 v7, v46 offset:6144
 ds_write_b32 v7, v47 offset:7168
 ds_write_b32 v7, v48 offset:8192
 s_waitcnt lgkmcnt(0)
 ds_read_b64_tr_b16 v[112:113], v13 offset:16384
 ds_read_b64_tr_b16 v[114:115], v13 offset:17408
 ds_read_b64_tr_b16 v[116:117], v13 offset:18432
 ds_read_b64_tr_b16 v[118:119], v13 offset:19456
 ds_read_b64_tr_b16 v[184:185], v13 offset:16416
 ds_read_b64_tr_b16 v[186:187], v13 offset:17440
 ds_read_b64_tr_b16 v[188:189], v13 offset:18464
 ds_read_b64_tr_b16 v[190:191], v13 offset:19488
 s_waitcnt lgkmcnt(0)
 s_add_u32 m0, s67, 16384
 s_add_u32 s69, s65, 2359296
 buffer_load_dwordx4 v10, s[36:39], s69 offen lds
 s_add_u32 m0, s67, 17408
 s_add_u32 s69, s65, 2367488
 buffer_load_dwordx4 v10, s[36:39], s69 offen lds
 s_add_u32 m0, s67, 18432
 s_add_u32 s69, s65, 2621440
 buffer_load_dwordx4 v10, s[36:39], s69 offen lds
 s_add_u32 m0, s67, 19456
 s_add_u32 s69, s65, 2629632
 buffer_load_dwordx4 v10, s[36:39], s69 offen lds
 s_waitcnt vmcnt(32)
 ds_read_b64_tr_b16 v[120:121], v13 offset:20480
 ds_read_b64_tr_b16 v[122:123], v13 offset:21504
 ds_read_b64_tr_b16 v[124:125], v13 offset:22528
 ds_read_b64_tr_b16 v[126:127], v13 offset:23552
 ds_read_b64_tr_b16 v[192:193], v13 offset:20512
 ds_read_b64_tr_b16 v[194:195], v13 offset:21536
 ds_read_b64_tr_b16 v[196:197], v13 offset:22560
 ds_read_b64_tr_b16 v[198:199], v13 offset:23584
 s_waitcnt lgkmcnt(0)
 s_add_u32 m0, s67, 20480
 s_add_u32 s69, s65, 2883584
 buffer_load_dwordx4 v10, s[36:39], s69 offen lds
 s_add_u32 m0, s67, 21504
 s_add_u32 s69, s65, 2891776
 buffer_load_dwordx4 v10, s[36:39], s69 offen lds
 s_add_u32 m0, s67, 22528
 s_add_u32 s69, s65, 3145728
 buffer_load_dwordx4 v10, s[36:39], s69 offen lds
 s_add_u32 m0, s67, 23552
 s_add_u32 s69, s65, 3153920
 buffer_load_dwordx4 v10, s[36:39], s69 offen lds
 s_waitcnt vmcnt(32)
 ds_read_b64_tr_b16 v[128:129], v13 offset:24576
 ds_read_b64_tr_b16 v[130:131], v13 offset:25600
 ds_read_b64_tr_b16 v[132:133], v13 offset:26624
 ds_read_b64_tr_b16 v[134:135], v13 offset:27648
 ds_read_b64_tr_b16 v[200:201], v13 offset:24608
 ds_read_b64_tr_b16 v[202:203], v13 offset:25632
 ds_read_b64_tr_b16 v[204:205], v13 offset:26656
 ds_read_b64_tr_b16 v[206:207], v13 offset:27680
 s_waitcnt lgkmcnt(0)
 s_add_u32 m0, s67, 24576
 s_add_u32 s69, s65, 3538944
 buffer_load_dwordx4 v10, s[36:39], s69 offen lds
 s_add_u32 m0, s67, 25600
 s_add_u32 s69, s65, 3547136
 buffer_load_dwordx4 v10, s[36:39], s69 offen lds
 s_add_u32 m0, s67, 26624
 s_add_u32 s69, s65, 3801088
 buffer_load_dwordx4 v10, s[36:39], s69 offen lds
 s_add_u32 m0, s67, 27648
 s_add_u32 s69, s65, 3809280
 buffer_load_dwordx4 v10, s[36:39], s69 offen lds
 s_waitcnt vmcnt(32)
 ds_read_b64_tr_b16 v[136:137], v13 offset:28672
 ds_read_b64_tr_b16 v[138:139], v13 offset:29696
 ds_read_b64_tr_b16 v[140:141], v13 offset:30720
 ds_read_b64_tr_b16 v[142:143], v13 offset:31744
 ds_read_b64_tr_b16 v[208:209], v13 offset:28704
 ds_read_b64_tr_b16 v[210:211], v13 offset:29728
 ds_read_b64_tr_b16 v[212:213], v13 offset:30752
 ds_read_b64_tr_b16 v[214:215], v13 offset:31776
 s_waitcnt lgkmcnt(0)
 s_add_u32 m0, s67, 28672
 s_add_u32 s69, s65, 4063232
 buffer_load_dwordx4 v10, s[36:39], s69 offen lds
 s_add_u32 m0, s67, 29696
 s_add_u32 s69, s65, 4071424
 buffer_load_dwordx4 v10, s[36:39], s69 offen lds
 s_add_u32 m0, s67, 30720
 s_add_u32 s69, s65, 4325376
 buffer_load_dwordx4 v10, s[36:39], s69 offen lds
 s_add_u32 m0, s67, 31744
 s_add_u32 s69, s65, 4333568
 buffer_load_dwordx4 v10, s[36:39], s69 offen lds
 s_waitcnt vmcnt(32)
 ds_read_b64_tr_b16 v[144:145], v13 offset:32768
 ds_read_b64_tr_b16 v[146:147], v13 offset:33792
 ds_read_b64_tr_b16 v[148:149], v13 offset:34816
 ds_read_b64_tr_b16 v[150:151], v13 offset:35840
 ds_read_b64_tr_b16 v[216:217], v13 offset:32800
 ds_read_b64_tr_b16 v[218:219], v13 offset:33824
 ds_read_b64_tr_b16 v[220:221], v13 offset:34848
 ds_read_b64_tr_b16 v[222:223], v13 offset:35872
 s_waitcnt lgkmcnt(0)
 s_add_u32 m0, s67, 32768
 s_add_u32 s69, s65, 1048576
 buffer_load_dwordx4 v11, s[36:39], s69 offen lds
 s_add_u32 m0, s67, 33792
 s_add_u32 s69, s65, 1064960
 buffer_load_dwordx4 v11, s[36:39], s69 offen lds
 s_add_u32 m0, s67, 34816
 s_add_u32 s69, s65, 3407872
 buffer_load_dwordx4 v11, s[36:39], s69 offen lds
 s_add_u32 m0, s67, 35840
 s_add_u32 s69, s65, 3424256
 buffer_load_dwordx4 v11, s[36:39], s69 offen lds
 s_waitcnt vmcnt(32)
 ds_read_b64_tr_b16 v[224:225], v13 offset:0
 ds_read_b64_tr_b16 v[226:227], v13 offset:1024
 ds_read_b64_tr_b16 v[228:229], v13 offset:2048
 ds_read_b64_tr_b16 v[230:231], v13 offset:3072
 ds_read_b64_tr_b16 v[232:233], v13 offset:32
 ds_read_b64_tr_b16 v[234:235], v13 offset:1056
 ds_read_b64_tr_b16 v[236:237], v13 offset:2080
 ds_read_b64_tr_b16 v[238:239], v13 offset:3104
 s_waitcnt vmcnt(28)
 ds_read_b64_tr_b16 v[240:241], v13 offset:4096
 ds_read_b64_tr_b16 v[242:243], v13 offset:5120
 ds_read_b64_tr_b16 v[244:245], v13 offset:6144
 ds_read_b64_tr_b16 v[246:247], v13 offset:7168
 ds_read_b64_tr_b16 v[248:249], v13 offset:4128
 ds_read_b64_tr_b16 v[250:251], v13 offset:5152
 ds_read_b64_tr_b16 v[252:253], v13 offset:6176
 ds_read_b64_tr_b16 v[254:255], v13 offset:7200
 s_waitcnt vmcnt(24)
 ds_read_b64_tr_b16 a[0:1], v13 offset:8192
 ds_read_b64_tr_b16 a[2:3], v13 offset:9216
 ds_read_b64_tr_b16 a[4:5], v13 offset:10240
 ds_read_b64_tr_b16 a[6:7], v13 offset:11264
 ds_read_b64_tr_b16 a[8:9], v13 offset:8224
 ds_read_b64_tr_b16 a[10:11], v13 offset:9248
 ds_read_b64_tr_b16 a[12:13], v13 offset:10272
 ds_read_b64_tr_b16 a[14:15], v13 offset:11296
 s_waitcnt lgkmcnt(0)
 s_add_u32 s69, s66, 0
 s_add_u32 m0, s67, 0
 s_nop 0
 buffer_load_dwordx4 v24, s[40:43], s69 offen lds
 s_add_u32 m0, s67, 1024
 s_nop 0
 buffer_load_dwordx4 v25, s[40:43], s69 offen lds
 s_add_u32 m0, s67, 2048
 s_nop 0
 buffer_load_dwordx4 v26, s[40:43], s69 offen lds
 s_add_u32 m0, s67, 3072
 s_nop 0
 buffer_load_dwordx4 v27, s[40:43], s69 offen lds
 s_add_u32 m0, s67, 4096
 s_nop 0
 buffer_load_dwordx4 v28, s[40:43], s69 offen lds
 s_add_u32 m0, s67, 5120
 s_nop 0
 buffer_load_dwordx4 v29, s[40:43], s69 offen lds
 s_add_u32 m0, s67, 6144
 s_nop 0
 buffer_load_dwordx4 v30, s[40:43], s69 offen lds
 s_add_u32 m0, s67, 7168
 s_nop 0
 buffer_load_dwordx4 v31, s[40:43], s69 offen lds
 s_add_u32 m0, s67, 8192
 s_nop 0
 buffer_load_dwordx4 v32, s[40:43], s69 offen lds
 s_waitcnt vmcnt(29)
 ds_read_b64_tr_b16 a[16:17], v14 offset:12288
 ds_read_b64_tr_b16 a[18:19], v14 offset:13312
 ds_read_b64_tr_b16 a[20:21], v14 offset:14336
 ds_read_b64_tr_b16 a[22:23], v14 offset:15360
 ds_read_b64_tr_b16 a[24:25], v14 offset:12296
 ds_read_b64_tr_b16 a[26:27], v14 offset:13320
 ds_read_b64_tr_b16 a[28:29], v14 offset:14344
 ds_read_b64_tr_b16 a[30:31], v14 offset:15368
 s_waitcnt vmcnt(25)
 ds_read_b64_tr_b16 a[32:33], v14 offset:16384
 ds_read_b64_tr_b16 a[34:35], v14 offset:17408
 ds_read_b64_tr_b16 a[36:37], v14 offset:18432
 ds_read_b64_tr_b16 a[38:39], v14 offset:19456
 ds_read_b64_tr_b16 a[40:41], v14 offset:16392
 ds_read_b64_tr_b16 a[42:43], v14 offset:17416
 ds_read_b64_tr_b16 a[44:45], v14 offset:18440
 ds_read_b64_tr_b16 a[46:47], v14 offset:19464
 s_waitcnt lgkmcnt(0)
 s_add_u32 s69, s66, 36864
 s_add_u32 m0, s67, 9216
 s_nop 0
 buffer_load_dwordx4 v24, s[40:43], s69 offen lds
 s_add_u32 m0, s67, 10240
 s_nop 0
 buffer_load_dwordx4 v25, s[40:43], s69 offen lds
 s_add_u32 m0, s67, 11264
 s_nop 0
 buffer_load_dwordx4 v26, s[40:43], s69 offen lds
 s_add_u32 m0, s67, 12288
 s_nop 0
 buffer_load_dwordx4 v27, s[40:43], s69 offen lds
 s_add_u32 m0, s67, 13312
 s_nop 0
 buffer_load_dwordx4 v28, s[40:43], s69 offen lds
 s_add_u32 m0, s67, 14336
 s_nop 0
 buffer_load_dwordx4 v29, s[40:43], s69 offen lds
 s_add_u32 m0, s67, 15360
 s_nop 0
 buffer_load_dwordx4 v30, s[40:43], s69 offen lds
 s_add_u32 m0, s67, 16384
 s_nop 0
 buffer_load_dwordx4 v31, s[40:43], s69 offen lds
 s_add_u32 m0, s67, 17408
 s_nop 0
 buffer_load_dwordx4 v32, s[40:43], s69 offen lds
 s_waitcnt vmcnt(30)
 ds_read_b64_tr_b16 a[48:49], v14 offset:20480
 ds_read_b64_tr_b16 a[50:51], v14 offset:21504
 ds_read_b64_tr_b16 a[52:53], v14 offset:22528
 ds_read_b64_tr_b16 a[54:55], v14 offset:23552
 ds_read_b64_tr_b16 a[56:57], v14 offset:20488
 ds_read_b64_tr_b16 a[58:59], v14 offset:21512
 ds_read_b64_tr_b16 a[60:61], v14 offset:22536
 ds_read_b64_tr_b16 a[62:63], v14 offset:23560
 s_waitcnt vmcnt(26)
 ds_read_b64_tr_b16 a[64:65], v14 offset:24576
 ds_read_b64_tr_b16 a[66:67], v14 offset:25600
 ds_read_b64_tr_b16 a[68:69], v14 offset:26624
 ds_read_b64_tr_b16 a[70:71], v14 offset:27648
 ds_read_b64_tr_b16 a[72:73], v14 offset:24584
 ds_read_b64_tr_b16 a[74:75], v14 offset:25608
 ds_read_b64_tr_b16 a[76:77], v14 offset:26632
 ds_read_b64_tr_b16 a[78:79], v14 offset:27656
 s_waitcnt lgkmcnt(0)
 s_add_u32 s69, s66, 73728
 s_add_u32 m0, s67, 18432
 s_nop 0
 buffer_load_dwordx4 v24, s[40:43], s69 offen lds
 s_add_u32 m0, s67, 19456
 s_nop 0
 buffer_load_dwordx4 v25, s[40:43], s69 offen lds
 s_add_u32 m0, s67, 20480
 s_nop 0
 buffer_load_dwordx4 v26, s[40:43], s69 offen lds
 s_add_u32 m0, s67, 21504
 s_nop 0
 buffer_load_dwordx4 v27, s[40:43], s69 offen lds
 s_add_u32 m0, s67, 22528
 s_nop 0
 buffer_load_dwordx4 v28, s[40:43], s69 offen lds
 s_add_u32 m0, s67, 23552
 s_nop 0
 buffer_load_dwordx4 v29, s[40:43], s69 offen lds
 s_add_u32 m0, s67, 24576
 s_nop 0
 buffer_load_dwordx4 v30, s[40:43], s69 offen lds
 s_add_u32 m0, s67, 25600
 s_nop 0
 buffer_load_dwordx4 v31, s[40:43], s69 offen lds
 s_add_u32 m0, s67, 26624
 s_nop 0
 buffer_load_dwordx4 v32, s[40:43], s69 offen lds
 s_waitcnt vmcnt(31)
 ds_read_b64_tr_b16 a[80:81], v14 offset:28672
 ds_read_b64_tr_b16 a[82:83], v14 offset:29696
 ds_read_b64_tr_b16 a[84:85], v14 offset:30720
 ds_read_b64_tr_b16 a[86:87], v14 offset:31744
 ds_read_b64_tr_b16 a[88:89], v14 offset:28680
 ds_read_b64_tr_b16 a[90:91], v14 offset:29704
 ds_read_b64_tr_b16 a[92:93], v14 offset:30728
 ds_read_b64_tr_b16 a[94:95], v14 offset:31752
 s_waitcnt vmcnt(27)
 ds_read_b64_tr_b16 a[96:97], v14 offset:32768
 ds_read_b64_tr_b16 a[98:99], v14 offset:33792
 ds_read_b64_tr_b16 a[100:101], v14 offset:34816
 ds_read_b64_tr_b16 a[102:103], v14 offset:35840
 ds_read_b64_tr_b16 a[104:105], v14 offset:32776
 ds_read_b64_tr_b16 a[106:107], v14 offset:33800
 ds_read_b64_tr_b16 a[108:109], v14 offset:34824
 ds_read_b64_tr_b16 a[110:111], v14 offset:35848
 s_waitcnt lgkmcnt(0)
 s_add_u32 s69, s66, 110592
 s_add_u32 m0, s67, 27648
 s_nop 0
 buffer_load_dwordx4 v24, s[40:43], s69 offen lds
 s_add_u32 m0, s67, 28672
 s_nop 0
 buffer_load_dwordx4 v25, s[40:43], s69 offen lds
 s_add_u32 m0, s67, 29696
 s_nop 0
 buffer_load_dwordx4 v26, s[40:43], s69 offen lds
 s_add_u32 m0, s67, 30720
 s_nop 0
 buffer_load_dwordx4 v27, s[40:43], s69 offen lds
 s_add_u32 m0, s67, 31744
 s_nop 0
 buffer_load_dwordx4 v28, s[40:43], s69 offen lds
 s_add_u32 m0, s67, 32768
 s_nop 0
 buffer_load_dwordx4 v29, s[40:43], s69 offen lds
 s_add_u32 m0, s67, 33792
 s_nop 0
 buffer_load_dwordx4 v30, s[40:43], s69 offen lds
 s_add_u32 m0, s67, 34816
 s_nop 0
 buffer_load_dwordx4 v31, s[40:43], s69 offen lds
 s_add_u32 m0, s67, 35840
 s_nop 0
 buffer_load_dwordx4 v32, s[40:43], s69 offen lds
 s_waitcnt vmcnt(27)
 ds_read_b64_tr_b16 a[112:113], v15 offset:0
 ds_read_b64_tr_b16 a[114:115], v15 offset:576
 ds_read_b64_tr_b16 a[116:117], v15 offset:4608
 ds_read_b64_tr_b16 a[118:119], v15 offset:5184
 ds_read_b64_tr_b16 a[144:145], v15 offset:64
 ds_read_b64_tr_b16 a[146:147], v15 offset:640
 ds_read_b64_tr_b16 a[148:149], v15 offset:4672
 ds_read_b64_tr_b16 a[150:151], v15 offset:5248
 ds_read_b64_tr_b16 a[176:177], v15 offset:128
 ds_read_b64_tr_b16 a[178:179], v15 offset:704
 ds_read_b64_tr_b16 a[180:181], v15 offset:4736
 ds_read_b64_tr_b16 a[182:183], v15 offset:5312
 ds_read_b64_tr_b16 a[208:209], v15 offset:192
 ds_read_b64_tr_b16 a[210:211], v15 offset:768
 ds_read_b64_tr_b16 a[212:213], v15 offset:4800
 ds_read_b64_tr_b16 a[214:215], v15 offset:5376
 s_waitcnt vmcnt(18)
 ds_read_b64_tr_b16 a[120:121], v15 offset:9216
 ds_read_b64_tr_b16 a[122:123], v15 offset:9792
 ds_read_b64_tr_b16 a[124:125], v15 offset:13824
 ds_read_b64_tr_b16 a[126:127], v15 offset:14400
 ds_read_b64_tr_b16 a[152:153], v15 offset:9280
 ds_read_b64_tr_b16 a[154:155], v15 offset:9856
 ds_read_b64_tr_b16 a[156:157], v15 offset:13888
 ds_read_b64_tr_b16 a[158:159], v15 offset:14464
 ds_read_b64_tr_b16 a[184:185], v15 offset:9344
 ds_read_b64_tr_b16 a[186:187], v15 offset:9920
 ds_read_b64_tr_b16 a[188:189], v15 offset:13952
 ds_read_b64_tr_b16 a[190:191], v15 offset:14528
 ds_read_b64_tr_b16 a[216:217], v15 offset:9408
 ds_read_b64_tr_b16 a[218:219], v15 offset:9984
 ds_read_b64_tr_b16 a[220:221], v15 offset:14016
 ds_read_b64_tr_b16 a[222:223], v15 offset:14592
 ds_read_b64_tr_b16 a[240:241], v12 offset:256
 ds_read_b64_tr_b16 a[242:243], v12 offset:832
 ds_read_b64_tr_b16 a[244:245], v12 offset:4864
 ds_read_b64_tr_b16 a[246:247], v12 offset:5440
 s_waitcnt lgkmcnt(0)
 s_add_u32 m0, s67, 0
 s_add_u32 s69, s65, 0
 buffer_load_dwordx4 v10, s[32:35], s69 offen lds
 s_add_u32 m0, s67, 1024
 s_add_u32 s69, s65, 8192
 buffer_load_dwordx4 v10, s[32:35], s69 offen lds
 s_add_u32 m0, s67, 2048
 s_add_u32 s69, s65, 262144
 buffer_load_dwordx4 v10, s[32:35], s69 offen lds
 s_add_u32 m0, s67, 3072
 s_add_u32 s69, s65, 270336
 buffer_load_dwordx4 v10, s[32:35], s69 offen lds
 s_add_u32 m0, s67, 4096
 s_add_u32 s69, s65, 524288
 buffer_load_dwordx4 v10, s[32:35], s69 offen lds
 s_add_u32 m0, s67, 5120
 s_add_u32 s69, s65, 532480
 buffer_load_dwordx4 v10, s[32:35], s69 offen lds
 s_add_u32 m0, s67, 6144
 s_add_u32 s69, s65, 786432
 buffer_load_dwordx4 v10, s[32:35], s69 offen lds
 s_add_u32 m0, s67, 7168
 s_add_u32 s69, s65, 794624
 buffer_load_dwordx4 v10, s[32:35], s69 offen lds
 s_add_u32 m0, s67, 8192
 s_add_u32 s69, s65, 1703936
 buffer_load_dwordx4 v10, s[32:35], s69 offen lds
 s_add_u32 m0, s67, 9216
 s_add_u32 s69, s65, 1712128
 buffer_load_dwordx4 v10, s[32:35], s69 offen lds
 s_add_u32 m0, s67, 10240
 s_add_u32 s69, s65, 1966080
 buffer_load_dwordx4 v10, s[32:35], s69 offen lds
 s_add_u32 m0, s67, 11264
 s_add_u32 s69, s65, 1974272
 buffer_load_dwordx4 v10, s[32:35], s69 offen lds
 s_add_u32 m0, s67, 12288
 s_add_u32 s69, s65, 2359296
 buffer_load_dwordx4 v10, s[32:35], s69 offen lds
 s_add_u32 m0, s67, 13312
 s_add_u32 s69, s65, 2367488
 buffer_load_dwordx4 v10, s[32:35], s69 offen lds
 s_add_u32 m0, s67, 14336
 s_add_u32 s69, s65, 2621440
 buffer_load_dwordx4 v10, s[32:35], s69 offen lds
 s_add_u32 m0, s67, 15360
 s_add_u32 s69, s65, 2629632
 buffer_load_dwordx4 v10, s[32:35], s69 offen lds
 s_waitcnt vmcnt(25)
 ds_read_b64_tr_b16 a[128:129], v15 offset:18432
 ds_read_b64_tr_b16 a[130:131], v15 offset:19008
 ds_read_b64_tr_b16 a[132:133], v15 offset:23040
 ds_read_b64_tr_b16 a[134:135], v15 offset:23616
 ds_read_b64_tr_b16 a[160:161], v15 offset:18496
 ds_read_b64_tr_b16 a[162:163], v15 offset:19072
 ds_read_b64_tr_b16 a[164:165], v15 offset:23104
 ds_read_b64_tr_b16 a[166:167], v15 offset:23680
 ds_read_b64_tr_b16 a[192:193], v15 offset:18560
 ds_read_b64_tr_b16 a[194:195], v15 offset:19136
 ds_read_b64_tr_b16 a[196:197], v15 offset:23168
 ds_read_b64_tr_b16 a[198:199], v15 offset:23744
 ds_read_b64_tr_b16 a[224:225], v15 offset:18624
 ds_read_b64_tr_b16 a[226:227], v15 offset:19200
 ds_read_b64_tr_b16 a[228:229], v15 offset:23232
 ds_read_b64_tr_b16 a[230:231], v15 offset:23808
 s_waitcnt vmcnt(16)
 ds_read_b64_tr_b16 a[136:137], v15 offset:27648
 ds_read_b64_tr_b16 a[138:139], v15 offset:28224
 ds_read_b64_tr_b16 a[140:141], v15 offset:32256
 ds_read_b64_tr_b16 a[142:143], v15 offset:32832
 ds_read_b64_tr_b16 a[168:169], v15 offset:27712
 ds_read_b64_tr_b16 a[170:171], v15 offset:28288
 ds_read_b64_tr_b16 a[172:173], v15 offset:32320
 ds_read_b64_tr_b16 a[174:175], v15 offset:32896
 ds_read_b64_tr_b16 a[200:201], v15 offset:27776
 ds_read_b64_tr_b16 a[202:203], v15 offset:28352
 ds_read_b64_tr_b16 a[204:205], v15 offset:32384
 ds_read_b64_tr_b16 a[206:207], v15 offset:32960
 ds_read_b64_tr_b16 a[232:233], v15 offset:27840
 ds_read_b64_tr_b16 a[234:235], v15 offset:28416
 ds_read_b64_tr_b16 a[236:237], v15 offset:32448
 ds_read_b64_tr_b16 a[238:239], v15 offset:33024
 ds_read_b64_tr_b16 a[248:249], v12 offset:18688
 ds_read_b64_tr_b16 a[250:251], v12 offset:19264
 ds_read_b64_tr_b16 a[252:253], v12 offset:23296
 ds_read_b64_tr_b16 a[254:255], v12 offset:23872
 s_waitcnt lgkmcnt(0)
 s_add_u32 m0, s67, 16384
 s_add_u32 s69, s65, 3538944
 buffer_load_dwordx4 v10, s[32:35], s69 offen lds
 s_add_u32 m0, s67, 17408
 s_add_u32 s69, s65, 3547136
 buffer_load_dwordx4 v10, s[32:35], s69 offen lds
 s_add_u32 m0, s67, 18432
 s_add_u32 s69, s65, 3801088
 buffer_load_dwordx4 v10, s[32:35], s69 offen lds
 s_add_u32 m0, s67, 19456
 s_add_u32 s69, s65, 3809280
 buffer_load_dwordx4 v10, s[32:35], s69 offen lds
 s_add_u32 m0, s67, 20480
 s_add_u32 s69, s65, 4063232
 buffer_load_dwordx4 v10, s[32:35], s69 offen lds
 s_add_u32 m0, s67, 21504
 s_add_u32 s69, s65, 4071424
 buffer_load_dwordx4 v10, s[32:35], s69 offen lds
 s_add_u32 m0, s67, 22528
 s_add_u32 s69, s65, 4325376
 buffer_load_dwordx4 v10, s[32:35], s69 offen lds
 s_add_u32 m0, s67, 23552
 s_add_u32 s69, s65, 4333568
 buffer_load_dwordx4 v10, s[32:35], s69 offen lds
 s_add_u32 m0, s67, 24576
 s_add_u32 s69, s65, 0
 buffer_load_dwordx4 v10, s[36:39], s69 offen lds
 s_add_u32 m0, s67, 25600
 s_add_u32 s69, s65, 8192
 buffer_load_dwordx4 v10, s[36:39], s69 offen lds
 s_add_u32 m0, s67, 26624
 s_add_u32 s69, s65, 262144
 buffer_load_dwordx4 v10, s[36:39], s69 offen lds
 s_add_u32 m0, s67, 27648
 s_add_u32 s69, s65, 270336
 buffer_load_dwordx4 v10, s[36:39], s69 offen lds
 s_add_u32 m0, s67, 28672
 s_add_u32 s69, s65, 524288
 buffer_load_dwordx4 v10, s[36:39], s69 offen lds
 s_add_u32 m0, s67, 29696
 s_add_u32 s69, s65, 532480
 buffer_load_dwordx4 v10, s[36:39], s69 offen lds
 s_add_u32 m0, s67, 30720
 s_add_u32 s69, s65, 786432
 buffer_load_dwordx4 v10, s[36:39], s69 offen lds
 s_add_u32 m0, s67, 31744
 s_add_u32 s69, s65, 794624
 buffer_load_dwordx4 v10, s[36:39], s69 offen lds
 s_add_u32 m0, s67, 32768
 s_add_u32 s69, s65, 1179648
 buffer_load_dwordx4 v10, s[36:39], s69 offen lds
 s_add_u32 m0, s67, 33792
 s_add_u32 s69, s65, 1187840
 buffer_load_dwordx4 v10, s[36:39], s69 offen lds
 s_add_u32 m0, s67, 34816
 s_add_u32 s69, s65, 1441792
 buffer_load_dwordx4 v10, s[36:39], s69 offen lds
 s_add_u32 m0, s67, 35840
 s_add_u32 s69, s65, 1449984
 buffer_load_dwordx4 v10, s[36:39], s69 offen lds
 s_waitcnt vmcnt(32)
 ds_read_b64_tr_b16 v[36:37], v13 offset:0
 ds_read_b64_tr_b16 v[38:39], v13 offset:1024
 ds_read_b64_tr_b16 v[40:41], v13 offset:2048
 ds_read_b64_tr_b16 v[42:43], v13 offset:3072
 ds_read_b64_tr_b16 v[44:45], v13 offset:32
 ds_read_b64_tr_b16 v[46:47], v13 offset:1056
 ds_read_b64_tr_b16 v[48:49], v13 offset:2080
 ds_read_b64_tr_b16 v[50:51], v13 offset:3104
 s_waitcnt vmcnt(28)
 ds_read_b64_tr_b16 v[52:53], v13 offset:4096
 ds_read_b64_tr_b16 v[54:55], v13 offset:5120
 ds_read_b64_tr_b16 v[56:57], v13 offset:6144
 ds_read_b64_tr_b16 v[58:59], v13 offset:7168
 ds_read_b64_tr_b16 v[60:61], v13 offset:4128
 ds_read_b64_tr_b16 v[62:63], v13 offset:5152
 ds_read_b64_tr_b16 v[64:65], v13 offset:6176
 ds_read_b64_tr_b16 v[66:67], v13 offset:7200
 s_waitcnt lgkmcnt(8)
 ds_write_b128 v16, v[36:39] offset:0
 ds_write_b128 v16, v[40:43] offset:1024
 ds_write_b128 v16, v[44:47] offset:2048
 ds_write_b128 v16, v[48:51] offset:3072
 s_waitcnt vmcnt(24)
 ds_read_b64_tr_b16 v[36:37], v13 offset:8192
 ds_read_b64_tr_b16 v[38:39], v13 offset:9216
 ds_read_b64_tr_b16 v[40:41], v13 offset:10240
 ds_read_b64_tr_b16 v[42:43], v13 offset:11264
 ds_read_b64_tr_b16 v[44:45], v13 offset:8224
 ds_read_b64_tr_b16 v[46:47], v13 offset:9248
 ds_read_b64_tr_b16 v[48:49], v13 offset:10272
 ds_read_b64_tr_b16 v[50:51], v13 offset:11296
 s_waitcnt lgkmcnt(8)
 ds_write_b128 v16, v[52:55] offset:4096
 ds_write_b128 v16, v[56:59] offset:5120
 ds_write_b128 v16, v[60:63] offset:6144
 ds_write_b128 v16, v[64:67] offset:7168
 s_waitcnt vmcnt(20)
 ds_read_b64_tr_b16 v[52:53], v13 offset:12288
 ds_read_b64_tr_b16 v[54:55], v13 offset:13312
 ds_read_b64_tr_b16 v[56:57], v13 offset:14336
 ds_read_b64_tr_b16 v[58:59], v13 offset:15360
 ds_read_b64_tr_b16 v[60:61], v13 offset:12320
 ds_read_b64_tr_b16 v[62:63], v13 offset:13344
 ds_read_b64_tr_b16 v[64:65], v13 offset:14368
 ds_read_b64_tr_b16 v[66:67], v13 offset:15392
 s_waitcnt lgkmcnt(8)
 ds_write_b128 v16, v[36:39] offset:8192
 ds_write_b128 v16, v[40:43] offset:9216
 ds_write_b128 v16, v[44:47] offset:10240
 ds_write_b128 v16, v[48:51] offset:11264
 s_waitcnt vmcnt(16)
 ds_read_b64_tr_b16 v[36:37], v13 offset:16384
 ds_read_b64_tr_b16 v[38:39], v13 offset:17408
 ds_read_b64_tr_b16 v[40:41], v13 offset:18432
 ds_read_b64_tr_b16 v[42:43], v13 offset:19456
 ds_read_b64_tr_b16 v[44:45], v13 offset:16416
 ds_read_b64_tr_b16 v[46:47], v13 offset:17440
 ds_read_b64_tr_b16 v[48:49], v13 offset:18464
 ds_read_b64_tr_b16 v[50:51], v13 offset:19488
 s_waitcnt lgkmcnt(8)
 ds_write_b128 v16, v[52:55] offset:12288
 ds_write_b128 v16, v[56:59] offset:13312
 ds_write_b128 v16, v[60:63] offset:14336
 ds_write_b128 v16, v[64:67] offset:15360
 s_waitcnt vmcnt(12)
 ds_read_b64_tr_b16 v[52:53], v13 offset:20480
 ds_read_b64_tr_b16 v[54:55], v13 offset:21504
 ds_read_b64_tr_b16 v[56:57], v13 offset:22528
 ds_read_b64_tr_b16 v[58:59], v13 offset:23552
 ds_read_b64_tr_b16 v[60:61], v13 offset:20512
 ds_read_b64_tr_b16 v[62:63], v13 offset:21536
 ds_read_b64_tr_b16 v[64:65], v13 offset:22560
 ds_read_b64_tr_b16 v[66:67], v13 offset:23584
 s_waitcnt lgkmcnt(8)
 ds_write_b128 v16, v[36:39] offset:16384
 ds_write_b128 v16, v[40:43] offset:17408
 ds_write_b128 v16, v[44:47] offset:18432
 ds_write_b128 v16, v[48:51] offset:19456
 s_waitcnt vmcnt(8)
 ds_read_b64_tr_b16 v[36:37], v14 offset:24576
 ds_read_b64_tr_b16 v[38:39], v14 offset:25600
 ds_read_b64_tr_b16 v[40:41], v14 offset:26624
 ds_read_b64_tr_b16 v[42:43], v14 offset:27648
 ds_read_b64_tr_b16 v[44:45], v14 offset:24584
 ds_read_b64_tr_b16 v[46:47], v14 offset:25608
 ds_read_b64_tr_b16 v[48:49], v14 offset:26632
 ds_read_b64_tr_b16 v[50:51], v14 offset:27656
 s_waitcnt lgkmcnt(8)
 ds_write_b128 v16, v[52:55] offset:20480
 ds_write_b128 v16, v[56:59] offset:21504
 ds_write_b128 v16, v[60:63] offset:22528
 ds_write_b128 v16, v[64:67] offset:23552
 s_waitcnt vmcnt(4)
 ds_read_b64_tr_b16 v[52:53], v14 offset:28672
 ds_read_b64_tr_b16 v[54:55], v14 offset:29696
 ds_read_b64_tr_b16 v[56:57], v14 offset:30720
 ds_read_b64_tr_b16 v[58:59], v14 offset:31744
 ds_read_b64_tr_b16 v[60:61], v14 offset:28680
 ds_read_b64_tr_b16 v[62:63], v14 offset:29704
 ds_read_b64_tr_b16 v[64:65], v14 offset:30728
 ds_read_b64_tr_b16 v[66:67], v14 offset:31752
 s_waitcnt lgkmcnt(8)
 ds_write_b128 v16, v[36:39] offset:24576
 ds_write_b128 v16, v[40:43] offset:25600
 ds_write_b128 v16, v[44:47] offset:26624
 ds_write_b128 v16, v[48:51] offset:27648
 s_waitcnt vmcnt(0)
 ds_read_b64_tr_b16 v[36:37], v14 offset:32768
 ds_read_b64_tr_b16 v[38:39], v14 offset:33792
 ds_read_b64_tr_b16 v[40:41], v14 offset:34816
 ds_read_b64_tr_b16 v[42:43], v14 offset:35840
 ds_read_b64_tr_b16 v[44:45], v14 offset:32776
 ds_read_b64_tr_b16 v[46:47], v14 offset:33800
 ds_read_b64_tr_b16 v[48:49], v14 offset:34824
 ds_read_b64_tr_b16 v[50:51], v14 offset:35848
 s_waitcnt lgkmcnt(8)
 ds_write_b128 v16, v[52:55] offset:28672
 ds_write_b128 v16, v[56:59] offset:29696
 ds_write_b128 v16, v[60:63] offset:30720
 ds_write_b128 v16, v[64:67] offset:31744
 s_waitcnt lgkmcnt(4)
 ds_write_b128 v16, v[36:39] offset:32768
 ds_write_b128 v16, v[40:43] offset:33792
 ds_write_b128 v16, v[44:47] offset:34816
 ds_write_b128 v16, v[48:51] offset:35840
 s_waitcnt lgkmcnt(0)
 s_cmp_eq_u32 s7, 1
 s_cbranch_scc1 Lvalok_13
 v_mbcnt_lo_u32_b32 v1, -1, 0
 v_mbcnt_hi_u32_b32 v1, -1, v1
 v_lshlrev_b32 v1, 2, v1
 s_mov_b32 s62, 0
 s_mov_b32 s63, 0x80808080
Lval_11:
 buffer_load_dword v2, v1, s[20:23], 0 offen sc1
 s_waitcnt vmcnt(0)
 v_and_b32 v3, s63, v2
 v_cmp_ne_u32 vcc, s63, v3
 s_cbranch_vccz Lvald_12
 s_add_u32 s62, s62, 1
 s_cmp_lt_u32 s62, 400000
 s_cbranch_scc1 Lval_11
Lvald_12:
 s_mov_b32 s63, 1
 s_cbranch_vccnz L_abort
 v_lshlrev_b32 v3, v2, 1
 v_lshrrev_b32 v4, 8, v2
 v_lshl_or_b32 v3, 1, v4, v3
 v_lshrrev_b32 v4, 16, v2
 v_lshl_or_b32 v3, 1, v4, v3
 v_lshrrev_b32 v4, 24, v2
 v_lshl_or_b32 v3, 1, v4, v3
 s_nop 1
 v_or_b32_dpp v3, v3, v3 quad_perm:[1,0,3,2] row_mask:0xf bank_mask:0xf
 v_cmp_ne_u32 vcc, 255, v3
 s_cbranch_vccnz L_rerank
 s_mov_b32 s7, 1
Lvalok_13:
 v_mbcnt_lo_u32_b32 v1, -1, 0
 v_mbcnt_hi_u32_b32 v1, -1, v1
 v_and_b32 v2, 15, v1
 v_lshrrev_b32 v3, 4, v1
 v_and_b32 v8, 3, v1
 v_mov_b32 v6, 2147483632
 v_lshlrev_b32 v4, 4, v1
 v_add_u32 v64, 147456, v4
 s_mul_i32 s63, s58, 36864
 v_add_u32 v65, s63, v4
 s_lshl_b32 s63, s58, 10
 s_add_u32 s63, s63, 156672
 s_sub_u32 s66, s63, 147456
 v_lshlrev_b32 v4, 2, v1
 v_add_u32 v70, 162816, v4
 s_lshl_b32 s67, s58, 8
 v_and_b32 v4, 2, v1
 v_cmp_eq_u32 vcc, 0, v4
 v_mov_b32 v5, 0x4444
 v_mov_b32 v7, 0xeeee
 v_cndmask_b32 v66, v7, v5, vcc
 v_lshlrev_b32 v4, 4, v2
 v_lshl_add_u32 v4, v3, 2, v4
 v_add_u32 v67, s63, v4
 v_bfe_u32 v4, v1, 2, 2
 v_lshl_add_u32 v4, v3, 3, v4
 v_lshl_add_u32 v4, v4, 4, s63
 v_and_b32 v5, 1, v1
 v_lshl_add_u32 v68, v5, 3, v4
 v_bfe_u32 v5, v1, 1, 1
 v_lshl_add_u32 v69, v5, 3, v4
 v_lshrrev_b32 v4, 3, v2
 v_lshl_add_u32 v4, v4, 2, v8
 v_lshlrev_b32 v4, 4, v4
 v_lshl_add_u32 v4, v3, 7, v4
 s_lshl_b32 s64, s58, 9
 v_add_u32 v4, s64, v4
 v_and_b32 v5, 4, v1
 v_cmp_eq_u32 vcc, 0, v5
 s_add_u32 s68, s64, -323584
 s_nop 0
 v_cndmask_b32 v72, v6, v4, vcc
 s_lshr_b32 s63, s58, 1
 s_lshl_b32 s63, s63, 10
 s_and_b32 s64, s58, 1
 s_lshl_b32 s64, s64, 5
 s_add_u32 s63, s63, s64
 s_add_u32 s63, s63, 160768
 v_lshrrev_b32 v4, 1, v2
 v_lshlrev_b32 v4, 6, v4
 v_and_b32 v5, 1, v1
 v_lshl_add_u32 v4, v5, 4, v4
 v_lshl_add_u32 v4, v3, 8, v4
 v_add_u32 v71, s63, v4
 v_lshrrev_b32 v4, 3, v2
 v_lshrrev_b32 v5, 5, v1
 v_lshl_add_u32 v4, v4, 1, v5
 v_and_b32 v7, 1, v3
 v_and_b32 v9, 7, v1
 v_lshl_add_u32 v7, v7, 3, v9
 v_lshlrev_b32 v7, 3, v7
 v_lshl_add_u32 v73, v4, 12, v7
 v_bfe_u32 v4, v1, 1, 2
 v_lshlrev_b32 v4, 5, v4
 v_and_b32 v7, 1, v1
 v_lshl_add_u32 v4, v7, 3, v4
 v_lshl_add_u32 v4, v5, 4, v4
 v_and_b32 v7, 1, v3
 v_lshl_add_u32 v4, v7, 2, v4
 v_and_b32 v7, 8, v1
 v_cmp_eq_u32 vcc, 0, v7
 v_bfe_u32 v9, v1, 2, 1
 v_lshl_add_u32 v76, v9, 1, v8
 v_cndmask_b32 v74, v6, v4, vcc
 v_mov_b32 v4, 0x3f80
 v_mov_b32 v5, 0x3f800000
 v_cndmask_b32 v4, v5, v4, vcc
 v_and_b32 v7, 2, v1
 v_cmp_eq_u32 vcc, 0, v7
 s_nop 1
 v_cndmask_b32 v77, 0, v4, vcc
 s_lshl_b32 s63, s60, 5
 s_add_u32 s63, s63, s57
 s_lshl_b32 s63, s63, 7
 s_add_u32 s64, s63, 12288
 s_mov_b32 s54, s64
 s_add_u32 s55, s63, 20480
 v_and_b32 v4, 1, v1
 v_lshl_add_u32 v75, v4, 2, s64
 s_cmp_lg_u32 s58, 3
 s_cbranch_scc1 Lw3_14
 v_lshlrev_b32 v4, 8, v8
 v_add_u32 v76, 162816, v4
 s_add_u32 s64, s63, 20480
 v_cmp_eq_u32 vcc, 0, v1
 v_mov_b32 v4, s64
 s_nop 0
 v_cndmask_b32 v74, v6, v4, vcc
Lw3_14:
 s_mul_i32 s71, s60, 2048
 s_add_u32 s71, s71, s57
 s_mul_i32 s72, s71, 4096
 s_add_u32 s72, s72, 121634816
 s_mul_i32 s71, s71, 24576
 s_add_u32 s94, s71, 20979712
 s_lshl_b32 s63, s58, 11
 s_add_u32 s71, s71, s63
 s_add_u32 s71, s71, 20832256
 s_add_u32 s70, s71, 8192
 s_mul_i32 s73, s60, 589824
 s_add_u32 s73, s73, 196608
 s_lshl_b32 s74, s58, 5
 s_add_u32 s74, s74, s57
 s_lshl_b32 s63, s57, 7
 s_add_u32 s63, s63, s73
 s_lshl_b32 s64, s58, 16
 s_add_u32 s85, s63, s64
 s_add_u32 s86, s85, 32768
 s_lshl_b32 s64, s58, 13
 s_add_u32 s87, s63, s64
 s_add_u32 s87, s87, 262144
 s_lshl_b32 s83, s74, 12
 s_add_u32 s83, s83, s73
 s_sub_u32 s83, s83, 147456
 s_mov_b32 s82, 294912
 s_mul_i32 s75, s60, 27648
 s_add_u32 s75, s75, 2097152
 s_lshl_b32 s63, s74, 7
 s_add_u32 s88, s75, s63
 s_add_u32 s89, s88, 9216
 s_add_u32 s90, s88, 18432
 s_mul_i32 s91, s58, 3072
 s_sub_u32 s91, s91, s63
 s_sub_u32 s91, s91, 147456
 s_mov_b32 s77, 0x3e0293ee
 s_mov_b32 s78, 0x00ff00ff
 s_mov_b32 s79, 0x00ff00ff
 s_mov_b32 s92, 0x0000ffff
 s_mov_b32 s93, 0x0000ffff
 s_mov_b32 s84, 1
 s_mov_b32 s4, 0x3f803f80
 s_mov_b32 s5, 0x3f803f80
 s_mov_b32 s61, 0
 v_mov_b32 v76, -1
 s_cmp_lt_u32 s74, 72
 s_cbranch_scc1 Lnr_15
 v_mov_b32 v74, 2147483632
Lnr_15:
 s_cmp_lg_u32 s59, 0
 s_cbranch_scc1 L_chs
 ds_read_b128 v[32:35], v65 offset:0
 ds_read_b128 v[36:39], v65 offset:1024
 ds_read_b128 v[40:43], v65 offset:2048
 ds_read_b128 v[44:47], v65 offset:3072
 ds_read_b128 v[48:51], v65 offset:4096
 ds_read_b128 v[52:55], v65 offset:5120
 v_mov_b64 v[8:9], 0
 v_mov_b64 v[10:11], 0
 v_mov_b64 v[12:13], 0
 v_mov_b64 v[14:15], 0
 v_mov_b64 v[16:17], 0
 v_mov_b64 v[18:19], 0
 v_mov_b64 v[20:21], 0
 v_mov_b64 v[22:23], 0
 v_mov_b64 v[56:57], 0
 v_mov_b64 v[58:59], 0
 v_mov_b64 v[60:61], 0
 v_mov_b64 v[62:63], 0
 s_load_dwordx2 s[64:65], s[8:9], s54 glc
 s_add_u32 s63, s83, s82
 buffer_load_dwordx4 v[4:7], v64, s[8:11], s83 offen offset:0 sc1
 buffer_load_dwordx4 v[4:7], v64, s[8:11], s83 offen offset:1024 sc1
 buffer_load_dwordx4 v[4:7], v64, s[8:11], s83 offen offset:2048 sc1
 buffer_load_dwordx4 v[4:7], v64, s[8:11], s83 offen offset:3072 sc1
 buffer_load_dwordx4 v[4:7], v64, s[8:11], s63 offen offset:0 sc1
 buffer_load_dwordx4 v[4:7], v64, s[8:11], s63 offen offset:1024 sc1
 buffer_load_dwordx4 v[4:7], v64, s[8:11], s63 offen offset:2048 sc1
 buffer_load_dwordx4 v[4:7], v64, s[8:11], s63 offen offset:3072 sc1
 s_sub_u32 s63, s88, 162816
 buffer_load_dword v4, v70, s[8:11], s63 offen sc1
 s_sub_u32 s63, s89, 162816
 buffer_load_dword v4, v70, s[8:11], s63 offen sc1
 s_sub_u32 s63, s90, 162816
 buffer_load_dword v4, v70, s[8:11], s63 offen sc1
 s_mov_b32 s76, 0
 s_mov_b32 s80, 2147483632
L_chf_top:
 s_waitcnt lgkmcnt(0)
 s_barrier
L_chf_top2:
 ds_read_b128 v[24:27], v64 offset:0
 ds_read_b128 v[28:31], v64 offset:1024
 buffer_load_dwordx4 v[0:3], v64, s[8:11], s80 offen offset:0 sc1
 buffer_load_dwordx4 v[4:7], v64, s[8:11], s80 offen offset:1024 sc1
 s_cmp_eq_u32 s76, 0
 s_cbranch_scc1 L_chf_m1
L_chf_m1r:
 s_waitcnt lgkmcnt(1)
 v_smfmac_f32_16x16x64_bf16 v[16:19], v[24:27], v[32:39], v66
 ds_read_b128 v[32:35], v65 offset:6144
 v_smfmac_f32_16x16x64_bf16 v[8:11], v[24:27], v[80:87], v66
 ds_read_b128 v[36:39], v65 offset:7168
 v_smfmac_f32_16x16x64_bf16 v[20:23], v[24:27], v[40:47], v66
 ds_read_b128 v[40:43], v65 offset:8192
 v_smfmac_f32_16x16x64_bf16 v[12:15], v[24:27], v[152:159], v66
 ds_read_b128 v[44:47], v65 offset:9216
 s_waitcnt lgkmcnt(4)
 v_smfmac_f32_16x16x64_bf16 v[16:19], v[28:31], v[48:55], v66
 ds_read_b128 v[24:27], v64 offset:2048
 ds_read_b128 v[48:51], v65 offset:10240
 v_smfmac_f32_16x16x64_bf16 v[8:11], v[28:31], v[88:95], v66
 ds_read_b128 v[52:55], v65 offset:11264
 s_waitcnt lgkmcnt(5)
 v_smfmac_f32_16x16x64_bf16 v[20:23], v[28:31], v[32:39], v66
 ds_read_b128 v[32:35], v65 offset:12288
 v_smfmac_f32_16x16x64_bf16 v[12:15], v[28:31], v[160:167], v66
 ds_read_b128 v[36:39], v65 offset:13312
 s_waitcnt lgkmcnt(4)
 v_smfmac_f32_16x16x64_bf16 v[8:11], v[24:27], v[96:103], v66
 ds_read_b128 v[28:31], v64 offset:3072
 v_lshlrev_b32 v78, 2, v64
 s_sub_u32 s63, s81, 442368
 v_smfmac_f32_16x16x64_bf16 v[12:15], v[24:27], v[168:175], v66
 s_mov_b32 exec_hi, 0
 buffer_load_dword v78, v78, s[8:11], s63 offen sc1
 s_mov_b32 exec_hi, -1
 v_smfmac_f32_16x16x64_bf16 v[16:19], v[24:27], v[224:231], v66
 v_smfmac_f32_16x16x64_bf16 v[20:23], v[24:27], v[232:239], v66
 ds_read_b128 v[24:27], v64 offset:4096
 s_waitcnt lgkmcnt(1)
 v_smfmac_f32_16x16x64_bf16 v[16:19], v[28:31], v[40:47], v66
 ds_read_b128 v[40:43], v65 offset:14336
 v_smfmac_f32_16x16x64_bf16 v[8:11], v[28:31], v[104:111], v66
 ds_read_b128 v[44:47], v65 offset:15360
 v_smfmac_f32_16x16x64_bf16 v[20:23], v[28:31], v[48:55], v66
 ds_read_b128 v[48:51], v65 offset:16384
 v_smfmac_f32_16x16x64_bf16 v[12:15], v[28:31], v[176:183], v66
 ds_read_b128 v[52:55], v65 offset:17408
 s_cmp_eq_u32 s76, 0
 s_cbranch_scc1 L_chf_m2
L_chf_m2r:
 s_waitcnt lgkmcnt(4)
 v_smfmac_f32_16x16x64_bf16 v[16:19], v[24:27], v[32:39], v66
 ds_read_b128 v[28:31], v64 offset:5120
 ds_read_b128 v[32:35], v65 offset:18432
 v_smfmac_f32_16x16x64_bf16 v[8:11], v[24:27], v[112:119], v66
 ds_read_b128 v[36:39], v65 offset:19456
 s_waitcnt lgkmcnt(5)
 v_smfmac_f32_16x16x64_bf16 v[20:23], v[24:27], v[40:47], v66
 ds_read_b128 v[40:43], v65 offset:20480
 v_smfmac_f32_16x16x64_bf16 v[12:15], v[24:27], v[184:191], v66
 ds_read_b128 v[44:47], v65 offset:21504
 s_waitcnt lgkmcnt(4)
 v_smfmac_f32_16x16x64_bf16 v[8:11], v[28:31], v[120:127], v66
 ds_read_b128 v[24:27], v64 offset:6144
 v_smfmac_f32_16x16x64_bf16 v[12:15], v[28:31], v[192:199], v66
 v_smfmac_f32_16x16x64_bf16 v[16:19], v[28:31], v[240:247], v66
 v_smfmac_f32_16x16x64_bf16 v[20:23], v[28:31], v[248:255], v66
 ds_read_b128 v[28:31], v64 offset:7168
 s_waitcnt lgkmcnt(1)
 v_smfmac_f32_16x16x64_bf16 v[16:19], v[24:27], v[48:55], v66
 ds_read_b128 v[48:51], v65 offset:22528
 v_smfmac_f32_16x16x64_bf16 v[8:11], v[24:27], v[128:135], v66
 ds_read_b128 v[52:55], v65 offset:23552
 v_smfmac_f32_16x16x64_bf16 v[20:23], v[24:27], v[32:39], v66
 ds_read_b128 v[32:35], v65 offset:24576
 v_smfmac_f32_16x16x64_bf16 v[12:15], v[24:27], v[200:207], v66
 ds_read_b128 v[36:39], v65 offset:25600
 s_waitcnt lgkmcnt(4)
 v_smfmac_f32_16x16x64_bf16 v[16:19], v[28:31], v[40:47], v66
 ds_read_b128 v[24:27], v64 offset:8192
 ds_read_b128 v[40:43], v65 offset:26624
 v_smfmac_f32_16x16x64_bf16 v[8:11], v[28:31], v[136:143], v66
 ds_read_b128 v[44:47], v65 offset:27648
 s_waitcnt lgkmcnt(5)
 v_smfmac_f32_16x16x64_bf16 v[20:23], v[28:31], v[48:55], v66
 ds_read_b128 v[48:51], v65 offset:28672
 v_smfmac_f32_16x16x64_bf16 v[12:15], v[28:31], v[208:215], v66
 ds_read_b128 v[52:55], v65 offset:29696
 s_waitcnt lgkmcnt(4)
 v_smfmac_f32_16x16x64_bf16 v[8:11], v[24:27], v[144:151], v66
 v_smfmac_f32_16x16x64_bf16 v[12:15], v[24:27], v[216:223], v66
 v_smfmac_f32_16x16x64_bf16 v[16:19], v[24:27], a[0:7], v66
 s_cmp_eq_u32 s61, 63
 v_smfmac_f32_16x16x64_bf16 v[20:23], v[24:27], a[8:15], v66
 v_smfmac_f32_16x16x64_bf16 v[56:59], v[28:31], a[80:87], v66
 s_nop 0
 v_smfmac_f32_16x16x64_bf16 v[60:63], v[28:31], a[88:95], v66
 ds_read_b128 v[28:31], v64 offset:0
 v_add_f32 v8, v8, v10
 v_add_f32 v9, v9, v11
 v_add_f32 v12, v12, v14
 v_add_f32 v13, v13, v15
 v_cvt_pk_bf16_f32 v10, v8, v9
 v_cvt_pk_bf16_f32 v11, v12, v13
 ds_write2_b32 v67, v10, v11 offset0:0 offset1:64
 v_pk_add_f32 v[16:17], v[16:17], v[18:19]
 v_pk_add_f32 v[20:21], v[20:21], v[22:23]
 ds_read_b64_tr_b16 v[8:9], v68
 v_cvt_pk_bf16_f32 v18, v16, v17
 v_cvt_pk_bf16_f32 v19, v20, v21
 ds_write2_b32 v67, v18, v19 offset0:128 offset1:192
 ds_read_b64_tr_b16 v[10:11], v68 offset:64
 ds_read_b64_tr_b16 v[12:13], v69 offset:512
 ds_read_b64_tr_b16 v[14:15], v69 offset:576
 s_cbranch_scc1 L_chf_late
 v_smfmac_f32_16x16x64_bf16 v[56:59], v[24:27], a[96:103], v66
 s_cmp_lg_u32 s76, 1
 v_smfmac_f32_16x16x64_bf16 v[60:63], v[24:27], a[104:111], v66
 ds_read_b128 v[24:27], v64 offset:3072
 s_waitcnt lgkmcnt(7)
 v_smfmac_f32_16x16x64_bf16 v[56:59], v[28:31], v[32:39], v66
 ds_read_b128 v[32:35], v65 offset:30720
 ds_read_b128 v[36:39], v65 offset:31744
 v_smfmac_f32_16x16x64_bf16 v[60:63], v[28:31], v[40:47], v66
 ds_read_b128 v[40:43], v65 offset:32768
 ds_read_b128 v[44:47], v65 offset:33792
 ds_read_b128 v[28:31], v64 offset:1024
 s_cbranch_scc1 L_chf_m3
L_chf_m3r:
 s_mov_b64 vcc, s[78:79]
 s_waitcnt vmcnt(1)
 s_waitcnt lgkmcnt(8)
 v_mfma_f32_16x16x32_bf16 v[16:19], v[0:3], v[8:11], 0
 v_mfma_f32_16x16x32_bf16 v[20:23], v[4:7], v[8:11], 0
 s_waitcnt lgkmcnt(6)
 v_mfma_f32_16x16x32_bf16 v[0:3], v[12:15], v[8:11], 0
 s_waitcnt lgkmcnt(5)
 v_smfmac_f32_16x16x64_bf16 v[56:59], v[24:27], a[16:23], v66
 v_add_u32 v4, s66, v64
 v_smfmac_f32_16x16x64_bf16 v[60:63], v[24:27], a[24:31], v66
 ds_read_b128 v[24:27], v64 offset:2048
 v_add_u32 v5, s67, v70
 s_nop 1
 v_cndmask_b32 v16, v20, v16, vcc
 v_cndmask_b32 v17, v21, v17, vcc
 v_cndmask_b32 v18, v22, v18, vcc
 v_cndmask_b32 v19, v23, v19, vcc
 ds_write_b128 v4, v[16:19]
 v_cndmask_b32 v0, v1, v0, vcc
 v_cndmask_b32 v2, v3, v2, vcc
 v_cndmask_b32 v0, v2, v0, s[92:93]
 ds_write_b32 v5, v0
 s_waitcnt lgkmcnt(3)
 v_smfmac_f32_16x16x64_bf16 v[56:59], v[28:31], v[48:55], v66
 ds_read_b128 v[48:51], v65 offset:34816
 ds_read_b128 v[52:55], v65 offset:35840
 buffer_load_dwordx4 v[20:23], v64, s[8:11], s70 offen offset:0 sc1
 v_smfmac_f32_16x16x64_bf16 v[60:63], v[28:31], v[32:39], v66
 ds_read_b128 v[28:31], v64 offset:4096
 ds_read_b128 v[36:39], v64 offset:5120
 buffer_load_dwordx4 v[8:11], v64, s[8:11], s70 offen offset:1024 sc1
 s_waitcnt lgkmcnt(6)
 v_smfmac_f32_16x16x64_bf16 v[56:59], v[24:27], v[40:47], v66
 ds_read_b128 v[44:47], v64 offset:6144
 s_waitcnt lgkmcnt(3)
 v_smfmac_f32_16x16x64_bf16 v[60:63], v[24:27], v[48:55], v66
 s_barrier
 ds_read_b128 v[0:3], v64 offset:9216
 ds_read_b128 v[4:7], v64 offset:10240
 ds_read_b128 v[40:43], v64 offset:11264
 ds_read_b128 v[16:19], v64 offset:12288
 ds_read2st64_b32 v[32:33], v70 offset0:0 offset1:1
 ds_read2st64_b32 v[34:35], v70 offset0:2 offset1:3
 buffer_store_dwordx4 v[12:15], v72, s[8:11], s72 offen sc1
 s_waitcnt lgkmcnt(8)
 v_smfmac_f32_16x16x64_bf16 v[56:59], v[28:31], a[32:39], v66
 v_smfmac_f32_16x16x64_bf16 v[60:63], v[28:31], a[40:47], v66
 s_waitcnt lgkmcnt(7)
 v_smfmac_f32_16x16x64_bf16 v[56:59], v[36:39], a[48:55], v66
 v_smfmac_f32_16x16x64_bf16 v[60:63], v[36:39], a[56:63], v66
 s_waitcnt lgkmcnt(6)
 v_smfmac_f32_16x16x64_bf16 v[56:59], v[44:47], a[64:71], v66
 v_smfmac_f32_16x16x64_bf16 v[60:63], v[44:47], a[72:79], v66
 s_waitcnt lgkmcnt(0)
L_chf_join:
 v_pk_add_f32 v[0:1], v[0:1], v[4:5]
 v_pk_add_f32 v[2:3], v[2:3], v[6:7]
 v_pk_add_f32 v[16:17], v[40:41], v[16:17]
 v_pk_add_f32 v[18:19], v[42:43], v[18:19]
 v_pk_add_f32 v[32:33], v[32:33], v[34:35]
 v_pk_add_f32 v[0:1], v[0:1], v[16:17]
 v_pk_add_f32 v[2:3], v[2:3], v[18:19]
 v_add_f32 v4, v32, v33
 v_max3_f32 v24, v0, v1, v2
 v_max3_f32 v24, v24, v3, v4
 v_pk_add_f32 v[36:37], v[56:57], v[58:59]
 v_pk_add_f32 v[38:39], v[60:61], v[62:63]
 v_max_f32_dpp v24, v24, v24 row_ror:8 row_mask:0xf bank_mask:0xf
 v_mov_b32 v25, v24
 v_cvt_pk_bf16_f32 v40, v36, v37
 v_cvt_pk_bf16_f32 v41, v38, v39
 v_permlane16_swap_b32 v24, v25
 v_max_f32 v24, v24, v25
 v_mov_b32 v25, v24
 v_mov_b64 v[44:45], s[4:5]
 v_mov_b64 v[46:47], s[4:5]
 v_permlane32_swap_b32 v24, v25
 v_max_f32 v24, v24, v25
 v_mul_f32 v24, s77, v24
 v_fma_f32 v4, v4, s77, -v24
 v_fma_f32 v0, v0, s77, -v24
 v_fma_f32 v1, v1, s77, -v24
 v_fma_f32 v2, v2, s77, -v24
 v_fma_f32 v3, v3, s77, -v24
 v_exp_f32 v4, v4
 v_exp_f32 v0, v0
 v_exp_f32 v1, v1
 v_exp_f32 v2, v2
 v_exp_f32 v3, v3
 v_cvt_pk_bf16_f32 v36, v0, v1
 v_cvt_pk_bf16_f32 v37, v2, v3
 v_mov_b32_dpp v5, v4 row_ror:8 row_mask:0xf bank_mask:0xf
 v_mov_b32_dpp v38, v36 row_ror:8 row_mask:0xf bank_mask:0xf
 v_mov_b32_dpp v39, v37 row_ror:8 row_mask:0xf bank_mask:0xf
 v_cvt_pk_bf16_f32 v16, v4, v5
 s_waitcnt vmcnt(1)
 v_mfma_f32_16x16x32_bf16 v[32:35], v[44:47], v[36:39], 0
 v_mov_b32 v17, 0
 v_mfma_f32_16x16x32_bf16 v[24:27], v[20:23], v[36:39], 0
 v_mov_b32 v18, 0
 v_mfma_f32_16x16x32_bf16 v[28:31], v[8:11], v[36:39], 0
 v_mov_b32 v19, v16
 v_lshl_add_u32 v42, v70, 1, s68
 v_mfma_f32_16x16x16_bf16 v[32:35], v[44:45], v[16:17], v[32:35]
 v_and_b32 v43, 0xffffffdf, v64
 v_mfma_f32_16x16x16_bf16 v[24:27], v[40:41], v[16:17], v[24:27]
 v_mov_b64 v[48:49], 0
 v_mfma_f32_16x16x16_bf16 v[28:31], v[40:41], v[18:19], v[28:31]
 buffer_store_dwordx2 v[40:41], v42, s[8:11], s72 offen sc1
 v_mov_b64 v[50:51], 0
 v_mov_b64 v[52:53], 0
 v_mov_b64 v[54:55], 0
 v_rcp_f32 v32, v32
 v_mov_b64 v[56:57], 0
 v_pk_mul_f32 v[24:25], v[24:25], v[32:33] op_sel_hi:[1,0]
 v_pk_mul_f32 v[26:27], v[26:27], v[32:33] op_sel_hi:[1,0]
 v_pk_mul_f32 v[28:29], v[28:29], v[32:33] op_sel_hi:[1,0]
 v_pk_mul_f32 v[30:31], v[30:31], v[32:33] op_sel_hi:[1,0]
 v_cvt_pk_bf16_f32 v36, v24, v25
 v_cvt_pk_bf16_f32 v37, v26, v27
 v_cvt_pk_bf16_f32 v38, v28, v29
 v_cvt_pk_bf16_f32 v39, v30, v31
 s_mov_b64 exec, s[78:79]
 ds_write_b128 v71, v[36:39]
 s_mov_b64 exec, -1
 v_mov_b64 v[58:59], 0
 v_mov_b64 v[60:61], 0
 v_mov_b64 v[62:63], 0
 v_mov_b64 v[44:45], 0
 v_mov_b64 v[46:47], 0
 v_and_b32 v34, 0x7c, v70
 v_bfe_u32 v35, v70, 7, 1
 v_lshl_add_u32 v34, v35, 12, v34
 s_waitcnt lgkmcnt(0)
 s_barrier
 ds_read_b128 v[0:3], v43 offset:13312
 ds_read_b128 v[4:7], v43 offset:13344
 ds_read_b128 v[8:11], v43 offset:14336
 ds_read_b128 v[12:15], v43 offset:14368
 ds_read_b128 v[16:19], v64 offset:13312
 ds_read_b128 v[20:23], v64 offset:14336
 s_add_u32 s71, s71, 786432
 s_add_u32 s70, s70, 786432
 s_add_u32 s72, s72, 131072
 s_add_u32 s61, s61, 1
 s_add_u32 s95, s89, s91
 s_mov_b32 s62, 0
 s_cmp_eq_u32 s58, 3
 s_waitcnt lgkmcnt(5)
 v_smfmac_f32_16x16x64_bf16 v[48:51], v[0:3], a[112:119], v66
 s_waitcnt lgkmcnt(4)
 v_smfmac_f32_16x16x64_bf16 v[48:51], v[4:7], a[120:127], v66
 s_waitcnt lgkmcnt(3)
 v_smfmac_f32_16x16x64_bf16 v[48:51], v[8:11], a[128:135], v66
 s_waitcnt lgkmcnt(2)
 v_smfmac_f32_16x16x64_bf16 v[48:51], v[12:15], a[136:143], v66
 s_add_u32 s64, s85, 16384
 s_add_u32 s65, s86, 16384
 v_smfmac_f32_16x16x64_bf16 v[52:55], v[0:3], a[144:151], v66
 s_nop 0
 v_smfmac_f32_16x16x64_bf16 v[52:55], v[4:7], a[152:159], v66
 s_nop 0
 v_smfmac_f32_16x16x64_bf16 v[52:55], v[8:11], a[160:167], v66
 s_cmp_eq_u32 s58, 3
 v_smfmac_f32_16x16x64_bf16 v[52:55], v[12:15], a[168:175], v66
 v_cvt_pk_bf16_f32 v24, v48, v49
 v_smfmac_f32_16x16x64_bf16 v[56:59], v[0:3], a[176:183], v66
 v_cvt_pk_bf16_f32 v25, v50, v51
 v_smfmac_f32_16x16x64_bf16 v[56:59], v[4:7], a[184:191], v66
 v_and_or_b32 v24, v24, -2, s84
 buffer_store_dwordx2 v[24:25], v73, s[8:11], s85 offen
 v_smfmac_f32_16x16x64_bf16 v[56:59], v[8:11], a[192:199], v66
 s_nop 0
 v_smfmac_f32_16x16x64_bf16 v[56:59], v[12:15], a[200:207], v66
 v_cvt_pk_bf16_f32 v26, v52, v53
 v_smfmac_f32_16x16x64_bf16 v[60:63], v[0:3], a[208:215], v66
 v_cvt_pk_bf16_f32 v27, v54, v55
 v_smfmac_f32_16x16x64_bf16 v[60:63], v[4:7], a[216:223], v66
 v_and_or_b32 v26, v26, -2, s84
 buffer_store_dwordx2 v[26:27], v73, s[8:11], s64 offen
 v_smfmac_f32_16x16x64_bf16 v[60:63], v[8:11], a[224:231], v66
 s_nop 0
 v_smfmac_f32_16x16x64_bf16 v[60:63], v[12:15], a[232:239], v66
 v_cvt_pk_bf16_f32 v28, v56, v57
 s_waitcnt lgkmcnt(0)
 v_smfmac_f32_16x16x64_bf16 v[44:47], v[16:19], a[240:247], v66
 v_cvt_pk_bf16_f32 v29, v58, v59
 v_smfmac_f32_16x16x64_bf16 v[44:47], v[20:23], a[248:255], v66
 v_and_or_b32 v28, v28, -2, s84
 buffer_store_dwordx2 v[28:29], v73, s[8:11], s86 offen
 s_nop 0
 v_cvt_pk_bf16_f32 v30, v60, v61
 v_cvt_pk_bf16_f32 v31, v62, v63
 v_and_or_b32 v30, v30, -2, s84
 buffer_store_dwordx2 v[30:31], v73, s[8:11], s65 offen
 s_nop 0
 v_pk_add_f32 v[44:45], v[44:45], v[46:47]
 v_cvt_pk_bf16_f32 v33, v44, v45
 v_and_or_b32 v33, v33, -2, s84
 buffer_store_dword v33, v34, s[8:11], s87 offen
 ds_read_b128 v[32:35], v65 offset:0
 ds_read_b128 v[36:39], v65 offset:1024
 ds_read_b128 v[40:43], v65 offset:2048
 ds_read_b128 v[44:47], v65 offset:3072
 ds_read_b128 v[48:51], v65 offset:4096
 ds_read_b128 v[52:55], v65 offset:5120
 s_load_dwordx2 s[64:65], s[8:9], s54 glc
 s_cbranch_scc1 L_chf_w3
 s_cmp_ge_u32 s74, 72
 s_cbranch_scc1 L_chf_nred
 s_mov_b32 vcc_lo, 0x1010101
 s_mov_b32 vcc_hi, 0x1010101
 v_cndmask_b32 v60, 0, v77, vcc
 s_mov_b32 vcc_lo, 0x2020202
 s_mov_b32 vcc_hi, 0x2020202
 v_cndmask_b32 v61, 0, v77, vcc
 s_mov_b32 vcc_lo, 0x10101010
 s_mov_b32 vcc_hi, 0x10101010
 v_cndmask_b32 v62, 0, v77, vcc
 s_mov_b32 vcc_lo, 0x20202020
 s_mov_b32 vcc_hi, 0x20202020
 v_cndmask_b32 v63, 0, v77, vcc
 s_waitcnt vmcnt(2)
 buffer_load_dwordx4 v[0:3], v64, s[8:11], s83 offen offset:0 sc1
 buffer_load_dwordx4 v[4:7], v64, s[8:11], s83 offen offset:1024 sc1
 buffer_load_dwordx4 v[8:11], v64, s[8:11], s83 offen offset:2048 sc1
 buffer_load_dwordx4 v[12:15], v64, s[8:11], s83 offen offset:3072 sc1
 s_waitcnt vmcnt(3)
L_chf_g:
 buffer_load_dwordx4 v[16:19], v64, s[8:11], s83 offen offset:0 sc1
 buffer_load_dwordx4 v[20:23], v64, s[8:11], s83 offen offset:1024 sc1
 buffer_load_dwordx4 v[24:27], v64, s[8:11], s83 offen offset:2048 sc1
 buffer_load_dwordx4 v[28:31], v64, s[8:11], s83 offen offset:3072 sc1
 s_waitcnt vmcnt(6)
 v_mfma_f32_16x16x32_bf16 v[56:59], v[60:63], v[0:3], 0
 v_xor_b32 v78, s84, v0
 v_mfma_f32_16x16x32_bf16 v[56:59], v[60:63], v[4:7], v[56:59]
 v_bitop3_b32 v78, v78, v4, s84 bitop3:0xf6
 s_waitcnt vmcnt(5)
 v_mfma_f32_16x16x32_bf16 v[56:59], v[60:63], v[8:11], v[56:59]
 v_bitop3_b32 v78, v78, v8, s84 bitop3:0xf6
 s_waitcnt vmcnt(4)
 v_mfma_f32_16x16x32_bf16 v[56:59], v[60:63], v[12:15], v[56:59]
 v_bitop3_b32 v78, v78, v12, s84 bitop3:0xf6
 v_and_b32 v78, 1, v78
 v_cmp_ne_u32 vcc, 0, v78
 s_add_u32 s62, s62, 1
 v_mov_b32 v78, -1
 s_nop 2
 v_add_f32_dpp v56, v56, v56 row_ror:8 row_mask:0xf bank_mask:0xf
 v_add_f32_dpp v57, v57, v57 row_ror:8 row_mask:0xf bank_mask:0xf
 v_cvt_pk_bf16_f32 v58, v56, v57
 v_min_u32 v58, -2, v58
 s_cbranch_vccz L_chf_gok
 buffer_load_dwordx4 v[0:3], v64, s[8:11], s83 offen offset:0 sc1
 buffer_load_dwordx4 v[4:7], v64, s[8:11], s83 offen offset:1024 sc1
 buffer_load_dwordx4 v[8:11], v64, s[8:11], s83 offen offset:2048 sc1
 buffer_load_dwordx4 v[12:15], v64, s[8:11], s83 offen offset:3072 sc1
 s_waitcnt vmcnt(6)
 v_mfma_f32_16x16x32_bf16 v[56:59], v[60:63], v[16:19], 0
 v_xor_b32 v78, s84, v16
 v_mfma_f32_16x16x32_bf16 v[56:59], v[60:63], v[20:23], v[56:59]
 v_bitop3_b32 v78, v78, v20, s84 bitop3:0xf6
 s_waitcnt vmcnt(5)
 v_mfma_f32_16x16x32_bf16 v[56:59], v[60:63], v[24:27], v[56:59]
 v_bitop3_b32 v78, v78, v24, s84 bitop3:0xf6
 s_waitcnt vmcnt(4)
 v_mfma_f32_16x16x32_bf16 v[56:59], v[60:63], v[28:31], v[56:59]
 v_bitop3_b32 v78, v78, v28, s84 bitop3:0xf6
 v_and_b32 v78, 1, v78
 v_cmp_ne_u32 vcc, 0, v78
 s_add_u32 s62, s62, 1
 v_mov_b32 v78, -1
 s_nop 2
 v_add_f32_dpp v56, v56, v56 row_ror:8 row_mask:0xf bank_mask:0xf
 v_add_f32_dpp v57, v57, v57 row_ror:8 row_mask:0xf bank_mask:0xf
 v_cvt_pk_bf16_f32 v58, v56, v57
 v_min_u32 v58, -2, v58
 s_cbranch_vccz L_chf_gok
 s_cmp_lt_u32 s62, 400000
 s_cbranch_scc1 L_chf_g
 s_mov_b32 s63, 41
 s_branch L_abort
L_chf_gok:
 buffer_store_dword v58, v74, s[8:11], s89 offen
 buffer_store_dword v78, v74, s[8:11], s88 offen
L_chf_poll:
 s_barrier
 s_mov_b32 s63, s88
 s_mov_b32 s88, s89
 s_mov_b32 s89, s90
 s_mov_b32 s90, s63
 s_add_u32 s85, s85, s82
 s_add_u32 s86, s86, s82
 s_add_u32 s87, s87, s82
 s_add_u32 s83, s83, s82
 s_sub_u32 s82, 0, s82
 s_bfe_u32 s84, s61, 0x10001
 s_xor_b32 s84, s84, 1
 s_mul_i32 s63, s58, 3072
 s_add_u32 m0, s63, 147456
 s_waitcnt vmcnt(2)
 v_add_u32 v78, s63, v64
 buffer_load_dwordx4 v64, s[8:11], s95 offen offset:0 sc1 lds
 buffer_load_dwordx4 v64, s[8:11], s95 offen offset:1024 sc1 lds
 buffer_load_dwordx4 v64, s[8:11], s95 offen offset:2048 sc1 lds
 v_mov_b64 v[8:9], 0
 v_mov_b64 v[10:11], 0
 v_mov_b64 v[12:13], 0
 v_mov_b64 v[14:15], 0
 v_mov_b64 v[16:17], 0
 v_mov_b64 v[18:19], 0
 v_mov_b64 v[20:21], 0
 v_mov_b64 v[22:23], 0
 v_mov_b64 v[56:57], 0
 v_mov_b64 v[58:59], 0
 v_mov_b64 v[60:61], 0
 v_mov_b64 v[62:63], 0
 s_waitcnt lgkmcnt(0)
 s_min_u32 s63, s64, s65
 s_cmp_gt_u32 s63, s61
 s_cselect_b32 s76, 1, 0
 s_cselect_b32 s80, s71, 2147483632
 s_cselect_b32 s81, s70, 2147483632
 s_cbranch_scc1 Lrd_17
 s_load_dwordx2 s[64:65], s[8:9], s54 glc
Lrd_17:
 s_waitcnt vmcnt(2)
Lp_16:
 buffer_load_dwordx4 v64, s[8:11], s95 offen offset:0 sc1 lds
 buffer_load_dwordx4 v64, s[8:11], s95 offen offset:1024 sc1 lds
 buffer_load_dwordx4 v64, s[8:11], s95 offen offset:2048 sc1 lds
 s_waitcnt vmcnt(3)
 ds_read_b128 v[24:27], v78
 ds_read_b128 v[28:31], v78 offset:1024
 ds_read_b128 v[4:7], v78 offset:2048
 s_add_u32 s62, s62, 1
 s_waitcnt lgkmcnt(1)
 v_max3_u32 v0, v24, v25, v26
 v_max3_u32 v1, v27, v28, v29
 v_max3_u32 v0, v0, v30, v31
 s_waitcnt lgkmcnt(0)
 v_max3_u32 v1, v1, v4, v5
 v_max3_u32 v0, v0, v6, v7
 v_max_u32 v0, v0, v1
 v_cmp_eq_u32 vcc, -1, v0
 s_cbranch_vccz L_chf_top
 s_cmp_lt_u32 s62, 400000
 s_cbranch_scc1 Lp_16
 s_mov_b32 s63, 42
 s_branch L_abort
L_chf_nred:
 s_waitcnt vmcnt(5)
 s_branch L_chf_poll
L_chf_w3:
 s_mov_b32 s69, 1
 s_waitcnt vmcnt(5) lgkmcnt(0)
 s_min_u32 s63, s64, s65
 s_cmp_gt_u32 s63, s61
 s_cselect_b32 s76, 1, 0
 s_cselect_b32 s80, s71, 2147483632
 s_cselect_b32 s81, s70, 2147483632
 s_barrier
 s_atomic_add s69, s[8:9], s55
 s_cbranch_scc1 L_chf_w3b
 s_load_dwordx2 s[64:65], s[8:9], s54 glc
 s_waitcnt lgkmcnt(0)
L_chf_w3b:
 v_mov_b64 v[8:9], 0
 v_mov_b64 v[10:11], 0
 v_mov_b64 v[12:13], 0
 v_mov_b64 v[14:15], 0
 v_mov_b64 v[16:17], 0
 v_mov_b64 v[18:19], 0
 v_mov_b64 v[20:21], 0
 v_mov_b64 v[22:23], 0
 v_mov_b64 v[56:57], 0
 v_mov_b64 v[58:59], 0
 v_mov_b64 v[60:61], 0
 v_mov_b64 v[62:63], 0
 s_mov_b32 s63, s88
 s_mov_b32 s88, s89
 s_mov_b32 s89, s90
 s_mov_b32 s90, s63
 s_add_u32 s85, s85, s82
 s_add_u32 s86, s86, s82
 s_add_u32 s87, s87, s82
 s_add_u32 s83, s83, s82
 s_sub_u32 s82, 0, s82
 s_bfe_u32 s84, s61, 0x10001
 s_xor_b32 s84, s84, 1
 s_barrier
 s_branch L_chf_top2
L_chf_m1:
 s_min_u32 s63, s64, s65
 s_cmp_gt_u32 s63, s61
 s_cselect_b32 s76, 1, 0
 s_cselect_b32 s80, s71, 2147483632
 s_cselect_b32 s81, s70, 2147483632
 s_cbranch_scc0 L_chf_m1b
 buffer_load_dwordx4 v[0:3], v64, s[8:11], s71 offen offset:0 sc1
 buffer_load_dwordx4 v[4:7], v64, s[8:11], s71 offen offset:1024 sc1
 s_branch L_chf_m1r
L_chf_m1b:
 buffer_load_dword v0, v75, s[8:11], 0 offen sc1
 s_branch L_chf_m1r
L_chf_m2:
 s_waitcnt vmcnt(0)
 v_cmp_ge_u32 vcc, s61, v0
 s_cbranch_vccnz L_chf_m2r
 buffer_load_dwordx4 v[0:3], v64, s[8:11], s71 offen offset:0 sc1
 buffer_load_dwordx4 v[4:7], v64, s[8:11], s71 offen offset:1024 sc1
 v_lshlrev_b32 v78, 2, v64
 s_sub_u32 s63, s70, 442368
 s_mov_b32 exec_hi, 0
 buffer_load_dword v78, v78, s[8:11], s63 offen sc1
 s_mov_b32 exec_hi, -1
 s_mov_b32 s76, 2
 s_branch L_chf_m2r
L_chf_m3:
 s_cmp_eq_u32 s76, 2
 s_cbranch_scc1 L_chf_m4
 s_add_u32 s64, s61, 1
 s_mov_b32 s62, 0
Lspin_18:
 buffer_load_dword v0, v75, s[8:11], 0 offen sc1
 s_waitcnt vmcnt(0)
 v_cmp_gt_u32 vcc, s64, v0
 s_cbranch_vccz Lspind_19
 s_add_u32 s62, s62, 1
 s_cmp_lt_u32 s62, 400000
 s_cbranch_scc1 Lspin_18
 s_mov_b32 s63, 40
 s_branch L_abort
Lspind_19:
 buffer_load_dwordx4 v[0:3], v64, s[8:11], s71 offen offset:0 sc1
 buffer_load_dwordx4 v[4:7], v64, s[8:11], s71 offen offset:1024 sc1
 v_lshlrev_b32 v78, 2, v64
 s_sub_u32 s63, s70, 442368
 s_mov_b32 exec_hi, 0
 buffer_load_dword v78, v78, s[8:11], s63 offen sc1
 s_mov_b32 exec_hi, -1
 s_waitcnt vmcnt(1)
L_chf_m4:
 s_branch L_chf_m3r
L_chf_late:
 v_smfmac_f32_16x16x64_bf16 v[56:59], v[24:27], a[96:103], v66
 v_smfmac_f32_16x16x64_bf16 v[60:63], v[24:27], a[104:111], v66
 ds_read_b128 v[24:27], v64 offset:3072
 s_waitcnt lgkmcnt(7)
 v_smfmac_f32_16x16x64_bf16 v[56:59], v[28:31], v[32:39], v66
 ds_read_b128 v[32:35], v65 offset:30720
 ds_read_b128 v[36:39], v65 offset:31744
 v_smfmac_f32_16x16x64_bf16 v[60:63], v[28:31], v[40:47], v66
 ds_read_b128 v[40:43], v65 offset:32768
 ds_read_b128 v[44:47], v65 offset:33792
 ds_read_b128 v[28:31], v64 offset:1024
 s_waitcnt lgkmcnt(5)
 v_smfmac_f32_16x16x64_bf16 v[56:59], v[24:27], a[16:23], v66
 v_smfmac_f32_16x16x64_bf16 v[60:63], v[24:27], a[24:31], v66
 ds_read_b128 v[24:27], v64 offset:2048
 s_waitcnt lgkmcnt(1)
 v_smfmac_f32_16x16x64_bf16 v[56:59], v[28:31], v[48:55], v66
 ds_read_b128 v[48:51], v65 offset:34816
 ds_read_b128 v[52:55], v65 offset:35840
 v_smfmac_f32_16x16x64_bf16 v[60:63], v[28:31], v[32:39], v66
 ds_read_b128 v[28:31], v64 offset:4096
 ds_read_b128 v[36:39], v64 offset:5120
 s_waitcnt lgkmcnt(4)
 v_smfmac_f32_16x16x64_bf16 v[56:59], v[24:27], v[40:47], v66
 ds_read_b128 v[44:47], v64 offset:6144
 s_waitcnt lgkmcnt(3)
 v_smfmac_f32_16x16x64_bf16 v[60:63], v[24:27], v[48:55], v66
 s_waitcnt lgkmcnt(2)
 v_smfmac_f32_16x16x64_bf16 v[56:59], v[28:31], a[32:39], v66
 v_smfmac_f32_16x16x64_bf16 v[60:63], v[28:31], a[40:47], v66
 s_waitcnt lgkmcnt(1)
 v_smfmac_f32_16x16x64_bf16 v[56:59], v[36:39], a[48:55], v66
 v_smfmac_f32_16x16x64_bf16 v[60:63], v[36:39], a[56:63], v66
 s_waitcnt lgkmcnt(0)
 v_smfmac_f32_16x16x64_bf16 v[56:59], v[44:47], a[64:71], v66
 v_smfmac_f32_16x16x64_bf16 v[60:63], v[44:47], a[72:79], v66
 buffer_store_dwordx4 v[12:15], v72, s[8:11], s72 offen sc1
 s_nop 6
 v_pk_add_f32 v[36:37], v[56:57], v[58:59]
 v_pk_add_f32 v[38:39], v[60:61], v[62:63]
 v_cvt_pk_bf16_f32 v40, v36, v37
 v_cvt_pk_bf16_f32 v41, v38, v39
 v_lshl_add_u32 v42, v70, 1, s68
 buffer_store_dwordx2 v[40:41], v42, s[8:11], s72 offen sc1
 s_waitcnt vmcnt(0) lgkmcnt(0)
 s_barrier
 s_cmp_lg_u32 s58, 3
 s_cbranch_scc1 L_chf_fin
 s_mov_b32 s69, 1
 s_atomic_add s69, s[8:9], s55
 s_waitcnt lgkmcnt(0)
L_chf_fin:
 s_endpgm
L_chs:
 ds_read_b128 v[32:35], v65 offset:0
 ds_read_b128 v[36:39], v65 offset:1024
 ds_read_b128 v[40:43], v65 offset:2048
 ds_read_b128 v[44:47], v65 offset:3072
 ds_read_b128 v[48:51], v65 offset:4096
 ds_read_b128 v[52:55], v65 offset:5120
 v_mov_b64 v[8:9], 0
 v_mov_b64 v[10:11], 0
 v_mov_b64 v[12:13], 0
 v_mov_b64 v[14:15], 0
 v_mov_b64 v[16:17], 0
 v_mov_b64 v[18:19], 0
 v_mov_b64 v[20:21], 0
 v_mov_b64 v[22:23], 0
 v_mov_b64 v[56:57], 0
 v_mov_b64 v[58:59], 0
 v_mov_b64 v[60:61], 0
 v_mov_b64 v[62:63], 0
 s_load_dwordx2 s[64:65], s[8:9], s54 glc
 s_add_u32 s63, s83, s82
 buffer_load_dwordx4 v[4:7], v64, s[8:11], s83 offen offset:0 sc1
 buffer_load_dwordx4 v[4:7], v64, s[8:11], s83 offen offset:1024 sc1
 buffer_load_dwordx4 v[4:7], v64, s[8:11], s83 offen offset:2048 sc1
 buffer_load_dwordx4 v[4:7], v64, s[8:11], s83 offen offset:3072 sc1
 buffer_load_dwordx4 v[4:7], v64, s[8:11], s63 offen offset:0 sc1
 buffer_load_dwordx4 v[4:7], v64, s[8:11], s63 offen offset:1024 sc1
 buffer_load_dwordx4 v[4:7], v64, s[8:11], s63 offen offset:2048 sc1
 buffer_load_dwordx4 v[4:7], v64, s[8:11], s63 offen offset:3072 sc1
 s_sub_u32 s63, s88, 162816
 buffer_load_dword v4, v70, s[8:11], s63 offen sc1
 s_sub_u32 s63, s89, 162816
 buffer_load_dword v4, v70, s[8:11], s63 offen sc1
 s_sub_u32 s63, s90, 162816
 buffer_load_dword v4, v70, s[8:11], s63 offen sc1
 s_mov_b32 s76, 0
 s_mov_b32 s80, 2147483632
L_chs_top:
 s_waitcnt lgkmcnt(0)
 s_barrier
L_chs_top2:
 ds_read_b128 v[24:27], v64 offset:0
 ds_read_b128 v[28:31], v64 offset:1024
 buffer_load_dwordx4 v[0:3], v64, s[8:11], s80 offen offset:0 sc1
 buffer_load_dwordx4 v[4:7], v64, s[8:11], s80 offen offset:1024 sc1
 s_cmp_eq_u32 s76, 0
 s_cbranch_scc1 L_chs_m1
L_chs_m1r:
 s_waitcnt lgkmcnt(1)
 v_smfmac_f32_16x16x64_bf16 v[16:19], v[24:27], v[32:39], v66
 ds_read_b128 v[32:35], v65 offset:6144
 v_smfmac_f32_16x16x64_bf16 v[8:11], v[24:27], v[80:87], v66
 ds_read_b128 v[36:39], v65 offset:7168
 v_smfmac_f32_16x16x64_bf16 v[20:23], v[24:27], v[40:47], v66
 ds_read_b128 v[40:43], v65 offset:8192
 v_smfmac_f32_16x16x64_bf16 v[12:15], v[24:27], v[152:159], v66
 ds_read_b128 v[44:47], v65 offset:9216
 s_waitcnt lgkmcnt(4)
 v_smfmac_f32_16x16x64_bf16 v[16:19], v[28:31], v[48:55], v66
 ds_read_b128 v[24:27], v64 offset:2048
 ds_read_b128 v[48:51], v65 offset:10240
 v_smfmac_f32_16x16x64_bf16 v[8:11], v[28:31], v[88:95], v66
 ds_read_b128 v[52:55], v65 offset:11264
 s_waitcnt lgkmcnt(5)
 v_smfmac_f32_16x16x64_bf16 v[20:23], v[28:31], v[32:39], v66
 ds_read_b128 v[32:35], v65 offset:12288
 v_smfmac_f32_16x16x64_bf16 v[12:15], v[28:31], v[160:167], v66
 ds_read_b128 v[36:39], v65 offset:13312
 s_waitcnt lgkmcnt(4)
 v_smfmac_f32_16x16x64_bf16 v[8:11], v[24:27], v[96:103], v66
 ds_read_b128 v[28:31], v64 offset:3072
 v_lshlrev_b32 v78, 2, v64
 s_sub_u32 s63, s81, 442368
 v_smfmac_f32_16x16x64_bf16 v[12:15], v[24:27], v[168:175], v66
 s_mov_b32 exec_hi, 0
 buffer_load_dword v78, v78, s[8:11], s63 offen sc1
 s_mov_b32 exec_hi, -1
 v_smfmac_f32_16x16x64_bf16 v[16:19], v[24:27], v[224:231], v66
 v_smfmac_f32_16x16x64_bf16 v[20:23], v[24:27], v[232:239], v66
 ds_read_b128 v[24:27], v64 offset:4096
 s_waitcnt lgkmcnt(1)
 v_smfmac_f32_16x16x64_bf16 v[16:19], v[28:31], v[40:47], v66
 ds_read_b128 v[40:43], v65 offset:14336
 v_smfmac_f32_16x16x64_bf16 v[8:11], v[28:31], v[104:111], v66
 ds_read_b128 v[44:47], v65 offset:15360
 v_smfmac_f32_16x16x64_bf16 v[20:23], v[28:31], v[48:55], v66
 ds_read_b128 v[48:51], v65 offset:16384
 v_smfmac_f32_16x16x64_bf16 v[12:15], v[28:31], v[176:183], v66
 ds_read_b128 v[52:55], v65 offset:17408
 s_cmp_eq_u32 s76, 0
 s_cbranch_scc1 L_chs_m2
L_chs_m2r:
 s_waitcnt lgkmcnt(4)
 v_smfmac_f32_16x16x64_bf16 v[16:19], v[24:27], v[32:39], v66
 ds_read_b128 v[28:31], v64 offset:5120
 ds_read_b128 v[32:35], v65 offset:18432
 v_smfmac_f32_16x16x64_bf16 v[8:11], v[24:27], v[112:119], v66
 ds_read_b128 v[36:39], v65 offset:19456
 s_waitcnt lgkmcnt(5)
 v_smfmac_f32_16x16x64_bf16 v[20:23], v[24:27], v[40:47], v66
 ds_read_b128 v[40:43], v65 offset:20480
 v_smfmac_f32_16x16x64_bf16 v[12:15], v[24:27], v[184:191], v66
 ds_read_b128 v[44:47], v65 offset:21504
 s_waitcnt lgkmcnt(4)
 v_smfmac_f32_16x16x64_bf16 v[8:11], v[28:31], v[120:127], v66
 ds_read_b128 v[24:27], v64 offset:6144
 v_smfmac_f32_16x16x64_bf16 v[12:15], v[28:31], v[192:199], v66
 v_smfmac_f32_16x16x64_bf16 v[16:19], v[28:31], v[240:247], v66
 v_smfmac_f32_16x16x64_bf16 v[20:23], v[28:31], v[248:255], v66
 ds_read_b128 v[28:31], v64 offset:7168
 s_waitcnt lgkmcnt(1)
 v_smfmac_f32_16x16x64_bf16 v[16:19], v[24:27], v[48:55], v66
 ds_read_b128 v[48:51], v65 offset:22528
 v_smfmac_f32_16x16x64_bf16 v[8:11], v[24:27], v[128:135], v66
 ds_read_b128 v[52:55], v65 offset:23552
 v_smfmac_f32_16x16x64_bf16 v[20:23], v[24:27], v[32:39], v66
 ds_read_b128 v[32:35], v65 offset:24576
 v_smfmac_f32_16x16x64_bf16 v[12:15], v[24:27], v[200:207], v66
 ds_read_b128 v[36:39], v65 offset:25600
 s_waitcnt lgkmcnt(4)
 v_smfmac_f32_16x16x64_bf16 v[16:19], v[28:31], v[40:47], v66
 ds_read_b128 v[24:27], v64 offset:8192
 ds_read_b128 v[40:43], v65 offset:26624
 v_smfmac_f32_16x16x64_bf16 v[8:11], v[28:31], v[136:143], v66
 ds_read_b128 v[44:47], v65 offset:27648
 s_waitcnt lgkmcnt(5)
 v_smfmac_f32_16x16x64_bf16 v[20:23], v[28:31], v[48:55], v66
 ds_read_b128 v[48:51], v65 offset:28672
 v_smfmac_f32_16x16x64_bf16 v[12:15], v[28:31], v[208:215], v66
 ds_read_b128 v[52:55], v65 offset:29696
 s_waitcnt lgkmcnt(4)
 v_smfmac_f32_16x16x64_bf16 v[8:11], v[24:27], v[144:151], v66
 v_smfmac_f32_16x16x64_bf16 v[12:15], v[24:27], v[216:223], v66
 v_smfmac_f32_16x16x64_bf16 v[16:19], v[24:27], a[0:7], v66
 s_cmp_eq_u32 s61, 63
 v_smfmac_f32_16x16x64_bf16 v[20:23], v[24:27], a[8:15], v66
 v_smfmac_f32_16x16x64_bf16 v[56:59], v[28:31], a[80:87], v66
 s_nop 0
 v_smfmac_f32_16x16x64_bf16 v[60:63], v[28:31], a[88:95], v66
 ds_read_b128 v[28:31], v64 offset:0
 v_add_f32 v8, v8, v10
 v_add_f32 v9, v9, v11
 v_add_f32 v12, v12, v14
 v_add_f32 v13, v13, v15
 v_cvt_pk_bf16_f32 v10, v8, v9
 v_cvt_pk_bf16_f32 v11, v12, v13
 ds_write2_b32 v67, v10, v11 offset0:0 offset1:64
 v_pk_add_f32 v[16:17], v[16:17], v[18:19]
 v_pk_add_f32 v[20:21], v[20:21], v[22:23]
 ds_read_b64_tr_b16 v[8:9], v68
 v_cvt_pk_bf16_f32 v18, v16, v17
 v_cvt_pk_bf16_f32 v19, v20, v21
 ds_write2_b32 v67, v18, v19 offset0:128 offset1:192
 ds_read_b64_tr_b16 v[10:11], v68 offset:64
 ds_read_b64_tr_b16 v[12:13], v69 offset:512
 ds_read_b64_tr_b16 v[14:15], v69 offset:576
 s_cbranch_scc1 L_chs_late
 v_smfmac_f32_16x16x64_bf16 v[56:59], v[24:27], a[96:103], v66
 s_cmp_lg_u32 s76, 1
 v_smfmac_f32_16x16x64_bf16 v[60:63], v[24:27], a[104:111], v66
 ds_read_b128 v[24:27], v64 offset:3072
 s_waitcnt lgkmcnt(7)
 v_smfmac_f32_16x16x64_bf16 v[56:59], v[28:31], v[32:39], v66
 ds_read_b128 v[32:35], v65 offset:30720
 ds_read_b128 v[36:39], v65 offset:31744
 v_smfmac_f32_16x16x64_bf16 v[60:63], v[28:31], v[40:47], v66
 ds_read_b128 v[40:43], v65 offset:32768
 ds_read_b128 v[44:47], v65 offset:33792
 ds_read_b128 v[28:31], v64 offset:1024
 s_cbranch_scc1 L_chs_m3
L_chs_m3r:
 s_mov_b64 vcc, s[78:79]
 s_waitcnt vmcnt(1)
 s_waitcnt lgkmcnt(8)
 v_mfma_f32_16x16x32_bf16 v[16:19], v[0:3], v[8:11], 0
 v_mfma_f32_16x16x32_bf16 v[20:23], v[4:7], v[8:11], 0
 s_waitcnt lgkmcnt(6)
 v_mfma_f32_16x16x32_bf16 v[0:3], v[12:15], v[8:11], 0
 s_waitcnt lgkmcnt(5)
 v_smfmac_f32_16x16x64_bf16 v[56:59], v[24:27], a[16:23], v66
 v_add_u32 v4, s66, v64
 v_smfmac_f32_16x16x64_bf16 v[60:63], v[24:27], a[24:31], v66
 ds_read_b128 v[24:27], v64 offset:2048
 v_add_u32 v5, s67, v70
 s_nop 1
 v_cndmask_b32 v16, v20, v16, vcc
 v_cndmask_b32 v17, v21, v17, vcc
 v_cndmask_b32 v18, v22, v18, vcc
 v_cndmask_b32 v19, v23, v19, vcc
 ds_write_b128 v4, v[16:19]
 v_cndmask_b32 v0, v1, v0, vcc
 v_cndmask_b32 v2, v3, v2, vcc
 v_cndmask_b32 v0, v2, v0, s[92:93]
 ds_write_b32 v5, v0
 s_waitcnt lgkmcnt(3)
 v_smfmac_f32_16x16x64_bf16 v[56:59], v[28:31], v[48:55], v66
 ds_read_b128 v[48:51], v65 offset:34816
 ds_read_b128 v[52:55], v65 offset:35840
 buffer_load_dwordx4 v[20:23], v64, s[8:11], s70 offen offset:0 sc1
 v_smfmac_f32_16x16x64_bf16 v[60:63], v[28:31], v[32:39], v66
 ds_read_b128 v[28:31], v64 offset:4096
 ds_read_b128 v[36:39], v64 offset:5120
 buffer_load_dwordx4 v[8:11], v64, s[8:11], s70 offen offset:1024 sc1
 s_waitcnt lgkmcnt(6)
 v_smfmac_f32_16x16x64_bf16 v[56:59], v[24:27], v[40:47], v66
 ds_read_b128 v[44:47], v64 offset:6144
 s_waitcnt lgkmcnt(3)
 v_smfmac_f32_16x16x64_bf16 v[60:63], v[24:27], v[48:55], v66
 s_barrier
 ds_read_b128 v[0:3], v64 offset:9216
 ds_read_b128 v[4:7], v64 offset:10240
 ds_read_b128 v[40:43], v64 offset:11264
 ds_read_b128 v[16:19], v64 offset:12288
 ds_read2st64_b32 v[32:33], v70 offset0:0 offset1:1
 ds_read2st64_b32 v[34:35], v70 offset0:2 offset1:3
 buffer_store_dwordx4 v[12:15], v72, s[8:11], s72 offen sc1
 s_waitcnt lgkmcnt(8)
 v_smfmac_f32_16x16x64_bf16 v[56:59], v[28:31], a[32:39], v66
 v_smfmac_f32_16x16x64_bf16 v[60:63], v[28:31], a[40:47], v66
 s_waitcnt lgkmcnt(7)
 v_smfmac_f32_16x16x64_bf16 v[56:59], v[36:39], a[48:55], v66
 v_smfmac_f32_16x16x64_bf16 v[60:63], v[36:39], a[56:63], v66
 s_waitcnt lgkmcnt(6)
 v_smfmac_f32_16x16x64_bf16 v[56:59], v[44:47], a[64:71], v66
 v_smfmac_f32_16x16x64_bf16 v[60:63], v[44:47], a[72:79], v66
 s_waitcnt lgkmcnt(0)
L_chs_join:
 v_pk_add_f32 v[0:1], v[0:1], v[4:5]
 v_pk_add_f32 v[2:3], v[2:3], v[6:7]
 v_pk_add_f32 v[16:17], v[40:41], v[16:17]
 v_pk_add_f32 v[18:19], v[42:43], v[18:19]
 v_pk_add_f32 v[32:33], v[32:33], v[34:35]
 v_pk_add_f32 v[0:1], v[0:1], v[16:17]
 v_pk_add_f32 v[2:3], v[2:3], v[18:19]
 v_add_f32 v4, v32, v33
 v_max3_f32 v24, v0, v1, v2
 v_max3_f32 v24, v24, v3, v4
 v_pk_add_f32 v[36:37], v[56:57], v[58:59]
 v_pk_add_f32 v[38:39], v[60:61], v[62:63]
 v_max_f32_dpp v24, v24, v24 row_ror:8 row_mask:0xf bank_mask:0xf
 v_mov_b32 v25, v24
 v_cvt_pk_bf16_f32 v40, v36, v37
 v_cvt_pk_bf16_f32 v41, v38, v39
 v_permlane16_swap_b32 v24, v25
 v_max_f32 v24, v24, v25
 v_mov_b32 v25, v24
 v_mov_b64 v[44:45], s[4:5]
 v_mov_b64 v[46:47], s[4:5]
 v_permlane32_swap_b32 v24, v25
 v_max_f32 v24, v24, v25
 v_mul_f32 v24, s77, v24
 v_fma_f32 v4, v4, s77, -v24
 v_fma_f32 v0, v0, s77, -v24
 v_fma_f32 v1, v1, s77, -v24
 v_fma_f32 v2, v2, s77, -v24
 v_fma_f32 v3, v3, s77, -v24
 v_exp_f32 v4, v4
 v_exp_f32 v0, v0
 v_exp_f32 v1, v1
 v_exp_f32 v2, v2
 v_exp_f32 v3, v3
 v_cvt_pk_bf16_f32 v36, v0, v1
 v_cvt_pk_bf16_f32 v37, v2, v3
 v_mov_b32_dpp v5, v4 row_ror:8 row_mask:0xf bank_mask:0xf
 v_mov_b32_dpp v38, v36 row_ror:8 row_mask:0xf bank_mask:0xf
 v_mov_b32_dpp v39, v37 row_ror:8 row_mask:0xf bank_mask:0xf
 v_cvt_pk_bf16_f32 v16, v4, v5
 s_waitcnt vmcnt(1)
 v_mfma_f32_16x16x32_bf16 v[32:35], v[44:47], v[36:39], 0
 v_mov_b32 v17, 0
 v_mfma_f32_16x16x32_bf16 v[24:27], v[20:23], v[36:39], 0
 v_mov_b32 v18, 0
 v_mfma_f32_16x16x32_bf16 v[28:31], v[8:11], v[36:39], 0
 v_mov_b32 v19, v16
 v_lshl_add_u32 v42, v70, 1, s68
 v_mfma_f32_16x16x16_bf16 v[32:35], v[44:45], v[16:17], v[32:35]
 v_and_b32 v43, 0xffffffdf, v64
 v_mfma_f32_16x16x16_bf16 v[24:27], v[40:41], v[16:17], v[24:27]
 v_mov_b64 v[48:49], 0
 v_mfma_f32_16x16x16_bf16 v[28:31], v[40:41], v[18:19], v[28:31]
 buffer_store_dwordx2 v[40:41], v42, s[8:11], s72 offen sc1
 v_mov_b64 v[50:51], 0
 v_mov_b64 v[52:53], 0
 v_mov_b64 v[54:55], 0
 v_rcp_f32 v32, v32
 v_mov_b64 v[56:57], 0
 v_pk_mul_f32 v[24:25], v[24:25], v[32:33] op_sel_hi:[1,0]
 v_pk_mul_f32 v[26:27], v[26:27], v[32:33] op_sel_hi:[1,0]
 v_pk_mul_f32 v[28:29], v[28:29], v[32:33] op_sel_hi:[1,0]
 v_pk_mul_f32 v[30:31], v[30:31], v[32:33] op_sel_hi:[1,0]
 v_cvt_pk_bf16_f32 v36, v24, v25
 v_cvt_pk_bf16_f32 v37, v26, v27
 v_cvt_pk_bf16_f32 v38, v28, v29
 v_cvt_pk_bf16_f32 v39, v30, v31
 s_mov_b64 exec, s[78:79]
 ds_write_b128 v71, v[36:39]
 s_mov_b64 exec, -1
 v_mov_b64 v[58:59], 0
 v_mov_b64 v[60:61], 0
 v_mov_b64 v[62:63], 0
 v_mov_b64 v[44:45], 0
 v_mov_b64 v[46:47], 0
 v_and_b32 v34, 0x7c, v70
 v_bfe_u32 v35, v70, 7, 1
 v_lshl_add_u32 v34, v35, 12, v34
 s_waitcnt lgkmcnt(0)
 s_barrier
 ds_read_b128 v[0:3], v43 offset:13312
 ds_read_b128 v[4:7], v43 offset:13344
 ds_read_b128 v[8:11], v43 offset:14336
 ds_read_b128 v[12:15], v43 offset:14368
 ds_read_b128 v[16:19], v64 offset:13312
 ds_read_b128 v[20:23], v64 offset:14336
 s_add_u32 s71, s71, 786432
 s_add_u32 s70, s70, 786432
 s_add_u32 s72, s72, 131072
 s_add_u32 s61, s61, 1
 s_add_u32 s95, s89, s91
 s_mov_b32 s62, 0
 s_cmp_eq_u32 s58, 3
 s_waitcnt lgkmcnt(5)
 v_smfmac_f32_16x16x64_bf16 v[48:51], v[0:3], a[112:119], v66
 s_waitcnt lgkmcnt(4)
 v_smfmac_f32_16x16x64_bf16 v[48:51], v[4:7], a[120:127], v66
 s_waitcnt lgkmcnt(3)
 v_smfmac_f32_16x16x64_bf16 v[48:51], v[8:11], a[128:135], v66
 s_waitcnt lgkmcnt(2)
 v_smfmac_f32_16x16x64_bf16 v[48:51], v[12:15], a[136:143], v66
 s_add_u32 s64, s85, 16384
 s_add_u32 s65, s86, 16384
 v_smfmac_f32_16x16x64_bf16 v[52:55], v[0:3], a[144:151], v66
 s_nop 0
 v_smfmac_f32_16x16x64_bf16 v[52:55], v[4:7], a[152:159], v66
 s_nop 0
 v_smfmac_f32_16x16x64_bf16 v[52:55], v[8:11], a[160:167], v66
 s_cmp_eq_u32 s58, 3
 v_smfmac_f32_16x16x64_bf16 v[52:55], v[12:15], a[168:175], v66
 v_cvt_pk_bf16_f32 v24, v48, v49
 v_smfmac_f32_16x16x64_bf16 v[56:59], v[0:3], a[176:183], v66
 v_cvt_pk_bf16_f32 v25, v50, v51
 v_smfmac_f32_16x16x64_bf16 v[56:59], v[4:7], a[184:191], v66
 v_and_or_b32 v24, v24, -2, s84
 buffer_store_dwordx2 v[24:25], v73, s[8:11], s85 offen sc1
 v_smfmac_f32_16x16x64_bf16 v[56:59], v[8:11], a[192:199], v66
 s_nop 0
 v_smfmac_f32_16x16x64_bf16 v[56:59], v[12:15], a[200:207], v66
 v_cvt_pk_bf16_f32 v26, v52, v53
 v_smfmac_f32_16x16x64_bf16 v[60:63], v[0:3], a[208:215], v66
 v_cvt_pk_bf16_f32 v27, v54, v55
 v_smfmac_f32_16x16x64_bf16 v[60:63], v[4:7], a[216:223], v66
 v_and_or_b32 v26, v26, -2, s84
 buffer_store_dwordx2 v[26:27], v73, s[8:11], s64 offen sc1
 v_smfmac_f32_16x16x64_bf16 v[60:63], v[8:11], a[224:231], v66
 s_nop 0
 v_smfmac_f32_16x16x64_bf16 v[60:63], v[12:15], a[232:239], v66
 v_cvt_pk_bf16_f32 v28, v56, v57
 s_waitcnt lgkmcnt(0)
 v_smfmac_f32_16x16x64_bf16 v[44:47], v[16:19], a[240:247], v66
 v_cvt_pk_bf16_f32 v29, v58, v59
 v_smfmac_f32_16x16x64_bf16 v[44:47], v[20:23], a[248:255], v66
 v_and_or_b32 v28, v28, -2, s84
 buffer_store_dwordx2 v[28:29], v73, s[8:11], s86 offen sc1
 s_nop 0
 v_cvt_pk_bf16_f32 v30, v60, v61
 v_cvt_pk_bf16_f32 v31, v62, v63
 v_and_or_b32 v30, v30, -2, s84
 buffer_store_dwordx2 v[30:31], v73, s[8:11], s65 offen sc1
 s_nop 0
 v_pk_add_f32 v[44:45], v[44:45], v[46:47]
 v_cvt_pk_bf16_f32 v33, v44, v45
 v_and_or_b32 v33, v33, -2, s84
 buffer_store_dword v33, v34, s[8:11], s87 offen sc1
 ds_read_b128 v[32:35], v65 offset:0
 ds_read_b128 v[36:39], v65 offset:1024
 ds_read_b128 v[40:43], v65 offset:2048
 ds_read_b128 v[44:47], v65 offset:3072
 ds_read_b128 v[48:51], v65 offset:4096
 ds_read_b128 v[52:55], v65 offset:5120
 s_load_dwordx2 s[64:65], s[8:9], s54 glc
 s_cbranch_scc1 L_chs_w3
 s_cmp_ge_u32 s74, 72
 s_cbranch_scc1 L_chs_nred
 s_mov_b32 vcc_lo, 0x1010101
 s_mov_b32 vcc_hi, 0x1010101
 v_cndmask_b32 v60, 0, v77, vcc
 s_mov_b32 vcc_lo, 0x2020202
 s_mov_b32 vcc_hi, 0x2020202
 v_cndmask_b32 v61, 0, v77, vcc
 s_mov_b32 vcc_lo, 0x10101010
 s_mov_b32 vcc_hi, 0x10101010
 v_cndmask_b32 v62, 0, v77, vcc
 s_mov_b32 vcc_lo, 0x20202020
 s_mov_b32 vcc_hi, 0x20202020
 v_cndmask_b32 v63, 0, v77, vcc
 s_waitcnt vmcnt(2)
 buffer_load_dwordx4 v[0:3], v64, s[8:11], s83 offen offset:0 sc1
 buffer_load_dwordx4 v[4:7], v64, s[8:11], s83 offen offset:1024 sc1
 buffer_load_dwordx4 v[8:11], v64, s[8:11], s83 offen offset:2048 sc1
 buffer_load_dwordx4 v[12:15], v64, s[8:11], s83 offen offset:3072 sc1
 s_waitcnt vmcnt(3)
L_chs_g:
 buffer_load_dwordx4 v[16:19], v64, s[8:11], s83 offen offset:0 sc1
 buffer_load_dwordx4 v[20:23], v64, s[8:11], s83 offen offset:1024 sc1
 buffer_load_dwordx4 v[24:27], v64, s[8:11], s83 offen offset:2048 sc1
 buffer_load_dwordx4 v[28:31], v64, s[8:11], s83 offen offset:3072 sc1
 s_waitcnt vmcnt(6)
 v_mfma_f32_16x16x32_bf16 v[56:59], v[60:63], v[0:3], 0
 v_xor_b32 v78, s84, v0
 v_mfma_f32_16x16x32_bf16 v[56:59], v[60:63], v[4:7], v[56:59]
 v_bitop3_b32 v78, v78, v4, s84 bitop3:0xf6
 s_waitcnt vmcnt(5)
 v_mfma_f32_16x16x32_bf16 v[56:59], v[60:63], v[8:11], v[56:59]
 v_bitop3_b32 v78, v78, v8, s84 bitop3:0xf6
 s_waitcnt vmcnt(4)
 v_mfma_f32_16x16x32_bf16 v[56:59], v[60:63], v[12:15], v[56:59]
 v_bitop3_b32 v78, v78, v12, s84 bitop3:0xf6
 v_and_b32 v78, 1, v78
 v_cmp_ne_u32 vcc, 0, v78
 s_add_u32 s62, s62, 1
 v_mov_b32 v78, -1
 s_nop 2
 v_add_f32_dpp v56, v56, v56 row_ror:8 row_mask:0xf bank_mask:0xf
 v_add_f32_dpp v57, v57, v57 row_ror:8 row_mask:0xf bank_mask:0xf
 v_cvt_pk_bf16_f32 v58, v56, v57
 v_min_u32 v58, -2, v58
 s_cbranch_vccz L_chs_gok
 buffer_load_dwordx4 v[0:3], v64, s[8:11], s83 offen offset:0 sc1
 buffer_load_dwordx4 v[4:7], v64, s[8:11], s83 offen offset:1024 sc1
 buffer_load_dwordx4 v[8:11], v64, s[8:11], s83 offen offset:2048 sc1
 buffer_load_dwordx4 v[12:15], v64, s[8:11], s83 offen offset:3072 sc1
 s_waitcnt vmcnt(6)
 v_mfma_f32_16x16x32_bf16 v[56:59], v[60:63], v[16:19], 0
 v_xor_b32 v78, s84, v16
 v_mfma_f32_16x16x32_bf16 v[56:59], v[60:63], v[20:23], v[56:59]
 v_bitop3_b32 v78, v78, v20, s84 bitop3:0xf6
 s_waitcnt vmcnt(5)
 v_mfma_f32_16x16x32_bf16 v[56:59], v[60:63], v[24:27], v[56:59]
 v_bitop3_b32 v78, v78, v24, s84 bitop3:0xf6
 s_waitcnt vmcnt(4)
 v_mfma_f32_16x16x32_bf16 v[56:59], v[60:63], v[28:31], v[56:59]
 v_bitop3_b32 v78, v78, v28, s84 bitop3:0xf6
 v_and_b32 v78, 1, v78
 v_cmp_ne_u32 vcc, 0, v78
 s_add_u32 s62, s62, 1
 v_mov_b32 v78, -1
 s_nop 2
 v_add_f32_dpp v56, v56, v56 row_ror:8 row_mask:0xf bank_mask:0xf
 v_add_f32_dpp v57, v57, v57 row_ror:8 row_mask:0xf bank_mask:0xf
 v_cvt_pk_bf16_f32 v58, v56, v57
 v_min_u32 v58, -2, v58
 s_cbranch_vccz L_chs_gok
 s_cmp_lt_u32 s62, 400000
 s_cbranch_scc1 L_chs_g
 s_mov_b32 s63, 41
 s_branch L_abort
L_chs_gok:
 buffer_store_dword v58, v74, s[8:11], s89 offen sc1
 buffer_store_dword v78, v74, s[8:11], s88 offen sc1
L_chs_poll:
 s_barrier
 s_mov_b32 s63, s88
 s_mov_b32 s88, s89
 s_mov_b32 s89, s90
 s_mov_b32 s90, s63
 s_add_u32 s85, s85, s82
 s_add_u32 s86, s86, s82
 s_add_u32 s87, s87, s82
 s_add_u32 s83, s83, s82
 s_sub_u32 s82, 0, s82
 s_bfe_u32 s84, s61, 0x10001
 s_xor_b32 s84, s84, 1
 s_mul_i32 s63, s58, 3072
 s_add_u32 m0, s63, 147456
 s_waitcnt vmcnt(2)
 v_add_u32 v78, s63, v64
 buffer_load_dwordx4 v64, s[8:11], s95 offen offset:0 sc1 lds
 buffer_load_dwordx4 v64, s[8:11], s95 offen offset:1024 sc1 lds
 buffer_load_dwordx4 v64, s[8:11], s95 offen offset:2048 sc1 lds
 v_mov_b64 v[8:9], 0
 v_mov_b64 v[10:11], 0
 v_mov_b64 v[12:13], 0
 v_mov_b64 v[14:15], 0
 v_mov_b64 v[16:17], 0
 v_mov_b64 v[18:19], 0
 v_mov_b64 v[20:21], 0
 v_mov_b64 v[22:23], 0
 v_mov_b64 v[56:57], 0
 v_mov_b64 v[58:59], 0
 v_mov_b64 v[60:61], 0
 v_mov_b64 v[62:63], 0
 s_waitcnt lgkmcnt(0)
 s_min_u32 s63, s64, s65
 s_cmp_gt_u32 s63, s61
 s_cselect_b32 s76, 1, 0
 s_cselect_b32 s80, s71, 2147483632
 s_cselect_b32 s81, s70, 2147483632
 s_cbranch_scc1 Lrd_21
 s_load_dwordx2 s[64:65], s[8:9], s54 glc
Lrd_21:
 s_waitcnt vmcnt(2)
Lp_20:
 buffer_load_dwordx4 v64, s[8:11], s95 offen offset:0 sc1 lds
 buffer_load_dwordx4 v64, s[8:11], s95 offen offset:1024 sc1 lds
 buffer_load_dwordx4 v64, s[8:11], s95 offen offset:2048 sc1 lds
 s_waitcnt vmcnt(3)
 ds_read_b128 v[24:27], v78
 ds_read_b128 v[28:31], v78 offset:1024
 ds_read_b128 v[4:7], v78 offset:2048
 s_add_u32 s62, s62, 1
 s_waitcnt lgkmcnt(1)
 v_max3_u32 v0, v24, v25, v26
 v_max3_u32 v1, v27, v28, v29
 v_max3_u32 v0, v0, v30, v31
 s_waitcnt lgkmcnt(0)
 v_max3_u32 v1, v1, v4, v5
 v_max3_u32 v0, v0, v6, v7
 v_max_u32 v0, v0, v1
 v_cmp_eq_u32 vcc, -1, v0
 s_cbranch_vccz L_chs_top
 s_cmp_lt_u32 s62, 400000
 s_cbranch_scc1 Lp_20
 s_mov_b32 s63, 42
 s_branch L_abort
L_chs_nred:
 s_waitcnt vmcnt(5)
 s_branch L_chs_poll
L_chs_w3:
 s_mov_b32 s69, 1
 s_waitcnt vmcnt(5) lgkmcnt(0)
 s_min_u32 s63, s64, s65
 s_cmp_gt_u32 s63, s61
 s_cselect_b32 s76, 1, 0
 s_cselect_b32 s80, s71, 2147483632
 s_cselect_b32 s81, s70, 2147483632
 s_barrier
 s_atomic_add s69, s[8:9], s55
 s_cbranch_scc1 L_chs_w3b
 s_load_dwordx2 s[64:65], s[8:9], s54 glc
 s_waitcnt lgkmcnt(0)
L_chs_w3b:
 v_mov_b64 v[8:9], 0
 v_mov_b64 v[10:11], 0
 v_mov_b64 v[12:13], 0
 v_mov_b64 v[14:15], 0
 v_mov_b64 v[16:17], 0
 v_mov_b64 v[18:19], 0
 v_mov_b64 v[20:21], 0
 v_mov_b64 v[22:23], 0
 v_mov_b64 v[56:57], 0
 v_mov_b64 v[58:59], 0
 v_mov_b64 v[60:61], 0
 v_mov_b64 v[62:63], 0
 s_mov_b32 s63, s88
 s_mov_b32 s88, s89
 s_mov_b32 s89, s90
 s_mov_b32 s90, s63
 s_add_u32 s85, s85, s82
 s_add_u32 s86, s86, s82
 s_add_u32 s87, s87, s82
 s_add_u32 s83, s83, s82
 s_sub_u32 s82, 0, s82
 s_bfe_u32 s84, s61, 0x10001
 s_xor_b32 s84, s84, 1
 s_barrier
 s_branch L_chs_top2
L_chs_m1:
 s_min_u32 s63, s64, s65
 s_cmp_gt_u32 s63, s61
 s_cselect_b32 s76, 1, 0
 s_cselect_b32 s80, s71, 2147483632
 s_cselect_b32 s81, s70, 2147483632
 s_cbranch_scc0 L_chs_m1b
 buffer_load_dwordx4 v[0:3], v64, s[8:11], s71 offen offset:0 sc1
 buffer_load_dwordx4 v[4:7], v64, s[8:11], s71 offen offset:1024 sc1
 s_branch L_chs_m1r
L_chs_m1b:
 buffer_load_dword v0, v75, s[8:11], 0 offen sc1
 s_branch L_chs_m1r
L_chs_m2:
 s_waitcnt vmcnt(0)
 v_cmp_ge_u32 vcc, s61, v0
 s_cbranch_vccnz L_chs_m2r
 buffer_load_dwordx4 v[0:3], v64, s[8:11], s71 offen offset:0 sc1
 buffer_load_dwordx4 v[4:7], v64, s[8:11], s71 offen offset:1024 sc1
 v_lshlrev_b32 v78, 2, v64
 s_sub_u32 s63, s70, 442368
 s_mov_b32 exec_hi, 0
 buffer_load_dword v78, v78, s[8:11], s63 offen sc1
 s_mov_b32 exec_hi, -1
 s_mov_b32 s76, 2
 s_branch L_chs_m2r
L_chs_m3:
 s_cmp_eq_u32 s76, 2
 s_cbranch_scc1 L_chs_m4
 s_add_u32 s64, s61, 1
 s_mov_b32 s62, 0
Lspin_22:
 buffer_load_dword v0, v75, s[8:11], 0 offen sc1
 s_waitcnt vmcnt(0)
 v_cmp_gt_u32 vcc, s64, v0
 s_cbranch_vccz Lspind_23
 s_add_u32 s62, s62, 1
 s_cmp_lt_u32 s62, 400000
 s_cbranch_scc1 Lspin_22
 s_mov_b32 s63, 40
 s_branch L_abort
Lspind_23:
 buffer_load_dwordx4 v[0:3], v64, s[8:11], s71 offen offset:0 sc1
 buffer_load_dwordx4 v[4:7], v64, s[8:11], s71 offen offset:1024 sc1
 v_lshlrev_b32 v78, 2, v64
 s_sub_u32 s63, s70, 442368
 s_mov_b32 exec_hi, 0
 buffer_load_dword v78, v78, s[8:11], s63 offen sc1
 s_mov_b32 exec_hi, -1
 s_waitcnt vmcnt(1)
L_chs_m4:
 s_branch L_chs_m3r
L_chs_late:
 v_smfmac_f32_16x16x64_bf16 v[56:59], v[24:27], a[96:103], v66
 v_smfmac_f32_16x16x64_bf16 v[60:63], v[24:27], a[104:111], v66
 ds_read_b128 v[24:27], v64 offset:3072
 s_waitcnt lgkmcnt(7)
 v_smfmac_f32_16x16x64_bf16 v[56:59], v[28:31], v[32:39], v66
 ds_read_b128 v[32:35], v65 offset:30720
 ds_read_b128 v[36:39], v65 offset:31744
 v_smfmac_f32_16x16x64_bf16 v[60:63], v[28:31], v[40:47], v66
 ds_read_b128 v[40:43], v65 offset:32768
 ds_read_b128 v[44:47], v65 offset:33792
 ds_read_b128 v[28:31], v64 offset:1024
 s_waitcnt lgkmcnt(5)
 v_smfmac_f32_16x16x64_bf16 v[56:59], v[24:27], a[16:23], v66
 v_smfmac_f32_16x16x64_bf16 v[60:63], v[24:27], a[24:31], v66
 ds_read_b128 v[24:27], v64 offset:2048
 s_waitcnt lgkmcnt(1)
 v_smfmac_f32_16x16x64_bf16 v[56:59], v[28:31], v[48:55], v66
 ds_read_b128 v[48:51], v65 offset:34816
 ds_read_b128 v[52:55], v65 offset:35840
 v_smfmac_f32_16x16x64_bf16 v[60:63], v[28:31], v[32:39], v66
 ds_read_b128 v[28:31], v64 offset:4096
 ds_read_b128 v[36:39], v64 offset:5120
 s_waitcnt lgkmcnt(4)
 v_smfmac_f32_16x16x64_bf16 v[56:59], v[24:27], v[40:47], v66
 ds_read_b128 v[44:47], v64 offset:6144
 s_waitcnt lgkmcnt(3)
 v_smfmac_f32_16x16x64_bf16 v[60:63], v[24:27], v[48:55], v66
 s_waitcnt lgkmcnt(2)
 v_smfmac_f32_16x16x64_bf16 v[56:59], v[28:31], a[32:39], v66
 v_smfmac_f32_16x16x64_bf16 v[60:63], v[28:31], a[40:47], v66
 s_waitcnt lgkmcnt(1)
 v_smfmac_f32_16x16x64_bf16 v[56:59], v[36:39], a[48:55], v66
 v_smfmac_f32_16x16x64_bf16 v[60:63], v[36:39], a[56:63], v66
 s_waitcnt lgkmcnt(0)
 v_smfmac_f32_16x16x64_bf16 v[56:59], v[44:47], a[64:71], v66
 v_smfmac_f32_16x16x64_bf16 v[60:63], v[44:47], a[72:79], v66
 buffer_store_dwordx4 v[12:15], v72, s[8:11], s72 offen sc1
 s_nop 6
 v_pk_add_f32 v[36:37], v[56:57], v[58:59]
 v_pk_add_f32 v[38:39], v[60:61], v[62:63]
 v_cvt_pk_bf16_f32 v40, v36, v37
 v_cvt_pk_bf16_f32 v41, v38, v39
 v_lshl_add_u32 v42, v70, 1, s68
 buffer_store_dwordx2 v[40:41], v42, s[8:11], s72 offen sc1
 s_waitcnt vmcnt(0) lgkmcnt(0)
 s_barrier
 s_cmp_lg_u32 s58, 3
 s_cbranch_scc1 L_chs_fin
 s_mov_b32 s69, 1
 s_atomic_add s69, s[8:9], s55
 s_waitcnt lgkmcnt(0)
L_chs_fin:
 s_endpgm
L_qkv:
 v_mbcnt_lo_u32_b32 v1, -1, 0
 v_mbcnt_hi_u32_b32 v1, -1, v1
 v_lshrrev_b32 v2, 2, v1
 v_and_b32 v4, 3, v1
 v_lshlrev_b32 v3, 4, v4
 v_lshl_add_u32 v10, v2, 13, v3
 v_lshrrev_b32 v5, 4, v1
 v_and_b32 v2, 3, v2
 v_lshl_add_u32 v5, v5, 3, v2
 s_mul_i32 s67, s58, 36864
 v_lshl_add_u32 v5, v5, 6, v3
 v_add_u32 v11, s67, v5
 s_lshl_b32 s65, s57, 8
 s_lshl_b32 s63, s58, 6
 s_add_u32 s65, s65, s63
 s_cmp_lg_u32 s7, 0
 s_cbranch_scc1 Lln_24
 s_waitcnt vmcnt(3)
 v_lshlrev_b32 v52, 16, v40
 v_and_b32 v53, 0xffff0000, v40
 v_lshlrev_b32 v54, 16, v41
 v_and_b32 v55, 0xffff0000, v41
 v_lshlrev_b32 v56, 16, v42
 v_and_b32 v57, 0xffff0000, v42
 v_lshlrev_b32 v58, 16, v43
 v_and_b32 v59, 0xffff0000, v43
 v_lshlrev_b32 v60, 16, v44
 v_and_b32 v61, 0xffff0000, v44
 v_lshlrev_b32 v62, 16, v45
 v_and_b32 v63, 0xffff0000, v45
 v_lshlrev_b32 v64, 16, v46
 v_and_b32 v65, 0xffff0000, v46
 v_lshlrev_b32 v66, 16, v47
 v_and_b32 v67, 0xffff0000, v47
 v_lshlrev_b32 v68, 16, v48
 v_and_b32 v69, 0xffff0000, v48
 v_lshlrev_b32 v70, 16, v49
 v_and_b32 v71, 0xffff0000, v49
 v_lshlrev_b32 v72, 16, v50
 v_and_b32 v73, 0xffff0000, v50
 v_lshlrev_b32 v74, 16, v51
 v_and_b32 v75, 0xffff0000, v51
 v_pk_add_f32 v[20:21], v[52:53], v[54:55]
 v_pk_add_f32 v[20:21], v[20:21], v[56:57]
 v_pk_add_f32 v[20:21], v[20:21], v[58:59]
 v_pk_add_f32 v[20:21], v[20:21], v[60:61]
 v_pk_add_f32 v[20:21], v[20:21], v[62:63]
 v_pk_add_f32 v[20:21], v[20:21], v[64:65]
 v_pk_add_f32 v[20:21], v[20:21], v[66:67]
 v_pk_add_f32 v[20:21], v[20:21], v[68:69]
 v_pk_add_f32 v[20:21], v[20:21], v[70:71]
 v_pk_add_f32 v[20:21], v[20:21], v[72:73]
 v_pk_add_f32 v[20:21], v[20:21], v[74:75]
 v_add_f32 v20, v20, v21
 s_nop 1
 v_add_f32_dpp v20, v20, v20 quad_perm:[1,0,3,2] row_mask:0xf bank_mask:0xf
 s_nop 1
 v_add_f32_dpp v20, v20, v20 quad_perm:[2,3,0,1] row_mask:0xf bank_mask:0xf
 s_nop 1
 v_add_f32_dpp v20, v20, v20 row_half_mirror row_mask:0xf bank_mask:0xf
 s_nop 1
 v_add_f32_dpp v20, v20, v20 row_mirror row_mask:0xf bank_mask:0xf
 v_mov_b32 v21, v20
 s_nop 1
 v_permlane16_swap_b32 v20, v21
 v_add_f32 v20, v20, v21
 v_mul_f32 v20, v78, v20
 v_pk_add_f32 v[52:53], v[52:53], v[20:21] op_sel_hi:[1,0]
 v_pk_add_f32 v[54:55], v[54:55], v[20:21] op_sel_hi:[1,0]
 v_pk_add_f32 v[56:57], v[56:57], v[20:21] op_sel_hi:[1,0]
 v_pk_add_f32 v[58:59], v[58:59], v[20:21] op_sel_hi:[1,0]
 v_pk_add_f32 v[60:61], v[60:61], v[20:21] op_sel_hi:[1,0]
 v_pk_add_f32 v[62:63], v[62:63], v[20:21] op_sel_hi:[1,0]
 v_pk_add_f32 v[64:65], v[64:65], v[20:21] op_sel_hi:[1,0]
 v_pk_add_f32 v[66:67], v[66:67], v[20:21] op_sel_hi:[1,0]
 v_pk_add_f32 v[68:69], v[68:69], v[20:21] op_sel_hi:[1,0]
 v_pk_add_f32 v[70:71], v[70:71], v[20:21] op_sel_hi:[1,0]
 v_pk_add_f32 v[72:73], v[72:73], v[20:21] op_sel_hi:[1,0]
 v_pk_add_f32 v[74:75], v[74:75], v[20:21] op_sel_hi:[1,0]
 v_pk_mul_f32 v[22:23], v[52:53], v[52:53]
 v_pk_fma_f32 v[22:23], v[54:55], v[54:55], v[22:23]
 v_pk_fma_f32 v[22:23], v[56:57], v[56:57], v[22:23]
 v_pk_fma_f32 v[22:23], v[58:59], v[58:59], v[22:23]
 v_pk_fma_f32 v[22:23], v[60:61], v[60:61], v[22:23]
 v_pk_fma_f32 v[22:23], v[62:63], v[62:63], v[22:23]
 v_pk_fma_f32 v[22:23], v[64:65], v[64:65], v[22:23]
 v_pk_fma_f32 v[22:23], v[66:67], v[66:67], v[22:23]
 v_pk_fma_f32 v[22:23], v[68:69], v[68:69], v[22:23]
 v_pk_fma_f32 v[22:23], v[70:71], v[70:71], v[22:23]
 v_pk_fma_f32 v[22:23], v[72:73], v[72:73], v[22:23]
 v_pk_fma_f32 v[22:23], v[74:75], v[74:75], v[22:23]
 v_add_f32 v22, v22, v23
 s_nop 1
 v_add_f32_dpp v22, v22, v22 quad_perm:[1,0,3,2] row_mask:0xf bank_mask:0xf
 s_nop 1
 v_add_f32_dpp v22, v22, v22 quad_perm:[2,3,0,1] row_mask:0xf bank_mask:0xf
 s_nop 1
 v_add_f32_dpp v22, v22, v22 row_half_mirror row_mask:0xf bank_mask:0xf
 s_nop 1
 v_add_f32_dpp v22, v22, v22 row_mirror row_mask:0xf bank_mask:0xf
 v_mov_b32 v23, v22
 s_nop 1
 v_permlane16_swap_b32 v22, v23
 v_add_f32 v22, v22, v23
 v_mov_b32 v23, 0x3727c5ac
 v_fmac_f32 v23, 0x3ae38e39, v22
 v_rsq_f32 v22, v23
 v_sub_f32 v20, 0, v20
 v_mul_f32 v21, v23, v22
 v_lshrrev_b32 v76, 2, v0
 v_and_b32 v78, 31, v0
 v_cmp_eq_u32 vcc, 0, v78
 v_mov_b32 v78, 2147483632
 s_lshl_b32 s63, s2, 6
 v_cndmask_b32 v76, v78, v76, vcc
 s_add_u32 s63, s63, 12582912
 buffer_store_dwordx2 v[20:21], v76, s[8:11], s63 offen sc1
 s_add_u32 s63, s3, 3145728
 v_pk_mul_f32 v[52:53], v[52:53], v[22:23] op_sel_hi:[1,0]
 v_pk_mul_f32 v[54:55], v[54:55], v[22:23] op_sel_hi:[1,0]
 v_pk_mul_f32 v[56:57], v[56:57], v[22:23] op_sel_hi:[1,0]
 v_pk_mul_f32 v[58:59], v[58:59], v[22:23] op_sel_hi:[1,0]
 v_pk_mul_f32 v[60:61], v[60:61], v[22:23] op_sel_hi:[1,0]
 v_pk_mul_f32 v[62:63], v[62:63], v[22:23] op_sel_hi:[1,0]
 v_pk_mul_f32 v[64:65], v[64:65], v[22:23] op_sel_hi:[1,0]
 v_pk_mul_f32 v[66:67], v[66:67], v[22:23] op_sel_hi:[1,0]
 v_pk_mul_f32 v[68:69], v[68:69], v[22:23] op_sel_hi:[1,0]
 v_pk_mul_f32 v[70:71], v[70:71], v[22:23] op_sel_hi:[1,0]
 v_pk_mul_f32 v[72:73], v[72:73], v[22:23] op_sel_hi:[1,0]
 v_pk_mul_f32 v[74:75], v[74:75], v[22:23] op_sel_hi:[1,0]
 v_cvt_pk_bf16_f32 v40, v52, v53
 v_cvt_pk_bf16_f32 v41, v54, v55
 v_cvt_pk_bf16_f32 v42, v56, v57
 v_cvt_pk_bf16_f32 v43, v58, v59
 v_cvt_pk_bf16_f32 v44, v60, v61
 v_cvt_pk_bf16_f32 v45, v62, v63
 v_cvt_pk_bf16_f32 v46, v64, v65
 v_cvt_pk_bf16_f32 v47, v66, v67
 v_cvt_pk_bf16_f32 v48, v68, v69
 v_cvt_pk_bf16_f32 v49, v70, v71
 v_cvt_pk_bf16_f32 v50, v72, v73
 v_cvt_pk_bf16_f32 v51, v74, v75
 buffer_store_dwordx4 v[40:43], v77, s[8:11], s63 offen offset:0 sc1
 buffer_store_dwordx4 v[44:47], v77, s[8:11], s63 offen offset:384 sc1
 buffer_store_dwordx4 v[48:51], v77, s[8:11], s63 offen offset:768 sc1
Lln_24:
 s_add_u32 m0, s67, 0
 s_add_u32 s69, s65, 0
 buffer_load_dwordx4 v10, s[32:35], s69 offen lds
 s_add_u32 m0, s67, 1024
 s_add_u32 s69, s65, 131072
 buffer_load_dwordx4 v10, s[32:35], s69 offen lds
 s_add_u32 m0, s67, 2048
 s_add_u32 s69, s65, 262144
 buffer_load_dwordx4 v10, s[32:35], s69 offen lds
 s_add_u32 m0, s67, 3072
 s_add_u32 s69, s65, 393216
 buffer_load_dwordx4 v10, s[32:35], s69 offen lds
 s_waitcnt vmcnt(4)
 s_cmp_lg_u32 s7, 0
 s_cbranch_scc1 Lar_25
 s_or_b32 s63, s6, 0x80
 v_mov_b32 v20, s63
 s_barrier
 buffer_store_byte v20, v79, s[20:23], 0 offen sc1
Lar_25:
 s_add_u32 m0, s67, 4096
 s_add_u32 s69, s65, 524288
 buffer_load_dwordx4 v10, s[32:35], s69 offen lds
 s_add_u32 m0, s67, 5120
 s_add_u32 s69, s65, 655360
 buffer_load_dwordx4 v10, s[32:35], s69 offen lds
 s_add_u32 m0, s67, 6144
 s_add_u32 s69, s65, 786432
 buffer_load_dwordx4 v10, s[32:35], s69 offen lds
 s_add_u32 m0, s67, 7168
 s_add_u32 s69, s65, 917504
 buffer_load_dwordx4 v10, s[32:35], s69 offen lds
 s_add_u32 m0, s67, 8192
 s_add_u32 s69, s65, 1048576
 buffer_load_dwordx4 v10, s[32:35], s69 offen lds
 s_add_u32 m0, s67, 9216
 s_add_u32 s69, s65, 1179648
 buffer_load_dwordx4 v10, s[32:35], s69 offen lds
 s_add_u32 m0, s67, 10240
 s_add_u32 s69, s65, 1310720
 buffer_load_dwordx4 v10, s[32:35], s69 offen lds
 s_add_u32 m0, s67, 11264
 s_add_u32 s69, s65, 1441792
 buffer_load_dwordx4 v10, s[32:35], s69 offen lds
 s_add_u32 m0, s67, 12288
 s_add_u32 s69, s65, 1572864
 buffer_load_dwordx4 v10, s[32:35], s69 offen lds
 s_add_u32 m0, s67, 13312
 s_add_u32 s69, s65, 1703936
 buffer_load_dwordx4 v10, s[32:35], s69 offen lds
 s_add_u32 m0, s67, 14336
 s_add_u32 s69, s65, 1835008
 buffer_load_dwordx4 v10, s[32:35], s69 offen lds
 s_add_u32 m0, s67, 15360
 s_add_u32 s69, s65, 1966080
 buffer_load_dwordx4 v10, s[32:35], s69 offen lds
 s_add_u32 m0, s67, 16384
 s_add_u32 s69, s65, 2097152
 buffer_load_dwordx4 v10, s[32:35], s69 offen lds
 s_add_u32 m0, s67, 17408
 s_add_u32 s69, s65, 2228224
 buffer_load_dwordx4 v10, s[32:35], s69 offen lds
 s_add_u32 m0, s67, 18432
 s_add_u32 s69, s65, 2359296
 buffer_load_dwordx4 v10, s[32:35], s69 offen lds
 s_add_u32 m0, s67, 19456
 s_add_u32 s69, s65, 2490368
 buffer_load_dwordx4 v10, s[32:35], s69 offen lds
 s_add_u32 m0, s67, 20480
 s_add_u32 s69, s65, 2621440
 buffer_load_dwordx4 v10, s[32:35], s69 offen lds
 s_add_u32 m0, s67, 21504
 s_add_u32 s69, s65, 2752512
 buffer_load_dwordx4 v10, s[32:35], s69 offen lds
 s_add_u32 m0, s67, 22528
 s_add_u32 s69, s65, 2883584
 buffer_load_dwordx4 v10, s[32:35], s69 offen lds
 s_add_u32 m0, s67, 23552
 s_add_u32 s69, s65, 3014656
 buffer_load_dwordx4 v10, s[32:35], s69 offen lds
 s_add_u32 m0, s67, 24576
 s_add_u32 s69, s65, 3145728
 buffer_load_dwordx4 v10, s[32:35], s69 offen lds
 s_add_u32 m0, s67, 25600
 s_add_u32 s69, s65, 3276800
 buffer_load_dwordx4 v10, s[32:35], s69 offen lds
 s_add_u32 m0, s67, 26624
 s_add_u32 s69, s65, 3407872
 buffer_load_dwordx4 v10, s[32:35], s69 offen lds
 s_add_u32 m0, s67, 27648
 s_add_u32 s69, s65, 3538944
 buffer_load_dwordx4 v10, s[32:35], s69 offen lds
 s_add_u32 m0, s67, 28672
 s_add_u32 s69, s65, 3670016
 buffer_load_dwordx4 v10, s[32:35], s69 offen lds
 s_add_u32 m0, s67, 29696
 s_add_u32 s69, s65, 3801088
 buffer_load_dwordx4 v10, s[32:35], s69 offen lds
 s_add_u32 m0, s67, 30720
 s_add_u32 s69, s65, 3932160
 buffer_load_dwordx4 v10, s[32:35], s69 offen lds
 s_add_u32 m0, s67, 31744
 s_add_u32 s69, s65, 4063232
 buffer_load_dwordx4 v10, s[32:35], s69 offen lds
 s_add_u32 m0, s67, 32768
 s_add_u32 s69, s65, 4194304
 buffer_load_dwordx4 v10, s[32:35], s69 offen lds
 s_add_u32 m0, s67, 33792
 s_add_u32 s69, s65, 4325376
 buffer_load_dwordx4 v10, s[32:35], s69 offen lds
 s_add_u32 m0, s67, 34816
 s_add_u32 s69, s65, 4456448
 buffer_load_dwordx4 v10, s[32:35], s69 offen lds
 s_add_u32 m0, s67, 35840
 s_add_u32 s69, s65, 4587520
 buffer_load_dwordx4 v10, s[32:35], s69 offen lds
 s_waitcnt vmcnt(32)
 ds_read_b64_tr_b16 v[80:81], v11 offset:0
 ds_read_b64_tr_b16 v[82:83], v11 offset:256
 ds_read_b64_tr_b16 v[84:85], v11 offset:8
 ds_read_b64_tr_b16 v[86:87], v11 offset:264
 ds_read_b64_tr_b16 v[104:105], v11 offset:2048
 ds_read_b64_tr_b16 v[106:107], v11 offset:2304
 ds_read_b64_tr_b16 v[108:109], v11 offset:2056
 ds_read_b64_tr_b16 v[110:111], v11 offset:2312
 s_waitcnt lgkmcnt(0)
 s_add_u32 m0, s67, 0
 s_add_u32 s69, s65, 0
 buffer_load_dwordx4 v10, s[36:39], s69 offen lds
 s_add_u32 m0, s67, 1024
 s_add_u32 s69, s65, 131072
 buffer_load_dwordx4 v10, s[36:39], s69 offen lds
 s_add_u32 m0, s67, 2048
 s_add_u32 s69, s65, 262144
 buffer_load_dwordx4 v10, s[36:39], s69 offen lds
 s_add_u32 m0, s67, 3072
 s_add_u32 s69, s65, 393216
 buffer_load_dwordx4 v10, s[36:39], s69 offen lds
 s_waitcnt vmcnt(32)
 ds_read_b64_tr_b16 v[128:129], v11 offset:4096
 ds_read_b64_tr_b16 v[130:131], v11 offset:4352
 ds_read_b64_tr_b16 v[132:133], v11 offset:4104
 ds_read_b64_tr_b16 v[134:135], v11 offset:4360
 ds_read_b64_tr_b16 v[152:153], v11 offset:6144
 ds_read_b64_tr_b16 v[154:155], v11 offset:6400
 ds_read_b64_tr_b16 v[156:157], v11 offset:6152
 ds_read_b64_tr_b16 v[158:159], v11 offset:6408
 s_waitcnt lgkmcnt(0)
 s_add_u32 m0, s67, 4096
 s_add_u32 s69, s65, 524288
 buffer_load_dwordx4 v10, s[36:39], s69 offen lds
 s_add_u32 m0, s67, 5120
 s_add_u32 s69, s65, 655360
 buffer_load_dwordx4 v10, s[36:39], s69 offen lds
 s_add_u32 m0, s67, 6144
 s_add_u32 s69, s65, 786432
 buffer_load_dwordx4 v10, s[36:39], s69 offen lds
 s_add_u32 m0, s67, 7168
 s_add_u32 s69, s65, 917504
 buffer_load_dwordx4 v10, s[36:39], s69 offen lds
 s_waitcnt vmcnt(32)
 ds_read_b64_tr_b16 v[176:177], v11 offset:8192
 ds_read_b64_tr_b16 v[178:179], v11 offset:8448
 ds_read_b64_tr_b16 v[180:181], v11 offset:8200
 ds_read_b64_tr_b16 v[182:183], v11 offset:8456
 ds_read_b64_tr_b16 v[200:201], v11 offset:10240
 ds_read_b64_tr_b16 v[202:203], v11 offset:10496
 ds_read_b64_tr_b16 v[204:205], v11 offset:10248
 ds_read_b64_tr_b16 v[206:207], v11 offset:10504
 s_waitcnt lgkmcnt(0)
 s_add_u32 m0, s67, 8192
 s_add_u32 s69, s65, 1048576
 buffer_load_dwordx4 v10, s[36:39], s69 offen lds
 s_add_u32 m0, s67, 9216
 s_add_u32 s69, s65, 1179648
 buffer_load_dwordx4 v10, s[36:39], s69 offen lds
 s_add_u32 m0, s67, 10240
 s_add_u32 s69, s65, 1310720
 buffer_load_dwordx4 v10, s[36:39], s69 offen lds
 s_add_u32 m0, s67, 11264
 s_add_u32 s69, s65, 1441792
 buffer_load_dwordx4 v10, s[36:39], s69 offen lds
 s_waitcnt vmcnt(32)
 ds_read_b64_tr_b16 v[224:225], v11 offset:12288
 ds_read_b64_tr_b16 v[226:227], v11 offset:12544
 ds_read_b64_tr_b16 v[228:229], v11 offset:12296
 ds_read_b64_tr_b16 v[230:231], v11 offset:12552
 ds_read_b64_tr_b16 v[248:249], v11 offset:14336
 ds_read_b64_tr_b16 v[250:251], v11 offset:14592
 ds_read_b64_tr_b16 v[252:253], v11 offset:14344
 ds_read_b64_tr_b16 v[254:255], v11 offset:14600
 s_waitcnt lgkmcnt(0)
 s_add_u32 m0, s67, 12288
 s_add_u32 s69, s65, 1572864
 buffer_load_dwordx4 v10, s[36:39], s69 offen lds
 s_add_u32 m0, s67, 13312
 s_add_u32 s69, s65, 1703936
 buffer_load_dwordx4 v10, s[36:39], s69 offen lds
 s_add_u32 m0, s67, 14336
 s_add_u32 s69, s65, 1835008
 buffer_load_dwordx4 v10, s[36:39], s69 offen lds
 s_add_u32 m0, s67, 15360
 s_add_u32 s69, s65, 1966080
 buffer_load_dwordx4 v10, s[36:39], s69 offen lds
 s_waitcnt vmcnt(32)
 ds_read_b64_tr_b16 a[16:17], v11 offset:16384
 ds_read_b64_tr_b16 a[18:19], v11 offset:16640
 ds_read_b64_tr_b16 a[20:21], v11 offset:16392
 ds_read_b64_tr_b16 a[22:23], v11 offset:16648
 ds_read_b64_tr_b16 a[40:41], v11 offset:18432
 ds_read_b64_tr_b16 a[42:43], v11 offset:18688
 ds_read_b64_tr_b16 a[44:45], v11 offset:18440
 ds_read_b64_tr_b16 a[46:47], v11 offset:18696
 s_waitcnt lgkmcnt(0)
 s_add_u32 m0, s67, 16384
 s_add_u32 s69, s65, 2097152
 buffer_load_dwordx4 v10, s[36:39], s69 offen lds
 s_add_u32 m0, s67, 17408
 s_add_u32 s69, s65, 2228224
 buffer_load_dwordx4 v10, s[36:39], s69 offen lds
 s_add_u32 m0, s67, 18432
 s_add_u32 s69, s65, 2359296
 buffer_load_dwordx4 v10, s[36:39], s69 offen lds
 s_add_u32 m0, s67, 19456
 s_add_u32 s69, s65, 2490368
 buffer_load_dwordx4 v10, s[36:39], s69 offen lds
 s_waitcnt vmcnt(32)
 ds_read_b64_tr_b16 a[64:65], v11 offset:20480
 ds_read_b64_tr_b16 a[66:67], v11 offset:20736
 ds_read_b64_tr_b16 a[68:69], v11 offset:20488
 ds_read_b64_tr_b16 a[70:71], v11 offset:20744
 ds_read_b64_tr_b16 a[88:89], v11 offset:22528
 ds_read_b64_tr_b16 a[90:91], v11 offset:22784
 ds_read_b64_tr_b16 a[92:93], v11 offset:22536
 ds_read_b64_tr_b16 a[94:95], v11 offset:22792
 s_waitcnt lgkmcnt(0)
 s_add_u32 m0, s67, 20480
 s_add_u32 s69, s65, 2621440
 buffer_load_dwordx4 v10, s[36:39], s69 offen lds
 s_add_u32 m0, s67, 21504
 s_add_u32 s69, s65, 2752512
 buffer_load_dwordx4 v10, s[36:39], s69 offen lds
 s_add_u32 m0, s67, 22528
 s_add_u32 s69, s65, 2883584
 buffer_load_dwordx4 v10, s[36:39], s69 offen lds
 s_add_u32 m0, s67, 23552
 s_add_u32 s69, s65, 3014656
 buffer_load_dwordx4 v10, s[36:39], s69 offen lds
 s_waitcnt vmcnt(32)
 ds_read_b64_tr_b16 a[112:113], v11 offset:24576
 ds_read_b64_tr_b16 a[114:115], v11 offset:24832
 ds_read_b64_tr_b16 a[116:117], v11 offset:24584
 ds_read_b64_tr_b16 a[118:119], v11 offset:24840
 ds_read_b64_tr_b16 a[136:137], v11 offset:26624
 ds_read_b64_tr_b16 a[138:139], v11 offset:26880
 ds_read_b64_tr_b16 a[140:141], v11 offset:26632
 ds_read_b64_tr_b16 a[142:143], v11 offset:26888
 s_waitcnt lgkmcnt(0)
 s_add_u32 m0, s67, 24576
 s_add_u32 s69, s65, 3145728
 buffer_load_dwordx4 v10, s[36:39], s69 offen lds
 s_add_u32 m0, s67, 25600
 s_add_u32 s69, s65, 3276800
 buffer_load_dwordx4 v10, s[36:39], s69 offen lds
 s_add_u32 m0, s67, 26624
 s_add_u32 s69, s65, 3407872
 buffer_load_dwordx4 v10, s[36:39], s69 offen lds
 s_add_u32 m0, s67, 27648
 s_add_u32 s69, s65, 3538944
 buffer_load_dwordx4 v10, s[36:39], s69 offen lds
 s_waitcnt vmcnt(32)
 ds_read_b64_tr_b16 a[160:161], v11 offset:28672
 ds_read_b64_tr_b16 a[162:163], v11 offset:28928
 ds_read_b64_tr_b16 a[164:165], v11 offset:28680
 ds_read_b64_tr_b16 a[166:167], v11 offset:28936
 ds_read_b64_tr_b16 a[184:185], v11 offset:30720
 ds_read_b64_tr_b16 a[186:187], v11 offset:30976
 ds_read_b64_tr_b16 a[188:189], v11 offset:30728
 ds_read_b64_tr_b16 a[190:191], v11 offset:30984
 s_waitcnt lgkmcnt(0)
 s_add_u32 m0, s67, 28672
 s_add_u32 s69, s65, 3670016
 buffer_load_dwordx4 v10, s[36:39], s69 offen lds
 s_add_u32 m0, s67, 29696
 s_add_u32 s69, s65, 3801088
 buffer_load_dwordx4 v10, s[36:39], s69 offen lds
 s_add_u32 m0, s67, 30720
 s_add_u32 s69, s65, 3932160
 buffer_load_dwordx4 v10, s[36:39], s69 offen lds
 s_add_u32 m0, s67, 31744
 s_add_u32 s69, s65, 4063232
 buffer_load_dwordx4 v10, s[36:39], s69 offen lds
 s_waitcnt vmcnt(32)
 ds_read_b64_tr_b16 a[208:209], v11 offset:32768
 ds_read_b64_tr_b16 a[210:211], v11 offset:33024
 ds_read_b64_tr_b16 a[212:213], v11 offset:32776
 ds_read_b64_tr_b16 a[214:215], v11 offset:33032
 ds_read_b64_tr_b16 a[232:233], v11 offset:34816
 ds_read_b64_tr_b16 a[234:235], v11 offset:35072
 ds_read_b64_tr_b16 a[236:237], v11 offset:34824
 ds_read_b64_tr_b16 a[238:239], v11 offset:35080
 s_waitcnt lgkmcnt(0)
 s_add_u32 m0, s67, 32768
 s_add_u32 s69, s65, 4194304
 buffer_load_dwordx4 v10, s[36:39], s69 offen lds
 s_add_u32 m0, s67, 33792
 s_add_u32 s69, s65, 4325376
 buffer_load_dwordx4 v10, s[36:39], s69 offen lds
 s_add_u32 m0, s67, 34816
 s_add_u32 s69, s65, 4456448
 buffer_load_dwordx4 v10, s[36:39], s69 offen lds
 s_add_u32 m0, s67, 35840
 s_add_u32 s69, s65, 4587520
 buffer_load_dwordx4 v10, s[36:39], s69 offen lds
 s_waitcnt vmcnt(32)
 ds_read_b64_tr_b16 v[88:89], v11 offset:0
 ds_read_b64_tr_b16 v[90:91], v11 offset:256
 ds_read_b64_tr_b16 v[92:93], v11 offset:8
 ds_read_b64_tr_b16 v[94:95], v11 offset:264
 ds_read_b64_tr_b16 v[112:113], v11 offset:2048
 ds_read_b64_tr_b16 v[114:115], v11 offset:2304
 ds_read_b64_tr_b16 v[116:117], v11 offset:2056
 ds_read_b64_tr_b16 v[118:119], v11 offset:2312
 s_waitcnt lgkmcnt(0)
 s_add_u32 m0, s67, 0
 s_add_u32 s69, s65, 0
 buffer_load_dwordx4 v10, s[28:31], s69 offen lds
 s_add_u32 m0, s67, 1024
 s_add_u32 s69, s65, 131072
 buffer_load_dwordx4 v10, s[28:31], s69 offen lds
 s_add_u32 m0, s67, 2048
 s_add_u32 s69, s65, 262144
 buffer_load_dwordx4 v10, s[28:31], s69 offen lds
 s_add_u32 m0, s67, 3072
 s_add_u32 s69, s65, 393216
 buffer_load_dwordx4 v10, s[28:31], s69 offen lds
 s_waitcnt vmcnt(32)
 ds_read_b64_tr_b16 v[136:137], v11 offset:4096
 ds_read_b64_tr_b16 v[138:139], v11 offset:4352
 ds_read_b64_tr_b16 v[140:141], v11 offset:4104
 ds_read_b64_tr_b16 v[142:143], v11 offset:4360
 ds_read_b64_tr_b16 v[160:161], v11 offset:6144
 ds_read_b64_tr_b16 v[162:163], v11 offset:6400
 ds_read_b64_tr_b16 v[164:165], v11 offset:6152
 ds_read_b64_tr_b16 v[166:167], v11 offset:6408
 s_waitcnt lgkmcnt(0)
 s_add_u32 m0, s67, 4096
 s_add_u32 s69, s65, 524288
 buffer_load_dwordx4 v10, s[28:31], s69 offen lds
 s_add_u32 m0, s67, 5120
 s_add_u32 s69, s65, 655360
 buffer_load_dwordx4 v10, s[28:31], s69 offen lds
 s_add_u32 m0, s67, 6144
 s_add_u32 s69, s65, 786432
 buffer_load_dwordx4 v10, s[28:31], s69 offen lds
 s_add_u32 m0, s67, 7168
 s_add_u32 s69, s65, 917504
 buffer_load_dwordx4 v10, s[28:31], s69 offen lds
 s_waitcnt vmcnt(32)
 ds_read_b64_tr_b16 v[184:185], v11 offset:8192
 ds_read_b64_tr_b16 v[186:187], v11 offset:8448
 ds_read_b64_tr_b16 v[188:189], v11 offset:8200
 ds_read_b64_tr_b16 v[190:191], v11 offset:8456
 ds_read_b64_tr_b16 v[208:209], v11 offset:10240
 ds_read_b64_tr_b16 v[210:211], v11 offset:10496
 ds_read_b64_tr_b16 v[212:213], v11 offset:10248
 ds_read_b64_tr_b16 v[214:215], v11 offset:10504
 s_waitcnt lgkmcnt(0)
 s_add_u32 m0, s67, 8192
 s_add_u32 s69, s65, 1048576
 buffer_load_dwordx4 v10, s[28:31], s69 offen lds
 s_add_u32 m0, s67, 9216
 s_add_u32 s69, s65, 1179648
 buffer_load_dwordx4 v10, s[28:31], s69 offen lds
 s_add_u32 m0, s67, 10240
 s_add_u32 s69, s65, 1310720
 buffer_load_dwordx4 v10, s[28:31], s69 offen lds
 s_add_u32 m0, s67, 11264
 s_add_u32 s69, s65, 1441792
 buffer_load_dwordx4 v10, s[28:31], s69 offen lds
 s_waitcnt vmcnt(32)
 ds_read_b64_tr_b16 v[232:233], v11 offset:12288
 ds_read_b64_tr_b16 v[234:235], v11 offset:12544
 ds_read_b64_tr_b16 v[236:237], v11 offset:12296
 ds_read_b64_tr_b16 v[238:239], v11 offset:12552
 ds_read_b64_tr_b16 a[0:1], v11 offset:14336
 ds_read_b64_tr_b16 a[2:3], v11 offset:14592
 ds_read_b64_tr_b16 a[4:5], v11 offset:14344
 ds_read_b64_tr_b16 a[6:7], v11 offset:14600
 s_waitcnt lgkmcnt(0)
 s_add_u32 m0, s67, 12288
 s_add_u32 s69, s65, 1572864
 buffer_load_dwordx4 v10, s[28:31], s69 offen lds
 s_add_u32 m0, s67, 13312
 s_add_u32 s69, s65, 1703936
 buffer_load_dwordx4 v10, s[28:31], s69 offen lds
 s_add_u32 m0, s67, 14336
 s_add_u32 s69, s65, 1835008
 buffer_load_dwordx4 v10, s[28:31], s69 offen lds
 s_add_u32 m0, s67, 15360
 s_add_u32 s69, s65, 1966080
 buffer_load_dwordx4 v10, s[28:31], s69 offen lds
 s_waitcnt vmcnt(32)
 ds_read_b64_tr_b16 a[24:25], v11 offset:16384
 ds_read_b64_tr_b16 a[26:27], v11 offset:16640
 ds_read_b64_tr_b16 a[28:29], v11 offset:16392
 ds_read_b64_tr_b16 a[30:31], v11 offset:16648
 ds_read_b64_tr_b16 a[48:49], v11 offset:18432
 ds_read_b64_tr_b16 a[50:51], v11 offset:18688
 ds_read_b64_tr_b16 a[52:53], v11 offset:18440
 ds_read_b64_tr_b16 a[54:55], v11 offset:18696
 s_waitcnt lgkmcnt(0)
 s_add_u32 m0, s67, 16384
 s_add_u32 s69, s65, 2097152
 buffer_load_dwordx4 v10, s[28:31], s69 offen lds
 s_add_u32 m0, s67, 17408
 s_add_u32 s69, s65, 2228224
 buffer_load_dwordx4 v10, s[28:31], s69 offen lds
 s_add_u32 m0, s67, 18432
 s_add_u32 s69, s65, 2359296
 buffer_load_dwordx4 v10, s[28:31], s69 offen lds
 s_add_u32 m0, s67, 19456
 s_add_u32 s69, s65, 2490368
 buffer_load_dwordx4 v10, s[28:31], s69 offen lds
 s_waitcnt vmcnt(32)
 ds_read_b64_tr_b16 a[72:73], v11 offset:20480
 ds_read_b64_tr_b16 a[74:75], v11 offset:20736
 ds_read_b64_tr_b16 a[76:77], v11 offset:20488
 ds_read_b64_tr_b16 a[78:79], v11 offset:20744
 ds_read_b64_tr_b16 a[96:97], v11 offset:22528
 ds_read_b64_tr_b16 a[98:99], v11 offset:22784
 ds_read_b64_tr_b16 a[100:101], v11 offset:22536
 ds_read_b64_tr_b16 a[102:103], v11 offset:22792
 s_waitcnt lgkmcnt(0)
 s_add_u32 m0, s67, 20480
 s_add_u32 s69, s65, 2621440
 buffer_load_dwordx4 v10, s[28:31], s69 offen lds
 s_add_u32 m0, s67, 21504
 s_add_u32 s69, s65, 2752512
 buffer_load_dwordx4 v10, s[28:31], s69 offen lds
 s_add_u32 m0, s67, 22528
 s_add_u32 s69, s65, 2883584
 buffer_load_dwordx4 v10, s[28:31], s69 offen lds
 s_add_u32 m0, s67, 23552
 s_add_u32 s69, s65, 3014656
 buffer_load_dwordx4 v10, s[28:31], s69 offen lds
 s_waitcnt vmcnt(32)
 ds_read_b64_tr_b16 a[120:121], v11 offset:24576
 ds_read_b64_tr_b16 a[122:123], v11 offset:24832
 ds_read_b64_tr_b16 a[124:125], v11 offset:24584
 ds_read_b64_tr_b16 a[126:127], v11 offset:24840
 ds_read_b64_tr_b16 a[144:145], v11 offset:26624
 ds_read_b64_tr_b16 a[146:147], v11 offset:26880
 ds_read_b64_tr_b16 a[148:149], v11 offset:26632
 ds_read_b64_tr_b16 a[150:151], v11 offset:26888
 s_waitcnt lgkmcnt(0)
 s_add_u32 m0, s67, 24576
 s_add_u32 s69, s65, 3145728
 buffer_load_dwordx4 v10, s[28:31], s69 offen lds
 s_add_u32 m0, s67, 25600
 s_add_u32 s69, s65, 3276800
 buffer_load_dwordx4 v10, s[28:31], s69 offen lds
 s_add_u32 m0, s67, 26624
 s_add_u32 s69, s65, 3407872
 buffer_load_dwordx4 v10, s[28:31], s69 offen lds
 s_add_u32 m0, s67, 27648
 s_add_u32 s69, s65, 3538944
 buffer_load_dwordx4 v10, s[28:31], s69 offen lds
 s_waitcnt vmcnt(32)
 ds_read_b64_tr_b16 a[168:169], v11 offset:28672
 ds_read_b64_tr_b16 a[170:171], v11 offset:28928
 ds_read_b64_tr_b16 a[172:173], v11 offset:28680
 ds_read_b64_tr_b16 a[174:175], v11 offset:28936
 ds_read_b64_tr_b16 a[192:193], v11 offset:30720
 ds_read_b64_tr_b16 a[194:195], v11 offset:30976
 ds_read_b64_tr_b16 a[196:197], v11 offset:30728
 ds_read_b64_tr_b16 a[198:199], v11 offset:30984
 s_waitcnt lgkmcnt(0)
 s_add_u32 m0, s67, 28672
 s_add_u32 s69, s65, 3670016
 buffer_load_dwordx4 v10, s[28:31], s69 offen lds
 s_add_u32 m0, s67, 29696
 s_add_u32 s69, s65, 3801088
 buffer_load_dwordx4 v10, s[28:31], s69 offen lds
 s_add_u32 m0, s67, 30720
 s_add_u32 s69, s65, 3932160
 buffer_load_dwordx4 v10, s[28:31], s69 offen lds
 s_add_u32 m0, s67, 31744
 s_add_u32 s69, s65, 4063232
 buffer_load_dwordx4 v10, s[28:31], s69 offen lds
 s_waitcnt vmcnt(32)
 ds_read_b64_tr_b16 a[216:217], v11 offset:32768
 ds_read_b64_tr_b16 a[218:219], v11 offset:33024
 ds_read_b64_tr_b16 a[220:221], v11 offset:32776
 ds_read_b64_tr_b16 a[222:223], v11 offset:33032
 ds_read_b64_tr_b16 a[240:241], v11 offset:34816
 ds_read_b64_tr_b16 a[242:243], v11 offset:35072
 ds_read_b64_tr_b16 a[244:245], v11 offset:34824
 ds_read_b64_tr_b16 a[246:247], v11 offset:35080
 s_waitcnt lgkmcnt(0)
 s_add_u32 m0, s67, 32768
 s_add_u32 s69, s65, 4194304
 buffer_load_dwordx4 v10, s[28:31], s69 offen lds
 s_add_u32 m0, s67, 33792
 s_add_u32 s69, s65, 4325376
 buffer_load_dwordx4 v10, s[28:31], s69 offen lds
 s_add_u32 m0, s67, 34816
 s_add_u32 s69, s65, 4456448
 buffer_load_dwordx4 v10, s[28:31], s69 offen lds
 s_add_u32 m0, s67, 35840
 s_add_u32 s69, s65, 4587520
 buffer_load_dwordx4 v10, s[28:31], s69 offen lds
 s_waitcnt vmcnt(32)
 ds_read_b64_tr_b16 v[96:97], v11 offset:0
 ds_read_b64_tr_b16 v[98:99], v11 offset:256
 ds_read_b64_tr_b16 v[100:101], v11 offset:8
 ds_read_b64_tr_b16 v[102:103], v11 offset:264
 ds_read_b64_tr_b16 v[120:121], v11 offset:2048
 ds_read_b64_tr_b16 v[122:123], v11 offset:2304
 ds_read_b64_tr_b16 v[124:125], v11 offset:2056
 ds_read_b64_tr_b16 v[126:127], v11 offset:2312
 s_waitcnt vmcnt(28)
 ds_read_b64_tr_b16 v[144:145], v11 offset:4096
 ds_read_b64_tr_b16 v[146:147], v11 offset:4352
 ds_read_b64_tr_b16 v[148:149], v11 offset:4104
 ds_read_b64_tr_b16 v[150:151], v11 offset:4360
 ds_read_b64_tr_b16 v[168:169], v11 offset:6144
 ds_read_b64_tr_b16 v[170:171], v11 offset:6400
 ds_read_b64_tr_b16 v[172:173], v11 offset:6152
 ds_read_b64_tr_b16 v[174:175], v11 offset:6408
 s_waitcnt vmcnt(24)
 ds_read_b64_tr_b16 v[192:193], v11 offset:8192
 ds_read_b64_tr_b16 v[194:195], v11 offset:8448
 ds_read_b64_tr_b16 v[196:197], v11 offset:8200
 ds_read_b64_tr_b16 v[198:199], v11 offset:8456
 ds_read_b64_tr_b16 v[216:217], v11 offset:10240
 ds_read_b64_tr_b16 v[218:219], v11 offset:10496
 ds_read_b64_tr_b16 v[220:221], v11 offset:10248
 ds_read_b64_tr_b16 v[222:223], v11 offset:10504
 s_waitcnt vmcnt(20)
 ds_read_b64_tr_b16 v[240:241], v11 offset:12288
 ds_read_b64_tr_b16 v[242:243], v11 offset:12544
 ds_read_b64_tr_b16 v[244:245], v11 offset:12296
 ds_read_b64_tr_b16 v[246:247], v11 offset:12552
 ds_read_b64_tr_b16 a[8:9], v11 offset:14336
 ds_read_b64_tr_b16 a[10:11], v11 offset:14592
 ds_read_b64_tr_b16 a[12:13], v11 offset:14344
 ds_read_b64_tr_b16 a[14:15], v11 offset:14600
 s_waitcnt vmcnt(16)
 ds_read_b64_tr_b16 a[32:33], v11 offset:16384
 ds_read_b64_tr_b16 a[34:35], v11 offset:16640
 ds_read_b64_tr_b16 a[36:37], v11 offset:16392
 ds_read_b64_tr_b16 a[38:39], v11 offset:16648
 ds_read_b64_tr_b16 a[56:57], v11 offset:18432
 ds_read_b64_tr_b16 a[58:59], v11 offset:18688
 ds_read_b64_tr_b16 a[60:61], v11 offset:18440
 ds_read_b64_tr_b16 a[62:63], v11 offset:18696
 s_waitcnt vmcnt(12)
 ds_read_b64_tr_b16 a[80:81], v11 offset:20480
 ds_read_b64_tr_b16 a[82:83], v11 offset:20736
 ds_read_b64_tr_b16 a[84:85], v11 offset:20488
 ds_read_b64_tr_b16 a[86:87], v11 offset:20744
 ds_read_b64_tr_b16 a[104:105], v11 offset:22528
 ds_read_b64_tr_b16 a[106:107], v11 offset:22784
 ds_read_b64_tr_b16 a[108:109], v11 offset:22536
 ds_read_b64_tr_b16 a[110:111], v11 offset:22792
 s_waitcnt vmcnt(8)
 ds_read_b64_tr_b16 a[128:129], v11 offset:24576
 ds_read_b64_tr_b16 a[130:131], v11 offset:24832
 ds_read_b64_tr_b16 a[132:133], v11 offset:24584
 ds_read_b64_tr_b16 a[134:135], v11 offset:24840
 ds_read_b64_tr_b16 a[152:153], v11 offset:26624
 ds_read_b64_tr_b16 a[154:155], v11 offset:26880
 ds_read_b64_tr_b16 a[156:157], v11 offset:26632
 ds_read_b64_tr_b16 a[158:159], v11 offset:26888
 s_waitcnt vmcnt(4)
 ds_read_b64_tr_b16 a[176:177], v11 offset:28672
 ds_read_b64_tr_b16 a[178:179], v11 offset:28928
 ds_read_b64_tr_b16 a[180:181], v11 offset:28680
 ds_read_b64_tr_b16 a[182:183], v11 offset:28936
 ds_read_b64_tr_b16 a[200:201], v11 offset:30720
 ds_read_b64_tr_b16 a[202:203], v11 offset:30976
 ds_read_b64_tr_b16 a[204:205], v11 offset:30728
 ds_read_b64_tr_b16 a[206:207], v11 offset:30984
 s_waitcnt vmcnt(0)
 ds_read_b64_tr_b16 a[224:225], v11 offset:32768
 ds_read_b64_tr_b16 a[226:227], v11 offset:33024
 ds_read_b64_tr_b16 a[228:229], v11 offset:32776
 ds_read_b64_tr_b16 a[230:231], v11 offset:33032
 ds_read_b64_tr_b16 a[248:249], v11 offset:34816
 ds_read_b64_tr_b16 a[250:251], v11 offset:35072
 ds_read_b64_tr_b16 a[252:253], v11 offset:34824
 ds_read_b64_tr_b16 a[254:255], v11 offset:35080
 s_waitcnt lgkmcnt(0)
 s_barrier
 s_cmp_eq_u32 s7, 1
 s_cbranch_scc1 Lvalok_28
 v_mbcnt_lo_u32_b32 v1, -1, 0
 v_mbcnt_hi_u32_b32 v1, -1, v1
 v_lshlrev_b32 v1, 2, v1
 s_mov_b32 s62, 0
 s_mov_b32 s63, 0x80808080
Lval_26:
 buffer_load_dword v2, v1, s[20:23], 0 offen sc1
 s_waitcnt vmcnt(0)
 v_and_b32 v3, s63, v2
 v_cmp_ne_u32 vcc, s63, v3
 s_cbranch_vccz Lvald_27
 s_add_u32 s62, s62, 1
 s_cmp_lt_u32 s62, 400000
 s_cbranch_scc1 Lval_26
Lvald_27:
 s_mov_b32 s63, 1
 s_cbranch_vccnz L_abort
 v_lshlrev_b32 v3, v2, 1
 v_lshrrev_b32 v4, 8, v2
 v_lshl_or_b32 v3, 1, v4, v3
 v_lshrrev_b32 v4, 16, v2
 v_lshl_or_b32 v3, 1, v4, v3
 v_lshrrev_b32 v4, 24, v2
 v_lshl_or_b32 v3, 1, v4, v3
 s_nop 1
 v_or_b32_dpp v3, v3, v3 quad_perm:[1,0,3,2] row_mask:0xf bank_mask:0xf
 v_cmp_ne_u32 vcc, 255, v3
 s_cbranch_vccnz L_rerank
 s_mov_b32 s7, 1
Lvalok_28:
 s_lshl_b32 s63, s57, 7
 s_lshl_b32 s64, s60, 2
 s_add_u32 s63, s63, s64
 s_add_u32 s74, s60, 1
 s_add_u32 s75, s60, 1
 s_add_u32 s63, s63, 12288
 s_mov_b32 s71, s63
 v_mbcnt_lo_u32_b32 v1, -1, 0
 v_mbcnt_hi_u32_b32 v1, -1, v1
 v_cmp_eq_u32 vcc, 0, v1
 v_mov_b32 v2, s63
 v_mov_b32 v77, 2147483632
 v_cndmask_b32 v77, v77, v2, vcc
 v_and_b32 v2, 3, v1
 v_lshrrev_b32 v3, 5, v1
 v_lshlrev_b32 v2, 2, v2
 v_lshl_add_u32 v2, v3, 7, v2
 v_add_u32 v74, 0, v2
 v_mov_b32 v2, 2147483632
 s_nop 0
 s_mov_b32 s90, 0
 s_mov_b32 s91, 64
 s_sub_u32 s64, s75, 1
 v_mov_b32 v2, s60
 v_mov_b32 v3, s64
 s_mov_b32 s63, 4096
 buffer_store_dword v2, v77, s[8:11], 0 offen sc1
 buffer_store_dword v3, v77, s[8:11], s63 offen sc1
 s_mul_i32 s63, s57, 24576
 s_lshl_b32 s64, s58, 11
 s_add_u32 s63, s63, s64
 v_lshlrev_b32 v73, 4, v1
 s_add_u32 s87, s63, 20971520
 s_add_u32 s88, s87, 8192
 s_add_u32 s89, s87, 16384
 v_mbcnt_lo_u32_b32 v1, -1, 0
 v_mbcnt_hi_u32_b32 v1, -1, v1
 v_and_b32 v2, 15, v1
 v_lshrrev_b32 v3, 4, v1
 v_lshrrev_b32 v4, 1, v2
 v_mul_u32_u24 v5, 1152, v2
 v_add_u32 v5, 81920, v5
 v_xor_b32 v6, v3, v4
 v_lshl_add_u32 v70, v6, 4, v5
 v_xor_b32 v6, 4, v6
 v_lshl_add_u32 v71, v6, 4, v5
 s_lshl_b32 s70, s58, 10
 v_lshl_add_u32 v72, v1, 4, s70
 s_add_u32 s70, s70, 8192
 s_mov_b32 s85, -73728
 s_mov_b32 s3, 4096
 s_mov_b32 s84, 1
 s_mov_b32 s4, 36864
 s_mov_b32 s5, 36864
 s_mov_b32 s61, 0
 s_mov_b32 s77, 0
 s_mov_b32 s78, 0
 s_mov_b32 s79, 0
 s_mov_b32 s92, 2147483632
 s_mov_b32 s93, 0
 s_cmp_eq_u32 s58, 0
 s_cbranch_scc1 Lw0_29
 v_mov_b32 v74, 2147483632
 v_mov_b32 v77, 2147483632
Lw0_29:
 s_add_u32 s90, s90, 3108864
 s_sub_u32 s87, s87, 786432
 s_sub_u32 s88, s88, 786432
 s_sub_u32 s89, s89, 786432
L_q_idle:
 s_cmp_lg_u32 s58, 0
 s_cbranch_scc1 Lspd_31
 s_mov_b32 s62, 0
Lsp_30:
 buffer_load_dword v75, v74, s[8:11], 0 offen sc1
 s_waitcnt vmcnt(0)
 v_cmp_gt_u32 vcc, s74, v75
 v_cmp_gt_u32 s[66:67], s75, v75
 s_cmp_eq_u32 vcc_lo, 0
 s_cselect_b32 s72, s84, 0
 s_cmp_eq_u32 s67, 0
 s_cselect_b32 s72, 2, s72
 v_mov_b32 v76, s72
 ds_write_b32 v72, v76 offset:4096
 s_cmp_lg_u32 s72, 0
 s_cbranch_scc1 Lspd_31
 s_add_u32 s62, s62, 1
 s_cmp_lt_u32 s62, 400000
 s_cbranch_scc1 Lsp_30
Lspd_31:
 s_waitcnt lgkmcnt(0)
 s_barrier
 ds_read_b32 v76, v73 offset:4096
 s_waitcnt lgkmcnt(0)
 v_readfirstlane_b32 s72, v76
 s_mov_b32 s63, 20
 s_cmp_eq_u32 s72, 0
 s_cbranch_scc1 L_abort
 s_sub_u32 s68, s72, 1
 s_cmp_eq_u32 s68, 0
 s_cselect_b32 s69, s74, s75
 s_cselect_b32 s63, 2, 0
 s_cselect_b32 s64, 0, 2
 s_add_u32 s74, s74, s63
 s_add_u32 s75, s75, s64
 s_add_u32 s63, s75, 8
 s_cmp_lt_u32 s74, s63
 s_cselect_b32 s84, 1, s68
 s_cmp_lt_u32 s75, 3
 s_cselect_b32 s84, 1, s84
 s_mul_i32 s73, s69, 36864
 s_mul_i32 s63, s68, 2359296
 s_add_u32 s73, s73, s63
 s_add_u32 s73, s73, s90
 s_mov_b32 m0, s70
 s_nop 0
 buffer_load_dwordx4 v72, s[8:11], s73 offen sc1 lds
 s_add_u32 m0, m0, s3
 s_add_u32 s73, s73, s3
 buffer_load_dwordx4 v72, s[8:11], s73 offen sc1 lds
 s_add_u32 m0, m0, s3
 s_add_u32 s73, s73, s3
 buffer_load_dwordx4 v72, s[8:11], s73 offen sc1 lds
 s_add_u32 m0, m0, s3
 s_add_u32 s73, s73, s3
 buffer_load_dwordx4 v72, s[8:11], s73 offen sc1 lds
 s_add_u32 m0, m0, s3
 s_add_u32 s73, s73, s3
 buffer_load_dwordx4 v72, s[8:11], s73 offen sc1 lds
 s_add_u32 m0, m0, s3
 s_add_u32 s73, s73, s3
 buffer_load_dwordx4 v72, s[8:11], s73 offen sc1 lds
 s_add_u32 m0, m0, s3
 s_add_u32 s73, s73, s3
 buffer_load_dwordx4 v72, s[8:11], s73 offen sc1 lds
 s_add_u32 m0, m0, s3
 s_add_u32 s73, s73, s3
 buffer_load_dwordx4 v72, s[8:11], s73 offen sc1 lds
 s_add_u32 m0, m0, s3
 s_add_u32 s73, s73, s3
 buffer_load_dwordx4 v72, s[8:11], s73 offen sc1 lds
 s_mov_b32 s63, s85
 s_mov_b32 s85, s4
 s_mov_b32 s4, s5
 s_mov_b32 s5, s63
 s_add_u32 s70, s70, s85
 s_mov_b32 s81, s77
 s_mov_b32 s82, s78
 s_mov_b32 s83, s79
 s_mov_b32 s94, s92
 s_mov_b32 s95, s93
 s_mov_b32 s63, s69
 s_mul_i32 s63, s63, 786432
 s_mul_i32 s64, s68, 50331648
 s_add_u32 s63, s63, s64
 s_add_u32 s77, s63, s87
 s_add_u32 s78, s63, s88
 s_add_u32 s79, s63, s89
 s_mul_i32 s92, s68, 4096
 s_add_u32 s93, s69, 1
 s_add_u32 s61, s61, 1
 v_add_u32 v70, s5, v70
 v_add_u32 v71, s5, v71
 v_cmp_gt_u32 vcc, s74, v75
 v_cmp_gt_u32 s[66:67], s75, v75
 s_cmp_eq_u32 vcc_lo, 0
 s_cselect_b32 s72, s84, 0
 s_cmp_eq_u32 s67, 0
 s_cselect_b32 s72, 2, s72
 v_mov_b32 v76, s72
 ds_write_b32 v72, v76 offset:12
 s_waitcnt vmcnt(4) lgkmcnt(0)
 s_barrier
 ds_read_b32 v76, v73 offset:12
 ds_read_b128 v[48:51], v70 offset:0
 ds_read_b128 v[52:55], v71 offset:0
 s_waitcnt lgkmcnt(2)
 v_readfirstlane_b32 s72, v76
 s_cmp_lg_u32 s72, 0
L_q_slow:
 s_cbranch_scc1 L_q_p0d
 s_waitcnt lgkmcnt(1)
 v_mfma_f32_16x16x32_bf16 v[0:3], v[80:83], v[48:51], 0
 ds_read_b128 v[56:59], v70 offset:128
 v_mfma_f32_16x16x32_bf16 v[4:7], v[84:87], v[48:51], 0
 v_mfma_f32_16x16x32_bf16 v[8:11], v[48:51], v[88:91], 0
 v_mfma_f32_16x16x32_bf16 v[12:15], v[48:51], v[92:95], 0
 v_mfma_f32_16x16x32_bf16 v[16:19], v[96:99], v[48:51], 0
 v_mfma_f32_16x16x32_bf16 v[20:23], v[100:103], v[48:51], 0
 s_waitcnt lgkmcnt(1)
 v_mfma_f32_16x16x32_bf16 v[0:3], v[104:107], v[52:55], v[0:3]
 ds_read_b128 v[48:51], v71 offset:128
 v_mfma_f32_16x16x32_bf16 v[4:7], v[108:111], v[52:55], v[4:7]
 v_mfma_f32_16x16x32_bf16 v[8:11], v[52:55], v[112:115], v[8:11]
 v_mfma_f32_16x16x32_bf16 v[12:15], v[52:55], v[116:119], v[12:15]
 v_mfma_f32_16x16x32_bf16 v[16:19], v[120:123], v[52:55], v[16:19]
 v_mfma_f32_16x16x32_bf16 v[20:23], v[124:127], v[52:55], v[20:23]
 s_waitcnt lgkmcnt(1)
 v_mfma_f32_16x16x32_bf16 v[0:3], v[128:131], v[56:59], v[0:3]
 ds_read_b128 v[52:55], v70 offset:256
 v_mfma_f32_16x16x32_bf16 v[4:7], v[132:135], v[56:59], v[4:7]
 v_mfma_f32_16x16x32_bf16 v[8:11], v[56:59], v[136:139], v[8:11]
 v_mfma_f32_16x16x32_bf16 v[12:15], v[56:59], v[140:143], v[12:15]
 v_mfma_f32_16x16x32_bf16 v[16:19], v[144:147], v[56:59], v[16:19]
 v_mfma_f32_16x16x32_bf16 v[20:23], v[148:151], v[56:59], v[20:23]
 s_waitcnt lgkmcnt(1)
 v_mfma_f32_16x16x32_bf16 v[0:3], v[152:155], v[48:51], v[0:3]
 ds_read_b128 v[56:59], v71 offset:256
 v_mfma_f32_16x16x32_bf16 v[4:7], v[156:159], v[48:51], v[4:7]
 v_mfma_f32_16x16x32_bf16 v[8:11], v[48:51], v[160:163], v[8:11]
 v_mfma_f32_16x16x32_bf16 v[12:15], v[48:51], v[164:167], v[12:15]
 v_mfma_f32_16x16x32_bf16 v[16:19], v[168:171], v[48:51], v[16:19]
 v_mfma_f32_16x16x32_bf16 v[20:23], v[172:175], v[48:51], v[20:23]
 s_waitcnt lgkmcnt(1)
 v_mfma_f32_16x16x32_bf16 v[0:3], v[176:179], v[52:55], v[0:3]
 ds_read_b128 v[48:51], v70 offset:384
 v_mfma_f32_16x16x32_bf16 v[4:7], v[180:183], v[52:55], v[4:7]
 v_mfma_f32_16x16x32_bf16 v[8:11], v[52:55], v[184:187], v[8:11]
 v_mfma_f32_16x16x32_bf16 v[12:15], v[52:55], v[188:191], v[12:15]
 v_mfma_f32_16x16x32_bf16 v[16:19], v[192:195], v[52:55], v[16:19]
 v_mfma_f32_16x16x32_bf16 v[20:23], v[196:199], v[52:55], v[20:23]
 s_waitcnt lgkmcnt(1)
 v_mfma_f32_16x16x32_bf16 v[0:3], v[200:203], v[56:59], v[0:3]
 ds_read_b128 v[52:55], v71 offset:384
 v_mfma_f32_16x16x32_bf16 v[4:7], v[204:207], v[56:59], v[4:7]
 v_mfma_f32_16x16x32_bf16 v[8:11], v[56:59], v[208:211], v[8:11]
 v_mfma_f32_16x16x32_bf16 v[12:15], v[56:59], v[212:215], v[12:15]
 v_mfma_f32_16x16x32_bf16 v[16:19], v[216:219], v[56:59], v[16:19]
 v_mfma_f32_16x16x32_bf16 v[20:23], v[220:223], v[56:59], v[20:23]
 s_waitcnt lgkmcnt(1)
 v_mfma_f32_16x16x32_bf16 v[0:3], v[224:227], v[48:51], v[0:3]
 ds_read_b128 v[56:59], v70 offset:512
 v_mfma_f32_16x16x32_bf16 v[4:7], v[228:231], v[48:51], v[4:7]
 v_mfma_f32_16x16x32_bf16 v[8:11], v[48:51], v[232:235], v[8:11]
 v_mfma_f32_16x16x32_bf16 v[12:15], v[48:51], v[236:239], v[12:15]
 v_mfma_f32_16x16x32_bf16 v[16:19], v[240:243], v[48:51], v[16:19]
 v_mfma_f32_16x16x32_bf16 v[20:23], v[244:247], v[48:51], v[20:23]
 s_waitcnt lgkmcnt(1)
 v_mfma_f32_16x16x32_bf16 v[0:3], v[248:251], v[52:55], v[0:3]
 ds_read_b128 v[48:51], v71 offset:512
 v_mfma_f32_16x16x32_bf16 v[4:7], v[252:255], v[52:55], v[4:7]
 v_mfma_f32_16x16x32_bf16 v[8:11], v[52:55], a[0:3], v[8:11]
 buffer_load_dword v75, v74, s[8:11], 0 offen sc1
 v_mfma_f32_16x16x32_bf16 v[12:15], v[52:55], a[4:7], v[12:15]
 v_mfma_f32_16x16x32_bf16 v[16:19], a[8:11], v[52:55], v[16:19]
 v_mfma_f32_16x16x32_bf16 v[20:23], a[12:15], v[52:55], v[20:23]
 s_waitcnt lgkmcnt(1)
 v_mfma_f32_16x16x32_bf16 v[0:3], a[16:19], v[56:59], v[0:3]
 ds_read_b128 v[52:55], v70 offset:640
 v_mfma_f32_16x16x32_bf16 v[4:7], a[20:23], v[56:59], v[4:7]
 v_mfma_f32_16x16x32_bf16 v[8:11], v[56:59], a[24:27], v[8:11]
 v_mfma_f32_16x16x32_bf16 v[12:15], v[56:59], a[28:31], v[12:15]
 v_mfma_f32_16x16x32_bf16 v[16:19], a[32:35], v[56:59], v[16:19]
 v_mfma_f32_16x16x32_bf16 v[20:23], a[36:39], v[56:59], v[20:23]
 s_waitcnt lgkmcnt(1)
 v_mfma_f32_16x16x32_bf16 v[0:3], a[40:43], v[48:51], v[0:3]
 ds_read_b128 v[56:59], v71 offset:640
 v_mfma_f32_16x16x32_bf16 v[4:7], a[44:47], v[48:51], v[4:7]
 v_mfma_f32_16x16x32_bf16 v[8:11], v[48:51], a[48:51], v[8:11]
 v_mfma_f32_16x16x32_bf16 v[12:15], v[48:51], a[52:55], v[12:15]
 v_mfma_f32_16x16x32_bf16 v[16:19], a[56:59], v[48:51], v[16:19]
 v_mfma_f32_16x16x32_bf16 v[20:23], a[60:63], v[48:51], v[20:23]
 s_waitcnt lgkmcnt(1)
 v_mfma_f32_16x16x32_bf16 v[0:3], a[64:67], v[52:55], v[0:3]
 ds_read_b128 v[48:51], v70 offset:768
 v_mfma_f32_16x16x32_bf16 v[4:7], a[68:71], v[52:55], v[4:7]
 v_mfma_f32_16x16x32_bf16 v[8:11], v[52:55], a[72:75], v[8:11]
 v_mfma_f32_16x16x32_bf16 v[12:15], v[52:55], a[76:79], v[12:15]
 v_mfma_f32_16x16x32_bf16 v[16:19], a[80:83], v[52:55], v[16:19]
 v_mfma_f32_16x16x32_bf16 v[20:23], a[84:87], v[52:55], v[20:23]
 s_waitcnt lgkmcnt(1)
 v_mfma_f32_16x16x32_bf16 v[0:3], a[88:91], v[56:59], v[0:3]
 ds_read_b128 v[52:55], v71 offset:768
 v_mfma_f32_16x16x32_bf16 v[4:7], a[92:95], v[56:59], v[4:7]
 v_mfma_f32_16x16x32_bf16 v[8:11], v[56:59], a[96:99], v[8:11]
 v_mfma_f32_16x16x32_bf16 v[12:15], v[56:59], a[100:103], v[12:15]
 v_mfma_f32_16x16x32_bf16 v[16:19], a[104:107], v[56:59], v[16:19]
 v_mfma_f32_16x16x32_bf16 v[20:23], a[108:111], v[56:59], v[20:23]
 s_waitcnt lgkmcnt(1)
 v_mfma_f32_16x16x32_bf16 v[0:3], a[112:115], v[48:51], v[0:3]
 ds_read_b128 v[56:59], v70 offset:896
 v_mfma_f32_16x16x32_bf16 v[4:7], a[116:119], v[48:51], v[4:7]
 v_mfma_f32_16x16x32_bf16 v[8:11], v[48:51], a[120:123], v[8:11]
 v_mfma_f32_16x16x32_bf16 v[12:15], v[48:51], a[124:127], v[12:15]
 v_mfma_f32_16x16x32_bf16 v[16:19], a[128:131], v[48:51], v[16:19]
 v_mfma_f32_16x16x32_bf16 v[20:23], a[132:135], v[48:51], v[20:23]
 s_waitcnt lgkmcnt(1)
 v_mfma_f32_16x16x32_bf16 v[0:3], a[136:139], v[52:55], v[0:3]
 ds_read_b128 v[48:51], v71 offset:896
 v_mfma_f32_16x16x32_bf16 v[4:7], a[140:143], v[52:55], v[4:7]
 v_mfma_f32_16x16x32_bf16 v[8:11], v[52:55], a[144:147], v[8:11]
 v_mfma_f32_16x16x32_bf16 v[12:15], v[52:55], a[148:151], v[12:15]
 v_mfma_f32_16x16x32_bf16 v[16:19], a[152:155], v[52:55], v[16:19]
 v_mfma_f32_16x16x32_bf16 v[20:23], a[156:159], v[52:55], v[20:23]
 s_waitcnt vmcnt(0)
 v_cmp_gt_u32 vcc, s74, v75
 s_waitcnt lgkmcnt(1)
 v_mfma_f32_16x16x32_bf16 v[0:3], a[160:163], v[56:59], v[0:3]
 ds_read_b128 v[52:55], v70 offset:1024
 v_cmp_gt_u32 s[66:67], s75, v75
 v_mfma_f32_16x16x32_bf16 v[4:7], a[164:167], v[56:59], v[4:7]
 v_mfma_f32_16x16x32_bf16 v[8:11], v[56:59], a[168:171], v[8:11]
 v_mfma_f32_16x16x32_bf16 v[12:15], v[56:59], a[172:175], v[12:15]
 s_cmp_eq_u32 vcc_lo, 0
 s_cselect_b32 s72, s84, 0
 s_cmp_eq_u32 s67, 0
 s_cselect_b32 s72, 2, s72
 v_mfma_f32_16x16x32_bf16 v[16:19], a[176:179], v[56:59], v[16:19]
 v_mov_b32 v76, s72
 v_mfma_f32_16x16x32_bf16 v[20:23], a[180:183], v[56:59], v[20:23]
 ds_write_b32 v72, v76 offset:0
 s_waitcnt lgkmcnt(2)
 v_mfma_f32_16x16x32_bf16 v[0:3], a[184:187], v[48:51], v[0:3]
 ds_read_b128 v[56:59], v71 offset:1024
 v_mfma_f32_16x16x32_bf16 v[4:7], a[188:191], v[48:51], v[4:7]
 v_mfma_f32_16x16x32_bf16 v[8:11], v[48:51], a[192:195], v[8:11]
 v_mfma_f32_16x16x32_bf16 v[12:15], v[48:51], a[196:199], v[12:15]
 v_mfma_f32_16x16x32_bf16 v[16:19], a[200:203], v[48:51], v[16:19]
 v_mov_b32 v76, s95
 v_mfma_f32_16x16x32_bf16 v[20:23], a[204:207], v[48:51], v[20:23]
 s_waitcnt vmcnt(1)
 s_waitcnt lgkmcnt(1)
 s_barrier
 buffer_store_dword v76, v77, s[8:11], s94 offen sc1
 ds_read_b32 v76, v73 offset:0
 v_mfma_f32_16x16x32_bf16 v[0:3], a[208:211], v[52:55], v[0:3]
 ds_read_b128 v[48:51], v70 offset:18432
 v_mfma_f32_16x16x32_bf16 v[4:7], a[212:215], v[52:55], v[4:7]
 v_mfma_f32_16x16x32_bf16 v[8:11], v[52:55], a[216:219], v[8:11]
 v_mfma_f32_16x16x32_bf16 v[12:15], v[52:55], a[220:223], v[12:15]
 v_mfma_f32_16x16x32_bf16 v[16:19], a[224:227], v[52:55], v[16:19]
 v_mfma_f32_16x16x32_bf16 v[20:23], a[228:231], v[52:55], v[20:23]
 s_waitcnt lgkmcnt(2)
 v_mfma_f32_16x16x32_bf16 v[0:3], a[232:235], v[56:59], v[0:3]
 ds_read_b128 v[52:55], v71 offset:18432
 v_mfma_f32_16x16x32_bf16 v[4:7], a[236:239], v[56:59], v[4:7]
 v_mfma_f32_16x16x32_bf16 v[8:11], v[56:59], a[240:243], v[8:11]
 s_waitcnt lgkmcnt(2)
 v_readfirstlane_b32 s72, v76
 v_mfma_f32_16x16x32_bf16 v[12:15], v[56:59], a[244:247], v[12:15]
 v_mfma_f32_16x16x32_bf16 v[16:19], a[248:251], v[56:59], v[16:19]
 v_mfma_f32_16x16x32_bf16 v[20:23], a[252:255], v[56:59], v[20:23]
 s_cmp_lg_u32 s72, 0
 s_cbranch_scc1 L_q_p1d
 s_branch L_q_p1n
L_q_p0d:
 s_waitcnt lgkmcnt(1)
 v_mfma_f32_16x16x32_bf16 v[0:3], v[80:83], v[48:51], 0
 ds_read_b128 v[56:59], v70 offset:128
 s_sub_u32 s68, s72, 1
 s_cmp_eq_u32 s68, 0
 v_mfma_f32_16x16x32_bf16 v[4:7], v[84:87], v[48:51], 0
 s_cselect_b32 s69, s74, s75
 s_cselect_b32 s63, 2, 0
 s_cselect_b32 s64, 0, 2
 s_add_u32 s74, s74, s63
 v_mfma_f32_16x16x32_bf16 v[8:11], v[48:51], v[88:91], 0
 s_add_u32 s75, s75, s64
 s_add_u32 s63, s75, 8
 s_cmp_lt_u32 s74, s63
 s_cselect_b32 s84, 1, s68
 v_mfma_f32_16x16x32_bf16 v[12:15], v[48:51], v[92:95], 0
 s_cmp_lt_u32 s75, 3
 s_cselect_b32 s84, 1, s84
 s_mul_i32 s73, s69, 36864
 v_mfma_f32_16x16x32_bf16 v[16:19], v[96:99], v[48:51], 0
 s_mul_i32 s63, s68, 2359296
 s_add_u32 s73, s73, s63
 s_add_u32 s73, s73, s90
 v_mfma_f32_16x16x32_bf16 v[20:23], v[100:103], v[48:51], 0
 s_mov_b32 m0, s70
 s_waitcnt lgkmcnt(1)
 v_mfma_f32_16x16x32_bf16 v[0:3], v[104:107], v[52:55], v[0:3]
 ds_read_b128 v[48:51], v71 offset:128
 v_mfma_f32_16x16x32_bf16 v[4:7], v[108:111], v[52:55], v[4:7]
 buffer_load_dwordx4 v72, s[8:11], s73 offen sc1 lds
 v_mfma_f32_16x16x32_bf16 v[8:11], v[52:55], v[112:115], v[8:11]
 v_mfma_f32_16x16x32_bf16 v[12:15], v[52:55], v[116:119], v[12:15]
 v_mfma_f32_16x16x32_bf16 v[16:19], v[120:123], v[52:55], v[16:19]
 v_mfma_f32_16x16x32_bf16 v[20:23], v[124:127], v[52:55], v[20:23]
 s_add_u32 m0, m0, s3
 s_add_u32 s73, s73, s3
 s_waitcnt lgkmcnt(1)
 v_mfma_f32_16x16x32_bf16 v[0:3], v[128:131], v[56:59], v[0:3]
 ds_read_b128 v[52:55], v70 offset:256
 v_mfma_f32_16x16x32_bf16 v[4:7], v[132:135], v[56:59], v[4:7]
 buffer_load_dwordx4 v72, s[8:11], s73 offen sc1 lds
 v_mfma_f32_16x16x32_bf16 v[8:11], v[56:59], v[136:139], v[8:11]
 v_mfma_f32_16x16x32_bf16 v[12:15], v[56:59], v[140:143], v[12:15]
 v_mfma_f32_16x16x32_bf16 v[16:19], v[144:147], v[56:59], v[16:19]
 v_mfma_f32_16x16x32_bf16 v[20:23], v[148:151], v[56:59], v[20:23]
 s_add_u32 m0, m0, s3
 s_add_u32 s73, s73, s3
 s_waitcnt lgkmcnt(1)
 v_mfma_f32_16x16x32_bf16 v[0:3], v[152:155], v[48:51], v[0:3]
 ds_read_b128 v[56:59], v71 offset:256
 v_mfma_f32_16x16x32_bf16 v[4:7], v[156:159], v[48:51], v[4:7]
 buffer_load_dwordx4 v72, s[8:11], s73 offen sc1 lds
 v_mfma_f32_16x16x32_bf16 v[8:11], v[48:51], v[160:163], v[8:11]
 v_mfma_f32_16x16x32_bf16 v[12:15], v[48:51], v[164:167], v[12:15]
 v_mfma_f32_16x16x32_bf16 v[16:19], v[168:171], v[48:51], v[16:19]
 v_mfma_f32_16x16x32_bf16 v[20:23], v[172:175], v[48:51], v[20:23]
 s_add_u32 m0, m0, s3
 s_add_u32 s73, s73, s3
 s_waitcnt lgkmcnt(1)
 v_mfma_f32_16x16x32_bf16 v[0:3], v[176:179], v[52:55], v[0:3]
 ds_read_b128 v[48:51], v70 offset:384
 v_mfma_f32_16x16x32_bf16 v[4:7], v[180:183], v[52:55], v[4:7]
 buffer_load_dwordx4 v72, s[8:11], s73 offen sc1 lds
 v_mfma_f32_16x16x32_bf16 v[8:11], v[52:55], v[184:187], v[8:11]
 v_mfma_f32_16x16x32_bf16 v[12:15], v[52:55], v[188:191], v[12:15]
 v_mfma_f32_16x16x32_bf16 v[16:19], v[192:195], v[52:55], v[16:19]
 v_mfma_f32_16x16x32_bf16 v[20:23], v[196:199], v[52:55], v[20:23]
 s_add_u32 m0, m0, s3
 s_add_u32 s73, s73, s3
 s_waitcnt lgkmcnt(1)
 v_mfma_f32_16x16x32_bf16 v[0:3], v[200:203], v[56:59], v[0:3]
 ds_read_b128 v[52:55], v71 offset:384
 v_mfma_f32_16x16x32_bf16 v[4:7], v[204:207], v[56:59], v[4:7]
 buffer_load_dwordx4 v72, s[8:11], s73 offen sc1 lds
 v_mfma_f32_16x16x32_bf16 v[8:11], v[56:59], v[208:211], v[8:11]
 v_mfma_f32_16x16x32_bf16 v[12:15], v[56:59], v[212:215], v[12:15]
 v_mfma_f32_16x16x32_bf16 v[16:19], v[216:219], v[56:59], v[16:19]
 v_mfma_f32_16x16x32_bf16 v[20:23], v[220:223], v[56:59], v[20:23]
 s_add_u32 m0, m0, s3
 s_add_u32 s73, s73, s3
 s_waitcnt lgkmcnt(1)
 v_mfma_f32_16x16x32_bf16 v[0:3], v[224:227], v[48:51], v[0:3]
 ds_read_b128 v[56:59], v70 offset:512
 v_mfma_f32_16x16x32_bf16 v[4:7], v[228:231], v[48:51], v[4:7]
 buffer_load_dwordx4 v72, s[8:11], s73 offen sc1 lds
 v_mfma_f32_16x16x32_bf16 v[8:11], v[48:51], v[232:235], v[8:11]
 v_mfma_f32_16x16x32_bf16 v[12:15], v[48:51], v[236:239], v[12:15]
 v_mfma_f32_16x16x32_bf16 v[16:19], v[240:243], v[48:51], v[16:19]
 v_mfma_f32_16x16x32_bf16 v[20:23], v[244:247], v[48:51], v[20:23]
 s_add_u32 m0, m0, s3
 s_add_u32 s73, s73, s3
 s_waitcnt lgkmcnt(1)
 v_mfma_f32_16x16x32_bf16 v[0:3], v[248:251], v[52:55], v[0:3]
 ds_read_b128 v[48:51], v71 offset:512
 v_mfma_f32_16x16x32_bf16 v[4:7], v[252:255], v[52:55], v[4:7]
 buffer_load_dwordx4 v72, s[8:11], s73 offen sc1 lds
 v_mfma_f32_16x16x32_bf16 v[8:11], v[52:55], a[0:3], v[8:11]
 v_mfma_f32_16x16x32_bf16 v[12:15], v[52:55], a[4:7], v[12:15]
 v_mfma_f32_16x16x32_bf16 v[16:19], a[8:11], v[52:55], v[16:19]
 v_mfma_f32_16x16x32_bf16 v[20:23], a[12:15], v[52:55], v[20:23]
 s_add_u32 m0, m0, s3
 s_add_u32 s73, s73, s3
 s_waitcnt lgkmcnt(1)
 v_mfma_f32_16x16x32_bf16 v[0:3], a[16:19], v[56:59], v[0:3]
 ds_read_b128 v[52:55], v70 offset:640
 v_mfma_f32_16x16x32_bf16 v[4:7], a[20:23], v[56:59], v[4:7]
 buffer_load_dwordx4 v72, s[8:11], s73 offen sc1 lds
 v_mfma_f32_16x16x32_bf16 v[8:11], v[56:59], a[24:27], v[8:11]
 v_mfma_f32_16x16x32_bf16 v[12:15], v[56:59], a[28:31], v[12:15]
 v_mfma_f32_16x16x32_bf16 v[16:19], a[32:35], v[56:59], v[16:19]
 v_mfma_f32_16x16x32_bf16 v[20:23], a[36:39], v[56:59], v[20:23]
 s_add_u32 m0, m0, s3
 s_add_u32 s73, s73, s3
 s_waitcnt lgkmcnt(1)
 v_mfma_f32_16x16x32_bf16 v[0:3], a[40:43], v[48:51], v[0:3]
 ds_read_b128 v[56:59], v71 offset:640
 v_mfma_f32_16x16x32_bf16 v[4:7], a[44:47], v[48:51], v[4:7]
 buffer_load_dwordx4 v72, s[8:11], s73 offen sc1 lds
 v_mfma_f32_16x16x32_bf16 v[8:11], v[48:51], a[48:51], v[8:11]
 v_mfma_f32_16x16x32_bf16 v[12:15], v[48:51], a[52:55], v[12:15]
 v_mfma_f32_16x16x32_bf16 v[16:19], a[56:59], v[48:51], v[16:19]
 v_mfma_f32_16x16x32_bf16 v[20:23], a[60:63], v[48:51], v[20:23]
 s_waitcnt lgkmcnt(1)
 v_mfma_f32_16x16x32_bf16 v[0:3], a[64:67], v[52:55], v[0:3]
 ds_read_b128 v[48:51], v70 offset:768
 v_mfma_f32_16x16x32_bf16 v[4:7], a[68:71], v[52:55], v[4:7]
 v_mfma_f32_16x16x32_bf16 v[8:11], v[52:55], a[72:75], v[8:11]
 v_mfma_f32_16x16x32_bf16 v[12:15], v[52:55], a[76:79], v[12:15]
 v_mfma_f32_16x16x32_bf16 v[16:19], a[80:83], v[52:55], v[16:19]
 v_mfma_f32_16x16x32_bf16 v[20:23], a[84:87], v[52:55], v[20:23]
 s_waitcnt lgkmcnt(1)
 v_mfma_f32_16x16x32_bf16 v[0:3], a[88:91], v[56:59], v[0:3]
 ds_read_b128 v[52:55], v71 offset:768
 v_mfma_f32_16x16x32_bf16 v[4:7], a[92:95], v[56:59], v[4:7]
 v_mfma_f32_16x16x32_bf16 v[8:11], v[56:59], a[96:99], v[8:11]
 v_mfma_f32_16x16x32_bf16 v[12:15], v[56:59], a[100:103], v[12:15]
 v_mfma_f32_16x16x32_bf16 v[16:19], a[104:107], v[56:59], v[16:19]
 v_mfma_f32_16x16x32_bf16 v[20:23], a[108:111], v[56:59], v[20:23]
 s_waitcnt lgkmcnt(1)
 v_mfma_f32_16x16x32_bf16 v[0:3], a[112:115], v[48:51], v[0:3]
 ds_read_b128 v[56:59], v70 offset:896
 v_mfma_f32_16x16x32_bf16 v[4:7], a[116:119], v[48:51], v[4:7]
 v_mfma_f32_16x16x32_bf16 v[8:11], v[48:51], a[120:123], v[8:11]
 v_mfma_f32_16x16x32_bf16 v[12:15], v[48:51], a[124:127], v[12:15]
 v_mfma_f32_16x16x32_bf16 v[16:19], a[128:131], v[48:51], v[16:19]
 v_mfma_f32_16x16x32_bf16 v[20:23], a[132:135], v[48:51], v[20:23]
 s_waitcnt lgkmcnt(1)
 v_mfma_f32_16x16x32_bf16 v[0:3], a[136:139], v[52:55], v[0:3]
 ds_read_b128 v[48:51], v71 offset:896
 v_mfma_f32_16x16x32_bf16 v[4:7], a[140:143], v[52:55], v[4:7]
 v_mfma_f32_16x16x32_bf16 v[8:11], v[52:55], a[144:147], v[8:11]
 v_mfma_f32_16x16x32_bf16 v[12:15], v[52:55], a[148:151], v[12:15]
 v_mfma_f32_16x16x32_bf16 v[16:19], a[152:155], v[52:55], v[16:19]
 v_mfma_f32_16x16x32_bf16 v[20:23], a[156:159], v[52:55], v[20:23]
 s_waitcnt lgkmcnt(1)
 v_mfma_f32_16x16x32_bf16 v[0:3], a[160:163], v[56:59], v[0:3]
 ds_read_b128 v[52:55], v70 offset:1024
 v_mfma_f32_16x16x32_bf16 v[4:7], a[164:167], v[56:59], v[4:7]
 v_mfma_f32_16x16x32_bf16 v[8:11], v[56:59], a[168:171], v[8:11]
 v_mfma_f32_16x16x32_bf16 v[12:15], v[56:59], a[172:175], v[12:15]
 v_mfma_f32_16x16x32_bf16 v[16:19], a[176:179], v[56:59], v[16:19]
 v_mfma_f32_16x16x32_bf16 v[20:23], a[180:183], v[56:59], v[20:23]
 s_waitcnt lgkmcnt(1)
 v_mfma_f32_16x16x32_bf16 v[0:3], a[184:187], v[48:51], v[0:3]
 ds_read_b128 v[56:59], v71 offset:1024
 v_mfma_f32_16x16x32_bf16 v[4:7], a[188:191], v[48:51], v[4:7]
 v_mfma_f32_16x16x32_bf16 v[8:11], v[48:51], a[192:195], v[8:11]
 v_mfma_f32_16x16x32_bf16 v[12:15], v[48:51], a[196:199], v[12:15]
 v_mfma_f32_16x16x32_bf16 v[16:19], a[200:203], v[48:51], v[16:19]
 v_mov_b32 v76, s95
 v_mfma_f32_16x16x32_bf16 v[20:23], a[204:207], v[48:51], v[20:23]
 s_waitcnt vmcnt(9)
 s_barrier
 buffer_store_dword v76, v77, s[8:11], s94 offen sc1
 s_waitcnt lgkmcnt(1)
 v_mfma_f32_16x16x32_bf16 v[0:3], a[208:211], v[52:55], v[0:3]
 ds_read_b128 v[48:51], v70 offset:18432
 v_mfma_f32_16x16x32_bf16 v[4:7], a[212:215], v[52:55], v[4:7]
 v_mfma_f32_16x16x32_bf16 v[8:11], v[52:55], a[216:219], v[8:11]
 v_mfma_f32_16x16x32_bf16 v[12:15], v[52:55], a[220:223], v[12:15]
 v_mfma_f32_16x16x32_bf16 v[16:19], a[224:227], v[52:55], v[16:19]
 v_mfma_f32_16x16x32_bf16 v[20:23], a[228:231], v[52:55], v[20:23]
 s_waitcnt lgkmcnt(1)
 v_mfma_f32_16x16x32_bf16 v[0:3], a[232:235], v[56:59], v[0:3]
 ds_read_b128 v[52:55], v71 offset:18432
 v_mfma_f32_16x16x32_bf16 v[4:7], a[236:239], v[56:59], v[4:7]
 v_mfma_f32_16x16x32_bf16 v[8:11], v[56:59], a[240:243], v[8:11]
 v_mfma_f32_16x16x32_bf16 v[12:15], v[56:59], a[244:247], v[12:15]
 v_mfma_f32_16x16x32_bf16 v[16:19], a[248:251], v[56:59], v[16:19]
 v_mfma_f32_16x16x32_bf16 v[20:23], a[252:255], v[56:59], v[20:23]
 s_waitcnt lgkmcnt(1)
 v_mfma_f32_16x16x32_bf16 v[24:27], v[80:83], v[48:51], 0
 ds_read_b128 v[56:59], v70 offset:18560
 v_mfma_f32_16x16x32_bf16 v[28:31], v[84:87], v[48:51], 0
 v_mfma_f32_16x16x32_bf16 v[32:35], v[48:51], v[88:91], 0
 v_mfma_f32_16x16x32_bf16 v[36:39], v[48:51], v[92:95], 0
 v_mfma_f32_16x16x32_bf16 v[40:43], v[96:99], v[48:51], 0
 v_cvt_pk_bf16_f32 v0, v0, v1
 v_cvt_pk_bf16_f32 v1, v2, v3
 v_mfma_f32_16x16x32_bf16 v[44:47], v[100:103], v[48:51], 0
 v_cvt_pk_bf16_f32 v2, v4, v5
 s_waitcnt lgkmcnt(1)
 v_mfma_f32_16x16x32_bf16 v[24:27], v[104:107], v[52:55], v[24:27]
 ds_read_b128 v[48:51], v71 offset:18560
 v_cvt_pk_bf16_f32 v3, v6, v7
 v_mfma_f32_16x16x32_bf16 v[28:31], v[108:111], v[52:55], v[28:31]
 buffer_store_dwordx4 v[0:3], v73, s[8:11], s78 offen offset:0 sc1
 v_mfma_f32_16x16x32_bf16 v[32:35], v[52:55], v[112:115], v[32:35]
 v_cvt_pk_bf16_f32 v60, v8, v9
 v_cvt_pk_bf16_f32 v61, v10, v11
 v_mfma_f32_16x16x32_bf16 v[36:39], v[52:55], v[116:119], v[36:39]
 v_cvt_pk_bf16_f32 v62, v12, v13
 v_cvt_pk_bf16_f32 v63, v14, v15
 v_mfma_f32_16x16x32_bf16 v[40:43], v[120:123], v[52:55], v[40:43]
 v_cvt_pk_bf16_f32 v16, v16, v17
 v_cvt_pk_bf16_f32 v17, v18, v19
 v_mfma_f32_16x16x32_bf16 v[44:47], v[124:127], v[52:55], v[44:47]
 v_cvt_pk_bf16_f32 v18, v20, v21
 s_waitcnt lgkmcnt(1)
 v_mfma_f32_16x16x32_bf16 v[24:27], v[128:131], v[56:59], v[24:27]
 ds_read_b128 v[52:55], v70 offset:18688
 v_cvt_pk_bf16_f32 v19, v22, v23
 v_mfma_f32_16x16x32_bf16 v[28:31], v[132:135], v[56:59], v[28:31]
 v_mfma_f32_16x16x32_bf16 v[32:35], v[56:59], v[136:139], v[32:35]
 v_mfma_f32_16x16x32_bf16 v[36:39], v[56:59], v[140:143], v[36:39]
 buffer_store_dwordx4 v[16:19], v73, s[8:11], s77 offen offset:0 sc1
 v_mfma_f32_16x16x32_bf16 v[40:43], v[144:147], v[56:59], v[40:43]
 s_mov_b32 s63, s85
 s_mov_b32 s85, s4
 s_mov_b32 s4, s5
 v_mfma_f32_16x16x32_bf16 v[44:47], v[148:151], v[56:59], v[44:47]
 s_mov_b32 s5, s63
 s_add_u32 s70, s70, s85
 s_waitcnt lgkmcnt(1)
 v_mfma_f32_16x16x32_bf16 v[24:27], v[152:155], v[48:51], v[24:27]
 ds_read_b128 v[56:59], v71 offset:18688
 s_mov_b32 s81, s77
 v_mfma_f32_16x16x32_bf16 v[28:31], v[156:159], v[48:51], v[28:31]
 s_mov_b32 s82, s78
 s_mov_b32 s83, s79
 s_mov_b32 s94, s92
 v_mfma_f32_16x16x32_bf16 v[32:35], v[48:51], v[160:163], v[32:35]
 s_mov_b32 s95, s93
 s_mov_b32 s63, s69
 v_mfma_f32_16x16x32_bf16 v[36:39], v[48:51], v[164:167], v[36:39]
 s_mul_i32 s63, s63, 786432
 s_mul_i32 s64, s68, 50331648
 v_mfma_f32_16x16x32_bf16 v[40:43], v[168:171], v[48:51], v[40:43]
 s_add_u32 s63, s63, s64
 s_add_u32 s77, s63, s87
 s_add_u32 s78, s63, s88
 v_mfma_f32_16x16x32_bf16 v[44:47], v[172:175], v[48:51], v[44:47]
 s_add_u32 s79, s63, s89
 s_waitcnt lgkmcnt(1)
 v_mfma_f32_16x16x32_bf16 v[24:27], v[176:179], v[52:55], v[24:27]
 ds_read_b128 v[48:51], v70 offset:18816
 s_mul_i32 s92, s68, 4096
 v_mfma_f32_16x16x32_bf16 v[28:31], v[180:183], v[52:55], v[28:31]
 s_add_u32 s93, s69, 1
 s_add_u32 s61, s61, 1
 v_mfma_f32_16x16x32_bf16 v[32:35], v[52:55], v[184:187], v[32:35]
 v_mfma_f32_16x16x32_bf16 v[36:39], v[52:55], v[188:191], v[36:39]
 v_mfma_f32_16x16x32_bf16 v[40:43], v[192:195], v[52:55], v[40:43]
 v_mfma_f32_16x16x32_bf16 v[44:47], v[196:199], v[52:55], v[44:47]
 s_waitcnt lgkmcnt(1)
 v_mfma_f32_16x16x32_bf16 v[24:27], v[200:203], v[56:59], v[24:27]
 ds_read_b128 v[52:55], v71 offset:18816
 v_mfma_f32_16x16x32_bf16 v[28:31], v[204:207], v[56:59], v[28:31]
 v_mfma_f32_16x16x32_bf16 v[32:35], v[56:59], v[208:211], v[32:35]
 v_mfma_f32_16x16x32_bf16 v[36:39], v[56:59], v[212:215], v[36:39]
 v_mfma_f32_16x16x32_bf16 v[40:43], v[216:219], v[56:59], v[40:43]
 v_mfma_f32_16x16x32_bf16 v[44:47], v[220:223], v[56:59], v[44:47]
 s_waitcnt lgkmcnt(1)
 v_mfma_f32_16x16x32_bf16 v[24:27], v[224:227], v[48:51], v[24:27]
 ds_read_b128 v[56:59], v70 offset:18944
 v_mfma_f32_16x16x32_bf16 v[28:31], v[228:231], v[48:51], v[28:31]
 v_mfma_f32_16x16x32_bf16 v[32:35], v[48:51], v[232:235], v[32:35]
 v_mfma_f32_16x16x32_bf16 v[36:39], v[48:51], v[236:239], v[36:39]
 v_mfma_f32_16x16x32_bf16 v[40:43], v[240:243], v[48:51], v[40:43]
 v_mfma_f32_16x16x32_bf16 v[44:47], v[244:247], v[48:51], v[44:47]
 s_waitcnt lgkmcnt(1)
 v_mfma_f32_16x16x32_bf16 v[24:27], v[248:251], v[52:55], v[24:27]
 ds_read_b128 v[48:51], v71 offset:18944
 v_mfma_f32_16x16x32_bf16 v[28:31], v[252:255], v[52:55], v[28:31]
 v_mfma_f32_16x16x32_bf16 v[32:35], v[52:55], a[0:3], v[32:35]
 buffer_load_dword v75, v74, s[8:11], 0 offen sc1
 v_mfma_f32_16x16x32_bf16 v[36:39], v[52:55], a[4:7], v[36:39]
 v_mfma_f32_16x16x32_bf16 v[40:43], a[8:11], v[52:55], v[40:43]
 v_mfma_f32_16x16x32_bf16 v[44:47], a[12:15], v[52:55], v[44:47]
 s_waitcnt lgkmcnt(1)
 v_mfma_f32_16x16x32_bf16 v[24:27], a[16:19], v[56:59], v[24:27]
 ds_read_b128 v[52:55], v70 offset:19072
 v_mfma_f32_16x16x32_bf16 v[28:31], a[20:23], v[56:59], v[28:31]
 v_mfma_f32_16x16x32_bf16 v[32:35], v[56:59], a[24:27], v[32:35]
 v_mfma_f32_16x16x32_bf16 v[36:39], v[56:59], a[28:31], v[36:39]
 v_mfma_f32_16x16x32_bf16 v[40:43], a[32:35], v[56:59], v[40:43]
 v_mfma_f32_16x16x32_bf16 v[44:47], a[36:39], v[56:59], v[44:47]
 s_waitcnt lgkmcnt(1)
 v_mfma_f32_16x16x32_bf16 v[24:27], a[40:43], v[48:51], v[24:27]
 ds_read_b128 v[56:59], v71 offset:19072
 v_mfma_f32_16x16x32_bf16 v[28:31], a[44:47], v[48:51], v[28:31]
 v_mfma_f32_16x16x32_bf16 v[32:35], v[48:51], a[48:51], v[32:35]
 v_mfma_f32_16x16x32_bf16 v[36:39], v[48:51], a[52:55], v[36:39]
 v_mfma_f32_16x16x32_bf16 v[40:43], a[56:59], v[48:51], v[40:43]
 v_mfma_f32_16x16x32_bf16 v[44:47], a[60:63], v[48:51], v[44:47]
 s_waitcnt lgkmcnt(1)
 v_mfma_f32_16x16x32_bf16 v[24:27], a[64:67], v[52:55], v[24:27]
 ds_read_b128 v[48:51], v70 offset:19200
 v_mfma_f32_16x16x32_bf16 v[28:31], a[68:71], v[52:55], v[28:31]
 v_mfma_f32_16x16x32_bf16 v[32:35], v[52:55], a[72:75], v[32:35]
 v_mfma_f32_16x16x32_bf16 v[36:39], v[52:55], a[76:79], v[36:39]
 v_mfma_f32_16x16x32_bf16 v[40:43], a[80:83], v[52:55], v[40:43]
 v_mfma_f32_16x16x32_bf16 v[44:47], a[84:87], v[52:55], v[44:47]
 s_waitcnt lgkmcnt(1)
 v_mfma_f32_16x16x32_bf16 v[24:27], a[88:91], v[56:59], v[24:27]
 ds_read_b128 v[52:55], v71 offset:19200
 v_mfma_f32_16x16x32_bf16 v[28:31], a[92:95], v[56:59], v[28:31]
 v_mfma_f32_16x16x32_bf16 v[32:35], v[56:59], a[96:99], v[32:35]
 v_mfma_f32_16x16x32_bf16 v[36:39], v[56:59], a[100:103], v[36:39]
 v_mfma_f32_16x16x32_bf16 v[40:43], a[104:107], v[56:59], v[40:43]
 v_mfma_f32_16x16x32_bf16 v[44:47], a[108:111], v[56:59], v[44:47]
 s_waitcnt lgkmcnt(1)
 v_mfma_f32_16x16x32_bf16 v[24:27], a[112:115], v[48:51], v[24:27]
 ds_read_b128 v[56:59], v70 offset:19328
 v_mfma_f32_16x16x32_bf16 v[28:31], a[116:119], v[48:51], v[28:31]
 v_mfma_f32_16x16x32_bf16 v[32:35], v[48:51], a[120:123], v[32:35]
 v_mfma_f32_16x16x32_bf16 v[36:39], v[48:51], a[124:127], v[36:39]
 v_mfma_f32_16x16x32_bf16 v[40:43], a[128:131], v[48:51], v[40:43]
 v_mfma_f32_16x16x32_bf16 v[44:47], a[132:135], v[48:51], v[44:47]
 s_waitcnt lgkmcnt(1)
 v_mfma_f32_16x16x32_bf16 v[24:27], a[136:139], v[52:55], v[24:27]
 ds_read_b128 v[48:51], v71 offset:19328
 v_mfma_f32_16x16x32_bf16 v[28:31], a[140:143], v[52:55], v[28:31]
 v_mfma_f32_16x16x32_bf16 v[32:35], v[52:55], a[144:147], v[32:35]
 v_mfma_f32_16x16x32_bf16 v[36:39], v[52:55], a[148:151], v[36:39]
 v_mfma_f32_16x16x32_bf16 v[40:43], a[152:155], v[52:55], v[40:43]
 v_mfma_f32_16x16x32_bf16 v[44:47], a[156:159], v[52:55], v[44:47]
 s_waitcnt vmcnt(0)
 v_cmp_gt_u32 vcc, s74, v75
 s_waitcnt lgkmcnt(1)
 v_mfma_f32_16x16x32_bf16 v[24:27], a[160:163], v[56:59], v[24:27]
 ds_read_b128 v[52:55], v70 offset:19456
 v_cmp_gt_u32 s[66:67], s75, v75
 v_mfma_f32_16x16x32_bf16 v[28:31], a[164:167], v[56:59], v[28:31]
 v_mfma_f32_16x16x32_bf16 v[32:35], v[56:59], a[168:171], v[32:35]
 v_mfma_f32_16x16x32_bf16 v[36:39], v[56:59], a[172:175], v[36:39]
 s_cmp_eq_u32 vcc_lo, 0
 s_cselect_b32 s72, s84, 0
 s_cmp_eq_u32 s67, 0
 s_cselect_b32 s72, 2, s72
 v_mfma_f32_16x16x32_bf16 v[40:43], a[176:179], v[56:59], v[40:43]
 v_mov_b32 v76, s72
 v_mfma_f32_16x16x32_bf16 v[44:47], a[180:183], v[56:59], v[44:47]
 ds_write_b32 v72, v76 offset:4
 s_waitcnt lgkmcnt(2)
 v_mfma_f32_16x16x32_bf16 v[24:27], a[184:187], v[48:51], v[24:27]
 ds_read_b128 v[56:59], v71 offset:19456
 v_mfma_f32_16x16x32_bf16 v[28:31], a[188:191], v[48:51], v[28:31]
 v_mfma_f32_16x16x32_bf16 v[32:35], v[48:51], a[192:195], v[32:35]
 v_mfma_f32_16x16x32_bf16 v[36:39], v[48:51], a[196:199], v[36:39]
 v_mfma_f32_16x16x32_bf16 v[40:43], a[200:203], v[48:51], v[40:43]
 v_mfma_f32_16x16x32_bf16 v[44:47], a[204:207], v[48:51], v[44:47]
 s_waitcnt lgkmcnt(1)
 s_branch L_q_fe
L_q_p0e:
 s_waitcnt lgkmcnt(1)
 v_mfma_f32_16x16x32_bf16 v[0:3], v[80:83], v[48:51], 0
 ds_read_b128 v[56:59], v70 offset:128
 v_mfma_f32_16x16x32_bf16 v[4:7], v[84:87], v[48:51], 0
 v_mfma_f32_16x16x32_bf16 v[8:11], v[48:51], v[88:91], 0
 v_mfma_f32_16x16x32_bf16 v[12:15], v[48:51], v[92:95], 0
 v_mfma_f32_16x16x32_bf16 v[16:19], v[96:99], v[48:51], 0
 v_cvt_pk_bf16_f32 v24, v24, v25
 v_cvt_pk_bf16_f32 v25, v26, v27
 v_mfma_f32_16x16x32_bf16 v[20:23], v[100:103], v[48:51], 0
 v_cvt_pk_bf16_f32 v26, v28, v29
 s_waitcnt lgkmcnt(1)
 v_mfma_f32_16x16x32_bf16 v[0:3], v[104:107], v[52:55], v[0:3]
 ds_read_b128 v[48:51], v71 offset:128
 v_cvt_pk_bf16_f32 v27, v30, v31
 v_mfma_f32_16x16x32_bf16 v[4:7], v[108:111], v[52:55], v[4:7]
 buffer_store_dwordx4 v[24:27], v73, s[8:11], s82 offen offset:1024 sc1
 v_mfma_f32_16x16x32_bf16 v[8:11], v[52:55], v[112:115], v[8:11]
 v_cvt_pk_bf16_f32 v35, v34, v35
 v_cvt_pk_bf16_f32 v34, v32, v33
 v_mfma_f32_16x16x32_bf16 v[12:15], v[52:55], v[116:119], v[12:15]
 v_mov_b64 v[32:33], v[60:61]
 v_cvt_pk_bf16_f32 v39, v38, v39
 v_mfma_f32_16x16x32_bf16 v[16:19], v[120:123], v[52:55], v[16:19]
 v_cvt_pk_bf16_f32 v38, v36, v37
 v_mov_b64 v[36:37], v[62:63]
 v_mfma_f32_16x16x32_bf16 v[20:23], v[124:127], v[52:55], v[20:23]
 v_cvt_pk_bf16_f32 v40, v40, v41
 s_waitcnt lgkmcnt(1)
 v_mfma_f32_16x16x32_bf16 v[0:3], v[128:131], v[56:59], v[0:3]
 ds_read_b128 v[52:55], v70 offset:256
 v_cvt_pk_bf16_f32 v41, v42, v43
 v_mfma_f32_16x16x32_bf16 v[4:7], v[132:135], v[56:59], v[4:7]
 v_cvt_pk_bf16_f32 v42, v44, v45
 v_cvt_pk_bf16_f32 v43, v46, v47
 v_mfma_f32_16x16x32_bf16 v[8:11], v[56:59], v[136:139], v[8:11]
 v_mfma_f32_16x16x32_bf16 v[12:15], v[56:59], v[140:143], v[12:15]
 buffer_store_dwordx4 v[32:35], v73, s[8:11], s83 offen offset:0 sc1
 v_mfma_f32_16x16x32_bf16 v[16:19], v[144:147], v[56:59], v[16:19]
 v_mfma_f32_16x16x32_bf16 v[20:23], v[148:151], v[56:59], v[20:23]
 s_waitcnt lgkmcnt(1)
 v_mfma_f32_16x16x32_bf16 v[0:3], v[152:155], v[48:51], v[0:3]
 ds_read_b128 v[56:59], v71 offset:256
 v_mfma_f32_16x16x32_bf16 v[4:7], v[156:159], v[48:51], v[4:7]
 v_mfma_f32_16x16x32_bf16 v[8:11], v[48:51], v[160:163], v[8:11]
 v_mfma_f32_16x16x32_bf16 v[12:15], v[48:51], v[164:167], v[12:15]
 v_mfma_f32_16x16x32_bf16 v[16:19], v[168:171], v[48:51], v[16:19]
 v_mfma_f32_16x16x32_bf16 v[20:23], v[172:175], v[48:51], v[20:23]
 s_waitcnt lgkmcnt(1)
 v_mfma_f32_16x16x32_bf16 v[0:3], v[176:179], v[52:55], v[0:3]
 ds_read_b128 v[48:51], v70 offset:384
 v_mfma_f32_16x16x32_bf16 v[4:7], v[180:183], v[52:55], v[4:7]
 buffer_store_dwordx4 v[36:39], v73, s[8:11], s83 offen offset:1024 sc1
 v_mfma_f32_16x16x32_bf16 v[8:11], v[52:55], v[184:187], v[8:11]
 v_mfma_f32_16x16x32_bf16 v[12:15], v[52:55], v[188:191], v[12:15]
 v_mfma_f32_16x16x32_bf16 v[16:19], v[192:195], v[52:55], v[16:19]
 v_mfma_f32_16x16x32_bf16 v[20:23], v[196:199], v[52:55], v[20:23]
 s_waitcnt lgkmcnt(1)
 v_mfma_f32_16x16x32_bf16 v[0:3], v[200:203], v[56:59], v[0:3]
 ds_read_b128 v[52:55], v71 offset:384
 v_mfma_f32_16x16x32_bf16 v[4:7], v[204:207], v[56:59], v[4:7]
 v_mfma_f32_16x16x32_bf16 v[8:11], v[56:59], v[208:211], v[8:11]
 v_mfma_f32_16x16x32_bf16 v[12:15], v[56:59], v[212:215], v[12:15]
 buffer_store_dwordx4 v[40:43], v73, s[8:11], s81 offen offset:1024 sc1
 v_mfma_f32_16x16x32_bf16 v[16:19], v[216:219], v[56:59], v[16:19]
 v_mfma_f32_16x16x32_bf16 v[20:23], v[220:223], v[56:59], v[20:23]
 s_waitcnt lgkmcnt(1)
 v_mfma_f32_16x16x32_bf16 v[0:3], v[224:227], v[48:51], v[0:3]
 ds_read_b128 v[56:59], v70 offset:512
 v_mfma_f32_16x16x32_bf16 v[4:7], v[228:231], v[48:51], v[4:7]
 v_mfma_f32_16x16x32_bf16 v[8:11], v[48:51], v[232:235], v[8:11]
 v_mfma_f32_16x16x32_bf16 v[12:15], v[48:51], v[236:239], v[12:15]
 v_mfma_f32_16x16x32_bf16 v[16:19], v[240:243], v[48:51], v[16:19]
 v_mfma_f32_16x16x32_bf16 v[20:23], v[244:247], v[48:51], v[20:23]
 s_waitcnt lgkmcnt(1)
 v_mfma_f32_16x16x32_bf16 v[0:3], v[248:251], v[52:55], v[0:3]
 ds_read_b128 v[48:51], v71 offset:512
 v_mfma_f32_16x16x32_bf16 v[4:7], v[252:255], v[52:55], v[4:7]
 v_mfma_f32_16x16x32_bf16 v[8:11], v[52:55], a[0:3], v[8:11]
 buffer_load_dword v75, v74, s[8:11], 0 offen sc1
 v_mfma_f32_16x16x32_bf16 v[12:15], v[52:55], a[4:7], v[12:15]
 v_mfma_f32_16x16x32_bf16 v[16:19], a[8:11], v[52:55], v[16:19]
 v_mfma_f32_16x16x32_bf16 v[20:23], a[12:15], v[52:55], v[20:23]
 s_waitcnt lgkmcnt(1)
 v_mfma_f32_16x16x32_bf16 v[0:3], a[16:19], v[56:59], v[0:3]
 ds_read_b128 v[52:55], v70 offset:640
 v_mfma_f32_16x16x32_bf16 v[4:7], a[20:23], v[56:59], v[4:7]
 v_mfma_f32_16x16x32_bf16 v[8:11], v[56:59], a[24:27], v[8:11]
 v_mfma_f32_16x16x32_bf16 v[12:15], v[56:59], a[28:31], v[12:15]
 v_mfma_f32_16x16x32_bf16 v[16:19], a[32:35], v[56:59], v[16:19]
 v_mfma_f32_16x16x32_bf16 v[20:23], a[36:39], v[56:59], v[20:23]
 s_waitcnt lgkmcnt(1)
 v_mfma_f32_16x16x32_bf16 v[0:3], a[40:43], v[48:51], v[0:3]
 ds_read_b128 v[56:59], v71 offset:640
 v_mfma_f32_16x16x32_bf16 v[4:7], a[44:47], v[48:51], v[4:7]
 v_mfma_f32_16x16x32_bf16 v[8:11], v[48:51], a[48:51], v[8:11]
 v_mfma_f32_16x16x32_bf16 v[12:15], v[48:51], a[52:55], v[12:15]
 v_mfma_f32_16x16x32_bf16 v[16:19], a[56:59], v[48:51], v[16:19]
 v_mfma_f32_16x16x32_bf16 v[20:23], a[60:63], v[48:51], v[20:23]
 s_waitcnt lgkmcnt(1)
 v_mfma_f32_16x16x32_bf16 v[0:3], a[64:67], v[52:55], v[0:3]
 ds_read_b128 v[48:51], v70 offset:768
 v_mfma_f32_16x16x32_bf16 v[4:7], a[68:71], v[52:55], v[4:7]
 v_mfma_f32_16x16x32_bf16 v[8:11], v[52:55], a[72:75], v[8:11]
 v_mfma_f32_16x16x32_bf16 v[12:15], v[52:55], a[76:79], v[12:15]
 v_mfma_f32_16x16x32_bf16 v[16:19], a[80:83], v[52:55], v[16:19]
 v_mfma_f32_16x16x32_bf16 v[20:23], a[84:87], v[52:55], v[20:23]
 s_waitcnt lgkmcnt(1)
 v_mfma_f32_16x16x32_bf16 v[0:3], a[88:91], v[56:59], v[0:3]
 ds_read_b128 v[52:55], v71 offset:768
 v_mfma_f32_16x16x32_bf16 v[4:7], a[92:95], v[56:59], v[4:7]
 v_mfma_f32_16x16x32_bf16 v[8:11], v[56:59], a[96:99], v[8:11]
 v_mfma_f32_16x16x32_bf16 v[12:15], v[56:59], a[100:103], v[12:15]
 v_mfma_f32_16x16x32_bf16 v[16:19], a[104:107], v[56:59], v[16:19]
 v_mfma_f32_16x16x32_bf16 v[20:23], a[108:111], v[56:59], v[20:23]
 s_waitcnt lgkmcnt(1)
 v_mfma_f32_16x16x32_bf16 v[0:3], a[112:115], v[48:51], v[0:3]
 ds_read_b128 v[56:59], v70 offset:896
 v_mfma_f32_16x16x32_bf16 v[4:7], a[116:119], v[48:51], v[4:7]
 v_mfma_f32_16x16x32_bf16 v[8:11], v[48:51], a[120:123], v[8:11]
 v_mfma_f32_16x16x32_bf16 v[12:15], v[48:51], a[124:127], v[12:15]
 v_mfma_f32_16x16x32_bf16 v[16:19], a[128:131], v[48:51], v[16:19]
 v_mfma_f32_16x16x32_bf16 v[20:23], a[132:135], v[48:51], v[20:23]
 s_waitcnt lgkmcnt(1)
 v_mfma_f32_16x16x32_bf16 v[0:3], a[136:139], v[52:55], v[0:3]
 ds_read_b128 v[48:51], v71 offset:896
 v_mfma_f32_16x16x32_bf16 v[4:7], a[140:143], v[52:55], v[4:7]
 v_mfma_f32_16x16x32_bf16 v[8:11], v[52:55], a[144:147], v[8:11]
 v_mfma_f32_16x16x32_bf16 v[12:15], v[52:55], a[148:151], v[12:15]
 v_mfma_f32_16x16x32_bf16 v[16:19], a[152:155], v[52:55], v[16:19]
 v_mfma_f32_16x16x32_bf16 v[20:23], a[156:159], v[52:55], v[20:23]
 s_waitcnt vmcnt(0)
 v_cmp_gt_u32 vcc, s74, v75
 s_waitcnt lgkmcnt(1)
 v_mfma_f32_16x16x32_bf16 v[0:3], a[160:163], v[56:59], v[0:3]
 ds_read_b128 v[52:55], v70 offset:1024
 v_cmp_gt_u32 s[66:67], s75, v75
 v_mfma_f32_16x16x32_bf16 v[4:7], a[164:167], v[56:59], v[4:7]
 v_mfma_f32_16x16x32_bf16 v[8:11], v[56:59], a[168:171], v[8:11]
 v_mfma_f32_16x16x32_bf16 v[12:15], v[56:59], a[172:175], v[12:15]
 s_cmp_eq_u32 vcc_lo, 0
 s_cselect_b32 s72, s84, 0
 s_cmp_eq_u32 s67, 0
 s_cselect_b32 s72, 2, s72
 v_mfma_f32_16x16x32_bf16 v[16:19], a[176:179], v[56:59], v[16:19]
 v_mov_b32 v76, s72
 v_mfma_f32_16x16x32_bf16 v[20:23], a[180:183], v[56:59], v[20:23]
 ds_write_b32 v72, v76 offset:0
 s_waitcnt lgkmcnt(2)
 v_mfma_f32_16x16x32_bf16 v[0:3], a[184:187], v[48:51], v[0:3]
 ds_read_b128 v[56:59], v71 offset:1024
 v_mfma_f32_16x16x32_bf16 v[4:7], a[188:191], v[48:51], v[4:7]
 v_mfma_f32_16x16x32_bf16 v[8:11], v[48:51], a[192:195], v[8:11]
 v_mfma_f32_16x16x32_bf16 v[12:15], v[48:51], a[196:199], v[12:15]
 v_mfma_f32_16x16x32_bf16 v[16:19], a[200:203], v[48:51], v[16:19]
 v_mov_b32 v76, s95
 v_mfma_f32_16x16x32_bf16 v[20:23], a[204:207], v[48:51], v[20:23]
 s_waitcnt vmcnt(1)
 s_waitcnt lgkmcnt(1)
 s_barrier
 buffer_store_dword v76, v77, s[8:11], s94 offen sc1
 ds_read_b32 v76, v73 offset:0
 v_mfma_f32_16x16x32_bf16 v[0:3], a[208:211], v[52:55], v[0:3]
 ds_read_b128 v[48:51], v70 offset:18432
 v_mfma_f32_16x16x32_bf16 v[4:7], a[212:215], v[52:55], v[4:7]
 v_mfma_f32_16x16x32_bf16 v[8:11], v[52:55], a[216:219], v[8:11]
 v_mfma_f32_16x16x32_bf16 v[12:15], v[52:55], a[220:223], v[12:15]
 v_mfma_f32_16x16x32_bf16 v[16:19], a[224:227], v[52:55], v[16:19]
 v_mfma_f32_16x16x32_bf16 v[20:23], a[228:231], v[52:55], v[20:23]
 s_waitcnt lgkmcnt(2)
 v_mfma_f32_16x16x32_bf16 v[0:3], a[232:235], v[56:59], v[0:3]
 ds_read_b128 v[52:55], v71 offset:18432
 v_mfma_f32_16x16x32_bf16 v[4:7], a[236:239], v[56:59], v[4:7]
 v_mfma_f32_16x16x32_bf16 v[8:11], v[56:59], a[240:243], v[8:11]
 s_waitcnt lgkmcnt(2)
 v_readfirstlane_b32 s72, v76
 v_mfma_f32_16x16x32_bf16 v[12:15], v[56:59], a[244:247], v[12:15]
 v_mfma_f32_16x16x32_bf16 v[16:19], a[248:251], v[56:59], v[16:19]
 v_mfma_f32_16x16x32_bf16 v[20:23], a[252:255], v[56:59], v[20:23]
 s_cmp_lg_u32 s72, 0
 s_cbranch_scc1 L_q_p1d
 s_branch L_q_p1n
L_q_p1d:
 s_waitcnt lgkmcnt(1)
 v_mfma_f32_16x16x32_bf16 v[24:27], v[80:83], v[48:51], 0
 ds_read_b128 v[56:59], v70 offset:18560
 buffer_load_dword v75, v74, s[8:11], 0 offen sc1
 v_mfma_f32_16x16x32_bf16 v[28:31], v[84:87], v[48:51], 0
 s_sub_u32 s68, s72, 1
 s_cmp_eq_u32 s68, 0
 s_cselect_b32 s69, s74, s75
 s_cselect_b32 s63, 2, 0
 s_cselect_b32 s64, 0, 2
 v_mfma_f32_16x16x32_bf16 v[32:35], v[48:51], v[88:91], 0
 s_add_u32 s74, s74, s63
 s_add_u32 s75, s75, s64
 s_add_u32 s63, s75, 8
 s_cmp_lt_u32 s74, s63
 s_cselect_b32 s84, 1, s68
 v_mfma_f32_16x16x32_bf16 v[36:39], v[48:51], v[92:95], 0
 s_cmp_lt_u32 s75, 3
 s_cselect_b32 s84, 1, s84
 s_mul_i32 s73, s69, 36864
 v_mfma_f32_16x16x32_bf16 v[40:43], v[96:99], v[48:51], 0
 s_mul_i32 s63, s68, 2359296
 s_add_u32 s73, s73, s63
 s_add_u32 s73, s73, s90
 v_mfma_f32_16x16x32_bf16 v[44:47], v[100:103], v[48:51], 0
 s_mov_b32 m0, s70
 s_waitcnt lgkmcnt(1)
 v_mfma_f32_16x16x32_bf16 v[24:27], v[104:107], v[52:55], v[24:27]
 ds_read_b128 v[48:51], v71 offset:18560
 v_cvt_pk_bf16_f32 v0, v0, v1
 v_mfma_f32_16x16x32_bf16 v[28:31], v[108:111], v[52:55], v[28:31]
 buffer_load_dwordx4 v72, s[8:11], s73 offen sc1 lds
 v_mfma_f32_16x16x32_bf16 v[32:35], v[52:55], v[112:115], v[32:35]
 v_cvt_pk_bf16_f32 v1, v2, v3
 v_cvt_pk_bf16_f32 v2, v4, v5
 v_mfma_f32_16x16x32_bf16 v[36:39], v[52:55], v[116:119], v[36:39]
 v_cvt_pk_bf16_f32 v3, v6, v7
 v_cvt_pk_bf16_f32 v60, v8, v9
 v_mfma_f32_16x16x32_bf16 v[40:43], v[120:123], v[52:55], v[40:43]
 buffer_store_dwordx4 v[0:3], v73, s[8:11], s78 offen offset:0 sc1
 v_mfma_f32_16x16x32_bf16 v[44:47], v[124:127], v[52:55], v[44:47]
 s_add_u32 m0, m0, s3
 s_add_u32 s73, s73, s3
 s_waitcnt lgkmcnt(1)
 v_mfma_f32_16x16x32_bf16 v[24:27], v[128:131], v[56:59], v[24:27]
 ds_read_b128 v[52:55], v70 offset:18688
 v_cvt_pk_bf16_f32 v61, v10, v11
 v_mfma_f32_16x16x32_bf16 v[28:31], v[132:135], v[56:59], v[28:31]
 buffer_load_dwordx4 v72, s[8:11], s73 offen sc1 lds
 v_mfma_f32_16x16x32_bf16 v[32:35], v[56:59], v[136:139], v[32:35]
 v_cvt_pk_bf16_f32 v62, v12, v13
 v_cvt_pk_bf16_f32 v63, v14, v15
 v_mfma_f32_16x16x32_bf16 v[36:39], v[56:59], v[140:143], v[36:39]
 v_cvt_pk_bf16_f32 v16, v16, v17
 v_cvt_pk_bf16_f32 v17, v18, v19
 v_mfma_f32_16x16x32_bf16 v[40:43], v[144:147], v[56:59], v[40:43]
 v_cvt_pk_bf16_f32 v18, v20, v21
 v_cvt_pk_bf16_f32 v19, v22, v23
 v_mfma_f32_16x16x32_bf16 v[44:47], v[148:151], v[56:59], v[44:47]
 s_add_u32 m0, m0, s3
 s_add_u32 s73, s73, s3
 s_waitcnt lgkmcnt(1)
 v_mfma_f32_16x16x32_bf16 v[24:27], v[152:155], v[48:51], v[24:27]
 ds_read_b128 v[56:59], v71 offset:18688
 v_mfma_f32_16x16x32_bf16 v[28:31], v[156:159], v[48:51], v[28:31]
 buffer_load_dwordx4 v72, s[8:11], s73 offen sc1 lds
 v_mfma_f32_16x16x32_bf16 v[32:35], v[48:51], v[160:163], v[32:35]
 buffer_store_dwordx4 v[16:19], v73, s[8:11], s77 offen offset:0 sc1
 v_mfma_f32_16x16x32_bf16 v[36:39], v[48:51], v[164:167], v[36:39]
 v_mfma_f32_16x16x32_bf16 v[40:43], v[168:171], v[48:51], v[40:43]
 v_mfma_f32_16x16x32_bf16 v[44:47], v[172:175], v[48:51], v[44:47]
 s_add_u32 m0, m0, s3
 s_add_u32 s73, s73, s3
 s_waitcnt lgkmcnt(1)
 v_mfma_f32_16x16x32_bf16 v[24:27], v[176:179], v[52:55], v[24:27]
 ds_read_b128 v[48:51], v70 offset:18816
 v_mfma_f32_16x16x32_bf16 v[28:31], v[180:183], v[52:55], v[28:31]
 buffer_load_dwordx4 v72, s[8:11], s73 offen sc1 lds
 v_mfma_f32_16x16x32_bf16 v[32:35], v[52:55], v[184:187], v[32:35]
 v_mfma_f32_16x16x32_bf16 v[36:39], v[52:55], v[188:191], v[36:39]
 v_mfma_f32_16x16x32_bf16 v[40:43], v[192:195], v[52:55], v[40:43]
 v_mfma_f32_16x16x32_bf16 v[44:47], v[196:199], v[52:55], v[44:47]
 s_add_u32 m0, m0, s3
 s_add_u32 s73, s73, s3
 s_waitcnt lgkmcnt(1)
 v_mfma_f32_16x16x32_bf16 v[24:27], v[200:203], v[56:59], v[24:27]
 ds_read_b128 v[52:55], v71 offset:18816
 v_mfma_f32_16x16x32_bf16 v[28:31], v[204:207], v[56:59], v[28:31]
 buffer_load_dwordx4 v72, s[8:11], s73 offen sc1 lds
 v_mfma_f32_16x16x32_bf16 v[32:35], v[56:59], v[208:211], v[32:35]
 v_mfma_f32_16x16x32_bf16 v[36:39], v[56:59], v[212:215], v[36:39]
 v_mfma_f32_16x16x32_bf16 v[40:43], v[216:219], v[56:59], v[40:43]
 v_mfma_f32_16x16x32_bf16 v[44:47], v[220:223], v[56:59], v[44:47]
 s_add_u32 m0, m0, s3
 s_add_u32 s73, s73, s3
 s_waitcnt lgkmcnt(1)
 v_mfma_f32_16x16x32_bf16 v[24:27], v[224:227], v[48:51], v[24:27]
 ds_read_b128 v[56:59], v70 offset:18944
 v_mfma_f32_16x16x32_bf16 v[28:31], v[228:231], v[48:51], v[28:31]
 buffer_load_dwordx4 v72, s[8:11], s73 offen sc1 lds
 v_mfma_f32_16x16x32_bf16 v[32:35], v[48:51], v[232:235], v[32:35]
 v_mfma_f32_16x16x32_bf16 v[36:39], v[48:51], v[236:239], v[36:39]
 v_mfma_f32_16x16x32_bf16 v[40:43], v[240:243], v[48:51], v[40:43]
 v_mfma_f32_16x16x32_bf16 v[44:47], v[244:247], v[48:51], v[44:47]
 s_add_u32 m0, m0, s3
 s_add_u32 s73, s73, s3
 s_waitcnt lgkmcnt(1)
 v_mfma_f32_16x16x32_bf16 v[24:27], v[248:251], v[52:55], v[24:27]
 ds_read_b128 v[48:51], v71 offset:18944
 v_mfma_f32_16x16x32_bf16 v[28:31], v[252:255], v[52:55], v[28:31]
 buffer_load_dwordx4 v72, s[8:11], s73 offen sc1 lds
 v_mfma_f32_16x16x32_bf16 v[32:35], v[52:55], a[0:3], v[32:35]
 v_mfma_f32_16x16x32_bf16 v[36:39], v[52:55], a[4:7], v[36:39]
 v_mfma_f32_16x16x32_bf16 v[40:43], a[8:11], v[52:55], v[40:43]
 v_mfma_f32_16x16x32_bf16 v[44:47], a[12:15], v[52:55], v[44:47]
 s_add_u32 m0, m0, s3
 s_add_u32 s73, s73, s3
 s_waitcnt lgkmcnt(1)
 v_mfma_f32_16x16x32_bf16 v[24:27], a[16:19], v[56:59], v[24:27]
 ds_read_b128 v[52:55], v70 offset:19072
 v_mfma_f32_16x16x32_bf16 v[28:31], a[20:23], v[56:59], v[28:31]
 buffer_load_dwordx4 v72, s[8:11], s73 offen sc1 lds
 v_mfma_f32_16x16x32_bf16 v[32:35], v[56:59], a[24:27], v[32:35]
 v_mfma_f32_16x16x32_bf16 v[36:39], v[56:59], a[28:31], v[36:39]
 v_mfma_f32_16x16x32_bf16 v[40:43], a[32:35], v[56:59], v[40:43]
 v_mfma_f32_16x16x32_bf16 v[44:47], a[36:39], v[56:59], v[44:47]
 s_add_u32 m0, m0, s3
 s_add_u32 s73, s73, s3
 s_waitcnt lgkmcnt(1)
 v_mfma_f32_16x16x32_bf16 v[24:27], a[40:43], v[48:51], v[24:27]
 ds_read_b128 v[56:59], v71 offset:19072
 v_mfma_f32_16x16x32_bf16 v[28:31], a[44:47], v[48:51], v[28:31]
 buffer_load_dwordx4 v72, s[8:11], s73 offen sc1 lds
 v_mfma_f32_16x16x32_bf16 v[32:35], v[48:51], a[48:51], v[32:35]
 s_mov_b32 s63, s85
 s_mov_b32 s85, s4
 s_mov_b32 s4, s5
 v_mfma_f32_16x16x32_bf16 v[36:39], v[48:51], a[52:55], v[36:39]
 s_mov_b32 s5, s63
 s_add_u32 s70, s70, s85
 s_mov_b32 s81, s77
 v_mfma_f32_16x16x32_bf16 v[40:43], a[56:59], v[48:51], v[40:43]
 s_mov_b32 s82, s78
 s_mov_b32 s83, s79
 s_mov_b32 s94, s92
 v_mfma_f32_16x16x32_bf16 v[44:47], a[60:63], v[48:51], v[44:47]
 s_mov_b32 s95, s93
 s_mov_b32 s63, s69
 s_waitcnt lgkmcnt(1)
 v_mfma_f32_16x16x32_bf16 v[24:27], a[64:67], v[52:55], v[24:27]
 ds_read_b128 v[48:51], v70 offset:19200
 s_mul_i32 s63, s63, 786432
 v_mfma_f32_16x16x32_bf16 v[28:31], a[68:71], v[52:55], v[28:31]
 s_mul_i32 s64, s68, 50331648
 s_add_u32 s63, s63, s64
 v_mfma_f32_16x16x32_bf16 v[32:35], v[52:55], a[72:75], v[32:35]
 s_add_u32 s77, s63, s87
 s_add_u32 s78, s63, s88
 s_add_u32 s79, s63, s89
 v_mfma_f32_16x16x32_bf16 v[36:39], v[52:55], a[76:79], v[36:39]
 s_mul_i32 s92, s68, 4096
 s_add_u32 s93, s69, 1
 v_mfma_f32_16x16x32_bf16 v[40:43], a[80:83], v[52:55], v[40:43]
 s_add_u32 s61, s61, 1
 v_mfma_f32_16x16x32_bf16 v[44:47], a[84:87], v[52:55], v[44:47]
 s_waitcnt lgkmcnt(1)
 v_mfma_f32_16x16x32_bf16 v[24:27], a[88:91], v[56:59], v[24:27]
 ds_read_b128 v[52:55], v71 offset:19200
 v_mfma_f32_16x16x32_bf16 v[28:31], a[92:95], v[56:59], v[28:31]
 v_mfma_f32_16x16x32_bf16 v[32:35], v[56:59], a[96:99], v[32:35]
 v_mfma_f32_16x16x32_bf16 v[36:39], v[56:59], a[100:103], v[36:39]
 v_mfma_f32_16x16x32_bf16 v[40:43], a[104:107], v[56:59], v[40:43]
 v_mfma_f32_16x16x32_bf16 v[44:47], a[108:111], v[56:59], v[44:47]
 s_waitcnt lgkmcnt(1)
 v_mfma_f32_16x16x32_bf16 v[24:27], a[112:115], v[48:51], v[24:27]
 ds_read_b128 v[56:59], v70 offset:19328
 v_mfma_f32_16x16x32_bf16 v[28:31], a[116:119], v[48:51], v[28:31]
 v_mfma_f32_16x16x32_bf16 v[32:35], v[48:51], a[120:123], v[32:35]
 v_mfma_f32_16x16x32_bf16 v[36:39], v[48:51], a[124:127], v[36:39]
 v_mfma_f32_16x16x32_bf16 v[40:43], a[128:131], v[48:51], v[40:43]
 v_mfma_f32_16x16x32_bf16 v[44:47], a[132:135], v[48:51], v[44:47]
 s_waitcnt lgkmcnt(1)
 v_mfma_f32_16x16x32_bf16 v[24:27], a[136:139], v[52:55], v[24:27]
 ds_read_b128 v[48:51], v71 offset:19328
 v_mfma_f32_16x16x32_bf16 v[28:31], a[140:143], v[52:55], v[28:31]
 v_mfma_f32_16x16x32_bf16 v[32:35], v[52:55], a[144:147], v[32:35]
 v_mfma_f32_16x16x32_bf16 v[36:39], v[52:55], a[148:151], v[36:39]
 v_mfma_f32_16x16x32_bf16 v[40:43], a[152:155], v[52:55], v[40:43]
 v_mfma_f32_16x16x32_bf16 v[44:47], a[156:159], v[52:55], v[44:47]
 s_waitcnt vmcnt(11)
 v_cmp_gt_u32 vcc, s74, v75
 s_waitcnt lgkmcnt(1)
 v_mfma_f32_16x16x32_bf16 v[24:27], a[160:163], v[56:59], v[24:27]
 ds_read_b128 v[52:55], v70 offset:19456
 v_cmp_gt_u32 s[66:67], s75, v75
 v_mfma_f32_16x16x32_bf16 v[28:31], a[164:167], v[56:59], v[28:31]
 v_mfma_f32_16x16x32_bf16 v[32:35], v[56:59], a[168:171], v[32:35]
 v_mfma_f32_16x16x32_bf16 v[36:39], v[56:59], a[172:175], v[36:39]
 s_cmp_eq_u32 vcc_lo, 0
 s_cselect_b32 s72, s84, 0
 s_cmp_eq_u32 s67, 0
 s_cselect_b32 s72, 2, s72
 v_mfma_f32_16x16x32_bf16 v[40:43], a[176:179], v[56:59], v[40:43]
 v_mov_b32 v76, s72
 v_mfma_f32_16x16x32_bf16 v[44:47], a[180:183], v[56:59], v[44:47]
 ds_write_b32 v72, v76 offset:4
 s_waitcnt lgkmcnt(2)
 v_mfma_f32_16x16x32_bf16 v[24:27], a[184:187], v[48:51], v[24:27]
 ds_read_b128 v[56:59], v71 offset:19456
 v_mfma_f32_16x16x32_bf16 v[28:31], a[188:191], v[48:51], v[28:31]
 v_mfma_f32_16x16x32_bf16 v[32:35], v[48:51], a[192:195], v[32:35]
 v_mfma_f32_16x16x32_bf16 v[36:39], v[48:51], a[196:199], v[36:39]
 v_mfma_f32_16x16x32_bf16 v[40:43], a[200:203], v[48:51], v[40:43]
 v_mfma_f32_16x16x32_bf16 v[44:47], a[204:207], v[48:51], v[44:47]
 s_waitcnt lgkmcnt(1)
 s_waitcnt vmcnt(4)
 s_branch L_q_fe
L_q_p0ed:
 s_waitcnt lgkmcnt(1)
 v_mfma_f32_16x16x32_bf16 v[0:3], v[80:83], v[48:51], 0
 ds_read_b128 v[56:59], v70 offset:128
 s_sub_u32 s68, s72, 1
 v_mfma_f32_16x16x32_bf16 v[4:7], v[84:87], v[48:51], 0
 s_cmp_eq_u32 s68, 0
 s_cselect_b32 s69, s74, s75
 s_cselect_b32 s63, 2, 0
 v_mfma_f32_16x16x32_bf16 v[8:11], v[48:51], v[88:91], 0
 s_cselect_b32 s64, 0, 2
 s_add_u32 s74, s74, s63
 s_add_u32 s75, s75, s64
 v_mfma_f32_16x16x32_bf16 v[12:15], v[48:51], v[92:95], 0
 s_add_u32 s63, s75, 8
 s_cmp_lt_u32 s74, s63
 s_cselect_b32 s84, 1, s68
 v_mfma_f32_16x16x32_bf16 v[16:19], v[96:99], v[48:51], 0
 s_cmp_lt_u32 s75, 3
 s_cselect_b32 s84, 1, s84
 v_mfma_f32_16x16x32_bf16 v[20:23], v[100:103], v[48:51], 0
 s_mul_i32 s73, s69, 36864
 s_waitcnt lgkmcnt(1)
 v_mfma_f32_16x16x32_bf16 v[0:3], v[104:107], v[52:55], v[0:3]
 ds_read_b128 v[48:51], v71 offset:128
 s_mul_i32 s63, s68, 2359296
 v_mfma_f32_16x16x32_bf16 v[4:7], v[108:111], v[52:55], v[4:7]
 s_add_u32 s73, s73, s63
 s_add_u32 s73, s73, s90
 v_mfma_f32_16x16x32_bf16 v[8:11], v[52:55], v[112:115], v[8:11]
 v_cvt_pk_bf16_f32 v24, v24, v25
 v_cvt_pk_bf16_f32 v25, v26, v27
 v_mfma_f32_16x16x32_bf16 v[12:15], v[52:55], v[116:119], v[12:15]
 v_cvt_pk_bf16_f32 v26, v28, v29
 v_cvt_pk_bf16_f32 v27, v30, v31
 v_mfma_f32_16x16x32_bf16 v[16:19], v[120:123], v[52:55], v[16:19]
 buffer_store_dwordx4 v[24:27], v73, s[8:11], s82 offen offset:1024 sc1
 v_mfma_f32_16x16x32_bf16 v[20:23], v[124:127], v[52:55], v[20:23]
 v_cvt_pk_bf16_f32 v35, v34, v35
 s_waitcnt lgkmcnt(1)
 v_mfma_f32_16x16x32_bf16 v[0:3], v[128:131], v[56:59], v[0:3]
 ds_read_b128 v[52:55], v70 offset:256
 v_cvt_pk_bf16_f32 v34, v32, v33
 v_mfma_f32_16x16x32_bf16 v[4:7], v[132:135], v[56:59], v[4:7]
 v_mov_b64 v[32:33], v[60:61]
 v_cvt_pk_bf16_f32 v39, v38, v39
 v_mfma_f32_16x16x32_bf16 v[8:11], v[56:59], v[136:139], v[8:11]
 v_cvt_pk_bf16_f32 v38, v36, v37
 v_mov_b64 v[36:37], v[62:63]
 v_mfma_f32_16x16x32_bf16 v[12:15], v[56:59], v[140:143], v[12:15]
 v_cvt_pk_bf16_f32 v40, v40, v41
 v_cvt_pk_bf16_f32 v41, v42, v43
 v_mfma_f32_16x16x32_bf16 v[16:19], v[144:147], v[56:59], v[16:19]
 v_cvt_pk_bf16_f32 v42, v44, v45
 v_cvt_pk_bf16_f32 v43, v46, v47
 v_mfma_f32_16x16x32_bf16 v[20:23], v[148:151], v[56:59], v[20:23]
 s_waitcnt lgkmcnt(1)
 v_mfma_f32_16x16x32_bf16 v[0:3], v[152:155], v[48:51], v[0:3]
 ds_read_b128 v[56:59], v71 offset:256
 v_mfma_f32_16x16x32_bf16 v[4:7], v[156:159], v[48:51], v[4:7]
 buffer_store_dwordx4 v[32:35], v73, s[8:11], s83 offen offset:0 sc1
 v_mfma_f32_16x16x32_bf16 v[8:11], v[48:51], v[160:163], v[8:11]
 v_mfma_f32_16x16x32_bf16 v[12:15], v[48:51], v[164:167], v[12:15]
 v_mfma_f32_16x16x32_bf16 v[16:19], v[168:171], v[48:51], v[16:19]
 v_mfma_f32_16x16x32_bf16 v[20:23], v[172:175], v[48:51], v[20:23]
 s_waitcnt lgkmcnt(1)
 v_mfma_f32_16x16x32_bf16 v[0:3], v[176:179], v[52:55], v[0:3]
 ds_read_b128 v[48:51], v70 offset:384
 v_mfma_f32_16x16x32_bf16 v[4:7], v[180:183], v[52:55], v[4:7]
 v_mfma_f32_16x16x32_bf16 v[8:11], v[52:55], v[184:187], v[8:11]
 v_mfma_f32_16x16x32_bf16 v[12:15], v[52:55], v[188:191], v[12:15]
 buffer_store_dwordx4 v[36:39], v73, s[8:11], s83 offen offset:1024 sc1
 v_mfma_f32_16x16x32_bf16 v[16:19], v[192:195], v[52:55], v[16:19]
 v_mfma_f32_16x16x32_bf16 v[20:23], v[196:199], v[52:55], v[20:23]
 s_waitcnt lgkmcnt(1)
 v_mfma_f32_16x16x32_bf16 v[0:3], v[200:203], v[56:59], v[0:3]
 ds_read_b128 v[52:55], v71 offset:384
 v_mfma_f32_16x16x32_bf16 v[4:7], v[204:207], v[56:59], v[4:7]
 v_mfma_f32_16x16x32_bf16 v[8:11], v[56:59], v[208:211], v[8:11]
 v_mfma_f32_16x16x32_bf16 v[12:15], v[56:59], v[212:215], v[12:15]
 v_mfma_f32_16x16x32_bf16 v[16:19], v[216:219], v[56:59], v[16:19]
 v_mfma_f32_16x16x32_bf16 v[20:23], v[220:223], v[56:59], v[20:23]
 s_waitcnt lgkmcnt(1)
 v_mfma_f32_16x16x32_bf16 v[0:3], v[224:227], v[48:51], v[0:3]
 ds_read_b128 v[56:59], v70 offset:512
 v_mfma_f32_16x16x32_bf16 v[4:7], v[228:231], v[48:51], v[4:7]
 buffer_store_dwordx4 v[40:43], v73, s[8:11], s81 offen offset:1024 sc1
 v_mfma_f32_16x16x32_bf16 v[8:11], v[48:51], v[232:235], v[8:11]
 v_mfma_f32_16x16x32_bf16 v[12:15], v[48:51], v[236:239], v[12:15]
 v_mfma_f32_16x16x32_bf16 v[16:19], v[240:243], v[48:51], v[16:19]
 v_mfma_f32_16x16x32_bf16 v[20:23], v[244:247], v[48:51], v[20:23]
 s_waitcnt lgkmcnt(1)
 v_mfma_f32_16x16x32_bf16 v[0:3], v[248:251], v[52:55], v[0:3]
 ds_read_b128 v[48:51], v71 offset:512
 v_mfma_f32_16x16x32_bf16 v[4:7], v[252:255], v[52:55], v[4:7]
 v_mfma_f32_16x16x32_bf16 v[8:11], v[52:55], a[0:3], v[8:11]
 s_mov_b32 m0, s70
 v_mfma_f32_16x16x32_bf16 v[12:15], v[52:55], a[4:7], v[12:15]
 buffer_load_dwordx4 v72, s[8:11], s73 offen sc1 lds
 v_mfma_f32_16x16x32_bf16 v[16:19], a[8:11], v[52:55], v[16:19]
 v_mfma_f32_16x16x32_bf16 v[20:23], a[12:15], v[52:55], v[20:23]
 s_waitcnt lgkmcnt(1)
 v_mfma_f32_16x16x32_bf16 v[0:3], a[16:19], v[56:59], v[0:3]
 ds_read_b128 v[52:55], v70 offset:640
 v_mfma_f32_16x16x32_bf16 v[4:7], a[20:23], v[56:59], v[4:7]
 v_mfma_f32_16x16x32_bf16 v[8:11], v[56:59], a[24:27], v[8:11]
 s_add_u32 m0, m0, s3
 s_add_u32 s73, s73, s3
 v_mfma_f32_16x16x32_bf16 v[12:15], v[56:59], a[28:31], v[12:15]
 buffer_load_dwordx4 v72, s[8:11], s73 offen sc1 lds
 v_mfma_f32_16x16x32_bf16 v[16:19], a[32:35], v[56:59], v[16:19]
 v_mfma_f32_16x16x32_bf16 v[20:23], a[36:39], v[56:59], v[20:23]
 s_waitcnt lgkmcnt(1)
 v_mfma_f32_16x16x32_bf16 v[0:3], a[40:43], v[48:51], v[0:3]
 ds_read_b128 v[56:59], v71 offset:640
 v_mfma_f32_16x16x32_bf16 v[4:7], a[44:47], v[48:51], v[4:7]
 v_mfma_f32_16x16x32_bf16 v[8:11], v[48:51], a[48:51], v[8:11]
 s_add_u32 m0, m0, s3
 s_add_u32 s73, s73, s3
 v_mfma_f32_16x16x32_bf16 v[12:15], v[48:51], a[52:55], v[12:15]
 buffer_load_dwordx4 v72, s[8:11], s73 offen sc1 lds
 v_mfma_f32_16x16x32_bf16 v[16:19], a[56:59], v[48:51], v[16:19]
 v_mfma_f32_16x16x32_bf16 v[20:23], a[60:63], v[48:51], v[20:23]
 s_waitcnt lgkmcnt(1)
 v_mfma_f32_16x16x32_bf16 v[0:3], a[64:67], v[52:55], v[0:3]
 ds_read_b128 v[48:51], v70 offset:768
 v_mfma_f32_16x16x32_bf16 v[4:7], a[68:71], v[52:55], v[4:7]
 v_mfma_f32_16x16x32_bf16 v[8:11], v[52:55], a[72:75], v[8:11]
 s_add_u32 m0, m0, s3
 s_add_u32 s73, s73, s3
 v_mfma_f32_16x16x32_bf16 v[12:15], v[52:55], a[76:79], v[12:15]
 buffer_load_dwordx4 v72, s[8:11], s73 offen sc1 lds
 v_mfma_f32_16x16x32_bf16 v[16:19], a[80:83], v[52:55], v[16:19]
 v_mfma_f32_16x16x32_bf16 v[20:23], a[84:87], v[52:55], v[20:23]
 s_waitcnt lgkmcnt(1)
 v_mfma_f32_16x16x32_bf16 v[0:3], a[88:91], v[56:59], v[0:3]
 ds_read_b128 v[52:55], v71 offset:768
 v_mfma_f32_16x16x32_bf16 v[4:7], a[92:95], v[56:59], v[4:7]
 v_mfma_f32_16x16x32_bf16 v[8:11], v[56:59], a[96:99], v[8:11]
 s_add_u32 m0, m0, s3
 s_add_u32 s73, s73, s3
 v_mfma_f32_16x16x32_bf16 v[12:15], v[56:59], a[100:103], v[12:15]
 buffer_load_dwordx4 v72, s[8:11], s73 offen sc1 lds
 v_mfma_f32_16x16x32_bf16 v[16:19], a[104:107], v[56:59], v[16:19]
 v_mfma_f32_16x16x32_bf16 v[20:23], a[108:111], v[56:59], v[20:23]
 s_waitcnt lgkmcnt(1)
 v_mfma_f32_16x16x32_bf16 v[0:3], a[112:115], v[48:51], v[0:3]
 ds_read_b128 v[56:59], v70 offset:896
 v_mfma_f32_16x16x32_bf16 v[4:7], a[116:119], v[48:51], v[4:7]
 v_mfma_f32_16x16x32_bf16 v[8:11], v[48:51], a[120:123], v[8:11]
 s_add_u32 m0, m0, s3
 s_add_u32 s73, s73, s3
 v_mfma_f32_16x16x32_bf16 v[12:15], v[48:51], a[124:127], v[12:15]
 buffer_load_dwordx4 v72, s[8:11], s73 offen sc1 lds
 v_mfma_f32_16x16x32_bf16 v[16:19], a[128:131], v[48:51], v[16:19]
 v_mfma_f32_16x16x32_bf16 v[20:23], a[132:135], v[48:51], v[20:23]
 s_waitcnt lgkmcnt(1)
 v_mfma_f32_16x16x32_bf16 v[0:3], a[136:139], v[52:55], v[0:3]
 ds_read_b128 v[48:51], v71 offset:896
 v_mfma_f32_16x16x32_bf16 v[4:7], a[140:143], v[52:55], v[4:7]
 v_mfma_f32_16x16x32_bf16 v[8:11], v[52:55], a[144:147], v[8:11]
 s_add_u32 m0, m0, s3
 s_add_u32 s73, s73, s3
 v_mfma_f32_16x16x32_bf16 v[12:15], v[52:55], a[148:151], v[12:15]
 buffer_load_dwordx4 v72, s[8:11], s73 offen sc1 lds
 v_mfma_f32_16x16x32_bf16 v[16:19], a[152:155], v[52:55], v[16:19]
 v_mfma_f32_16x16x32_bf16 v[20:23], a[156:159], v[52:55], v[20:23]
 s_waitcnt lgkmcnt(1)
 v_mfma_f32_16x16x32_bf16 v[0:3], a[160:163], v[56:59], v[0:3]
 ds_read_b128 v[52:55], v70 offset:1024
 v_mfma_f32_16x16x32_bf16 v[4:7], a[164:167], v[56:59], v[4:7]
 v_mfma_f32_16x16x32_bf16 v[8:11], v[56:59], a[168:171], v[8:11]
 s_add_u32 m0, m0, s3
 s_add_u32 s73, s73, s3
 v_mfma_f32_16x16x32_bf16 v[12:15], v[56:59], a[172:175], v[12:15]
 buffer_load_dwordx4 v72, s[8:11], s73 offen sc1 lds
 v_mfma_f32_16x16x32_bf16 v[16:19], a[176:179], v[56:59], v[16:19]
 v_mfma_f32_16x16x32_bf16 v[20:23], a[180:183], v[56:59], v[20:23]
 s_waitcnt lgkmcnt(1)
 v_mfma_f32_16x16x32_bf16 v[0:3], a[184:187], v[48:51], v[0:3]
 ds_read_b128 v[56:59], v71 offset:1024
 v_mfma_f32_16x16x32_bf16 v[4:7], a[188:191], v[48:51], v[4:7]
 v_mfma_f32_16x16x32_bf16 v[8:11], v[48:51], a[192:195], v[8:11]
 s_add_u32 m0, m0, s3
 s_add_u32 s73, s73, s3
 v_mfma_f32_16x16x32_bf16 v[12:15], v[48:51], a[196:199], v[12:15]
 buffer_load_dwordx4 v72, s[8:11], s73 offen sc1 lds
 v_mfma_f32_16x16x32_bf16 v[16:19], a[200:203], v[48:51], v[16:19]
 v_mov_b32 v76, s95
 v_mfma_f32_16x16x32_bf16 v[20:23], a[204:207], v[48:51], v[20:23]
 s_waitcnt vmcnt(9)
 s_barrier
 buffer_store_dword v76, v77, s[8:11], s94 offen sc1
 s_waitcnt lgkmcnt(1)
 v_mfma_f32_16x16x32_bf16 v[0:3], a[208:211], v[52:55], v[0:3]
 ds_read_b128 v[48:51], v70 offset:18432
 v_mfma_f32_16x16x32_bf16 v[4:7], a[212:215], v[52:55], v[4:7]
 v_mfma_f32_16x16x32_bf16 v[8:11], v[52:55], a[216:219], v[8:11]
 v_mfma_f32_16x16x32_bf16 v[12:15], v[52:55], a[220:223], v[12:15]
 v_mfma_f32_16x16x32_bf16 v[16:19], a[224:227], v[52:55], v[16:19]
 v_mfma_f32_16x16x32_bf16 v[20:23], a[228:231], v[52:55], v[20:23]
 s_waitcnt lgkmcnt(1)
 v_mfma_f32_16x16x32_bf16 v[0:3], a[232:235], v[56:59], v[0:3]
 ds_read_b128 v[52:55], v71 offset:18432
 v_mfma_f32_16x16x32_bf16 v[4:7], a[236:239], v[56:59], v[4:7]
 v_mfma_f32_16x16x32_bf16 v[8:11], v[56:59], a[240:243], v[8:11]
 v_mfma_f32_16x16x32_bf16 v[12:15], v[56:59], a[244:247], v[12:15]
 v_mfma_f32_16x16x32_bf16 v[16:19], a[248:251], v[56:59], v[16:19]
 v_mfma_f32_16x16x32_bf16 v[20:23], a[252:255], v[56:59], v[20:23]
 s_waitcnt lgkmcnt(1)
 v_mfma_f32_16x16x32_bf16 v[24:27], v[80:83], v[48:51], 0
 ds_read_b128 v[56:59], v70 offset:18560
 v_mfma_f32_16x16x32_bf16 v[28:31], v[84:87], v[48:51], 0
 v_mfma_f32_16x16x32_bf16 v[32:35], v[48:51], v[88:91], 0
 v_mfma_f32_16x16x32_bf16 v[36:39], v[48:51], v[92:95], 0
 v_mfma_f32_16x16x32_bf16 v[40:43], v[96:99], v[48:51], 0
 v_cvt_pk_bf16_f32 v0, v0, v1
 v_cvt_pk_bf16_f32 v1, v2, v3
 v_mfma_f32_16x16x32_bf16 v[44:47], v[100:103], v[48:51], 0
 v_cvt_pk_bf16_f32 v2, v4, v5
 s_waitcnt lgkmcnt(1)
 v_mfma_f32_16x16x32_bf16 v[24:27], v[104:107], v[52:55], v[24:27]
 ds_read_b128 v[48:51], v71 offset:18560
 v_cvt_pk_bf16_f32 v3, v6, v7
 v_mfma_f32_16x16x32_bf16 v[28:31], v[108:111], v[52:55], v[28:31]
 buffer_store_dwordx4 v[0:3], v73, s[8:11], s78 offen offset:0 sc1
 v_mfma_f32_16x16x32_bf16 v[32:35], v[52:55], v[112:115], v[32:35]
 v_cvt_pk_bf16_f32 v60, v8, v9
 v_cvt_pk_bf16_f32 v61, v10, v11
 v_mfma_f32_16x16x32_bf16 v[36:39], v[52:55], v[116:119], v[36:39]
 v_cvt_pk_bf16_f32 v62, v12, v13
 v_cvt_pk_bf16_f32 v63, v14, v15
 v_mfma_f32_16x16x32_bf16 v[40:43], v[120:123], v[52:55], v[40:43]
 v_cvt_pk_bf16_f32 v16, v16, v17
 v_cvt_pk_bf16_f32 v17, v18, v19
 v_mfma_f32_16x16x32_bf16 v[44:47], v[124:127], v[52:55], v[44:47]
 v_cvt_pk_bf16_f32 v18, v20, v21
 s_waitcnt lgkmcnt(1)
 v_mfma_f32_16x16x32_bf16 v[24:27], v[128:131], v[56:59], v[24:27]
 ds_read_b128 v[52:55], v70 offset:18688
 v_cvt_pk_bf16_f32 v19, v22, v23
 v_mfma_f32_16x16x32_bf16 v[28:31], v[132:135], v[56:59], v[28:31]
 v_mfma_f32_16x16x32_bf16 v[32:35], v[56:59], v[136:139], v[32:35]
 v_mfma_f32_16x16x32_bf16 v[36:39], v[56:59], v[140:143], v[36:39]
 buffer_store_dwordx4 v[16:19], v73, s[8:11], s77 offen offset:0 sc1
 v_mfma_f32_16x16x32_bf16 v[40:43], v[144:147], v[56:59], v[40:43]
 s_mov_b32 s63, s85
 s_mov_b32 s85, s4
 s_mov_b32 s4, s5
 v_mfma_f32_16x16x32_bf16 v[44:47], v[148:151], v[56:59], v[44:47]
 s_mov_b32 s5, s63
 s_add_u32 s70, s70, s85
 s_waitcnt lgkmcnt(1)
 v_mfma_f32_16x16x32_bf16 v[24:27], v[152:155], v[48:51], v[24:27]
 ds_read_b128 v[56:59], v71 offset:18688
 s_mov_b32 s81, s77
 v_mfma_f32_16x16x32_bf16 v[28:31], v[156:159], v[48:51], v[28:31]
 s_mov_b32 s82, s78
 s_mov_b32 s83, s79
 s_mov_b32 s94, s92
 v_mfma_f32_16x16x32_bf16 v[32:35], v[48:51], v[160:163], v[32:35]
 s_mov_b32 s95, s93
 s_mov_b32 s63, s69
 v_mfma_f32_16x16x32_bf16 v[36:39], v[48:51], v[164:167], v[36:39]
 s_mul_i32 s63, s63, 786432
 s_mul_i32 s64, s68, 50331648
 v_mfma_f32_16x16x32_bf16 v[40:43], v[168:171], v[48:51], v[40:43]
 s_add_u32 s63, s63, s64
 s_add_u32 s77, s63, s87
 s_add_u32 s78, s63, s88
 v_mfma_f32_16x16x32_bf16 v[44:47], v[172:175], v[48:51], v[44:47]
 s_add_u32 s79, s63, s89
 s_waitcnt lgkmcnt(1)
 v_mfma_f32_16x16x32_bf16 v[24:27], v[176:179], v[52:55], v[24:27]
 ds_read_b128 v[48:51], v70 offset:18816
 s_mul_i32 s92, s68, 4096
 v_mfma_f32_16x16x32_bf16 v[28:31], v[180:183], v[52:55], v[28:31]
 s_add_u32 s93, s69, 1
 s_add_u32 s61, s61, 1
 v_mfma_f32_16x16x32_bf16 v[32:35], v[52:55], v[184:187], v[32:35]
 v_mfma_f32_16x16x32_bf16 v[36:39], v[52:55], v[188:191], v[36:39]
 v_mfma_f32_16x16x32_bf16 v[40:43], v[192:195], v[52:55], v[40:43]
 v_mfma_f32_16x16x32_bf16 v[44:47], v[196:199], v[52:55], v[44:47]
 s_waitcnt lgkmcnt(1)
 v_mfma_f32_16x16x32_bf16 v[24:27], v[200:203], v[56:59], v[24:27]
 ds_read_b128 v[52:55], v71 offset:18816
 v_mfma_f32_16x16x32_bf16 v[28:31], v[204:207], v[56:59], v[28:31]
 v_mfma_f32_16x16x32_bf16 v[32:35], v[56:59], v[208:211], v[32:35]
 v_mfma_f32_16x16x32_bf16 v[36:39], v[56:59], v[212:215], v[36:39]
 v_mfma_f32_16x16x32_bf16 v[40:43], v[216:219], v[56:59], v[40:43]
 v_mfma_f32_16x16x32_bf16 v[44:47], v[220:223], v[56:59], v[44:47]
 s_waitcnt lgkmcnt(1)
 v_mfma_f32_16x16x32_bf16 v[24:27], v[224:227], v[48:51], v[24:27]
 ds_read_b128 v[56:59], v70 offset:18944
 v_mfma_f32_16x16x32_bf16 v[28:31], v[228:231], v[48:51], v[28:31]
 v_mfma_f32_16x16x32_bf16 v[32:35], v[48:51], v[232:235], v[32:35]
 v_mfma_f32_16x16x32_bf16 v[36:39], v[48:51], v[236:239], v[36:39]
 v_mfma_f32_16x16x32_bf16 v[40:43], v[240:243], v[48:51], v[40:43]
 v_mfma_f32_16x16x32_bf16 v[44:47], v[244:247], v[48:51], v[44:47]
 s_waitcnt lgkmcnt(1)
 v_mfma_f32_16x16x32_bf16 v[24:27], v[248:251], v[52:55], v[24:27]
 ds_read_b128 v[48:51], v71 offset:18944
 v_mfma_f32_16x16x32_bf16 v[28:31], v[252:255], v[52:55], v[28:31]
 v_mfma_f32_16x16x32_bf16 v[32:35], v[52:55], a[0:3], v[32:35]
 buffer_load_dword v75, v74, s[8:11], 0 offen sc1
 v_mfma_f32_16x16x32_bf16 v[36:39], v[52:55], a[4:7], v[36:39]
 v_mfma_f32_16x16x32_bf16 v[40:43], a[8:11], v[52:55], v[40:43]
 v_mfma_f32_16x16x32_bf16 v[44:47], a[12:15], v[52:55], v[44:47]
 s_waitcnt lgkmcnt(1)
 v_mfma_f32_16x16x32_bf16 v[24:27], a[16:19], v[56:59], v[24:27]
 ds_read_b128 v[52:55], v70 offset:19072
 v_mfma_f32_16x16x32_bf16 v[28:31], a[20:23], v[56:59], v[28:31]
 v_mfma_f32_16x16x32_bf16 v[32:35], v[56:59], a[24:27], v[32:35]
 v_mfma_f32_16x16x32_bf16 v[36:39], v[56:59], a[28:31], v[36:39]
 v_mfma_f32_16x16x32_bf16 v[40:43], a[32:35], v[56:59], v[40:43]
 v_mfma_f32_16x16x32_bf16 v[44:47], a[36:39], v[56:59], v[44:47]
 s_waitcnt lgkmcnt(1)
 v_mfma_f32_16x16x32_bf16 v[24:27], a[40:43], v[48:51], v[24:27]
 ds_read_b128 v[56:59], v71 offset:19072
 v_mfma_f32_16x16x32_bf16 v[28:31], a[44:47], v[48:51], v[28:31]
 v_mfma_f32_16x16x32_bf16 v[32:35], v[48:51], a[48:51], v[32:35]
 v_mfma_f32_16x16x32_bf16 v[36:39], v[48:51], a[52:55], v[36:39]
 v_mfma_f32_16x16x32_bf16 v[40:43], a[56:59], v[48:51], v[40:43]
 v_mfma_f32_16x16x32_bf16 v[44:47], a[60:63], v[48:51], v[44:47]
 s_waitcnt lgkmcnt(1)
 v_mfma_f32_16x16x32_bf16 v[24:27], a[64:67], v[52:55], v[24:27]
 ds_read_b128 v[48:51], v70 offset:19200
 v_mfma_f32_16x16x32_bf16 v[28:31], a[68:71], v[52:55], v[28:31]
 v_mfma_f32_16x16x32_bf16 v[32:35], v[52:55], a[72:75], v[32:35]
 v_mfma_f32_16x16x32_bf16 v[36:39], v[52:55], a[76:79], v[36:39]
 v_mfma_f32_16x16x32_bf16 v[40:43], a[80:83], v[52:55], v[40:43]
 v_mfma_f32_16x16x32_bf16 v[44:47], a[84:87], v[52:55], v[44:47]
 s_waitcnt lgkmcnt(1)
 v_mfma_f32_16x16x32_bf16 v[24:27], a[88:91], v[56:59], v[24:27]
 ds_read_b128 v[52:55], v71 offset:19200
 v_mfma_f32_16x16x32_bf16 v[28:31], a[92:95], v[56:59], v[28:31]
 v_mfma_f32_16x16x32_bf16 v[32:35], v[56:59], a[96:99], v[32:35]
 v_mfma_f32_16x16x32_bf16 v[36:39], v[56:59], a[100:103], v[36:39]
 v_mfma_f32_16x16x32_bf16 v[40:43], a[104:107], v[56:59], v[40:43]
 v_mfma_f32_16x16x32_bf16 v[44:47], a[108:111], v[56:59], v[44:47]
 s_waitcnt lgkmcnt(1)
 v_mfma_f32_16x16x32_bf16 v[24:27], a[112:115], v[48:51], v[24:27]
 ds_read_b128 v[56:59], v70 offset:19328
 v_mfma_f32_16x16x32_bf16 v[28:31], a[116:119], v[48:51], v[28:31]
 v_mfma_f32_16x16x32_bf16 v[32:35], v[48:51], a[120:123], v[32:35]
 v_mfma_f32_16x16x32_bf16 v[36:39], v[48:51], a[124:127], v[36:39]
 v_mfma_f32_16x16x32_bf16 v[40:43], a[128:131], v[48:51], v[40:43]
 v_mfma_f32_16x16x32_bf16 v[44:47], a[132:135], v[48:51], v[44:47]
 s_waitcnt lgkmcnt(1)
 v_mfma_f32_16x16x32_bf16 v[24:27], a[136:139], v[52:55], v[24:27]
 ds_read_b128 v[48:51], v71 offset:19328
 v_mfma_f32_16x16x32_bf16 v[28:31], a[140:143], v[52:55], v[28:31]
 v_mfma_f32_16x16x32_bf16 v[32:35], v[52:55], a[144:147], v[32:35]
 v_mfma_f32_16x16x32_bf16 v[36:39], v[52:55], a[148:151], v[36:39]
 v_mfma_f32_16x16x32_bf16 v[40:43], a[152:155], v[52:55], v[40:43]
 v_mfma_f32_16x16x32_bf16 v[44:47], a[156:159], v[52:55], v[44:47]
 s_waitcnt vmcnt(0)
 v_cmp_gt_u32 vcc, s74, v75
 s_waitcnt lgkmcnt(1)
 v_mfma_f32_16x16x32_bf16 v[24:27], a[160:163], v[56:59], v[24:27]
 ds_read_b128 v[52:55], v70 offset:19456
 v_cmp_gt_u32 s[66:67], s75, v75
 v_mfma_f32_16x16x32_bf16 v[28:31], a[164:167], v[56:59], v[28:31]
 v_mfma_f32_16x16x32_bf16 v[32:35], v[56:59], a[168:171], v[32:35]
 v_mfma_f32_16x16x32_bf16 v[36:39], v[56:59], a[172:175], v[36:39]
 s_cmp_eq_u32 vcc_lo, 0
 s_cselect_b32 s72, s84, 0
 s_cmp_eq_u32 s67, 0
 s_cselect_b32 s72, 2, s72
 v_mfma_f32_16x16x32_bf16 v[40:43], a[176:179], v[56:59], v[40:43]
 v_mov_b32 v76, s72
 v_mfma_f32_16x16x32_bf16 v[44:47], a[180:183], v[56:59], v[44:47]
 ds_write_b32 v72, v76 offset:4
 s_waitcnt lgkmcnt(2)
 v_mfma_f32_16x16x32_bf16 v[24:27], a[184:187], v[48:51], v[24:27]
 ds_read_b128 v[56:59], v71 offset:19456
 v_mfma_f32_16x16x32_bf16 v[28:31], a[188:191], v[48:51], v[28:31]
 v_mfma_f32_16x16x32_bf16 v[32:35], v[48:51], a[192:195], v[32:35]
 v_mfma_f32_16x16x32_bf16 v[36:39], v[48:51], a[196:199], v[36:39]
 v_mfma_f32_16x16x32_bf16 v[40:43], a[200:203], v[48:51], v[40:43]
 v_mfma_f32_16x16x32_bf16 v[44:47], a[204:207], v[48:51], v[44:47]
 s_waitcnt lgkmcnt(1)
L_q_fe:
 s_barrier
 ds_read_b32 v76, v73 offset:4
 s_waitcnt lgkmcnt(2)
 v_mfma_f32_16x16x32_bf16 v[24:27], a[208:211], v[52:55], v[24:27]
 v_add_u32 v70, s5, v70
 v_add_u32 v71, s5, v71
 ds_read_b128 v[48:51], v70 offset:0
 v_mfma_f32_16x16x32_bf16 v[28:31], a[212:215], v[52:55], v[28:31]
 v_mfma_f32_16x16x32_bf16 v[32:35], v[52:55], a[216:219], v[32:35]
 v_mfma_f32_16x16x32_bf16 v[36:39], v[52:55], a[220:223], v[36:39]
 v_mfma_f32_16x16x32_bf16 v[40:43], a[224:227], v[52:55], v[40:43]
 v_mfma_f32_16x16x32_bf16 v[44:47], a[228:231], v[52:55], v[44:47]
 s_waitcnt lgkmcnt(2)
 v_mfma_f32_16x16x32_bf16 v[24:27], a[232:235], v[56:59], v[24:27]
 ds_read_b128 v[52:55], v71 offset:0
 v_mfma_f32_16x16x32_bf16 v[28:31], a[236:239], v[56:59], v[28:31]
 v_mfma_f32_16x16x32_bf16 v[32:35], v[56:59], a[240:243], v[32:35]
 s_waitcnt lgkmcnt(2)
 v_readfirstlane_b32 s72, v76
 v_mfma_f32_16x16x32_bf16 v[36:39], v[56:59], a[244:247], v[36:39]
 v_mfma_f32_16x16x32_bf16 v[40:43], a[248:251], v[56:59], v[40:43]
 v_mfma_f32_16x16x32_bf16 v[44:47], a[252:255], v[56:59], v[44:47]
 s_cmp_lg_u32 s72, 0
 s_cbranch_scc1 L_q_p0ed
 s_branch L_q_p0e
L_q_p1n:
 s_waitcnt lgkmcnt(1)
 v_mfma_f32_16x16x32_bf16 v[24:27], v[80:83], v[48:51], 0
 ds_read_b128 v[56:59], v70 offset:18560
 v_mfma_f32_16x16x32_bf16 v[28:31], v[84:87], v[48:51], 0
 v_mfma_f32_16x16x32_bf16 v[32:35], v[48:51], v[88:91], 0
 v_mfma_f32_16x16x32_bf16 v[36:39], v[48:51], v[92:95], 0
 v_mfma_f32_16x16x32_bf16 v[40:43], v[96:99], v[48:51], 0
 v_cvt_pk_bf16_f32 v0, v0, v1
 v_cvt_pk_bf16_f32 v1, v2, v3
 v_mfma_f32_16x16x32_bf16 v[44:47], v[100:103], v[48:51], 0
 v_cvt_pk_bf16_f32 v2, v4, v5
 s_waitcnt lgkmcnt(1)
 v_mfma_f32_16x16x32_bf16 v[24:27], v[104:107], v[52:55], v[24:27]
 ds_read_b128 v[48:51], v71 offset:18560
 v_cvt_pk_bf16_f32 v3, v6, v7
 v_mfma_f32_16x16x32_bf16 v[28:31], v[108:111], v[52:55], v[28:31]
 buffer_store_dwordx4 v[0:3], v73, s[8:11], s78 offen offset:0 sc1
 v_mfma_f32_16x16x32_bf16 v[32:35], v[52:55], v[112:115], v[32:35]
 v_cvt_pk_bf16_f32 v60, v8, v9
 v_cvt_pk_bf16_f32 v61, v10, v11
 v_mfma_f32_16x16x32_bf16 v[36:39], v[52:55], v[116:119], v[36:39]
 v_cvt_pk_bf16_f32 v62, v12, v13
 v_cvt_pk_bf16_f32 v63, v14, v15
 v_mfma_f32_16x16x32_bf16 v[40:43], v[120:123], v[52:55], v[40:43]
 v_cvt_pk_bf16_f32 v16, v16, v17
 v_cvt_pk_bf16_f32 v17, v18, v19
 v_mfma_f32_16x16x32_bf16 v[44:47], v[124:127], v[52:55], v[44:47]
 v_cvt_pk_bf16_f32 v18, v20, v21
 s_waitcnt lgkmcnt(1)
 v_mfma_f32_16x16x32_bf16 v[24:27], v[128:131], v[56:59], v[24:27]
 ds_read_b128 v[52:55], v70 offset:18688
 v_cvt_pk_bf16_f32 v19, v22, v23
 v_mfma_f32_16x16x32_bf16 v[28:31], v[132:135], v[56:59], v[28:31]
 v_mfma_f32_16x16x32_bf16 v[32:35], v[56:59], v[136:139], v[32:35]
 v_mfma_f32_16x16x32_bf16 v[36:39], v[56:59], v[140:143], v[36:39]
 buffer_store_dwordx4 v[16:19], v73, s[8:11], s77 offen offset:0 sc1
 v_mfma_f32_16x16x32_bf16 v[40:43], v[144:147], v[56:59], v[40:43]
 v_mfma_f32_16x16x32_bf16 v[44:47], v[148:151], v[56:59], v[44:47]
 s_waitcnt lgkmcnt(1)
 v_mfma_f32_16x16x32_bf16 v[24:27], v[152:155], v[48:51], v[24:27]
 ds_read_b128 v[56:59], v71 offset:18688
 v_mfma_f32_16x16x32_bf16 v[28:31], v[156:159], v[48:51], v[28:31]
 v_mfma_f32_16x16x32_bf16 v[32:35], v[48:51], v[160:163], v[32:35]
 v_mfma_f32_16x16x32_bf16 v[36:39], v[48:51], v[164:167], v[36:39]
 v_mfma_f32_16x16x32_bf16 v[40:43], v[168:171], v[48:51], v[40:43]
 v_mfma_f32_16x16x32_bf16 v[44:47], v[172:175], v[48:51], v[44:47]
 s_waitcnt lgkmcnt(1)
 v_mfma_f32_16x16x32_bf16 v[24:27], v[176:179], v[52:55], v[24:27]
 ds_read_b128 v[48:51], v70 offset:18816
 v_mfma_f32_16x16x32_bf16 v[28:31], v[180:183], v[52:55], v[28:31]
 v_mfma_f32_16x16x32_bf16 v[32:35], v[52:55], v[184:187], v[32:35]
 v_mfma_f32_16x16x32_bf16 v[36:39], v[52:55], v[188:191], v[36:39]
 v_mfma_f32_16x16x32_bf16 v[40:43], v[192:195], v[52:55], v[40:43]
 v_mfma_f32_16x16x32_bf16 v[44:47], v[196:199], v[52:55], v[44:47]
 s_waitcnt lgkmcnt(1)
 v_mfma_f32_16x16x32_bf16 v[24:27], v[200:203], v[56:59], v[24:27]
 ds_read_b128 v[52:55], v71 offset:18816
 v_mfma_f32_16x16x32_bf16 v[28:31], v[204:207], v[56:59], v[28:31]
 v_mfma_f32_16x16x32_bf16 v[32:35], v[56:59], v[208:211], v[32:35]
 v_mfma_f32_16x16x32_bf16 v[36:39], v[56:59], v[212:215], v[36:39]
 v_mfma_f32_16x16x32_bf16 v[40:43], v[216:219], v[56:59], v[40:43]
 v_mfma_f32_16x16x32_bf16 v[44:47], v[220:223], v[56:59], v[44:47]
 s_waitcnt lgkmcnt(1)
 v_mfma_f32_16x16x32_bf16 v[24:27], v[224:227], v[48:51], v[24:27]
 ds_read_b128 v[56:59], v70 offset:18944
 v_mfma_f32_16x16x32_bf16 v[28:31], v[228:231], v[48:51], v[28:31]
 v_mfma_f32_16x16x32_bf16 v[32:35], v[48:51], v[232:235], v[32:35]
 v_mfma_f32_16x16x32_bf16 v[36:39], v[48:51], v[236:239], v[36:39]
 v_mfma_f32_16x16x32_bf16 v[40:43], v[240:243], v[48:51], v[40:43]
 v_mfma_f32_16x16x32_bf16 v[44:47], v[244:247], v[48:51], v[44:47]
 s_waitcnt lgkmcnt(1)
 v_mfma_f32_16x16x32_bf16 v[24:27], v[248:251], v[52:55], v[24:27]
 ds_read_b128 v[48:51], v71 offset:18944
 v_mfma_f32_16x16x32_bf16 v[28:31], v[252:255], v[52:55], v[28:31]
 v_mfma_f32_16x16x32_bf16 v[32:35], v[52:55], a[0:3], v[32:35]
 buffer_load_dword v75, v74, s[8:11], 0 offen sc1
 v_mfma_f32_16x16x32_bf16 v[36:39], v[52:55], a[4:7], v[36:39]
 v_mfma_f32_16x16x32_bf16 v[40:43], a[8:11], v[52:55], v[40:43]
 v_mfma_f32_16x16x32_bf16 v[44:47], a[12:15], v[52:55], v[44:47]
 s_waitcnt lgkmcnt(1)
 v_mfma_f32_16x16x32_bf16 v[24:27], a[16:19], v[56:59], v[24:27]
 ds_read_b128 v[52:55], v70 offset:19072
 v_mfma_f32_16x16x32_bf16 v[28:31], a[20:23], v[56:59], v[28:31]
 v_mfma_f32_16x16x32_bf16 v[32:35], v[56:59], a[24:27], v[32:35]
 v_mfma_f32_16x16x32_bf16 v[36:39], v[56:59], a[28:31], v[36:39]
 v_mfma_f32_16x16x32_bf16 v[40:43], a[32:35], v[56:59], v[40:43]
 v_mfma_f32_16x16x32_bf16 v[44:47], a[36:39], v[56:59], v[44:47]
 s_waitcnt lgkmcnt(1)
 v_mfma_f32_16x16x32_bf16 v[24:27], a[40:43], v[48:51], v[24:27]
 ds_read_b128 v[56:59], v71 offset:19072
 v_mfma_f32_16x16x32_bf16 v[28:31], a[44:47], v[48:51], v[28:31]
 v_mfma_f32_16x16x32_bf16 v[32:35], v[48:51], a[48:51], v[32:35]
 v_mfma_f32_16x16x32_bf16 v[36:39], v[48:51], a[52:55], v[36:39]
 v_mfma_f32_16x16x32_bf16 v[40:43], a[56:59], v[48:51], v[40:43]
 v_mfma_f32_16x16x32_bf16 v[44:47], a[60:63], v[48:51], v[44:47]
 s_waitcnt lgkmcnt(1)
 v_mfma_f32_16x16x32_bf16 v[24:27], a[64:67], v[52:55], v[24:27]
 ds_read_b128 v[48:51], v70 offset:19200
 v_mfma_f32_16x16x32_bf16 v[28:31], a[68:71], v[52:55], v[28:31]
 v_mfma_f32_16x16x32_bf16 v[32:35], v[52:55], a[72:75], v[32:35]
 v_mfma_f32_16x16x32_bf16 v[36:39], v[52:55], a[76:79], v[36:39]
 v_mfma_f32_16x16x32_bf16 v[40:43], a[80:83], v[52:55], v[40:43]
 v_mfma_f32_16x16x32_bf16 v[44:47], a[84:87], v[52:55], v[44:47]
 s_waitcnt lgkmcnt(1)
 v_mfma_f32_16x16x32_bf16 v[24:27], a[88:91], v[56:59], v[24:27]
 ds_read_b128 v[52:55], v71 offset:19200
 v_mfma_f32_16x16x32_bf16 v[28:31], a[92:95], v[56:59], v[28:31]
 v_mfma_f32_16x16x32_bf16 v[32:35], v[56:59], a[96:99], v[32:35]
 v_mfma_f32_16x16x32_bf16 v[36:39], v[56:59], a[100:103], v[36:39]
 v_mfma_f32_16x16x32_bf16 v[40:43], a[104:107], v[56:59], v[40:43]
 v_mfma_f32_16x16x32_bf16 v[44:47], a[108:111], v[56:59], v[44:47]
 s_waitcnt lgkmcnt(1)
 v_mfma_f32_16x16x32_bf16 v[24:27], a[112:115], v[48:51], v[24:27]
 ds_read_b128 v[56:59], v70 offset:19328
 v_mfma_f32_16x16x32_bf16 v[28:31], a[116:119], v[48:51], v[28:31]
 v_mfma_f32_16x16x32_bf16 v[32:35], v[48:51], a[120:123], v[32:35]
 v_mfma_f32_16x16x32_bf16 v[36:39], v[48:51], a[124:127], v[36:39]
 v_mfma_f32_16x16x32_bf16 v[40:43], a[128:131], v[48:51], v[40:43]
 v_mfma_f32_16x16x32_bf16 v[44:47], a[132:135], v[48:51], v[44:47]
 s_waitcnt lgkmcnt(1)
 v_mfma_f32_16x16x32_bf16 v[24:27], a[136:139], v[52:55], v[24:27]
 ds_read_b128 v[48:51], v71 offset:19328
 v_mfma_f32_16x16x32_bf16 v[28:31], a[140:143], v[52:55], v[28:31]
 v_mfma_f32_16x16x32_bf16 v[32:35], v[52:55], a[144:147], v[32:35]
 v_mfma_f32_16x16x32_bf16 v[36:39], v[52:55], a[148:151], v[36:39]
 v_mfma_f32_16x16x32_bf16 v[40:43], a[152:155], v[52:55], v[40:43]
 v_mfma_f32_16x16x32_bf16 v[44:47], a[156:159], v[52:55], v[44:47]
 s_waitcnt vmcnt(0)
 v_cmp_gt_u32 vcc, s74, v75
 s_waitcnt lgkmcnt(1)
 v_mfma_f32_16x16x32_bf16 v[24:27], a[160:163], v[56:59], v[24:27]
 ds_read_b128 v[52:55], v70 offset:19456
 v_cmp_gt_u32 s[66:67], s75, v75
 v_mfma_f32_16x16x32_bf16 v[28:31], a[164:167], v[56:59], v[28:31]
 v_mfma_f32_16x16x32_bf16 v[32:35], v[56:59], a[168:171], v[32:35]
 v_mfma_f32_16x16x32_bf16 v[36:39], v[56:59], a[172:175], v[36:39]
 s_cmp_eq_u32 vcc_lo, 0
 s_cselect_b32 s72, s84, 0
 s_cmp_eq_u32 s67, 0
 s_cselect_b32 s72, 2, s72
 v_mfma_f32_16x16x32_bf16 v[40:43], a[176:179], v[56:59], v[40:43]
 v_mov_b32 v76, s72
 v_mfma_f32_16x16x32_bf16 v[44:47], a[180:183], v[56:59], v[44:47]
 ds_write_b32 v72, v76 offset:4
 s_waitcnt lgkmcnt(2)
 v_mfma_f32_16x16x32_bf16 v[24:27], a[184:187], v[48:51], v[24:27]
 ds_read_b128 v[56:59], v71 offset:19456
 v_mfma_f32_16x16x32_bf16 v[28:31], a[188:191], v[48:51], v[28:31]
 v_mfma_f32_16x16x32_bf16 v[32:35], v[48:51], a[192:195], v[32:35]
 v_mfma_f32_16x16x32_bf16 v[36:39], v[48:51], a[196:199], v[36:39]
 v_mfma_f32_16x16x32_bf16 v[40:43], a[200:203], v[48:51], v[40:43]
 v_mfma_f32_16x16x32_bf16 v[44:47], a[204:207], v[48:51], v[44:47]
 s_waitcnt lgkmcnt(1)
 s_barrier
 ds_read_b32 v76, v73 offset:4
 s_waitcnt lgkmcnt(2)
 v_mfma_f32_16x16x32_bf16 v[24:27], a[208:211], v[52:55], v[24:27]
 v_mfma_f32_16x16x32_bf16 v[28:31], a[212:215], v[52:55], v[28:31]
 v_mfma_f32_16x16x32_bf16 v[32:35], v[52:55], a[216:219], v[32:35]
 v_mfma_f32_16x16x32_bf16 v[36:39], v[52:55], a[220:223], v[36:39]
 v_mfma_f32_16x16x32_bf16 v[40:43], a[224:227], v[52:55], v[40:43]
 v_mfma_f32_16x16x32_bf16 v[44:47], a[228:231], v[52:55], v[44:47]
 s_waitcnt lgkmcnt(1)
 v_mfma_f32_16x16x32_bf16 v[24:27], a[232:235], v[56:59], v[24:27]
 v_mfma_f32_16x16x32_bf16 v[28:31], a[236:239], v[56:59], v[28:31]
 v_mfma_f32_16x16x32_bf16 v[32:35], v[56:59], a[240:243], v[32:35]
 s_waitcnt lgkmcnt(0)
 v_readfirstlane_b32 s72, v76
 v_mfma_f32_16x16x32_bf16 v[36:39], v[56:59], a[244:247], v[36:39]
 v_mfma_f32_16x16x32_bf16 v[40:43], a[248:251], v[56:59], v[40:43]
 v_mfma_f32_16x16x32_bf16 v[44:47], a[252:255], v[56:59], v[44:47]
 s_cmp_lg_u32 s72, 0
 s_cbranch_scc0 L_q_t2
 s_sub_u32 s68, s72, 1
 s_cmp_eq_u32 s68, 0
 s_cselect_b32 s69, s74, s75
 s_cselect_b32 s63, 2, 0
 s_cselect_b32 s64, 0, 2
 s_add_u32 s74, s74, s63
 s_add_u32 s75, s75, s64
 s_add_u32 s63, s75, 8
 s_cmp_lt_u32 s74, s63
 s_cselect_b32 s84, 1, s68
 s_cmp_lt_u32 s75, 3
 s_cselect_b32 s84, 1, s84
 s_mul_i32 s73, s69, 36864
 s_mul_i32 s63, s68, 2359296
 s_add_u32 s73, s73, s63
 s_add_u32 s73, s73, s90
 s_mov_b32 m0, s70
 s_nop 0
 buffer_load_dwordx4 v72, s[8:11], s73 offen sc1 lds
 s_add_u32 m0, m0, s3
 s_add_u32 s73, s73, s3
 buffer_load_dwordx4 v72, s[8:11], s73 offen sc1 lds
 s_add_u32 m0, m0, s3
 s_add_u32 s73, s73, s3
 buffer_load_dwordx4 v72, s[8:11], s73 offen sc1 lds
 s_add_u32 m0, m0, s3
 s_add_u32 s73, s73, s3
 buffer_load_dwordx4 v72, s[8:11], s73 offen sc1 lds
 s_add_u32 m0, m0, s3
 s_add_u32 s73, s73, s3
 buffer_load_dwordx4 v72, s[8:11], s73 offen sc1 lds
 s_add_u32 m0, m0, s3
 s_add_u32 s73, s73, s3
 buffer_load_dwordx4 v72, s[8:11], s73 offen sc1 lds
 s_add_u32 m0, m0, s3
 s_add_u32 s73, s73, s3
 buffer_load_dwordx4 v72, s[8:11], s73 offen sc1 lds
 s_add_u32 m0, m0, s3
 s_add_u32 s73, s73, s3
 buffer_load_dwordx4 v72, s[8:11], s73 offen sc1 lds
 s_add_u32 m0, m0, s3
 s_add_u32 s73, s73, s3
 buffer_load_dwordx4 v72, s[8:11], s73 offen sc1 lds
 s_nop 7
 v_cvt_pk_bf16_f32 v24, v24, v25
 v_cvt_pk_bf16_f32 v25, v26, v27
 v_cvt_pk_bf16_f32 v26, v28, v29
 v_cvt_pk_bf16_f32 v27, v30, v31
 buffer_store_dwordx4 v[24:27], v73, s[8:11], s78 offen offset:1024 sc1
 v_cvt_pk_bf16_f32 v35, v34, v35
 v_cvt_pk_bf16_f32 v34, v32, v33
 v_mov_b64 v[32:33], v[60:61]
 buffer_store_dwordx4 v[32:35], v73, s[8:11], s79 offen offset:0 sc1
 v_cvt_pk_bf16_f32 v39, v38, v39
 v_cvt_pk_bf16_f32 v38, v36, v37
 v_mov_b64 v[36:37], v[62:63]
 buffer_store_dwordx4 v[36:39], v73, s[8:11], s79 offen offset:1024 sc1
 v_cvt_pk_bf16_f32 v40, v40, v41
 v_cvt_pk_bf16_f32 v41, v42, v43
 v_cvt_pk_bf16_f32 v42, v44, v45
 v_cvt_pk_bf16_f32 v43, v46, v47
 buffer_store_dwordx4 v[40:43], v73, s[8:11], s77 offen offset:1024 sc1
 s_mov_b32 s63, s85
 s_mov_b32 s85, s4
 s_mov_b32 s4, s5
 s_mov_b32 s5, s63
 s_add_u32 s70, s70, s85
 s_mov_b32 s81, s77
 s_mov_b32 s82, s78
 s_mov_b32 s83, s79
 s_mov_b32 s94, s92
 s_mov_b32 s95, s93
 s_mov_b32 s63, s69
 s_mul_i32 s63, s63, 786432
 s_mul_i32 s64, s68, 50331648
 s_add_u32 s63, s63, s64
 s_add_u32 s77, s63, s87
 s_add_u32 s78, s63, s88
 s_add_u32 s79, s63, s89
 s_mul_i32 s92, s68, 4096
 s_add_u32 s93, s69, 1
 s_add_u32 s61, s61, 1
 v_add_u32 v70, s5, v70
 v_add_u32 v71, s5, v71
 v_cmp_gt_u32 vcc, s74, v75
 v_cmp_gt_u32 s[66:67], s75, v75
 s_cmp_eq_u32 vcc_lo, 0
 s_cselect_b32 s72, s84, 0
 s_cmp_eq_u32 s67, 0
 s_cselect_b32 s72, 2, s72
 v_mov_b32 v76, s72
 ds_write_b32 v72, v76 offset:12
 s_waitcnt vmcnt(8) lgkmcnt(0)
 s_barrier
 ds_read_b32 v76, v73 offset:12
 ds_read_b128 v[48:51], v70 offset:0
 ds_read_b128 v[52:55], v71 offset:0
 s_waitcnt lgkmcnt(2)
 v_readfirstlane_b32 s72, v76
 s_cmp_lg_u32 s72, 0
 s_branch L_q_slow
L_q_t2:
 s_nop 7
 v_cvt_pk_bf16_f32 v24, v24, v25
 v_cvt_pk_bf16_f32 v25, v26, v27
 v_cvt_pk_bf16_f32 v26, v28, v29
 v_cvt_pk_bf16_f32 v27, v30, v31
 buffer_store_dwordx4 v[24:27], v73, s[8:11], s78 offen offset:1024 sc1
 v_cvt_pk_bf16_f32 v35, v34, v35
 v_cvt_pk_bf16_f32 v34, v32, v33
 v_mov_b64 v[32:33], v[60:61]
 buffer_store_dwordx4 v[32:35], v73, s[8:11], s79 offen offset:0 sc1
 v_cvt_pk_bf16_f32 v39, v38, v39
 v_cvt_pk_bf16_f32 v38, v36, v37
 v_mov_b64 v[36:37], v[62:63]
 buffer_store_dwordx4 v[36:39], v73, s[8:11], s79 offen offset:1024 sc1
 v_cvt_pk_bf16_f32 v40, v40, v41
 v_cvt_pk_bf16_f32 v41, v42, v43
 v_cvt_pk_bf16_f32 v42, v44, v45
 v_cvt_pk_bf16_f32 v43, v46, v47
 buffer_store_dwordx4 v[40:43], v73, s[8:11], s77 offen offset:1024 sc1
 v_mov_b32 v76, s93
 s_waitcnt vmcnt(0)
 s_barrier
 buffer_store_dword v76, v77, s[8:11], s92 offen sc1
 s_cmp_ge_u32 s61, s91
 s_cbranch_scc1 L_q_done
 s_branch L_q_idle
L_q_done:
 s_waitcnt vmcnt(0) lgkmcnt(0)
 s_endpgm
L_up:
 s_cmp_lg_u32 s7, 0
 s_cbranch_scc1 Ld1_32
 v_mbcnt_lo_u32_b32 v1, -1, 0
 v_mbcnt_hi_u32_b32 v1, -1, v1
 s_mul_i32 s63, s60, 24
 s_add_u32 s63, s63, 32
 s_add_u32 s63, s63, s57
 s_lshl_b32 s63, s63, 2
 s_add_u32 s63, s63, s58
 s_lshl_b32 s63, s63, 10
 v_lshl_add_u32 v10, v1, 4, s63
 s_lshl_b32 s64, s58, 10
 s_mov_b32 m0, s64
 s_mov_b32 s65, 0
 buffer_load_dwordx4 v10, s[32:35], s65 offen lds
 buffer_load_dwordx4 v10, s[28:31], s65 offen lds
 s_mov_b32 s65, 524288
 buffer_load_dwordx4 v10, s[32:35], s65 offen lds
 buffer_load_dwordx4 v10, s[28:31], s65 offen lds
 s_mov_b32 s65, 1048576
 buffer_load_dwordx4 v10, s[32:35], s65 offen lds
 buffer_load_dwordx4 v10, s[28:31], s65 offen lds
 s_mov_b32 s65, 1572864
 buffer_load_dwordx4 v10, s[32:35], s65 offen lds
 buffer_load_dwordx4 v10, s[28:31], s65 offen lds
 s_cmp_lg_u32 s7, 0
 s_cbranch_scc1 Lln_33
 s_waitcnt vmcnt(11)
 v_lshlrev_b32 v52, 16, v40
 v_and_b32 v53, 0xffff0000, v40
 v_lshlrev_b32 v54, 16, v41
 v_and_b32 v55, 0xffff0000, v41
 v_lshlrev_b32 v56, 16, v42
 v_and_b32 v57, 0xffff0000, v42
 v_lshlrev_b32 v58, 16, v43
 v_and_b32 v59, 0xffff0000, v43
 v_lshlrev_b32 v60, 16, v44
 v_and_b32 v61, 0xffff0000, v44
 v_lshlrev_b32 v62, 16, v45
 v_and_b32 v63, 0xffff0000, v45
 v_lshlrev_b32 v64, 16, v46
 v_and_b32 v65, 0xffff0000, v46
 v_lshlrev_b32 v66, 16, v47
 v_and_b32 v67, 0xffff0000, v47
 v_lshlrev_b32 v68, 16, v48
 v_and_b32 v69, 0xffff0000, v48
 v_lshlrev_b32 v70, 16, v49
 v_and_b32 v71, 0xffff0000, v49
 v_lshlrev_b32 v72, 16, v50
 v_and_b32 v73, 0xffff0000, v50
 v_lshlrev_b32 v74, 16, v51
 v_and_b32 v75, 0xffff0000, v51
 v_pk_add_f32 v[20:21], v[52:53], v[54:55]
 v_pk_add_f32 v[20:21], v[20:21], v[56:57]
 v_pk_add_f32 v[20:21], v[20:21], v[58:59]
 v_pk_add_f32 v[20:21], v[20:21], v[60:61]
 v_pk_add_f32 v[20:21], v[20:21], v[62:63]
 v_pk_add_f32 v[20:21], v[20:21], v[64:65]
 v_pk_add_f32 v[20:21], v[20:21], v[66:67]
 v_pk_add_f32 v[20:21], v[20:21], v[68:69]
 v_pk_add_f32 v[20:21], v[20:21], v[70:71]
 v_pk_add_f32 v[20:21], v[20:21], v[72:73]
 v_pk_add_f32 v[20:21], v[20:21], v[74:75]
 v_add_f32 v20, v20, v21
 s_nop 1
 v_add_f32_dpp v20, v20, v20 quad_perm:[1,0,3,2] row_mask:0xf bank_mask:0xf
 s_nop 1
 v_add_f32_dpp v20, v20, v20 quad_perm:[2,3,0,1] row_mask:0xf bank_mask:0xf
 s_nop 1
 v_add_f32_dpp v20, v20, v20 row_half_mirror row_mask:0xf bank_mask:0xf
 s_nop 1
 v_add_f32_dpp v20, v20, v20 row_mirror row_mask:0xf bank_mask:0xf
 v_mov_b32 v21, v20
 s_nop 1
 v_permlane16_swap_b32 v20, v21
 v_add_f32 v20, v20, v21
 v_mul_f32 v20, v78, v20
 v_pk_add_f32 v[52:53], v[52:53], v[20:21] op_sel_hi:[1,0]
 v_pk_add_f32 v[54:55], v[54:55], v[20:21] op_sel_hi:[1,0]
 v_pk_add_f32 v[56:57], v[56:57], v[20:21] op_sel_hi:[1,0]
 v_pk_add_f32 v[58:59], v[58:59], v[20:21] op_sel_hi:[1,0]
 v_pk_add_f32 v[60:61], v[60:61], v[20:21] op_sel_hi:[1,0]
 v_pk_add_f32 v[62:63], v[62:63], v[20:21] op_sel_hi:[1,0]
 v_pk_add_f32 v[64:65], v[64:65], v[20:21] op_sel_hi:[1,0]
 v_pk_add_f32 v[66:67], v[66:67], v[20:21] op_sel_hi:[1,0]
 v_pk_add_f32 v[68:69], v[68:69], v[20:21] op_sel_hi:[1,0]
 v_pk_add_f32 v[70:71], v[70:71], v[20:21] op_sel_hi:[1,0]
 v_pk_add_f32 v[72:73], v[72:73], v[20:21] op_sel_hi:[1,0]
 v_pk_add_f32 v[74:75], v[74:75], v[20:21] op_sel_hi:[1,0]
 v_pk_mul_f32 v[22:23], v[52:53], v[52:53]
 v_pk_fma_f32 v[22:23], v[54:55], v[54:55], v[22:23]
 v_pk_fma_f32 v[22:23], v[56:57], v[56:57], v[22:23]
 v_pk_fma_f32 v[22:23], v[58:59], v[58:59], v[22:23]
 v_pk_fma_f32 v[22:23], v[60:61], v[60:61], v[22:23]
 v_pk_fma_f32 v[22:23], v[62:63], v[62:63], v[22:23]
 v_pk_fma_f32 v[22:23], v[64:65], v[64:65], v[22:23]
 v_pk_fma_f32 v[22:23], v[66:67], v[66:67], v[22:23]
 v_pk_fma_f32 v[22:23], v[68:69], v[68:69], v[22:23]
 v_pk_fma_f32 v[22:23], v[70:71], v[70:71], v[22:23]
 v_pk_fma_f32 v[22:23], v[72:73], v[72:73], v[22:23]
 v_pk_fma_f32 v[22:23], v[74:75], v[74:75], v[22:23]
 v_add_f32 v22, v22, v23
 s_nop 1
 v_add_f32_dpp v22, v22, v22 quad_perm:[1,0,3,2] row_mask:0xf bank_mask:0xf
 s_nop 1
 v_add_f32_dpp v22, v22, v22 quad_perm:[2,3,0,1] row_mask:0xf bank_mask:0xf
 s_nop 1
 v_add_f32_dpp v22, v22, v22 row_half_mirror row_mask:0xf bank_mask:0xf
 s_nop 1
 v_add_f32_dpp v22, v22, v22 row_mirror row_mask:0xf bank_mask:0xf
 v_mov_b32 v23, v22
 s_nop 1
 v_permlane16_swap_b32 v22, v23
 v_add_f32 v22, v22, v23
 v_mov_b32 v23, 0x3727c5ac
 v_fmac_f32 v23, 0x3ae38e39, v22
 v_rsq_f32 v22, v23
 v_sub_f32 v20, 0, v20
 v_mul_f32 v21, v23, v22
 v_lshrrev_b32 v76, 2, v0
 v_and_b32 v78, 31, v0
 v_cmp_eq_u32 vcc, 0, v78
 v_mov_b32 v78, 2147483632
 s_lshl_b32 s63, s2, 6
 v_cndmask_b32 v76, v78, v76, vcc
 s_add_u32 s63, s63, 12582912
 buffer_store_dwordx2 v[20:21], v76, s[8:11], s63 offen sc1
 s_add_u32 s63, s3, 3145728
 v_pk_mul_f32 v[52:53], v[52:53], v[22:23] op_sel_hi:[1,0]
 v_pk_mul_f32 v[54:55], v[54:55], v[22:23] op_sel_hi:[1,0]
 v_pk_mul_f32 v[56:57], v[56:57], v[22:23] op_sel_hi:[1,0]
 v_pk_mul_f32 v[58:59], v[58:59], v[22:23] op_sel_hi:[1,0]
 v_pk_mul_f32 v[60:61], v[60:61], v[22:23] op_sel_hi:[1,0]
 v_pk_mul_f32 v[62:63], v[62:63], v[22:23] op_sel_hi:[1,0]
 v_pk_mul_f32 v[64:65], v[64:65], v[22:23] op_sel_hi:[1,0]
 v_pk_mul_f32 v[66:67], v[66:67], v[22:23] op_sel_hi:[1,0]
 v_pk_mul_f32 v[68:69], v[68:69], v[22:23] op_sel_hi:[1,0]
 v_pk_mul_f32 v[70:71], v[70:71], v[22:23] op_sel_hi:[1,0]
 v_pk_mul_f32 v[72:73], v[72:73], v[22:23] op_sel_hi:[1,0]
 v_pk_mul_f32 v[74:75], v[74:75], v[22:23] op_sel_hi:[1,0]
 v_cvt_pk_bf16_f32 v40, v52, v53
 v_cvt_pk_bf16_f32 v41, v54, v55
 v_cvt_pk_bf16_f32 v42, v56, v57
 v_cvt_pk_bf16_f32 v43, v58, v59
 v_cvt_pk_bf16_f32 v44, v60, v61
 v_cvt_pk_bf16_f32 v45, v62, v63
 v_cvt_pk_bf16_f32 v46, v64, v65
 v_cvt_pk_bf16_f32 v47, v66, v67
 v_cvt_pk_bf16_f32 v48, v68, v69
 v_cvt_pk_bf16_f32 v49, v70, v71
 v_cvt_pk_bf16_f32 v50, v72, v73
 v_cvt_pk_bf16_f32 v51, v74, v75
 buffer_store_dwordx4 v[40:43], v77, s[8:11], s63 offen offset:0 sc1
 buffer_store_dwordx4 v[44:47], v77, s[8:11], s63 offen offset:384 sc1
 buffer_store_dwordx4 v[48:51], v77, s[8:11], s63 offen offset:768 sc1
Lln_33:
 s_mov_b32 s65, 2097152
 buffer_load_dwordx4 v10, s[32:35], s65 offen lds
 buffer_load_dwordx4 v10, s[28:31], s65 offen lds
 s_mov_b32 s65, 2621440
 buffer_load_dwordx4 v10, s[32:35], s65 offen lds
 buffer_load_dwordx4 v10, s[28:31], s65 offen lds
 s_mov_b32 s65, 3145728
 buffer_load_dwordx4 v10, s[32:35], s65 offen lds
 buffer_load_dwordx4 v10, s[28:31], s65 offen lds
 s_waitcnt vmcnt(6)
 s_cmp_lg_u32 s7, 0
 s_cbranch_scc1 Lar_34
 s_or_b32 s63, s6, 0x80
 v_mov_b32 v20, s63
 s_barrier
 buffer_store_byte v20, v79, s[20:23], 0 offen sc1
Lar_34:
 s_mov_b32 s65, 3670016
 buffer_load_dwordx4 v10, s[32:35], s65 offen lds
 buffer_load_dwordx4 v10, s[28:31], s65 offen lds
 s_mov_b32 s65, 4194304
 buffer_load_dwordx4 v10, s[32:35], s65 offen lds
 buffer_load_dwordx4 v10, s[28:31], s65 offen lds
 s_mov_b32 s65, 0
 buffer_load_dwordx4 v10, s[36:39], s65 offen lds
 buffer_load_dwordx4 v10, s[40:43], s65 offen lds
 s_mov_b32 s65, 524288
 buffer_load_dwordx4 v10, s[36:39], s65 offen lds
 buffer_load_dwordx4 v10, s[40:43], s65 offen lds
 s_mov_b32 s65, 1048576
 buffer_load_dwordx4 v10, s[36:39], s65 offen lds
 buffer_load_dwordx4 v10, s[40:43], s65 offen lds
 s_mov_b32 s65, 1572864
 buffer_load_dwordx4 v10, s[36:39], s65 offen lds
 buffer_load_dwordx4 v10, s[40:43], s65 offen lds
 s_mov_b32 s65, 2097152
 buffer_load_dwordx4 v10, s[36:39], s65 offen lds
 buffer_load_dwordx4 v10, s[40:43], s65 offen lds
 s_mov_b32 s65, 2621440
 buffer_load_dwordx4 v10, s[36:39], s65 offen lds
 buffer_load_dwordx4 v10, s[40:43], s65 offen lds
 s_mov_b32 s65, 3145728
 buffer_load_dwordx4 v10, s[36:39], s65 offen lds
 buffer_load_dwordx4 v10, s[40:43], s65 offen lds
 s_mov_b32 s65, 3670016
 buffer_load_dwordx4 v10, s[36:39], s65 offen lds
 buffer_load_dwordx4 v10, s[40:43], s65 offen lds
 s_mov_b32 s65, 4194304
 buffer_load_dwordx4 v10, s[36:39], s65 offen lds
 buffer_load_dwordx4 v10, s[40:43], s65 offen lds
 s_waitcnt vmcnt(0)
 s_mov_b32 s7, 2
 s_barrier
Ld1_32:
 v_mbcnt_lo_u32_b32 v1, -1, 0
 v_mbcnt_hi_u32_b32 v1, -1, v1
 v_add_u32 v2, 0, v1
 v_mul_u32_u24 v3, 10923, v2
 v_lshrrev_b32 v3, 16, v3
 v_mul_u32_u24 v4, 6, v3
 v_sub_u32 v4, v2, v4
 v_mul_u32_u24 v3, 9216, v3
 v_lshl_add_u32 v10, v4, 4, v3
 v_add_u32 v2, 64, v1
 v_mul_u32_u24 v3, 10923, v2
 v_lshrrev_b32 v3, 16, v3
 v_mul_u32_u24 v4, 6, v3
 v_sub_u32 v4, v2, v4
 v_mul_u32_u24 v3, 9216, v3
 v_lshl_add_u32 v11, v4, 4, v3
 v_add_u32 v2, 128, v1
 v_mul_u32_u24 v3, 10923, v2
 v_lshrrev_b32 v3, 16, v3
 v_mul_u32_u24 v4, 6, v3
 v_sub_u32 v4, v2, v4
 v_mul_u32_u24 v3, 9216, v3
 v_lshl_add_u32 v12, v4, 4, v3
 v_lshrrev_b32 v2, 4, v1
 v_bfe_u32 v3, v1, 2, 2
 v_lshl_add_u32 v2, v2, 3, v3
 v_mul_u32_u24 v2, 96, v2
 v_and_b32 v3, 1, v1
 v_lshl_add_u32 v2, v3, 4, v2
 v_bfe_u32 v3, v1, 1, 1
 v_lshl_add_u32 v2, v3, 3, v2
 s_mul_i32 s67, s58, 36864
 v_add_u32 v13, s67, v2
 s_mul_i32 s65, s57, 384
 s_mul_i32 s63, s58, 96
 s_add_u32 s65, s65, s63
 s_cmp_lg_u32 s7, 0
 s_cbranch_scc1 Lln_35
 s_waitcnt vmcnt(3)
 v_lshlrev_b32 v52, 16, v40
 v_and_b32 v53, 0xffff0000, v40
 v_lshlrev_b32 v54, 16, v41
 v_and_b32 v55, 0xffff0000, v41
 v_lshlrev_b32 v56, 16, v42
 v_and_b32 v57, 0xffff0000, v42
 v_lshlrev_b32 v58, 16, v43
 v_and_b32 v59, 0xffff0000, v43
 v_lshlrev_b32 v60, 16, v44
 v_and_b32 v61, 0xffff0000, v44
 v_lshlrev_b32 v62, 16, v45
 v_and_b32 v63, 0xffff0000, v45
 v_lshlrev_b32 v64, 16, v46
 v_and_b32 v65, 0xffff0000, v46
 v_lshlrev_b32 v66, 16, v47
 v_and_b32 v67, 0xffff0000, v47
 v_lshlrev_b32 v68, 16, v48
 v_and_b32 v69, 0xffff0000, v48
 v_lshlrev_b32 v70, 16, v49
 v_and_b32 v71, 0xffff0000, v49
 v_lshlrev_b32 v72, 16, v50
 v_and_b32 v73, 0xffff0000, v50
 v_lshlrev_b32 v74, 16, v51
 v_and_b32 v75, 0xffff0000, v51
 v_pk_add_f32 v[20:21], v[52:53], v[54:55]
 v_pk_add_f32 v[20:21], v[20:21], v[56:57]
 v_pk_add_f32 v[20:21], v[20:21], v[58:59]
 v_pk_add_f32 v[20:21], v[20:21], v[60:61]
 v_pk_add_f32 v[20:21], v[20:21], v[62:63]
 v_pk_add_f32 v[20:21], v[20:21], v[64:65]
 v_pk_add_f32 v[20:21], v[20:21], v[66:67]
 v_pk_add_f32 v[20:21], v[20:21], v[68:69]
 v_pk_add_f32 v[20:21], v[20:21], v[70:71]
 v_pk_add_f32 v[20:21], v[20:21], v[72:73]
 v_pk_add_f32 v[20:21], v[20:21], v[74:75]
 v_add_f32 v20, v20, v21
 s_nop 1
 v_add_f32_dpp v20, v20, v20 quad_perm:[1,0,3,2] row_mask:0xf bank_mask:0xf
 s_nop 1
 v_add_f32_dpp v20, v20, v20 quad_perm:[2,3,0,1] row_mask:0xf bank_mask:0xf
 s_nop 1
 v_add_f32_dpp v20, v20, v20 row_half_mirror row_mask:0xf bank_mask:0xf
 s_nop 1
 v_add_f32_dpp v20, v20, v20 row_mirror row_mask:0xf bank_mask:0xf
 v_mov_b32 v21, v20
 s_nop 1
 v_permlane16_swap_b32 v20, v21
 v_add_f32 v20, v20, v21
 v_mul_f32 v20, v78, v20
 v_pk_add_f32 v[52:53], v[52:53], v[20:21] op_sel_hi:[1,0]
 v_pk_add_f32 v[54:55], v[54:55], v[20:21] op_sel_hi:[1,0]
 v_pk_add_f32 v[56:57], v[56:57], v[20:21] op_sel_hi:[1,0]
 v_pk_add_f32 v[58:59], v[58:59], v[20:21] op_sel_hi:[1,0]
 v_pk_add_f32 v[60:61], v[60:61], v[20:21] op_sel_hi:[1,0]
 v_pk_add_f32 v[62:63], v[62:63], v[20:21] op_sel_hi:[1,0]
 v_pk_add_f32 v[64:65], v[64:65], v[20:21] op_sel_hi:[1,0]
 v_pk_add_f32 v[66:67], v[66:67], v[20:21] op_sel_hi:[1,0]
 v_pk_add_f32 v[68:69], v[68:69], v[20:21] op_sel_hi:[1,0]
 v_pk_add_f32 v[70:71], v[70:71], v[20:21] op_sel_hi:[1,0]
 v_pk_add_f32 v[72:73], v[72:73], v[20:21] op_sel_hi:[1,0]
 v_pk_add_f32 v[74:75], v[74:75], v[20:21] op_sel_hi:[1,0]
 v_pk_mul_f32 v[22:23], v[52:53], v[52:53]
 v_pk_fma_f32 v[22:23], v[54:55], v[54:55], v[22:23]
 v_pk_fma_f32 v[22:23], v[56:57], v[56:57], v[22:23]
 v_pk_fma_f32 v[22:23], v[58:59], v[58:59], v[22:23]
 v_pk_fma_f32 v[22:23], v[60:61], v[60:61], v[22:23]
 v_pk_fma_f32 v[22:23], v[62:63], v[62:63], v[22:23]
 v_pk_fma_f32 v[22:23], v[64:65], v[64:65], v[22:23]
 v_pk_fma_f32 v[22:23], v[66:67], v[66:67], v[22:23]
 v_pk_fma_f32 v[22:23], v[68:69], v[68:69], v[22:23]
 v_pk_fma_f32 v[22:23], v[70:71], v[70:71], v[22:23]
 v_pk_fma_f32 v[22:23], v[72:73], v[72:73], v[22:23]
 v_pk_fma_f32 v[22:23], v[74:75], v[74:75], v[22:23]
 v_add_f32 v22, v22, v23
 s_nop 1
 v_add_f32_dpp v22, v22, v22 quad_perm:[1,0,3,2] row_mask:0xf bank_mask:0xf
 s_nop 1
 v_add_f32_dpp v22, v22, v22 quad_perm:[2,3,0,1] row_mask:0xf bank_mask:0xf
 s_nop 1
 v_add_f32_dpp v22, v22, v22 row_half_mirror row_mask:0xf bank_mask:0xf
 s_nop 1
 v_add_f32_dpp v22, v22, v22 row_mirror row_mask:0xf bank_mask:0xf
 v_mov_b32 v23, v22
 s_nop 1
 v_permlane16_swap_b32 v22, v23
 v_add_f32 v22, v22, v23
 v_mov_b32 v23, 0x3727c5ac
 v_fmac_f32 v23, 0x3ae38e39, v22
 v_rsq_f32 v22, v23
 v_sub_f32 v20, 0, v20
 v_mul_f32 v21, v23, v22
 v_lshrrev_b32 v76, 2, v0
 v_and_b32 v78, 31, v0
 v_cmp_eq_u32 vcc, 0, v78
 v_mov_b32 v78, 2147483632
 s_lshl_b32 s63, s2, 6
 v_cndmask_b32 v76, v78, v76, vcc
 s_add_u32 s63, s63, 12582912
 buffer_store_dwordx2 v[20:21], v76, s[8:11], s63 offen sc1
 s_add_u32 s63, s3, 3145728
 v_pk_mul_f32 v[52:53], v[52:53], v[22:23] op_sel_hi:[1,0]
 v_pk_mul_f32 v[54:55], v[54:55], v[22:23] op_sel_hi:[1,0]
 v_pk_mul_f32 v[56:57], v[56:57], v[22:23] op_sel_hi:[1,0]
 v_pk_mul_f32 v[58:59], v[58:59], v[22:23] op_sel_hi:[1,0]
 v_pk_mul_f32 v[60:61], v[60:61], v[22:23] op_sel_hi:[1,0]
 v_pk_mul_f32 v[62:63], v[62:63], v[22:23] op_sel_hi:[1,0]
 v_pk_mul_f32 v[64:65], v[64:65], v[22:23] op_sel_hi:[1,0]
 v_pk_mul_f32 v[66:67], v[66:67], v[22:23] op_sel_hi:[1,0]
 v_pk_mul_f32 v[68:69], v[68:69], v[22:23] op_sel_hi:[1,0]
 v_pk_mul_f32 v[70:71], v[70:71], v[22:23] op_sel_hi:[1,0]
 v_pk_mul_f32 v[72:73], v[72:73], v[22:23] op_sel_hi:[1,0]
 v_pk_mul_f32 v[74:75], v[74:75], v[22:23] op_sel_hi:[1,0]
 v_cvt_pk_bf16_f32 v40, v52, v53
 v_cvt_pk_bf16_f32 v41, v54, v55
 v_cvt_pk_bf16_f32 v42, v56, v57
 v_cvt_pk_bf16_f32 v43, v58, v59
 v_cvt_pk_bf16_f32 v44, v60, v61
 v_cvt_pk_bf16_f32 v45, v62, v63
 v_cvt_pk_bf16_f32 v46, v64, v65
 v_cvt_pk_bf16_f32 v47, v66, v67
 v_cvt_pk_bf16_f32 v48, v68, v69
 v_cvt_pk_bf16_f32 v49, v70, v71
 v_cvt_pk_bf16_f32 v50, v72, v73
 v_cvt_pk_bf16_f32 v51, v74, v75
 buffer_store_dwordx4 v[40:43], v77, s[8:11], s63 offen offset:0 sc1
 buffer_store_dwordx4 v[44:47], v77, s[8:11], s63 offen offset:384 sc1
 buffer_store_dwordx4 v[48:51], v77, s[8:11], s63 offen offset:768 sc1
Lln_35:
 s_add_u32 s69, s65, 0
 s_add_u32 m0, s67, 0
 s_nop 0
 buffer_load_dwordx4 v10, s[44:47], s69 offen lds
 s_add_u32 m0, s67, 1024
 s_nop 0
 buffer_load_dwordx4 v11, s[44:47], s69 offen lds
 s_add_u32 m0, s67, 2048
 s_nop 0
 buffer_load_dwordx4 v12, s[44:47], s69 offen lds
 s_add_u32 m0, s67, 3072
 s_nop 0
 buffer_load_dwordx4 v10, s[48:51], s69 offen lds
 s_add_u32 m0, s67, 4096
 s_nop 0
 buffer_load_dwordx4 v11, s[48:51], s69 offen lds
 s_add_u32 m0, s67, 5120
 s_nop 0
 buffer_load_dwordx4 v12, s[48:51], s69 offen lds
 s_waitcnt vmcnt(6)
 s_cmp_lg_u32 s7, 0
 s_cbranch_scc1 Lar_36
 s_or_b32 s63, s6, 0x80
 v_mov_b32 v20, s63
 s_barrier
 buffer_store_byte v20, v79, s[20:23], 0 offen sc1
Lar_36:
 s_add_u32 s69, s65, 294912
 s_add_u32 m0, s67, 6144
 s_nop 0
 buffer_load_dwordx4 v10, s[44:47], s69 offen lds
 s_add_u32 m0, s67, 7168
 s_nop 0
 buffer_load_dwordx4 v11, s[44:47], s69 offen lds
 s_add_u32 m0, s67, 8192
 s_nop 0
 buffer_load_dwordx4 v12, s[44:47], s69 offen lds
 s_add_u32 m0, s67, 9216
 s_nop 0
 buffer_load_dwordx4 v10, s[48:51], s69 offen lds
 s_add_u32 m0, s67, 10240
 s_nop 0
 buffer_load_dwordx4 v11, s[48:51], s69 offen lds
 s_add_u32 m0, s67, 11264
 s_nop 0
 buffer_load_dwordx4 v12, s[48:51], s69 offen lds
 s_add_u32 s69, s65, 589824
 s_add_u32 m0, s67, 12288
 s_nop 0
 buffer_load_dwordx4 v10, s[44:47], s69 offen lds
 s_add_u32 m0, s67, 13312
 s_nop 0
 buffer_load_dwordx4 v11, s[44:47], s69 offen lds
 s_add_u32 m0, s67, 14336
 s_nop 0
 buffer_load_dwordx4 v12, s[44:47], s69 offen lds
 s_add_u32 m0, s67, 15360
 s_nop 0
 buffer_load_dwordx4 v10, s[48:51], s69 offen lds
 s_add_u32 m0, s67, 16384
 s_nop 0
 buffer_load_dwordx4 v11, s[48:51], s69 offen lds
 s_add_u32 m0, s67, 17408
 s_nop 0
 buffer_load_dwordx4 v12, s[48:51], s69 offen lds
 s_add_u32 s69, s65, 884736
 s_add_u32 m0, s67, 18432
 s_nop 0
 buffer_load_dwordx4 v10, s[44:47], s69 offen lds
 s_add_u32 m0, s67, 19456
 s_nop 0
 buffer_load_dwordx4 v11, s[44:47], s69 offen lds
 s_add_u32 m0, s67, 20480
 s_nop 0
 buffer_load_dwordx4 v12, s[44:47], s69 offen lds
 s_add_u32 m0, s67, 21504
 s_nop 0
 buffer_load_dwordx4 v10, s[48:51], s69 offen lds
 s_add_u32 m0, s67, 22528
 s_nop 0
 buffer_load_dwordx4 v11, s[48:51], s69 offen lds
 s_add_u32 m0, s67, 23552
 s_nop 0
 buffer_load_dwordx4 v12, s[48:51], s69 offen lds
 s_add_u32 s69, s65, 1179648
 s_add_u32 m0, s67, 24576
 s_nop 0
 buffer_load_dwordx4 v10, s[44:47], s69 offen lds
 s_add_u32 m0, s67, 25600
 s_nop 0
 buffer_load_dwordx4 v11, s[44:47], s69 offen lds
 s_add_u32 m0, s67, 26624
 s_nop 0
 buffer_load_dwordx4 v12, s[44:47], s69 offen lds
 s_add_u32 m0, s67, 27648
 s_nop 0
 buffer_load_dwordx4 v10, s[48:51], s69 offen lds
 s_add_u32 m0, s67, 28672
 s_nop 0
 buffer_load_dwordx4 v11, s[48:51], s69 offen lds
 s_add_u32 m0, s67, 29696
 s_nop 0
 buffer_load_dwordx4 v12, s[48:51], s69 offen lds
 s_add_u32 s69, s65, 1474560
 s_add_u32 m0, s67, 30720
 s_nop 0
 buffer_load_dwordx4 v10, s[44:47], s69 offen lds
 s_add_u32 m0, s67, 31744
 s_nop 0
 buffer_load_dwordx4 v11, s[44:47], s69 offen lds
 s_add_u32 m0, s67, 32768
 s_nop 0
 buffer_load_dwordx4 v12, s[44:47], s69 offen lds
 s_add_u32 m0, s67, 33792
 s_nop 0
 buffer_load_dwordx4 v10, s[48:51], s69 offen lds
 s_add_u32 m0, s67, 34816
 s_nop 0
 buffer_load_dwordx4 v11, s[48:51], s69 offen lds
 s_add_u32 m0, s67, 35840
 s_nop 0
 buffer_load_dwordx4 v12, s[48:51], s69 offen lds
 s_waitcnt vmcnt(30)
 ds_read_b64_tr_b16 v[80:81], v13 offset:0
 ds_read_b64_tr_b16 v[82:83], v13 offset:384
 ds_read_b64_tr_b16 v[84:85], v13 offset:3072
 ds_read_b64_tr_b16 v[86:87], v13 offset:3456
 ds_read_b64_tr_b16 v[88:89], v13 offset:32
 ds_read_b64_tr_b16 v[90:91], v13 offset:416
 ds_read_b64_tr_b16 v[92:93], v13 offset:3104
 ds_read_b64_tr_b16 v[94:95], v13 offset:3488
 ds_read_b64_tr_b16 v[96:97], v13 offset:64
 ds_read_b64_tr_b16 v[98:99], v13 offset:448
 ds_read_b64_tr_b16 v[100:101], v13 offset:3136
 ds_read_b64_tr_b16 v[102:103], v13 offset:3520
 s_waitcnt lgkmcnt(0)
 s_add_u32 s69, s65, 1769472
 s_add_u32 m0, s67, 0
 s_nop 0
 buffer_load_dwordx4 v10, s[44:47], s69 offen lds
 s_add_u32 m0, s67, 1024
 s_nop 0
 buffer_load_dwordx4 v11, s[44:47], s69 offen lds
 s_add_u32 m0, s67, 2048
 s_nop 0
 buffer_load_dwordx4 v12, s[44:47], s69 offen lds
 s_add_u32 m0, s67, 3072
 s_nop 0
 buffer_load_dwordx4 v10, s[48:51], s69 offen lds
 s_add_u32 m0, s67, 4096
 s_nop 0
 buffer_load_dwordx4 v11, s[48:51], s69 offen lds
 s_add_u32 m0, s67, 5120
 s_nop 0
 buffer_load_dwordx4 v12, s[48:51], s69 offen lds
 s_waitcnt vmcnt(30)
 ds_read_b64_tr_b16 v[104:105], v13 offset:6144
 ds_read_b64_tr_b16 v[106:107], v13 offset:6528
 ds_read_b64_tr_b16 v[108:109], v13 offset:9216
 ds_read_b64_tr_b16 v[110:111], v13 offset:9600
 ds_read_b64_tr_b16 v[112:113], v13 offset:6176
 ds_read_b64_tr_b16 v[114:115], v13 offset:6560
 ds_read_b64_tr_b16 v[116:117], v13 offset:9248
 ds_read_b64_tr_b16 v[118:119], v13 offset:9632
 ds_read_b64_tr_b16 v[120:121], v13 offset:6208
 ds_read_b64_tr_b16 v[122:123], v13 offset:6592
 ds_read_b64_tr_b16 v[124:125], v13 offset:9280
 ds_read_b64_tr_b16 v[126:127], v13 offset:9664
 s_waitcnt lgkmcnt(0)
 s_add_u32 s69, s65, 2064384
 s_add_u32 m0, s67, 6144
 s_nop 0
 buffer_load_dwordx4 v10, s[44:47], s69 offen lds
 s_add_u32 m0, s67, 7168
 s_nop 0
 buffer_load_dwordx4 v11, s[44:47], s69 offen lds
 s_add_u32 m0, s67, 8192
 s_nop 0
 buffer_load_dwordx4 v12, s[44:47], s69 offen lds
 s_add_u32 m0, s67, 9216
 s_nop 0
 buffer_load_dwordx4 v10, s[48:51], s69 offen lds
 s_add_u32 m0, s67, 10240
 s_nop 0
 buffer_load_dwordx4 v11, s[48:51], s69 offen lds
 s_add_u32 m0, s67, 11264
 s_nop 0
 buffer_load_dwordx4 v12, s[48:51], s69 offen lds
 s_waitcnt vmcnt(30)
 ds_read_b64_tr_b16 v[128:129], v13 offset:12288
 ds_read_b64_tr_b16 v[130:131], v13 offset:12672
 ds_read_b64_tr_b16 v[132:133], v13 offset:15360
 ds_read_b64_tr_b16 v[134:135], v13 offset:15744
 ds_read_b64_tr_b16 v[136:137], v13 offset:12320
 ds_read_b64_tr_b16 v[138:139], v13 offset:12704
 ds_read_b64_tr_b16 v[140:141], v13 offset:15392
 ds_read_b64_tr_b16 v[142:143], v13 offset:15776
 ds_read_b64_tr_b16 v[144:145], v13 offset:12352
 ds_read_b64_tr_b16 v[146:147], v13 offset:12736
 ds_read_b64_tr_b16 v[148:149], v13 offset:15424
 ds_read_b64_tr_b16 v[150:151], v13 offset:15808
 s_waitcnt lgkmcnt(0)
 s_add_u32 s69, s65, 2359296
 s_add_u32 m0, s67, 12288
 s_nop 0
 buffer_load_dwordx4 v10, s[44:47], s69 offen lds
 s_add_u32 m0, s67, 13312
 s_nop 0
 buffer_load_dwordx4 v11, s[44:47], s69 offen lds
 s_add_u32 m0, s67, 14336
 s_nop 0
 buffer_load_dwordx4 v12, s[44:47], s69 offen lds
 s_add_u32 m0, s67, 15360
 s_nop 0
 buffer_load_dwordx4 v10, s[48:51], s69 offen lds
 s_add_u32 m0, s67, 16384
 s_nop 0
 buffer_load_dwordx4 v11, s[48:51], s69 offen lds
 s_add_u32 m0, s67, 17408
 s_nop 0
 buffer_load_dwordx4 v12, s[48:51], s69 offen lds
 s_waitcnt vmcnt(30)
 ds_read_b64_tr_b16 v[152:153], v13 offset:18432
 ds_read_b64_tr_b16 v[154:155], v13 offset:18816
 ds_read_b64_tr_b16 v[156:157], v13 offset:21504
 ds_read_b64_tr_b16 v[158:159], v13 offset:21888
 ds_read_b64_tr_b16 v[160:161], v13 offset:18464
 ds_read_b64_tr_b16 v[162:163], v13 offset:18848
 ds_read_b64_tr_b16 v[164:165], v13 offset:21536
 ds_read_b64_tr_b16 v[166:167], v13 offset:21920
 ds_read_b64_tr_b16 v[168:169], v13 offset:18496
 ds_read_b64_tr_b16 v[170:171], v13 offset:18880
 ds_read_b64_tr_b16 v[172:173], v13 offset:21568
 ds_read_b64_tr_b16 v[174:175], v13 offset:21952
 s_waitcnt lgkmcnt(0)
 s_add_u32 s69, s65, 2654208
 s_add_u32 m0, s67, 18432
 s_nop 0
 buffer_load_dwordx4 v10, s[44:47], s69 offen lds
 s_add_u32 m0, s67, 19456
 s_nop 0
 buffer_load_dwordx4 v11, s[44:47], s69 offen lds
 s_add_u32 m0, s67, 20480
 s_nop 0
 buffer_load_dwordx4 v12, s[44:47], s69 offen lds
 s_add_u32 m0, s67, 21504
 s_nop 0
 buffer_load_dwordx4 v10, s[48:51], s69 offen lds
 s_add_u32 m0, s67, 22528
 s_nop 0
 buffer_load_dwordx4 v11, s[48:51], s69 offen lds
 s_add_u32 m0, s67, 23552
 s_nop 0
 buffer_load_dwordx4 v12, s[48:51], s69 offen lds
 s_waitcnt vmcnt(30)
 ds_read_b64_tr_b16 v[176:177], v13 offset:24576
 ds_read_b64_tr_b16 v[178:179], v13 offset:24960
 ds_read_b64_tr_b16 v[180:181], v13 offset:27648
 ds_read_b64_tr_b16 v[182:183], v13 offset:28032
 ds_read_b64_tr_b16 v[184:185], v13 offset:24608
 ds_read_b64_tr_b16 v[186:187], v13 offset:24992
 ds_read_b64_tr_b16 v[188:189], v13 offset:27680
 ds_read_b64_tr_b16 v[190:191], v13 offset:28064
 ds_read_b64_tr_b16 v[192:193], v13 offset:24640
 ds_read_b64_tr_b16 v[194:195], v13 offset:25024
 ds_read_b64_tr_b16 v[196:197], v13 offset:27712
 ds_read_b64_tr_b16 v[198:199], v13 offset:28096
 s_waitcnt lgkmcnt(0)
 s_add_u32 s69, s65, 2949120
 s_add_u32 m0, s67, 24576
 s_nop 0
 buffer_load_dwordx4 v10, s[44:47], s69 offen lds
 s_add_u32 m0, s67, 25600
 s_nop 0
 buffer_load_dwordx4 v11, s[44:47], s69 offen lds
 s_add_u32 m0, s67, 26624
 s_nop 0
 buffer_load_dwordx4 v12, s[44:47], s69 offen lds
 s_add_u32 m0, s67, 27648
 s_nop 0
 buffer_load_dwordx4 v10, s[48:51], s69 offen lds
 s_add_u32 m0, s67, 28672
 s_nop 0
 buffer_load_dwordx4 v11, s[48:51], s69 offen lds
 s_add_u32 m0, s67, 29696
 s_nop 0
 buffer_load_dwordx4 v12, s[48:51], s69 offen lds
 s_waitcnt vmcnt(30)
 ds_read_b64_tr_b16 v[200:201], v13 offset:30720
 ds_read_b64_tr_b16 v[202:203], v13 offset:31104
 ds_read_b64_tr_b16 v[204:205], v13 offset:33792
 ds_read_b64_tr_b16 v[206:207], v13 offset:34176
 ds_read_b64_tr_b16 v[208:209], v13 offset:30752
 ds_read_b64_tr_b16 v[210:211], v13 offset:31136
 ds_read_b64_tr_b16 v[212:213], v13 offset:33824
 ds_read_b64_tr_b16 v[214:215], v13 offset:34208
 ds_read_b64_tr_b16 v[216:217], v13 offset:30784
 ds_read_b64_tr_b16 v[218:219], v13 offset:31168
 ds_read_b64_tr_b16 v[220:221], v13 offset:33856
 ds_read_b64_tr_b16 v[222:223], v13 offset:34240
 s_waitcnt lgkmcnt(0)
 s_add_u32 s69, s65, 3244032
 s_add_u32 m0, s67, 30720
 s_nop 0
 buffer_load_dwordx4 v10, s[44:47], s69 offen lds
 s_add_u32 m0, s67, 31744
 s_nop 0
 buffer_load_dwordx4 v11, s[44:47], s69 offen lds
 s_add_u32 m0, s67, 32768
 s_nop 0
 buffer_load_dwordx4 v12, s[44:47], s69 offen lds
 s_add_u32 m0, s67, 33792
 s_nop 0
 buffer_load_dwordx4 v10, s[48:51], s69 offen lds
 s_add_u32 m0, s67, 34816
 s_nop 0
 buffer_load_dwordx4 v11, s[48:51], s69 offen lds
 s_add_u32 m0, s67, 35840
 s_nop 0
 buffer_load_dwordx4 v12, s[48:51], s69 offen lds
 s_waitcnt vmcnt(30)
 ds_read_b64_tr_b16 v[224:225], v13 offset:0
 ds_read_b64_tr_b16 v[226:227], v13 offset:384
 ds_read_b64_tr_b16 v[228:229], v13 offset:3072
 ds_read_b64_tr_b16 v[230:231], v13 offset:3456
 ds_read_b64_tr_b16 v[232:233], v13 offset:32
 ds_read_b64_tr_b16 v[234:235], v13 offset:416
 ds_read_b64_tr_b16 v[236:237], v13 offset:3104
 ds_read_b64_tr_b16 v[238:239], v13 offset:3488
 ds_read_b64_tr_b16 v[240:241], v13 offset:64
 ds_read_b64_tr_b16 v[242:243], v13 offset:448
 ds_read_b64_tr_b16 v[244:245], v13 offset:3136
 ds_read_b64_tr_b16 v[246:247], v13 offset:3520
 s_waitcnt lgkmcnt(0)
 s_add_u32 s69, s65, 3538944
 s_add_u32 m0, s67, 0
 s_nop 0
 buffer_load_dwordx4 v10, s[44:47], s69 offen lds
 s_add_u32 m0, s67, 1024
 s_nop 0
 buffer_load_dwordx4 v11, s[44:47], s69 offen lds
 s_add_u32 m0, s67, 2048
 s_nop 0
 buffer_load_dwordx4 v12, s[44:47], s69 offen lds
 s_add_u32 m0, s67, 3072
 s_nop 0
 buffer_load_dwordx4 v10, s[48:51], s69 offen lds
 s_add_u32 m0, s67, 4096
 s_nop 0
 buffer_load_dwordx4 v11, s[48:51], s69 offen lds
 s_add_u32 m0, s67, 5120
 s_nop 0
 buffer_load_dwordx4 v12, s[48:51], s69 offen lds
 s_waitcnt vmcnt(30)
 ds_read_b64_tr_b16 v[248:249], v13 offset:6144
 ds_read_b64_tr_b16 v[250:251], v13 offset:6528
 ds_read_b64_tr_b16 v[252:253], v13 offset:9216
 ds_read_b64_tr_b16 v[254:255], v13 offset:9600
 ds_read_b64_tr_b16 a[0:1], v13 offset:6176
 ds_read_b64_tr_b16 a[2:3], v13 offset:6560
 ds_read_b64_tr_b16 a[4:5], v13 offset:9248
 ds_read_b64_tr_b16 a[6:7], v13 offset:9632
 ds_read_b64_tr_b16 a[8:9], v13 offset:6208
 ds_read_b64_tr_b16 a[10:11], v13 offset:6592
 ds_read_b64_tr_b16 a[12:13], v13 offset:9280
 ds_read_b64_tr_b16 a[14:15], v13 offset:9664
 s_waitcnt lgkmcnt(0)
 s_add_u32 s69, s65, 3833856
 s_add_u32 m0, s67, 6144
 s_nop 0
 buffer_load_dwordx4 v10, s[44:47], s69 offen lds
 s_add_u32 m0, s67, 7168
 s_nop 0
 buffer_load_dwordx4 v11, s[44:47], s69 offen lds
 s_add_u32 m0, s67, 8192
 s_nop 0
 buffer_load_dwordx4 v12, s[44:47], s69 offen lds
 s_add_u32 m0, s67, 9216
 s_nop 0
 buffer_load_dwordx4 v10, s[48:51], s69 offen lds
 s_add_u32 m0, s67, 10240
 s_nop 0
 buffer_load_dwordx4 v11, s[48:51], s69 offen lds
 s_add_u32 m0, s67, 11264
 s_nop 0
 buffer_load_dwordx4 v12, s[48:51], s69 offen lds
 s_waitcnt vmcnt(30)
 ds_read_b64_tr_b16 a[16:17], v13 offset:12288
 ds_read_b64_tr_b16 a[18:19], v13 offset:12672
 ds_read_b64_tr_b16 a[20:21], v13 offset:15360
 ds_read_b64_tr_b16 a[22:23], v13 offset:15744
 ds_read_b64_tr_b16 a[24:25], v13 offset:12320
 ds_read_b64_tr_b16 a[26:27], v13 offset:12704
 ds_read_b64_tr_b16 a[28:29], v13 offset:15392
 ds_read_b64_tr_b16 a[30:31], v13 offset:15776
 ds_read_b64_tr_b16 a[32:33], v13 offset:12352
 ds_read_b64_tr_b16 a[34:35], v13 offset:12736
 ds_read_b64_tr_b16 a[36:37], v13 offset:15424
 ds_read_b64_tr_b16 a[38:39], v13 offset:15808
 s_waitcnt lgkmcnt(0)
 s_add_u32 s69, s65, 4128768
 s_add_u32 m0, s67, 12288
 s_nop 0
 buffer_load_dwordx4 v10, s[44:47], s69 offen lds
 s_add_u32 m0, s67, 13312
 s_nop 0
 buffer_load_dwordx4 v11, s[44:47], s69 offen lds
 s_add_u32 m0, s67, 14336
 s_nop 0
 buffer_load_dwordx4 v12, s[44:47], s69 offen lds
 s_add_u32 m0, s67, 15360
 s_nop 0
 buffer_load_dwordx4 v10, s[48:51], s69 offen lds
 s_add_u32 m0, s67, 16384
 s_nop 0
 buffer_load_dwordx4 v11, s[48:51], s69 offen lds
 s_add_u32 m0, s67, 17408
 s_nop 0
 buffer_load_dwordx4 v12, s[48:51], s69 offen lds
 s_waitcnt vmcnt(30)
 ds_read_b64_tr_b16 a[40:41], v13 offset:18432
 ds_read_b64_tr_b16 a[42:43], v13 offset:18816
 ds_read_b64_tr_b16 a[44:45], v13 offset:21504
 ds_read_b64_tr_b16 a[46:47], v13 offset:21888
 ds_read_b64_tr_b16 a[48:49], v13 offset:18464
 ds_read_b64_tr_b16 a[50:51], v13 offset:18848
 ds_read_b64_tr_b16 a[52:53], v13 offset:21536
 ds_read_b64_tr_b16 a[54:55], v13 offset:21920
 ds_read_b64_tr_b16 a[56:57], v13 offset:18496
 ds_read_b64_tr_b16 a[58:59], v13 offset:18880
 ds_read_b64_tr_b16 a[60:61], v13 offset:21568
 ds_read_b64_tr_b16 a[62:63], v13 offset:21952
 s_waitcnt lgkmcnt(0)
 s_add_u32 s69, s65, 4423680
 s_add_u32 m0, s67, 18432
 s_nop 0
 buffer_load_dwordx4 v10, s[44:47], s69 offen lds
 s_add_u32 m0, s67, 19456
 s_nop 0
 buffer_load_dwordx4 v11, s[44:47], s69 offen lds
 s_add_u32 m0, s67, 20480
 s_nop 0
 buffer_load_dwordx4 v12, s[44:47], s69 offen lds
 s_add_u32 m0, s67, 21504
 s_nop 0
 buffer_load_dwordx4 v10, s[48:51], s69 offen lds
 s_add_u32 m0, s67, 22528
 s_nop 0
 buffer_load_dwordx4 v11, s[48:51], s69 offen lds
 s_add_u32 m0, s67, 23552
 s_nop 0
 buffer_load_dwordx4 v12, s[48:51], s69 offen lds
 s_waitcnt vmcnt(30)
 ds_read_b64_tr_b16 a[64:65], v13 offset:24576
 ds_read_b64_tr_b16 a[66:67], v13 offset:24960
 ds_read_b64_tr_b16 a[68:69], v13 offset:27648
 ds_read_b64_tr_b16 a[70:71], v13 offset:28032
 ds_read_b64_tr_b16 a[72:73], v13 offset:24608
 ds_read_b64_tr_b16 a[74:75], v13 offset:24992
 ds_read_b64_tr_b16 a[76:77], v13 offset:27680
 ds_read_b64_tr_b16 a[78:79], v13 offset:28064
 ds_read_b64_tr_b16 a[80:81], v13 offset:24640
 ds_read_b64_tr_b16 a[82:83], v13 offset:25024
 ds_read_b64_tr_b16 a[84:85], v13 offset:27712
 ds_read_b64_tr_b16 a[86:87], v13 offset:28096
 s_waitcnt lgkmcnt(0)
 s_add_u32 s69, s65, 4718592
 s_add_u32 m0, s67, 24576
 s_nop 0
 buffer_load_dwordx4 v10, s[44:47], s69 offen lds
 s_add_u32 m0, s67, 25600
 s_nop 0
 buffer_load_dwordx4 v11, s[44:47], s69 offen lds
 s_add_u32 m0, s67, 26624
 s_nop 0
 buffer_load_dwordx4 v12, s[44:47], s69 offen lds
 s_add_u32 m0, s67, 27648
 s_nop 0
 buffer_load_dwordx4 v10, s[48:51], s69 offen lds
 s_add_u32 m0, s67, 28672
 s_nop 0
 buffer_load_dwordx4 v11, s[48:51], s69 offen lds
 s_add_u32 m0, s67, 29696
 s_nop 0
 buffer_load_dwordx4 v12, s[48:51], s69 offen lds
 s_waitcnt vmcnt(30)
 ds_read_b64_tr_b16 a[88:89], v13 offset:30720
 ds_read_b64_tr_b16 a[90:91], v13 offset:31104
 ds_read_b64_tr_b16 a[92:93], v13 offset:33792
 ds_read_b64_tr_b16 a[94:95], v13 offset:34176
 ds_read_b64_tr_b16 a[96:97], v13 offset:30752
 ds_read_b64_tr_b16 a[98:99], v13 offset:31136
 ds_read_b64_tr_b16 a[100:101], v13 offset:33824
 ds_read_b64_tr_b16 a[102:103], v13 offset:34208
 ds_read_b64_tr_b16 a[104:105], v13 offset:30784
 ds_read_b64_tr_b16 a[106:107], v13 offset:31168
 ds_read_b64_tr_b16 a[108:109], v13 offset:33856
 ds_read_b64_tr_b16 a[110:111], v13 offset:34240
 s_waitcnt lgkmcnt(0)
 s_add_u32 s69, s65, 5013504
 s_add_u32 m0, s67, 30720
 s_nop 0
 buffer_load_dwordx4 v10, s[44:47], s69 offen lds
 s_add_u32 m0, s67, 31744
 s_nop 0
 buffer_load_dwordx4 v11, s[44:47], s69 offen lds
 s_add_u32 m0, s67, 32768
 s_nop 0
 buffer_load_dwordx4 v12, s[44:47], s69 offen lds
 s_add_u32 m0, s67, 33792
 s_nop 0
 buffer_load_dwordx4 v10, s[48:51], s69 offen lds
 s_add_u32 m0, s67, 34816
 s_nop 0
 buffer_load_dwordx4 v11, s[48:51], s69 offen lds
 s_add_u32 m0, s67, 35840
 s_nop 0
 buffer_load_dwordx4 v12, s[48:51], s69 offen lds
 s_waitcnt vmcnt(30)
 ds_read_b64_tr_b16 a[112:113], v13 offset:0
 ds_read_b64_tr_b16 a[114:115], v13 offset:384
 ds_read_b64_tr_b16 a[116:117], v13 offset:3072
 ds_read_b64_tr_b16 a[118:119], v13 offset:3456
 ds_read_b64_tr_b16 a[120:121], v13 offset:32
 ds_read_b64_tr_b16 a[122:123], v13 offset:416
 ds_read_b64_tr_b16 a[124:125], v13 offset:3104
 ds_read_b64_tr_b16 a[126:127], v13 offset:3488
 ds_read_b64_tr_b16 a[128:129], v13 offset:64
 ds_read_b64_tr_b16 a[130:131], v13 offset:448
 ds_read_b64_tr_b16 a[132:133], v13 offset:3136
 ds_read_b64_tr_b16 a[134:135], v13 offset:3520
 s_waitcnt vmcnt(24)
 ds_read_b64_tr_b16 a[136:137], v13 offset:6144
 ds_read_b64_tr_b16 a[138:139], v13 offset:6528
 ds_read_b64_tr_b16 a[140:141], v13 offset:9216
 ds_read_b64_tr_b16 a[142:143], v13 offset:9600
 ds_read_b64_tr_b16 a[144:145], v13 offset:6176
 ds_read_b64_tr_b16 a[146:147], v13 offset:6560
 ds_read_b64_tr_b16 a[148:149], v13 offset:9248
 ds_read_b64_tr_b16 a[150:151], v13 offset:9632
 ds_read_b64_tr_b16 a[152:153], v13 offset:6208
 ds_read_b64_tr_b16 a[154:155], v13 offset:6592
 ds_read_b64_tr_b16 a[156:157], v13 offset:9280
 ds_read_b64_tr_b16 a[158:159], v13 offset:9664
 s_waitcnt vmcnt(18)
 ds_read_b64_tr_b16 a[160:161], v13 offset:12288
 ds_read_b64_tr_b16 a[162:163], v13 offset:12672
 ds_read_b64_tr_b16 a[164:165], v13 offset:15360
 ds_read_b64_tr_b16 a[166:167], v13 offset:15744
 ds_read_b64_tr_b16 a[168:169], v13 offset:12320
 ds_read_b64_tr_b16 a[170:171], v13 offset:12704
 ds_read_b64_tr_b16 a[172:173], v13 offset:15392
 ds_read_b64_tr_b16 a[174:175], v13 offset:15776
 ds_read_b64_tr_b16 a[176:177], v13 offset:12352
 ds_read_b64_tr_b16 a[178:179], v13 offset:12736
 ds_read_b64_tr_b16 a[180:181], v13 offset:15424
 ds_read_b64_tr_b16 a[182:183], v13 offset:15808
 s_waitcnt vmcnt(12)
 ds_read_b64_tr_b16 a[184:185], v13 offset:18432
 ds_read_b64_tr_b16 a[186:187], v13 offset:18816
 ds_read_b64_tr_b16 a[188:189], v13 offset:21504
 ds_read_b64_tr_b16 a[190:191], v13 offset:21888
 ds_read_b64_tr_b16 a[192:193], v13 offset:18464
 ds_read_b64_tr_b16 a[194:195], v13 offset:18848
 ds_read_b64_tr_b16 a[196:197], v13 offset:21536
 ds_read_b64_tr_b16 a[198:199], v13 offset:21920
 ds_read_b64_tr_b16 a[200:201], v13 offset:18496
 ds_read_b64_tr_b16 a[202:203], v13 offset:18880
 ds_read_b64_tr_b16 a[204:205], v13 offset:21568
 ds_read_b64_tr_b16 a[206:207], v13 offset:21952
 s_waitcnt vmcnt(6)
 ds_read_b64_tr_b16 a[208:209], v13 offset:24576
 ds_read_b64_tr_b16 a[210:211], v13 offset:24960
 ds_read_b64_tr_b16 a[212:213], v13 offset:27648
 ds_read_b64_tr_b16 a[214:215], v13 offset:28032
 ds_read_b64_tr_b16 a[216:217], v13 offset:24608
 ds_read_b64_tr_b16 a[218:219], v13 offset:24992
 ds_read_b64_tr_b16 a[220:221], v13 offset:27680
 ds_read_b64_tr_b16 a[222:223], v13 offset:28064
 ds_read_b64_tr_b16 a[224:225], v13 offset:24640
 ds_read_b64_tr_b16 a[226:227], v13 offset:25024
 ds_read_b64_tr_b16 a[228:229], v13 offset:27712
 ds_read_b64_tr_b16 a[230:231], v13 offset:28096
 s_waitcnt vmcnt(0)
 ds_read_b64_tr_b16 a[232:233], v13 offset:30720
 ds_read_b64_tr_b16 a[234:235], v13 offset:31104
 ds_read_b64_tr_b16 a[236:237], v13 offset:33792
 ds_read_b64_tr_b16 a[238:239], v13 offset:34176
 ds_read_b64_tr_b16 a[240:241], v13 offset:30752
 ds_read_b64_tr_b16 a[242:243], v13 offset:31136
 ds_read_b64_tr_b16 a[244:245], v13 offset:33824
 ds_read_b64_tr_b16 a[246:247], v13 offset:34208
 ds_read_b64_tr_b16 a[248:249], v13 offset:30784
 ds_read_b64_tr_b16 a[250:251], v13 offset:31168
 ds_read_b64_tr_b16 a[252:253], v13 offset:33856
 ds_read_b64_tr_b16 a[254:255], v13 offset:34240
 s_waitcnt lgkmcnt(0)
 s_barrier
 s_cmp_eq_u32 s7, 1
 s_cbranch_scc1 Lvalok_39
 v_mbcnt_lo_u32_b32 v1, -1, 0
 v_mbcnt_hi_u32_b32 v1, -1, v1
 v_lshlrev_b32 v1, 2, v1
 s_mov_b32 s62, 0
 s_mov_b32 s63, 0x80808080
Lval_37:
 buffer_load_dword v2, v1, s[20:23], 0 offen sc1
 s_waitcnt vmcnt(0)
 v_and_b32 v3, s63, v2
 v_cmp_ne_u32 vcc, s63, v3
 s_cbranch_vccz Lvald_38
 s_add_u32 s62, s62, 1
 s_cmp_lt_u32 s62, 400000
 s_cbranch_scc1 Lval_37
Lvald_38:
 s_mov_b32 s63, 1
 s_cbranch_vccnz L_abort
 v_lshlrev_b32 v3, v2, 1
 v_lshrrev_b32 v4, 8, v2
 v_lshl_or_b32 v3, 1, v4, v3
 v_lshrrev_b32 v4, 16, v2
 v_lshl_or_b32 v3, 1, v4, v3
 v_lshrrev_b32 v4, 24, v2
 v_lshl_or_b32 v3, 1, v4, v3
 s_nop 1
 v_or_b32_dpp v3, v3, v3 quad_perm:[1,0,3,2] row_mask:0xf bank_mask:0xf
 v_cmp_ne_u32 vcc, 255, v3
 s_cbranch_vccnz L_rerank
 s_mov_b32 s7, 1
Lvalok_39:
 s_lshl_b32 s63, s57, 7
 s_lshl_b32 s64, s60, 2
 s_add_u32 s63, s63, s64
 s_add_u32 s74, s60, 1
 s_add_u32 s75, s60, 1
 s_add_u32 s63, s63, 4096
 s_mov_b32 s71, s63
 v_mbcnt_lo_u32_b32 v1, -1, 0
 v_mbcnt_hi_u32_b32 v1, -1, v1
 v_cmp_eq_u32 vcc, 0, v1
 v_mov_b32 v2, s63
 v_mov_b32 v77, 2147483632
 v_cndmask_b32 v77, v77, v2, vcc
 v_and_b32 v2, 3, v1
 v_lshrrev_b32 v3, 5, v1
 v_lshlrev_b32 v2, 2, v2
 v_lshl_add_u32 v2, v3, 7, v2
 v_add_u32 v74, 256, v2
 v_mov_b32 v2, 2147483632
 s_nop 0
 s_mov_b32 s90, 0
 s_mov_b32 s91, 64
 s_cmp_eq_u32 s60, 0
 s_mov_b32 s44, 12
 s_mov_b32 s45, 2
 s_cselect_b32 s46, 1, 1000
 s_mov_b32 s47, 48
 s_mov_b32 s48, 1
 s_mov_b32 s49, 2
 s_cselect_b32 s75, 49, 1
 s_cselect_b32 s91, 66, 62
 s_sub_u32 s64, s75, 1
 v_mov_b32 v2, s60
 v_mov_b32 v3, s64
 s_mov_b32 s63, 4096
 buffer_store_dword v2, v77, s[8:11], 0 offen sc1
 buffer_store_dword v3, v77, s[8:11], s63 offen sc1
 v_lshrrev_b32 v2, 5, v1
 v_and_b32 v3, 31, v1
 v_lshlrev_b32 v3, 4, v3
 v_mul_u32_u24 v2, 36864, v2
 v_add_u32 v73, v2, v3
 s_mul_i32 s63, s57, 12
 s_mul_i32 s64, s58, 3
 s_add_u32 s63, s63, s64
 s_mul_i32 s66, s57, 86
 s_lshr_b32 s66, s66, 9
 s_mul_i32 s66, s66, 36864
 s_add_u32 s66, s66, 171966464
 s_mov_b32 s86, 0xbfb8aa3b
 s_add_u32 s64, s63, 0
 s_lshl_b32 s64, s64, 9
 s_add_u32 s87, s64, s66
 s_add_u32 s64, s63, 1
 s_lshl_b32 s64, s64, 9
 s_add_u32 s88, s64, s66
 s_add_u32 s64, s63, 2
 s_lshl_b32 s64, s64, 9
 s_add_u32 s89, s64, s66
 v_mbcnt_lo_u32_b32 v1, -1, 0
 v_mbcnt_hi_u32_b32 v1, -1, v1
 v_and_b32 v2, 15, v1
 v_lshrrev_b32 v3, 4, v1
 v_lshrrev_b32 v4, 1, v2
 v_mul_u32_u24 v5, 1152, v2
 v_add_u32 v5, 81920, v5
 v_xor_b32 v6, v3, v4
 v_lshl_add_u32 v70, v6, 4, v5
 v_xor_b32 v6, 4, v6
 v_lshl_add_u32 v71, v6, 4, v5
 s_lshl_b32 s70, s58, 10
 v_lshl_add_u32 v72, v1, 4, s70
 s_add_u32 s70, s70, 8192
 s_mov_b32 s85, -73728
 s_mov_b32 s3, 4096
 s_mov_b32 s84, 1
 s_mov_b32 s4, 36864
 s_mov_b32 s5, 36864
 s_mov_b32 s61, 0
 s_mov_b32 s77, 0
 s_mov_b32 s78, 0
 s_mov_b32 s79, 0
 s_mov_b32 s92, 2147483632
 s_mov_b32 s93, 0
 s_cmp_eq_u32 s58, 0
 s_cbranch_scc1 Lw0_40
 v_mov_b32 v74, 2147483632
 v_mov_b32 v77, 2147483632
Lw0_40:
 s_add_u32 s90, s90, 7827456
 s_sub_u32 s87, s87, 294912
 s_sub_u32 s88, s88, 294912
 s_sub_u32 s89, s89, 294912
L_u_idle:
 s_cmp_lg_u32 s58, 0
 s_cbranch_scc1 Lspd_42
 s_mov_b32 s62, 0
Lsp_41:
 buffer_load_dword v75, v74, s[8:11], 0 offen sc1
 s_waitcnt vmcnt(0)
 v_cmp_gt_u32 vcc, s74, v75
 v_cmp_gt_u32 s[66:67], s75, v75
 s_cmp_eq_u32 s67, 0
 s_cselect_b32 s72, 2, 0
 s_cmp_eq_u32 vcc_lo, 0
 s_cselect_b32 s72, 1, s72
 v_mov_b32 v76, s72
 ds_write_b32 v72, v76 offset:4096
 s_cmp_lg_u32 s72, 0
 s_cbranch_scc1 Lspd_42
 s_add_u32 s62, s62, 1
 s_cmp_lt_u32 s62, 400000
 s_cbranch_scc1 Lsp_41
Lspd_42:
 s_waitcnt lgkmcnt(0)
 s_barrier
 ds_read_b32 v76, v73 offset:4096
 s_waitcnt lgkmcnt(0)
 v_readfirstlane_b32 s72, v76
 s_mov_b32 s63, 21
 s_cmp_eq_u32 s72, 0
 s_cbranch_scc1 L_abort
 s_sub_u32 s68, s72, 1
 s_cmp_eq_u32 s68, 0
 s_cselect_b32 s69, s74, s75
 s_cselect_b32 s63, s44, s47
 s_cselect_b32 s64, s45, s48
 s_cselect_b32 s80, s46, s49
 s_cmp_lt_u32 s69, s63
 s_cselect_b32 s80, s64, s80
 s_add_u32 s80, s80, s69
 s_cmp_eq_u32 s68, 0
 s_cselect_b32 s74, s80, s74
 s_cselect_b32 s75, s75, s80
 s_mul_i32 s73, s69, 36864
 s_mul_i32 s63, s68, 2359296
 s_add_u32 s73, s73, s63
 s_add_u32 s73, s73, s90
 s_mov_b32 m0, s70
 s_nop 0
 buffer_load_dwordx4 v72, s[8:11], s73 offen sc1 lds
 s_add_u32 m0, m0, s3
 s_add_u32 s73, s73, s3
 buffer_load_dwordx4 v72, s[8:11], s73 offen sc1 lds
 s_add_u32 m0, m0, s3
 s_add_u32 s73, s73, s3
 buffer_load_dwordx4 v72, s[8:11], s73 offen sc1 lds
 s_add_u32 m0, m0, s3
 s_add_u32 s73, s73, s3
 buffer_load_dwordx4 v72, s[8:11], s73 offen sc1 lds
 s_add_u32 m0, m0, s3
 s_add_u32 s73, s73, s3
 buffer_load_dwordx4 v72, s[8:11], s73 offen sc1 lds
 s_add_u32 m0, m0, s3
 s_add_u32 s73, s73, s3
 buffer_load_dwordx4 v72, s[8:11], s73 offen sc1 lds
 s_add_u32 m0, m0, s3
 s_add_u32 s73, s73, s3
 buffer_load_dwordx4 v72, s[8:11], s73 offen sc1 lds
 s_add_u32 m0, m0, s3
 s_add_u32 s73, s73, s3
 buffer_load_dwordx4 v72, s[8:11], s73 offen sc1 lds
 s_add_u32 m0, m0, s3
 s_add_u32 s73, s73, s3
 buffer_load_dwordx4 v72, s[8:11], s73 offen sc1 lds
 s_mov_b32 s63, s85
 s_mov_b32 s85, s4
 s_mov_b32 s4, s5
 s_mov_b32 s5, s63
 s_add_u32 s70, s70, s85
 s_mov_b32 s81, s77
 s_mov_b32 s82, s78
 s_mov_b32 s83, s79
 s_mov_b32 s94, s92
 s_mov_b32 s95, s93
 s_mov_b32 s63, s69
 s_mul_i32 s63, s63, 294912
 s_mul_i32 s64, s68, 18874368
 s_add_u32 s63, s63, s64
 s_add_u32 s77, s63, s87
 s_add_u32 s78, s63, s88
 s_add_u32 s79, s63, s89
 s_mul_i32 s92, s68, 4096
 s_sub_u32 s93, s80, 1
 s_min_u32 s93, s93, 64
 s_add_u32 s61, s61, 1
 v_add_u32 v70, s5, v70
 v_add_u32 v71, s5, v71
 v_cmp_gt_u32 vcc, s74, v75
 v_cmp_gt_u32 s[66:67], s75, v75
 s_cmp_eq_u32 s67, 0
 s_cselect_b32 s72, 2, 0
 s_cmp_eq_u32 vcc_lo, 0
 s_cselect_b32 s72, 1, s72
 v_mov_b32 v76, s72
 ds_write_b32 v72, v76 offset:12
 s_waitcnt vmcnt(4) lgkmcnt(0)
 s_barrier
 ds_read_b32 v76, v73 offset:12
 ds_read_b128 v[48:51], v70 offset:0
 ds_read_b128 v[52:55], v71 offset:0
 s_waitcnt lgkmcnt(2)
 v_readfirstlane_b32 s72, v76
 s_cmp_lg_u32 s72, 0
L_u_slow:
 s_cbranch_scc1 L_u_p0d
 s_waitcnt lgkmcnt(1)
 v_mfma_f32_16x16x32_bf16 v[0:3], v[80:83], v[48:51], 0
 ds_read_b128 v[56:59], v70 offset:128
 v_mfma_f32_16x16x32_bf16 v[4:7], v[84:87], v[48:51], 0
 v_mfma_f32_16x16x32_bf16 v[8:11], v[88:91], v[48:51], 0
 v_mfma_f32_16x16x32_bf16 v[12:15], v[92:95], v[48:51], 0
 v_mfma_f32_16x16x32_bf16 v[16:19], v[96:99], v[48:51], 0
 v_mfma_f32_16x16x32_bf16 v[20:23], v[100:103], v[48:51], 0
 s_waitcnt lgkmcnt(1)
 v_mfma_f32_16x16x32_bf16 v[0:3], v[104:107], v[52:55], v[0:3]
 ds_read_b128 v[48:51], v71 offset:128
 v_mfma_f32_16x16x32_bf16 v[4:7], v[108:111], v[52:55], v[4:7]
 v_mfma_f32_16x16x32_bf16 v[8:11], v[112:115], v[52:55], v[8:11]
 v_mfma_f32_16x16x32_bf16 v[12:15], v[116:119], v[52:55], v[12:15]
 v_mfma_f32_16x16x32_bf16 v[16:19], v[120:123], v[52:55], v[16:19]
 v_mfma_f32_16x16x32_bf16 v[20:23], v[124:127], v[52:55], v[20:23]
 s_waitcnt lgkmcnt(1)
 v_mfma_f32_16x16x32_bf16 v[0:3], v[128:131], v[56:59], v[0:3]
 ds_read_b128 v[52:55], v70 offset:256
 v_mfma_f32_16x16x32_bf16 v[4:7], v[132:135], v[56:59], v[4:7]
 v_mfma_f32_16x16x32_bf16 v[8:11], v[136:139], v[56:59], v[8:11]
 v_mfma_f32_16x16x32_bf16 v[12:15], v[140:143], v[56:59], v[12:15]
 v_mfma_f32_16x16x32_bf16 v[16:19], v[144:147], v[56:59], v[16:19]
 v_mfma_f32_16x16x32_bf16 v[20:23], v[148:151], v[56:59], v[20:23]
 s_waitcnt lgkmcnt(1)
 v_mfma_f32_16x16x32_bf16 v[0:3], v[152:155], v[48:51], v[0:3]
 ds_read_b128 v[56:59], v71 offset:256
 v_mfma_f32_16x16x32_bf16 v[4:7], v[156:159], v[48:51], v[4:7]
 v_mfma_f32_16x16x32_bf16 v[8:11], v[160:163], v[48:51], v[8:11]
 v_mfma_f32_16x16x32_bf16 v[12:15], v[164:167], v[48:51], v[12:15]
 v_mfma_f32_16x16x32_bf16 v[16:19], v[168:171], v[48:51], v[16:19]
 v_mfma_f32_16x16x32_bf16 v[20:23], v[172:175], v[48:51], v[20:23]
 s_waitcnt lgkmcnt(1)
 v_mfma_f32_16x16x32_bf16 v[0:3], v[176:179], v[52:55], v[0:3]
 ds_read_b128 v[48:51], v70 offset:384
 v_mfma_f32_16x16x32_bf16 v[4:7], v[180:183], v[52:55], v[4:7]
 v_mfma_f32_16x16x32_bf16 v[8:11], v[184:187], v[52:55], v[8:11]
 v_mfma_f32_16x16x32_bf16 v[12:15], v[188:191], v[52:55], v[12:15]
 v_mfma_f32_16x16x32_bf16 v[16:19], v[192:195], v[52:55], v[16:19]
 v_mfma_f32_16x16x32_bf16 v[20:23], v[196:199], v[52:55], v[20:23]
 s_waitcnt lgkmcnt(1)
 v_mfma_f32_16x16x32_bf16 v[0:3], v[200:203], v[56:59], v[0:3]
 ds_read_b128 v[52:55], v71 offset:384
 v_mfma_f32_16x16x32_bf16 v[4:7], v[204:207], v[56:59], v[4:7]
 v_mfma_f32_16x16x32_bf16 v[8:11], v[208:211], v[56:59], v[8:11]
 v_mfma_f32_16x16x32_bf16 v[12:15], v[212:215], v[56:59], v[12:15]
 v_mfma_f32_16x16x32_bf16 v[16:19], v[216:219], v[56:59], v[16:19]
 v_mfma_f32_16x16x32_bf16 v[20:23], v[220:223], v[56:59], v[20:23]
 s_waitcnt lgkmcnt(1)
 v_mfma_f32_16x16x32_bf16 v[0:3], v[224:227], v[48:51], v[0:3]
 ds_read_b128 v[56:59], v70 offset:512
 v_mfma_f32_16x16x32_bf16 v[4:7], v[228:231], v[48:51], v[4:7]
 v_mfma_f32_16x16x32_bf16 v[8:11], v[232:235], v[48:51], v[8:11]
 v_mfma_f32_16x16x32_bf16 v[12:15], v[236:239], v[48:51], v[12:15]
 v_mfma_f32_16x16x32_bf16 v[16:19], v[240:243], v[48:51], v[16:19]
 v_mfma_f32_16x16x32_bf16 v[20:23], v[244:247], v[48:51], v[20:23]
 s_waitcnt lgkmcnt(1)
 v_mfma_f32_16x16x32_bf16 v[0:3], v[248:251], v[52:55], v[0:3]
 ds_read_b128 v[48:51], v71 offset:512
 v_mfma_f32_16x16x32_bf16 v[4:7], v[252:255], v[52:55], v[4:7]
 v_mfma_f32_16x16x32_bf16 v[8:11], a[0:3], v[52:55], v[8:11]
 buffer_load_dword v75, v74, s[8:11], 0 offen sc1
 v_mfma_f32_16x16x32_bf16 v[12:15], a[4:7], v[52:55], v[12:15]
 v_mfma_f32_16x16x32_bf16 v[16:19], a[8:11], v[52:55], v[16:19]
 v_mfma_f32_16x16x32_bf16 v[20:23], a[12:15], v[52:55], v[20:23]
 s_waitcnt lgkmcnt(1)
 v_mfma_f32_16x16x32_bf16 v[0:3], a[16:19], v[56:59], v[0:3]
 ds_read_b128 v[52:55], v70 offset:640
 v_mfma_f32_16x16x32_bf16 v[4:7], a[20:23], v[56:59], v[4:7]
 v_mfma_f32_16x16x32_bf16 v[8:11], a[24:27], v[56:59], v[8:11]
 v_mfma_f32_16x16x32_bf16 v[12:15], a[28:31], v[56:59], v[12:15]
 v_mfma_f32_16x16x32_bf16 v[16:19], a[32:35], v[56:59], v[16:19]
 v_mfma_f32_16x16x32_bf16 v[20:23], a[36:39], v[56:59], v[20:23]
 s_waitcnt lgkmcnt(1)
 v_mfma_f32_16x16x32_bf16 v[0:3], a[40:43], v[48:51], v[0:3]
 ds_read_b128 v[56:59], v71 offset:640
 v_mfma_f32_16x16x32_bf16 v[4:7], a[44:47], v[48:51], v[4:7]
 v_mfma_f32_16x16x32_bf16 v[8:11], a[48:51], v[48:51], v[8:11]
 v_mfma_f32_16x16x32_bf16 v[12:15], a[52:55], v[48:51], v[12:15]
 v_mfma_f32_16x16x32_bf16 v[16:19], a[56:59], v[48:51], v[16:19]
 v_mfma_f32_16x16x32_bf16 v[20:23], a[60:63], v[48:51], v[20:23]
 s_waitcnt lgkmcnt(1)
 v_mfma_f32_16x16x32_bf16 v[0:3], a[64:67], v[52:55], v[0:3]
 ds_read_b128 v[48:51], v70 offset:768
 v_mfma_f32_16x16x32_bf16 v[4:7], a[68:71], v[52:55], v[4:7]
 v_mfma_f32_16x16x32_bf16 v[8:11], a[72:75], v[52:55], v[8:11]
 v_mfma_f32_16x16x32_bf16 v[12:15], a[76:79], v[52:55], v[12:15]
 v_mfma_f32_16x16x32_bf16 v[16:19], a[80:83], v[52:55], v[16:19]
 v_mfma_f32_16x16x32_bf16 v[20:23], a[84:87], v[52:55], v[20:23]
 s_waitcnt lgkmcnt(1)
 v_mfma_f32_16x16x32_bf16 v[0:3], a[88:91], v[56:59], v[0:3]
 ds_read_b128 v[52:55], v71 offset:768
 v_mfma_f32_16x16x32_bf16 v[4:7], a[92:95], v[56:59], v[4:7]
 v_mfma_f32_16x16x32_bf16 v[8:11], a[96:99], v[56:59], v[8:11]
 v_mfma_f32_16x16x32_bf16 v[12:15], a[100:103], v[56:59], v[12:15]
 v_mfma_f32_16x16x32_bf16 v[16:19], a[104:107], v[56:59], v[16:19]
 v_mfma_f32_16x16x32_bf16 v[20:23], a[108:111], v[56:59], v[20:23]
 s_waitcnt lgkmcnt(1)
 v_mfma_f32_16x16x32_bf16 v[0:3], a[112:115], v[48:51], v[0:3]
 ds_read_b128 v[56:59], v70 offset:896
 v_mfma_f32_16x16x32_bf16 v[4:7], a[116:119], v[48:51], v[4:7]
 v_mfma_f32_16x16x32_bf16 v[8:11], a[120:123], v[48:51], v[8:11]
 v_mfma_f32_16x16x32_bf16 v[12:15], a[124:127], v[48:51], v[12:15]
 v_mfma_f32_16x16x32_bf16 v[16:19], a[128:131], v[48:51], v[16:19]
 v_mfma_f32_16x16x32_bf16 v[20:23], a[132:135], v[48:51], v[20:23]
 s_waitcnt lgkmcnt(1)
 v_mfma_f32_16x16x32_bf16 v[0:3], a[136:139], v[52:55], v[0:3]
 ds_read_b128 v[48:51], v71 offset:896
 v_mfma_f32_16x16x32_bf16 v[4:7], a[140:143], v[52:55], v[4:7]
 v_mfma_f32_16x16x32_bf16 v[8:11], a[144:147], v[52:55], v[8:11]
 v_mfma_f32_16x16x32_bf16 v[12:15], a[148:151], v[52:55], v[12:15]
 v_mfma_f32_16x16x32_bf16 v[16:19], a[152:155], v[52:55], v[16:19]
 v_mfma_f32_16x16x32_bf16 v[20:23], a[156:159], v[52:55], v[20:23]
 s_waitcnt vmcnt(0)
 v_cmp_gt_u32 vcc, s74, v75
 s_waitcnt lgkmcnt(1)
 v_mfma_f32_16x16x32_bf16 v[0:3], a[160:163], v[56:59], v[0:3]
 ds_read_b128 v[52:55], v70 offset:1024
 v_cmp_gt_u32 s[66:67], s75, v75
 v_mfma_f32_16x16x32_bf16 v[4:7], a[164:167], v[56:59], v[4:7]
 v_mfma_f32_16x16x32_bf16 v[8:11], a[168:171], v[56:59], v[8:11]
 v_mfma_f32_16x16x32_bf16 v[12:15], a[172:175], v[56:59], v[12:15]
 s_cmp_eq_u32 s67, 0
 s_cselect_b32 s72, 2, 0
 s_cmp_eq_u32 vcc_lo, 0
 s_cselect_b32 s72, 1, s72
 v_mfma_f32_16x16x32_bf16 v[16:19], a[176:179], v[56:59], v[16:19]
 v_mov_b32 v76, s72
 v_mfma_f32_16x16x32_bf16 v[20:23], a[180:183], v[56:59], v[20:23]
 ds_write_b32 v72, v76 offset:0
 s_waitcnt lgkmcnt(2)
 v_mfma_f32_16x16x32_bf16 v[0:3], a[184:187], v[48:51], v[0:3]
 ds_read_b128 v[56:59], v71 offset:1024
 v_mfma_f32_16x16x32_bf16 v[4:7], a[188:191], v[48:51], v[4:7]
 v_mfma_f32_16x16x32_bf16 v[8:11], a[192:195], v[48:51], v[8:11]
 v_mfma_f32_16x16x32_bf16 v[12:15], a[196:199], v[48:51], v[12:15]
 v_mfma_f32_16x16x32_bf16 v[16:19], a[200:203], v[48:51], v[16:19]
 v_mov_b32 v76, s95
 v_mfma_f32_16x16x32_bf16 v[20:23], a[204:207], v[48:51], v[20:23]
 s_waitcnt vmcnt(1)
 s_waitcnt lgkmcnt(1)
 s_barrier
 buffer_store_dword v76, v77, s[8:11], s94 offen sc1
 ds_read_b32 v76, v73 offset:0
 v_mfma_f32_16x16x32_bf16 v[0:3], a[208:211], v[52:55], v[0:3]
 ds_read_b128 v[48:51], v70 offset:18432
 v_mfma_f32_16x16x32_bf16 v[4:7], a[212:215], v[52:55], v[4:7]
 v_mfma_f32_16x16x32_bf16 v[8:11], a[216:219], v[52:55], v[8:11]
 v_mfma_f32_16x16x32_bf16 v[12:15], a[220:223], v[52:55], v[12:15]
 v_mfma_f32_16x16x32_bf16 v[16:19], a[224:227], v[52:55], v[16:19]
 v_mfma_f32_16x16x32_bf16 v[20:23], a[228:231], v[52:55], v[20:23]
 s_waitcnt lgkmcnt(2)
 v_mfma_f32_16x16x32_bf16 v[0:3], a[232:235], v[56:59], v[0:3]
 ds_read_b128 v[52:55], v71 offset:18432
 v_mfma_f32_16x16x32_bf16 v[4:7], a[236:239], v[56:59], v[4:7]
 v_mfma_f32_16x16x32_bf16 v[8:11], a[240:243], v[56:59], v[8:11]
 s_waitcnt lgkmcnt(2)
 v_readfirstlane_b32 s72, v76
 v_mfma_f32_16x16x32_bf16 v[12:15], a[244:247], v[56:59], v[12:15]
 v_mfma_f32_16x16x32_bf16 v[16:19], a[248:251], v[56:59], v[16:19]
 v_mfma_f32_16x16x32_bf16 v[20:23], a[252:255], v[56:59], v[20:23]
 s_cmp_lg_u32 s72, 0
 s_cbranch_scc1 L_u_p1d
 s_branch L_u_p1n
L_u_p0d:
 s_waitcnt lgkmcnt(1)
 v_mfma_f32_16x16x32_bf16 v[0:3], v[80:83], v[48:51], 0
 ds_read_b128 v[56:59], v70 offset:128
 s_sub_u32 s68, s72, 1
 s_cmp_eq_u32 s68, 0
 s_cselect_b32 s69, s74, s75
 v_mfma_f32_16x16x32_bf16 v[4:7], v[84:87], v[48:51], 0
 s_cselect_b32 s63, s44, s47
 s_cselect_b32 s64, s45, s48
 s_cselect_b32 s80, s46, s49
 v_mfma_f32_16x16x32_bf16 v[8:11], v[88:91], v[48:51], 0
 s_cmp_lt_u32 s69, s63
 s_cselect_b32 s80, s64, s80
 s_add_u32 s80, s80, s69
 v_mfma_f32_16x16x32_bf16 v[12:15], v[92:95], v[48:51], 0
 s_cmp_eq_u32 s68, 0
 s_cselect_b32 s74, s80, s74
 s_cselect_b32 s75, s75, s80
 s_mul_i32 s73, s69, 36864
 v_mfma_f32_16x16x32_bf16 v[16:19], v[96:99], v[48:51], 0
 s_mul_i32 s63, s68, 2359296
 s_add_u32 s73, s73, s63
 s_add_u32 s73, s73, s90
 v_mfma_f32_16x16x32_bf16 v[20:23], v[100:103], v[48:51], 0
 s_mov_b32 m0, s70
 s_waitcnt lgkmcnt(1)
 v_mfma_f32_16x16x32_bf16 v[0:3], v[104:107], v[52:55], v[0:3]
 ds_read_b128 v[48:51], v71 offset:128
 v_mfma_f32_16x16x32_bf16 v[4:7], v[108:111], v[52:55], v[4:7]
 buffer_load_dwordx4 v72, s[8:11], s73 offen sc1 lds
 v_mfma_f32_16x16x32_bf16 v[8:11], v[112:115], v[52:55], v[8:11]
 v_mfma_f32_16x16x32_bf16 v[12:15], v[116:119], v[52:55], v[12:15]
 v_mfma_f32_16x16x32_bf16 v[16:19], v[120:123], v[52:55], v[16:19]
 v_mfma_f32_16x16x32_bf16 v[20:23], v[124:127], v[52:55], v[20:23]
 s_add_u32 m0, m0, s3
 s_add_u32 s73, s73, s3
 s_waitcnt lgkmcnt(1)
 v_mfma_f32_16x16x32_bf16 v[0:3], v[128:131], v[56:59], v[0:3]
 ds_read_b128 v[52:55], v70 offset:256
 v_mfma_f32_16x16x32_bf16 v[4:7], v[132:135], v[56:59], v[4:7]
 buffer_load_dwordx4 v72, s[8:11], s73 offen sc1 lds
 v_mfma_f32_16x16x32_bf16 v[8:11], v[136:139], v[56:59], v[8:11]
 v_mfma_f32_16x16x32_bf16 v[12:15], v[140:143], v[56:59], v[12:15]
 v_mfma_f32_16x16x32_bf16 v[16:19], v[144:147], v[56:59], v[16:19]
 v_mfma_f32_16x16x32_bf16 v[20:23], v[148:151], v[56:59], v[20:23]
 s_add_u32 m0, m0, s3
 s_add_u32 s73, s73, s3
 s_waitcnt lgkmcnt(1)
 v_mfma_f32_16x16x32_bf16 v[0:3], v[152:155], v[48:51], v[0:3]
 ds_read_b128 v[56:59], v71 offset:256
 v_mfma_f32_16x16x32_bf16 v[4:7], v[156:159], v[48:51], v[4:7]
 buffer_load_dwordx4 v72, s[8:11], s73 offen sc1 lds
 v_mfma_f32_16x16x32_bf16 v[8:11], v[160:163], v[48:51], v[8:11]
 v_mfma_f32_16x16x32_bf16 v[12:15], v[164:167], v[48:51], v[12:15]
 v_mfma_f32_16x16x32_bf16 v[16:19], v[168:171], v[48:51], v[16:19]
 v_mfma_f32_16x16x32_bf16 v[20:23], v[172:175], v[48:51], v[20:23]
 s_add_u32 m0, m0, s3
 s_add_u32 s73, s73, s3
 s_waitcnt lgkmcnt(1)
 v_mfma_f32_16x16x32_bf16 v[0:3], v[176:179], v[52:55], v[0:3]
 ds_read_b128 v[48:51], v70 offset:384
 v_mfma_f32_16x16x32_bf16 v[4:7], v[180:183], v[52:55], v[4:7]
 buffer_load_dwordx4 v72, s[8:11], s73 offen sc1 lds
 v_mfma_f32_16x16x32_bf16 v[8:11], v[184:187], v[52:55], v[8:11]
 v_mfma_f32_16x16x32_bf16 v[12:15], v[188:191], v[52:55], v[12:15]
 v_mfma_f32_16x16x32_bf16 v[16:19], v[192:195], v[52:55], v[16:19]
 v_mfma_f32_16x16x32_bf16 v[20:23], v[196:199], v[52:55], v[20:23]
 s_add_u32 m0, m0, s3
 s_add_u32 s73, s73, s3
 s_waitcnt lgkmcnt(1)
 v_mfma_f32_16x16x32_bf16 v[0:3], v[200:203], v[56:59], v[0:3]
 ds_read_b128 v[52:55], v71 offset:384
 v_mfma_f32_16x16x32_bf16 v[4:7], v[204:207], v[56:59], v[4:7]
 buffer_load_dwordx4 v72, s[8:11], s73 offen sc1 lds
 v_mfma_f32_16x16x32_bf16 v[8:11], v[208:211], v[56:59], v[8:11]
 v_mfma_f32_16x16x32_bf16 v[12:15], v[212:215], v[56:59], v[12:15]
 v_mfma_f32_16x16x32_bf16 v[16:19], v[216:219], v[56:59], v[16:19]
 v_mfma_f32_16x16x32_bf16 v[20:23], v[220:223], v[56:59], v[20:23]
 s_add_u32 m0, m0, s3
 s_add_u32 s73, s73, s3
 s_waitcnt lgkmcnt(1)
 v_mfma_f32_16x16x32_bf16 v[0:3], v[224:227], v[48:51], v[0:3]
 ds_read_b128 v[56:59], v70 offset:512
 v_mfma_f32_16x16x32_bf16 v[4:7], v[228:231], v[48:51], v[4:7]
 buffer_load_dwordx4 v72, s[8:11], s73 offen sc1 lds
 v_mfma_f32_16x16x32_bf16 v[8:11], v[232:235], v[48:51], v[8:11]
 v_mfma_f32_16x16x32_bf16 v[12:15], v[236:239], v[48:51], v[12:15]
 v_mfma_f32_16x16x32_bf16 v[16:19], v[240:243], v[48:51], v[16:19]
 v_mfma_f32_16x16x32_bf16 v[20:23], v[244:247], v[48:51], v[20:23]
 s_add_u32 m0, m0, s3
 s_add_u32 s73, s73, s3
 s_waitcnt lgkmcnt(1)
 v_mfma_f32_16x16x32_bf16 v[0:3], v[248:251], v[52:55], v[0:3]
 ds_read_b128 v[48:51], v71 offset:512
 v_mfma_f32_16x16x32_bf16 v[4:7], v[252:255], v[52:55], v[4:7]
 buffer_load_dwordx4 v72, s[8:11], s73 offen sc1 lds
 v_mfma_f32_16x16x32_bf16 v[8:11], a[0:3], v[52:55], v[8:11]
 v_mfma_f32_16x16x32_bf16 v[12:15], a[4:7], v[52:55], v[12:15]
 v_mfma_f32_16x16x32_bf16 v[16:19], a[8:11], v[52:55], v[16:19]
 v_mfma_f32_16x16x32_bf16 v[20:23], a[12:15], v[52:55], v[20:23]
 s_add_u32 m0, m0, s3
 s_add_u32 s73, s73, s3
 s_waitcnt lgkmcnt(1)
 v_mfma_f32_16x16x32_bf16 v[0:3], a[16:19], v[56:59], v[0:3]
 ds_read_b128 v[52:55], v70 offset:640
 v_mfma_f32_16x16x32_bf16 v[4:7], a[20:23], v[56:59], v[4:7]
 buffer_load_dwordx4 v72, s[8:11], s73 offen sc1 lds
 v_mfma_f32_16x16x32_bf16 v[8:11], a[24:27], v[56:59], v[8:11]
 v_mfma_f32_16x16x32_bf16 v[12:15], a[28:31], v[56:59], v[12:15]
 v_mfma_f32_16x16x32_bf16 v[16:19], a[32:35], v[56:59], v[16:19]
 v_mfma_f32_16x16x32_bf16 v[20:23], a[36:39], v[56:59], v[20:23]
 s_add_u32 m0, m0, s3
 s_add_u32 s73, s73, s3
 s_waitcnt lgkmcnt(1)
 v_mfma_f32_16x16x32_bf16 v[0:3], a[40:43], v[48:51], v[0:3]
 ds_read_b128 v[56:59], v71 offset:640
 v_mfma_f32_16x16x32_bf16 v[4:7], a[44:47], v[48:51], v[4:7]
 buffer_load_dwordx4 v72, s[8:11], s73 offen sc1 lds
 v_mfma_f32_16x16x32_bf16 v[8:11], a[48:51], v[48:51], v[8:11]
 v_mfma_f32_16x16x32_bf16 v[12:15], a[52:55], v[48:51], v[12:15]
 v_mfma_f32_16x16x32_bf16 v[16:19], a[56:59], v[48:51], v[16:19]
 v_mfma_f32_16x16x32_bf16 v[20:23], a[60:63], v[48:51], v[20:23]
 s_waitcnt lgkmcnt(1)
 v_mfma_f32_16x16x32_bf16 v[0:3], a[64:67], v[52:55], v[0:3]
 ds_read_b128 v[48:51], v70 offset:768
 v_mfma_f32_16x16x32_bf16 v[4:7], a[68:71], v[52:55], v[4:7]
 v_mfma_f32_16x16x32_bf16 v[8:11], a[72:75], v[52:55], v[8:11]
 v_mfma_f32_16x16x32_bf16 v[12:15], a[76:79], v[52:55], v[12:15]
 v_mfma_f32_16x16x32_bf16 v[16:19], a[80:83], v[52:55], v[16:19]
 v_mfma_f32_16x16x32_bf16 v[20:23], a[84:87], v[52:55], v[20:23]
 s_waitcnt lgkmcnt(1)
 v_mfma_f32_16x16x32_bf16 v[0:3], a[88:91], v[56:59], v[0:3]
 ds_read_b128 v[52:55], v71 offset:768
 v_mfma_f32_16x16x32_bf16 v[4:7], a[92:95], v[56:59], v[4:7]
 v_mfma_f32_16x16x32_bf16 v[8:11], a[96:99], v[56:59], v[8:11]
 v_mfma_f32_16x16x32_bf16 v[12:15], a[100:103], v[56:59], v[12:15]
 v_mfma_f32_16x16x32_bf16 v[16:19], a[104:107], v[56:59], v[16:19]
 v_mfma_f32_16x16x32_bf16 v[20:23], a[108:111], v[56:59], v[20:23]
 s_waitcnt lgkmcnt(1)
 v_mfma_f32_16x16x32_bf16 v[0:3], a[112:115], v[48:51], v[0:3]
 ds_read_b128 v[56:59], v70 offset:896
 v_mfma_f32_16x16x32_bf16 v[4:7], a[116:119], v[48:51], v[4:7]
 v_mfma_f32_16x16x32_bf16 v[8:11], a[120:123], v[48:51], v[8:11]
 v_mfma_f32_16x16x32_bf16 v[12:15], a[124:127], v[48:51], v[12:15]
 v_mfma_f32_16x16x32_bf16 v[16:19], a[128:131], v[48:51], v[16:19]
 v_mfma_f32_16x16x32_bf16 v[20:23], a[132:135], v[48:51], v[20:23]
 s_waitcnt lgkmcnt(1)
 v_mfma_f32_16x16x32_bf16 v[0:3], a[136:139], v[52:55], v[0:3]
 ds_read_b128 v[48:51], v71 offset:896
 v_mfma_f32_16x16x32_bf16 v[4:7], a[140:143], v[52:55], v[4:7]
 v_mfma_f32_16x16x32_bf16 v[8:11], a[144:147], v[52:55], v[8:11]
 v_mfma_f32_16x16x32_bf16 v[12:15], a[148:151], v[52:55], v[12:15]
 v_mfma_f32_16x16x32_bf16 v[16:19], a[152:155], v[52:55], v[16:19]
 v_mfma_f32_16x16x32_bf16 v[20:23], a[156:159], v[52:55], v[20:23]
 s_waitcnt lgkmcnt(1)
 v_mfma_f32_16x16x32_bf16 v[0:3], a[160:163], v[56:59], v[0:3]
 ds_read_b128 v[52:55], v70 offset:1024
 v_mfma_f32_16x16x32_bf16 v[4:7], a[164:167], v[56:59], v[4:7]
 v_mfma_f32_16x16x32_bf16 v[8:11], a[168:171], v[56:59], v[8:11]
 v_mfma_f32_16x16x32_bf16 v[12:15], a[172:175], v[56:59], v[12:15]
 v_mfma_f32_16x16x32_bf16 v[16:19], a[176:179], v[56:59], v[16:19]
 v_mfma_f32_16x16x32_bf16 v[20:23], a[180:183], v[56:59], v[20:23]
 s_waitcnt lgkmcnt(1)
 v_mfma_f32_16x16x32_bf16 v[0:3], a[184:187], v[48:51], v[0:3]
 ds_read_b128 v[56:59], v71 offset:1024
 v_mfma_f32_16x16x32_bf16 v[4:7], a[188:191], v[48:51], v[4:7]
 v_mfma_f32_16x16x32_bf16 v[8:11], a[192:195], v[48:51], v[8:11]
 v_mfma_f32_16x16x32_bf16 v[12:15], a[196:199], v[48:51], v[12:15]
 v_mfma_f32_16x16x32_bf16 v[16:19], a[200:203], v[48:51], v[16:19]
 v_mov_b32 v76, s95
 v_mfma_f32_16x16x32_bf16 v[20:23], a[204:207], v[48:51], v[20:23]
 s_waitcnt vmcnt(9)
 s_barrier
 buffer_store_dword v76, v77, s[8:11], s94 offen sc1
 s_waitcnt lgkmcnt(1)
 v_mfma_f32_16x16x32_bf16 v[0:3], a[208:211], v[52:55], v[0:3]
 ds_read_b128 v[48:51], v70 offset:18432
 v_mfma_f32_16x16x32_bf16 v[4:7], a[212:215], v[52:55], v[4:7]
 v_mfma_f32_16x16x32_bf16 v[8:11], a[216:219], v[52:55], v[8:11]
 v_mfma_f32_16x16x32_bf16 v[12:15], a[220:223], v[52:55], v[12:15]
 v_mfma_f32_16x16x32_bf16 v[16:19], a[224:227], v[52:55], v[16:19]
 v_mfma_f32_16x16x32_bf16 v[20:23], a[228:231], v[52:55], v[20:23]
 s_waitcnt lgkmcnt(1)
 v_mfma_f32_16x16x32_bf16 v[0:3], a[232:235], v[56:59], v[0:3]
 ds_read_b128 v[52:55], v71 offset:18432
 v_mfma_f32_16x16x32_bf16 v[4:7], a[236:239], v[56:59], v[4:7]
 v_mfma_f32_16x16x32_bf16 v[8:11], a[240:243], v[56:59], v[8:11]
 v_mfma_f32_16x16x32_bf16 v[12:15], a[244:247], v[56:59], v[12:15]
 v_mfma_f32_16x16x32_bf16 v[16:19], a[248:251], v[56:59], v[16:19]
 v_mfma_f32_16x16x32_bf16 v[20:23], a[252:255], v[56:59], v[20:23]
 s_waitcnt lgkmcnt(1)
 v_mfma_f32_16x16x32_bf16 v[24:27], v[80:83], v[48:51], 0
 ds_read_b128 v[56:59], v70 offset:18560
 v_mfma_f32_16x16x32_bf16 v[28:31], v[84:87], v[48:51], 0
 v_mfma_f32_16x16x32_bf16 v[32:35], v[88:91], v[48:51], 0
 v_mfma_f32_16x16x32_bf16 v[36:39], v[92:95], v[48:51], 0
 v_mfma_f32_16x16x32_bf16 v[40:43], v[96:99], v[48:51], 0
 v_mul_f32 v66, s86, v0
 v_mul_f32 v67, s86, v1
 v_mfma_f32_16x16x32_bf16 v[44:47], v[100:103], v[48:51], 0
 s_waitcnt lgkmcnt(1)
 v_mfma_f32_16x16x32_bf16 v[24:27], v[104:107], v[52:55], v[24:27]
 ds_read_b128 v[48:51], v71 offset:18560
 v_mfma_f32_16x16x32_bf16 v[28:31], v[108:111], v[52:55], v[28:31]
 v_exp_f32 v66, v66
 v_mfma_f32_16x16x32_bf16 v[32:35], v[112:115], v[52:55], v[32:35]
 v_mul_f32 v68, s86, v2
 v_mul_f32 v4, v0, v4
 v_mfma_f32_16x16x32_bf16 v[36:39], v[116:119], v[52:55], v[36:39]
 v_exp_f32 v67, v67
 v_mfma_f32_16x16x32_bf16 v[40:43], v[120:123], v[52:55], v[40:43]
 v_mul_f32 v69, s86, v3
 v_add_f32 v66, 1.0, v66
 v_mfma_f32_16x16x32_bf16 v[44:47], v[124:127], v[52:55], v[44:47]
 s_waitcnt lgkmcnt(1)
 v_mfma_f32_16x16x32_bf16 v[24:27], v[128:131], v[56:59], v[24:27]
 ds_read_b128 v[52:55], v70 offset:18688
 v_mfma_f32_16x16x32_bf16 v[28:31], v[132:135], v[56:59], v[28:31]
 v_exp_f32 v68, v68
 v_mfma_f32_16x16x32_bf16 v[32:35], v[136:139], v[56:59], v[32:35]
 v_mul_f32 v5, v1, v5
 v_add_f32 v67, 1.0, v67
 v_mfma_f32_16x16x32_bf16 v[36:39], v[140:143], v[56:59], v[36:39]
 v_rcp_f32 v66, v66
 v_mfma_f32_16x16x32_bf16 v[40:43], v[144:147], v[56:59], v[40:43]
 v_mul_f32 v6, v2, v6
 v_add_f32 v68, 1.0, v68
 v_mfma_f32_16x16x32_bf16 v[44:47], v[148:151], v[56:59], v[44:47]
 s_waitcnt lgkmcnt(1)
 v_mfma_f32_16x16x32_bf16 v[24:27], v[152:155], v[48:51], v[24:27]
 ds_read_b128 v[56:59], v71 offset:18688
 v_mfma_f32_16x16x32_bf16 v[28:31], v[156:159], v[48:51], v[28:31]
 v_exp_f32 v69, v69
 v_mfma_f32_16x16x32_bf16 v[32:35], v[160:163], v[48:51], v[32:35]
 v_mul_f32 v7, v3, v7
 v_mul_f32 v4, v66, v4
 v_mfma_f32_16x16x32_bf16 v[36:39], v[164:167], v[48:51], v[36:39]
 v_rcp_f32 v67, v67
 v_mfma_f32_16x16x32_bf16 v[40:43], v[168:171], v[48:51], v[40:43]
 v_add_f32 v69, 1.0, v69
 v_mfma_f32_16x16x32_bf16 v[44:47], v[172:175], v[48:51], v[44:47]
 s_waitcnt lgkmcnt(1)
 v_mfma_f32_16x16x32_bf16 v[24:27], v[176:179], v[52:55], v[24:27]
 ds_read_b128 v[48:51], v70 offset:18816
 v_mfma_f32_16x16x32_bf16 v[28:31], v[180:183], v[52:55], v[28:31]
 v_rcp_f32 v68, v68
 v_mfma_f32_16x16x32_bf16 v[32:35], v[184:187], v[52:55], v[32:35]
 v_mul_f32 v5, v67, v5
 v_mfma_f32_16x16x32_bf16 v[36:39], v[188:191], v[52:55], v[36:39]
 v_rcp_f32 v69, v69
 v_mfma_f32_16x16x32_bf16 v[40:43], v[192:195], v[52:55], v[40:43]
 v_mul_f32 v6, v68, v6
 v_mul_f32 v7, v69, v7
 v_mfma_f32_16x16x32_bf16 v[44:47], v[196:199], v[52:55], v[44:47]
 v_cvt_pk_bf16_f32 v60, v4, v5
 s_waitcnt lgkmcnt(1)
 v_mfma_f32_16x16x32_bf16 v[24:27], v[200:203], v[56:59], v[24:27]
 ds_read_b128 v[52:55], v71 offset:18816
 v_cvt_pk_bf16_f32 v61, v6, v7
 v_mfma_f32_16x16x32_bf16 v[28:31], v[204:207], v[56:59], v[28:31]
 v_mul_f32 v66, s86, v8
 v_mul_f32 v67, s86, v9
 v_mfma_f32_16x16x32_bf16 v[32:35], v[208:211], v[56:59], v[32:35]
 v_exp_f32 v66, v66
 v_mfma_f32_16x16x32_bf16 v[36:39], v[212:215], v[56:59], v[36:39]
 buffer_load_dword v75, v74, s[8:11], 0 offen sc1
 v_mfma_f32_16x16x32_bf16 v[40:43], v[216:219], v[56:59], v[40:43]
 v_mul_f32 v68, s86, v10
 v_mul_f32 v12, v8, v12
 v_mfma_f32_16x16x32_bf16 v[44:47], v[220:223], v[56:59], v[44:47]
 s_waitcnt lgkmcnt(1)
 v_mfma_f32_16x16x32_bf16 v[24:27], v[224:227], v[48:51], v[24:27]
 ds_read_b128 v[56:59], v70 offset:18944
 v_mfma_f32_16x16x32_bf16 v[28:31], v[228:231], v[48:51], v[28:31]
 v_exp_f32 v67, v67
 v_mfma_f32_16x16x32_bf16 v[32:35], v[232:235], v[48:51], v[32:35]
 v_mov_b32 v76, s95
 v_mul_f32 v69, s86, v11
 v_mfma_f32_16x16x32_bf16 v[36:39], v[236:239], v[48:51], v[36:39]
 s_waitcnt vmcnt(1)
 s_barrier
 buffer_store_dword v76, v77, s[8:11], s94 offen sc1
 v_mfma_f32_16x16x32_bf16 v[40:43], v[240:243], v[48:51], v[40:43]
 v_add_f32 v66, 1.0, v66
 s_mov_b32 s63, s85
 v_mfma_f32_16x16x32_bf16 v[44:47], v[244:247], v[48:51], v[44:47]
 s_mov_b32 s85, s4
 s_mov_b32 s4, s5
 s_waitcnt lgkmcnt(1)
 v_mfma_f32_16x16x32_bf16 v[24:27], v[248:251], v[52:55], v[24:27]
 ds_read_b128 v[48:51], v71 offset:18944
 s_mov_b32 s5, s63
 v_mfma_f32_16x16x32_bf16 v[28:31], v[252:255], v[52:55], v[28:31]
 v_exp_f32 v68, v68
 v_mfma_f32_16x16x32_bf16 v[32:35], a[0:3], v[52:55], v[32:35]
 v_mul_f32 v13, v9, v13
 v_add_f32 v67, 1.0, v67
 v_mfma_f32_16x16x32_bf16 v[36:39], a[4:7], v[52:55], v[36:39]
 v_rcp_f32 v66, v66
 v_mfma_f32_16x16x32_bf16 v[40:43], a[8:11], v[52:55], v[40:43]
 v_mul_f32 v14, v10, v14
 v_add_f32 v68, 1.0, v68
 v_mfma_f32_16x16x32_bf16 v[44:47], a[12:15], v[52:55], v[44:47]
 s_add_u32 s70, s70, s85
 s_mov_b32 s81, s77
 s_waitcnt lgkmcnt(1)
 v_mfma_f32_16x16x32_bf16 v[24:27], a[16:19], v[56:59], v[24:27]
 ds_read_b128 v[52:55], v70 offset:19072
 s_mov_b32 s82, s78
 v_mfma_f32_16x16x32_bf16 v[28:31], a[20:23], v[56:59], v[28:31]
 v_exp_f32 v69, v69
 v_mfma_f32_16x16x32_bf16 v[32:35], a[24:27], v[56:59], v[32:35]
 v_mul_f32 v15, v11, v15
 v_mul_f32 v12, v66, v12
 v_mfma_f32_16x16x32_bf16 v[36:39], a[28:31], v[56:59], v[36:39]
 v_rcp_f32 v67, v67
 v_mfma_f32_16x16x32_bf16 v[40:43], a[32:35], v[56:59], v[40:43]
 v_add_f32 v69, 1.0, v69
 s_mov_b32 s83, s79
 v_mfma_f32_16x16x32_bf16 v[44:47], a[36:39], v[56:59], v[44:47]
 s_mov_b32 s94, s92
 s_mov_b32 s95, s93
 s_waitcnt lgkmcnt(1)
 v_mfma_f32_16x16x32_bf16 v[24:27], a[40:43], v[48:51], v[24:27]
 ds_read_b128 v[56:59], v71 offset:19072
 s_mov_b32 s63, s69
 v_mfma_f32_16x16x32_bf16 v[28:31], a[44:47], v[48:51], v[28:31]
 v_rcp_f32 v68, v68
 v_mfma_f32_16x16x32_bf16 v[32:35], a[48:51], v[48:51], v[32:35]
 v_mul_f32 v13, v67, v13
 s_mul_i32 s63, s63, 294912
 v_mfma_f32_16x16x32_bf16 v[36:39], a[52:55], v[48:51], v[36:39]
 v_rcp_f32 v69, v69
 v_mfma_f32_16x16x32_bf16 v[40:43], a[56:59], v[48:51], v[40:43]
 v_mul_f32 v14, v68, v14
 v_mul_f32 v15, v69, v15
 v_mfma_f32_16x16x32_bf16 v[44:47], a[60:63], v[48:51], v[44:47]
 v_cvt_pk_bf16_f32 v62, v12, v13
 s_waitcnt lgkmcnt(1)
 v_mfma_f32_16x16x32_bf16 v[24:27], a[64:67], v[52:55], v[24:27]
 ds_read_b128 v[48:51], v70 offset:19200
 v_cvt_pk_bf16_f32 v63, v14, v15
 v_mfma_f32_16x16x32_bf16 v[28:31], a[68:71], v[52:55], v[28:31]
 v_mul_f32 v66, s86, v16
 v_mul_f32 v67, s86, v17
 v_mfma_f32_16x16x32_bf16 v[32:35], a[72:75], v[52:55], v[32:35]
 v_exp_f32 v66, v66
 v_mfma_f32_16x16x32_bf16 v[36:39], a[76:79], v[52:55], v[36:39]
 v_mul_f32 v68, s86, v18
 v_mul_f32 v20, v16, v20
 v_mfma_f32_16x16x32_bf16 v[40:43], a[80:83], v[52:55], v[40:43]
 v_exp_f32 v67, v67
 v_mfma_f32_16x16x32_bf16 v[44:47], a[84:87], v[52:55], v[44:47]
 v_mul_f32 v69, s86, v19
 s_waitcnt lgkmcnt(1)
 v_mfma_f32_16x16x32_bf16 v[24:27], a[88:91], v[56:59], v[24:27]
 ds_read_b128 v[52:55], v71 offset:19200
 v_add_f32 v66, 1.0, v66
 v_mfma_f32_16x16x32_bf16 v[28:31], a[92:95], v[56:59], v[28:31]
 v_exp_f32 v68, v68
 v_mfma_f32_16x16x32_bf16 v[32:35], a[96:99], v[56:59], v[32:35]
 v_mul_f32 v21, v17, v21
 v_add_f32 v67, 1.0, v67
 v_mfma_f32_16x16x32_bf16 v[36:39], a[100:103], v[56:59], v[36:39]
 v_rcp_f32 v66, v66
 v_mfma_f32_16x16x32_bf16 v[40:43], a[104:107], v[56:59], v[40:43]
 v_mul_f32 v22, v18, v22
 v_add_f32 v68, 1.0, v68
 v_mfma_f32_16x16x32_bf16 v[44:47], a[108:111], v[56:59], v[44:47]
 s_mul_i32 s64, s68, 18874368
 s_waitcnt lgkmcnt(1)
 v_mfma_f32_16x16x32_bf16 v[24:27], a[112:115], v[48:51], v[24:27]
 ds_read_b128 v[56:59], v70 offset:19328
 s_add_u32 s63, s63, s64
 v_mfma_f32_16x16x32_bf16 v[28:31], a[116:119], v[48:51], v[28:31]
 v_exp_f32 v69, v69
 v_mfma_f32_16x16x32_bf16 v[32:35], a[120:123], v[48:51], v[32:35]
 v_mul_f32 v23, v19, v23
 v_mul_f32 v20, v66, v20
 v_mfma_f32_16x16x32_bf16 v[36:39], a[124:127], v[48:51], v[36:39]
 v_rcp_f32 v67, v67
 v_mfma_f32_16x16x32_bf16 v[40:43], a[128:131], v[48:51], v[40:43]
 v_add_f32 v69, 1.0, v69
 s_add_u32 s77, s63, s87
 v_mfma_f32_16x16x32_bf16 v[44:47], a[132:135], v[48:51], v[44:47]
 s_add_u32 s78, s63, s88
 s_add_u32 s79, s63, s89
 s_waitcnt lgkmcnt(1)
 v_mfma_f32_16x16x32_bf16 v[24:27], a[136:139], v[52:55], v[24:27]
 ds_read_b128 v[48:51], v71 offset:19328
 s_mul_i32 s92, s68, 4096
 v_mfma_f32_16x16x32_bf16 v[28:31], a[140:143], v[52:55], v[28:31]
 v_rcp_f32 v68, v68
 v_mfma_f32_16x16x32_bf16 v[32:35], a[144:147], v[52:55], v[32:35]
 v_mul_f32 v21, v67, v21
 s_sub_u32 s93, s80, 1
 v_mfma_f32_16x16x32_bf16 v[36:39], a[148:151], v[52:55], v[36:39]
 v_rcp_f32 v69, v69
 v_mfma_f32_16x16x32_bf16 v[40:43], a[152:155], v[52:55], v[40:43]
 v_mul_f32 v22, v68, v22
 v_mul_f32 v23, v69, v23
 v_mfma_f32_16x16x32_bf16 v[44:47], a[156:159], v[52:55], v[44:47]
 s_waitcnt vmcnt(1)
 v_cmp_gt_u32 vcc, s74, v75
 s_waitcnt lgkmcnt(1)
 v_mfma_f32_16x16x32_bf16 v[24:27], a[160:163], v[56:59], v[24:27]
 ds_read_b128 v[52:55], v70 offset:19456
 v_cmp_gt_u32 s[66:67], s75, v75
 v_mfma_f32_16x16x32_bf16 v[28:31], a[164:167], v[56:59], v[28:31]
 v_cvt_pk_bf16_f32 v64, v20, v21
 v_cvt_pk_bf16_f32 v65, v22, v23
 v_mfma_f32_16x16x32_bf16 v[32:35], a[168:171], v[56:59], v[32:35]
 s_min_u32 s93, s93, 64
 s_add_u32 s61, s61, 1
 v_mfma_f32_16x16x32_bf16 v[36:39], a[172:175], v[56:59], v[36:39]
 s_cmp_eq_u32 s67, 0
 s_cselect_b32 s72, 2, 0
 s_cmp_eq_u32 vcc_lo, 0
 s_cselect_b32 s72, 1, s72
 v_mfma_f32_16x16x32_bf16 v[40:43], a[176:179], v[56:59], v[40:43]
 v_mov_b32 v76, s72
 v_mfma_f32_16x16x32_bf16 v[44:47], a[180:183], v[56:59], v[44:47]
 ds_write_b32 v72, v76 offset:4
 s_waitcnt lgkmcnt(2)
 v_mfma_f32_16x16x32_bf16 v[24:27], a[184:187], v[48:51], v[24:27]
 ds_read_b128 v[56:59], v71 offset:19456
 v_mfma_f32_16x16x32_bf16 v[28:31], a[188:191], v[48:51], v[28:31]
 v_mfma_f32_16x16x32_bf16 v[32:35], a[192:195], v[48:51], v[32:35]
 v_mfma_f32_16x16x32_bf16 v[36:39], a[196:199], v[48:51], v[36:39]
 v_mfma_f32_16x16x32_bf16 v[40:43], a[200:203], v[48:51], v[40:43]
 v_mfma_f32_16x16x32_bf16 v[44:47], a[204:207], v[48:51], v[44:47]
 s_waitcnt lgkmcnt(1)
 s_branch L_u_fe
L_u_p0e:
 s_waitcnt lgkmcnt(1)
 v_mfma_f32_16x16x32_bf16 v[0:3], v[80:83], v[48:51], 0
 ds_read_b128 v[56:59], v70 offset:128
 v_mfma_f32_16x16x32_bf16 v[4:7], v[84:87], v[48:51], 0
 v_mfma_f32_16x16x32_bf16 v[8:11], v[88:91], v[48:51], 0
 v_mfma_f32_16x16x32_bf16 v[12:15], v[92:95], v[48:51], 0
 v_mfma_f32_16x16x32_bf16 v[16:19], v[96:99], v[48:51], 0
 v_mul_f32 v66, s86, v24
 v_mul_f32 v67, s86, v25
 v_mfma_f32_16x16x32_bf16 v[20:23], v[100:103], v[48:51], 0
 s_waitcnt lgkmcnt(1)
 v_mfma_f32_16x16x32_bf16 v[0:3], v[104:107], v[52:55], v[0:3]
 ds_read_b128 v[48:51], v71 offset:128
 v_mfma_f32_16x16x32_bf16 v[4:7], v[108:111], v[52:55], v[4:7]
 v_exp_f32 v66, v66
 v_mfma_f32_16x16x32_bf16 v[8:11], v[112:115], v[52:55], v[8:11]
 v_mul_f32 v68, s86, v26
 v_mul_f32 v28, v24, v28
 v_mfma_f32_16x16x32_bf16 v[12:15], v[116:119], v[52:55], v[12:15]
 v_exp_f32 v67, v67
 v_mfma_f32_16x16x32_bf16 v[16:19], v[120:123], v[52:55], v[16:19]
 v_mul_f32 v69, s86, v27
 v_add_f32 v66, 1.0, v66
 v_mfma_f32_16x16x32_bf16 v[20:23], v[124:127], v[52:55], v[20:23]
 s_waitcnt lgkmcnt(1)
 v_mfma_f32_16x16x32_bf16 v[0:3], v[128:131], v[56:59], v[0:3]
 ds_read_b128 v[52:55], v70 offset:256
 v_mfma_f32_16x16x32_bf16 v[4:7], v[132:135], v[56:59], v[4:7]
 v_exp_f32 v68, v68
 v_mfma_f32_16x16x32_bf16 v[8:11], v[136:139], v[56:59], v[8:11]
 v_mul_f32 v29, v25, v29
 v_add_f32 v67, 1.0, v67
 v_mfma_f32_16x16x32_bf16 v[12:15], v[140:143], v[56:59], v[12:15]
 v_rcp_f32 v66, v66
 v_mfma_f32_16x16x32_bf16 v[16:19], v[144:147], v[56:59], v[16:19]
 v_mul_f32 v30, v26, v30
 v_add_f32 v68, 1.0, v68
 v_mfma_f32_16x16x32_bf16 v[20:23], v[148:151], v[56:59], v[20:23]
 s_waitcnt lgkmcnt(1)
 v_mfma_f32_16x16x32_bf16 v[0:3], v[152:155], v[48:51], v[0:3]
 ds_read_b128 v[56:59], v71 offset:256
 v_mfma_f32_16x16x32_bf16 v[4:7], v[156:159], v[48:51], v[4:7]
 v_exp_f32 v69, v69
 v_mfma_f32_16x16x32_bf16 v[8:11], v[160:163], v[48:51], v[8:11]
 v_mul_f32 v31, v27, v31
 v_mul_f32 v28, v66, v28
 v_mfma_f32_16x16x32_bf16 v[12:15], v[164:167], v[48:51], v[12:15]
 v_rcp_f32 v67, v67
 v_mfma_f32_16x16x32_bf16 v[16:19], v[168:171], v[48:51], v[16:19]
 v_add_f32 v69, 1.0, v69
 v_mfma_f32_16x16x32_bf16 v[20:23], v[172:175], v[48:51], v[20:23]
 s_waitcnt lgkmcnt(1)
 v_mfma_f32_16x16x32_bf16 v[0:3], v[176:179], v[52:55], v[0:3]
 ds_read_b128 v[48:51], v70 offset:384
 v_mfma_f32_16x16x32_bf16 v[4:7], v[180:183], v[52:55], v[4:7]
 v_rcp_f32 v68, v68
 v_mfma_f32_16x16x32_bf16 v[8:11], v[184:187], v[52:55], v[8:11]
 v_mul_f32 v29, v67, v29
 v_mfma_f32_16x16x32_bf16 v[12:15], v[188:191], v[52:55], v[12:15]
 v_rcp_f32 v69, v69
 v_mfma_f32_16x16x32_bf16 v[16:19], v[192:195], v[52:55], v[16:19]
 v_mul_f32 v30, v68, v30
 v_mul_f32 v31, v69, v31
 v_mfma_f32_16x16x32_bf16 v[20:23], v[196:199], v[52:55], v[20:23]
 s_waitcnt lgkmcnt(1)
 v_mfma_f32_16x16x32_bf16 v[0:3], v[200:203], v[56:59], v[0:3]
 ds_read_b128 v[52:55], v71 offset:384
 v_mfma_f32_16x16x32_bf16 v[4:7], v[204:207], v[56:59], v[4:7]
 v_mov_b64 v[24:25], v[60:61]
 v_cvt_pk_bf16_f32 v26, v28, v29
 v_mfma_f32_16x16x32_bf16 v[8:11], v[208:211], v[56:59], v[8:11]
 v_cvt_pk_bf16_f32 v27, v30, v31
 s_nop 0
 v_mfma_f32_16x16x32_bf16 v[12:15], v[212:215], v[56:59], v[12:15]
 v_permlane32_swap_b32 v24, v26
 v_mfma_f32_16x16x32_bf16 v[16:19], v[216:219], v[56:59], v[16:19]
 v_permlane32_swap_b32 v25, v27
 v_mfma_f32_16x16x32_bf16 v[20:23], v[220:223], v[56:59], v[20:23]
 v_mul_f32 v66, s86, v32
 s_waitcnt lgkmcnt(1)
 v_mfma_f32_16x16x32_bf16 v[0:3], v[224:227], v[48:51], v[0:3]
 ds_read_b128 v[56:59], v70 offset:512
 v_mul_f32 v67, s86, v33
 v_mfma_f32_16x16x32_bf16 v[4:7], v[228:231], v[48:51], v[4:7]
 buffer_store_dwordx4 v[24:27], v73, s[8:11], s81 offen sc1
 v_mfma_f32_16x16x32_bf16 v[8:11], v[232:235], v[48:51], v[8:11]
 v_exp_f32 v66, v66
 v_mfma_f32_16x16x32_bf16 v[12:15], v[236:239], v[48:51], v[12:15]
 v_mul_f32 v68, s86, v34
 v_mul_f32 v36, v32, v36
 v_mfma_f32_16x16x32_bf16 v[16:19], v[240:243], v[48:51], v[16:19]
 v_exp_f32 v67, v67
 v_mfma_f32_16x16x32_bf16 v[20:23], v[244:247], v[48:51], v[20:23]
 v_mul_f32 v69, s86, v35
 s_waitcnt lgkmcnt(1)
 v_mfma_f32_16x16x32_bf16 v[0:3], v[248:251], v[52:55], v[0:3]
 ds_read_b128 v[48:51], v71 offset:512
 v_add_f32 v66, 1.0, v66
 v_mfma_f32_16x16x32_bf16 v[4:7], v[252:255], v[52:55], v[4:7]
 v_exp_f32 v68, v68
 v_mfma_f32_16x16x32_bf16 v[8:11], a[0:3], v[52:55], v[8:11]
 buffer_load_dword v75, v74, s[8:11], 0 offen sc1
 v_mfma_f32_16x16x32_bf16 v[12:15], a[4:7], v[52:55], v[12:15]
 v_mul_f32 v37, v33, v37
 v_add_f32 v67, 1.0, v67
 v_mfma_f32_16x16x32_bf16 v[16:19], a[8:11], v[52:55], v[16:19]
 v_rcp_f32 v66, v66
 v_mfma_f32_16x16x32_bf16 v[20:23], a[12:15], v[52:55], v[20:23]
 v_mul_f32 v38, v34, v38
 s_waitcnt lgkmcnt(1)
 v_mfma_f32_16x16x32_bf16 v[0:3], a[16:19], v[56:59], v[0:3]
 ds_read_b128 v[52:55], v70 offset:640
 v_add_f32 v68, 1.0, v68
 v_mfma_f32_16x16x32_bf16 v[4:7], a[20:23], v[56:59], v[4:7]
 v_exp_f32 v69, v69
 v_mfma_f32_16x16x32_bf16 v[8:11], a[24:27], v[56:59], v[8:11]
 v_mul_f32 v39, v35, v39
 v_mul_f32 v36, v66, v36
 v_mfma_f32_16x16x32_bf16 v[12:15], a[28:31], v[56:59], v[12:15]
 v_rcp_f32 v67, v67
 v_mfma_f32_16x16x32_bf16 v[16:19], a[32:35], v[56:59], v[16:19]
 v_add_f32 v69, 1.0, v69
 v_mfma_f32_16x16x32_bf16 v[20:23], a[36:39], v[56:59], v[20:23]
 s_waitcnt lgkmcnt(1)
 v_mfma_f32_16x16x32_bf16 v[0:3], a[40:43], v[48:51], v[0:3]
 ds_read_b128 v[56:59], v71 offset:640
 v_mfma_f32_16x16x32_bf16 v[4:7], a[44:47], v[48:51], v[4:7]
 v_rcp_f32 v68, v68
 v_mfma_f32_16x16x32_bf16 v[8:11], a[48:51], v[48:51], v[8:11]
 v_mul_f32 v37, v67, v37
 v_mfma_f32_16x16x32_bf16 v[12:15], a[52:55], v[48:51], v[12:15]
 v_rcp_f32 v69, v69
 v_mfma_f32_16x16x32_bf16 v[16:19], a[56:59], v[48:51], v[16:19]
 v_mul_f32 v38, v68, v38
 v_mul_f32 v39, v69, v39
 v_mfma_f32_16x16x32_bf16 v[20:23], a[60:63], v[48:51], v[20:23]
 s_waitcnt lgkmcnt(1)
 v_mfma_f32_16x16x32_bf16 v[0:3], a[64:67], v[52:55], v[0:3]
 ds_read_b128 v[48:51], v70 offset:768
 v_mfma_f32_16x16x32_bf16 v[4:7], a[68:71], v[52:55], v[4:7]
 v_mov_b64 v[32:33], v[62:63]
 v_cvt_pk_bf16_f32 v34, v36, v37
 v_mfma_f32_16x16x32_bf16 v[8:11], a[72:75], v[52:55], v[8:11]
 v_cvt_pk_bf16_f32 v35, v38, v39
 s_nop 0
 v_mfma_f32_16x16x32_bf16 v[12:15], a[76:79], v[52:55], v[12:15]
 v_permlane32_swap_b32 v32, v34
 v_mfma_f32_16x16x32_bf16 v[16:19], a[80:83], v[52:55], v[16:19]
 v_permlane32_swap_b32 v33, v35
 v_mfma_f32_16x16x32_bf16 v[20:23], a[84:87], v[52:55], v[20:23]
 v_mul_f32 v66, s86, v40
 s_waitcnt lgkmcnt(1)
 v_mfma_f32_16x16x32_bf16 v[0:3], a[88:91], v[56:59], v[0:3]
 ds_read_b128 v[52:55], v71 offset:768
 v_mul_f32 v67, s86, v41
 v_mfma_f32_16x16x32_bf16 v[4:7], a[92:95], v[56:59], v[4:7]
 buffer_store_dwordx4 v[32:35], v73, s[8:11], s82 offen sc1
 v_mfma_f32_16x16x32_bf16 v[8:11], a[96:99], v[56:59], v[8:11]
 v_exp_f32 v66, v66
 v_mfma_f32_16x16x32_bf16 v[12:15], a[100:103], v[56:59], v[12:15]
 v_mul_f32 v68, s86, v42
 v_mul_f32 v44, v40, v44
 v_mfma_f32_16x16x32_bf16 v[16:19], a[104:107], v[56:59], v[16:19]
 v_exp_f32 v67, v67
 v_mfma_f32_16x16x32_bf16 v[20:23], a[108:111], v[56:59], v[20:23]
 v_mul_f32 v69, s86, v43
 s_waitcnt lgkmcnt(1)
 v_mfma_f32_16x16x32_bf16 v[0:3], a[112:115], v[48:51], v[0:3]
 ds_read_b128 v[56:59], v70 offset:896
 v_add_f32 v66, 1.0, v66
 v_mfma_f32_16x16x32_bf16 v[4:7], a[116:119], v[48:51], v[4:7]
 v_exp_f32 v68, v68
 v_mfma_f32_16x16x32_bf16 v[8:11], a[120:123], v[48:51], v[8:11]
 v_mul_f32 v45, v41, v45
 v_add_f32 v67, 1.0, v67
 v_mfma_f32_16x16x32_bf16 v[12:15], a[124:127], v[48:51], v[12:15]
 v_rcp_f32 v66, v66
 v_mfma_f32_16x16x32_bf16 v[16:19], a[128:131], v[48:51], v[16:19]
 v_mul_f32 v46, v42, v46
 v_add_f32 v68, 1.0, v68
 v_mfma_f32_16x16x32_bf16 v[20:23], a[132:135], v[48:51], v[20:23]
 s_waitcnt lgkmcnt(1)
 v_mfma_f32_16x16x32_bf16 v[0:3], a[136:139], v[52:55], v[0:3]
 ds_read_b128 v[48:51], v71 offset:896
 v_mfma_f32_16x16x32_bf16 v[4:7], a[140:143], v[52:55], v[4:7]
 v_exp_f32 v69, v69
 v_mfma_f32_16x16x32_bf16 v[8:11], a[144:147], v[52:55], v[8:11]
 v_mul_f32 v47, v43, v47
 v_mul_f32 v44, v66, v44
 v_mfma_f32_16x16x32_bf16 v[12:15], a[148:151], v[52:55], v[12:15]
 v_rcp_f32 v67, v67
 v_mfma_f32_16x16x32_bf16 v[16:19], a[152:155], v[52:55], v[16:19]
 v_add_f32 v69, 1.0, v69
 v_mfma_f32_16x16x32_bf16 v[20:23], a[156:159], v[52:55], v[20:23]
 s_waitcnt vmcnt(1)
 v_cmp_gt_u32 vcc, s74, v75
 s_waitcnt lgkmcnt(1)
 v_mfma_f32_16x16x32_bf16 v[0:3], a[160:163], v[56:59], v[0:3]
 ds_read_b128 v[52:55], v70 offset:1024
 v_cmp_gt_u32 s[66:67], s75, v75
 v_mfma_f32_16x16x32_bf16 v[4:7], a[164:167], v[56:59], v[4:7]
 v_rcp_f32 v68, v68
 v_mfma_f32_16x16x32_bf16 v[8:11], a[168:171], v[56:59], v[8:11]
 v_mul_f32 v45, v67, v45
 v_mfma_f32_16x16x32_bf16 v[12:15], a[172:175], v[56:59], v[12:15]
 s_cmp_eq_u32 s67, 0
 s_cselect_b32 s72, 2, 0
 s_cmp_eq_u32 vcc_lo, 0
 s_cselect_b32 s72, 1, s72
 v_mfma_f32_16x16x32_bf16 v[16:19], a[176:179], v[56:59], v[16:19]
 v_mov_b32 v76, s72
 v_mfma_f32_16x16x32_bf16 v[20:23], a[180:183], v[56:59], v[20:23]
 ds_write_b32 v72, v76 offset:0
 s_waitcnt lgkmcnt(2)
 v_mfma_f32_16x16x32_bf16 v[0:3], a[184:187], v[48:51], v[0:3]
 ds_read_b128 v[56:59], v71 offset:1024
 v_mfma_f32_16x16x32_bf16 v[4:7], a[188:191], v[48:51], v[4:7]
 v_rcp_f32 v69, v69
 v_mfma_f32_16x16x32_bf16 v[8:11], a[192:195], v[48:51], v[8:11]
 v_mul_f32 v46, v68, v46
 v_mul_f32 v47, v69, v47
 v_mfma_f32_16x16x32_bf16 v[12:15], a[196:199], v[48:51], v[12:15]
 v_mov_b64 v[40:41], v[64:65]
 v_cvt_pk_bf16_f32 v42, v44, v45
 v_mfma_f32_16x16x32_bf16 v[16:19], a[200:203], v[48:51], v[16:19]
 v_cvt_pk_bf16_f32 v43, v46, v47
 s_nop 0
 v_mfma_f32_16x16x32_bf16 v[20:23], a[204:207], v[48:51], v[20:23]
 s_waitcnt vmcnt(3)
 s_waitcnt lgkmcnt(1)
 s_barrier
 ds_read_b32 v76, v73 offset:0
 v_mfma_f32_16x16x32_bf16 v[0:3], a[208:211], v[52:55], v[0:3]
 ds_read_b128 v[48:51], v70 offset:18432
 v_mfma_f32_16x16x32_bf16 v[4:7], a[212:215], v[52:55], v[4:7]
 v_permlane32_swap_b32 v40, v42
 v_mfma_f32_16x16x32_bf16 v[8:11], a[216:219], v[52:55], v[8:11]
 v_permlane32_swap_b32 v41, v43
 v_mfma_f32_16x16x32_bf16 v[12:15], a[220:223], v[52:55], v[12:15]
 buffer_store_dwordx4 v[40:43], v73, s[8:11], s83 offen sc1
 v_mfma_f32_16x16x32_bf16 v[16:19], a[224:227], v[52:55], v[16:19]
 v_mfma_f32_16x16x32_bf16 v[20:23], a[228:231], v[52:55], v[20:23]
 s_waitcnt lgkmcnt(2)
 v_mfma_f32_16x16x32_bf16 v[0:3], a[232:235], v[56:59], v[0:3]
 ds_read_b128 v[52:55], v71 offset:18432
 v_mfma_f32_16x16x32_bf16 v[4:7], a[236:239], v[56:59], v[4:7]
 v_mfma_f32_16x16x32_bf16 v[8:11], a[240:243], v[56:59], v[8:11]
 s_waitcnt lgkmcnt(2)
 v_readfirstlane_b32 s72, v76
 v_mfma_f32_16x16x32_bf16 v[12:15], a[244:247], v[56:59], v[12:15]
 v_mfma_f32_16x16x32_bf16 v[16:19], a[248:251], v[56:59], v[16:19]
 v_mfma_f32_16x16x32_bf16 v[20:23], a[252:255], v[56:59], v[20:23]
 s_cmp_lg_u32 s72, 0
 s_cbranch_scc1 L_u_p1d
 s_branch L_u_p1n
L_u_p1d:
 s_waitcnt lgkmcnt(1)
 v_mfma_f32_16x16x32_bf16 v[24:27], v[80:83], v[48:51], 0
 ds_read_b128 v[56:59], v70 offset:18560
 buffer_load_dword v75, v74, s[8:11], 0 offen sc1
 v_mfma_f32_16x16x32_bf16 v[28:31], v[84:87], v[48:51], 0
 s_sub_u32 s68, s72, 1
 s_cmp_eq_u32 s68, 0
 s_cselect_b32 s69, s74, s75
 s_cselect_b32 s63, s44, s47
 s_cselect_b32 s64, s45, s48
 s_cselect_b32 s80, s46, s49
 v_mfma_f32_16x16x32_bf16 v[32:35], v[88:91], v[48:51], 0
 s_cmp_lt_u32 s69, s63
 s_cselect_b32 s80, s64, s80
 s_add_u32 s80, s80, s69
 s_cmp_eq_u32 s68, 0
 s_cselect_b32 s74, s80, s74
 s_cselect_b32 s75, s75, s80
 v_mfma_f32_16x16x32_bf16 v[36:39], v[92:95], v[48:51], 0
 s_mul_i32 s73, s69, 36864
 s_mul_i32 s63, s68, 2359296
 s_add_u32 s73, s73, s63
 s_add_u32 s73, s73, s90
 v_mfma_f32_16x16x32_bf16 v[40:43], v[96:99], v[48:51], 0
 s_mov_b32 m0, s70
 v_mul_f32 v66, s86, v0
 v_mfma_f32_16x16x32_bf16 v[44:47], v[100:103], v[48:51], 0
 buffer_load_dwordx4 v72, s[8:11], s73 offen sc1 lds
 s_waitcnt lgkmcnt(1)
 v_mfma_f32_16x16x32_bf16 v[24:27], v[104:107], v[52:55], v[24:27]
 ds_read_b128 v[48:51], v71 offset:18560
 v_mul_f32 v67, s86, v1
 v_mfma_f32_16x16x32_bf16 v[28:31], v[108:111], v[52:55], v[28:31]
 v_exp_f32 v66, v66
 v_mfma_f32_16x16x32_bf16 v[32:35], v[112:115], v[52:55], v[32:35]
 v_mul_f32 v68, s86, v2
 v_mul_f32 v4, v0, v4
 v_mfma_f32_16x16x32_bf16 v[36:39], v[116:119], v[52:55], v[36:39]
 v_exp_f32 v67, v67
 v_mfma_f32_16x16x32_bf16 v[40:43], v[120:123], v[52:55], v[40:43]
 s_add_u32 m0, m0, s3
 s_add_u32 s73, s73, s3
 v_mul_f32 v69, s86, v3
 v_mfma_f32_16x16x32_bf16 v[44:47], v[124:127], v[52:55], v[44:47]
 buffer_load_dwordx4 v72, s[8:11], s73 offen sc1 lds
 s_waitcnt lgkmcnt(1)
 v_mfma_f32_16x16x32_bf16 v[24:27], v[128:131], v[56:59], v[24:27]
 ds_read_b128 v[52:55], v70 offset:18688
 v_add_f32 v66, 1.0, v66
 v_mfma_f32_16x16x32_bf16 v[28:31], v[132:135], v[56:59], v[28:31]
 v_exp_f32 v68, v68
 v_mfma_f32_16x16x32_bf16 v[32:35], v[136:139], v[56:59], v[32:35]
 v_mul_f32 v5, v1, v5
 v_add_f32 v67, 1.0, v67
 v_mfma_f32_16x16x32_bf16 v[36:39], v[140:143], v[56:59], v[36:39]
 v_rcp_f32 v66, v66
 v_mfma_f32_16x16x32_bf16 v[40:43], v[144:147], v[56:59], v[40:43]
 s_add_u32 m0, m0, s3
 s_add_u32 s73, s73, s3
 v_mul_f32 v6, v2, v6
 v_mfma_f32_16x16x32_bf16 v[44:47], v[148:151], v[56:59], v[44:47]
 buffer_load_dwordx4 v72, s[8:11], s73 offen sc1 lds
 s_waitcnt lgkmcnt(1)
 v_mfma_f32_16x16x32_bf16 v[24:27], v[152:155], v[48:51], v[24:27]
 ds_read_b128 v[56:59], v71 offset:18688
 v_add_f32 v68, 1.0, v68
 v_mfma_f32_16x16x32_bf16 v[28:31], v[156:159], v[48:51], v[28:31]
 v_exp_f32 v69, v69
 v_mfma_f32_16x16x32_bf16 v[32:35], v[160:163], v[48:51], v[32:35]
 v_mul_f32 v7, v3, v7
 v_mul_f32 v4, v66, v4
 v_mfma_f32_16x16x32_bf16 v[36:39], v[164:167], v[48:51], v[36:39]
 v_rcp_f32 v67, v67
 v_mfma_f32_16x16x32_bf16 v[40:43], v[168:171], v[48:51], v[40:43]
 s_add_u32 m0, m0, s3
 s_add_u32 s73, s73, s3
 v_add_f32 v69, 1.0, v69
 v_mfma_f32_16x16x32_bf16 v[44:47], v[172:175], v[48:51], v[44:47]
 buffer_load_dwordx4 v72, s[8:11], s73 offen sc1 lds
 s_waitcnt lgkmcnt(1)
 v_mfma_f32_16x16x32_bf16 v[24:27], v[176:179], v[52:55], v[24:27]
 ds_read_b128 v[48:51], v70 offset:18816
 v_mfma_f32_16x16x32_bf16 v[28:31], v[180:183], v[52:55], v[28:31]
 v_rcp_f32 v68, v68
 v_mfma_f32_16x16x32_bf16 v[32:35], v[184:187], v[52:55], v[32:35]
 v_mul_f32 v5, v67, v5
 v_mfma_f32_16x16x32_bf16 v[36:39], v[188:191], v[52:55], v[36:39]
 v_rcp_f32 v69, v69
 v_mfma_f32_16x16x32_bf16 v[40:43], v[192:195], v[52:55], v[40:43]
 s_add_u32 m0, m0, s3
 s_add_u32 s73, s73, s3
 v_mul_f32 v6, v68, v6
 v_mfma_f32_16x16x32_bf16 v[44:47], v[196:199], v[52:55], v[44:47]
 buffer_load_dwordx4 v72, s[8:11], s73 offen sc1 lds
 s_waitcnt lgkmcnt(1)
 v_mfma_f32_16x16x32_bf16 v[24:27], v[200:203], v[56:59], v[24:27]
 ds_read_b128 v[52:55], v71 offset:18816
 v_mul_f32 v7, v69, v7
 v_mfma_f32_16x16x32_bf16 v[28:31], v[204:207], v[56:59], v[28:31]
 v_cvt_pk_bf16_f32 v60, v4, v5
 v_cvt_pk_bf16_f32 v61, v6, v7
 v_mfma_f32_16x16x32_bf16 v[32:35], v[208:211], v[56:59], v[32:35]
 v_mul_f32 v66, s86, v8
 v_mul_f32 v67, s86, v9
 v_mfma_f32_16x16x32_bf16 v[36:39], v[212:215], v[56:59], v[36:39]
 v_exp_f32 v66, v66
 v_mfma_f32_16x16x32_bf16 v[40:43], v[216:219], v[56:59], v[40:43]
 s_add_u32 m0, m0, s3
 s_add_u32 s73, s73, s3
 v_mul_f32 v68, s86, v10
 v_mfma_f32_16x16x32_bf16 v[44:47], v[220:223], v[56:59], v[44:47]
 buffer_load_dwordx4 v72, s[8:11], s73 offen sc1 lds
 s_waitcnt lgkmcnt(1)
 v_mfma_f32_16x16x32_bf16 v[24:27], v[224:227], v[48:51], v[24:27]
 ds_read_b128 v[56:59], v70 offset:18944
 v_mul_f32 v12, v8, v12
 v_mfma_f32_16x16x32_bf16 v[28:31], v[228:231], v[48:51], v[28:31]
 v_exp_f32 v67, v67
 v_mfma_f32_16x16x32_bf16 v[32:35], v[232:235], v[48:51], v[32:35]
 v_mov_b32 v76, s95
 v_mul_f32 v69, s86, v11
 v_mfma_f32_16x16x32_bf16 v[36:39], v[236:239], v[48:51], v[36:39]
 s_waitcnt vmcnt(6)
 s_barrier
 buffer_store_dword v76, v77, s[8:11], s94 offen sc1
 v_mfma_f32_16x16x32_bf16 v[40:43], v[240:243], v[48:51], v[40:43]
 s_add_u32 m0, m0, s3
 s_add_u32 s73, s73, s3
 v_add_f32 v66, 1.0, v66
 v_mfma_f32_16x16x32_bf16 v[44:47], v[244:247], v[48:51], v[44:47]
 buffer_load_dwordx4 v72, s[8:11], s73 offen sc1 lds
 s_waitcnt lgkmcnt(1)
 v_mfma_f32_16x16x32_bf16 v[24:27], v[248:251], v[52:55], v[24:27]
 ds_read_b128 v[48:51], v71 offset:18944
 v_mfma_f32_16x16x32_bf16 v[28:31], v[252:255], v[52:55], v[28:31]
 v_exp_f32 v68, v68
 v_mfma_f32_16x16x32_bf16 v[32:35], a[0:3], v[52:55], v[32:35]
 v_mul_f32 v13, v9, v13
 v_add_f32 v67, 1.0, v67
 v_mfma_f32_16x16x32_bf16 v[36:39], a[4:7], v[52:55], v[36:39]
 v_rcp_f32 v66, v66
 v_mfma_f32_16x16x32_bf16 v[40:43], a[8:11], v[52:55], v[40:43]
 s_add_u32 m0, m0, s3
 s_add_u32 s73, s73, s3
 v_mul_f32 v14, v10, v14
 v_mfma_f32_16x16x32_bf16 v[44:47], a[12:15], v[52:55], v[44:47]
 buffer_load_dwordx4 v72, s[8:11], s73 offen sc1 lds
 s_waitcnt lgkmcnt(1)
 v_mfma_f32_16x16x32_bf16 v[24:27], a[16:19], v[56:59], v[24:27]
 ds_read_b128 v[52:55], v70 offset:19072
 v_add_f32 v68, 1.0, v68
 v_mfma_f32_16x16x32_bf16 v[28:31], a[20:23], v[56:59], v[28:31]
 v_exp_f32 v69, v69
 v_mfma_f32_16x16x32_bf16 v[32:35], a[24:27], v[56:59], v[32:35]
 v_mul_f32 v15, v11, v15
 v_mul_f32 v12, v66, v12
 v_mfma_f32_16x16x32_bf16 v[36:39], a[28:31], v[56:59], v[36:39]
 v_rcp_f32 v67, v67
 v_mfma_f32_16x16x32_bf16 v[40:43], a[32:35], v[56:59], v[40:43]
 s_add_u32 m0, m0, s3
 s_add_u32 s73, s73, s3
 v_add_f32 v69, 1.0, v69
 v_mfma_f32_16x16x32_bf16 v[44:47], a[36:39], v[56:59], v[44:47]
 buffer_load_dwordx4 v72, s[8:11], s73 offen sc1 lds
 s_waitcnt lgkmcnt(1)
 v_mfma_f32_16x16x32_bf16 v[24:27], a[40:43], v[48:51], v[24:27]
 ds_read_b128 v[56:59], v71 offset:19072
 s_mov_b32 s63, s85
 v_mfma_f32_16x16x32_bf16 v[28:31], a[44:47], v[48:51], v[28:31]
 v_rcp_f32 v68, v68
 v_mfma_f32_16x16x32_bf16 v[32:35], a[48:51], v[48:51], v[32:35]
 v_mul_f32 v13, v67, v13
 s_mov_b32 s85, s4
 v_mfma_f32_16x16x32_bf16 v[36:39], a[52:55], v[48:51], v[36:39]
 v_rcp_f32 v69, v69
 v_mfma_f32_16x16x32_bf16 v[40:43], a[56:59], v[48:51], v[40:43]
 v_mul_f32 v14, v68, v14
 v_mul_f32 v15, v69, v15
 v_mfma_f32_16x16x32_bf16 v[44:47], a[60:63], v[48:51], v[44:47]
 v_cvt_pk_bf16_f32 v62, v12, v13
 s_waitcnt lgkmcnt(1)
 v_mfma_f32_16x16x32_bf16 v[24:27], a[64:67], v[52:55], v[24:27]
 ds_read_b128 v[48:51], v70 offset:19200
 v_cvt_pk_bf16_f32 v63, v14, v15
 v_mfma_f32_16x16x32_bf16 v[28:31], a[68:71], v[52:55], v[28:31]
 v_mul_f32 v66, s86, v16
 v_mul_f32 v67, s86, v17
 v_mfma_f32_16x16x32_bf16 v[32:35], a[72:75], v[52:55], v[32:35]
 v_exp_f32 v66, v66
 v_mfma_f32_16x16x32_bf16 v[36:39], a[76:79], v[52:55], v[36:39]
 v_mul_f32 v68, s86, v18
 v_mul_f32 v20, v16, v20
 v_mfma_f32_16x16x32_bf16 v[40:43], a[80:83], v[52:55], v[40:43]
 v_exp_f32 v67, v67
 v_mfma_f32_16x16x32_bf16 v[44:47], a[84:87], v[52:55], v[44:47]
 v_mul_f32 v69, s86, v19
 s_waitcnt lgkmcnt(1)
 v_mfma_f32_16x16x32_bf16 v[24:27], a[88:91], v[56:59], v[24:27]
 ds_read_b128 v[52:55], v71 offset:19200
 v_add_f32 v66, 1.0, v66
 v_mfma_f32_16x16x32_bf16 v[28:31], a[92:95], v[56:59], v[28:31]
 v_exp_f32 v68, v68
 v_mfma_f32_16x16x32_bf16 v[32:35], a[96:99], v[56:59], v[32:35]
 v_mul_f32 v21, v17, v21
 v_add_f32 v67, 1.0, v67
 v_mfma_f32_16x16x32_bf16 v[36:39], a[100:103], v[56:59], v[36:39]
 v_rcp_f32 v66, v66
 v_mfma_f32_16x16x32_bf16 v[40:43], a[104:107], v[56:59], v[40:43]
 v_mul_f32 v22, v18, v22
 v_add_f32 v68, 1.0, v68
 v_mfma_f32_16x16x32_bf16 v[44:47], a[108:111], v[56:59], v[44:47]
 s_mov_b32 s4, s5
 s_mov_b32 s5, s63
 s_waitcnt lgkmcnt(1)
 v_mfma_f32_16x16x32_bf16 v[24:27], a[112:115], v[48:51], v[24:27]
 ds_read_b128 v[56:59], v70 offset:19328
 s_add_u32 s70, s70, s85
 v_mfma_f32_16x16x32_bf16 v[28:31], a[116:119], v[48:51], v[28:31]
 v_exp_f32 v69, v69
 v_mfma_f32_16x16x32_bf16 v[32:35], a[120:123], v[48:51], v[32:35]
 v_mul_f32 v23, v19, v23
 v_mul_f32 v20, v66, v20
 v_mfma_f32_16x16x32_bf16 v[36:39], a[124:127], v[48:51], v[36:39]
 v_rcp_f32 v67, v67
 v_mfma_f32_16x16x32_bf16 v[40:43], a[128:131], v[48:51], v[40:43]
 v_add_f32 v69, 1.0, v69
 s_mov_b32 s81, s77
 v_mfma_f32_16x16x32_bf16 v[44:47], a[132:135], v[48:51], v[44:47]
 s_mov_b32 s82, s78
 s_mov_b32 s83, s79
 s_waitcnt lgkmcnt(1)
 v_mfma_f32_16x16x32_bf16 v[24:27], a[136:139], v[52:55], v[24:27]
 ds_read_b128 v[48:51], v71 offset:19328
 s_mov_b32 s94, s92
 v_mfma_f32_16x16x32_bf16 v[28:31], a[140:143], v[52:55], v[28:31]
 v_rcp_f32 v68, v68
 v_mfma_f32_16x16x32_bf16 v[32:35], a[144:147], v[52:55], v[32:35]
 v_mul_f32 v21, v67, v21
 s_mov_b32 s95, s93
 v_mfma_f32_16x16x32_bf16 v[36:39], a[148:151], v[52:55], v[36:39]
 v_rcp_f32 v69, v69
 v_mfma_f32_16x16x32_bf16 v[40:43], a[152:155], v[52:55], v[40:43]
 v_mul_f32 v22, v68, v22
 v_mul_f32 v23, v69, v23
 v_mfma_f32_16x16x32_bf16 v[44:47], a[156:159], v[52:55], v[44:47]
 s_waitcnt vmcnt(10)
 v_cmp_gt_u32 vcc, s74, v75
 s_waitcnt lgkmcnt(1)
 v_mfma_f32_16x16x32_bf16 v[24:27], a[160:163], v[56:59], v[24:27]
 ds_read_b128 v[52:55], v70 offset:19456
 v_cmp_gt_u32 s[66:67], s75, v75
 v_mfma_f32_16x16x32_bf16 v[28:31], a[164:167], v[56:59], v[28:31]
 v_cvt_pk_bf16_f32 v64, v20, v21
 v_cvt_pk_bf16_f32 v65, v22, v23
 v_mfma_f32_16x16x32_bf16 v[32:35], a[168:171], v[56:59], v[32:35]
 s_mov_b32 s63, s69
 s_mul_i32 s63, s63, 294912
 v_mfma_f32_16x16x32_bf16 v[36:39], a[172:175], v[56:59], v[36:39]
 s_cmp_eq_u32 s67, 0
 s_cselect_b32 s72, 2, 0
 s_cmp_eq_u32 vcc_lo, 0
 s_cselect_b32 s72, 1, s72
 v_mfma_f32_16x16x32_bf16 v[40:43], a[176:179], v[56:59], v[40:43]
 v_mov_b32 v76, s72
 s_mul_i32 s64, s68, 18874368
 v_mfma_f32_16x16x32_bf16 v[44:47], a[180:183], v[56:59], v[44:47]
 ds_write_b32 v72, v76 offset:4
 s_waitcnt lgkmcnt(2)
 v_mfma_f32_16x16x32_bf16 v[24:27], a[184:187], v[48:51], v[24:27]
 ds_read_b128 v[56:59], v71 offset:19456
 s_add_u32 s63, s63, s64
 v_mfma_f32_16x16x32_bf16 v[28:31], a[188:191], v[48:51], v[28:31]
 s_add_u32 s77, s63, s87
 s_add_u32 s78, s63, s88
 s_add_u32 s79, s63, s89
 v_mfma_f32_16x16x32_bf16 v[32:35], a[192:195], v[48:51], v[32:35]
 s_mul_i32 s92, s68, 4096
 s_sub_u32 s93, s80, 1
 v_mfma_f32_16x16x32_bf16 v[36:39], a[196:199], v[48:51], v[36:39]
 s_min_u32 s93, s93, 64
 s_add_u32 s61, s61, 1
 v_mfma_f32_16x16x32_bf16 v[40:43], a[200:203], v[48:51], v[40:43]
 v_mfma_f32_16x16x32_bf16 v[44:47], a[204:207], v[48:51], v[44:47]
 s_waitcnt lgkmcnt(1)
 s_waitcnt vmcnt(0)
 s_branch L_u_fe
L_u_p0ed:
 s_waitcnt lgkmcnt(1)
 v_mfma_f32_16x16x32_bf16 v[0:3], v[80:83], v[48:51], 0
 ds_read_b128 v[56:59], v70 offset:128
 s_sub_u32 s68, s72, 1
 s_cmp_eq_u32 s68, 0
 s_cselect_b32 s69, s74, s75
 v_mfma_f32_16x16x32_bf16 v[4:7], v[84:87], v[48:51], 0
 s_cselect_b32 s63, s44, s47
 s_cselect_b32 s64, s45, s48
 s_cselect_b32 s80, s46, s49
 v_mfma_f32_16x16x32_bf16 v[8:11], v[88:91], v[48:51], 0
 s_cmp_lt_u32 s69, s63
 s_cselect_b32 s80, s64, s80
 s_add_u32 s80, s80, s69
 v_mfma_f32_16x16x32_bf16 v[12:15], v[92:95], v[48:51], 0
 s_cmp_eq_u32 s68, 0
 s_cselect_b32 s74, s80, s74
 s_cselect_b32 s75, s75, s80
 s_mul_i32 s73, s69, 36864
 v_mfma_f32_16x16x32_bf16 v[16:19], v[96:99], v[48:51], 0
 s_mul_i32 s63, s68, 2359296
 s_add_u32 s73, s73, s63
 s_add_u32 s73, s73, s90
 v_mfma_f32_16x16x32_bf16 v[20:23], v[100:103], v[48:51], 0
 s_mov_b32 m0, s70
 v_mul_f32 v66, s86, v24
 s_waitcnt lgkmcnt(1)
 v_mfma_f32_16x16x32_bf16 v[0:3], v[104:107], v[52:55], v[0:3]
 ds_read_b128 v[48:51], v71 offset:128
 v_mul_f32 v67, s86, v25
 v_mfma_f32_16x16x32_bf16 v[4:7], v[108:111], v[52:55], v[4:7]
 buffer_load_dwordx4 v72, s[8:11], s73 offen sc1 lds
 v_mfma_f32_16x16x32_bf16 v[8:11], v[112:115], v[52:55], v[8:11]
 v_exp_f32 v66, v66
 v_mfma_f32_16x16x32_bf16 v[12:15], v[116:119], v[52:55], v[12:15]
 v_mul_f32 v68, s86, v26
 v_mul_f32 v28, v24, v28
 v_mfma_f32_16x16x32_bf16 v[16:19], v[120:123], v[52:55], v[16:19]
 v_exp_f32 v67, v67
 v_mfma_f32_16x16x32_bf16 v[20:23], v[124:127], v[52:55], v[20:23]
 s_add_u32 m0, m0, s3
 s_add_u32 s73, s73, s3
 s_waitcnt lgkmcnt(1)
 v_mfma_f32_16x16x32_bf16 v[0:3], v[128:131], v[56:59], v[0:3]
 ds_read_b128 v[52:55], v70 offset:256
 v_mul_f32 v69, s86, v27
 v_mfma_f32_16x16x32_bf16 v[4:7], v[132:135], v[56:59], v[4:7]
 buffer_load_dwordx4 v72, s[8:11], s73 offen sc1 lds
 v_add_f32 v66, 1.0, v66
 v_mfma_f32_16x16x32_bf16 v[8:11], v[136:139], v[56:59], v[8:11]
 v_exp_f32 v68, v68
 v_mfma_f32_16x16x32_bf16 v[12:15], v[140:143], v[56:59], v[12:15]
 v_mul_f32 v29, v25, v29
 v_add_f32 v67, 1.0, v67
 v_mfma_f32_16x16x32_bf16 v[16:19], v[144:147], v[56:59], v[16:19]
 v_rcp_f32 v66, v66
 v_mfma_f32_16x16x32_bf16 v[20:23], v[148:151], v[56:59], v[20:23]
 s_add_u32 m0, m0, s3
 s_add_u32 s73, s73, s3
 s_waitcnt lgkmcnt(1)
 v_mfma_f32_16x16x32_bf16 v[0:3], v[152:155], v[48:51], v[0:3]
 ds_read_b128 v[56:59], v71 offset:256
 v_mul_f32 v30, v26, v30
 v_mfma_f32_16x16x32_bf16 v[4:7], v[156:159], v[48:51], v[4:7]
 buffer_load_dwordx4 v72, s[8:11], s73 offen sc1 lds
 v_add_f32 v68, 1.0, v68
 v_mfma_f32_16x16x32_bf16 v[8:11], v[160:163], v[48:51], v[8:11]
 v_exp_f32 v69, v69
 v_mfma_f32_16x16x32_bf16 v[12:15], v[164:167], v[48:51], v[12:15]
 v_mul_f32 v31, v27, v31
 v_mul_f32 v28, v66, v28
 v_mfma_f32_16x16x32_bf16 v[16:19], v[168:171], v[48:51], v[16:19]
 v_rcp_f32 v67, v67
 v_mfma_f32_16x16x32_bf16 v[20:23], v[172:175], v[48:51], v[20:23]
 s_add_u32 m0, m0, s3
 s_add_u32 s73, s73, s3
 s_waitcnt lgkmcnt(1)
 v_mfma_f32_16x16x32_bf16 v[0:3], v[176:179], v[52:55], v[0:3]
 ds_read_b128 v[48:51], v70 offset:384
 v_add_f32 v69, 1.0, v69
 v_mfma_f32_16x16x32_bf16 v[4:7], v[180:183], v[52:55], v[4:7]
 buffer_load_dwordx4 v72, s[8:11], s73 offen sc1 lds
 v_mfma_f32_16x16x32_bf16 v[8:11], v[184:187], v[52:55], v[8:11]
 v_rcp_f32 v68, v68
 v_mfma_f32_16x16x32_bf16 v[12:15], v[188:191], v[52:55], v[12:15]
 v_mul_f32 v29, v67, v29
 v_mfma_f32_16x16x32_bf16 v[16:19], v[192:195], v[52:55], v[16:19]
 v_rcp_f32 v69, v69
 v_mfma_f32_16x16x32_bf16 v[20:23], v[196:199], v[52:55], v[20:23]
 s_add_u32 m0, m0, s3
 s_add_u32 s73, s73, s3
 s_waitcnt lgkmcnt(1)
 v_mfma_f32_16x16x32_bf16 v[0:3], v[200:203], v[56:59], v[0:3]
 ds_read_b128 v[52:55], v71 offset:384
 v_mul_f32 v30, v68, v30
 v_mfma_f32_16x16x32_bf16 v[4:7], v[204:207], v[56:59], v[4:7]
 buffer_load_dwordx4 v72, s[8:11], s73 offen sc1 lds
 v_mul_f32 v31, v69, v31
 v_mfma_f32_16x16x32_bf16 v[8:11], v[208:211], v[56:59], v[8:11]
 v_mov_b64 v[24:25], v[60:61]
 v_cvt_pk_bf16_f32 v26, v28, v29
 v_mfma_f32_16x16x32_bf16 v[12:15], v[212:215], v[56:59], v[12:15]
 v_cvt_pk_bf16_f32 v27, v30, v31
 s_nop 0
 v_mfma_f32_16x16x32_bf16 v[16:19], v[216:219], v[56:59], v[16:19]
 v_permlane32_swap_b32 v24, v26
 v_mfma_f32_16x16x32_bf16 v[20:23], v[220:223], v[56:59], v[20:23]
 s_add_u32 m0, m0, s3
 s_add_u32 s73, s73, s3
 s_waitcnt lgkmcnt(1)
 v_mfma_f32_16x16x32_bf16 v[0:3], v[224:227], v[48:51], v[0:3]
 ds_read_b128 v[56:59], v70 offset:512
 v_mfma_f32_16x16x32_bf16 v[4:7], v[228:231], v[48:51], v[4:7]
 buffer_load_dwordx4 v72, s[8:11], s73 offen sc1 lds
 v_mfma_f32_16x16x32_bf16 v[8:11], v[232:235], v[48:51], v[8:11]
 v_permlane32_swap_b32 v25, v27
 v_mfma_f32_16x16x32_bf16 v[12:15], v[236:239], v[48:51], v[12:15]
 buffer_store_dwordx4 v[24:27], v73, s[8:11], s81 offen sc1
 v_mul_f32 v66, s86, v32
 v_mfma_f32_16x16x32_bf16 v[16:19], v[240:243], v[48:51], v[16:19]
 v_mul_f32 v67, s86, v33
 v_mfma_f32_16x16x32_bf16 v[20:23], v[244:247], v[48:51], v[20:23]
 s_add_u32 m0, m0, s3
 s_add_u32 s73, s73, s3
 s_waitcnt lgkmcnt(1)
 v_mfma_f32_16x16x32_bf16 v[0:3], v[248:251], v[52:55], v[0:3]
 ds_read_b128 v[48:51], v71 offset:512
 v_mfma_f32_16x16x32_bf16 v[4:7], v[252:255], v[52:55], v[4:7]
 buffer_load_dwordx4 v72, s[8:11], s73 offen sc1 lds
 v_mfma_f32_16x16x32_bf16 v[8:11], a[0:3], v[52:55], v[8:11]
 v_exp_f32 v66, v66
 v_mfma_f32_16x16x32_bf16 v[12:15], a[4:7], v[52:55], v[12:15]
 v_mul_f32 v68, s86, v34
 v_mul_f32 v36, v32, v36
 v_mfma_f32_16x16x32_bf16 v[16:19], a[8:11], v[52:55], v[16:19]
 v_exp_f32 v67, v67
 v_mfma_f32_16x16x32_bf16 v[20:23], a[12:15], v[52:55], v[20:23]
 s_add_u32 m0, m0, s3
 s_add_u32 s73, s73, s3
 s_waitcnt lgkmcnt(1)
 v_mfma_f32_16x16x32_bf16 v[0:3], a[16:19], v[56:59], v[0:3]
 ds_read_b128 v[52:55], v70 offset:640
 v_mul_f32 v69, s86, v35
 v_mfma_f32_16x16x32_bf16 v[4:7], a[20:23], v[56:59], v[4:7]
 buffer_load_dwordx4 v72, s[8:11], s73 offen sc1 lds
 v_add_f32 v66, 1.0, v66
 v_mfma_f32_16x16x32_bf16 v[8:11], a[24:27], v[56:59], v[8:11]
 v_exp_f32 v68, v68
 v_mfma_f32_16x16x32_bf16 v[12:15], a[28:31], v[56:59], v[12:15]
 v_mul_f32 v37, v33, v37
 v_add_f32 v67, 1.0, v67
 v_mfma_f32_16x16x32_bf16 v[16:19], a[32:35], v[56:59], v[16:19]
 v_rcp_f32 v66, v66
 v_mfma_f32_16x16x32_bf16 v[20:23], a[36:39], v[56:59], v[20:23]
 s_add_u32 m0, m0, s3
 s_add_u32 s73, s73, s3
 s_waitcnt lgkmcnt(1)
 v_mfma_f32_16x16x32_bf16 v[0:3], a[40:43], v[48:51], v[0:3]
 ds_read_b128 v[56:59], v71 offset:640
 v_mul_f32 v38, v34, v38
 v_mfma_f32_16x16x32_bf16 v[4:7], a[44:47], v[48:51], v[4:7]
 buffer_load_dwordx4 v72, s[8:11], s73 offen sc1 lds
 v_add_f32 v68, 1.0, v68
 v_mfma_f32_16x16x32_bf16 v[8:11], a[48:51], v[48:51], v[8:11]
 v_exp_f32 v69, v69
 v_mfma_f32_16x16x32_bf16 v[12:15], a[52:55], v[48:51], v[12:15]
 v_mul_f32 v39, v35, v39
 v_mul_f32 v36, v66, v36
 v_mfma_f32_16x16x32_bf16 v[16:19], a[56:59], v[48:51], v[16:19]
 v_rcp_f32 v67, v67
 v_mfma_f32_16x16x32_bf16 v[20:23], a[60:63], v[48:51], v[20:23]
 v_add_f32 v69, 1.0, v69
 s_waitcnt lgkmcnt(1)
 v_mfma_f32_16x16x32_bf16 v[0:3], a[64:67], v[52:55], v[0:3]
 ds_read_b128 v[48:51], v70 offset:768
 v_mfma_f32_16x16x32_bf16 v[4:7], a[68:71], v[52:55], v[4:7]
 v_rcp_f32 v68, v68
 v_mfma_f32_16x16x32_bf16 v[8:11], a[72:75], v[52:55], v[8:11]
 v_mul_f32 v37, v67, v37
 v_mfma_f32_16x16x32_bf16 v[12:15], a[76:79], v[52:55], v[12:15]
 v_rcp_f32 v69, v69
 v_mfma_f32_16x16x32_bf16 v[16:19], a[80:83], v[52:55], v[16:19]
 v_mul_f32 v38, v68, v38
 v_mul_f32 v39, v69, v39
 v_mfma_f32_16x16x32_bf16 v[20:23], a[84:87], v[52:55], v[20:23]
 s_waitcnt lgkmcnt(1)
 v_mfma_f32_16x16x32_bf16 v[0:3], a[88:91], v[56:59], v[0:3]
 ds_read_b128 v[52:55], v71 offset:768
 v_mfma_f32_16x16x32_bf16 v[4:7], a[92:95], v[56:59], v[4:7]
 v_mov_b64 v[32:33], v[62:63]
 v_cvt_pk_bf16_f32 v34, v36, v37
 v_mfma_f32_16x16x32_bf16 v[8:11], a[96:99], v[56:59], v[8:11]
 v_cvt_pk_bf16_f32 v35, v38, v39
 s_nop 0
 v_mfma_f32_16x16x32_bf16 v[12:15], a[100:103], v[56:59], v[12:15]
 v_permlane32_swap_b32 v32, v34
 v_mfma_f32_16x16x32_bf16 v[16:19], a[104:107], v[56:59], v[16:19]
 v_permlane32_swap_b32 v33, v35
 v_mfma_f32_16x16x32_bf16 v[20:23], a[108:111], v[56:59], v[20:23]
 buffer_store_dwordx4 v[32:35], v73, s[8:11], s82 offen sc1
 s_waitcnt lgkmcnt(1)
 v_mfma_f32_16x16x32_bf16 v[0:3], a[112:115], v[48:51], v[0:3]
 ds_read_b128 v[56:59], v70 offset:896
 v_mul_f32 v66, s86, v40
 v_mfma_f32_16x16x32_bf16 v[4:7], a[116:119], v[48:51], v[4:7]
 v_mul_f32 v67, s86, v41
 v_mfma_f32_16x16x32_bf16 v[8:11], a[120:123], v[48:51], v[8:11]
 v_exp_f32 v66, v66
 v_mfma_f32_16x16x32_bf16 v[12:15], a[124:127], v[48:51], v[12:15]
 v_mul_f32 v68, s86, v42
 v_mul_f32 v44, v40, v44
 v_mfma_f32_16x16x32_bf16 v[16:19], a[128:131], v[48:51], v[16:19]
 v_exp_f32 v67, v67
 v_mfma_f32_16x16x32_bf16 v[20:23], a[132:135], v[48:51], v[20:23]
 v_mul_f32 v69, s86, v43
 s_waitcnt lgkmcnt(1)
 v_mfma_f32_16x16x32_bf16 v[0:3], a[136:139], v[52:55], v[0:3]
 ds_read_b128 v[48:51], v71 offset:896
 v_add_f32 v66, 1.0, v66
 v_mfma_f32_16x16x32_bf16 v[4:7], a[140:143], v[52:55], v[4:7]
 v_exp_f32 v68, v68
 v_mfma_f32_16x16x32_bf16 v[8:11], a[144:147], v[52:55], v[8:11]
 v_mul_f32 v45, v41, v45
 v_add_f32 v67, 1.0, v67
 v_mfma_f32_16x16x32_bf16 v[12:15], a[148:151], v[52:55], v[12:15]
 v_rcp_f32 v66, v66
 v_mfma_f32_16x16x32_bf16 v[16:19], a[152:155], v[52:55], v[16:19]
 v_mul_f32 v46, v42, v46
 v_add_f32 v68, 1.0, v68
 v_mfma_f32_16x16x32_bf16 v[20:23], a[156:159], v[52:55], v[20:23]
 v_exp_f32 v69, v69
 s_waitcnt lgkmcnt(1)
 v_mfma_f32_16x16x32_bf16 v[0:3], a[160:163], v[56:59], v[0:3]
 ds_read_b128 v[52:55], v70 offset:1024
 v_mul_f32 v47, v43, v47
 v_mfma_f32_16x16x32_bf16 v[4:7], a[164:167], v[56:59], v[4:7]
 v_mul_f32 v44, v66, v44
 v_mfma_f32_16x16x32_bf16 v[8:11], a[168:171], v[56:59], v[8:11]
 v_rcp_f32 v67, v67
 v_mfma_f32_16x16x32_bf16 v[12:15], a[172:175], v[56:59], v[12:15]
 v_add_f32 v69, 1.0, v69
 v_mfma_f32_16x16x32_bf16 v[16:19], a[176:179], v[56:59], v[16:19]
 v_rcp_f32 v68, v68
 v_mfma_f32_16x16x32_bf16 v[20:23], a[180:183], v[56:59], v[20:23]
 v_mul_f32 v45, v67, v45
 s_waitcnt lgkmcnt(1)
 v_mfma_f32_16x16x32_bf16 v[0:3], a[184:187], v[48:51], v[0:3]
 ds_read_b128 v[56:59], v71 offset:1024
 v_mfma_f32_16x16x32_bf16 v[4:7], a[188:191], v[48:51], v[4:7]
 v_rcp_f32 v69, v69
 v_mfma_f32_16x16x32_bf16 v[8:11], a[192:195], v[48:51], v[8:11]
 v_mul_f32 v46, v68, v46
 v_mul_f32 v47, v69, v47
 v_mfma_f32_16x16x32_bf16 v[12:15], a[196:199], v[48:51], v[12:15]
 v_mov_b64 v[40:41], v[64:65]
 v_cvt_pk_bf16_f32 v42, v44, v45
 v_mfma_f32_16x16x32_bf16 v[16:19], a[200:203], v[48:51], v[16:19]
 v_cvt_pk_bf16_f32 v43, v46, v47
 s_nop 0
 v_mfma_f32_16x16x32_bf16 v[20:23], a[204:207], v[48:51], v[20:23]
 v_permlane32_swap_b32 v40, v42
 s_waitcnt lgkmcnt(1)
 v_mfma_f32_16x16x32_bf16 v[0:3], a[208:211], v[52:55], v[0:3]
 ds_read_b128 v[48:51], v70 offset:18432
 v_mfma_f32_16x16x32_bf16 v[4:7], a[212:215], v[52:55], v[4:7]
 v_permlane32_swap_b32 v41, v43
 v_mfma_f32_16x16x32_bf16 v[8:11], a[216:219], v[52:55], v[8:11]
 buffer_store_dwordx4 v[40:43], v73, s[8:11], s83 offen sc1
 v_mfma_f32_16x16x32_bf16 v[12:15], a[220:223], v[52:55], v[12:15]
 v_mfma_f32_16x16x32_bf16 v[16:19], a[224:227], v[52:55], v[16:19]
 v_mfma_f32_16x16x32_bf16 v[20:23], a[228:231], v[52:55], v[20:23]
 s_waitcnt lgkmcnt(1)
 v_mfma_f32_16x16x32_bf16 v[0:3], a[232:235], v[56:59], v[0:3]
 ds_read_b128 v[52:55], v71 offset:18432
 v_mfma_f32_16x16x32_bf16 v[4:7], a[236:239], v[56:59], v[4:7]
 v_mfma_f32_16x16x32_bf16 v[8:11], a[240:243], v[56:59], v[8:11]
 v_mfma_f32_16x16x32_bf16 v[12:15], a[244:247], v[56:59], v[12:15]
 v_mfma_f32_16x16x32_bf16 v[16:19], a[248:251], v[56:59], v[16:19]
 v_mfma_f32_16x16x32_bf16 v[20:23], a[252:255], v[56:59], v[20:23]
 s_waitcnt lgkmcnt(1)
 v_mfma_f32_16x16x32_bf16 v[24:27], v[80:83], v[48:51], 0
 ds_read_b128 v[56:59], v70 offset:18560
 v_mfma_f32_16x16x32_bf16 v[28:31], v[84:87], v[48:51], 0
 v_mfma_f32_16x16x32_bf16 v[32:35], v[88:91], v[48:51], 0
 v_mfma_f32_16x16x32_bf16 v[36:39], v[92:95], v[48:51], 0
 v_mfma_f32_16x16x32_bf16 v[40:43], v[96:99], v[48:51], 0
 v_mul_f32 v66, s86, v0
 v_mul_f32 v67, s86, v1
 v_mfma_f32_16x16x32_bf16 v[44:47], v[100:103], v[48:51], 0
 s_waitcnt lgkmcnt(1)
 v_mfma_f32_16x16x32_bf16 v[24:27], v[104:107], v[52:55], v[24:27]
 ds_read_b128 v[48:51], v71 offset:18560
 v_mfma_f32_16x16x32_bf16 v[28:31], v[108:111], v[52:55], v[28:31]
 v_exp_f32 v66, v66
 v_mfma_f32_16x16x32_bf16 v[32:35], v[112:115], v[52:55], v[32:35]
 v_mul_f32 v68, s86, v2
 v_mul_f32 v4, v0, v4
 v_mfma_f32_16x16x32_bf16 v[36:39], v[116:119], v[52:55], v[36:39]
 v_exp_f32 v67, v67
 v_mfma_f32_16x16x32_bf16 v[40:43], v[120:123], v[52:55], v[40:43]
 v_mul_f32 v69, s86, v3
 v_add_f32 v66, 1.0, v66
 v_mfma_f32_16x16x32_bf16 v[44:47], v[124:127], v[52:55], v[44:47]
 s_waitcnt lgkmcnt(1)
 v_mfma_f32_16x16x32_bf16 v[24:27], v[128:131], v[56:59], v[24:27]
 ds_read_b128 v[52:55], v70 offset:18688
 v_mfma_f32_16x16x32_bf16 v[28:31], v[132:135], v[56:59], v[28:31]
 v_exp_f32 v68, v68
 v_mfma_f32_16x16x32_bf16 v[32:35], v[136:139], v[56:59], v[32:35]
 v_mul_f32 v5, v1, v5
 v_add_f32 v67, 1.0, v67
 v_mfma_f32_16x16x32_bf16 v[36:39], v[140:143], v[56:59], v[36:39]
 v_rcp_f32 v66, v66
 v_mfma_f32_16x16x32_bf16 v[40:43], v[144:147], v[56:59], v[40:43]
 v_mul_f32 v6, v2, v6
 v_add_f32 v68, 1.0, v68
 v_mfma_f32_16x16x32_bf16 v[44:47], v[148:151], v[56:59], v[44:47]
 s_waitcnt lgkmcnt(1)
 v_mfma_f32_16x16x32_bf16 v[24:27], v[152:155], v[48:51], v[24:27]
 ds_read_b128 v[56:59], v71 offset:18688
 v_mfma_f32_16x16x32_bf16 v[28:31], v[156:159], v[48:51], v[28:31]
 v_exp_f32 v69, v69
 v_mfma_f32_16x16x32_bf16 v[32:35], v[160:163], v[48:51], v[32:35]
 v_mul_f32 v7, v3, v7
 v_mul_f32 v4, v66, v4
 v_mfma_f32_16x16x32_bf16 v[36:39], v[164:167], v[48:51], v[36:39]
 v_rcp_f32 v67, v67
 v_mfma_f32_16x16x32_bf16 v[40:43], v[168:171], v[48:51], v[40:43]
 v_add_f32 v69, 1.0, v69
 v_mfma_f32_16x16x32_bf16 v[44:47], v[172:175], v[48:51], v[44:47]
 s_waitcnt lgkmcnt(1)
 v_mfma_f32_16x16x32_bf16 v[24:27], v[176:179], v[52:55], v[24:27]
 ds_read_b128 v[48:51], v70 offset:18816
 v_mfma_f32_16x16x32_bf16 v[28:31], v[180:183], v[52:55], v[28:31]
 v_rcp_f32 v68, v68
 v_mfma_f32_16x16x32_bf16 v[32:35], v[184:187], v[52:55], v[32:35]
 v_mul_f32 v5, v67, v5
 v_mfma_f32_16x16x32_bf16 v[36:39], v[188:191], v[52:55], v[36:39]
 v_rcp_f32 v69, v69
 v_mfma_f32_16x16x32_bf16 v[40:43], v[192:195], v[52:55], v[40:43]
 v_mul_f32 v6, v68, v6
 v_mul_f32 v7, v69, v7
 v_mfma_f32_16x16x32_bf16 v[44:47], v[196:199], v[52:55], v[44:47]
 v_cvt_pk_bf16_f32 v60, v4, v5
 s_waitcnt lgkmcnt(1)
 v_mfma_f32_16x16x32_bf16 v[24:27], v[200:203], v[56:59], v[24:27]
 ds_read_b128 v[52:55], v71 offset:18816
 v_cvt_pk_bf16_f32 v61, v6, v7
 v_mfma_f32_16x16x32_bf16 v[28:31], v[204:207], v[56:59], v[28:31]
 v_mul_f32 v66, s86, v8
 v_mul_f32 v67, s86, v9
 v_mfma_f32_16x16x32_bf16 v[32:35], v[208:211], v[56:59], v[32:35]
 v_exp_f32 v66, v66
 v_mfma_f32_16x16x32_bf16 v[36:39], v[212:215], v[56:59], v[36:39]
 buffer_load_dword v75, v74, s[8:11], 0 offen sc1
 v_mfma_f32_16x16x32_bf16 v[40:43], v[216:219], v[56:59], v[40:43]
 v_mul_f32 v68, s86, v10
 v_mul_f32 v12, v8, v12
 v_mfma_f32_16x16x32_bf16 v[44:47], v[220:223], v[56:59], v[44:47]
 s_waitcnt lgkmcnt(1)
 v_mfma_f32_16x16x32_bf16 v[24:27], v[224:227], v[48:51], v[24:27]
 ds_read_b128 v[56:59], v70 offset:18944
 v_mfma_f32_16x16x32_bf16 v[28:31], v[228:231], v[48:51], v[28:31]
 v_exp_f32 v67, v67
 v_mfma_f32_16x16x32_bf16 v[32:35], v[232:235], v[48:51], v[32:35]
 v_mov_b32 v76, s95
 v_mul_f32 v69, s86, v11
 v_mfma_f32_16x16x32_bf16 v[36:39], v[236:239], v[48:51], v[36:39]
 s_waitcnt vmcnt(1)
 s_barrier
 buffer_store_dword v76, v77, s[8:11], s94 offen sc1
 v_mfma_f32_16x16x32_bf16 v[40:43], v[240:243], v[48:51], v[40:43]
 v_add_f32 v66, 1.0, v66
 s_mov_b32 s63, s85
 v_mfma_f32_16x16x32_bf16 v[44:47], v[244:247], v[48:51], v[44:47]
 s_mov_b32 s85, s4
 s_mov_b32 s4, s5
 s_waitcnt lgkmcnt(1)
 v_mfma_f32_16x16x32_bf16 v[24:27], v[248:251], v[52:55], v[24:27]
 ds_read_b128 v[48:51], v71 offset:18944
 s_mov_b32 s5, s63
 v_mfma_f32_16x16x32_bf16 v[28:31], v[252:255], v[52:55], v[28:31]
 v_exp_f32 v68, v68
 v_mfma_f32_16x16x32_bf16 v[32:35], a[0:3], v[52:55], v[32:35]
 v_mul_f32 v13, v9, v13
 v_add_f32 v67, 1.0, v67
 v_mfma_f32_16x16x32_bf16 v[36:39], a[4:7], v[52:55], v[36:39]
 v_rcp_f32 v66, v66
 v_mfma_f32_16x16x32_bf16 v[40:43], a[8:11], v[52:55], v[40:43]
 v_mul_f32 v14, v10, v14
 v_add_f32 v68, 1.0, v68
 v_mfma_f32_16x16x32_bf16 v[44:47], a[12:15], v[52:55], v[44:47]
 s_add_u32 s70, s70, s85
 s_mov_b32 s81, s77
 s_waitcnt lgkmcnt(1)
 v_mfma_f32_16x16x32_bf16 v[24:27], a[16:19], v[56:59], v[24:27]
 ds_read_b128 v[52:55], v70 offset:19072
 s_mov_b32 s82, s78
 v_mfma_f32_16x16x32_bf16 v[28:31], a[20:23], v[56:59], v[28:31]
 v_exp_f32 v69, v69
 v_mfma_f32_16x16x32_bf16 v[32:35], a[24:27], v[56:59], v[32:35]
 v_mul_f32 v15, v11, v15
 v_mul_f32 v12, v66, v12
 v_mfma_f32_16x16x32_bf16 v[36:39], a[28:31], v[56:59], v[36:39]
 v_rcp_f32 v67, v67
 v_mfma_f32_16x16x32_bf16 v[40:43], a[32:35], v[56:59], v[40:43]
 v_add_f32 v69, 1.0, v69
 s_mov_b32 s83, s79
 v_mfma_f32_16x16x32_bf16 v[44:47], a[36:39], v[56:59], v[44:47]
 s_mov_b32 s94, s92
 s_mov_b32 s95, s93
 s_waitcnt lgkmcnt(1)
 v_mfma_f32_16x16x32_bf16 v[24:27], a[40:43], v[48:51], v[24:27]
 ds_read_b128 v[56:59], v71 offset:19072
 s_mov_b32 s63, s69
 v_mfma_f32_16x16x32_bf16 v[28:31], a[44:47], v[48:51], v[28:31]
 v_rcp_f32 v68, v68
 v_mfma_f32_16x16x32_bf16 v[32:35], a[48:51], v[48:51], v[32:35]
 v_mul_f32 v13, v67, v13
 s_mul_i32 s63, s63, 294912
 v_mfma_f32_16x16x32_bf16 v[36:39], a[52:55], v[48:51], v[36:39]
 v_rcp_f32 v69, v69
 v_mfma_f32_16x16x32_bf16 v[40:43], a[56:59], v[48:51], v[40:43]
 v_mul_f32 v14, v68, v14
 v_mul_f32 v15, v69, v15
 v_mfma_f32_16x16x32_bf16 v[44:47], a[60:63], v[48:51], v[44:47]
 v_cvt_pk_bf16_f32 v62, v12, v13
 s_waitcnt lgkmcnt(1)
 v_mfma_f32_16x16x32_bf16 v[24:27], a[64:67], v[52:55], v[24:27]
 ds_read_b128 v[48:51], v70 offset:19200
 v_cvt_pk_bf16_f32 v63, v14, v15
 v_mfma_f32_16x16x32_bf16 v[28:31], a[68:71], v[52:55], v[28:31]
 v_mul_f32 v66, s86, v16
 v_mul_f32 v67, s86, v17
 v_mfma_f32_16x16x32_bf16 v[32:35], a[72:75], v[52:55], v[32:35]
 v_exp_f32 v66, v66
 v_mfma_f32_16x16x32_bf16 v[36:39], a[76:79], v[52:55], v[36:39]
 v_mul_f32 v68, s86, v18
 v_mul_f32 v20, v16, v20
 v_mfma_f32_16x16x32_bf16 v[40:43], a[80:83], v[52:55], v[40:43]
 v_exp_f32 v67, v67
 v_mfma_f32_16x16x32_bf16 v[44:47], a[84:87], v[52:55], v[44:47]
 v_mul_f32 v69, s86, v19
 s_waitcnt lgkmcnt(1)
 v_mfma_f32_16x16x32_bf16 v[24:27], a[88:91], v[56:59], v[24:27]
 ds_read_b128 v[52:55], v71 offset:19200
 v_add_f32 v66, 1.0, v66
 v_mfma_f32_16x16x32_bf16 v[28:31], a[92:95], v[56:59], v[28:31]
 v_exp_f32 v68, v68
 v_mfma_f32_16x16x32_bf16 v[32:35], a[96:99], v[56:59], v[32:35]
 v_mul_f32 v21, v17, v21
 v_add_f32 v67, 1.0, v67
 v_mfma_f32_16x16x32_bf16 v[36:39], a[100:103], v[56:59], v[36:39]
 v_rcp_f32 v66, v66
 v_mfma_f32_16x16x32_bf16 v[40:43], a[104:107], v[56:59], v[40:43]
 v_mul_f32 v22, v18, v22
 v_add_f32 v68, 1.0, v68
 v_mfma_f32_16x16x32_bf16 v[44:47], a[108:111], v[56:59], v[44:47]
 s_mul_i32 s64, s68, 18874368
 s_waitcnt lgkmcnt(1)
 v_mfma_f32_16x16x32_bf16 v[24:27], a[112:115], v[48:51], v[24:27]
 ds_read_b128 v[56:59], v70 offset:19328
 s_add_u32 s63, s63, s64
 v_mfma_f32_16x16x32_bf16 v[28:31], a[116:119], v[48:51], v[28:31]
 v_exp_f32 v69, v69
 v_mfma_f32_16x16x32_bf16 v[32:35], a[120:123], v[48:51], v[32:35]
 v_mul_f32 v23, v19, v23
 v_mul_f32 v20, v66, v20
 v_mfma_f32_16x16x32_bf16 v[36:39], a[124:127], v[48:51], v[36:39]
 v_rcp_f32 v67, v67
 v_mfma_f32_16x16x32_bf16 v[40:43], a[128:131], v[48:51], v[40:43]
 v_add_f32 v69, 1.0, v69
 s_add_u32 s77, s63, s87
 v_mfma_f32_16x16x32_bf16 v[44:47], a[132:135], v[48:51], v[44:47]
 s_add_u32 s78, s63, s88
 s_add_u32 s79, s63, s89
 s_waitcnt lgkmcnt(1)
 v_mfma_f32_16x16x32_bf16 v[24:27], a[136:139], v[52:55], v[24:27]
 ds_read_b128 v[48:51], v71 offset:19328
 s_mul_i32 s92, s68, 4096
 v_mfma_f32_16x16x32_bf16 v[28:31], a[140:143], v[52:55], v[28:31]
 v_rcp_f32 v68, v68
 v_mfma_f32_16x16x32_bf16 v[32:35], a[144:147], v[52:55], v[32:35]
 v_mul_f32 v21, v67, v21
 s_sub_u32 s93, s80, 1
 v_mfma_f32_16x16x32_bf16 v[36:39], a[148:151], v[52:55], v[36:39]
 v_rcp_f32 v69, v69
 v_mfma_f32_16x16x32_bf16 v[40:43], a[152:155], v[52:55], v[40:43]
 v_mul_f32 v22, v68, v22
 v_mul_f32 v23, v69, v23
 v_mfma_f32_16x16x32_bf16 v[44:47], a[156:159], v[52:55], v[44:47]
 s_waitcnt vmcnt(1)
 v_cmp_gt_u32 vcc, s74, v75
 s_waitcnt lgkmcnt(1)
 v_mfma_f32_16x16x32_bf16 v[24:27], a[160:163], v[56:59], v[24:27]
 ds_read_b128 v[52:55], v70 offset:19456
 v_cmp_gt_u32 s[66:67], s75, v75
 v_mfma_f32_16x16x32_bf16 v[28:31], a[164:167], v[56:59], v[28:31]
 v_cvt_pk_bf16_f32 v64, v20, v21
 v_cvt_pk_bf16_f32 v65, v22, v23
 v_mfma_f32_16x16x32_bf16 v[32:35], a[168:171], v[56:59], v[32:35]
 s_min_u32 s93, s93, 64
 s_add_u32 s61, s61, 1
 v_mfma_f32_16x16x32_bf16 v[36:39], a[172:175], v[56:59], v[36:39]
 s_cmp_eq_u32 s67, 0
 s_cselect_b32 s72, 2, 0
 s_cmp_eq_u32 vcc_lo, 0
 s_cselect_b32 s72, 1, s72
 v_mfma_f32_16x16x32_bf16 v[40:43], a[176:179], v[56:59], v[40:43]
 v_mov_b32 v76, s72
 v_mfma_f32_16x16x32_bf16 v[44:47], a[180:183], v[56:59], v[44:47]
 ds_write_b32 v72, v76 offset:4
 s_waitcnt lgkmcnt(2)
 v_mfma_f32_16x16x32_bf16 v[24:27], a[184:187], v[48:51], v[24:27]
 ds_read_b128 v[56:59], v71 offset:19456
 v_mfma_f32_16x16x32_bf16 v[28:31], a[188:191], v[48:51], v[28:31]
 v_mfma_f32_16x16x32_bf16 v[32:35], a[192:195], v[48:51], v[32:35]
 v_mfma_f32_16x16x32_bf16 v[36:39], a[196:199], v[48:51], v[36:39]
 v_mfma_f32_16x16x32_bf16 v[40:43], a[200:203], v[48:51], v[40:43]
 v_mfma_f32_16x16x32_bf16 v[44:47], a[204:207], v[48:51], v[44:47]
 s_waitcnt lgkmcnt(1)
L_u_fe:
 s_barrier
 ds_read_b32 v76, v73 offset:4
 s_waitcnt lgkmcnt(2)
 v_mfma_f32_16x16x32_bf16 v[24:27], a[208:211], v[52:55], v[24:27]
 v_add_u32 v70, s5, v70
 v_add_u32 v71, s5, v71
 ds_read_b128 v[48:51], v70 offset:0
 v_mfma_f32_16x16x32_bf16 v[28:31], a[212:215], v[52:55], v[28:31]
 v_mfma_f32_16x16x32_bf16 v[32:35], a[216:219], v[52:55], v[32:35]
 v_mfma_f32_16x16x32_bf16 v[36:39], a[220:223], v[52:55], v[36:39]
 v_mfma_f32_16x16x32_bf16 v[40:43], a[224:227], v[52:55], v[40:43]
 v_mfma_f32_16x16x32_bf16 v[44:47], a[228:231], v[52:55], v[44:47]
 s_waitcnt lgkmcnt(2)
 v_mfma_f32_16x16x32_bf16 v[24:27], a[232:235], v[56:59], v[24:27]
 ds_read_b128 v[52:55], v71 offset:0
 v_mfma_f32_16x16x32_bf16 v[28:31], a[236:239], v[56:59], v[28:31]
 v_mfma_f32_16x16x32_bf16 v[32:35], a[240:243], v[56:59], v[32:35]
 s_waitcnt lgkmcnt(2)
 v_readfirstlane_b32 s72, v76
 v_mfma_f32_16x16x32_bf16 v[36:39], a[244:247], v[56:59], v[36:39]
 v_mfma_f32_16x16x32_bf16 v[40:43], a[248:251], v[56:59], v[40:43]
 v_mfma_f32_16x16x32_bf16 v[44:47], a[252:255], v[56:59], v[44:47]
 s_cmp_lg_u32 s72, 0
 s_cbranch_scc1 L_u_p0ed
 s_branch L_u_p0e
L_u_p1n:
 s_waitcnt lgkmcnt(1)
 v_mfma_f32_16x16x32_bf16 v[24:27], v[80:83], v[48:51], 0
 ds_read_b128 v[56:59], v70 offset:18560
 v_mfma_f32_16x16x32_bf16 v[28:31], v[84:87], v[48:51], 0
 v_mfma_f32_16x16x32_bf16 v[32:35], v[88:91], v[48:51], 0
 v_mfma_f32_16x16x32_bf16 v[36:39], v[92:95], v[48:51], 0
 v_mfma_f32_16x16x32_bf16 v[40:43], v[96:99], v[48:51], 0
 v_mul_f32 v66, s86, v0
 v_mul_f32 v67, s86, v1
 v_mfma_f32_16x16x32_bf16 v[44:47], v[100:103], v[48:51], 0
 s_waitcnt lgkmcnt(1)
 v_mfma_f32_16x16x32_bf16 v[24:27], v[104:107], v[52:55], v[24:27]
 ds_read_b128 v[48:51], v71 offset:18560
 v_mfma_f32_16x16x32_bf16 v[28:31], v[108:111], v[52:55], v[28:31]
 v_exp_f32 v66, v66
 v_mfma_f32_16x16x32_bf16 v[32:35], v[112:115], v[52:55], v[32:35]
 v_mul_f32 v68, s86, v2
 v_mul_f32 v4, v0, v4
 v_mfma_f32_16x16x32_bf16 v[36:39], v[116:119], v[52:55], v[36:39]
 v_exp_f32 v67, v67
 v_mfma_f32_16x16x32_bf16 v[40:43], v[120:123], v[52:55], v[40:43]
 v_mul_f32 v69, s86, v3
 v_add_f32 v66, 1.0, v66
 v_mfma_f32_16x16x32_bf16 v[44:47], v[124:127], v[52:55], v[44:47]
 s_waitcnt lgkmcnt(1)
 v_mfma_f32_16x16x32_bf16 v[24:27], v[128:131], v[56:59], v[24:27]
 ds_read_b128 v[52:55], v70 offset:18688
 v_mfma_f32_16x16x32_bf16 v[28:31], v[132:135], v[56:59], v[28:31]
 v_exp_f32 v68, v68
 v_mfma_f32_16x16x32_bf16 v[32:35], v[136:139], v[56:59], v[32:35]
 v_mul_f32 v5, v1, v5
 v_add_f32 v67, 1.0, v67
 v_mfma_f32_16x16x32_bf16 v[36:39], v[140:143], v[56:59], v[36:39]
 v_rcp_f32 v66, v66
 v_mfma_f32_16x16x32_bf16 v[40:43], v[144:147], v[56:59], v[40:43]
 v_mul_f32 v6, v2, v6
 v_add_f32 v68, 1.0, v68
 v_mfma_f32_16x16x32_bf16 v[44:47], v[148:151], v[56:59], v[44:47]
 s_waitcnt lgkmcnt(1)
 v_mfma_f32_16x16x32_bf16 v[24:27], v[152:155], v[48:51], v[24:27]
 ds_read_b128 v[56:59], v71 offset:18688
 v_mfma_f32_16x16x32_bf16 v[28:31], v[156:159], v[48:51], v[28:31]
 v_exp_f32 v69, v69
 v_mfma_f32_16x16x32_bf16 v[32:35], v[160:163], v[48:51], v[32:35]
 v_mul_f32 v7, v3, v7
 v_mul_f32 v4, v66, v4
 v_mfma_f32_16x16x32_bf16 v[36:39], v[164:167], v[48:51], v[36:39]
 v_rcp_f32 v67, v67
 v_mfma_f32_16x16x32_bf16 v[40:43], v[168:171], v[48:51], v[40:43]
 v_add_f32 v69, 1.0, v69
 v_mfma_f32_16x16x32_bf16 v[44:47], v[172:175], v[48:51], v[44:47]
 s_waitcnt lgkmcnt(1)
 v_mfma_f32_16x16x32_bf16 v[24:27], v[176:179], v[52:55], v[24:27]
 ds_read_b128 v[48:51], v70 offset:18816
 v_mfma_f32_16x16x32_bf16 v[28:31], v[180:183], v[52:55], v[28:31]
 v_rcp_f32 v68, v68
 v_mfma_f32_16x16x32_bf16 v[32:35], v[184:187], v[52:55], v[32:35]
 v_mul_f32 v5, v67, v5
 v_mfma_f32_16x16x32_bf16 v[36:39], v[188:191], v[52:55], v[36:39]
 v_rcp_f32 v69, v69
 v_mfma_f32_16x16x32_bf16 v[40:43], v[192:195], v[52:55], v[40:43]
 v_mul_f32 v6, v68, v6
 v_mul_f32 v7, v69, v7
 v_mfma_f32_16x16x32_bf16 v[44:47], v[196:199], v[52:55], v[44:47]
 v_cvt_pk_bf16_f32 v60, v4, v5
 s_waitcnt lgkmcnt(1)
 v_mfma_f32_16x16x32_bf16 v[24:27], v[200:203], v[56:59], v[24:27]
 ds_read_b128 v[52:55], v71 offset:18816
 v_cvt_pk_bf16_f32 v61, v6, v7
 v_mfma_f32_16x16x32_bf16 v[28:31], v[204:207], v[56:59], v[28:31]
 v_mul_f32 v66, s86, v8
 v_mul_f32 v67, s86, v9
 v_mfma_f32_16x16x32_bf16 v[32:35], v[208:211], v[56:59], v[32:35]
 v_exp_f32 v66, v66
 v_mfma_f32_16x16x32_bf16 v[36:39], v[212:215], v[56:59], v[36:39]
 buffer_load_dword v75, v74, s[8:11], 0 offen sc1
 v_mfma_f32_16x16x32_bf16 v[40:43], v[216:219], v[56:59], v[40:43]
 v_mul_f32 v68, s86, v10
 v_mul_f32 v12, v8, v12
 v_mfma_f32_16x16x32_bf16 v[44:47], v[220:223], v[56:59], v[44:47]
 s_waitcnt lgkmcnt(1)
 v_mfma_f32_16x16x32_bf16 v[24:27], v[224:227], v[48:51], v[24:27]
 ds_read_b128 v[56:59], v70 offset:18944
 v_mfma_f32_16x16x32_bf16 v[28:31], v[228:231], v[48:51], v[28:31]
 v_exp_f32 v67, v67
 v_mfma_f32_16x16x32_bf16 v[32:35], v[232:235], v[48:51], v[32:35]
 v_mov_b32 v76, s95
 v_mul_f32 v69, s86, v11
 v_mfma_f32_16x16x32_bf16 v[36:39], v[236:239], v[48:51], v[36:39]
 s_waitcnt vmcnt(1)
 s_barrier
 buffer_store_dword v76, v77, s[8:11], s94 offen sc1
 v_mfma_f32_16x16x32_bf16 v[40:43], v[240:243], v[48:51], v[40:43]
 v_add_f32 v66, 1.0, v66
 v_mfma_f32_16x16x32_bf16 v[44:47], v[244:247], v[48:51], v[44:47]
 s_waitcnt lgkmcnt(1)
 v_mfma_f32_16x16x32_bf16 v[24:27], v[248:251], v[52:55], v[24:27]
 ds_read_b128 v[48:51], v71 offset:18944
 v_mfma_f32_16x16x32_bf16 v[28:31], v[252:255], v[52:55], v[28:31]
 v_exp_f32 v68, v68
 v_mfma_f32_16x16x32_bf16 v[32:35], a[0:3], v[52:55], v[32:35]
 v_mul_f32 v13, v9, v13
 v_add_f32 v67, 1.0, v67
 v_mfma_f32_16x16x32_bf16 v[36:39], a[4:7], v[52:55], v[36:39]
 v_rcp_f32 v66, v66
 v_mfma_f32_16x16x32_bf16 v[40:43], a[8:11], v[52:55], v[40:43]
 v_mul_f32 v14, v10, v14
 v_add_f32 v68, 1.0, v68
 v_mfma_f32_16x16x32_bf16 v[44:47], a[12:15], v[52:55], v[44:47]
 s_waitcnt lgkmcnt(1)
 v_mfma_f32_16x16x32_bf16 v[24:27], a[16:19], v[56:59], v[24:27]
 ds_read_b128 v[52:55], v70 offset:19072
 v_mfma_f32_16x16x32_bf16 v[28:31], a[20:23], v[56:59], v[28:31]
 v_exp_f32 v69, v69
 v_mfma_f32_16x16x32_bf16 v[32:35], a[24:27], v[56:59], v[32:35]
 v_mul_f32 v15, v11, v15
 v_mul_f32 v12, v66, v12
 v_mfma_f32_16x16x32_bf16 v[36:39], a[28:31], v[56:59], v[36:39]
 v_rcp_f32 v67, v67
 v_mfma_f32_16x16x32_bf16 v[40:43], a[32:35], v[56:59], v[40:43]
 v_add_f32 v69, 1.0, v69
 v_mfma_f32_16x16x32_bf16 v[44:47], a[36:39], v[56:59], v[44:47]
 s_waitcnt lgkmcnt(1)
 v_mfma_f32_16x16x32_bf16 v[24:27], a[40:43], v[48:51], v[24:27]
 ds_read_b128 v[56:59], v71 offset:19072
 v_mfma_f32_16x16x32_bf16 v[28:31], a[44:47], v[48:51], v[28:31]
 v_rcp_f32 v68, v68
 v_mfma_f32_16x16x32_bf16 v[32:35], a[48:51], v[48:51], v[32:35]
 v_mul_f32 v13, v67, v13
 v_mfma_f32_16x16x32_bf16 v[36:39], a[52:55], v[48:51], v[36:39]
 v_rcp_f32 v69, v69
 v_mfma_f32_16x16x32_bf16 v[40:43], a[56:59], v[48:51], v[40:43]
 v_mul_f32 v14, v68, v14
 v_mul_f32 v15, v69, v15
 v_mfma_f32_16x16x32_bf16 v[44:47], a[60:63], v[48:51], v[44:47]
 v_cvt_pk_bf16_f32 v62, v12, v13
 s_waitcnt lgkmcnt(1)
 v_mfma_f32_16x16x32_bf16 v[24:27], a[64:67], v[52:55], v[24:27]
 ds_read_b128 v[48:51], v70 offset:19200
 v_cvt_pk_bf16_f32 v63, v14, v15
 v_mfma_f32_16x16x32_bf16 v[28:31], a[68:71], v[52:55], v[28:31]
 v_mul_f32 v66, s86, v16
 v_mul_f32 v67, s86, v17
 v_mfma_f32_16x16x32_bf16 v[32:35], a[72:75], v[52:55], v[32:35]
 v_exp_f32 v66, v66
 v_mfma_f32_16x16x32_bf16 v[36:39], a[76:79], v[52:55], v[36:39]
 v_mul_f32 v68, s86, v18
 v_mul_f32 v20, v16, v20
 v_mfma_f32_16x16x32_bf16 v[40:43], a[80:83], v[52:55], v[40:43]
 v_exp_f32 v67, v67
 v_mfma_f32_16x16x32_bf16 v[44:47], a[84:87], v[52:55], v[44:47]
 v_mul_f32 v69, s86, v19
 s_waitcnt lgkmcnt(1)
 v_mfma_f32_16x16x32_bf16 v[24:27], a[88:91], v[56:59], v[24:27]
 ds_read_b128 v[52:55], v71 offset:19200
 v_add_f32 v66, 1.0, v66
 v_mfma_f32_16x16x32_bf16 v[28:31], a[92:95], v[56:59], v[28:31]
 v_exp_f32 v68, v68
 v_mfma_f32_16x16x32_bf16 v[32:35], a[96:99], v[56:59], v[32:35]
 v_mul_f32 v21, v17, v21
 v_add_f32 v67, 1.0, v67
 v_mfma_f32_16x16x32_bf16 v[36:39], a[100:103], v[56:59], v[36:39]
 v_rcp_f32 v66, v66
 v_mfma_f32_16x16x32_bf16 v[40:43], a[104:107], v[56:59], v[40:43]
 v_mul_f32 v22, v18, v22
 v_add_f32 v68, 1.0, v68
 v_mfma_f32_16x16x32_bf16 v[44:47], a[108:111], v[56:59], v[44:47]
 s_waitcnt lgkmcnt(1)
 v_mfma_f32_16x16x32_bf16 v[24:27], a[112:115], v[48:51], v[24:27]
 ds_read_b128 v[56:59], v70 offset:19328
 v_mfma_f32_16x16x32_bf16 v[28:31], a[116:119], v[48:51], v[28:31]
 v_exp_f32 v69, v69
 v_mfma_f32_16x16x32_bf16 v[32:35], a[120:123], v[48:51], v[32:35]
 v_mul_f32 v23, v19, v23
 v_mul_f32 v20, v66, v20
 v_mfma_f32_16x16x32_bf16 v[36:39], a[124:127], v[48:51], v[36:39]
 v_rcp_f32 v67, v67
 v_mfma_f32_16x16x32_bf16 v[40:43], a[128:131], v[48:51], v[40:43]
 v_add_f32 v69, 1.0, v69
 v_mfma_f32_16x16x32_bf16 v[44:47], a[132:135], v[48:51], v[44:47]
 s_waitcnt lgkmcnt(1)
 v_mfma_f32_16x16x32_bf16 v[24:27], a[136:139], v[52:55], v[24:27]
 ds_read_b128 v[48:51], v71 offset:19328
 v_mfma_f32_16x16x32_bf16 v[28:31], a[140:143], v[52:55], v[28:31]
 v_rcp_f32 v68, v68
 v_mfma_f32_16x16x32_bf16 v[32:35], a[144:147], v[52:55], v[32:35]
 v_mul_f32 v21, v67, v21
 v_mfma_f32_16x16x32_bf16 v[36:39], a[148:151], v[52:55], v[36:39]
 v_rcp_f32 v69, v69
 v_mfma_f32_16x16x32_bf16 v[40:43], a[152:155], v[52:55], v[40:43]
 v_mul_f32 v22, v68, v22
 v_mul_f32 v23, v69, v23
 v_mfma_f32_16x16x32_bf16 v[44:47], a[156:159], v[52:55], v[44:47]
 s_waitcnt vmcnt(1)
 v_cmp_gt_u32 vcc, s74, v75
 s_waitcnt lgkmcnt(1)
 v_mfma_f32_16x16x32_bf16 v[24:27], a[160:163], v[56:59], v[24:27]
 ds_read_b128 v[52:55], v70 offset:19456
 v_cmp_gt_u32 s[66:67], s75, v75
 v_mfma_f32_16x16x32_bf16 v[28:31], a[164:167], v[56:59], v[28:31]
 v_cvt_pk_bf16_f32 v64, v20, v21
 v_cvt_pk_bf16_f32 v65, v22, v23
 v_mfma_f32_16x16x32_bf16 v[32:35], a[168:171], v[56:59], v[32:35]
 v_mfma_f32_16x16x32_bf16 v[36:39], a[172:175], v[56:59], v[36:39]
 s_cmp_eq_u32 s67, 0
 s_cselect_b32 s72, 2, 0
 s_cmp_eq_u32 vcc_lo, 0
 s_cselect_b32 s72, 1, s72
 v_mfma_f32_16x16x32_bf16 v[40:43], a[176:179], v[56:59], v[40:43]
 v_mov_b32 v76, s72
 v_mfma_f32_16x16x32_bf16 v[44:47], a[180:183], v[56:59], v[44:47]
 ds_write_b32 v72, v76 offset:4
 s_waitcnt lgkmcnt(2)
 v_mfma_f32_16x16x32_bf16 v[24:27], a[184:187], v[48:51], v[24:27]
 ds_read_b128 v[56:59], v71 offset:19456
 v_mfma_f32_16x16x32_bf16 v[28:31], a[188:191], v[48:51], v[28:31]
 v_mfma_f32_16x16x32_bf16 v[32:35], a[192:195], v[48:51], v[32:35]
 v_mfma_f32_16x16x32_bf16 v[36:39], a[196:199], v[48:51], v[36:39]
 v_mfma_f32_16x16x32_bf16 v[40:43], a[200:203], v[48:51], v[40:43]
 v_mfma_f32_16x16x32_bf16 v[44:47], a[204:207], v[48:51], v[44:47]
 s_waitcnt lgkmcnt(1)
 s_barrier
 ds_read_b32 v76, v73 offset:4
 s_waitcnt lgkmcnt(2)
 v_mfma_f32_16x16x32_bf16 v[24:27], a[208:211], v[52:55], v[24:27]
 v_mfma_f32_16x16x32_bf16 v[28:31], a[212:215], v[52:55], v[28:31]
 v_mfma_f32_16x16x32_bf16 v[32:35], a[216:219], v[52:55], v[32:35]
 v_mfma_f32_16x16x32_bf16 v[36:39], a[220:223], v[52:55], v[36:39]
 v_mfma_f32_16x16x32_bf16 v[40:43], a[224:227], v[52:55], v[40:43]
 v_mfma_f32_16x16x32_bf16 v[44:47], a[228:231], v[52:55], v[44:47]
 s_waitcnt lgkmcnt(1)
 v_mfma_f32_16x16x32_bf16 v[24:27], a[232:235], v[56:59], v[24:27]
 v_mfma_f32_16x16x32_bf16 v[28:31], a[236:239], v[56:59], v[28:31]
 v_mfma_f32_16x16x32_bf16 v[32:35], a[240:243], v[56:59], v[32:35]
 s_waitcnt lgkmcnt(0)
 v_readfirstlane_b32 s72, v76
 v_mfma_f32_16x16x32_bf16 v[36:39], a[244:247], v[56:59], v[36:39]
 v_mfma_f32_16x16x32_bf16 v[40:43], a[248:251], v[56:59], v[40:43]
 v_mfma_f32_16x16x32_bf16 v[44:47], a[252:255], v[56:59], v[44:47]
 s_cmp_lg_u32 s72, 0
 s_cbranch_scc0 L_u_t2
 s_sub_u32 s68, s72, 1
 s_cmp_eq_u32 s68, 0
 s_cselect_b32 s69, s74, s75
 s_cselect_b32 s63, s44, s47
 s_cselect_b32 s64, s45, s48
 s_cselect_b32 s80, s46, s49
 s_cmp_lt_u32 s69, s63
 s_cselect_b32 s80, s64, s80
 s_add_u32 s80, s80, s69
 s_cmp_eq_u32 s68, 0
 s_cselect_b32 s74, s80, s74
 s_cselect_b32 s75, s75, s80
 s_mul_i32 s73, s69, 36864
 s_mul_i32 s63, s68, 2359296
 s_add_u32 s73, s73, s63
 s_add_u32 s73, s73, s90
 s_mov_b32 m0, s70
 s_nop 0
 buffer_load_dwordx4 v72, s[8:11], s73 offen sc1 lds
 s_add_u32 m0, m0, s3
 s_add_u32 s73, s73, s3
 buffer_load_dwordx4 v72, s[8:11], s73 offen sc1 lds
 s_add_u32 m0, m0, s3
 s_add_u32 s73, s73, s3
 buffer_load_dwordx4 v72, s[8:11], s73 offen sc1 lds
 s_add_u32 m0, m0, s3
 s_add_u32 s73, s73, s3
 buffer_load_dwordx4 v72, s[8:11], s73 offen sc1 lds
 s_add_u32 m0, m0, s3
 s_add_u32 s73, s73, s3
 buffer_load_dwordx4 v72, s[8:11], s73 offen sc1 lds
 s_add_u32 m0, m0, s3
 s_add_u32 s73, s73, s3
 buffer_load_dwordx4 v72, s[8:11], s73 offen sc1 lds
 s_add_u32 m0, m0, s3
 s_add_u32 s73, s73, s3
 buffer_load_dwordx4 v72, s[8:11], s73 offen sc1 lds
 s_add_u32 m0, m0, s3
 s_add_u32 s73, s73, s3
 buffer_load_dwordx4 v72, s[8:11], s73 offen sc1 lds
 s_add_u32 m0, m0, s3
 s_add_u32 s73, s73, s3
 buffer_load_dwordx4 v72, s[8:11], s73 offen sc1 lds
 s_nop 7
 v_mul_f32 v0, s86, v24
 v_mul_f32 v1, s86, v25
 v_mul_f32 v2, s86, v26
 v_mul_f32 v3, s86, v27
 v_mul_f32 v4, s86, v32
 v_mul_f32 v5, s86, v33
 v_mul_f32 v6, s86, v34
 v_mul_f32 v7, s86, v35
 v_mul_f32 v8, s86, v40
 v_mul_f32 v9, s86, v41
 v_mul_f32 v10, s86, v42
 v_mul_f32 v11, s86, v43
 v_exp_f32 v0, v0
 v_exp_f32 v1, v1
 v_exp_f32 v2, v2
 v_exp_f32 v3, v3
 v_exp_f32 v4, v4
 v_exp_f32 v5, v5
 v_exp_f32 v6, v6
 v_exp_f32 v7, v7
 v_exp_f32 v8, v8
 v_exp_f32 v9, v9
 v_exp_f32 v10, v10
 v_exp_f32 v11, v11
 v_pk_mul_f32 v[28:29], v[24:25], v[28:29]
 v_pk_mul_f32 v[30:31], v[26:27], v[30:31]
 v_pk_mul_f32 v[36:37], v[32:33], v[36:37]
 v_pk_mul_f32 v[38:39], v[34:35], v[38:39]
 v_pk_mul_f32 v[44:45], v[40:41], v[44:45]
 v_pk_mul_f32 v[46:47], v[42:43], v[46:47]
 v_pk_add_f32 v[0:1], v[0:1], 1.0 op_sel_hi:[1,0]
 v_pk_add_f32 v[2:3], v[2:3], 1.0 op_sel_hi:[1,0]
 v_pk_add_f32 v[4:5], v[4:5], 1.0 op_sel_hi:[1,0]
 v_pk_add_f32 v[6:7], v[6:7], 1.0 op_sel_hi:[1,0]
 v_pk_add_f32 v[8:9], v[8:9], 1.0 op_sel_hi:[1,0]
 v_pk_add_f32 v[10:11], v[10:11], 1.0 op_sel_hi:[1,0]
 v_rcp_f32 v0, v0
 v_rcp_f32 v1, v1
 v_rcp_f32 v2, v2
 v_rcp_f32 v3, v3
 v_rcp_f32 v4, v4
 v_rcp_f32 v5, v5
 v_rcp_f32 v6, v6
 v_rcp_f32 v7, v7
 v_rcp_f32 v8, v8
 v_rcp_f32 v9, v9
 v_rcp_f32 v10, v10
 v_rcp_f32 v11, v11
 v_mov_b64 v[24:25], v[60:61]
 v_mov_b64 v[32:33], v[62:63]
 v_mov_b64 v[40:41], v[64:65]
 v_pk_mul_f32 v[28:29], v[0:1], v[28:29]
 v_pk_mul_f32 v[30:31], v[2:3], v[30:31]
 v_pk_mul_f32 v[36:37], v[4:5], v[36:37]
 v_pk_mul_f32 v[38:39], v[6:7], v[38:39]
 v_pk_mul_f32 v[44:45], v[8:9], v[44:45]
 v_pk_mul_f32 v[46:47], v[10:11], v[46:47]
 v_cvt_pk_bf16_f32 v26, v28, v29
 v_cvt_pk_bf16_f32 v27, v30, v31
 v_cvt_pk_bf16_f32 v34, v36, v37
 v_cvt_pk_bf16_f32 v35, v38, v39
 v_cvt_pk_bf16_f32 v42, v44, v45
 v_cvt_pk_bf16_f32 v43, v46, v47
 v_permlane32_swap_b32 v24, v26
 v_permlane32_swap_b32 v25, v27
 buffer_store_dwordx4 v[24:27], v73, s[8:11], s77 offen sc1
 v_permlane32_swap_b32 v32, v34
 v_permlane32_swap_b32 v33, v35
 buffer_store_dwordx4 v[32:35], v73, s[8:11], s78 offen sc1
 v_permlane32_swap_b32 v40, v42
 v_permlane32_swap_b32 v41, v43
 buffer_store_dwordx4 v[40:43], v73, s[8:11], s79 offen sc1
 s_mov_b32 s63, s85
 s_mov_b32 s85, s4
 s_mov_b32 s4, s5
 s_mov_b32 s5, s63
 s_add_u32 s70, s70, s85
 s_mov_b32 s81, s77
 s_mov_b32 s82, s78
 s_mov_b32 s83, s79
 s_mov_b32 s94, s92
 s_mov_b32 s95, s93
 s_mov_b32 s63, s69
 s_mul_i32 s63, s63, 294912
 s_mul_i32 s64, s68, 18874368
 s_add_u32 s63, s63, s64
 s_add_u32 s77, s63, s87
 s_add_u32 s78, s63, s88
 s_add_u32 s79, s63, s89
 s_mul_i32 s92, s68, 4096
 s_sub_u32 s93, s80, 1
 s_min_u32 s93, s93, 64
 s_add_u32 s61, s61, 1
 v_add_u32 v70, s5, v70
 v_add_u32 v71, s5, v71
 v_cmp_gt_u32 vcc, s74, v75
 v_cmp_gt_u32 s[66:67], s75, v75
 s_cmp_eq_u32 s67, 0
 s_cselect_b32 s72, 2, 0
 s_cmp_eq_u32 vcc_lo, 0
 s_cselect_b32 s72, 1, s72
 v_mov_b32 v76, s72
 ds_write_b32 v72, v76 offset:12
 s_waitcnt vmcnt(7) lgkmcnt(0)
 s_barrier
 ds_read_b32 v76, v73 offset:12
 ds_read_b128 v[48:51], v70 offset:0
 ds_read_b128 v[52:55], v71 offset:0
 s_waitcnt lgkmcnt(2)
 v_readfirstlane_b32 s72, v76
 s_cmp_lg_u32 s72, 0
 s_branch L_u_slow
L_u_t2:
 s_nop 7
 v_mul_f32 v0, s86, v24
 v_mul_f32 v1, s86, v25
 v_mul_f32 v2, s86, v26
 v_mul_f32 v3, s86, v27
 v_mul_f32 v4, s86, v32
 v_mul_f32 v5, s86, v33
 v_mul_f32 v6, s86, v34
 v_mul_f32 v7, s86, v35
 v_mul_f32 v8, s86, v40
 v_mul_f32 v9, s86, v41
 v_mul_f32 v10, s86, v42
 v_mul_f32 v11, s86, v43
 v_exp_f32 v0, v0
 v_exp_f32 v1, v1
 v_exp_f32 v2, v2
 v_exp_f32 v3, v3
 v_exp_f32 v4, v4
 v_exp_f32 v5, v5
 v_exp_f32 v6, v6
 v_exp_f32 v7, v7
 v_exp_f32 v8, v8
 v_exp_f32 v9, v9
 v_exp_f32 v10, v10
 v_exp_f32 v11, v11
 v_pk_mul_f32 v[28:29], v[24:25], v[28:29]
 v_pk_mul_f32 v[30:31], v[26:27], v[30:31]
 v_pk_mul_f32 v[36:37], v[32:33], v[36:37]
 v_pk_mul_f32 v[38:39], v[34:35], v[38:39]
 v_pk_mul_f32 v[44:45], v[40:41], v[44:45]
 v_pk_mul_f32 v[46:47], v[42:43], v[46:47]
 v_pk_add_f32 v[0:1], v[0:1], 1.0 op_sel_hi:[1,0]
 v_pk_add_f32 v[2:3], v[2:3], 1.0 op_sel_hi:[1,0]
 v_pk_add_f32 v[4:5], v[4:5], 1.0 op_sel_hi:[1,0]
 v_pk_add_f32 v[6:7], v[6:7], 1.0 op_sel_hi:[1,0]
 v_pk_add_f32 v[8:9], v[8:9], 1.0 op_sel_hi:[1,0]
 v_pk_add_f32 v[10:11], v[10:11], 1.0 op_sel_hi:[1,0]
 v_rcp_f32 v0, v0
 v_rcp_f32 v1, v1
 v_rcp_f32 v2, v2
 v_rcp_f32 v3, v3
 v_rcp_f32 v4, v4
 v_rcp_f32 v5, v5
 v_rcp_f32 v6, v6
 v_rcp_f32 v7, v7
 v_rcp_f32 v8, v8
 v_rcp_f32 v9, v9
 v_rcp_f32 v10, v10
 v_rcp_f32 v11, v11
 v_mov_b64 v[24:25], v[60:61]
 v_mov_b64 v[32:33], v[62:63]
 v_mov_b64 v[40:41], v[64:65]
 v_pk_mul_f32 v[28:29], v[0:1], v[28:29]
 v_pk_mul_f32 v[30:31], v[2:3], v[30:31]
 v_pk_mul_f32 v[36:37], v[4:5], v[36:37]
 v_pk_mul_f32 v[38:39], v[6:7], v[38:39]
 v_pk_mul_f32 v[44:45], v[8:9], v[44:45]
 v_pk_mul_f32 v[46:47], v[10:11], v[46:47]
 v_cvt_pk_bf16_f32 v26, v28, v29
 v_cvt_pk_bf16_f32 v27, v30, v31
 v_cvt_pk_bf16_f32 v34, v36, v37
 v_cvt_pk_bf16_f32 v35, v38, v39
 v_cvt_pk_bf16_f32 v42, v44, v45
 v_cvt_pk_bf16_f32 v43, v46, v47
 v_permlane32_swap_b32 v24, v26
 v_permlane32_swap_b32 v25, v27
 buffer_store_dwordx4 v[24:27], v73, s[8:11], s77 offen sc1
 v_permlane32_swap_b32 v32, v34
 v_permlane32_swap_b32 v33, v35
 buffer_store_dwordx4 v[32:35], v73, s[8:11], s78 offen sc1
 v_permlane32_swap_b32 v40, v42
 v_permlane32_swap_b32 v41, v43
 buffer_store_dwordx4 v[40:43], v73, s[8:11], s79 offen sc1
 v_mov_b32 v76, s93
 s_waitcnt vmcnt(0)
 s_barrier
 buffer_store_dword v76, v77, s[8:11], s92 offen sc1
 s_cmp_ge_u32 s61, s91
 s_cbranch_scc1 L_u_done
 s_branch L_u_idle
L_u_done:
 s_waitcnt vmcnt(0) lgkmcnt(0)
 s_endpgm
L_abort_b:
 s_branch L_abort
L_rerank_b:
 s_branch L_rerank
L_att:
 s_branch L_att_b
L_red:
 s_branch L_red_b
L_wo:
 s_cmp_lg_u32 s7, 0
 s_cbranch_scc1 Ld1_43
 v_mbcnt_lo_u32_b32 v1, -1, 0
 v_mbcnt_hi_u32_b32 v1, -1, v1
 s_mov_b32 s63, 80
 s_add_u32 s63, s63, s57
 s_lshl_b32 s63, s63, 2
 s_add_u32 s63, s63, s58
 s_lshl_b32 s63, s63, 10
 v_lshl_add_u32 v10, v1, 4, s63
 s_lshl_b32 s64, s58, 10
 s_mov_b32 m0, s64
 s_mov_b32 s65, 0
 buffer_load_dwordx4 v10, s[32:35], s65 offen lds
 buffer_load_dwordx4 v10, s[28:31], s65 offen lds
 s_mov_b32 s65, 524288
 buffer_load_dwordx4 v10, s[32:35], s65 offen lds
 buffer_load_dwordx4 v10, s[28:31], s65 offen lds
 s_mov_b32 s65, 1048576
 buffer_load_dwordx4 v10, s[32:35], s65 offen lds
 buffer_load_dwordx4 v10, s[28:31], s65 offen lds
 s_mov_b32 s65, 1572864
 buffer_load_dwordx4 v10, s[32:35], s65 offen lds
 buffer_load_dwordx4 v10, s[28:31], s65 offen lds
 s_cmp_lg_u32 s7, 0
 s_cbranch_scc1 Lln_44
 s_waitcnt vmcnt(11)
 v_lshlrev_b32 v52, 16, v40
 v_and_b32 v53, 0xffff0000, v40
 v_lshlrev_b32 v54, 16, v41
 v_and_b32 v55, 0xffff0000, v41
 v_lshlrev_b32 v56, 16, v42
 v_and_b32 v57, 0xffff0000, v42
 v_lshlrev_b32 v58, 16, v43
 v_and_b32 v59, 0xffff0000, v43
 v_lshlrev_b32 v60, 16, v44
 v_and_b32 v61, 0xffff0000, v44
 v_lshlrev_b32 v62, 16, v45
 v_and_b32 v63, 0xffff0000, v45
 v_lshlrev_b32 v64, 16, v46
 v_and_b32 v65, 0xffff0000, v46
 v_lshlrev_b32 v66, 16, v47
 v_and_b32 v67, 0xffff0000, v47
 v_lshlrev_b32 v68, 16, v48
 v_and_b32 v69, 0xffff0000, v48
 v_lshlrev_b32 v70, 16, v49
 v_and_b32 v71, 0xffff0000, v49
 v_lshlrev_b32 v72, 16, v50
 v_and_b32 v73, 0xffff0000, v50
 v_lshlrev_b32 v74, 16, v51
 v_and_b32 v75, 0xffff0000, v51
 v_pk_add_f32 v[20:21], v[52:53], v[54:55]
 v_pk_add_f32 v[20:21], v[20:21], v[56:57]
 v_pk_add_f32 v[20:21], v[20:21], v[58:59]
 v_pk_add_f32 v[20:21], v[20:21], v[60:61]
 v_pk_add_f32 v[20:21], v[20:21], v[62:63]
 v_pk_add_f32 v[20:21], v[20:21], v[64:65]
 v_pk_add_f32 v[20:21], v[20:21], v[66:67]
 v_pk_add_f32 v[20:21], v[20:21], v[68:69]
 v_pk_add_f32 v[20:21], v[20:21], v[70:71]
 v_pk_add_f32 v[20:21], v[20:21], v[72:73]
 v_pk_add_f32 v[20:21], v[20:21], v[74:75]
 v_add_f32 v20, v20, v21
 s_nop 1
 v_add_f32_dpp v20, v20, v20 quad_perm:[1,0,3,2] row_mask:0xf bank_mask:0xf
 s_nop 1
 v_add_f32_dpp v20, v20, v20 quad_perm:[2,3,0,1] row_mask:0xf bank_mask:0xf
 s_nop 1
 v_add_f32_dpp v20, v20, v20 row_half_mirror row_mask:0xf bank_mask:0xf
 s_nop 1
 v_add_f32_dpp v20, v20, v20 row_mirror row_mask:0xf bank_mask:0xf
 v_mov_b32 v21, v20
 s_nop 1
 v_permlane16_swap_b32 v20, v21
 v_add_f32 v20, v20, v21
 v_mul_f32 v20, v78, v20
 v_pk_add_f32 v[52:53], v[52:53], v[20:21] op_sel_hi:[1,0]
 v_pk_add_f32 v[54:55], v[54:55], v[20:21] op_sel_hi:[1,0]
 v_pk_add_f32 v[56:57], v[56:57], v[20:21] op_sel_hi:[1,0]
 v_pk_add_f32 v[58:59], v[58:59], v[20:21] op_sel_hi:[1,0]
 v_pk_add_f32 v[60:61], v[60:61], v[20:21] op_sel_hi:[1,0]
 v_pk_add_f32 v[62:63], v[62:63], v[20:21] op_sel_hi:[1,0]
 v_pk_add_f32 v[64:65], v[64:65], v[20:21] op_sel_hi:[1,0]
 v_pk_add_f32 v[66:67], v[66:67], v[20:21] op_sel_hi:[1,0]
 v_pk_add_f32 v[68:69], v[68:69], v[20:21] op_sel_hi:[1,0]
 v_pk_add_f32 v[70:71], v[70:71], v[20:21] op_sel_hi:[1,0]
 v_pk_add_f32 v[72:73], v[72:73], v[20:21] op_sel_hi:[1,0]
 v_pk_add_f32 v[74:75], v[74:75], v[20:21] op_sel_hi:[1,0]
 v_pk_mul_f32 v[22:23], v[52:53], v[52:53]
 v_pk_fma_f32 v[22:23], v[54:55], v[54:55], v[22:23]
 v_pk_fma_f32 v[22:23], v[56:57], v[56:57], v[22:23]
 v_pk_fma_f32 v[22:23], v[58:59], v[58:59], v[22:23]
 v_pk_fma_f32 v[22:23], v[60:61], v[60:61], v[22:23]
 v_pk_fma_f32 v[22:23], v[62:63], v[62:63], v[22:23]
 v_pk_fma_f32 v[22:23], v[64:65], v[64:65], v[22:23]
 v_pk_fma_f32 v[22:23], v[66:67], v[66:67], v[22:23]
 v_pk_fma_f32 v[22:23], v[68:69], v[68:69], v[22:23]
 v_pk_fma_f32 v[22:23], v[70:71], v[70:71], v[22:23]
 v_pk_fma_f32 v[22:23], v[72:73], v[72:73], v[22:23]
 v_pk_fma_f32 v[22:23], v[74:75], v[74:75], v[22:23]
 v_add_f32 v22, v22, v23
 s_nop 1
 v_add_f32_dpp v22, v22, v22 quad_perm:[1,0,3,2] row_mask:0xf bank_mask:0xf
 s_nop 1
 v_add_f32_dpp v22, v22, v22 quad_perm:[2,3,0,1] row_mask:0xf bank_mask:0xf
 s_nop 1
 v_add_f32_dpp v22, v22, v22 row_half_mirror row_mask:0xf bank_mask:0xf
 s_nop 1
 v_add_f32_dpp v22, v22, v22 row_mirror row_mask:0xf bank_mask:0xf
 v_mov_b32 v23, v22
 s_nop 1
 v_permlane16_swap_b32 v22, v23
 v_add_f32 v22, v22, v23
 v_mov_b32 v23, 0x3727c5ac
 v_fmac_f32 v23, 0x3ae38e39, v22
 v_rsq_f32 v22, v23
 v_sub_f32 v20, 0, v20
 v_mul_f32 v21, v23, v22
 v_lshrrev_b32 v76, 2, v0
 v_and_b32 v78, 31, v0
 v_cmp_eq_u32 vcc, 0, v78
 v_mov_b32 v78, 2147483632
 s_lshl_b32 s63, s2, 6
 v_cndmask_b32 v76, v78, v76, vcc
 s_add_u32 s63, s63, 12582912
 buffer_store_dwordx2 v[20:21], v76, s[8:11], s63 offen sc1
 s_add_u32 s63, s3, 3145728
 v_pk_mul_f32 v[52:53], v[52:53], v[22:23] op_sel_hi:[1,0]
 v_pk_mul_f32 v[54:55], v[54:55], v[22:23] op_sel_hi:[1,0]
 v_pk_mul_f32 v[56:57], v[56:57], v[22:23] op_sel_hi:[1,0]
 v_pk_mul_f32 v[58:59], v[58:59], v[22:23] op_sel_hi:[1,0]
 v_pk_mul_f32 v[60:61], v[60:61], v[22:23] op_sel_hi:[1,0]
 v_pk_mul_f32 v[62:63], v[62:63], v[22:23] op_sel_hi:[1,0]
 v_pk_mul_f32 v[64:65], v[64:65], v[22:23] op_sel_hi:[1,0]
 v_pk_mul_f32 v[66:67], v[66:67], v[22:23] op_sel_hi:[1,0]
 v_pk_mul_f32 v[68:69], v[68:69], v[22:23] op_sel_hi:[1,0]
 v_pk_mul_f32 v[70:71], v[70:71], v[22:23] op_sel_hi:[1,0]
 v_pk_mul_f32 v[72:73], v[72:73], v[22:23] op_sel_hi:[1,0]
 v_pk_mul_f32 v[74:75], v[74:75], v[22:23] op_sel_hi:[1,0]
 v_cvt_pk_bf16_f32 v40, v52, v53
 v_cvt_pk_bf16_f32 v41, v54, v55
 v_cvt_pk_bf16_f32 v42, v56, v57
 v_cvt_pk_bf16_f32 v43, v58, v59
 v_cvt_pk_bf16_f32 v44, v60, v61
 v_cvt_pk_bf16_f32 v45, v62, v63
 v_cvt_pk_bf16_f32 v46, v64, v65
 v_cvt_pk_bf16_f32 v47, v66, v67
 v_cvt_pk_bf16_f32 v48, v68, v69
 v_cvt_pk_bf16_f32 v49, v70, v71
 v_cvt_pk_bf16_f32 v50, v72, v73
 v_cvt_pk_bf16_f32 v51, v74, v75
 buffer_store_dwordx4 v[40:43], v77, s[8:11], s63 offen offset:0 sc1
 buffer_store_dwordx4 v[44:47], v77, s[8:11], s63 offen offset:384 sc1
 buffer_store_dwordx4 v[48:51], v77, s[8:11], s63 offen offset:768 sc1
Lln_44:
 s_mov_b32 s65, 2097152
 buffer_load_dwordx4 v10, s[32:35], s65 offen lds
 buffer_load_dwordx4 v10, s[28:31], s65 offen lds
 s_mov_b32 s65, 2621440
 buffer_load_dwordx4 v10, s[32:35], s65 offen lds
 buffer_load_dwordx4 v10, s[28:31], s65 offen lds
 s_mov_b32 s65, 3145728
 buffer_load_dwordx4 v10, s[32:35], s65 offen lds
 buffer_load_dwordx4 v10, s[28:31], s65 offen lds
 s_waitcnt vmcnt(6)
 s_cmp_lg_u32 s7, 0
 s_cbranch_scc1 Lar_45
 s_or_b32 s63, s6, 0x80
 v_mov_b32 v20, s63
 s_barrier
 buffer_store_byte v20, v79, s[20:23], 0 offen sc1
Lar_45:
 s_mov_b32 s65, 3670016
 buffer_load_dwordx4 v10, s[32:35], s65 offen lds
 buffer_load_dwordx4 v10, s[28:31], s65 offen lds
 s_mov_b32 s65, 4194304
 buffer_load_dwordx4 v10, s[32:35], s65 offen lds
 buffer_load_dwordx4 v10, s[28:31], s65 offen lds
 s_mov_b32 s65, 0
 buffer_load_dwordx4 v10, s[36:39], s65 offen lds
 buffer_load_dwordx4 v10, s[40:43], s65 offen lds
 s_mov_b32 s65, 524288
 buffer_load_dwordx4 v10, s[36:39], s65 offen lds
 buffer_load_dwordx4 v10, s[40:43], s65 offen lds
 s_mov_b32 s65, 1048576
 buffer_load_dwordx4 v10, s[36:39], s65 offen lds
 buffer_load_dwordx4 v10, s[40:43], s65 offen lds
 s_mov_b32 s65, 1572864
 buffer_load_dwordx4 v10, s[36:39], s65 offen lds
 buffer_load_dwordx4 v10, s[40:43], s65 offen lds
 s_mov_b32 s65, 2097152
 buffer_load_dwordx4 v10, s[36:39], s65 offen lds
 buffer_load_dwordx4 v10, s[40:43], s65 offen lds
 s_mov_b32 s65, 2621440
 buffer_load_dwordx4 v10, s[36:39], s65 offen lds
 buffer_load_dwordx4 v10, s[40:43], s65 offen lds
 s_mov_b32 s65, 3145728
 buffer_load_dwordx4 v10, s[36:39], s65 offen lds
 buffer_load_dwordx4 v10, s[40:43], s65 offen lds
 s_mov_b32 s65, 3670016
 buffer_load_dwordx4 v10, s[36:39], s65 offen lds
 buffer_load_dwordx4 v10, s[40:43], s65 offen lds
 s_mov_b32 s65, 4194304
 buffer_load_dwordx4 v10, s[36:39], s65 offen lds
 buffer_load_dwordx4 v10, s[40:43], s65 offen lds
 s_waitcnt vmcnt(0)
 s_mov_b32 s7, 2
 s_barrier
Ld1_43:
 s_mul_i32 s86, s57, 86
 s_lshr_b32 s86, s86, 8
 s_mul_i32 s63, s86, 3
 s_sub_u32 s80, s57, s63
 s_lshr_b32 s81, s86, 2
 s_and_b32 s86, s86, 3
 v_mbcnt_lo_u32_b32 v1, -1, 0
 v_mbcnt_hi_u32_b32 v1, -1, v1
 v_add_u32 v2, 0, v1
 v_mul_u32_u24 v3, 10923, v2
 v_lshrrev_b32 v3, 16, v3
 v_mul_u32_u24 v4, 6, v3
 v_sub_u32 v4, v2, v4
 v_mul_u32_u24 v3, 1152, v3
 v_lshl_add_u32 v10, v4, 4, v3
 v_add_u32 v2, 64, v1
 v_mul_u32_u24 v3, 10923, v2
 v_lshrrev_b32 v3, 16, v3
 v_mul_u32_u24 v4, 6, v3
 v_sub_u32 v4, v2, v4
 v_mul_u32_u24 v3, 1152, v3
 v_lshl_add_u32 v11, v4, 4, v3
 v_add_u32 v2, 128, v1
 v_mul_u32_u24 v3, 10923, v2
 v_lshrrev_b32 v3, 16, v3
 v_mul_u32_u24 v4, 6, v3
 v_sub_u32 v4, v2, v4
 v_mul_u32_u24 v3, 1152, v3
 v_lshl_add_u32 v12, v4, 4, v3
 v_lshrrev_b32 v2, 4, v1
 v_bfe_u32 v3, v1, 2, 2
 v_lshl_add_u32 v2, v2, 3, v3
 v_mul_u32_u24 v2, 96, v2
 s_mul_i32 s67, s58, 36864
 v_add_u32 v2, s67, v2
 v_and_b32 v3, 3, v1
 v_lshl_add_u32 v13, v3, 4, v2
 v_and_b32 v3, 1, v1
 v_lshl_add_u32 v2, v3, 4, v2
 v_bfe_u32 v3, v1, 1, 1
 v_lshl_add_u32 v14, v3, 3, v2
 s_mul_i32 s71, s80, 384
 s_mul_i32 s63, s58, 96
 s_add_u32 s71, s71, s63
 s_mul_i32 s65, s86, 1179648
 s_add_u32 s65, s65, s71
 s_cmp_lg_u32 s7, 0
 s_cbranch_scc1 Lln_46
 s_waitcnt vmcnt(3)
 v_lshlrev_b32 v52, 16, v40
 v_and_b32 v53, 0xffff0000, v40
 v_lshlrev_b32 v54, 16, v41
 v_and_b32 v55, 0xffff0000, v41
 v_lshlrev_b32 v56, 16, v42
 v_and_b32 v57, 0xffff0000, v42
 v_lshlrev_b32 v58, 16, v43
 v_and_b32 v59, 0xffff0000, v43
 v_lshlrev_b32 v60, 16, v44
 v_and_b32 v61, 0xffff0000, v44
 v_lshlrev_b32 v62, 16, v45
 v_and_b32 v63, 0xffff0000, v45
 v_lshlrev_b32 v64, 16, v46
 v_and_b32 v65, 0xffff0000, v46
 v_lshlrev_b32 v66, 16, v47
 v_and_b32 v67, 0xffff0000, v47
 v_lshlrev_b32 v68, 16, v48
 v_and_b32 v69, 0xffff0000, v48
 v_lshlrev_b32 v70, 16, v49
 v_and_b32 v71, 0xffff0000, v49
 v_lshlrev_b32 v72, 16, v50
 v_and_b32 v73, 0xffff0000, v50
 v_lshlrev_b32 v74, 16, v51
 v_and_b32 v75, 0xffff0000, v51
 v_pk_add_f32 v[20:21], v[52:53], v[54:55]
 v_pk_add_f32 v[20:21], v[20:21], v[56:57]
 v_pk_add_f32 v[20:21], v[20:21], v[58:59]
 v_pk_add_f32 v[20:21], v[20:21], v[60:61]
 v_pk_add_f32 v[20:21], v[20:21], v[62:63]
 v_pk_add_f32 v[20:21], v[20:21], v[64:65]
 v_pk_add_f32 v[20:21], v[20:21], v[66:67]
 v_pk_add_f32 v[20:21], v[20:21], v[68:69]
 v_pk_add_f32 v[20:21], v[20:21], v[70:71]
 v_pk_add_f32 v[20:21], v[20:21], v[72:73]
 v_pk_add_f32 v[20:21], v[20:21], v[74:75]
 v_add_f32 v20, v20, v21
 s_nop 1
 v_add_f32_dpp v20, v20, v20 quad_perm:[1,0,3,2] row_mask:0xf bank_mask:0xf
 s_nop 1
 v_add_f32_dpp v20, v20, v20 quad_perm:[2,3,0,1] row_mask:0xf bank_mask:0xf
 s_nop 1
 v_add_f32_dpp v20, v20, v20 row_half_mirror row_mask:0xf bank_mask:0xf
 s_nop 1
 v_add_f32_dpp v20, v20, v20 row_mirror row_mask:0xf bank_mask:0xf
 v_mov_b32 v21, v20
 s_nop 1
 v_permlane16_swap_b32 v20, v21
 v_add_f32 v20, v20, v21
 v_mul_f32 v20, v78, v20
 v_pk_add_f32 v[52:53], v[52:53], v[20:21] op_sel_hi:[1,0]
 v_pk_add_f32 v[54:55], v[54:55], v[20:21] op_sel_hi:[1,0]
 v_pk_add_f32 v[56:57], v[56:57], v[20:21] op_sel_hi:[1,0]
 v_pk_add_f32 v[58:59], v[58:59], v[20:21] op_sel_hi:[1,0]
 v_pk_add_f32 v[60:61], v[60:61], v[20:21] op_sel_hi:[1,0]
 v_pk_add_f32 v[62:63], v[62:63], v[20:21] op_sel_hi:[1,0]
 v_pk_add_f32 v[64:65], v[64:65], v[20:21] op_sel_hi:[1,0]
 v_pk_add_f32 v[66:67], v[66:67], v[20:21] op_sel_hi:[1,0]
 v_pk_add_f32 v[68:69], v[68:69], v[20:21] op_sel_hi:[1,0]
 v_pk_add_f32 v[70:71], v[70:71], v[20:21] op_sel_hi:[1,0]
 v_pk_add_f32 v[72:73], v[72:73], v[20:21] op_sel_hi:[1,0]
 v_pk_add_f32 v[74:75], v[74:75], v[20:21] op_sel_hi:[1,0]
 v_pk_mul_f32 v[22:23], v[52:53], v[52:53]
 v_pk_fma_f32 v[22:23], v[54:55], v[54:55], v[22:23]
 v_pk_fma_f32 v[22:23], v[56:57], v[56:57], v[22:23]
 v_pk_fma_f32 v[22:23], v[58:59], v[58:59], v[22:23]
 v_pk_fma_f32 v[22:23], v[60:61], v[60:61], v[22:23]
 v_pk_fma_f32 v[22:23], v[62:63], v[62:63], v[22:23]
 v_pk_fma_f32 v[22:23], v[64:65], v[64:65], v[22:23]
 v_pk_fma_f32 v[22:23], v[66:67], v[66:67], v[22:23]
 v_pk_fma_f32 v[22:23], v[68:69], v[68:69], v[22:23]
 v_pk_fma_f32 v[22:23], v[70:71], v[70:71], v[22:23]
 v_pk_fma_f32 v[22:23], v[72:73], v[72:73], v[22:23]
 v_pk_fma_f32 v[22:23], v[74:75], v[74:75], v[22:23]
 v_add_f32 v22, v22, v23
 s_nop 1
 v_add_f32_dpp v22, v22, v22 quad_perm:[1,0,3,2] row_mask:0xf bank_mask:0xf
 s_nop 1
 v_add_f32_dpp v22, v22, v22 quad_perm:[2,3,0,1] row_mask:0xf bank_mask:0xf
 s_nop 1
 v_add_f32_dpp v22, v22, v22 row_half_mirror row_mask:0xf bank_mask:0xf
 s_nop 1
 v_add_f32_dpp v22, v22, v22 row_mirror row_mask:0xf bank_mask:0xf
 v_mov_b32 v23, v22
 s_nop 1
 v_permlane16_swap_b32 v22, v23
 v_add_f32 v22, v22, v23
 v_mov_b32 v23, 0x3727c5ac
 v_fmac_f32 v23, 0x3ae38e39, v22
 v_rsq_f32 v22, v23
 v_sub_f32 v20, 0, v20
 v_mul_f32 v21, v23, v22
 v_lshrrev_b32 v76, 2, v0
 v_and_b32 v78, 31, v0
 v_cmp_eq_u32 vcc, 0, v78
 v_mov_b32 v78, 2147483632
 s_lshl_b32 s63, s2, 6
 v_cndmask_b32 v76, v78, v76, vcc
 s_add_u32 s63, s63, 12582912
 buffer_store_dwordx2 v[20:21], v76, s[8:11], s63 offen sc1
 s_add_u32 s63, s3, 3145728
 v_pk_mul_f32 v[52:53], v[52:53], v[22:23] op_sel_hi:[1,0]
 v_pk_mul_f32 v[54:55], v[54:55], v[22:23] op_sel_hi:[1,0]
 v_pk_mul_f32 v[56:57], v[56:57], v[22:23] op_sel_hi:[1,0]
 v_pk_mul_f32 v[58:59], v[58:59], v[22:23] op_sel_hi:[1,0]
 v_pk_mul_f32 v[60:61], v[60:61], v[22:23] op_sel_hi:[1,0]
 v_pk_mul_f32 v[62:63], v[62:63], v[22:23] op_sel_hi:[1,0]
 v_pk_mul_f32 v[64:65], v[64:65], v[22:23] op_sel_hi:[1,0]
 v_pk_mul_f32 v[66:67], v[66:67], v[22:23] op_sel_hi:[1,0]
 v_pk_mul_f32 v[68:69], v[68:69], v[22:23] op_sel_hi:[1,0]
 v_pk_mul_f32 v[70:71], v[70:71], v[22:23] op_sel_hi:[1,0]
 v_pk_mul_f32 v[72:73], v[72:73], v[22:23] op_sel_hi:[1,0]
 v_pk_mul_f32 v[74:75], v[74:75], v[22:23] op_sel_hi:[1,0]
 v_cvt_pk_bf16_f32 v40, v52, v53
 v_cvt_pk_bf16_f32 v41, v54, v55
 v_cvt_pk_bf16_f32 v42, v56, v57
 v_cvt_pk_bf16_f32 v43, v58, v59
 v_cvt_pk_bf16_f32 v44, v60, v61
 v_cvt_pk_bf16_f32 v45, v62, v63
 v_cvt_pk_bf16_f32 v46, v64, v65
 v_cvt_pk_bf16_f32 v47, v66, v67
 v_cvt_pk_bf16_f32 v48, v68, v69
 v_cvt_pk_bf16_f32 v49, v70, v71
 v_cvt_pk_bf16_f32 v50, v72, v73
 v_cvt_pk_bf16_f32 v51, v74, v75
 buffer_store_dwordx4 v[40:43], v77, s[8:11], s63 offen offset:0 sc1
 buffer_store_dwordx4 v[44:47], v77, s[8:11], s63 offen offset:384 sc1
 buffer_store_dwordx4 v[48:51], v77, s[8:11], s63 offen offset:768 sc1
Lln_46:
 s_add_u32 s69, s65, 0
 s_add_u32 m0, s67, 0
 s_nop 0
 buffer_load_dwordx4 v10, s[40:43], s69 offen lds
 s_add_u32 m0, s67, 1024
 s_nop 0
 buffer_load_dwordx4 v11, s[40:43], s69 offen lds
 s_add_u32 m0, s67, 2048
 s_nop 0
 buffer_load_dwordx4 v12, s[40:43], s69 offen lds
 s_waitcnt vmcnt(3)
 s_cmp_lg_u32 s7, 0
 s_cbranch_scc1 Lar_47
 s_or_b32 s63, s6, 0x80
 v_mov_b32 v20, s63
 s_barrier
 buffer_store_byte v20, v79, s[20:23], 0 offen sc1
Lar_47:
 s_add_u32 s69, s65, 36864
 s_add_u32 m0, s67, 3072
 s_nop 0
 buffer_load_dwordx4 v10, s[40:43], s69 offen lds
 s_add_u32 m0, s67, 4096
 s_nop 0
 buffer_load_dwordx4 v11, s[40:43], s69 offen lds
 s_add_u32 m0, s67, 5120
 s_nop 0
 buffer_load_dwordx4 v12, s[40:43], s69 offen lds
 s_add_u32 s69, s65, 73728
 s_add_u32 m0, s67, 6144
 s_nop 0
 buffer_load_dwordx4 v10, s[40:43], s69 offen lds
 s_add_u32 m0, s67, 7168
 s_nop 0
 buffer_load_dwordx4 v11, s[40:43], s69 offen lds
 s_add_u32 m0, s67, 8192
 s_nop 0
 buffer_load_dwordx4 v12, s[40:43], s69 offen lds
 s_add_u32 s69, s65, 110592
 s_add_u32 m0, s67, 9216
 s_nop 0
 buffer_load_dwordx4 v10, s[40:43], s69 offen lds
 s_add_u32 m0, s67, 10240
 s_nop 0
 buffer_load_dwordx4 v11, s[40:43], s69 offen lds
 s_add_u32 m0, s67, 11264
 s_nop 0
 buffer_load_dwordx4 v12, s[40:43], s69 offen lds
 s_add_u32 s69, s65, 147456
 s_add_u32 m0, s67, 12288
 s_nop 0
 buffer_load_dwordx4 v10, s[40:43], s69 offen lds
 s_add_u32 m0, s67, 13312
 s_nop 0
 buffer_load_dwordx4 v11, s[40:43], s69 offen lds
 s_add_u32 m0, s67, 14336
 s_nop 0
 buffer_load_dwordx4 v12, s[40:43], s69 offen lds
 s_add_u32 s69, s65, 184320
 s_add_u32 m0, s67, 15360
 s_nop 0
 buffer_load_dwordx4 v10, s[40:43], s69 offen lds
 s_add_u32 m0, s67, 16384
 s_nop 0
 buffer_load_dwordx4 v11, s[40:43], s69 offen lds
 s_add_u32 m0, s67, 17408
 s_nop 0
 buffer_load_dwordx4 v12, s[40:43], s69 offen lds
 s_add_u32 s69, s65, 221184
 s_add_u32 m0, s67, 18432
 s_nop 0
 buffer_load_dwordx4 v10, s[40:43], s69 offen lds
 s_add_u32 m0, s67, 19456
 s_nop 0
 buffer_load_dwordx4 v11, s[40:43], s69 offen lds
 s_add_u32 m0, s67, 20480
 s_nop 0
 buffer_load_dwordx4 v12, s[40:43], s69 offen lds
 s_add_u32 s69, s65, 258048
 s_add_u32 m0, s67, 21504
 s_nop 0
 buffer_load_dwordx4 v10, s[40:43], s69 offen lds
 s_add_u32 m0, s67, 22528
 s_nop 0
 buffer_load_dwordx4 v11, s[40:43], s69 offen lds
 s_add_u32 m0, s67, 23552
 s_nop 0
 buffer_load_dwordx4 v12, s[40:43], s69 offen lds
 s_add_u32 s69, s65, 294912
 s_add_u32 m0, s67, 24576
 s_nop 0
 buffer_load_dwordx4 v10, s[40:43], s69 offen lds
 s_add_u32 m0, s67, 25600
 s_nop 0
 buffer_load_dwordx4 v11, s[40:43], s69 offen lds
 s_add_u32 m0, s67, 26624
 s_nop 0
 buffer_load_dwordx4 v12, s[40:43], s69 offen lds
 s_add_u32 s69, s65, 331776
 s_add_u32 m0, s67, 27648
 s_nop 0
 buffer_load_dwordx4 v10, s[40:43], s69 offen lds
 s_add_u32 m0, s67, 28672
 s_nop 0
 buffer_load_dwordx4 v11, s[40:43], s69 offen lds
 s_add_u32 m0, s67, 29696
 s_nop 0
 buffer_load_dwordx4 v12, s[40:43], s69 offen lds
 s_add_u32 s69, s65, 368640
 s_add_u32 m0, s67, 30720
 s_nop 0
 buffer_load_dwordx4 v10, s[40:43], s69 offen lds
 s_add_u32 m0, s67, 31744
 s_nop 0
 buffer_load_dwordx4 v11, s[40:43], s69 offen lds
 s_add_u32 m0, s67, 32768
 s_nop 0
 buffer_load_dwordx4 v12, s[40:43], s69 offen lds
 s_add_u32 s69, s65, 405504
 s_add_u32 m0, s67, 33792
 s_nop 0
 buffer_load_dwordx4 v10, s[40:43], s69 offen lds
 s_add_u32 m0, s67, 34816
 s_nop 0
 buffer_load_dwordx4 v11, s[40:43], s69 offen lds
 s_add_u32 m0, s67, 35840
 s_nop 0
 buffer_load_dwordx4 v12, s[40:43], s69 offen lds
 s_waitcnt vmcnt(33)
 ds_read_b64_tr_b16 v[80:81], v13 offset:0
 ds_read_b64_tr_b16 v[82:83], v13 offset:384
 ds_read_b64_tr_b16 v[84:85], v13 offset:8
 ds_read_b64_tr_b16 v[86:87], v13 offset:392
 ds_read_b64_tr_b16 v[88:89], v14 offset:64
 ds_read_b64_tr_b16 v[90:91], v14 offset:448
 s_waitcnt lgkmcnt(0)
 s_add_u32 s69, s65, 442368
 s_add_u32 m0, s67, 0
 s_nop 0
 buffer_load_dwordx4 v10, s[40:43], s69 offen lds
 s_add_u32 m0, s67, 1024
 s_nop 0
 buffer_load_dwordx4 v11, s[40:43], s69 offen lds
 s_add_u32 m0, s67, 2048
 s_nop 0
 buffer_load_dwordx4 v12, s[40:43], s69 offen lds
 s_waitcnt vmcnt(33)
 ds_read_b64_tr_b16 v[92:93], v13 offset:3072
 ds_read_b64_tr_b16 v[94:95], v13 offset:3456
 ds_read_b64_tr_b16 v[96:97], v13 offset:3080
 ds_read_b64_tr_b16 v[98:99], v13 offset:3464
 ds_read_b64_tr_b16 v[100:101], v14 offset:3136
 ds_read_b64_tr_b16 v[102:103], v14 offset:3520
 s_waitcnt lgkmcnt(0)
 s_add_u32 s69, s65, 479232
 s_add_u32 m0, s67, 3072
 s_nop 0
 buffer_load_dwordx4 v10, s[40:43], s69 offen lds
 s_add_u32 m0, s67, 4096
 s_nop 0
 buffer_load_dwordx4 v11, s[40:43], s69 offen lds
 s_add_u32 m0, s67, 5120
 s_nop 0
 buffer_load_dwordx4 v12, s[40:43], s69 offen lds
 s_waitcnt vmcnt(33)
 ds_read_b64_tr_b16 v[104:105], v13 offset:6144
 ds_read_b64_tr_b16 v[106:107], v13 offset:6528
 ds_read_b64_tr_b16 v[108:109], v13 offset:6152
 ds_read_b64_tr_b16 v[110:111], v13 offset:6536
 ds_read_b64_tr_b16 v[112:113], v14 offset:6208
 ds_read_b64_tr_b16 v[114:115], v14 offset:6592
 s_waitcnt lgkmcnt(0)
 s_add_u32 s69, s65, 516096
 s_add_u32 m0, s67, 6144
 s_nop 0
 buffer_load_dwordx4 v10, s[40:43], s69 offen lds
 s_add_u32 m0, s67, 7168
 s_nop 0
 buffer_load_dwordx4 v11, s[40:43], s69 offen lds
 s_add_u32 m0, s67, 8192
 s_nop 0
 buffer_load_dwordx4 v12, s[40:43], s69 offen lds
 s_waitcnt vmcnt(33)
 ds_read_b64_tr_b16 v[116:117], v13 offset:9216
 ds_read_b64_tr_b16 v[118:119], v13 offset:9600
 ds_read_b64_tr_b16 v[120:121], v13 offset:9224
 ds_read_b64_tr_b16 v[122:123], v13 offset:9608
 ds_read_b64_tr_b16 v[124:125], v14 offset:9280
 ds_read_b64_tr_b16 v[126:127], v14 offset:9664
 s_waitcnt lgkmcnt(0)
 s_add_u32 s69, s65, 552960
 s_add_u32 m0, s67, 9216
 s_nop 0
 buffer_load_dwordx4 v10, s[40:43], s69 offen lds
 s_add_u32 m0, s67, 10240
 s_nop 0
 buffer_load_dwordx4 v11, s[40:43], s69 offen lds
 s_add_u32 m0, s67, 11264
 s_nop 0
 buffer_load_dwordx4 v12, s[40:43], s69 offen lds
 s_waitcnt vmcnt(33)
 ds_read_b64_tr_b16 v[128:129], v13 offset:12288
 ds_read_b64_tr_b16 v[130:131], v13 offset:12672
 ds_read_b64_tr_b16 v[132:133], v13 offset:12296
 ds_read_b64_tr_b16 v[134:135], v13 offset:12680
 ds_read_b64_tr_b16 v[136:137], v14 offset:12352
 ds_read_b64_tr_b16 v[138:139], v14 offset:12736
 s_waitcnt lgkmcnt(0)
 s_add_u32 s69, s65, 589824
 s_add_u32 m0, s67, 12288
 s_nop 0
 buffer_load_dwordx4 v10, s[40:43], s69 offen lds
 s_add_u32 m0, s67, 13312
 s_nop 0
 buffer_load_dwordx4 v11, s[40:43], s69 offen lds
 s_add_u32 m0, s67, 14336
 s_nop 0
 buffer_load_dwordx4 v12, s[40:43], s69 offen lds
 s_waitcnt vmcnt(33)
 ds_read_b64_tr_b16 v[140:141], v13 offset:15360
 ds_read_b64_tr_b16 v[142:143], v13 offset:15744
 ds_read_b64_tr_b16 v[144:145], v13 offset:15368
 ds_read_b64_tr_b16 v[146:147], v13 offset:15752
 ds_read_b64_tr_b16 v[148:149], v14 offset:15424
 ds_read_b64_tr_b16 v[150:151], v14 offset:15808
 s_waitcnt lgkmcnt(0)
 s_add_u32 s69, s65, 626688
 s_add_u32 m0, s67, 15360
 s_nop 0
 buffer_load_dwordx4 v10, s[40:43], s69 offen lds
 s_add_u32 m0, s67, 16384
 s_nop 0
 buffer_load_dwordx4 v11, s[40:43], s69 offen lds
 s_add_u32 m0, s67, 17408
 s_nop 0
 buffer_load_dwordx4 v12, s[40:43], s69 offen lds
 s_waitcnt vmcnt(33)
 ds_read_b64_tr_b16 v[152:153], v13 offset:18432
 ds_read_b64_tr_b16 v[154:155], v13 offset:18816
 ds_read_b64_tr_b16 v[156:157], v13 offset:18440
 ds_read_b64_tr_b16 v[158:159], v13 offset:18824
 ds_read_b64_tr_b16 v[160:161], v14 offset:18496
 ds_read_b64_tr_b16 v[162:163], v14 offset:18880
 s_waitcnt lgkmcnt(0)
 s_add_u32 s69, s65, 663552
 s_add_u32 m0, s67, 18432
 s_nop 0
 buffer_load_dwordx4 v10, s[40:43], s69 offen lds
 s_add_u32 m0, s67, 19456
 s_nop 0
 buffer_load_dwordx4 v11, s[40:43], s69 offen lds
 s_add_u32 m0, s67, 20480
 s_nop 0
 buffer_load_dwordx4 v12, s[40:43], s69 offen lds
 s_waitcnt vmcnt(33)
 ds_read_b64_tr_b16 v[164:165], v13 offset:21504
 ds_read_b64_tr_b16 v[166:167], v13 offset:21888
 ds_read_b64_tr_b16 v[168:169], v13 offset:21512
 ds_read_b64_tr_b16 v[170:171], v13 offset:21896
 ds_read_b64_tr_b16 v[172:173], v14 offset:21568
 ds_read_b64_tr_b16 v[174:175], v14 offset:21952
 s_waitcnt lgkmcnt(0)
 s_add_u32 s69, s65, 700416
 s_add_u32 m0, s67, 21504
 s_nop 0
 buffer_load_dwordx4 v10, s[40:43], s69 offen lds
 s_add_u32 m0, s67, 22528
 s_nop 0
 buffer_load_dwordx4 v11, s[40:43], s69 offen lds
 s_add_u32 m0, s67, 23552
 s_nop 0
 buffer_load_dwordx4 v12, s[40:43], s69 offen lds
 s_waitcnt vmcnt(33)
 ds_read_b64_tr_b16 v[176:177], v13 offset:24576
 ds_read_b64_tr_b16 v[178:179], v13 offset:24960
 ds_read_b64_tr_b16 v[180:181], v13 offset:24584
 ds_read_b64_tr_b16 v[182:183], v13 offset:24968
 ds_read_b64_tr_b16 v[184:185], v14 offset:24640
 ds_read_b64_tr_b16 v[186:187], v14 offset:25024
 s_waitcnt lgkmcnt(0)
 s_add_u32 s69, s65, 737280
 s_add_u32 m0, s67, 24576
 s_nop 0
 buffer_load_dwordx4 v10, s[40:43], s69 offen lds
 s_add_u32 m0, s67, 25600
 s_nop 0
 buffer_load_dwordx4 v11, s[40:43], s69 offen lds
 s_add_u32 m0, s67, 26624
 s_nop 0
 buffer_load_dwordx4 v12, s[40:43], s69 offen lds
 s_waitcnt vmcnt(33)
 ds_read_b64_tr_b16 v[188:189], v13 offset:27648
 ds_read_b64_tr_b16 v[190:191], v13 offset:28032
 ds_read_b64_tr_b16 v[192:193], v13 offset:27656
 ds_read_b64_tr_b16 v[194:195], v13 offset:28040
 ds_read_b64_tr_b16 v[196:197], v14 offset:27712
 ds_read_b64_tr_b16 v[198:199], v14 offset:28096
 s_waitcnt lgkmcnt(0)
 s_add_u32 s69, s65, 774144
 s_add_u32 m0, s67, 27648
 s_nop 0
 buffer_load_dwordx4 v10, s[40:43], s69 offen lds
 s_add_u32 m0, s67, 28672
 s_nop 0
 buffer_load_dwordx4 v11, s[40:43], s69 offen lds
 s_add_u32 m0, s67, 29696
 s_nop 0
 buffer_load_dwordx4 v12, s[40:43], s69 offen lds
 s_waitcnt vmcnt(33)
 ds_read_b64_tr_b16 v[200:201], v13 offset:30720
 ds_read_b64_tr_b16 v[202:203], v13 offset:31104
 ds_read_b64_tr_b16 v[204:205], v13 offset:30728
 ds_read_b64_tr_b16 v[206:207], v13 offset:31112
 ds_read_b64_tr_b16 v[208:209], v14 offset:30784
 ds_read_b64_tr_b16 v[210:211], v14 offset:31168
 s_waitcnt lgkmcnt(0)
 s_add_u32 s69, s65, 811008
 s_add_u32 m0, s67, 30720
 s_nop 0
 buffer_load_dwordx4 v10, s[40:43], s69 offen lds
 s_add_u32 m0, s67, 31744
 s_nop 0
 buffer_load_dwordx4 v11, s[40:43], s69 offen lds
 s_add_u32 m0, s67, 32768
 s_nop 0
 buffer_load_dwordx4 v12, s[40:43], s69 offen lds
 s_waitcnt vmcnt(33)
 ds_read_b64_tr_b16 v[212:213], v13 offset:33792
 ds_read_b64_tr_b16 v[214:215], v13 offset:34176
 ds_read_b64_tr_b16 v[216:217], v13 offset:33800
 ds_read_b64_tr_b16 v[218:219], v13 offset:34184
 ds_read_b64_tr_b16 v[220:221], v14 offset:33856
 ds_read_b64_tr_b16 v[222:223], v14 offset:34240
 s_waitcnt lgkmcnt(0)
 s_add_u32 s69, s65, 847872
 s_add_u32 m0, s67, 33792
 s_nop 0
 buffer_load_dwordx4 v10, s[40:43], s69 offen lds
 s_add_u32 m0, s67, 34816
 s_nop 0
 buffer_load_dwordx4 v11, s[40:43], s69 offen lds
 s_add_u32 m0, s67, 35840
 s_nop 0
 buffer_load_dwordx4 v12, s[40:43], s69 offen lds
 s_waitcnt vmcnt(33)
 ds_read_b64_tr_b16 v[224:225], v13 offset:0
 ds_read_b64_tr_b16 v[226:227], v13 offset:384
 ds_read_b64_tr_b16 v[228:229], v13 offset:8
 ds_read_b64_tr_b16 v[230:231], v13 offset:392
 ds_read_b64_tr_b16 v[232:233], v14 offset:64
 ds_read_b64_tr_b16 v[234:235], v14 offset:448
 s_waitcnt lgkmcnt(0)
 s_add_u32 s69, s65, 884736
 s_add_u32 m0, s67, 0
 s_nop 0
 buffer_load_dwordx4 v10, s[40:43], s69 offen lds
 s_add_u32 m0, s67, 1024
 s_nop 0
 buffer_load_dwordx4 v11, s[40:43], s69 offen lds
 s_add_u32 m0, s67, 2048
 s_nop 0
 buffer_load_dwordx4 v12, s[40:43], s69 offen lds
 s_waitcnt vmcnt(33)
 ds_read_b64_tr_b16 v[236:237], v13 offset:3072
 ds_read_b64_tr_b16 v[238:239], v13 offset:3456
 ds_read_b64_tr_b16 v[240:241], v13 offset:3080
 ds_read_b64_tr_b16 v[242:243], v13 offset:3464
 ds_read_b64_tr_b16 v[244:245], v14 offset:3136
 ds_read_b64_tr_b16 v[246:247], v14 offset:3520
 s_waitcnt lgkmcnt(0)
 s_add_u32 s69, s65, 921600
 s_add_u32 m0, s67, 3072
 s_nop 0
 buffer_load_dwordx4 v10, s[40:43], s69 offen lds
 s_add_u32 m0, s67, 4096
 s_nop 0
 buffer_load_dwordx4 v11, s[40:43], s69 offen lds
 s_add_u32 m0, s67, 5120
 s_nop 0
 buffer_load_dwordx4 v12, s[40:43], s69 offen lds
 s_waitcnt vmcnt(33)
 ds_read_b64_tr_b16 v[248:249], v13 offset:6144
 ds_read_b64_tr_b16 v[250:251], v13 offset:6528
 ds_read_b64_tr_b16 v[252:253], v13 offset:6152
 ds_read_b64_tr_b16 v[254:255], v13 offset:6536
 ds_read_b64_tr_b16 a[0:1], v14 offset:6208
 ds_read_b64_tr_b16 a[2:3], v14 offset:6592
 s_waitcnt lgkmcnt(0)
 s_add_u32 s69, s65, 958464
 s_add_u32 m0, s67, 6144
 s_nop 0
 buffer_load_dwordx4 v10, s[40:43], s69 offen lds
 s_add_u32 m0, s67, 7168
 s_nop 0
 buffer_load_dwordx4 v11, s[40:43], s69 offen lds
 s_add_u32 m0, s67, 8192
 s_nop 0
 buffer_load_dwordx4 v12, s[40:43], s69 offen lds
 s_waitcnt vmcnt(33)
 ds_read_b64_tr_b16 a[4:5], v13 offset:9216
 ds_read_b64_tr_b16 a[6:7], v13 offset:9600
 ds_read_b64_tr_b16 a[8:9], v13 offset:9224
 ds_read_b64_tr_b16 a[10:11], v13 offset:9608
 ds_read_b64_tr_b16 a[12:13], v14 offset:9280
 ds_read_b64_tr_b16 a[14:15], v14 offset:9664
 s_waitcnt lgkmcnt(0)
 s_add_u32 s69, s65, 995328
 s_add_u32 m0, s67, 9216
 s_nop 0
 buffer_load_dwordx4 v10, s[40:43], s69 offen lds
 s_add_u32 m0, s67, 10240
 s_nop 0
 buffer_load_dwordx4 v11, s[40:43], s69 offen lds
 s_add_u32 m0, s67, 11264
 s_nop 0
 buffer_load_dwordx4 v12, s[40:43], s69 offen lds
 s_waitcnt vmcnt(33)
 ds_read_b64_tr_b16 a[16:17], v13 offset:12288
 ds_read_b64_tr_b16 a[18:19], v13 offset:12672
 ds_read_b64_tr_b16 a[20:21], v13 offset:12296
 ds_read_b64_tr_b16 a[22:23], v13 offset:12680
 ds_read_b64_tr_b16 a[24:25], v14 offset:12352
 ds_read_b64_tr_b16 a[26:27], v14 offset:12736
 s_waitcnt lgkmcnt(0)
 s_add_u32 s69, s65, 1032192
 s_add_u32 m0, s67, 12288
 s_nop 0
 buffer_load_dwordx4 v10, s[40:43], s69 offen lds
 s_add_u32 m0, s67, 13312
 s_nop 0
 buffer_load_dwordx4 v11, s[40:43], s69 offen lds
 s_add_u32 m0, s67, 14336
 s_nop 0
 buffer_load_dwordx4 v12, s[40:43], s69 offen lds
 s_waitcnt vmcnt(33)
 ds_read_b64_tr_b16 a[28:29], v13 offset:15360
 ds_read_b64_tr_b16 a[30:31], v13 offset:15744
 ds_read_b64_tr_b16 a[32:33], v13 offset:15368
 ds_read_b64_tr_b16 a[34:35], v13 offset:15752
 ds_read_b64_tr_b16 a[36:37], v14 offset:15424
 ds_read_b64_tr_b16 a[38:39], v14 offset:15808
 s_waitcnt lgkmcnt(0)
 s_add_u32 s69, s65, 1069056
 s_add_u32 m0, s67, 15360
 s_nop 0
 buffer_load_dwordx4 v10, s[40:43], s69 offen lds
 s_add_u32 m0, s67, 16384
 s_nop 0
 buffer_load_dwordx4 v11, s[40:43], s69 offen lds
 s_add_u32 m0, s67, 17408
 s_nop 0
 buffer_load_dwordx4 v12, s[40:43], s69 offen lds
 s_waitcnt vmcnt(33)
 ds_read_b64_tr_b16 a[40:41], v13 offset:18432
 ds_read_b64_tr_b16 a[42:43], v13 offset:18816
 ds_read_b64_tr_b16 a[44:45], v13 offset:18440
 ds_read_b64_tr_b16 a[46:47], v13 offset:18824
 ds_read_b64_tr_b16 a[48:49], v14 offset:18496
 ds_read_b64_tr_b16 a[50:51], v14 offset:18880
 s_waitcnt lgkmcnt(0)
 s_add_u32 s69, s65, 1105920
 s_add_u32 m0, s67, 18432
 s_nop 0
 buffer_load_dwordx4 v10, s[40:43], s69 offen lds
 s_add_u32 m0, s67, 19456
 s_nop 0
 buffer_load_dwordx4 v11, s[40:43], s69 offen lds
 s_add_u32 m0, s67, 20480
 s_nop 0
 buffer_load_dwordx4 v12, s[40:43], s69 offen lds
 s_waitcnt vmcnt(33)
 ds_read_b64_tr_b16 a[52:53], v13 offset:21504
 ds_read_b64_tr_b16 a[54:55], v13 offset:21888
 ds_read_b64_tr_b16 a[56:57], v13 offset:21512
 ds_read_b64_tr_b16 a[58:59], v13 offset:21896
 ds_read_b64_tr_b16 a[60:61], v14 offset:21568
 ds_read_b64_tr_b16 a[62:63], v14 offset:21952
 s_waitcnt lgkmcnt(0)
 s_add_u32 s69, s65, 1142784
 s_add_u32 m0, s67, 21504
 s_nop 0
 buffer_load_dwordx4 v10, s[40:43], s69 offen lds
 s_add_u32 m0, s67, 22528
 s_nop 0
 buffer_load_dwordx4 v11, s[40:43], s69 offen lds
 s_add_u32 m0, s67, 23552
 s_nop 0
 buffer_load_dwordx4 v12, s[40:43], s69 offen lds
 s_waitcnt vmcnt(33)
 ds_read_b64_tr_b16 a[64:65], v13 offset:24576
 ds_read_b64_tr_b16 a[66:67], v13 offset:24960
 ds_read_b64_tr_b16 a[68:69], v13 offset:24584
 ds_read_b64_tr_b16 a[70:71], v13 offset:24968
 ds_read_b64_tr_b16 a[72:73], v14 offset:24640
 ds_read_b64_tr_b16 a[74:75], v14 offset:25024
 s_waitcnt vmcnt(30)
 ds_read_b64_tr_b16 a[76:77], v13 offset:27648
 ds_read_b64_tr_b16 a[78:79], v13 offset:28032
 ds_read_b64_tr_b16 a[80:81], v13 offset:27656
 ds_read_b64_tr_b16 a[82:83], v13 offset:28040
 ds_read_b64_tr_b16 a[84:85], v14 offset:27712
 ds_read_b64_tr_b16 a[86:87], v14 offset:28096
 s_waitcnt vmcnt(27)
 ds_read_b64_tr_b16 a[88:89], v13 offset:30720
 ds_read_b64_tr_b16 a[90:91], v13 offset:31104
 ds_read_b64_tr_b16 a[92:93], v13 offset:30728
 ds_read_b64_tr_b16 a[94:95], v13 offset:31112
 ds_read_b64_tr_b16 a[96:97], v14 offset:30784
 ds_read_b64_tr_b16 a[98:99], v14 offset:31168
 s_waitcnt vmcnt(24)
 ds_read_b64_tr_b16 a[100:101], v13 offset:33792
 ds_read_b64_tr_b16 a[102:103], v13 offset:34176
 ds_read_b64_tr_b16 a[104:105], v13 offset:33800
 ds_read_b64_tr_b16 a[106:107], v13 offset:34184
 ds_read_b64_tr_b16 a[108:109], v14 offset:33856
 ds_read_b64_tr_b16 a[110:111], v14 offset:34240
 s_waitcnt vmcnt(21)
 ds_read_b64_tr_b16 a[112:113], v13 offset:0
 ds_read_b64_tr_b16 a[114:115], v13 offset:384
 ds_read_b64_tr_b16 a[116:117], v13 offset:8
 ds_read_b64_tr_b16 a[118:119], v13 offset:392
 ds_read_b64_tr_b16 a[120:121], v14 offset:64
 ds_read_b64_tr_b16 a[122:123], v14 offset:448
 s_waitcnt vmcnt(18)
 ds_read_b64_tr_b16 a[124:125], v13 offset:3072
 ds_read_b64_tr_b16 a[126:127], v13 offset:3456
 ds_read_b64_tr_b16 a[128:129], v13 offset:3080
 ds_read_b64_tr_b16 a[130:131], v13 offset:3464
 ds_read_b64_tr_b16 a[132:133], v14 offset:3136
 ds_read_b64_tr_b16 a[134:135], v14 offset:3520
 s_waitcnt vmcnt(15)
 ds_read_b64_tr_b16 a[136:137], v13 offset:6144
 ds_read_b64_tr_b16 a[138:139], v13 offset:6528
 ds_read_b64_tr_b16 a[140:141], v13 offset:6152
 ds_read_b64_tr_b16 a[142:143], v13 offset:6536
 ds_read_b64_tr_b16 a[144:145], v14 offset:6208
 ds_read_b64_tr_b16 a[146:147], v14 offset:6592
 s_waitcnt vmcnt(12)
 ds_read_b64_tr_b16 a[148:149], v13 offset:9216
 ds_read_b64_tr_b16 a[150:151], v13 offset:9600
 ds_read_b64_tr_b16 a[152:153], v13 offset:9224
 ds_read_b64_tr_b16 a[154:155], v13 offset:9608
 ds_read_b64_tr_b16 a[156:157], v14 offset:9280
 ds_read_b64_tr_b16 a[158:159], v14 offset:9664
 s_waitcnt vmcnt(9)
 ds_read_b64_tr_b16 a[160:161], v13 offset:12288
 ds_read_b64_tr_b16 a[162:163], v13 offset:12672
 ds_read_b64_tr_b16 a[164:165], v13 offset:12296
 ds_read_b64_tr_b16 a[166:167], v13 offset:12680
 ds_read_b64_tr_b16 a[168:169], v14 offset:12352
 ds_read_b64_tr_b16 a[170:171], v14 offset:12736
 s_waitcnt vmcnt(6)
 ds_read_b64_tr_b16 a[172:173], v13 offset:15360
 ds_read_b64_tr_b16 a[174:175], v13 offset:15744
 ds_read_b64_tr_b16 a[176:177], v13 offset:15368
 ds_read_b64_tr_b16 a[178:179], v13 offset:15752
 ds_read_b64_tr_b16 a[180:181], v14 offset:15424
 ds_read_b64_tr_b16 a[182:183], v14 offset:15808
 s_waitcnt vmcnt(3)
 ds_read_b64_tr_b16 a[184:185], v13 offset:18432
 ds_read_b64_tr_b16 a[186:187], v13 offset:18816
 ds_read_b64_tr_b16 a[188:189], v13 offset:18440
 ds_read_b64_tr_b16 a[190:191], v13 offset:18824
 ds_read_b64_tr_b16 a[192:193], v14 offset:18496
 ds_read_b64_tr_b16 a[194:195], v14 offset:18880
 s_waitcnt vmcnt(0)
 ds_read_b64_tr_b16 a[196:197], v13 offset:21504
 ds_read_b64_tr_b16 a[198:199], v13 offset:21888
 ds_read_b64_tr_b16 a[200:201], v13 offset:21512
 ds_read_b64_tr_b16 a[202:203], v13 offset:21896
 ds_read_b64_tr_b16 a[204:205], v14 offset:21568
 ds_read_b64_tr_b16 a[206:207], v14 offset:21952
 s_waitcnt lgkmcnt(0)
 s_barrier
 s_cmp_eq_u32 s7, 1
 s_cbranch_scc1 Lvalok_50
 v_mbcnt_lo_u32_b32 v1, -1, 0
 v_mbcnt_hi_u32_b32 v1, -1, v1
 v_lshlrev_b32 v1, 2, v1
 s_mov_b32 s62, 0
 s_mov_b32 s63, 0x80808080
Lval_48:
 buffer_load_dword v2, v1, s[20:23], 0 offen sc1
 s_waitcnt vmcnt(0)
 v_and_b32 v3, s63, v2
 v_cmp_ne_u32 vcc, s63, v3
 s_cbranch_vccz Lvald_49
 s_add_u32 s62, s62, 1
 s_cmp_lt_u32 s62, 400000
 s_cbranch_scc1 Lval_48
Lvald_49:
 s_mov_b32 s63, 1
 s_cbranch_vccnz L_abort_b
 v_lshlrev_b32 v3, v2, 1
 v_lshrrev_b32 v4, 8, v2
 v_lshl_or_b32 v3, 1, v4, v3
 v_lshrrev_b32 v4, 16, v2
 v_lshl_or_b32 v3, 1, v4, v3
 v_lshrrev_b32 v4, 24, v2
 v_lshl_or_b32 v3, 1, v4, v3
 s_nop 1
 v_or_b32_dpp v3, v3, v3 quad_perm:[1,0,3,2] row_mask:0xf bank_mask:0xf
 v_cmp_ne_u32 vcc, 255, v3
 s_cbranch_vccnz L_rerank_b
 s_mov_b32 s7, 1
Lvalok_50:
 s_mul_i32 s64, s86, 3
 s_add_u32 s64, s64, s80
 s_lshl_b32 s63, s57, 2
 s_add_u32 s63, s63, 1024
 v_mbcnt_lo_u32_b32 v1, -1, 0
 v_mbcnt_hi_u32_b32 v1, -1, v1
 v_cmp_eq_u32 vcc, 0, v1
 v_mov_b32 v2, s63
 v_mov_b32 v77, 2147483632
 v_cndmask_b32 v77, v77, v2, vcc
 v_lshlrev_b32 v73, 4, v1
 s_lshl_b32 s87, s64, 2
 s_add_u32 s87, s87, s58
 s_mul_i32 s87, s87, 3072
 s_add_u32 s87, s87, 209715200
 s_mov_b32 s88, s87
 s_mov_b32 s89, s87
 s_mul_i32 s90, s86, 65536
 s_mov_b32 s91, 64
 s_mov_b32 s74, 1
 s_mov_b32 s75, 1
 v_lshrrev_b32 v2, 5, v1
 v_and_b32 v3, 31, v1
 s_add_u32 s74, s81, 1
 s_add_u32 s75, s81, 1
 s_cmp_eq_u32 s81, 0
 s_mov_b32 s44, 12
 s_mov_b32 s45, 2
 s_cselect_b32 s46, 1, 1000
 s_mov_b32 s47, 48
 s_mov_b32 s48, 1
 s_mov_b32 s49, 2
 s_cselect_b32 s75, 49, 1
 s_cselect_b32 s91, 66, 62
 s_sub_u32 s63, s75, 1
 v_mov_b32 v4, s81
 v_mov_b32 v5, s63
 buffer_store_dword v4, v77, s[8:11], 0 offen sc1
 buffer_store_dword v5, v77, s[8:11], 0 offen offset:512 sc1
 s_lshl_b32 s65, s86, 8
 v_and_b32 v4, 3, v3
 v_lshl_add_u32 v4, v4, 2, s65
 v_and_b32 v5, 4, v3
 v_lshl_add_u32 v4, v5, 5, v4
 v_and_b32 v5, 8, v3
 v_mul_u32_u24 v5, v5, v2
 v_lshl_add_u32 v4, v5, 1, v4
 v_lshl_add_u32 v4, v2, 12, v4
 v_add_u32 v74, 28672, v4
 v_and_b32 v4, 3, v3
 v_lshlrev_b32 v4, 2, v4
 v_lshl_add_u32 v4, v2, 7, v4
 v_add_u32 v4, 512, v4
 v_cmp_gt_u32 vcc, 16, v3
 v_mov_b64 v[8:9], 0
 v_mov_b64 v[10:11], 0
 v_cndmask_b32 v74, v4, v74, vcc
 v_mul_i32_i24 v65, 0, v2
 v_add_u32 v65, 4, v65
 v_cndmask_b32 v65, v65, 0, vcc
 v_mbcnt_lo_u32_b32 v1, -1, 0
 v_mbcnt_hi_u32_b32 v1, -1, v1
 v_lshlrev_b32 v70, 4, v1
 v_add_u32 v70, 81920, v70
 v_add_u32 v71, 32768, v70
 s_lshl_b32 s70, s58, 10
 v_lshl_add_u32 v72, v1, 4, s70
 s_add_u32 s70, s70, 8192
 s_mov_b32 s85, -73728
 s_mov_b32 s3, 4096
 s_mov_b32 s84, 1
 s_mov_b32 s4, 36864
 s_mov_b32 s5, 36864
 s_mov_b32 s61, 0
 s_mov_b32 s77, 0
 s_mov_b32 s78, 0
 s_mov_b32 s79, 0
 s_mov_b32 s92, 2147483632
 s_mov_b32 s93, 0
 s_cmp_eq_u32 s58, 0
 s_cbranch_scc1 Lw0_51
 v_mov_b32 v74, 2147483632
 v_mov_b32 v77, 2147483632
Lw0_51:
 s_add_u32 s90, s90, 138149888
 s_cmp_lg_u32 s59, 0
 s_cbranch_scc1 L_wo_sl
L_wo_idle:
 s_cmp_lg_u32 s58, 0
 s_cbranch_scc1 Lspd_53
 s_mov_b32 s62, 0
Lsp_52:
 buffer_load_dword v75, v74, s[8:11], 0 offen sc1
 s_waitcnt vmcnt(0)
 v_add_u32 v64, v65, v75
 v_cmp_gt_u32 vcc, s74, v64
 v_cmp_gt_u32 s[66:67], s75, v64
 s_cmp_eq_u32 s67, 0
 s_cselect_b32 s72, 2, 0
 s_cmp_eq_u32 vcc_lo, 0
 s_cselect_b32 s72, 1, s72
 v_mov_b32 v76, s72
 ds_write_b32 v72, v76 offset:4096
 s_cmp_lg_u32 s72, 0
 s_cbranch_scc1 Lspd_53
 s_add_u32 s62, s62, 1
 s_cmp_lt_u32 s62, 400000
 s_cbranch_scc1 Lsp_52
Lspd_53:
 s_waitcnt lgkmcnt(0)
 s_barrier
 ds_read_b32 v76, v73 offset:4096
 s_waitcnt lgkmcnt(0)
 v_readfirstlane_b32 s72, v76
 s_mov_b32 s63, 50
 s_cmp_eq_u32 s72, 0
 s_cbranch_scc1 L_abort_b
 s_sub_u32 s68, s72, 1
 s_cmp_eq_u32 s68, 0
 s_cselect_b32 s69, s74, s75
 s_cselect_b32 s63, s44, s47
 s_cselect_b32 s64, s45, s48
 s_cselect_b32 s80, s46, s49
 s_cmp_lt_u32 s69, s63
 s_cselect_b32 s80, s64, s80
 s_add_u32 s80, s80, s69
 s_cmp_eq_u32 s68, 0
 s_cselect_b32 s74, s80, s74
 s_cselect_b32 s75, s75, s80
 s_mul_i32 s73, s69, 262144
 s_mul_i32 s63, s68, 16777216
 s_add_u32 s73, s73, s63
 s_add_u32 s73, s73, s90
 s_mov_b32 m0, s70
 s_nop 0
 buffer_load_dwordx4 v72, s[8:11], s73 offen sc1 lds
 s_add_u32 m0, m0, s3
 s_add_u32 s73, s73, s3
 buffer_load_dwordx4 v72, s[8:11], s73 offen sc1 lds
 s_add_u32 m0, m0, s3
 s_add_u32 s73, s73, s3
 buffer_load_dwordx4 v72, s[8:11], s73 offen sc1 lds
 s_add_u32 m0, m0, s3
 s_add_u32 s73, s73, s3
 buffer_load_dwordx4 v72, s[8:11], s73 offen sc1 lds
 s_add_u32 m0, m0, s3
 s_add_u32 s73, s73, s3
 buffer_load_dwordx4 v72, s[8:11], s73 offen sc1 lds
 s_add_u32 m0, m0, s3
 s_add_u32 s73, s73, s3
 buffer_load_dwordx4 v72, s[8:11], s73 offen sc1 lds
 s_add_u32 m0, m0, s3
 s_add_u32 s73, s73, s3
 buffer_load_dwordx4 v72, s[8:11], s73 offen sc1 lds
 s_add_u32 m0, m0, s3
 s_add_u32 s73, s73, s3
 buffer_load_dwordx4 v72, s[8:11], s73 offen sc1 lds
 s_add_u32 m0, m0, s3
 s_add_u32 s73, s73, s3
 buffer_load_dwordx4 v72, s[8:11], s73 offen sc1 lds
 s_add_u32 m0, m0, s3
 s_add_u32 s73, s73, s3
 buffer_load_dwordx4 v72, s[8:11], s73 offen sc1 lds
 s_add_u32 m0, m0, s3
 s_add_u32 s73, s73, s3
 buffer_load_dwordx4 v72, s[8:11], s73 offen sc1 lds
 s_add_u32 m0, m0, s3
 s_add_u32 s73, s73, s3
 buffer_load_dwordx4 v72, s[8:11], s73 offen sc1 lds
 s_add_u32 m0, m0, s3
 s_add_u32 s73, s73, s3
 buffer_load_dwordx4 v72, s[8:11], s73 offen sc1 lds
 s_add_u32 m0, m0, s3
 s_add_u32 s73, s73, s3
 buffer_load_dwordx4 v72, s[8:11], s73 offen sc1 lds
 s_add_u32 m0, m0, s3
 s_add_u32 s73, s73, s3
 buffer_load_dwordx4 v72, s[8:11], s73 offen sc1 lds
 s_add_u32 m0, m0, s3
 s_add_u32 s73, s73, s3
 buffer_load_dwordx4 v72, s[8:11], s73 offen sc1 lds
 s_mov_b32 s5, s85
 s_sub_u32 s85, 0, s85
 s_add_u32 s70, s70, s85
 s_mov_b32 s81, s77
 s_mov_b32 s82, s78
 s_mov_b32 s83, s79
 s_mov_b32 s94, s92
 s_mov_b32 s95, s93
 s_mul_i32 s64, s68, 0
 s_add_u32 s64, s64, 4
 s_mul_i32 s63, s68, 0
 s_add_u32 s63, s63, 128
 s_mul_i32 s63, s69, s63
 s_lshr_b32 s63, s63, 9
 s_mul_i32 s63, s63, s64
 s_sub_u32 s63, s69, s63
 s_mul_i32 s63, s63, 294912
 s_mul_i32 s64, s68, 1179648
 s_add_u32 s63, s63, s64
 s_add_u32 s77, s63, s87
 s_add_u32 s78, s63, s88
 s_add_u32 s79, s63, s89
 s_mul_i32 s92, s68, 512
 s_sub_u32 s93, s80, 1
 s_min_u32 s93, s93, 64
 s_add_u32 s61, s61, 1
 v_add_u32 v70, s5, v70
 v_add_u32 v71, s5, v71
 v_add_u32 v64, v65, v75
 v_cmp_gt_u32 vcc, s74, v64
 v_cmp_gt_u32 s[66:67], s75, v64
 s_cmp_eq_u32 s67, 0
 s_cselect_b32 s72, 2, 0
 s_cmp_eq_u32 vcc_lo, 0
 s_cselect_b32 s72, 1, s72
 v_mov_b32 v76, s72
 ds_write_b32 v72, v76 offset:12
 s_waitcnt vmcnt(8) lgkmcnt(0)
 s_barrier
 ds_read_b32 v76, v73 offset:12
 ds_read_b128 v[24:27], v70 offset:0
 ds_read_b128 v[28:31], v70 offset:1024
 ds_read_b128 v[32:35], v70 offset:2048
 s_waitcnt lgkmcnt(3)
 v_readfirstlane_b32 s72, v76
 s_cmp_lg_u32 s72, 0
L_wo_slow:
 s_cbranch_scc1 L_wo_p0d
 s_waitcnt lgkmcnt(2)
 v_mfma_f32_16x16x32_bf16 v[0:3], v[80:83], v[24:27], 0
 ds_read_b128 v[36:39], v70 offset:3072
 v_mfma_f32_16x16x32_bf16 v[4:7], v[84:87], v[24:27], 0
 v_mfma_f32_16x16x32_bf16 v[8:11], v[88:91], v[24:27], 0
 s_waitcnt lgkmcnt(2)
 v_mfma_f32_16x16x32_bf16 v[0:3], v[92:95], v[28:31], v[0:3]
 ds_read_b128 v[24:27], v70 offset:4096
 v_mfma_f32_16x16x32_bf16 v[4:7], v[96:99], v[28:31], v[4:7]
 v_mfma_f32_16x16x32_bf16 v[8:11], v[100:103], v[28:31], v[8:11]
 s_waitcnt lgkmcnt(2)
 v_mfma_f32_16x16x32_bf16 v[0:3], v[104:107], v[32:35], v[0:3]
 ds_read_b128 v[28:31], v70 offset:5120
 v_mfma_f32_16x16x32_bf16 v[4:7], v[108:111], v[32:35], v[4:7]
 v_mfma_f32_16x16x32_bf16 v[8:11], v[112:115], v[32:35], v[8:11]
 s_waitcnt lgkmcnt(2)
 v_mfma_f32_16x16x32_bf16 v[0:3], v[116:119], v[36:39], v[0:3]
 ds_read_b128 v[32:35], v70 offset:6144
 v_mfma_f32_16x16x32_bf16 v[4:7], v[120:123], v[36:39], v[4:7]
 v_mfma_f32_16x16x32_bf16 v[8:11], v[124:127], v[36:39], v[8:11]
 s_waitcnt lgkmcnt(2)
 v_mfma_f32_16x16x32_bf16 v[0:3], v[128:131], v[24:27], v[0:3]
 ds_read_b128 v[36:39], v70 offset:7168
 v_mfma_f32_16x16x32_bf16 v[4:7], v[132:135], v[24:27], v[4:7]
 v_mfma_f32_16x16x32_bf16 v[8:11], v[136:139], v[24:27], v[8:11]
 s_waitcnt lgkmcnt(2)
 v_mfma_f32_16x16x32_bf16 v[0:3], v[140:143], v[28:31], v[0:3]
 ds_read_b128 v[24:27], v70 offset:8192
 v_mfma_f32_16x16x32_bf16 v[4:7], v[144:147], v[28:31], v[4:7]
 v_mfma_f32_16x16x32_bf16 v[8:11], v[148:151], v[28:31], v[8:11]
 s_waitcnt lgkmcnt(2)
 v_mfma_f32_16x16x32_bf16 v[0:3], v[152:155], v[32:35], v[0:3]
 ds_read_b128 v[28:31], v70 offset:9216
 v_mfma_f32_16x16x32_bf16 v[4:7], v[156:159], v[32:35], v[4:7]
 v_mfma_f32_16x16x32_bf16 v[8:11], v[160:163], v[32:35], v[8:11]
 s_waitcnt lgkmcnt(2)
 v_mfma_f32_16x16x32_bf16 v[0:3], v[164:167], v[36:39], v[0:3]
 ds_read_b128 v[32:35], v70 offset:10240
 v_mfma_f32_16x16x32_bf16 v[4:7], v[168:171], v[36:39], v[4:7]
 v_mfma_f32_16x16x32_bf16 v[8:11], v[172:175], v[36:39], v[8:11]
 s_waitcnt lgkmcnt(2)
 v_mfma_f32_16x16x32_bf16 v[0:3], v[176:179], v[24:27], v[0:3]
 ds_read_b128 v[36:39], v70 offset:11264
 v_mfma_f32_16x16x32_bf16 v[4:7], v[180:183], v[24:27], v[4:7]
 v_mfma_f32_16x16x32_bf16 v[8:11], v[184:187], v[24:27], v[8:11]
 s_waitcnt lgkmcnt(2)
 v_mfma_f32_16x16x32_bf16 v[0:3], v[188:191], v[28:31], v[0:3]
 ds_read_b128 v[24:27], v70 offset:12288
 v_mfma_f32_16x16x32_bf16 v[4:7], v[192:195], v[28:31], v[4:7]
 v_mfma_f32_16x16x32_bf16 v[8:11], v[196:199], v[28:31], v[8:11]
 s_waitcnt lgkmcnt(2)
 v_mfma_f32_16x16x32_bf16 v[0:3], v[200:203], v[32:35], v[0:3]
 ds_read_b128 v[28:31], v70 offset:13312
 v_mfma_f32_16x16x32_bf16 v[4:7], v[204:207], v[32:35], v[4:7]
 v_mfma_f32_16x16x32_bf16 v[8:11], v[208:211], v[32:35], v[8:11]
 s_waitcnt lgkmcnt(2)
 v_mfma_f32_16x16x32_bf16 v[0:3], v[212:215], v[36:39], v[0:3]
 ds_read_b128 v[32:35], v70 offset:14336
 v_mfma_f32_16x16x32_bf16 v[4:7], v[216:219], v[36:39], v[4:7]
 v_mfma_f32_16x16x32_bf16 v[8:11], v[220:223], v[36:39], v[8:11]
 s_waitcnt lgkmcnt(2)
 v_mfma_f32_16x16x32_bf16 v[0:3], v[224:227], v[24:27], v[0:3]
 ds_read_b128 v[36:39], v70 offset:15360
 v_mfma_f32_16x16x32_bf16 v[4:7], v[228:231], v[24:27], v[4:7]
 v_mfma_f32_16x16x32_bf16 v[8:11], v[232:235], v[24:27], v[8:11]
 s_waitcnt lgkmcnt(2)
 v_mfma_f32_16x16x32_bf16 v[0:3], v[236:239], v[28:31], v[0:3]
 ds_read_b128 v[24:27], v70 offset:16384
 v_mfma_f32_16x16x32_bf16 v[4:7], v[240:243], v[28:31], v[4:7]
 buffer_load_dword v75, v74, s[8:11], 0 offen sc1
 v_mfma_f32_16x16x32_bf16 v[8:11], v[244:247], v[28:31], v[8:11]
 s_waitcnt lgkmcnt(2)
 v_mfma_f32_16x16x32_bf16 v[0:3], v[248:251], v[32:35], v[0:3]
 ds_read_b128 v[28:31], v70 offset:17408
 v_mfma_f32_16x16x32_bf16 v[4:7], v[252:255], v[32:35], v[4:7]
 v_mfma_f32_16x16x32_bf16 v[8:11], a[0:3], v[32:35], v[8:11]
 s_waitcnt lgkmcnt(2)
 v_mfma_f32_16x16x32_bf16 v[0:3], a[4:7], v[36:39], v[0:3]
 ds_read_b128 v[32:35], v70 offset:18432
 v_mfma_f32_16x16x32_bf16 v[4:7], a[8:11], v[36:39], v[4:7]
 v_mfma_f32_16x16x32_bf16 v[8:11], a[12:15], v[36:39], v[8:11]
 s_waitcnt lgkmcnt(2)
 v_mfma_f32_16x16x32_bf16 v[0:3], a[16:19], v[24:27], v[0:3]
 ds_read_b128 v[36:39], v70 offset:19456
 v_mfma_f32_16x16x32_bf16 v[4:7], a[20:23], v[24:27], v[4:7]
 v_mfma_f32_16x16x32_bf16 v[8:11], a[24:27], v[24:27], v[8:11]
 s_waitcnt lgkmcnt(2)
 v_mfma_f32_16x16x32_bf16 v[0:3], a[28:31], v[28:31], v[0:3]
 ds_read_b128 v[24:27], v70 offset:20480
 v_mfma_f32_16x16x32_bf16 v[4:7], a[32:35], v[28:31], v[4:7]
 v_mfma_f32_16x16x32_bf16 v[8:11], a[36:39], v[28:31], v[8:11]
 s_waitcnt lgkmcnt(2)
 v_mfma_f32_16x16x32_bf16 v[0:3], a[40:43], v[32:35], v[0:3]
 ds_read_b128 v[28:31], v70 offset:21504
 v_mfma_f32_16x16x32_bf16 v[4:7], a[44:47], v[32:35], v[4:7]
 v_mfma_f32_16x16x32_bf16 v[8:11], a[48:51], v[32:35], v[8:11]
 s_waitcnt lgkmcnt(2)
 v_mfma_f32_16x16x32_bf16 v[0:3], a[52:55], v[36:39], v[0:3]
 ds_read_b128 v[32:35], v70 offset:22528
 v_mfma_f32_16x16x32_bf16 v[4:7], a[56:59], v[36:39], v[4:7]
 v_mfma_f32_16x16x32_bf16 v[8:11], a[60:63], v[36:39], v[8:11]
 s_waitcnt lgkmcnt(2)
 v_mfma_f32_16x16x32_bf16 v[0:3], a[64:67], v[24:27], v[0:3]
 ds_read_b128 v[36:39], v70 offset:23552
 v_mfma_f32_16x16x32_bf16 v[4:7], a[68:71], v[24:27], v[4:7]
 v_mfma_f32_16x16x32_bf16 v[8:11], a[72:75], v[24:27], v[8:11]
 s_waitcnt lgkmcnt(2)
 v_mfma_f32_16x16x32_bf16 v[0:3], a[76:79], v[28:31], v[0:3]
 ds_read_b128 v[24:27], v70 offset:24576
 v_mfma_f32_16x16x32_bf16 v[4:7], a[80:83], v[28:31], v[4:7]
 v_mfma_f32_16x16x32_bf16 v[8:11], a[84:87], v[28:31], v[8:11]
 s_waitcnt lgkmcnt(2)
 v_mfma_f32_16x16x32_bf16 v[0:3], a[88:91], v[32:35], v[0:3]
 ds_read_b128 v[28:31], v70 offset:25600
 v_mfma_f32_16x16x32_bf16 v[4:7], a[92:95], v[32:35], v[4:7]
 v_mfma_f32_16x16x32_bf16 v[8:11], a[96:99], v[32:35], v[8:11]
 s_waitcnt lgkmcnt(2)
 v_mfma_f32_16x16x32_bf16 v[0:3], a[100:103], v[36:39], v[0:3]
 ds_read_b128 v[32:35], v70 offset:26624
 v_mfma_f32_16x16x32_bf16 v[4:7], a[104:107], v[36:39], v[4:7]
 v_mfma_f32_16x16x32_bf16 v[8:11], a[108:111], v[36:39], v[8:11]
 s_waitcnt lgkmcnt(2)
 v_mfma_f32_16x16x32_bf16 v[0:3], a[112:115], v[24:27], v[0:3]
 ds_read_b128 v[36:39], v70 offset:27648
 v_mfma_f32_16x16x32_bf16 v[4:7], a[116:119], v[24:27], v[4:7]
 v_mfma_f32_16x16x32_bf16 v[8:11], a[120:123], v[24:27], v[8:11]
 s_waitcnt vmcnt(0)
 v_add_u32 v64, v65, v75
 v_cmp_gt_u32 vcc, s74, v64
 s_waitcnt lgkmcnt(2)
 v_mfma_f32_16x16x32_bf16 v[0:3], a[124:127], v[28:31], v[0:3]
 ds_read_b128 v[24:27], v70 offset:28672
 v_cmp_gt_u32 s[66:67], s75, v64
 v_mfma_f32_16x16x32_bf16 v[4:7], a[128:131], v[28:31], v[4:7]
 v_mfma_f32_16x16x32_bf16 v[8:11], a[132:135], v[28:31], v[8:11]
 s_waitcnt lgkmcnt(2)
 v_mfma_f32_16x16x32_bf16 v[0:3], a[136:139], v[32:35], v[0:3]
 ds_read_b128 v[28:31], v70 offset:29696
 s_cmp_eq_u32 s67, 0
 s_cselect_b32 s72, 2, 0
 s_cmp_eq_u32 vcc_lo, 0
 s_cselect_b32 s72, 1, s72
 v_mfma_f32_16x16x32_bf16 v[4:7], a[140:143], v[32:35], v[4:7]
 v_mov_b32 v76, s72
 v_mfma_f32_16x16x32_bf16 v[8:11], a[144:147], v[32:35], v[8:11]
 ds_write_b32 v72, v76 offset:0
 s_waitcnt lgkmcnt(3)
 v_mfma_f32_16x16x32_bf16 v[0:3], a[148:151], v[36:39], v[0:3]
 ds_read_b128 v[32:35], v70 offset:30720
 v_mfma_f32_16x16x32_bf16 v[4:7], a[152:155], v[36:39], v[4:7]
 v_mfma_f32_16x16x32_bf16 v[8:11], a[156:159], v[36:39], v[8:11]
 s_waitcnt lgkmcnt(3)
 v_mfma_f32_16x16x32_bf16 v[0:3], a[160:163], v[24:27], v[0:3]
 ds_read_b128 v[36:39], v70 offset:31744
 v_mfma_f32_16x16x32_bf16 v[4:7], a[164:167], v[24:27], v[4:7]
 v_mfma_f32_16x16x32_bf16 v[8:11], a[168:171], v[24:27], v[8:11]
 s_waitcnt vmcnt(1)
 s_waitcnt lgkmcnt(2)
 s_barrier
 ds_read_b32 v76, v73 offset:0
 v_mfma_f32_16x16x32_bf16 v[0:3], a[172:175], v[28:31], v[0:3]
 ds_read_b128 v[24:27], v71 offset:0
 v_mfma_f32_16x16x32_bf16 v[4:7], a[176:179], v[28:31], v[4:7]
 v_mfma_f32_16x16x32_bf16 v[8:11], a[180:183], v[28:31], v[8:11]
 s_waitcnt lgkmcnt(3)
 v_mfma_f32_16x16x32_bf16 v[0:3], a[184:187], v[32:35], v[0:3]
 ds_read_b128 v[28:31], v71 offset:1024
 v_mfma_f32_16x16x32_bf16 v[4:7], a[188:191], v[32:35], v[4:7]
 v_mfma_f32_16x16x32_bf16 v[8:11], a[192:195], v[32:35], v[8:11]
 s_waitcnt lgkmcnt(2)
 v_readfirstlane_b32 s72, v76
 v_mfma_f32_16x16x32_bf16 v[0:3], a[196:199], v[36:39], v[0:3]
 ds_read_b128 v[32:35], v71 offset:2048
 v_mfma_f32_16x16x32_bf16 v[4:7], a[200:203], v[36:39], v[4:7]
 v_mfma_f32_16x16x32_bf16 v[8:11], a[204:207], v[36:39], v[8:11]
 s_cmp_lg_u32 s72, 0
 s_cbranch_scc1 L_wo_p1d
 s_branch L_wo_p1n
L_wo_p0d:
 s_waitcnt lgkmcnt(2)
 v_mfma_f32_16x16x32_bf16 v[0:3], v[80:83], v[24:27], 0
 ds_read_b128 v[36:39], v70 offset:3072
 s_sub_u32 s68, s72, 1
 s_cmp_eq_u32 s68, 0
 s_cselect_b32 s69, s74, s75
 v_mfma_f32_16x16x32_bf16 v[4:7], v[84:87], v[24:27], 0
 s_cselect_b32 s63, s44, s47
 s_cselect_b32 s64, s45, s48
 s_cselect_b32 s80, s46, s49
 v_mfma_f32_16x16x32_bf16 v[8:11], v[88:91], v[24:27], 0
 s_cmp_lt_u32 s69, s63
 s_cselect_b32 s80, s64, s80
 s_add_u32 s80, s80, s69
 s_waitcnt lgkmcnt(2)
 v_mfma_f32_16x16x32_bf16 v[0:3], v[92:95], v[28:31], v[0:3]
 ds_read_b128 v[24:27], v70 offset:4096
 s_cmp_eq_u32 s68, 0
 s_cselect_b32 s74, s80, s74
 s_cselect_b32 s75, s75, s80
 v_mfma_f32_16x16x32_bf16 v[4:7], v[96:99], v[28:31], v[4:7]
 s_mul_i32 s73, s69, 262144
 s_mul_i32 s63, s68, 16777216
 s_add_u32 s73, s73, s63
 s_add_u32 s73, s73, s90
 v_mfma_f32_16x16x32_bf16 v[8:11], v[100:103], v[28:31], v[8:11]
 s_mov_b32 m0, s70
 s_waitcnt lgkmcnt(2)
 v_mfma_f32_16x16x32_bf16 v[0:3], v[104:107], v[32:35], v[0:3]
 ds_read_b128 v[28:31], v70 offset:5120
 v_mfma_f32_16x16x32_bf16 v[4:7], v[108:111], v[32:35], v[4:7]
 buffer_load_dwordx4 v72, s[8:11], s73 offen sc1 lds
 v_mfma_f32_16x16x32_bf16 v[8:11], v[112:115], v[32:35], v[8:11]
 s_waitcnt lgkmcnt(2)
 v_mfma_f32_16x16x32_bf16 v[0:3], v[116:119], v[36:39], v[0:3]
 ds_read_b128 v[32:35], v70 offset:6144
 v_mfma_f32_16x16x32_bf16 v[4:7], v[120:123], v[36:39], v[4:7]
 s_add_u32 m0, m0, s3
 s_add_u32 s73, s73, s3
 v_mfma_f32_16x16x32_bf16 v[8:11], v[124:127], v[36:39], v[8:11]
 buffer_load_dwordx4 v72, s[8:11], s73 offen sc1 lds
 s_waitcnt lgkmcnt(2)
 v_mfma_f32_16x16x32_bf16 v[0:3], v[128:131], v[24:27], v[0:3]
 ds_read_b128 v[36:39], v70 offset:7168
 v_mfma_f32_16x16x32_bf16 v[4:7], v[132:135], v[24:27], v[4:7]
 v_mfma_f32_16x16x32_bf16 v[8:11], v[136:139], v[24:27], v[8:11]
 s_add_u32 m0, m0, s3
 s_add_u32 s73, s73, s3
 s_waitcnt lgkmcnt(2)
 v_mfma_f32_16x16x32_bf16 v[0:3], v[140:143], v[28:31], v[0:3]
 ds_read_b128 v[24:27], v70 offset:8192
 v_mfma_f32_16x16x32_bf16 v[4:7], v[144:147], v[28:31], v[4:7]
 buffer_load_dwordx4 v72, s[8:11], s73 offen sc1 lds
 v_mfma_f32_16x16x32_bf16 v[8:11], v[148:151], v[28:31], v[8:11]
 s_waitcnt lgkmcnt(2)
 v_mfma_f32_16x16x32_bf16 v[0:3], v[152:155], v[32:35], v[0:3]
 ds_read_b128 v[28:31], v70 offset:9216
 v_mfma_f32_16x16x32_bf16 v[4:7], v[156:159], v[32:35], v[4:7]
 v_mfma_f32_16x16x32_bf16 v[8:11], v[160:163], v[32:35], v[8:11]
 s_add_u32 m0, m0, s3
 s_add_u32 s73, s73, s3
 s_waitcnt lgkmcnt(2)
 v_mfma_f32_16x16x32_bf16 v[0:3], v[164:167], v[36:39], v[0:3]
 ds_read_b128 v[32:35], v70 offset:10240
 v_mfma_f32_16x16x32_bf16 v[4:7], v[168:171], v[36:39], v[4:7]
 buffer_load_dwordx4 v72, s[8:11], s73 offen sc1 lds
 v_mfma_f32_16x16x32_bf16 v[8:11], v[172:175], v[36:39], v[8:11]
 s_waitcnt lgkmcnt(2)
 v_mfma_f32_16x16x32_bf16 v[0:3], v[176:179], v[24:27], v[0:3]
 ds_read_b128 v[36:39], v70 offset:11264
 v_mfma_f32_16x16x32_bf16 v[4:7], v[180:183], v[24:27], v[4:7]
 s_add_u32 m0, m0, s3
 s_add_u32 s73, s73, s3
 v_mfma_f32_16x16x32_bf16 v[8:11], v[184:187], v[24:27], v[8:11]
 buffer_load_dwordx4 v72, s[8:11], s73 offen sc1 lds
 s_waitcnt lgkmcnt(2)
 v_mfma_f32_16x16x32_bf16 v[0:3], v[188:191], v[28:31], v[0:3]
 ds_read_b128 v[24:27], v70 offset:12288
 v_mfma_f32_16x16x32_bf16 v[4:7], v[192:195], v[28:31], v[4:7]
 v_mfma_f32_16x16x32_bf16 v[8:11], v[196:199], v[28:31], v[8:11]
 s_add_u32 m0, m0, s3
 s_add_u32 s73, s73, s3
 s_waitcnt lgkmcnt(2)
 v_mfma_f32_16x16x32_bf16 v[0:3], v[200:203], v[32:35], v[0:3]
 ds_read_b128 v[28:31], v70 offset:13312
 v_mfma_f32_16x16x32_bf16 v[4:7], v[204:207], v[32:35], v[4:7]
 buffer_load_dwordx4 v72, s[8:11], s73 offen sc1 lds
 v_mfma_f32_16x16x32_bf16 v[8:11], v[208:211], v[32:35], v[8:11]
 s_waitcnt lgkmcnt(2)
 v_mfma_f32_16x16x32_bf16 v[0:3], v[212:215], v[36:39], v[0:3]
 ds_read_b128 v[32:35], v70 offset:14336
 v_mfma_f32_16x16x32_bf16 v[4:7], v[216:219], v[36:39], v[4:7]
 v_mfma_f32_16x16x32_bf16 v[8:11], v[220:223], v[36:39], v[8:11]
 s_add_u32 m0, m0, s3
 s_add_u32 s73, s73, s3
 s_waitcnt lgkmcnt(2)
 v_mfma_f32_16x16x32_bf16 v[0:3], v[224:227], v[24:27], v[0:3]
 ds_read_b128 v[36:39], v70 offset:15360
 v_mfma_f32_16x16x32_bf16 v[4:7], v[228:231], v[24:27], v[4:7]
 buffer_load_dwordx4 v72, s[8:11], s73 offen sc1 lds
 v_mfma_f32_16x16x32_bf16 v[8:11], v[232:235], v[24:27], v[8:11]
 s_waitcnt lgkmcnt(2)
 v_mfma_f32_16x16x32_bf16 v[0:3], v[236:239], v[28:31], v[0:3]
 ds_read_b128 v[24:27], v70 offset:16384
 v_mfma_f32_16x16x32_bf16 v[4:7], v[240:243], v[28:31], v[4:7]
 s_add_u32 m0, m0, s3
 s_add_u32 s73, s73, s3
 v_mfma_f32_16x16x32_bf16 v[8:11], v[244:247], v[28:31], v[8:11]
 buffer_load_dwordx4 v72, s[8:11], s73 offen sc1 lds
 s_waitcnt lgkmcnt(2)
 v_mfma_f32_16x16x32_bf16 v[0:3], v[248:251], v[32:35], v[0:3]
 ds_read_b128 v[28:31], v70 offset:17408
 v_mfma_f32_16x16x32_bf16 v[4:7], v[252:255], v[32:35], v[4:7]
 v_mfma_f32_16x16x32_bf16 v[8:11], a[0:3], v[32:35], v[8:11]
 s_waitcnt lgkmcnt(2)
 v_mfma_f32_16x16x32_bf16 v[0:3], a[4:7], v[36:39], v[0:3]
 ds_read_b128 v[32:35], v70 offset:18432
 v_mfma_f32_16x16x32_bf16 v[4:7], a[8:11], v[36:39], v[4:7]
 v_mfma_f32_16x16x32_bf16 v[8:11], a[12:15], v[36:39], v[8:11]
 s_waitcnt lgkmcnt(2)
 v_mfma_f32_16x16x32_bf16 v[0:3], a[16:19], v[24:27], v[0:3]
 ds_read_b128 v[36:39], v70 offset:19456
 v_mfma_f32_16x16x32_bf16 v[4:7], a[20:23], v[24:27], v[4:7]
 v_mfma_f32_16x16x32_bf16 v[8:11], a[24:27], v[24:27], v[8:11]
 s_waitcnt lgkmcnt(2)
 v_mfma_f32_16x16x32_bf16 v[0:3], a[28:31], v[28:31], v[0:3]
 ds_read_b128 v[24:27], v70 offset:20480
 v_mfma_f32_16x16x32_bf16 v[4:7], a[32:35], v[28:31], v[4:7]
 v_mfma_f32_16x16x32_bf16 v[8:11], a[36:39], v[28:31], v[8:11]
 s_waitcnt lgkmcnt(2)
 v_mfma_f32_16x16x32_bf16 v[0:3], a[40:43], v[32:35], v[0:3]
 ds_read_b128 v[28:31], v70 offset:21504
 v_mfma_f32_16x16x32_bf16 v[4:7], a[44:47], v[32:35], v[4:7]
 v_mfma_f32_16x16x32_bf16 v[8:11], a[48:51], v[32:35], v[8:11]
 s_waitcnt lgkmcnt(2)
 v_mfma_f32_16x16x32_bf16 v[0:3], a[52:55], v[36:39], v[0:3]
 ds_read_b128 v[32:35], v70 offset:22528
 v_mfma_f32_16x16x32_bf16 v[4:7], a[56:59], v[36:39], v[4:7]
 v_mfma_f32_16x16x32_bf16 v[8:11], a[60:63], v[36:39], v[8:11]
 s_waitcnt lgkmcnt(2)
 v_mfma_f32_16x16x32_bf16 v[0:3], a[64:67], v[24:27], v[0:3]
 ds_read_b128 v[36:39], v70 offset:23552
 v_mfma_f32_16x16x32_bf16 v[4:7], a[68:71], v[24:27], v[4:7]
 v_mfma_f32_16x16x32_bf16 v[8:11], a[72:75], v[24:27], v[8:11]
 s_waitcnt lgkmcnt(2)
 v_mfma_f32_16x16x32_bf16 v[0:3], a[76:79], v[28:31], v[0:3]
 ds_read_b128 v[24:27], v70 offset:24576
 v_mfma_f32_16x16x32_bf16 v[4:7], a[80:83], v[28:31], v[4:7]
 v_mfma_f32_16x16x32_bf16 v[8:11], a[84:87], v[28:31], v[8:11]
 s_waitcnt lgkmcnt(2)
 v_mfma_f32_16x16x32_bf16 v[0:3], a[88:91], v[32:35], v[0:3]
 ds_read_b128 v[28:31], v70 offset:25600
 v_mfma_f32_16x16x32_bf16 v[4:7], a[92:95], v[32:35], v[4:7]
 v_mfma_f32_16x16x32_bf16 v[8:11], a[96:99], v[32:35], v[8:11]
 s_waitcnt lgkmcnt(2)
 v_mfma_f32_16x16x32_bf16 v[0:3], a[100:103], v[36:39], v[0:3]
 ds_read_b128 v[32:35], v70 offset:26624
 v_mfma_f32_16x16x32_bf16 v[4:7], a[104:107], v[36:39], v[4:7]
 v_mfma_f32_16x16x32_bf16 v[8:11], a[108:111], v[36:39], v[8:11]
 s_waitcnt lgkmcnt(2)
 v_mfma_f32_16x16x32_bf16 v[0:3], a[112:115], v[24:27], v[0:3]
 ds_read_b128 v[36:39], v70 offset:27648
 v_mfma_f32_16x16x32_bf16 v[4:7], a[116:119], v[24:27], v[4:7]
 v_mfma_f32_16x16x32_bf16 v[8:11], a[120:123], v[24:27], v[8:11]
 s_waitcnt lgkmcnt(2)
 v_mfma_f32_16x16x32_bf16 v[0:3], a[124:127], v[28:31], v[0:3]
 ds_read_b128 v[24:27], v70 offset:28672
 v_mfma_f32_16x16x32_bf16 v[4:7], a[128:131], v[28:31], v[4:7]
 v_mfma_f32_16x16x32_bf16 v[8:11], a[132:135], v[28:31], v[8:11]
 s_waitcnt lgkmcnt(2)
 v_mfma_f32_16x16x32_bf16 v[0:3], a[136:139], v[32:35], v[0:3]
 ds_read_b128 v[28:31], v70 offset:29696
 v_mfma_f32_16x16x32_bf16 v[4:7], a[140:143], v[32:35], v[4:7]
 v_mfma_f32_16x16x32_bf16 v[8:11], a[144:147], v[32:35], v[8:11]
 s_waitcnt lgkmcnt(2)
 v_mfma_f32_16x16x32_bf16 v[0:3], a[148:151], v[36:39], v[0:3]
 ds_read_b128 v[32:35], v70 offset:30720
 v_mfma_f32_16x16x32_bf16 v[4:7], a[152:155], v[36:39], v[4:7]
 v_mfma_f32_16x16x32_bf16 v[8:11], a[156:159], v[36:39], v[8:11]
 s_waitcnt lgkmcnt(2)
 v_mfma_f32_16x16x32_bf16 v[0:3], a[160:163], v[24:27], v[0:3]
 ds_read_b128 v[36:39], v70 offset:31744
 v_mfma_f32_16x16x32_bf16 v[4:7], a[164:167], v[24:27], v[4:7]
 v_mfma_f32_16x16x32_bf16 v[8:11], a[168:171], v[24:27], v[8:11]
 s_waitcnt vmcnt(8)
 s_barrier
 s_waitcnt lgkmcnt(2)
 v_mfma_f32_16x16x32_bf16 v[0:3], a[172:175], v[28:31], v[0:3]
 ds_read_b128 v[24:27], v71 offset:0
 v_mfma_f32_16x16x32_bf16 v[4:7], a[176:179], v[28:31], v[4:7]
 s_add_u32 m0, m0, s3
 s_add_u32 s73, s73, s3
 v_mfma_f32_16x16x32_bf16 v[8:11], a[180:183], v[28:31], v[8:11]
 buffer_load_dwordx4 v72, s[8:11], s73 offen sc1 lds
 s_waitcnt lgkmcnt(2)
 v_mfma_f32_16x16x32_bf16 v[0:3], a[184:187], v[32:35], v[0:3]
 ds_read_b128 v[28:31], v71 offset:1024
 v_mfma_f32_16x16x32_bf16 v[4:7], a[188:191], v[32:35], v[4:7]
 v_mfma_f32_16x16x32_bf16 v[8:11], a[192:195], v[32:35], v[8:11]
 s_add_u32 m0, m0, s3
 s_add_u32 s73, s73, s3
 s_waitcnt lgkmcnt(2)
 v_mfma_f32_16x16x32_bf16 v[0:3], a[196:199], v[36:39], v[0:3]
 ds_read_b128 v[32:35], v71 offset:2048
 v_mfma_f32_16x16x32_bf16 v[4:7], a[200:203], v[36:39], v[4:7]
 buffer_load_dwordx4 v72, s[8:11], s73 offen sc1 lds
 v_mfma_f32_16x16x32_bf16 v[8:11], a[204:207], v[36:39], v[8:11]
 s_waitcnt lgkmcnt(2)
 v_mfma_f32_16x16x32_bf16 v[12:15], v[80:83], v[24:27], 0
 ds_read_b128 v[36:39], v71 offset:3072
 v_mfma_f32_16x16x32_bf16 v[16:19], v[84:87], v[24:27], 0
 v_mfma_f32_16x16x32_bf16 v[20:23], v[88:91], v[24:27], 0
 s_add_u32 m0, m0, s3
 s_add_u32 s73, s73, s3
 s_waitcnt lgkmcnt(2)
 v_mfma_f32_16x16x32_bf16 v[12:15], v[92:95], v[28:31], v[12:15]
 ds_read_b128 v[24:27], v71 offset:4096
 v_mfma_f32_16x16x32_bf16 v[16:19], v[96:99], v[28:31], v[16:19]
 buffer_load_dwordx4 v72, s[8:11], s73 offen sc1 lds
 v_mfma_f32_16x16x32_bf16 v[20:23], v[100:103], v[28:31], v[20:23]
 v_cvt_pk_bf16_f32 v48, v0, v1
 s_waitcnt lgkmcnt(2)
 v_mfma_f32_16x16x32_bf16 v[12:15], v[104:107], v[32:35], v[12:15]
 ds_read_b128 v[28:31], v71 offset:5120
 v_cvt_pk_bf16_f32 v49, v2, v3
 v_mfma_f32_16x16x32_bf16 v[16:19], v[108:111], v[32:35], v[16:19]
 s_add_u32 m0, m0, s3
 s_add_u32 s73, s73, s3
 v_mfma_f32_16x16x32_bf16 v[20:23], v[112:115], v[32:35], v[20:23]
 buffer_load_dwordx4 v72, s[8:11], s73 offen sc1 lds
 s_waitcnt lgkmcnt(2)
 v_mfma_f32_16x16x32_bf16 v[12:15], v[116:119], v[36:39], v[12:15]
 ds_read_b128 v[32:35], v71 offset:6144
 v_cvt_pk_bf16_f32 v50, v4, v5
 v_mfma_f32_16x16x32_bf16 v[16:19], v[120:123], v[36:39], v[16:19]
 v_cvt_pk_bf16_f32 v51, v6, v7
 v_cvt_pk_bf16_f32 v56, v8, v9
 v_mfma_f32_16x16x32_bf16 v[20:23], v[124:127], v[36:39], v[20:23]
 s_add_u32 m0, m0, s3
 s_add_u32 s73, s73, s3
 s_waitcnt lgkmcnt(2)
 v_mfma_f32_16x16x32_bf16 v[12:15], v[128:131], v[24:27], v[12:15]
 ds_read_b128 v[36:39], v71 offset:7168
 v_cvt_pk_bf16_f32 v57, v10, v11
 v_mfma_f32_16x16x32_bf16 v[16:19], v[132:135], v[24:27], v[16:19]
 buffer_load_dwordx4 v72, s[8:11], s73 offen sc1 lds
 v_mfma_f32_16x16x32_bf16 v[20:23], v[136:139], v[24:27], v[20:23]
 s_waitcnt lgkmcnt(2)
 v_mfma_f32_16x16x32_bf16 v[12:15], v[140:143], v[28:31], v[12:15]
 ds_read_b128 v[24:27], v71 offset:8192
 v_mfma_f32_16x16x32_bf16 v[16:19], v[144:147], v[28:31], v[16:19]
 v_mfma_f32_16x16x32_bf16 v[20:23], v[148:151], v[28:31], v[20:23]
 s_add_u32 m0, m0, s3
 s_add_u32 s73, s73, s3
 s_waitcnt lgkmcnt(2)
 v_mfma_f32_16x16x32_bf16 v[12:15], v[152:155], v[32:35], v[12:15]
 ds_read_b128 v[28:31], v71 offset:9216
 v_mfma_f32_16x16x32_bf16 v[16:19], v[156:159], v[32:35], v[16:19]
 buffer_load_dwordx4 v72, s[8:11], s73 offen sc1 lds
 v_mfma_f32_16x16x32_bf16 v[20:23], v[160:163], v[32:35], v[20:23]
 s_waitcnt lgkmcnt(2)
 v_mfma_f32_16x16x32_bf16 v[12:15], v[164:167], v[36:39], v[12:15]
 ds_read_b128 v[32:35], v71 offset:10240
 v_mfma_f32_16x16x32_bf16 v[16:19], v[168:171], v[36:39], v[16:19]
 s_add_u32 m0, m0, s3
 s_add_u32 s73, s73, s3
 v_mfma_f32_16x16x32_bf16 v[20:23], v[172:175], v[36:39], v[20:23]
 buffer_load_dwordx4 v72, s[8:11], s73 offen sc1 lds
 s_waitcnt lgkmcnt(2)
 v_mfma_f32_16x16x32_bf16 v[12:15], v[176:179], v[24:27], v[12:15]
 ds_read_b128 v[36:39], v71 offset:11264
 v_mfma_f32_16x16x32_bf16 v[16:19], v[180:183], v[24:27], v[16:19]
 v_mfma_f32_16x16x32_bf16 v[20:23], v[184:187], v[24:27], v[20:23]
 s_add_u32 m0, m0, s3
 s_add_u32 s73, s73, s3
 s_waitcnt lgkmcnt(2)
 v_mfma_f32_16x16x32_bf16 v[12:15], v[188:191], v[28:31], v[12:15]
 ds_read_b128 v[24:27], v71 offset:12288
 v_mfma_f32_16x16x32_bf16 v[16:19], v[192:195], v[28:31], v[16:19]
 buffer_load_dwordx4 v72, s[8:11], s73 offen sc1 lds
 v_mfma_f32_16x16x32_bf16 v[20:23], v[196:199], v[28:31], v[20:23]
 s_waitcnt lgkmcnt(2)
 v_mfma_f32_16x16x32_bf16 v[12:15], v[200:203], v[32:35], v[12:15]
 ds_read_b128 v[28:31], v71 offset:13312
 buffer_load_dword v75, v74, s[8:11], 0 offen sc1
 v_mfma_f32_16x16x32_bf16 v[16:19], v[204:207], v[32:35], v[16:19]
 v_mfma_f32_16x16x32_bf16 v[20:23], v[208:211], v[32:35], v[20:23]
 s_waitcnt lgkmcnt(2)
 v_mfma_f32_16x16x32_bf16 v[12:15], v[212:215], v[36:39], v[12:15]
 ds_read_b128 v[32:35], v71 offset:14336
 v_mfma_f32_16x16x32_bf16 v[16:19], v[216:219], v[36:39], v[16:19]
 buffer_store_dwordx4 v[48:51], v73, s[8:11], s77 offen offset:0
 v_mfma_f32_16x16x32_bf16 v[20:23], v[220:223], v[36:39], v[20:23]
 s_mov_b32 s5, s85
 s_sub_u32 s85, 0, s85
 s_waitcnt lgkmcnt(2)
 v_mfma_f32_16x16x32_bf16 v[12:15], v[224:227], v[24:27], v[12:15]
 ds_read_b128 v[36:39], v71 offset:15360
 s_add_u32 s70, s70, s85
 v_mfma_f32_16x16x32_bf16 v[16:19], v[228:231], v[24:27], v[16:19]
 s_mov_b32 s81, s77
 s_mov_b32 s82, s78
 s_mov_b32 s83, s79
 v_mfma_f32_16x16x32_bf16 v[20:23], v[232:235], v[24:27], v[20:23]
 s_mov_b32 s94, s92
 s_mov_b32 s95, s93
 s_waitcnt lgkmcnt(2)
 v_mfma_f32_16x16x32_bf16 v[12:15], v[236:239], v[28:31], v[12:15]
 ds_read_b128 v[24:27], v71 offset:16384
 s_mul_i32 s64, s68, 0
 v_mfma_f32_16x16x32_bf16 v[16:19], v[240:243], v[28:31], v[16:19]
 s_add_u32 s64, s64, 4
 s_mul_i32 s63, s68, 0
 v_mfma_f32_16x16x32_bf16 v[20:23], v[244:247], v[28:31], v[20:23]
 s_add_u32 s63, s63, 128
 s_waitcnt lgkmcnt(2)
 v_mfma_f32_16x16x32_bf16 v[12:15], v[248:251], v[32:35], v[12:15]
 ds_read_b128 v[28:31], v71 offset:17408
 s_mul_i32 s63, s69, s63
 v_mfma_f32_16x16x32_bf16 v[16:19], v[252:255], v[32:35], v[16:19]
 s_lshr_b32 s63, s63, 9
 s_mul_i32 s63, s63, s64
 s_sub_u32 s63, s69, s63
 v_mfma_f32_16x16x32_bf16 v[20:23], a[0:3], v[32:35], v[20:23]
 s_mul_i32 s63, s63, 294912
 s_waitcnt lgkmcnt(2)
 v_mfma_f32_16x16x32_bf16 v[12:15], a[4:7], v[36:39], v[12:15]
 ds_read_b128 v[32:35], v71 offset:18432
 s_mul_i32 s64, s68, 1179648
 v_mfma_f32_16x16x32_bf16 v[16:19], a[8:11], v[36:39], v[16:19]
 s_add_u32 s63, s63, s64
 s_add_u32 s77, s63, s87
 s_add_u32 s78, s63, s88
 v_mfma_f32_16x16x32_bf16 v[20:23], a[12:15], v[36:39], v[20:23]
 s_add_u32 s79, s63, s89
 s_waitcnt lgkmcnt(2)
 v_mfma_f32_16x16x32_bf16 v[12:15], a[16:19], v[24:27], v[12:15]
 ds_read_b128 v[36:39], v71 offset:19456
 s_mul_i32 s92, s68, 512
 v_mfma_f32_16x16x32_bf16 v[16:19], a[20:23], v[24:27], v[16:19]
 s_sub_u32 s93, s80, 1
 s_min_u32 s93, s93, 64
 s_add_u32 s61, s61, 1
 v_mfma_f32_16x16x32_bf16 v[20:23], a[24:27], v[24:27], v[20:23]
 s_waitcnt lgkmcnt(2)
 v_mfma_f32_16x16x32_bf16 v[12:15], a[28:31], v[28:31], v[12:15]
 ds_read_b128 v[24:27], v71 offset:20480
 v_mfma_f32_16x16x32_bf16 v[16:19], a[32:35], v[28:31], v[16:19]
 v_mfma_f32_16x16x32_bf16 v[20:23], a[36:39], v[28:31], v[20:23]
 s_waitcnt lgkmcnt(2)
 v_mfma_f32_16x16x32_bf16 v[12:15], a[40:43], v[32:35], v[12:15]
 ds_read_b128 v[28:31], v71 offset:21504
 v_mfma_f32_16x16x32_bf16 v[16:19], a[44:47], v[32:35], v[16:19]
 v_mfma_f32_16x16x32_bf16 v[20:23], a[48:51], v[32:35], v[20:23]
 s_waitcnt lgkmcnt(2)
 v_mfma_f32_16x16x32_bf16 v[12:15], a[52:55], v[36:39], v[12:15]
 ds_read_b128 v[32:35], v71 offset:22528
 v_mfma_f32_16x16x32_bf16 v[16:19], a[56:59], v[36:39], v[16:19]
 v_mfma_f32_16x16x32_bf16 v[20:23], a[60:63], v[36:39], v[20:23]
 s_waitcnt lgkmcnt(2)
 v_mfma_f32_16x16x32_bf16 v[12:15], a[64:67], v[24:27], v[12:15]
 ds_read_b128 v[36:39], v71 offset:23552
 v_mfma_f32_16x16x32_bf16 v[16:19], a[68:71], v[24:27], v[16:19]
 v_mfma_f32_16x16x32_bf16 v[20:23], a[72:75], v[24:27], v[20:23]
 s_waitcnt lgkmcnt(2)
 v_mfma_f32_16x16x32_bf16 v[12:15], a[76:79], v[28:31], v[12:15]
 ds_read_b128 v[24:27], v71 offset:24576
 v_mfma_f32_16x16x32_bf16 v[16:19], a[80:83], v[28:31], v[16:19]
 v_mfma_f32_16x16x32_bf16 v[20:23], a[84:87], v[28:31], v[20:23]
 s_waitcnt lgkmcnt(2)
 v_mfma_f32_16x16x32_bf16 v[12:15], a[88:91], v[32:35], v[12:15]
 ds_read_b128 v[28:31], v71 offset:25600
 v_mfma_f32_16x16x32_bf16 v[16:19], a[92:95], v[32:35], v[16:19]
 v_mfma_f32_16x16x32_bf16 v[20:23], a[96:99], v[32:35], v[20:23]
 s_waitcnt lgkmcnt(2)
 v_mfma_f32_16x16x32_bf16 v[12:15], a[100:103], v[36:39], v[12:15]
 ds_read_b128 v[32:35], v71 offset:26624
 v_mfma_f32_16x16x32_bf16 v[16:19], a[104:107], v[36:39], v[16:19]
 v_mfma_f32_16x16x32_bf16 v[20:23], a[108:111], v[36:39], v[20:23]
 s_waitcnt lgkmcnt(2)
 v_mfma_f32_16x16x32_bf16 v[12:15], a[112:115], v[24:27], v[12:15]
 ds_read_b128 v[36:39], v71 offset:27648
 v_mfma_f32_16x16x32_bf16 v[16:19], a[116:119], v[24:27], v[16:19]
 v_mfma_f32_16x16x32_bf16 v[20:23], a[120:123], v[24:27], v[20:23]
 s_waitcnt vmcnt(1)
 v_add_u32 v64, v65, v75
 v_cmp_gt_u32 vcc, s74, v64
 s_waitcnt lgkmcnt(2)
 v_mfma_f32_16x16x32_bf16 v[12:15], a[124:127], v[28:31], v[12:15]
 ds_read_b128 v[24:27], v71 offset:28672
 v_cmp_gt_u32 s[66:67], s75, v64
 v_mfma_f32_16x16x32_bf16 v[16:19], a[128:131], v[28:31], v[16:19]
 v_mfma_f32_16x16x32_bf16 v[20:23], a[132:135], v[28:31], v[20:23]
 s_waitcnt lgkmcnt(2)
 v_mfma_f32_16x16x32_bf16 v[12:15], a[136:139], v[32:35], v[12:15]
 ds_read_b128 v[28:31], v71 offset:29696
 s_cmp_eq_u32 s67, 0
 s_cselect_b32 s72, 2, 0
 s_cmp_eq_u32 vcc_lo, 0
 s_cselect_b32 s72, 1, s72
 v_mfma_f32_16x16x32_bf16 v[16:19], a[140:143], v[32:35], v[16:19]
 v_mov_b32 v76, s72
 v_mfma_f32_16x16x32_bf16 v[20:23], a[144:147], v[32:35], v[20:23]
 ds_write_b32 v72, v76 offset:4
 s_waitcnt lgkmcnt(3)
 v_mfma_f32_16x16x32_bf16 v[12:15], a[148:151], v[36:39], v[12:15]
 ds_read_b128 v[32:35], v71 offset:30720
 v_mfma_f32_16x16x32_bf16 v[16:19], a[152:155], v[36:39], v[16:19]
 v_mfma_f32_16x16x32_bf16 v[20:23], a[156:159], v[36:39], v[20:23]
 s_waitcnt lgkmcnt(3)
 v_mfma_f32_16x16x32_bf16 v[12:15], a[160:163], v[24:27], v[12:15]
 ds_read_b128 v[36:39], v71 offset:31744
 v_mfma_f32_16x16x32_bf16 v[16:19], a[164:167], v[24:27], v[16:19]
 v_mfma_f32_16x16x32_bf16 v[20:23], a[168:171], v[24:27], v[20:23]
 s_waitcnt lgkmcnt(2)
 s_branch L_wo_fe
L_wo_p0e:
 s_waitcnt lgkmcnt(2)
 v_mfma_f32_16x16x32_bf16 v[0:3], v[80:83], v[24:27], 0
 ds_read_b128 v[36:39], v70 offset:3072
 v_mfma_f32_16x16x32_bf16 v[4:7], v[84:87], v[24:27], 0
 v_mfma_f32_16x16x32_bf16 v[8:11], v[88:91], v[24:27], 0
 s_waitcnt lgkmcnt(2)
 v_mfma_f32_16x16x32_bf16 v[0:3], v[92:95], v[28:31], v[0:3]
 ds_read_b128 v[24:27], v70 offset:4096
 v_mfma_f32_16x16x32_bf16 v[4:7], v[96:99], v[28:31], v[4:7]
 v_cvt_pk_bf16_f32 v58, v20, v21
 v_cvt_pk_bf16_f32 v59, v22, v23
 v_mfma_f32_16x16x32_bf16 v[8:11], v[100:103], v[28:31], v[8:11]
 v_cvt_pk_bf16_f32 v52, v12, v13
 s_waitcnt lgkmcnt(2)
 v_mfma_f32_16x16x32_bf16 v[0:3], v[104:107], v[32:35], v[0:3]
 ds_read_b128 v[28:31], v70 offset:5120
 v_cvt_pk_bf16_f32 v53, v14, v15
 v_mfma_f32_16x16x32_bf16 v[4:7], v[108:111], v[32:35], v[4:7]
 v_cvt_pk_bf16_f32 v54, v16, v17
 v_cvt_pk_bf16_f32 v55, v18, v19
 v_mfma_f32_16x16x32_bf16 v[8:11], v[112:115], v[32:35], v[8:11]
 s_waitcnt lgkmcnt(2)
 v_mfma_f32_16x16x32_bf16 v[0:3], v[116:119], v[36:39], v[0:3]
 ds_read_b128 v[32:35], v70 offset:6144
 v_mfma_f32_16x16x32_bf16 v[4:7], v[120:123], v[36:39], v[4:7]
 buffer_store_dwordx4 v[52:55], v73, s[8:11], s81 offen offset:1024
 v_mfma_f32_16x16x32_bf16 v[8:11], v[124:127], v[36:39], v[8:11]
 s_waitcnt lgkmcnt(2)
 v_mfma_f32_16x16x32_bf16 v[0:3], v[128:131], v[24:27], v[0:3]
 ds_read_b128 v[36:39], v70 offset:7168
 v_mfma_f32_16x16x32_bf16 v[4:7], v[132:135], v[24:27], v[4:7]
 v_permlane32_swap_b32 v56, v58
 v_mfma_f32_16x16x32_bf16 v[8:11], v[136:139], v[24:27], v[8:11]
 s_waitcnt lgkmcnt(2)
 v_mfma_f32_16x16x32_bf16 v[0:3], v[140:143], v[28:31], v[0:3]
 ds_read_b128 v[24:27], v70 offset:8192
 v_mfma_f32_16x16x32_bf16 v[4:7], v[144:147], v[28:31], v[4:7]
 v_permlane32_swap_b32 v57, v59
 v_mfma_f32_16x16x32_bf16 v[8:11], v[148:151], v[28:31], v[8:11]
 s_waitcnt lgkmcnt(2)
 v_mfma_f32_16x16x32_bf16 v[0:3], v[152:155], v[32:35], v[0:3]
 ds_read_b128 v[28:31], v70 offset:9216
 v_mfma_f32_16x16x32_bf16 v[4:7], v[156:159], v[32:35], v[4:7]
 buffer_store_dwordx4 v[56:59], v73, s[8:11], s81 offen offset:2048
 v_mfma_f32_16x16x32_bf16 v[8:11], v[160:163], v[32:35], v[8:11]
 s_waitcnt lgkmcnt(2)
 v_mfma_f32_16x16x32_bf16 v[0:3], v[164:167], v[36:39], v[0:3]
 ds_read_b128 v[32:35], v70 offset:10240
 v_mfma_f32_16x16x32_bf16 v[4:7], v[168:171], v[36:39], v[4:7]
 v_mfma_f32_16x16x32_bf16 v[8:11], v[172:175], v[36:39], v[8:11]
 s_waitcnt lgkmcnt(2)
 v_mfma_f32_16x16x32_bf16 v[0:3], v[176:179], v[24:27], v[0:3]
 ds_read_b128 v[36:39], v70 offset:11264
 v_mfma_f32_16x16x32_bf16 v[4:7], v[180:183], v[24:27], v[4:7]
 v_mfma_f32_16x16x32_bf16 v[8:11], v[184:187], v[24:27], v[8:11]
 s_waitcnt lgkmcnt(2)
 v_mfma_f32_16x16x32_bf16 v[0:3], v[188:191], v[28:31], v[0:3]
 ds_read_b128 v[24:27], v70 offset:12288
 v_mfma_f32_16x16x32_bf16 v[4:7], v[192:195], v[28:31], v[4:7]
 v_mfma_f32_16x16x32_bf16 v[8:11], v[196:199], v[28:31], v[8:11]
 s_waitcnt lgkmcnt(2)
 v_mfma_f32_16x16x32_bf16 v[0:3], v[200:203], v[32:35], v[0:3]
 ds_read_b128 v[28:31], v70 offset:13312
 v_mfma_f32_16x16x32_bf16 v[4:7], v[204:207], v[32:35], v[4:7]
 v_mfma_f32_16x16x32_bf16 v[8:11], v[208:211], v[32:35], v[8:11]
 s_waitcnt lgkmcnt(2)
 v_mfma_f32_16x16x32_bf16 v[0:3], v[212:215], v[36:39], v[0:3]
 ds_read_b128 v[32:35], v70 offset:14336
 v_mfma_f32_16x16x32_bf16 v[4:7], v[216:219], v[36:39], v[4:7]
 v_mfma_f32_16x16x32_bf16 v[8:11], v[220:223], v[36:39], v[8:11]
 s_waitcnt lgkmcnt(2)
 v_mfma_f32_16x16x32_bf16 v[0:3], v[224:227], v[24:27], v[0:3]
 ds_read_b128 v[36:39], v70 offset:15360
 v_mfma_f32_16x16x32_bf16 v[4:7], v[228:231], v[24:27], v[4:7]
 v_mfma_f32_16x16x32_bf16 v[8:11], v[232:235], v[24:27], v[8:11]
 s_waitcnt lgkmcnt(2)
 v_mfma_f32_16x16x32_bf16 v[0:3], v[236:239], v[28:31], v[0:3]
 ds_read_b128 v[24:27], v70 offset:16384
 v_mfma_f32_16x16x32_bf16 v[4:7], v[240:243], v[28:31], v[4:7]
 buffer_load_dword v75, v74, s[8:11], 0 offen sc1
 v_mov_b32 v76, s95
 v_mfma_f32_16x16x32_bf16 v[8:11], v[244:247], v[28:31], v[8:11]
 s_waitcnt vmcnt(1)
 s_barrier
 buffer_store_dword v76, v77, s[8:11], s94 offen
 s_waitcnt lgkmcnt(2)
 v_mfma_f32_16x16x32_bf16 v[0:3], v[248:251], v[32:35], v[0:3]
 ds_read_b128 v[28:31], v70 offset:17408
 v_mfma_f32_16x16x32_bf16 v[4:7], v[252:255], v[32:35], v[4:7]
 v_mfma_f32_16x16x32_bf16 v[8:11], a[0:3], v[32:35], v[8:11]
 s_waitcnt lgkmcnt(2)
 v_mfma_f32_16x16x32_bf16 v[0:3], a[4:7], v[36:39], v[0:3]
 ds_read_b128 v[32:35], v70 offset:18432
 v_mfma_f32_16x16x32_bf16 v[4:7], a[8:11], v[36:39], v[4:7]
 v_mfma_f32_16x16x32_bf16 v[8:11], a[12:15], v[36:39], v[8:11]
 s_waitcnt lgkmcnt(2)
 v_mfma_f32_16x16x32_bf16 v[0:3], a[16:19], v[24:27], v[0:3]
 ds_read_b128 v[36:39], v70 offset:19456
 v_mfma_f32_16x16x32_bf16 v[4:7], a[20:23], v[24:27], v[4:7]
 v_mfma_f32_16x16x32_bf16 v[8:11], a[24:27], v[24:27], v[8:11]
 s_waitcnt lgkmcnt(2)
 v_mfma_f32_16x16x32_bf16 v[0:3], a[28:31], v[28:31], v[0:3]
 ds_read_b128 v[24:27], v70 offset:20480
 v_mfma_f32_16x16x32_bf16 v[4:7], a[32:35], v[28:31], v[4:7]
 v_mfma_f32_16x16x32_bf16 v[8:11], a[36:39], v[28:31], v[8:11]
 s_waitcnt lgkmcnt(2)
 v_mfma_f32_16x16x32_bf16 v[0:3], a[40:43], v[32:35], v[0:3]
 ds_read_b128 v[28:31], v70 offset:21504
 v_mfma_f32_16x16x32_bf16 v[4:7], a[44:47], v[32:35], v[4:7]
 v_mfma_f32_16x16x32_bf16 v[8:11], a[48:51], v[32:35], v[8:11]
 s_waitcnt lgkmcnt(2)
 v_mfma_f32_16x16x32_bf16 v[0:3], a[52:55], v[36:39], v[0:3]
 ds_read_b128 v[32:35], v70 offset:22528
 v_mfma_f32_16x16x32_bf16 v[4:7], a[56:59], v[36:39], v[4:7]
 v_mfma_f32_16x16x32_bf16 v[8:11], a[60:63], v[36:39], v[8:11]
 s_waitcnt lgkmcnt(2)
 v_mfma_f32_16x16x32_bf16 v[0:3], a[64:67], v[24:27], v[0:3]
 ds_read_b128 v[36:39], v70 offset:23552
 v_mfma_f32_16x16x32_bf16 v[4:7], a[68:71], v[24:27], v[4:7]
 v_mfma_f32_16x16x32_bf16 v[8:11], a[72:75], v[24:27], v[8:11]
 s_waitcnt lgkmcnt(2)
 v_mfma_f32_16x16x32_bf16 v[0:3], a[76:79], v[28:31], v[0:3]
 ds_read_b128 v[24:27], v70 offset:24576
 v_mfma_f32_16x16x32_bf16 v[4:7], a[80:83], v[28:31], v[4:7]
 v_mfma_f32_16x16x32_bf16 v[8:11], a[84:87], v[28:31], v[8:11]
 s_waitcnt lgkmcnt(2)
 v_mfma_f32_16x16x32_bf16 v[0:3], a[88:91], v[32:35], v[0:3]
 ds_read_b128 v[28:31], v70 offset:25600
 v_mfma_f32_16x16x32_bf16 v[4:7], a[92:95], v[32:35], v[4:7]
 v_mfma_f32_16x16x32_bf16 v[8:11], a[96:99], v[32:35], v[8:11]
 s_waitcnt lgkmcnt(2)
 v_mfma_f32_16x16x32_bf16 v[0:3], a[100:103], v[36:39], v[0:3]
 ds_read_b128 v[32:35], v70 offset:26624
 v_mfma_f32_16x16x32_bf16 v[4:7], a[104:107], v[36:39], v[4:7]
 v_mfma_f32_16x16x32_bf16 v[8:11], a[108:111], v[36:39], v[8:11]
 s_waitcnt lgkmcnt(2)
 v_mfma_f32_16x16x32_bf16 v[0:3], a[112:115], v[24:27], v[0:3]
 ds_read_b128 v[36:39], v70 offset:27648
 v_mfma_f32_16x16x32_bf16 v[4:7], a[116:119], v[24:27], v[4:7]
 v_mfma_f32_16x16x32_bf16 v[8:11], a[120:123], v[24:27], v[8:11]
 s_waitcnt vmcnt(1)
 v_add_u32 v64, v65, v75
 v_cmp_gt_u32 vcc, s74, v64
 s_waitcnt lgkmcnt(2)
 v_mfma_f32_16x16x32_bf16 v[0:3], a[124:127], v[28:31], v[0:3]
 ds_read_b128 v[24:27], v70 offset:28672
 v_cmp_gt_u32 s[66:67], s75, v64
 v_mfma_f32_16x16x32_bf16 v[4:7], a[128:131], v[28:31], v[4:7]
 v_mfma_f32_16x16x32_bf16 v[8:11], a[132:135], v[28:31], v[8:11]
 s_waitcnt lgkmcnt(2)
 v_mfma_f32_16x16x32_bf16 v[0:3], a[136:139], v[32:35], v[0:3]
 ds_read_b128 v[28:31], v70 offset:29696
 s_cmp_eq_u32 s67, 0
 s_cselect_b32 s72, 2, 0
 s_cmp_eq_u32 vcc_lo, 0
 s_cselect_b32 s72, 1, s72
 v_mfma_f32_16x16x32_bf16 v[4:7], a[140:143], v[32:35], v[4:7]
 v_mov_b32 v76, s72
 v_mfma_f32_16x16x32_bf16 v[8:11], a[144:147], v[32:35], v[8:11]
 ds_write_b32 v72, v76 offset:0
 s_waitcnt lgkmcnt(3)
 v_mfma_f32_16x16x32_bf16 v[0:3], a[148:151], v[36:39], v[0:3]
 ds_read_b128 v[32:35], v70 offset:30720
 v_mfma_f32_16x16x32_bf16 v[4:7], a[152:155], v[36:39], v[4:7]
 v_mfma_f32_16x16x32_bf16 v[8:11], a[156:159], v[36:39], v[8:11]
 s_waitcnt lgkmcnt(3)
 v_mfma_f32_16x16x32_bf16 v[0:3], a[160:163], v[24:27], v[0:3]
 ds_read_b128 v[36:39], v70 offset:31744
 v_mfma_f32_16x16x32_bf16 v[4:7], a[164:167], v[24:27], v[4:7]
 v_mfma_f32_16x16x32_bf16 v[8:11], a[168:171], v[24:27], v[8:11]
 s_waitcnt vmcnt(4)
 s_waitcnt lgkmcnt(2)
 s_barrier
 ds_read_b32 v76, v73 offset:0
 v_mfma_f32_16x16x32_bf16 v[0:3], a[172:175], v[28:31], v[0:3]
 ds_read_b128 v[24:27], v71 offset:0
 v_mfma_f32_16x16x32_bf16 v[4:7], a[176:179], v[28:31], v[4:7]
 v_mfma_f32_16x16x32_bf16 v[8:11], a[180:183], v[28:31], v[8:11]
 s_waitcnt lgkmcnt(3)
 v_mfma_f32_16x16x32_bf16 v[0:3], a[184:187], v[32:35], v[0:3]
 ds_read_b128 v[28:31], v71 offset:1024
 v_mfma_f32_16x16x32_bf16 v[4:7], a[188:191], v[32:35], v[4:7]
 v_mfma_f32_16x16x32_bf16 v[8:11], a[192:195], v[32:35], v[8:11]
 s_waitcnt lgkmcnt(2)
 v_readfirstlane_b32 s72, v76
 v_mfma_f32_16x16x32_bf16 v[0:3], a[196:199], v[36:39], v[0:3]
 ds_read_b128 v[32:35], v71 offset:2048
 v_mfma_f32_16x16x32_bf16 v[4:7], a[200:203], v[36:39], v[4:7]
 v_mfma_f32_16x16x32_bf16 v[8:11], a[204:207], v[36:39], v[8:11]
 s_cmp_lg_u32 s72, 0
 s_cbranch_scc1 L_wo_p1d
 s_branch L_wo_p1n
L_wo_p1d:
 s_waitcnt lgkmcnt(2)
 v_mfma_f32_16x16x32_bf16 v[12:15], v[80:83], v[24:27], 0
 ds_read_b128 v[36:39], v71 offset:3072
 buffer_load_dword v75, v74, s[8:11], 0 offen sc1
 v_mfma_f32_16x16x32_bf16 v[16:19], v[84:87], v[24:27], 0
 s_sub_u32 s68, s72, 1
 s_cmp_eq_u32 s68, 0
 s_cselect_b32 s69, s74, s75
 s_cselect_b32 s63, s44, s47
 s_cselect_b32 s64, s45, s48
 s_cselect_b32 s80, s46, s49
 v_mfma_f32_16x16x32_bf16 v[20:23], v[88:91], v[24:27], 0
 s_cmp_lt_u32 s69, s63
 s_cselect_b32 s80, s64, s80
 s_add_u32 s80, s80, s69
 s_waitcnt lgkmcnt(2)
 v_mfma_f32_16x16x32_bf16 v[12:15], v[92:95], v[28:31], v[12:15]
 ds_read_b128 v[24:27], v71 offset:4096
 s_cmp_eq_u32 s68, 0
 s_cselect_b32 s74, s80, s74
 s_cselect_b32 s75, s75, s80
 v_mfma_f32_16x16x32_bf16 v[16:19], v[96:99], v[28:31], v[16:19]
 s_mul_i32 s73, s69, 262144
 s_mul_i32 s63, s68, 16777216
 s_add_u32 s73, s73, s63
 s_add_u32 s73, s73, s90
 v_mfma_f32_16x16x32_bf16 v[20:23], v[100:103], v[28:31], v[20:23]
 s_mov_b32 m0, s70
 s_waitcnt lgkmcnt(2)
 v_mfma_f32_16x16x32_bf16 v[12:15], v[104:107], v[32:35], v[12:15]
 ds_read_b128 v[28:31], v71 offset:5120
 v_cvt_pk_bf16_f32 v48, v0, v1
 v_mfma_f32_16x16x32_bf16 v[16:19], v[108:111], v[32:35], v[16:19]
 buffer_load_dwordx4 v72, s[8:11], s73 offen sc1 lds
 v_mfma_f32_16x16x32_bf16 v[20:23], v[112:115], v[32:35], v[20:23]
 v_cvt_pk_bf16_f32 v49, v2, v3
 s_waitcnt lgkmcnt(2)
 v_mfma_f32_16x16x32_bf16 v[12:15], v[116:119], v[36:39], v[12:15]
 ds_read_b128 v[32:35], v71 offset:6144
 v_cvt_pk_bf16_f32 v50, v4, v5
 v_mfma_f32_16x16x32_bf16 v[16:19], v[120:123], v[36:39], v[16:19]
 s_add_u32 m0, m0, s3
 s_add_u32 s73, s73, s3
 v_mfma_f32_16x16x32_bf16 v[20:23], v[124:127], v[36:39], v[20:23]
 buffer_load_dwordx4 v72, s[8:11], s73 offen sc1 lds
 s_waitcnt lgkmcnt(2)
 v_mfma_f32_16x16x32_bf16 v[12:15], v[128:131], v[24:27], v[12:15]
 ds_read_b128 v[36:39], v71 offset:7168
 v_cvt_pk_bf16_f32 v51, v6, v7
 v_mfma_f32_16x16x32_bf16 v[16:19], v[132:135], v[24:27], v[16:19]
 buffer_store_dwordx4 v[48:51], v73, s[8:11], s77 offen offset:0
 v_mfma_f32_16x16x32_bf16 v[20:23], v[136:139], v[24:27], v[20:23]
 s_add_u32 m0, m0, s3
 s_add_u32 s73, s73, s3
 s_waitcnt lgkmcnt(2)
 v_mfma_f32_16x16x32_bf16 v[12:15], v[140:143], v[28:31], v[12:15]
 ds_read_b128 v[24:27], v71 offset:8192
 v_cvt_pk_bf16_f32 v56, v8, v9
 v_mfma_f32_16x16x32_bf16 v[16:19], v[144:147], v[28:31], v[16:19]
 buffer_load_dwordx4 v72, s[8:11], s73 offen sc1 lds
 v_mfma_f32_16x16x32_bf16 v[20:23], v[148:151], v[28:31], v[20:23]
 v_cvt_pk_bf16_f32 v57, v10, v11
 s_waitcnt lgkmcnt(2)
 v_mfma_f32_16x16x32_bf16 v[12:15], v[152:155], v[32:35], v[12:15]
 ds_read_b128 v[28:31], v71 offset:9216
 v_mfma_f32_16x16x32_bf16 v[16:19], v[156:159], v[32:35], v[16:19]
 v_mfma_f32_16x16x32_bf16 v[20:23], v[160:163], v[32:35], v[20:23]
 s_add_u32 m0, m0, s3
 s_add_u32 s73, s73, s3
 s_waitcnt lgkmcnt(2)
 v_mfma_f32_16x16x32_bf16 v[12:15], v[164:167], v[36:39], v[12:15]
 ds_read_b128 v[32:35], v71 offset:10240
 v_mfma_f32_16x16x32_bf16 v[16:19], v[168:171], v[36:39], v[16:19]
 buffer_load_dwordx4 v72, s[8:11], s73 offen sc1 lds
 v_mfma_f32_16x16x32_bf16 v[20:23], v[172:175], v[36:39], v[20:23]
 s_waitcnt lgkmcnt(2)
 v_mfma_f32_16x16x32_bf16 v[12:15], v[176:179], v[24:27], v[12:15]
 ds_read_b128 v[36:39], v71 offset:11264
 v_mfma_f32_16x16x32_bf16 v[16:19], v[180:183], v[24:27], v[16:19]
 s_add_u32 m0, m0, s3
 s_add_u32 s73, s73, s3
 v_mfma_f32_16x16x32_bf16 v[20:23], v[184:187], v[24:27], v[20:23]
 buffer_load_dwordx4 v72, s[8:11], s73 offen sc1 lds
 s_waitcnt lgkmcnt(2)
 v_mfma_f32_16x16x32_bf16 v[12:15], v[188:191], v[28:31], v[12:15]
 ds_read_b128 v[24:27], v71 offset:12288
 v_mfma_f32_16x16x32_bf16 v[16:19], v[192:195], v[28:31], v[16:19]
 v_mfma_f32_16x16x32_bf16 v[20:23], v[196:199], v[28:31], v[20:23]
 s_add_u32 m0, m0, s3
 s_add_u32 s73, s73, s3
 s_waitcnt lgkmcnt(2)
 v_mfma_f32_16x16x32_bf16 v[12:15], v[200:203], v[32:35], v[12:15]
 ds_read_b128 v[28:31], v71 offset:13312
 v_mfma_f32_16x16x32_bf16 v[16:19], v[204:207], v[32:35], v[16:19]
 buffer_load_dwordx4 v72, s[8:11], s73 offen sc1 lds
 v_mfma_f32_16x16x32_bf16 v[20:23], v[208:211], v[32:35], v[20:23]
 s_waitcnt lgkmcnt(2)
 v_mfma_f32_16x16x32_bf16 v[12:15], v[212:215], v[36:39], v[12:15]
 ds_read_b128 v[32:35], v71 offset:14336
 v_mfma_f32_16x16x32_bf16 v[16:19], v[216:219], v[36:39], v[16:19]
 v_mfma_f32_16x16x32_bf16 v[20:23], v[220:223], v[36:39], v[20:23]
 s_add_u32 m0, m0, s3
 s_add_u32 s73, s73, s3
 s_waitcnt lgkmcnt(2)
 v_mfma_f32_16x16x32_bf16 v[12:15], v[224:227], v[24:27], v[12:15]
 ds_read_b128 v[36:39], v71 offset:15360
 v_mfma_f32_16x16x32_bf16 v[16:19], v[228:231], v[24:27], v[16:19]
 buffer_load_dwordx4 v72, s[8:11], s73 offen sc1 lds
 v_mfma_f32_16x16x32_bf16 v[20:23], v[232:235], v[24:27], v[20:23]
 s_waitcnt lgkmcnt(2)
 v_mfma_f32_16x16x32_bf16 v[12:15], v[236:239], v[28:31], v[12:15]
 ds_read_b128 v[24:27], v71 offset:16384
 v_mfma_f32_16x16x32_bf16 v[16:19], v[240:243], v[28:31], v[16:19]
 s_add_u32 m0, m0, s3
 s_add_u32 s73, s73, s3
 v_mfma_f32_16x16x32_bf16 v[20:23], v[244:247], v[28:31], v[20:23]
 buffer_load_dwordx4 v72, s[8:11], s73 offen sc1 lds
 s_waitcnt lgkmcnt(2)
 v_mfma_f32_16x16x32_bf16 v[12:15], v[248:251], v[32:35], v[12:15]
 ds_read_b128 v[28:31], v71 offset:17408
 v_mfma_f32_16x16x32_bf16 v[16:19], v[252:255], v[32:35], v[16:19]
 v_mfma_f32_16x16x32_bf16 v[20:23], a[0:3], v[32:35], v[20:23]
 s_add_u32 m0, m0, s3
 s_add_u32 s73, s73, s3
 s_waitcnt lgkmcnt(2)
 v_mfma_f32_16x16x32_bf16 v[12:15], a[4:7], v[36:39], v[12:15]
 ds_read_b128 v[32:35], v71 offset:18432
 v_mfma_f32_16x16x32_bf16 v[16:19], a[8:11], v[36:39], v[16:19]
 buffer_load_dwordx4 v72, s[8:11], s73 offen sc1 lds
 v_mfma_f32_16x16x32_bf16 v[20:23], a[12:15], v[36:39], v[20:23]
 s_waitcnt lgkmcnt(2)
 v_mfma_f32_16x16x32_bf16 v[12:15], a[16:19], v[24:27], v[12:15]
 ds_read_b128 v[36:39], v71 offset:19456
 v_mfma_f32_16x16x32_bf16 v[16:19], a[20:23], v[24:27], v[16:19]
 v_mfma_f32_16x16x32_bf16 v[20:23], a[24:27], v[24:27], v[20:23]
 s_add_u32 m0, m0, s3
 s_add_u32 s73, s73, s3
 s_waitcnt lgkmcnt(2)
 v_mfma_f32_16x16x32_bf16 v[12:15], a[28:31], v[28:31], v[12:15]
 ds_read_b128 v[24:27], v71 offset:20480
 v_mfma_f32_16x16x32_bf16 v[16:19], a[32:35], v[28:31], v[16:19]
 buffer_load_dwordx4 v72, s[8:11], s73 offen sc1 lds
 v_mfma_f32_16x16x32_bf16 v[20:23], a[36:39], v[28:31], v[20:23]
 s_waitcnt lgkmcnt(2)
 v_mfma_f32_16x16x32_bf16 v[12:15], a[40:43], v[32:35], v[12:15]
 ds_read_b128 v[28:31], v71 offset:21504
 v_mfma_f32_16x16x32_bf16 v[16:19], a[44:47], v[32:35], v[16:19]
 s_add_u32 m0, m0, s3
 s_add_u32 s73, s73, s3
 v_mfma_f32_16x16x32_bf16 v[20:23], a[48:51], v[32:35], v[20:23]
 buffer_load_dwordx4 v72, s[8:11], s73 offen sc1 lds
 s_waitcnt lgkmcnt(2)
 v_mfma_f32_16x16x32_bf16 v[12:15], a[52:55], v[36:39], v[12:15]
 ds_read_b128 v[32:35], v71 offset:22528
 v_mfma_f32_16x16x32_bf16 v[16:19], a[56:59], v[36:39], v[16:19]
 v_mfma_f32_16x16x32_bf16 v[20:23], a[60:63], v[36:39], v[20:23]
 s_add_u32 m0, m0, s3
 s_add_u32 s73, s73, s3
 s_waitcnt lgkmcnt(2)
 v_mfma_f32_16x16x32_bf16 v[12:15], a[64:67], v[24:27], v[12:15]
 ds_read_b128 v[36:39], v71 offset:23552
 v_mfma_f32_16x16x32_bf16 v[16:19], a[68:71], v[24:27], v[16:19]
 buffer_load_dwordx4 v72, s[8:11], s73 offen sc1 lds
 v_mfma_f32_16x16x32_bf16 v[20:23], a[72:75], v[24:27], v[20:23]
 s_waitcnt lgkmcnt(2)
 v_mfma_f32_16x16x32_bf16 v[12:15], a[76:79], v[28:31], v[12:15]
 ds_read_b128 v[24:27], v71 offset:24576
 v_mfma_f32_16x16x32_bf16 v[16:19], a[80:83], v[28:31], v[16:19]
 v_mfma_f32_16x16x32_bf16 v[20:23], a[84:87], v[28:31], v[20:23]
 s_add_u32 m0, m0, s3
 s_add_u32 s73, s73, s3
 s_waitcnt lgkmcnt(2)
 v_mfma_f32_16x16x32_bf16 v[12:15], a[88:91], v[32:35], v[12:15]
 ds_read_b128 v[28:31], v71 offset:25600
 v_mfma_f32_16x16x32_bf16 v[16:19], a[92:95], v[32:35], v[16:19]
 buffer_load_dwordx4 v72, s[8:11], s73 offen sc1 lds
 v_mfma_f32_16x16x32_bf16 v[20:23], a[96:99], v[32:35], v[20:23]
 s_waitcnt lgkmcnt(2)
 v_mfma_f32_16x16x32_bf16 v[12:15], a[100:103], v[36:39], v[12:15]
 ds_read_b128 v[32:35], v71 offset:26624
 v_mfma_f32_16x16x32_bf16 v[16:19], a[104:107], v[36:39], v[16:19]
 s_add_u32 m0, m0, s3
 s_add_u32 s73, s73, s3
 v_mfma_f32_16x16x32_bf16 v[20:23], a[108:111], v[36:39], v[20:23]
 buffer_load_dwordx4 v72, s[8:11], s73 offen sc1 lds
 s_waitcnt lgkmcnt(2)
 v_mfma_f32_16x16x32_bf16 v[12:15], a[112:115], v[24:27], v[12:15]
 ds_read_b128 v[36:39], v71 offset:27648
 v_mfma_f32_16x16x32_bf16 v[16:19], a[116:119], v[24:27], v[16:19]
 v_mfma_f32_16x16x32_bf16 v[20:23], a[120:123], v[24:27], v[20:23]
 s_add_u32 m0, m0, s3
 s_add_u32 s73, s73, s3
 s_waitcnt vmcnt(15)
 v_add_u32 v64, v65, v75
 v_cmp_gt_u32 vcc, s74, v64
 s_waitcnt lgkmcnt(2)
 v_mfma_f32_16x16x32_bf16 v[12:15], a[124:127], v[28:31], v[12:15]
 ds_read_b128 v[24:27], v71 offset:28672
 v_cmp_gt_u32 s[66:67], s75, v64
 v_mfma_f32_16x16x32_bf16 v[16:19], a[128:131], v[28:31], v[16:19]
 buffer_load_dwordx4 v72, s[8:11], s73 offen sc1 lds
 v_mfma_f32_16x16x32_bf16 v[20:23], a[132:135], v[28:31], v[20:23]
 s_waitcnt lgkmcnt(2)
 v_mfma_f32_16x16x32_bf16 v[12:15], a[136:139], v[32:35], v[12:15]
 ds_read_b128 v[28:31], v71 offset:29696
 s_cmp_eq_u32 s67, 0
 s_cselect_b32 s72, 2, 0
 s_cmp_eq_u32 vcc_lo, 0
 s_cselect_b32 s72, 1, s72
 v_mfma_f32_16x16x32_bf16 v[16:19], a[140:143], v[32:35], v[16:19]
 v_mov_b32 v76, s72
 v_mfma_f32_16x16x32_bf16 v[20:23], a[144:147], v[32:35], v[20:23]
 s_add_u32 m0, m0, s3
 s_add_u32 s73, s73, s3
 ds_write_b32 v72, v76 offset:4
 s_waitcnt lgkmcnt(3)
 v_mfma_f32_16x16x32_bf16 v[12:15], a[148:151], v[36:39], v[12:15]
 ds_read_b128 v[32:35], v71 offset:30720
 v_mfma_f32_16x16x32_bf16 v[16:19], a[152:155], v[36:39], v[16:19]
 buffer_load_dwordx4 v72, s[8:11], s73 offen sc1 lds
 v_mfma_f32_16x16x32_bf16 v[20:23], a[156:159], v[36:39], v[20:23]
 s_mov_b32 s5, s85
 s_sub_u32 s85, 0, s85
 s_add_u32 s70, s70, s85
 s_mov_b32 s81, s77
 s_mov_b32 s82, s78
 s_mov_b32 s83, s79
 s_mov_b32 s94, s92
 s_waitcnt lgkmcnt(3)
 v_mfma_f32_16x16x32_bf16 v[12:15], a[160:163], v[24:27], v[12:15]
 ds_read_b128 v[36:39], v71 offset:31744
 s_mov_b32 s95, s93
 s_mul_i32 s64, s68, 0
 s_add_u32 s64, s64, 4
 s_mul_i32 s63, s68, 0
 s_add_u32 s63, s63, 128
 s_mul_i32 s63, s69, s63
 v_mfma_f32_16x16x32_bf16 v[16:19], a[164:167], v[24:27], v[16:19]
 s_lshr_b32 s63, s63, 9
 s_mul_i32 s63, s63, s64
 s_sub_u32 s63, s69, s63
 s_mul_i32 s63, s63, 294912
 s_mul_i32 s64, s68, 1179648
 s_add_u32 s63, s63, s64
 s_add_u32 s77, s63, s87
 v_mfma_f32_16x16x32_bf16 v[20:23], a[168:171], v[24:27], v[20:23]
 s_add_u32 s78, s63, s88
 s_add_u32 s79, s63, s89
 s_mul_i32 s92, s68, 512
 s_sub_u32 s93, s80, 1
 s_min_u32 s93, s93, 64
 s_add_u32 s61, s61, 1
 s_waitcnt lgkmcnt(2)
 s_waitcnt vmcnt(8)
 s_branch L_wo_fe
L_wo_p0ed:
 s_waitcnt lgkmcnt(2)
 v_mfma_f32_16x16x32_bf16 v[0:3], v[80:83], v[24:27], 0
 ds_read_b128 v[36:39], v70 offset:3072
 v_mfma_f32_16x16x32_bf16 v[4:7], v[84:87], v[24:27], 0
 s_sub_u32 s68, s72, 1
 s_cmp_eq_u32 s68, 0
 s_cselect_b32 s69, s74, s75
 v_mfma_f32_16x16x32_bf16 v[8:11], v[88:91], v[24:27], 0
 s_waitcnt lgkmcnt(2)
 v_mfma_f32_16x16x32_bf16 v[0:3], v[92:95], v[28:31], v[0:3]
 ds_read_b128 v[24:27], v70 offset:4096
 v_mfma_f32_16x16x32_bf16 v[4:7], v[96:99], v[28:31], v[4:7]
 s_cselect_b32 s63, s44, s47
 s_cselect_b32 s64, s45, s48
 s_cselect_b32 s80, s46, s49
 v_mfma_f32_16x16x32_bf16 v[8:11], v[100:103], v[28:31], v[8:11]
 v_cvt_pk_bf16_f32 v58, v20, v21
 v_cvt_pk_bf16_f32 v59, v22, v23
 s_waitcnt lgkmcnt(2)
 v_mfma_f32_16x16x32_bf16 v[0:3], v[104:107], v[32:35], v[0:3]
 ds_read_b128 v[28:31], v70 offset:5120
 v_cvt_pk_bf16_f32 v52, v12, v13
 v_mfma_f32_16x16x32_bf16 v[4:7], v[108:111], v[32:35], v[4:7]
 s_cmp_lt_u32 s69, s63
 s_cselect_b32 s80, s64, s80
 s_add_u32 s80, s80, s69
 v_mfma_f32_16x16x32_bf16 v[8:11], v[112:115], v[32:35], v[8:11]
 v_cvt_pk_bf16_f32 v53, v14, v15
 v_cvt_pk_bf16_f32 v54, v16, v17
 s_waitcnt lgkmcnt(2)
 v_mfma_f32_16x16x32_bf16 v[0:3], v[116:119], v[36:39], v[0:3]
 ds_read_b128 v[32:35], v70 offset:6144
 v_cvt_pk_bf16_f32 v55, v18, v19
 v_mfma_f32_16x16x32_bf16 v[4:7], v[120:123], v[36:39], v[4:7]
 s_cmp_eq_u32 s68, 0
 s_cselect_b32 s74, s80, s74
 s_cselect_b32 s75, s75, s80
 v_mfma_f32_16x16x32_bf16 v[8:11], v[124:127], v[36:39], v[8:11]
 s_mul_i32 s73, s69, 262144
 s_waitcnt lgkmcnt(2)
 v_mfma_f32_16x16x32_bf16 v[0:3], v[128:131], v[24:27], v[0:3]
 ds_read_b128 v[36:39], v70 offset:7168
 s_mul_i32 s63, s68, 16777216
 v_mfma_f32_16x16x32_bf16 v[4:7], v[132:135], v[24:27], v[4:7]
 s_add_u32 s73, s73, s63
 s_add_u32 s73, s73, s90
 buffer_store_dwordx4 v[52:55], v73, s[8:11], s81 offen offset:1024
 v_mfma_f32_16x16x32_bf16 v[8:11], v[136:139], v[24:27], v[8:11]
 v_permlane32_swap_b32 v56, v58
 s_waitcnt lgkmcnt(2)
 v_mfma_f32_16x16x32_bf16 v[0:3], v[140:143], v[28:31], v[0:3]
 ds_read_b128 v[24:27], v70 offset:8192
 v_permlane32_swap_b32 v57, v59
 v_mfma_f32_16x16x32_bf16 v[4:7], v[144:147], v[28:31], v[4:7]
 v_mfma_f32_16x16x32_bf16 v[8:11], v[148:151], v[28:31], v[8:11]
 s_waitcnt lgkmcnt(2)
 v_mfma_f32_16x16x32_bf16 v[0:3], v[152:155], v[32:35], v[0:3]
 ds_read_b128 v[28:31], v70 offset:9216
 v_mfma_f32_16x16x32_bf16 v[4:7], v[156:159], v[32:35], v[4:7]
 v_mfma_f32_16x16x32_bf16 v[8:11], v[160:163], v[32:35], v[8:11]
 s_waitcnt lgkmcnt(2)
 v_mfma_f32_16x16x32_bf16 v[0:3], v[164:167], v[36:39], v[0:3]
 ds_read_b128 v[32:35], v70 offset:10240
 buffer_store_dwordx4 v[56:59], v73, s[8:11], s81 offen offset:2048
 v_mfma_f32_16x16x32_bf16 v[4:7], v[168:171], v[36:39], v[4:7]
 v_mfma_f32_16x16x32_bf16 v[8:11], v[172:175], v[36:39], v[8:11]
 s_mov_b32 m0, s70
 s_waitcnt lgkmcnt(2)
 v_mfma_f32_16x16x32_bf16 v[0:3], v[176:179], v[24:27], v[0:3]
 ds_read_b128 v[36:39], v70 offset:11264
 v_mfma_f32_16x16x32_bf16 v[4:7], v[180:183], v[24:27], v[4:7]
 buffer_load_dwordx4 v72, s[8:11], s73 offen sc1 lds
 v_mfma_f32_16x16x32_bf16 v[8:11], v[184:187], v[24:27], v[8:11]
 s_waitcnt lgkmcnt(2)
 v_mfma_f32_16x16x32_bf16 v[0:3], v[188:191], v[28:31], v[0:3]
 ds_read_b128 v[24:27], v70 offset:12288
 v_mfma_f32_16x16x32_bf16 v[4:7], v[192:195], v[28:31], v[4:7]
 v_mfma_f32_16x16x32_bf16 v[8:11], v[196:199], v[28:31], v[8:11]
 s_add_u32 m0, m0, s3
 s_add_u32 s73, s73, s3
 s_waitcnt lgkmcnt(2)
 v_mfma_f32_16x16x32_bf16 v[0:3], v[200:203], v[32:35], v[0:3]
 ds_read_b128 v[28:31], v70 offset:13312
 v_mfma_f32_16x16x32_bf16 v[4:7], v[204:207], v[32:35], v[4:7]
 buffer_load_dwordx4 v72, s[8:11], s73 offen sc1 lds
 v_mfma_f32_16x16x32_bf16 v[8:11], v[208:211], v[32:35], v[8:11]
 s_waitcnt lgkmcnt(2)
 v_mfma_f32_16x16x32_bf16 v[0:3], v[212:215], v[36:39], v[0:3]
 ds_read_b128 v[32:35], v70 offset:14336
 v_mfma_f32_16x16x32_bf16 v[4:7], v[216:219], v[36:39], v[4:7]
 s_add_u32 m0, m0, s3
 s_add_u32 s73, s73, s3
 v_mfma_f32_16x16x32_bf16 v[8:11], v[220:223], v[36:39], v[8:11]
 buffer_load_dwordx4 v72, s[8:11], s73 offen sc1 lds
 s_waitcnt lgkmcnt(2)
 v_mfma_f32_16x16x32_bf16 v[0:3], v[224:227], v[24:27], v[0:3]
 ds_read_b128 v[36:39], v70 offset:15360
 v_mfma_f32_16x16x32_bf16 v[4:7], v[228:231], v[24:27], v[4:7]
 v_mfma_f32_16x16x32_bf16 v[8:11], v[232:235], v[24:27], v[8:11]
 s_add_u32 m0, m0, s3
 s_add_u32 s73, s73, s3
 s_waitcnt lgkmcnt(2)
 v_mfma_f32_16x16x32_bf16 v[0:3], v[236:239], v[28:31], v[0:3]
 ds_read_b128 v[24:27], v70 offset:16384
 v_mfma_f32_16x16x32_bf16 v[4:7], v[240:243], v[28:31], v[4:7]
 buffer_load_dwordx4 v72, s[8:11], s73 offen sc1 lds
 v_mov_b32 v76, s95
 v_mfma_f32_16x16x32_bf16 v[8:11], v[244:247], v[28:31], v[8:11]
 s_waitcnt vmcnt(4)
 s_barrier
 buffer_store_dword v76, v77, s[8:11], s94 offen
 s_waitcnt lgkmcnt(2)
 v_mfma_f32_16x16x32_bf16 v[0:3], v[248:251], v[32:35], v[0:3]
 ds_read_b128 v[28:31], v70 offset:17408
 v_mfma_f32_16x16x32_bf16 v[4:7], v[252:255], v[32:35], v[4:7]
 v_mfma_f32_16x16x32_bf16 v[8:11], a[0:3], v[32:35], v[8:11]
 s_add_u32 m0, m0, s3
 s_add_u32 s73, s73, s3
 s_waitcnt lgkmcnt(2)
 v_mfma_f32_16x16x32_bf16 v[0:3], a[4:7], v[36:39], v[0:3]
 ds_read_b128 v[32:35], v70 offset:18432
 v_mfma_f32_16x16x32_bf16 v[4:7], a[8:11], v[36:39], v[4:7]
 buffer_load_dwordx4 v72, s[8:11], s73 offen sc1 lds
 v_mfma_f32_16x16x32_bf16 v[8:11], a[12:15], v[36:39], v[8:11]
 s_waitcnt lgkmcnt(2)
 v_mfma_f32_16x16x32_bf16 v[0:3], a[16:19], v[24:27], v[0:3]
 ds_read_b128 v[36:39], v70 offset:19456
 v_mfma_f32_16x16x32_bf16 v[4:7], a[20:23], v[24:27], v[4:7]
 s_add_u32 m0, m0, s3
 s_add_u32 s73, s73, s3
 v_mfma_f32_16x16x32_bf16 v[8:11], a[24:27], v[24:27], v[8:11]
 buffer_load_dwordx4 v72, s[8:11], s73 offen sc1 lds
 s_waitcnt lgkmcnt(2)
 v_mfma_f32_16x16x32_bf16 v[0:3], a[28:31], v[28:31], v[0:3]
 ds_read_b128 v[24:27], v70 offset:20480
 v_mfma_f32_16x16x32_bf16 v[4:7], a[32:35], v[28:31], v[4:7]
 v_mfma_f32_16x16x32_bf16 v[8:11], a[36:39], v[28:31], v[8:11]
 s_add_u32 m0, m0, s3
 s_add_u32 s73, s73, s3
 s_waitcnt lgkmcnt(2)
 v_mfma_f32_16x16x32_bf16 v[0:3], a[40:43], v[32:35], v[0:3]
 ds_read_b128 v[28:31], v70 offset:21504
 v_mfma_f32_16x16x32_bf16 v[4:7], a[44:47], v[32:35], v[4:7]
 buffer_load_dwordx4 v72, s[8:11], s73 offen sc1 lds
 v_mfma_f32_16x16x32_bf16 v[8:11], a[48:51], v[32:35], v[8:11]
 s_waitcnt lgkmcnt(2)
 v_mfma_f32_16x16x32_bf16 v[0:3], a[52:55], v[36:39], v[0:3]
 ds_read_b128 v[32:35], v70 offset:22528
 v_mfma_f32_16x16x32_bf16 v[4:7], a[56:59], v[36:39], v[4:7]
 v_mfma_f32_16x16x32_bf16 v[8:11], a[60:63], v[36:39], v[8:11]
 s_add_u32 m0, m0, s3
 s_add_u32 s73, s73, s3
 s_waitcnt lgkmcnt(2)
 v_mfma_f32_16x16x32_bf16 v[0:3], a[64:67], v[24:27], v[0:3]
 ds_read_b128 v[36:39], v70 offset:23552
 v_mfma_f32_16x16x32_bf16 v[4:7], a[68:71], v[24:27], v[4:7]
 buffer_load_dwordx4 v72, s[8:11], s73 offen sc1 lds
 v_mfma_f32_16x16x32_bf16 v[8:11], a[72:75], v[24:27], v[8:11]
 s_waitcnt lgkmcnt(2)
 v_mfma_f32_16x16x32_bf16 v[0:3], a[76:79], v[28:31], v[0:3]
 ds_read_b128 v[24:27], v70 offset:24576
 v_mfma_f32_16x16x32_bf16 v[4:7], a[80:83], v[28:31], v[4:7]
 s_add_u32 m0, m0, s3
 s_add_u32 s73, s73, s3
 v_mfma_f32_16x16x32_bf16 v[8:11], a[84:87], v[28:31], v[8:11]
 buffer_load_dwordx4 v72, s[8:11], s73 offen sc1 lds
 s_waitcnt lgkmcnt(2)
 v_mfma_f32_16x16x32_bf16 v[0:3], a[88:91], v[32:35], v[0:3]
 ds_read_b128 v[28:31], v70 offset:25600
 v_mfma_f32_16x16x32_bf16 v[4:7], a[92:95], v[32:35], v[4:7]
 v_mfma_f32_16x16x32_bf16 v[8:11], a[96:99], v[32:35], v[8:11]
 s_add_u32 m0, m0, s3
 s_add_u32 s73, s73, s3
 s_waitcnt lgkmcnt(2)
 v_mfma_f32_16x16x32_bf16 v[0:3], a[100:103], v[36:39], v[0:3]
 ds_read_b128 v[32:35], v70 offset:26624
 v_mfma_f32_16x16x32_bf16 v[4:7], a[104:107], v[36:39], v[4:7]
 buffer_load_dwordx4 v72, s[8:11], s73 offen sc1 lds
 v_mfma_f32_16x16x32_bf16 v[8:11], a[108:111], v[36:39], v[8:11]
 s_waitcnt lgkmcnt(2)
 v_mfma_f32_16x16x32_bf16 v[0:3], a[112:115], v[24:27], v[0:3]
 ds_read_b128 v[36:39], v70 offset:27648
 v_mfma_f32_16x16x32_bf16 v[4:7], a[116:119], v[24:27], v[4:7]
 v_mfma_f32_16x16x32_bf16 v[8:11], a[120:123], v[24:27], v[8:11]
 s_add_u32 m0, m0, s3
 s_add_u32 s73, s73, s3
 s_waitcnt lgkmcnt(2)
 v_mfma_f32_16x16x32_bf16 v[0:3], a[124:127], v[28:31], v[0:3]
 ds_read_b128 v[24:27], v70 offset:28672
 v_mfma_f32_16x16x32_bf16 v[4:7], a[128:131], v[28:31], v[4:7]
 buffer_load_dwordx4 v72, s[8:11], s73 offen sc1 lds
 v_mfma_f32_16x16x32_bf16 v[8:11], a[132:135], v[28:31], v[8:11]
 s_waitcnt lgkmcnt(2)
 v_mfma_f32_16x16x32_bf16 v[0:3], a[136:139], v[32:35], v[0:3]
 ds_read_b128 v[28:31], v70 offset:29696
 v_mfma_f32_16x16x32_bf16 v[4:7], a[140:143], v[32:35], v[4:7]
 s_add_u32 m0, m0, s3
 s_add_u32 s73, s73, s3
 v_mfma_f32_16x16x32_bf16 v[8:11], a[144:147], v[32:35], v[8:11]
 buffer_load_dwordx4 v72, s[8:11], s73 offen sc1 lds
 s_waitcnt lgkmcnt(2)
 v_mfma_f32_16x16x32_bf16 v[0:3], a[148:151], v[36:39], v[0:3]
 ds_read_b128 v[32:35], v70 offset:30720
 v_mfma_f32_16x16x32_bf16 v[4:7], a[152:155], v[36:39], v[4:7]
 v_mfma_f32_16x16x32_bf16 v[8:11], a[156:159], v[36:39], v[8:11]
 s_add_u32 m0, m0, s3
 s_add_u32 s73, s73, s3
 s_waitcnt lgkmcnt(2)
 v_mfma_f32_16x16x32_bf16 v[0:3], a[160:163], v[24:27], v[0:3]
 ds_read_b128 v[36:39], v70 offset:31744
 v_mfma_f32_16x16x32_bf16 v[4:7], a[164:167], v[24:27], v[4:7]
 buffer_load_dwordx4 v72, s[8:11], s73 offen sc1 lds
 v_mfma_f32_16x16x32_bf16 v[8:11], a[168:171], v[24:27], v[8:11]
 s_waitcnt lgkmcnt(2)
 v_mfma_f32_16x16x32_bf16 v[0:3], a[172:175], v[28:31], v[0:3]
 ds_read_b128 v[24:27], v71 offset:0
 v_mfma_f32_16x16x32_bf16 v[4:7], a[176:179], v[28:31], v[4:7]
 v_mfma_f32_16x16x32_bf16 v[8:11], a[180:183], v[28:31], v[8:11]
 s_add_u32 m0, m0, s3
 s_add_u32 s73, s73, s3
 s_waitcnt lgkmcnt(2)
 v_mfma_f32_16x16x32_bf16 v[0:3], a[184:187], v[32:35], v[0:3]
 ds_read_b128 v[28:31], v71 offset:1024
 v_mfma_f32_16x16x32_bf16 v[4:7], a[188:191], v[32:35], v[4:7]
 buffer_load_dwordx4 v72, s[8:11], s73 offen sc1 lds
 v_mfma_f32_16x16x32_bf16 v[8:11], a[192:195], v[32:35], v[8:11]
 s_waitcnt lgkmcnt(2)
 v_mfma_f32_16x16x32_bf16 v[0:3], a[196:199], v[36:39], v[0:3]
 ds_read_b128 v[32:35], v71 offset:2048
 v_mfma_f32_16x16x32_bf16 v[4:7], a[200:203], v[36:39], v[4:7]
 s_add_u32 m0, m0, s3
 s_add_u32 s73, s73, s3
 v_mfma_f32_16x16x32_bf16 v[8:11], a[204:207], v[36:39], v[8:11]
 buffer_load_dwordx4 v72, s[8:11], s73 offen sc1 lds
 s_waitcnt lgkmcnt(2)
 v_mfma_f32_16x16x32_bf16 v[12:15], v[80:83], v[24:27], 0
 ds_read_b128 v[36:39], v71 offset:3072
 v_mfma_f32_16x16x32_bf16 v[16:19], v[84:87], v[24:27], 0
 v_mfma_f32_16x16x32_bf16 v[20:23], v[88:91], v[24:27], 0
 s_add_u32 m0, m0, s3
 s_add_u32 s73, s73, s3
 s_waitcnt lgkmcnt(2)
 v_mfma_f32_16x16x32_bf16 v[12:15], v[92:95], v[28:31], v[12:15]
 ds_read_b128 v[24:27], v71 offset:4096
 v_mfma_f32_16x16x32_bf16 v[16:19], v[96:99], v[28:31], v[16:19]
 buffer_load_dwordx4 v72, s[8:11], s73 offen sc1 lds
 v_mfma_f32_16x16x32_bf16 v[20:23], v[100:103], v[28:31], v[20:23]
 v_cvt_pk_bf16_f32 v48, v0, v1
 s_waitcnt lgkmcnt(2)
 v_mfma_f32_16x16x32_bf16 v[12:15], v[104:107], v[32:35], v[12:15]
 ds_read_b128 v[28:31], v71 offset:5120
 v_cvt_pk_bf16_f32 v49, v2, v3
 v_mfma_f32_16x16x32_bf16 v[16:19], v[108:111], v[32:35], v[16:19]
 v_cvt_pk_bf16_f32 v50, v4, v5
 v_cvt_pk_bf16_f32 v51, v6, v7
 v_mfma_f32_16x16x32_bf16 v[20:23], v[112:115], v[32:35], v[20:23]
 v_cvt_pk_bf16_f32 v56, v8, v9
 s_waitcnt lgkmcnt(2)
 v_mfma_f32_16x16x32_bf16 v[12:15], v[116:119], v[36:39], v[12:15]
 ds_read_b128 v[32:35], v71 offset:6144
 v_cvt_pk_bf16_f32 v57, v10, v11
 v_mfma_f32_16x16x32_bf16 v[16:19], v[120:123], v[36:39], v[16:19]
 buffer_store_dwordx4 v[48:51], v73, s[8:11], s77 offen offset:0
 v_mfma_f32_16x16x32_bf16 v[20:23], v[124:127], v[36:39], v[20:23]
 s_mov_b32 s5, s85
 s_sub_u32 s85, 0, s85
 s_waitcnt lgkmcnt(2)
 v_mfma_f32_16x16x32_bf16 v[12:15], v[128:131], v[24:27], v[12:15]
 ds_read_b128 v[36:39], v71 offset:7168
 s_add_u32 s70, s70, s85
 v_mfma_f32_16x16x32_bf16 v[16:19], v[132:135], v[24:27], v[16:19]
 s_mov_b32 s81, s77
 s_mov_b32 s82, s78
 s_mov_b32 s83, s79
 v_mfma_f32_16x16x32_bf16 v[20:23], v[136:139], v[24:27], v[20:23]
 s_mov_b32 s94, s92
 s_mov_b32 s95, s93
 s_waitcnt lgkmcnt(2)
 v_mfma_f32_16x16x32_bf16 v[12:15], v[140:143], v[28:31], v[12:15]
 ds_read_b128 v[24:27], v71 offset:8192
 s_mul_i32 s64, s68, 0
 v_mfma_f32_16x16x32_bf16 v[16:19], v[144:147], v[28:31], v[16:19]
 s_add_u32 s64, s64, 4
 s_mul_i32 s63, s68, 0
 v_mfma_f32_16x16x32_bf16 v[20:23], v[148:151], v[28:31], v[20:23]
 s_add_u32 s63, s63, 128
 s_waitcnt lgkmcnt(2)
 v_mfma_f32_16x16x32_bf16 v[12:15], v[152:155], v[32:35], v[12:15]
 ds_read_b128 v[28:31], v71 offset:9216
 s_mul_i32 s63, s69, s63
 v_mfma_f32_16x16x32_bf16 v[16:19], v[156:159], v[32:35], v[16:19]
 s_lshr_b32 s63, s63, 9
 s_mul_i32 s63, s63, s64
 s_sub_u32 s63, s69, s63
 v_mfma_f32_16x16x32_bf16 v[20:23], v[160:163], v[32:35], v[20:23]
 s_mul_i32 s63, s63, 294912
 s_waitcnt lgkmcnt(2)
 v_mfma_f32_16x16x32_bf16 v[12:15], v[164:167], v[36:39], v[12:15]
 ds_read_b128 v[32:35], v71 offset:10240
 s_mul_i32 s64, s68, 1179648
 v_mfma_f32_16x16x32_bf16 v[16:19], v[168:171], v[36:39], v[16:19]
 s_add_u32 s63, s63, s64
 s_add_u32 s77, s63, s87
 s_add_u32 s78, s63, s88
 v_mfma_f32_16x16x32_bf16 v[20:23], v[172:175], v[36:39], v[20:23]
 s_add_u32 s79, s63, s89
 s_waitcnt lgkmcnt(2)
 v_mfma_f32_16x16x32_bf16 v[12:15], v[176:179], v[24:27], v[12:15]
 ds_read_b128 v[36:39], v71 offset:11264
 s_mul_i32 s92, s68, 512
 v_mfma_f32_16x16x32_bf16 v[16:19], v[180:183], v[24:27], v[16:19]
 s_sub_u32 s93, s80, 1
 s_min_u32 s93, s93, 64
 s_add_u32 s61, s61, 1
 v_mfma_f32_16x16x32_bf16 v[20:23], v[184:187], v[24:27], v[20:23]
 s_waitcnt lgkmcnt(2)
 v_mfma_f32_16x16x32_bf16 v[12:15], v[188:191], v[28:31], v[12:15]
 ds_read_b128 v[24:27], v71 offset:12288
 v_mfma_f32_16x16x32_bf16 v[16:19], v[192:195], v[28:31], v[16:19]
 v_mfma_f32_16x16x32_bf16 v[20:23], v[196:199], v[28:31], v[20:23]
 s_waitcnt lgkmcnt(2)
 v_mfma_f32_16x16x32_bf16 v[12:15], v[200:203], v[32:35], v[12:15]
 ds_read_b128 v[28:31], v71 offset:13312
 buffer_load_dword v75, v74, s[8:11], 0 offen sc1
 v_mfma_f32_16x16x32_bf16 v[16:19], v[204:207], v[32:35], v[16:19]
 v_mfma_f32_16x16x32_bf16 v[20:23], v[208:211], v[32:35], v[20:23]
 s_waitcnt lgkmcnt(2)
 v_mfma_f32_16x16x32_bf16 v[12:15], v[212:215], v[36:39], v[12:15]
 ds_read_b128 v[32:35], v71 offset:14336
 v_mfma_f32_16x16x32_bf16 v[16:19], v[216:219], v[36:39], v[16:19]
 v_mfma_f32_16x16x32_bf16 v[20:23], v[220:223], v[36:39], v[20:23]
 s_waitcnt lgkmcnt(2)
 v_mfma_f32_16x16x32_bf16 v[12:15], v[224:227], v[24:27], v[12:15]
 ds_read_b128 v[36:39], v71 offset:15360
 v_mfma_f32_16x16x32_bf16 v[16:19], v[228:231], v[24:27], v[16:19]
 v_mfma_f32_16x16x32_bf16 v[20:23], v[232:235], v[24:27], v[20:23]
 s_waitcnt lgkmcnt(2)
 v_mfma_f32_16x16x32_bf16 v[12:15], v[236:239], v[28:31], v[12:15]
 ds_read_b128 v[24:27], v71 offset:16384
 v_mfma_f32_16x16x32_bf16 v[16:19], v[240:243], v[28:31], v[16:19]
 v_mfma_f32_16x16x32_bf16 v[20:23], v[244:247], v[28:31], v[20:23]
 s_waitcnt lgkmcnt(2)
 v_mfma_f32_16x16x32_bf16 v[12:15], v[248:251], v[32:35], v[12:15]
 ds_read_b128 v[28:31], v71 offset:17408
 v_mfma_f32_16x16x32_bf16 v[16:19], v[252:255], v[32:35], v[16:19]
 v_mfma_f32_16x16x32_bf16 v[20:23], a[0:3], v[32:35], v[20:23]
 s_waitcnt lgkmcnt(2)
 v_mfma_f32_16x16x32_bf16 v[12:15], a[4:7], v[36:39], v[12:15]
 ds_read_b128 v[32:35], v71 offset:18432
 v_mfma_f32_16x16x32_bf16 v[16:19], a[8:11], v[36:39], v[16:19]
 v_mfma_f32_16x16x32_bf16 v[20:23], a[12:15], v[36:39], v[20:23]
 s_waitcnt lgkmcnt(2)
 v_mfma_f32_16x16x32_bf16 v[12:15], a[16:19], v[24:27], v[12:15]
 ds_read_b128 v[36:39], v71 offset:19456
 v_mfma_f32_16x16x32_bf16 v[16:19], a[20:23], v[24:27], v[16:19]
 v_mfma_f32_16x16x32_bf16 v[20:23], a[24:27], v[24:27], v[20:23]
 s_waitcnt lgkmcnt(2)
 v_mfma_f32_16x16x32_bf16 v[12:15], a[28:31], v[28:31], v[12:15]
 ds_read_b128 v[24:27], v71 offset:20480
 v_mfma_f32_16x16x32_bf16 v[16:19], a[32:35], v[28:31], v[16:19]
 v_mfma_f32_16x16x32_bf16 v[20:23], a[36:39], v[28:31], v[20:23]
 s_waitcnt lgkmcnt(2)
 v_mfma_f32_16x16x32_bf16 v[12:15], a[40:43], v[32:35], v[12:15]
 ds_read_b128 v[28:31], v71 offset:21504
 v_mfma_f32_16x16x32_bf16 v[16:19], a[44:47], v[32:35], v[16:19]
 v_mfma_f32_16x16x32_bf16 v[20:23], a[48:51], v[32:35], v[20:23]
 s_waitcnt lgkmcnt(2)
 v_mfma_f32_16x16x32_bf16 v[12:15], a[52:55], v[36:39], v[12:15]
 ds_read_b128 v[32:35], v71 offset:22528
 v_mfma_f32_16x16x32_bf16 v[16:19], a[56:59], v[36:39], v[16:19]
 v_mfma_f32_16x16x32_bf16 v[20:23], a[60:63], v[36:39], v[20:23]
 s_waitcnt lgkmcnt(2)
 v_mfma_f32_16x16x32_bf16 v[12:15], a[64:67], v[24:27], v[12:15]
 ds_read_b128 v[36:39], v71 offset:23552
 v_mfma_f32_16x16x32_bf16 v[16:19], a[68:71], v[24:27], v[16:19]
 v_mfma_f32_16x16x32_bf16 v[20:23], a[72:75], v[24:27], v[20:23]
 s_waitcnt lgkmcnt(2)
 v_mfma_f32_16x16x32_bf16 v[12:15], a[76:79], v[28:31], v[12:15]
 ds_read_b128 v[24:27], v71 offset:24576
 v_mfma_f32_16x16x32_bf16 v[16:19], a[80:83], v[28:31], v[16:19]
 v_mfma_f32_16x16x32_bf16 v[20:23], a[84:87], v[28:31], v[20:23]
 s_waitcnt lgkmcnt(2)
 v_mfma_f32_16x16x32_bf16 v[12:15], a[88:91], v[32:35], v[12:15]
 ds_read_b128 v[28:31], v71 offset:25600
 v_mfma_f32_16x16x32_bf16 v[16:19], a[92:95], v[32:35], v[16:19]
 v_mfma_f32_16x16x32_bf16 v[20:23], a[96:99], v[32:35], v[20:23]
 s_waitcnt lgkmcnt(2)
 v_mfma_f32_16x16x32_bf16 v[12:15], a[100:103], v[36:39], v[12:15]
 ds_read_b128 v[32:35], v71 offset:26624
 v_mfma_f32_16x16x32_bf16 v[16:19], a[104:107], v[36:39], v[16:19]
 v_mfma_f32_16x16x32_bf16 v[20:23], a[108:111], v[36:39], v[20:23]
 s_waitcnt lgkmcnt(2)
 v_mfma_f32_16x16x32_bf16 v[12:15], a[112:115], v[24:27], v[12:15]
 ds_read_b128 v[36:39], v71 offset:27648
 v_mfma_f32_16x16x32_bf16 v[16:19], a[116:119], v[24:27], v[16:19]
 v_mfma_f32_16x16x32_bf16 v[20:23], a[120:123], v[24:27], v[20:23]
 s_waitcnt vmcnt(0)
 v_add_u32 v64, v65, v75
 v_cmp_gt_u32 vcc, s74, v64
 s_waitcnt lgkmcnt(2)
 v_mfma_f32_16x16x32_bf16 v[12:15], a[124:127], v[28:31], v[12:15]
 ds_read_b128 v[24:27], v71 offset:28672
 v_cmp_gt_u32 s[66:67], s75, v64
 v_mfma_f32_16x16x32_bf16 v[16:19], a[128:131], v[28:31], v[16:19]
 v_mfma_f32_16x16x32_bf16 v[20:23], a[132:135], v[28:31], v[20:23]
 s_waitcnt lgkmcnt(2)
 v_mfma_f32_16x16x32_bf16 v[12:15], a[136:139], v[32:35], v[12:15]
 ds_read_b128 v[28:31], v71 offset:29696
 s_cmp_eq_u32 s67, 0
 s_cselect_b32 s72, 2, 0
 s_cmp_eq_u32 vcc_lo, 0
 s_cselect_b32 s72, 1, s72
 v_mfma_f32_16x16x32_bf16 v[16:19], a[140:143], v[32:35], v[16:19]
 v_mov_b32 v76, s72
 v_mfma_f32_16x16x32_bf16 v[20:23], a[144:147], v[32:35], v[20:23]
 ds_write_b32 v72, v76 offset:4
 s_waitcnt lgkmcnt(3)
 v_mfma_f32_16x16x32_bf16 v[12:15], a[148:151], v[36:39], v[12:15]
 ds_read_b128 v[32:35], v71 offset:30720
 v_mfma_f32_16x16x32_bf16 v[16:19], a[152:155], v[36:39], v[16:19]
 v_mfma_f32_16x16x32_bf16 v[20:23], a[156:159], v[36:39], v[20:23]
 s_waitcnt lgkmcnt(3)
 v_mfma_f32_16x16x32_bf16 v[12:15], a[160:163], v[24:27], v[12:15]
 ds_read_b128 v[36:39], v71 offset:31744
 v_mfma_f32_16x16x32_bf16 v[16:19], a[164:167], v[24:27], v[16:19]
 v_mfma_f32_16x16x32_bf16 v[20:23], a[168:171], v[24:27], v[20:23]
 s_waitcnt lgkmcnt(2)
L_wo_fe:
 s_barrier
 ds_read_b32 v76, v73 offset:4
 s_waitcnt lgkmcnt(3)
 v_mfma_f32_16x16x32_bf16 v[12:15], a[172:175], v[28:31], v[12:15]
 v_add_u32 v70, s5, v70
 v_add_u32 v71, s5, v71
 ds_read_b128 v[24:27], v70 offset:0
 v_mfma_f32_16x16x32_bf16 v[16:19], a[176:179], v[28:31], v[16:19]
 v_mfma_f32_16x16x32_bf16 v[20:23], a[180:183], v[28:31], v[20:23]
 s_waitcnt lgkmcnt(3)
 v_mfma_f32_16x16x32_bf16 v[12:15], a[184:187], v[32:35], v[12:15]
 ds_read_b128 v[28:31], v70 offset:1024
 v_mfma_f32_16x16x32_bf16 v[16:19], a[188:191], v[32:35], v[16:19]
 v_mfma_f32_16x16x32_bf16 v[20:23], a[192:195], v[32:35], v[20:23]
 s_waitcnt lgkmcnt(2)
 v_readfirstlane_b32 s72, v76
 v_mfma_f32_16x16x32_bf16 v[12:15], a[196:199], v[36:39], v[12:15]
 ds_read_b128 v[32:35], v70 offset:2048
 v_mfma_f32_16x16x32_bf16 v[16:19], a[200:203], v[36:39], v[16:19]
 v_mfma_f32_16x16x32_bf16 v[20:23], a[204:207], v[36:39], v[20:23]
 s_cmp_lg_u32 s72, 0
 s_cbranch_scc1 L_wo_p0ed
 s_branch L_wo_p0e
L_wo_p1n:
 s_waitcnt lgkmcnt(2)
 v_mfma_f32_16x16x32_bf16 v[12:15], v[80:83], v[24:27], 0
 ds_read_b128 v[36:39], v71 offset:3072
 v_mfma_f32_16x16x32_bf16 v[16:19], v[84:87], v[24:27], 0
 v_mfma_f32_16x16x32_bf16 v[20:23], v[88:91], v[24:27], 0
 s_waitcnt lgkmcnt(2)
 v_mfma_f32_16x16x32_bf16 v[12:15], v[92:95], v[28:31], v[12:15]
 ds_read_b128 v[24:27], v71 offset:4096
 v_mfma_f32_16x16x32_bf16 v[16:19], v[96:99], v[28:31], v[16:19]
 v_cvt_pk_bf16_f32 v48, v0, v1
 v_cvt_pk_bf16_f32 v49, v2, v3
 v_mfma_f32_16x16x32_bf16 v[20:23], v[100:103], v[28:31], v[20:23]
 v_cvt_pk_bf16_f32 v50, v4, v5
 s_waitcnt lgkmcnt(2)
 v_mfma_f32_16x16x32_bf16 v[12:15], v[104:107], v[32:35], v[12:15]
 ds_read_b128 v[28:31], v71 offset:5120
 v_cvt_pk_bf16_f32 v51, v6, v7
 v_mfma_f32_16x16x32_bf16 v[16:19], v[108:111], v[32:35], v[16:19]
 buffer_store_dwordx4 v[48:51], v73, s[8:11], s77 offen offset:0
 v_mfma_f32_16x16x32_bf16 v[20:23], v[112:115], v[32:35], v[20:23]
 v_cvt_pk_bf16_f32 v56, v8, v9
 s_waitcnt lgkmcnt(2)
 v_mfma_f32_16x16x32_bf16 v[12:15], v[116:119], v[36:39], v[12:15]
 ds_read_b128 v[32:35], v71 offset:6144
 v_cvt_pk_bf16_f32 v57, v10, v11
 v_mfma_f32_16x16x32_bf16 v[16:19], v[120:123], v[36:39], v[16:19]
 v_mfma_f32_16x16x32_bf16 v[20:23], v[124:127], v[36:39], v[20:23]
 s_waitcnt lgkmcnt(2)
 v_mfma_f32_16x16x32_bf16 v[12:15], v[128:131], v[24:27], v[12:15]
 ds_read_b128 v[36:39], v71 offset:7168
 v_mfma_f32_16x16x32_bf16 v[16:19], v[132:135], v[24:27], v[16:19]
 v_mfma_f32_16x16x32_bf16 v[20:23], v[136:139], v[24:27], v[20:23]
 s_waitcnt lgkmcnt(2)
 v_mfma_f32_16x16x32_bf16 v[12:15], v[140:143], v[28:31], v[12:15]
 ds_read_b128 v[24:27], v71 offset:8192
 v_mfma_f32_16x16x32_bf16 v[16:19], v[144:147], v[28:31], v[16:19]
 v_mfma_f32_16x16x32_bf16 v[20:23], v[148:151], v[28:31], v[20:23]
 s_waitcnt lgkmcnt(2)
 v_mfma_f32_16x16x32_bf16 v[12:15], v[152:155], v[32:35], v[12:15]
 ds_read_b128 v[28:31], v71 offset:9216
 v_mfma_f32_16x16x32_bf16 v[16:19], v[156:159], v[32:35], v[16:19]
 v_mfma_f32_16x16x32_bf16 v[20:23], v[160:163], v[32:35], v[20:23]
 s_waitcnt lgkmcnt(2)
 v_mfma_f32_16x16x32_bf16 v[12:15], v[164:167], v[36:39], v[12:15]
 ds_read_b128 v[32:35], v71 offset:10240
 v_mfma_f32_16x16x32_bf16 v[16:19], v[168:171], v[36:39], v[16:19]
 v_mfma_f32_16x16x32_bf16 v[20:23], v[172:175], v[36:39], v[20:23]
 s_waitcnt lgkmcnt(2)
 v_mfma_f32_16x16x32_bf16 v[12:15], v[176:179], v[24:27], v[12:15]
 ds_read_b128 v[36:39], v71 offset:11264
 v_mfma_f32_16x16x32_bf16 v[16:19], v[180:183], v[24:27], v[16:19]
 v_mfma_f32_16x16x32_bf16 v[20:23], v[184:187], v[24:27], v[20:23]
 s_waitcnt lgkmcnt(2)
 v_mfma_f32_16x16x32_bf16 v[12:15], v[188:191], v[28:31], v[12:15]
 ds_read_b128 v[24:27], v71 offset:12288
 v_mfma_f32_16x16x32_bf16 v[16:19], v[192:195], v[28:31], v[16:19]
 v_mfma_f32_16x16x32_bf16 v[20:23], v[196:199], v[28:31], v[20:23]
 s_waitcnt lgkmcnt(2)
 v_mfma_f32_16x16x32_bf16 v[12:15], v[200:203], v[32:35], v[12:15]
 ds_read_b128 v[28:31], v71 offset:13312
 v_mfma_f32_16x16x32_bf16 v[16:19], v[204:207], v[32:35], v[16:19]
 v_mfma_f32_16x16x32_bf16 v[20:23], v[208:211], v[32:35], v[20:23]
 s_waitcnt lgkmcnt(2)
 v_mfma_f32_16x16x32_bf16 v[12:15], v[212:215], v[36:39], v[12:15]
 ds_read_b128 v[32:35], v71 offset:14336
 v_mfma_f32_16x16x32_bf16 v[16:19], v[216:219], v[36:39], v[16:19]
 v_mfma_f32_16x16x32_bf16 v[20:23], v[220:223], v[36:39], v[20:23]
 s_waitcnt lgkmcnt(2)
 v_mfma_f32_16x16x32_bf16 v[12:15], v[224:227], v[24:27], v[12:15]
 ds_read_b128 v[36:39], v71 offset:15360
 v_mfma_f32_16x16x32_bf16 v[16:19], v[228:231], v[24:27], v[16:19]
 v_mfma_f32_16x16x32_bf16 v[20:23], v[232:235], v[24:27], v[20:23]
 s_waitcnt lgkmcnt(2)
 v_mfma_f32_16x16x32_bf16 v[12:15], v[236:239], v[28:31], v[12:15]
 ds_read_b128 v[24:27], v71 offset:16384
 v_mfma_f32_16x16x32_bf16 v[16:19], v[240:243], v[28:31], v[16:19]
 buffer_load_dword v75, v74, s[8:11], 0 offen sc1
 v_mfma_f32_16x16x32_bf16 v[20:23], v[244:247], v[28:31], v[20:23]
 s_waitcnt lgkmcnt(2)
 v_mfma_f32_16x16x32_bf16 v[12:15], v[248:251], v[32:35], v[12:15]
 ds_read_b128 v[28:31], v71 offset:17408
 v_mfma_f32_16x16x32_bf16 v[16:19], v[252:255], v[32:35], v[16:19]
 v_mfma_f32_16x16x32_bf16 v[20:23], a[0:3], v[32:35], v[20:23]
 s_waitcnt lgkmcnt(2)
 v_mfma_f32_16x16x32_bf16 v[12:15], a[4:7], v[36:39], v[12:15]
 ds_read_b128 v[32:35], v71 offset:18432
 v_mfma_f32_16x16x32_bf16 v[16:19], a[8:11], v[36:39], v[16:19]
 v_mfma_f32_16x16x32_bf16 v[20:23], a[12:15], v[36:39], v[20:23]
 s_waitcnt lgkmcnt(2)
 v_mfma_f32_16x16x32_bf16 v[12:15], a[16:19], v[24:27], v[12:15]
 ds_read_b128 v[36:39], v71 offset:19456
 v_mfma_f32_16x16x32_bf16 v[16:19], a[20:23], v[24:27], v[16:19]
 v_mfma_f32_16x16x32_bf16 v[20:23], a[24:27], v[24:27], v[20:23]
 s_waitcnt lgkmcnt(2)
 v_mfma_f32_16x16x32_bf16 v[12:15], a[28:31], v[28:31], v[12:15]
 ds_read_b128 v[24:27], v71 offset:20480
 v_mfma_f32_16x16x32_bf16 v[16:19], a[32:35], v[28:31], v[16:19]
 v_mfma_f32_16x16x32_bf16 v[20:23], a[36:39], v[28:31], v[20:23]
 s_waitcnt lgkmcnt(2)
 v_mfma_f32_16x16x32_bf16 v[12:15], a[40:43], v[32:35], v[12:15]
 ds_read_b128 v[28:31], v71 offset:21504
 v_mfma_f32_16x16x32_bf16 v[16:19], a[44:47], v[32:35], v[16:19]
 v_mfma_f32_16x16x32_bf16 v[20:23], a[48:51], v[32:35], v[20:23]
 s_waitcnt lgkmcnt(2)
 v_mfma_f32_16x16x32_bf16 v[12:15], a[52:55], v[36:39], v[12:15]
 ds_read_b128 v[32:35], v71 offset:22528
 v_mfma_f32_16x16x32_bf16 v[16:19], a[56:59], v[36:39], v[16:19]
 v_mfma_f32_16x16x32_bf16 v[20:23], a[60:63], v[36:39], v[20:23]
 s_waitcnt lgkmcnt(2)
 v_mfma_f32_16x16x32_bf16 v[12:15], a[64:67], v[24:27], v[12:15]
 ds_read_b128 v[36:39], v71 offset:23552
 v_mfma_f32_16x16x32_bf16 v[16:19], a[68:71], v[24:27], v[16:19]
 v_mfma_f32_16x16x32_bf16 v[20:23], a[72:75], v[24:27], v[20:23]
 s_waitcnt lgkmcnt(2)
 v_mfma_f32_16x16x32_bf16 v[12:15], a[76:79], v[28:31], v[12:15]
 ds_read_b128 v[24:27], v71 offset:24576
 v_mfma_f32_16x16x32_bf16 v[16:19], a[80:83], v[28:31], v[16:19]
 v_mfma_f32_16x16x32_bf16 v[20:23], a[84:87], v[28:31], v[20:23]
 s_waitcnt lgkmcnt(2)
 v_mfma_f32_16x16x32_bf16 v[12:15], a[88:91], v[32:35], v[12:15]
 ds_read_b128 v[28:31], v71 offset:25600
 v_mfma_f32_16x16x32_bf16 v[16:19], a[92:95], v[32:35], v[16:19]
 v_mfma_f32_16x16x32_bf16 v[20:23], a[96:99], v[32:35], v[20:23]
 s_waitcnt lgkmcnt(2)
 v_mfma_f32_16x16x32_bf16 v[12:15], a[100:103], v[36:39], v[12:15]
 ds_read_b128 v[32:35], v71 offset:26624
 v_mfma_f32_16x16x32_bf16 v[16:19], a[104:107], v[36:39], v[16:19]
 v_mfma_f32_16x16x32_bf16 v[20:23], a[108:111], v[36:39], v[20:23]
 s_waitcnt lgkmcnt(2)
 v_mfma_f32_16x16x32_bf16 v[12:15], a[112:115], v[24:27], v[12:15]
 ds_read_b128 v[36:39], v71 offset:27648
 v_mfma_f32_16x16x32_bf16 v[16:19], a[116:119], v[24:27], v[16:19]
 v_mfma_f32_16x16x32_bf16 v[20:23], a[120:123], v[24:27], v[20:23]
 s_waitcnt vmcnt(0)
 v_add_u32 v64, v65, v75
 v_cmp_gt_u32 vcc, s74, v64
 s_waitcnt lgkmcnt(2)
 v_mfma_f32_16x16x32_bf16 v[12:15], a[124:127], v[28:31], v[12:15]
 ds_read_b128 v[24:27], v71 offset:28672
 v_cmp_gt_u32 s[66:67], s75, v64
 v_mfma_f32_16x16x32_bf16 v[16:19], a[128:131], v[28:31], v[16:19]
 v_mfma_f32_16x16x32_bf16 v[20:23], a[132:135], v[28:31], v[20:23]
 s_waitcnt lgkmcnt(2)
 v_mfma_f32_16x16x32_bf16 v[12:15], a[136:139], v[32:35], v[12:15]
 ds_read_b128 v[28:31], v71 offset:29696
 s_cmp_eq_u32 s67, 0
 s_cselect_b32 s72, 2, 0
 s_cmp_eq_u32 vcc_lo, 0
 s_cselect_b32 s72, 1, s72
 v_mfma_f32_16x16x32_bf16 v[16:19], a[140:143], v[32:35], v[16:19]
 v_mov_b32 v76, s72
 v_mfma_f32_16x16x32_bf16 v[20:23], a[144:147], v[32:35], v[20:23]
 ds_write_b32 v72, v76 offset:4
 s_waitcnt lgkmcnt(3)
 v_mfma_f32_16x16x32_bf16 v[12:15], a[148:151], v[36:39], v[12:15]
 ds_read_b128 v[32:35], v71 offset:30720
 v_mfma_f32_16x16x32_bf16 v[16:19], a[152:155], v[36:39], v[16:19]
 v_mfma_f32_16x16x32_bf16 v[20:23], a[156:159], v[36:39], v[20:23]
 s_waitcnt lgkmcnt(3)
 v_mfma_f32_16x16x32_bf16 v[12:15], a[160:163], v[24:27], v[12:15]
 ds_read_b128 v[36:39], v71 offset:31744
 v_mfma_f32_16x16x32_bf16 v[16:19], a[164:167], v[24:27], v[16:19]
 v_mfma_f32_16x16x32_bf16 v[20:23], a[168:171], v[24:27], v[20:23]
 s_waitcnt lgkmcnt(2)
 s_barrier
 ds_read_b32 v76, v73 offset:4
 s_waitcnt lgkmcnt(3)
 v_mfma_f32_16x16x32_bf16 v[12:15], a[172:175], v[28:31], v[12:15]
 v_mfma_f32_16x16x32_bf16 v[16:19], a[176:179], v[28:31], v[16:19]
 v_mfma_f32_16x16x32_bf16 v[20:23], a[180:183], v[28:31], v[20:23]
 s_waitcnt lgkmcnt(2)
 v_mfma_f32_16x16x32_bf16 v[12:15], a[184:187], v[32:35], v[12:15]
 v_mfma_f32_16x16x32_bf16 v[16:19], a[188:191], v[32:35], v[16:19]
 v_mfma_f32_16x16x32_bf16 v[20:23], a[192:195], v[32:35], v[20:23]
 s_waitcnt lgkmcnt(0)
 v_readfirstlane_b32 s72, v76
 v_mfma_f32_16x16x32_bf16 v[12:15], a[196:199], v[36:39], v[12:15]
 v_mfma_f32_16x16x32_bf16 v[16:19], a[200:203], v[36:39], v[16:19]
 v_mfma_f32_16x16x32_bf16 v[20:23], a[204:207], v[36:39], v[20:23]
 s_cmp_lg_u32 s72, 0
 s_cbranch_scc0 L_wo_t2
 s_nop 7
 v_cvt_pk_bf16_f32 v58, v20, v21
 v_cvt_pk_bf16_f32 v59, v22, v23
 v_cvt_pk_bf16_f32 v52, v12, v13
 v_cvt_pk_bf16_f32 v53, v14, v15
 v_cvt_pk_bf16_f32 v54, v16, v17
 v_cvt_pk_bf16_f32 v55, v18, v19
 buffer_store_dwordx4 v[52:55], v73, s[8:11], s77 offen offset:1024
 v_permlane32_swap_b32 v56, v58
 v_permlane32_swap_b32 v57, v59
 buffer_store_dwordx4 v[56:59], v73, s[8:11], s77 offen offset:2048
 s_sub_u32 s68, s72, 1
 s_cmp_eq_u32 s68, 0
 s_cselect_b32 s69, s74, s75
 s_cselect_b32 s63, s44, s47
 s_cselect_b32 s64, s45, s48
 s_cselect_b32 s80, s46, s49
 s_cmp_lt_u32 s69, s63
 s_cselect_b32 s80, s64, s80
 s_add_u32 s80, s80, s69
 s_cmp_eq_u32 s68, 0
 s_cselect_b32 s74, s80, s74
 s_cselect_b32 s75, s75, s80
 s_mul_i32 s73, s69, 262144
 s_mul_i32 s63, s68, 16777216
 s_add_u32 s73, s73, s63
 s_add_u32 s73, s73, s90
 s_mov_b32 m0, s70
 s_nop 0
 buffer_load_dwordx4 v72, s[8:11], s73 offen sc1 lds
 s_add_u32 m0, m0, s3
 s_add_u32 s73, s73, s3
 buffer_load_dwordx4 v72, s[8:11], s73 offen sc1 lds
 s_add_u32 m0, m0, s3
 s_add_u32 s73, s73, s3
 buffer_load_dwordx4 v72, s[8:11], s73 offen sc1 lds
 s_add_u32 m0, m0, s3
 s_add_u32 s73, s73, s3
 buffer_load_dwordx4 v72, s[8:11], s73 offen sc1 lds
 s_add_u32 m0, m0, s3
 s_add_u32 s73, s73, s3
 buffer_load_dwordx4 v72, s[8:11], s73 offen sc1 lds
 s_add_u32 m0, m0, s3
 s_add_u32 s73, s73, s3
 buffer_load_dwordx4 v72, s[8:11], s73 offen sc1 lds
 s_add_u32 m0, m0, s3
 s_add_u32 s73, s73, s3
 buffer_load_dwordx4 v72, s[8:11], s73 offen sc1 lds
 s_add_u32 m0, m0, s3
 s_add_u32 s73, s73, s3
 buffer_load_dwordx4 v72, s[8:11], s73 offen sc1 lds
 s_add_u32 m0, m0, s3
 s_add_u32 s73, s73, s3
 buffer_load_dwordx4 v72, s[8:11], s73 offen sc1 lds
 s_add_u32 m0, m0, s3
 s_add_u32 s73, s73, s3
 buffer_load_dwordx4 v72, s[8:11], s73 offen sc1 lds
 s_add_u32 m0, m0, s3
 s_add_u32 s73, s73, s3
 buffer_load_dwordx4 v72, s[8:11], s73 offen sc1 lds
 s_add_u32 m0, m0, s3
 s_add_u32 s73, s73, s3
 buffer_load_dwordx4 v72, s[8:11], s73 offen sc1 lds
 s_add_u32 m0, m0, s3
 s_add_u32 s73, s73, s3
 buffer_load_dwordx4 v72, s[8:11], s73 offen sc1 lds
 s_add_u32 m0, m0, s3
 s_add_u32 s73, s73, s3
 buffer_load_dwordx4 v72, s[8:11], s73 offen sc1 lds
 s_add_u32 m0, m0, s3
 s_add_u32 s73, s73, s3
 buffer_load_dwordx4 v72, s[8:11], s73 offen sc1 lds
 s_add_u32 m0, m0, s3
 s_add_u32 s73, s73, s3
 buffer_load_dwordx4 v72, s[8:11], s73 offen sc1 lds
 v_mov_b32 v76, s93
 s_waitcnt vmcnt(16)
 s_barrier
 buffer_store_dword v76, v77, s[8:11], s92 offen
 s_mov_b32 s5, s85
 s_sub_u32 s85, 0, s85
 s_add_u32 s70, s70, s85
 s_mov_b32 s81, s77
 s_mov_b32 s82, s78
 s_mov_b32 s83, s79
 s_mov_b32 s94, s92
 s_mov_b32 s95, s93
 s_mul_i32 s64, s68, 0
 s_add_u32 s64, s64, 4
 s_mul_i32 s63, s68, 0
 s_add_u32 s63, s63, 128
 s_mul_i32 s63, s69, s63
 s_lshr_b32 s63, s63, 9
 s_mul_i32 s63, s63, s64
 s_sub_u32 s63, s69, s63
 s_mul_i32 s63, s63, 294912
 s_mul_i32 s64, s68, 1179648
 s_add_u32 s63, s63, s64
 s_add_u32 s77, s63, s87
 s_add_u32 s78, s63, s88
 s_add_u32 s79, s63, s89
 s_mul_i32 s92, s68, 512
 s_sub_u32 s93, s80, 1
 s_min_u32 s93, s93, 64
 s_add_u32 s61, s61, 1
 v_add_u32 v70, s5, v70
 v_add_u32 v71, s5, v71
 v_add_u32 v64, v65, v75
 v_cmp_gt_u32 vcc, s74, v64
 v_cmp_gt_u32 s[66:67], s75, v64
 s_cmp_eq_u32 s67, 0
 s_cselect_b32 s72, 2, 0
 s_cmp_eq_u32 vcc_lo, 0
 s_cselect_b32 s72, 1, s72
 v_mov_b32 v76, s72
 ds_write_b32 v72, v76 offset:12
 s_waitcnt vmcnt(9) lgkmcnt(0)
 s_barrier
 ds_read_b32 v76, v73 offset:12
 ds_read_b128 v[24:27], v70 offset:0
 ds_read_b128 v[28:31], v70 offset:1024
 ds_read_b128 v[32:35], v70 offset:2048
 s_waitcnt lgkmcnt(3)
 v_readfirstlane_b32 s72, v76
 s_cmp_lg_u32 s72, 0
 s_branch L_wo_slow
L_wo_t2:
 s_nop 7
 v_cvt_pk_bf16_f32 v58, v20, v21
 v_cvt_pk_bf16_f32 v59, v22, v23
 v_cvt_pk_bf16_f32 v52, v12, v13
 v_cvt_pk_bf16_f32 v53, v14, v15
 v_cvt_pk_bf16_f32 v54, v16, v17
 v_cvt_pk_bf16_f32 v55, v18, v19
 buffer_store_dwordx4 v[52:55], v73, s[8:11], s77 offen offset:1024
 v_permlane32_swap_b32 v56, v58
 v_permlane32_swap_b32 v57, v59
 buffer_store_dwordx4 v[56:59], v73, s[8:11], s77 offen offset:2048
 v_mov_b32 v76, s93
 s_waitcnt vmcnt(0)
 s_barrier
 buffer_store_dword v76, v77, s[8:11], s92 offen
 s_cmp_ge_u32 s61, s91
 s_cbranch_scc1 L_wo_done
 s_branch L_wo_idle
L_wo_sl:
 s_cmp_lg_u32 s58, 0
 s_cbranch_scc1 Lspd_55
 s_mov_b32 s62, 0
Lsp_54:
 buffer_load_dword v75, v74, s[8:11], 0 offen sc1
 s_waitcnt vmcnt(0)
 v_add_u32 v64, v65, v75
 v_cmp_gt_u32 vcc, s74, v64
 v_cmp_gt_u32 s[66:67], s75, v64
 s_cmp_eq_u32 s67, 0
 s_cselect_b32 s72, 2, 0
 s_cmp_eq_u32 vcc_lo, 0
 s_cselect_b32 s72, 1, s72
 v_mov_b32 v76, s72
 ds_write_b32 v72, v76 offset:4096
 s_cmp_lg_u32 s72, 0
 s_cbranch_scc1 Lspd_55
 s_add_u32 s62, s62, 1
 s_cmp_lt_u32 s62, 400000
 s_cbranch_scc1 Lsp_54
Lspd_55:
 s_waitcnt lgkmcnt(0)
 s_barrier
 ds_read_b32 v76, v73 offset:4096
 s_waitcnt lgkmcnt(0)
 v_readfirstlane_b32 s72, v76
 s_mov_b32 s63, 50
 s_cmp_eq_u32 s72, 0
 s_cbranch_scc1 L_abort_b
 s_sub_u32 s68, s72, 1
 s_cmp_eq_u32 s68, 0
 s_cselect_b32 s69, s74, s75
 s_cselect_b32 s63, s44, s47
 s_cselect_b32 s64, s45, s48
 s_cselect_b32 s80, s46, s49
 s_cmp_lt_u32 s69, s63
 s_cselect_b32 s80, s64, s80
 s_add_u32 s80, s80, s69
 s_cmp_eq_u32 s68, 0
 s_cselect_b32 s74, s80, s74
 s_cselect_b32 s75, s75, s80
 s_mul_i32 s73, s69, 262144
 s_mul_i32 s63, s68, 16777216
 s_add_u32 s73, s73, s63
 s_add_u32 s73, s73, s90
 s_mov_b32 m0, s70
 s_nop 0
 buffer_load_dwordx4 v72, s[8:11], s73 offen sc1 lds
 s_add_u32 m0, m0, s3
 s_add_u32 s73, s73, s3
 buffer_load_dwordx4 v72, s[8:11], s73 offen sc1 lds
 s_add_u32 m0, m0, s3
 s_add_u32 s73, s73, s3
 buffer_load_dwordx4 v72, s[8:11], s73 offen sc1 lds
 s_add_u32 m0, m0, s3
 s_add_u32 s73, s73, s3
 buffer_load_dwordx4 v72, s[8:11], s73 offen sc1 lds
 s_add_u32 m0, m0, s3
 s_add_u32 s73, s73, s3
 buffer_load_dwordx4 v72, s[8:11], s73 offen sc1 lds
 s_add_u32 m0, m0, s3
 s_add_u32 s73, s73, s3
 buffer_load_dwordx4 v72, s[8:11], s73 offen sc1 lds
 s_add_u32 m0, m0, s3
 s_add_u32 s73, s73, s3
 buffer_load_dwordx4 v72, s[8:11], s73 offen sc1 lds
 s_add_u32 m0, m0, s3
 s_add_u32 s73, s73, s3
 buffer_load_dwordx4 v72, s[8:11], s73 offen sc1 lds
 s_add_u32 m0, m0, s3
 s_add_u32 s73, s73, s3
 buffer_load_dwordx4 v72, s[8:11], s73 offen sc1 lds
 s_add_u32 m0, m0, s3
 s_add_u32 s73, s73, s3
 buffer_load_dwordx4 v72, s[8:11], s73 offen sc1 lds
 s_add_u32 m0, m0, s3
 s_add_u32 s73, s73, s3
 buffer_load_dwordx4 v72, s[8:11], s73 offen sc1 lds
 s_add_u32 m0, m0, s3
 s_add_u32 s73, s73, s3
 buffer_load_dwordx4 v72, s[8:11], s73 offen sc1 lds
 s_add_u32 m0, m0, s3
 s_add_u32 s73, s73, s3
 buffer_load_dwordx4 v72, s[8:11], s73 offen sc1 lds
 s_add_u32 m0, m0, s3
 s_add_u32 s73, s73, s3
 buffer_load_dwordx4 v72, s[8:11], s73 offen sc1 lds
 s_add_u32 m0, m0, s3
 s_add_u32 s73, s73, s3
 buffer_load_dwordx4 v72, s[8:11], s73 offen sc1 lds
 s_add_u32 m0, m0, s3
 s_add_u32 s73, s73, s3
 buffer_load_dwordx4 v72, s[8:11], s73 offen sc1 lds
 s_mov_b32 s5, s85
 s_sub_u32 s85, 0, s85
 s_add_u32 s70, s70, s85
 s_mov_b32 s81, s77
 s_mov_b32 s82, s78
 s_mov_b32 s83, s79
 s_mov_b32 s94, s92
 s_mov_b32 s95, s93
 s_mul_i32 s64, s68, 0
 s_add_u32 s64, s64, 4
 s_mul_i32 s63, s68, 0
 s_add_u32 s63, s63, 128
 s_mul_i32 s63, s69, s63
 s_lshr_b32 s63, s63, 9
 s_mul_i32 s63, s63, s64
 s_sub_u32 s63, s69, s63
 s_mul_i32 s63, s63, 294912
 s_mul_i32 s64, s68, 1179648
 s_add_u32 s63, s63, s64
 s_add_u32 s77, s63, s87
 s_add_u32 s78, s63, s88
 s_add_u32 s79, s63, s89
 s_mul_i32 s92, s68, 512
 s_sub_u32 s93, s80, 1
 s_min_u32 s93, s93, 64
 s_add_u32 s61, s61, 1
 v_add_u32 v70, s5, v70
 v_add_u32 v71, s5, v71
 s_waitcnt vmcnt(0)
 s_barrier
 ds_read_b128 v[24:27], v70 offset:0
 ds_read_b128 v[28:31], v70 offset:1024
 ds_read_b128 v[32:35], v70 offset:2048
 s_waitcnt lgkmcnt(2)
 v_mfma_f32_16x16x32_bf16 v[0:3], v[80:83], v[24:27], 0
 ds_read_b128 v[36:39], v70 offset:3072
 v_mfma_f32_16x16x32_bf16 v[4:7], v[84:87], v[24:27], 0
 v_mfma_f32_16x16x32_bf16 v[8:11], v[88:91], v[24:27], 0
 s_waitcnt lgkmcnt(2)
 v_mfma_f32_16x16x32_bf16 v[0:3], v[92:95], v[28:31], v[0:3]
 ds_read_b128 v[24:27], v70 offset:4096
 v_mfma_f32_16x16x32_bf16 v[4:7], v[96:99], v[28:31], v[4:7]
 v_mfma_f32_16x16x32_bf16 v[8:11], v[100:103], v[28:31], v[8:11]
 s_waitcnt lgkmcnt(2)
 v_mfma_f32_16x16x32_bf16 v[0:3], v[104:107], v[32:35], v[0:3]
 ds_read_b128 v[28:31], v70 offset:5120
 v_mfma_f32_16x16x32_bf16 v[4:7], v[108:111], v[32:35], v[4:7]
 v_mfma_f32_16x16x32_bf16 v[8:11], v[112:115], v[32:35], v[8:11]
 s_waitcnt lgkmcnt(2)
 v_mfma_f32_16x16x32_bf16 v[0:3], v[116:119], v[36:39], v[0:3]
 ds_read_b128 v[32:35], v70 offset:6144
 v_mfma_f32_16x16x32_bf16 v[4:7], v[120:123], v[36:39], v[4:7]
 v_mfma_f32_16x16x32_bf16 v[8:11], v[124:127], v[36:39], v[8:11]
 s_waitcnt lgkmcnt(2)
 v_mfma_f32_16x16x32_bf16 v[0:3], v[128:131], v[24:27], v[0:3]
 ds_read_b128 v[36:39], v70 offset:7168
 v_mfma_f32_16x16x32_bf16 v[4:7], v[132:135], v[24:27], v[4:7]
 v_mfma_f32_16x16x32_bf16 v[8:11], v[136:139], v[24:27], v[8:11]
 s_waitcnt lgkmcnt(2)
 v_mfma_f32_16x16x32_bf16 v[0:3], v[140:143], v[28:31], v[0:3]
 ds_read_b128 v[24:27], v70 offset:8192
 v_mfma_f32_16x16x32_bf16 v[4:7], v[144:147], v[28:31], v[4:7]
 v_mfma_f32_16x16x32_bf16 v[8:11], v[148:151], v[28:31], v[8:11]
 s_waitcnt lgkmcnt(2)
 v_mfma_f32_16x16x32_bf16 v[0:3], v[152:155], v[32:35], v[0:3]
 ds_read_b128 v[28:31], v70 offset:9216
 v_mfma_f32_16x16x32_bf16 v[4:7], v[156:159], v[32:35], v[4:7]
 v_mfma_f32_16x16x32_bf16 v[8:11], v[160:163], v[32:35], v[8:11]
 s_waitcnt lgkmcnt(2)
 v_mfma_f32_16x16x32_bf16 v[0:3], v[164:167], v[36:39], v[0:3]
 ds_read_b128 v[32:35], v70 offset:10240
 v_mfma_f32_16x16x32_bf16 v[4:7], v[168:171], v[36:39], v[4:7]
 v_mfma_f32_16x16x32_bf16 v[8:11], v[172:175], v[36:39], v[8:11]
 s_waitcnt lgkmcnt(2)
 v_mfma_f32_16x16x32_bf16 v[0:3], v[176:179], v[24:27], v[0:3]
 ds_read_b128 v[36:39], v70 offset:11264
 v_mfma_f32_16x16x32_bf16 v[4:7], v[180:183], v[24:27], v[4:7]
 v_mfma_f32_16x16x32_bf16 v[8:11], v[184:187], v[24:27], v[8:11]
 s_waitcnt lgkmcnt(2)
 v_mfma_f32_16x16x32_bf16 v[0:3], v[188:191], v[28:31], v[0:3]
 ds_read_b128 v[24:27], v70 offset:12288
 v_mfma_f32_16x16x32_bf16 v[4:7], v[192:195], v[28:31], v[4:7]
 v_mfma_f32_16x16x32_bf16 v[8:11], v[196:199], v[28:31], v[8:11]
 s_waitcnt lgkmcnt(2)
 v_mfma_f32_16x16x32_bf16 v[0:3], v[200:203], v[32:35], v[0:3]
 ds_read_b128 v[28:31], v70 offset:13312
 v_mfma_f32_16x16x32_bf16 v[4:7], v[204:207], v[32:35], v[4:7]
 v_mfma_f32_16x16x32_bf16 v[8:11], v[208:211], v[32:35], v[8:11]
 s_waitcnt lgkmcnt(2)
 v_mfma_f32_16x16x32_bf16 v[0:3], v[212:215], v[36:39], v[0:3]
 ds_read_b128 v[32:35], v70 offset:14336
 v_mfma_f32_16x16x32_bf16 v[4:7], v[216:219], v[36:39], v[4:7]
 v_mfma_f32_16x16x32_bf16 v[8:11], v[220:223], v[36:39], v[8:11]
 s_waitcnt lgkmcnt(2)
 v_mfma_f32_16x16x32_bf16 v[0:3], v[224:227], v[24:27], v[0:3]
 ds_read_b128 v[36:39], v70 offset:15360
 v_mfma_f32_16x16x32_bf16 v[4:7], v[228:231], v[24:27], v[4:7]
 v_mfma_f32_16x16x32_bf16 v[8:11], v[232:235], v[24:27], v[8:11]
 s_waitcnt lgkmcnt(2)
 v_mfma_f32_16x16x32_bf16 v[0:3], v[236:239], v[28:31], v[0:3]
 ds_read_b128 v[24:27], v70 offset:16384
 v_mfma_f32_16x16x32_bf16 v[4:7], v[240:243], v[28:31], v[4:7]
 v_mfma_f32_16x16x32_bf16 v[8:11], v[244:247], v[28:31], v[8:11]
 s_waitcnt lgkmcnt(2)
 v_mfma_f32_16x16x32_bf16 v[0:3], v[248:251], v[32:35], v[0:3]
 ds_read_b128 v[28:31], v70 offset:17408
 v_mfma_f32_16x16x32_bf16 v[4:7], v[252:255], v[32:35], v[4:7]
 v_mfma_f32_16x16x32_bf16 v[8:11], a[0:3], v[32:35], v[8:11]
 s_waitcnt lgkmcnt(2)
 v_mfma_f32_16x16x32_bf16 v[0:3], a[4:7], v[36:39], v[0:3]
 ds_read_b128 v[32:35], v70 offset:18432
 v_mfma_f32_16x16x32_bf16 v[4:7], a[8:11], v[36:39], v[4:7]
 v_mfma_f32_16x16x32_bf16 v[8:11], a[12:15], v[36:39], v[8:11]
 s_waitcnt lgkmcnt(2)
 v_mfma_f32_16x16x32_bf16 v[0:3], a[16:19], v[24:27], v[0:3]
 ds_read_b128 v[36:39], v70 offset:19456
 v_mfma_f32_16x16x32_bf16 v[4:7], a[20:23], v[24:27], v[4:7]
 v_mfma_f32_16x16x32_bf16 v[8:11], a[24:27], v[24:27], v[8:11]
 s_waitcnt lgkmcnt(2)
 v_mfma_f32_16x16x32_bf16 v[0:3], a[28:31], v[28:31], v[0:3]
 ds_read_b128 v[24:27], v70 offset:20480
 v_mfma_f32_16x16x32_bf16 v[4:7], a[32:35], v[28:31], v[4:7]
 v_mfma_f32_16x16x32_bf16 v[8:11], a[36:39], v[28:31], v[8:11]
 s_waitcnt lgkmcnt(2)
 v_mfma_f32_16x16x32_bf16 v[0:3], a[40:43], v[32:35], v[0:3]
 ds_read_b128 v[28:31], v70 offset:21504
 v_mfma_f32_16x16x32_bf16 v[4:7], a[44:47], v[32:35], v[4:7]
 v_mfma_f32_16x16x32_bf16 v[8:11], a[48:51], v[32:35], v[8:11]
 s_waitcnt lgkmcnt(2)
 v_mfma_f32_16x16x32_bf16 v[0:3], a[52:55], v[36:39], v[0:3]
 ds_read_b128 v[32:35], v70 offset:22528
 v_mfma_f32_16x16x32_bf16 v[4:7], a[56:59], v[36:39], v[4:7]
 v_mfma_f32_16x16x32_bf16 v[8:11], a[60:63], v[36:39], v[8:11]
 s_waitcnt lgkmcnt(2)
 v_mfma_f32_16x16x32_bf16 v[0:3], a[64:67], v[24:27], v[0:3]
 ds_read_b128 v[36:39], v70 offset:23552
 v_mfma_f32_16x16x32_bf16 v[4:7], a[68:71], v[24:27], v[4:7]
 v_mfma_f32_16x16x32_bf16 v[8:11], a[72:75], v[24:27], v[8:11]
 s_waitcnt lgkmcnt(2)
 v_mfma_f32_16x16x32_bf16 v[0:3], a[76:79], v[28:31], v[0:3]
 ds_read_b128 v[24:27], v70 offset:24576
 v_mfma_f32_16x16x32_bf16 v[4:7], a[80:83], v[28:31], v[4:7]
 v_mfma_f32_16x16x32_bf16 v[8:11], a[84:87], v[28:31], v[8:11]
 s_waitcnt lgkmcnt(2)
 v_mfma_f32_16x16x32_bf16 v[0:3], a[88:91], v[32:35], v[0:3]
 ds_read_b128 v[28:31], v70 offset:25600
 v_mfma_f32_16x16x32_bf16 v[4:7], a[92:95], v[32:35], v[4:7]
 v_mfma_f32_16x16x32_bf16 v[8:11], a[96:99], v[32:35], v[8:11]
 s_waitcnt lgkmcnt(2)
 v_mfma_f32_16x16x32_bf16 v[0:3], a[100:103], v[36:39], v[0:3]
 ds_read_b128 v[32:35], v70 offset:26624
 v_mfma_f32_16x16x32_bf16 v[4:7], a[104:107], v[36:39], v[4:7]
 v_mfma_f32_16x16x32_bf16 v[8:11], a[108:111], v[36:39], v[8:11]
 s_waitcnt lgkmcnt(2)
 v_mfma_f32_16x16x32_bf16 v[0:3], a[112:115], v[24:27], v[0:3]
 ds_read_b128 v[36:39], v70 offset:27648
 v_mfma_f32_16x16x32_bf16 v[4:7], a[116:119], v[24:27], v[4:7]
 v_mfma_f32_16x16x32_bf16 v[8:11], a[120:123], v[24:27], v[8:11]
 s_waitcnt lgkmcnt(2)
 v_mfma_f32_16x16x32_bf16 v[0:3], a[124:127], v[28:31], v[0:3]
 ds_read_b128 v[24:27], v70 offset:28672
 v_mfma_f32_16x16x32_bf16 v[4:7], a[128:131], v[28:31], v[4:7]
 v_mfma_f32_16x16x32_bf16 v[8:11], a[132:135], v[28:31], v[8:11]
 s_waitcnt lgkmcnt(2)
 v_mfma_f32_16x16x32_bf16 v[0:3], a[136:139], v[32:35], v[0:3]
 ds_read_b128 v[28:31], v70 offset:29696
 v_mfma_f32_16x16x32_bf16 v[4:7], a[140:143], v[32:35], v[4:7]
 v_mfma_f32_16x16x32_bf16 v[8:11], a[144:147], v[32:35], v[8:11]
 s_waitcnt lgkmcnt(2)
 v_mfma_f32_16x16x32_bf16 v[0:3], a[148:151], v[36:39], v[0:3]
 ds_read_b128 v[32:35], v70 offset:30720
 v_mfma_f32_16x16x32_bf16 v[4:7], a[152:155], v[36:39], v[4:7]
 v_mfma_f32_16x16x32_bf16 v[8:11], a[156:159], v[36:39], v[8:11]
 s_waitcnt lgkmcnt(2)
 v_mfma_f32_16x16x32_bf16 v[0:3], a[160:163], v[24:27], v[0:3]
 ds_read_b128 v[36:39], v70 offset:31744
 v_mfma_f32_16x16x32_bf16 v[4:7], a[164:167], v[24:27], v[4:7]
 v_mfma_f32_16x16x32_bf16 v[8:11], a[168:171], v[24:27], v[8:11]
 s_waitcnt lgkmcnt(2)
 v_mfma_f32_16x16x32_bf16 v[0:3], a[172:175], v[28:31], v[0:3]
 ds_read_b128 v[24:27], v71 offset:0
 v_mfma_f32_16x16x32_bf16 v[4:7], a[176:179], v[28:31], v[4:7]
 v_mfma_f32_16x16x32_bf16 v[8:11], a[180:183], v[28:31], v[8:11]
 s_waitcnt lgkmcnt(2)
 v_mfma_f32_16x16x32_bf16 v[0:3], a[184:187], v[32:35], v[0:3]
 ds_read_b128 v[28:31], v71 offset:1024
 v_mfma_f32_16x16x32_bf16 v[4:7], a[188:191], v[32:35], v[4:7]
 v_mfma_f32_16x16x32_bf16 v[8:11], a[192:195], v[32:35], v[8:11]
 s_waitcnt lgkmcnt(2)
 v_mfma_f32_16x16x32_bf16 v[0:3], a[196:199], v[36:39], v[0:3]
 ds_read_b128 v[32:35], v71 offset:2048
 v_mfma_f32_16x16x32_bf16 v[4:7], a[200:203], v[36:39], v[4:7]
 v_mfma_f32_16x16x32_bf16 v[8:11], a[204:207], v[36:39], v[8:11]
 s_waitcnt lgkmcnt(2)
 v_mfma_f32_16x16x32_bf16 v[12:15], v[80:83], v[24:27], 0
 ds_read_b128 v[36:39], v71 offset:3072
 v_mfma_f32_16x16x32_bf16 v[16:19], v[84:87], v[24:27], 0
 v_mfma_f32_16x16x32_bf16 v[20:23], v[88:91], v[24:27], 0
 s_waitcnt lgkmcnt(2)
 v_mfma_f32_16x16x32_bf16 v[12:15], v[92:95], v[28:31], v[12:15]
 ds_read_b128 v[24:27], v71 offset:4096
 v_mfma_f32_16x16x32_bf16 v[16:19], v[96:99], v[28:31], v[16:19]
 v_cvt_pk_bf16_f32 v48, v0, v1
 v_mfma_f32_16x16x32_bf16 v[20:23], v[100:103], v[28:31], v[20:23]
 v_cvt_pk_bf16_f32 v49, v2, v3
 s_waitcnt lgkmcnt(2)
 v_mfma_f32_16x16x32_bf16 v[12:15], v[104:107], v[32:35], v[12:15]
 ds_read_b128 v[28:31], v71 offset:5120
 v_cvt_pk_bf16_f32 v50, v4, v5
 v_mfma_f32_16x16x32_bf16 v[16:19], v[108:111], v[32:35], v[16:19]
 v_cvt_pk_bf16_f32 v51, v6, v7
 v_mfma_f32_16x16x32_bf16 v[20:23], v[112:115], v[32:35], v[20:23]
 buffer_store_dwordx4 v[48:51], v73, s[8:11], s77 offen offset:0 sc1
 v_cvt_pk_bf16_f32 v56, v8, v9
 s_waitcnt lgkmcnt(2)
 v_mfma_f32_16x16x32_bf16 v[12:15], v[116:119], v[36:39], v[12:15]
 ds_read_b128 v[32:35], v71 offset:6144
 v_cvt_pk_bf16_f32 v57, v10, v11
 v_mfma_f32_16x16x32_bf16 v[16:19], v[120:123], v[36:39], v[16:19]
 v_mfma_f32_16x16x32_bf16 v[20:23], v[124:127], v[36:39], v[20:23]
 s_waitcnt lgkmcnt(2)
 v_mfma_f32_16x16x32_bf16 v[12:15], v[128:131], v[24:27], v[12:15]
 ds_read_b128 v[36:39], v71 offset:7168
 v_mfma_f32_16x16x32_bf16 v[16:19], v[132:135], v[24:27], v[16:19]
 v_mfma_f32_16x16x32_bf16 v[20:23], v[136:139], v[24:27], v[20:23]
 s_waitcnt lgkmcnt(2)
 v_mfma_f32_16x16x32_bf16 v[12:15], v[140:143], v[28:31], v[12:15]
 ds_read_b128 v[24:27], v71 offset:8192
 v_mfma_f32_16x16x32_bf16 v[16:19], v[144:147], v[28:31], v[16:19]
 v_mfma_f32_16x16x32_bf16 v[20:23], v[148:151], v[28:31], v[20:23]
 s_waitcnt lgkmcnt(2)
 v_mfma_f32_16x16x32_bf16 v[12:15], v[152:155], v[32:35], v[12:15]
 ds_read_b128 v[28:31], v71 offset:9216
 v_mfma_f32_16x16x32_bf16 v[16:19], v[156:159], v[32:35], v[16:19]
 v_mfma_f32_16x16x32_bf16 v[20:23], v[160:163], v[32:35], v[20:23]
 s_waitcnt lgkmcnt(2)
 v_mfma_f32_16x16x32_bf16 v[12:15], v[164:167], v[36:39], v[12:15]
 ds_read_b128 v[32:35], v71 offset:10240
 v_mfma_f32_16x16x32_bf16 v[16:19], v[168:171], v[36:39], v[16:19]
 v_mfma_f32_16x16x32_bf16 v[20:23], v[172:175], v[36:39], v[20:23]
 s_waitcnt lgkmcnt(2)
 v_mfma_f32_16x16x32_bf16 v[12:15], v[176:179], v[24:27], v[12:15]
 ds_read_b128 v[36:39], v71 offset:11264
 v_mfma_f32_16x16x32_bf16 v[16:19], v[180:183], v[24:27], v[16:19]
 v_mfma_f32_16x16x32_bf16 v[20:23], v[184:187], v[24:27], v[20:23]
 s_waitcnt lgkmcnt(2)
 v_mfma_f32_16x16x32_bf16 v[12:15], v[188:191], v[28:31], v[12:15]
 ds_read_b128 v[24:27], v71 offset:12288
 v_mfma_f32_16x16x32_bf16 v[16:19], v[192:195], v[28:31], v[16:19]
 v_mfma_f32_16x16x32_bf16 v[20:23], v[196:199], v[28:31], v[20:23]
 s_waitcnt lgkmcnt(2)
 v_mfma_f32_16x16x32_bf16 v[12:15], v[200:203], v[32:35], v[12:15]
 ds_read_b128 v[28:31], v71 offset:13312
 v_mfma_f32_16x16x32_bf16 v[16:19], v[204:207], v[32:35], v[16:19]
 v_mfma_f32_16x16x32_bf16 v[20:23], v[208:211], v[32:35], v[20:23]
 s_waitcnt lgkmcnt(2)
 v_mfma_f32_16x16x32_bf16 v[12:15], v[212:215], v[36:39], v[12:15]
 ds_read_b128 v[32:35], v71 offset:14336
 v_mfma_f32_16x16x32_bf16 v[16:19], v[216:219], v[36:39], v[16:19]
 v_mfma_f32_16x16x32_bf16 v[20:23], v[220:223], v[36:39], v[20:23]
 s_waitcnt lgkmcnt(2)
 v_mfma_f32_16x16x32_bf16 v[12:15], v[224:227], v[24:27], v[12:15]
 ds_read_b128 v[36:39], v71 offset:15360
 v_mfma_f32_16x16x32_bf16 v[16:19], v[228:231], v[24:27], v[16:19]
 v_mfma_f32_16x16x32_bf16 v[20:23], v[232:235], v[24:27], v[20:23]
 s_waitcnt lgkmcnt(2)
 v_mfma_f32_16x16x32_bf16 v[12:15], v[236:239], v[28:31], v[12:15]
 ds_read_b128 v[24:27], v71 offset:16384
 v_mfma_f32_16x16x32_bf16 v[16:19], v[240:243], v[28:31], v[16:19]
 v_mfma_f32_16x16x32_bf16 v[20:23], v[244:247], v[28:31], v[20:23]
 s_waitcnt lgkmcnt(2)
 v_mfma_f32_16x16x32_bf16 v[12:15], v[248:251], v[32:35], v[12:15]
 ds_read_b128 v[28:31], v71 offset:17408
 v_mfma_f32_16x16x32_bf16 v[16:19], v[252:255], v[32:35], v[16:19]
 v_mfma_f32_16x16x32_bf16 v[20:23], a[0:3], v[32:35], v[20:23]
 s_waitcnt lgkmcnt(2)
 v_mfma_f32_16x16x32_bf16 v[12:15], a[4:7], v[36:39], v[12:15]
 ds_read_b128 v[32:35], v71 offset:18432
 v_mfma_f32_16x16x32_bf16 v[16:19], a[8:11], v[36:39], v[16:19]
 v_mfma_f32_16x16x32_bf16 v[20:23], a[12:15], v[36:39], v[20:23]
 s_waitcnt lgkmcnt(2)
 v_mfma_f32_16x16x32_bf16 v[12:15], a[16:19], v[24:27], v[12:15]
 ds_read_b128 v[36:39], v71 offset:19456
 v_mfma_f32_16x16x32_bf16 v[16:19], a[20:23], v[24:27], v[16:19]
 v_mfma_f32_16x16x32_bf16 v[20:23], a[24:27], v[24:27], v[20:23]
 s_waitcnt lgkmcnt(2)
 v_mfma_f32_16x16x32_bf16 v[12:15], a[28:31], v[28:31], v[12:15]
 ds_read_b128 v[24:27], v71 offset:20480
 v_mfma_f32_16x16x32_bf16 v[16:19], a[32:35], v[28:31], v[16:19]
 v_mfma_f32_16x16x32_bf16 v[20:23], a[36:39], v[28:31], v[20:23]
 s_waitcnt lgkmcnt(2)
 v_mfma_f32_16x16x32_bf16 v[12:15], a[40:43], v[32:35], v[12:15]
 ds_read_b128 v[28:31], v71 offset:21504
 v_mfma_f32_16x16x32_bf16 v[16:19], a[44:47], v[32:35], v[16:19]
 v_mfma_f32_16x16x32_bf16 v[20:23], a[48:51], v[32:35], v[20:23]
 s_waitcnt lgkmcnt(2)
 v_mfma_f32_16x16x32_bf16 v[12:15], a[52:55], v[36:39], v[12:15]
 ds_read_b128 v[32:35], v71 offset:22528
 v_mfma_f32_16x16x32_bf16 v[16:19], a[56:59], v[36:39], v[16:19]
 v_mfma_f32_16x16x32_bf16 v[20:23], a[60:63], v[36:39], v[20:23]
 s_waitcnt lgkmcnt(2)
 v_mfma_f32_16x16x32_bf16 v[12:15], a[64:67], v[24:27], v[12:15]
 ds_read_b128 v[36:39], v71 offset:23552
 v_mfma_f32_16x16x32_bf16 v[16:19], a[68:71], v[24:27], v[16:19]
 v_mfma_f32_16x16x32_bf16 v[20:23], a[72:75], v[24:27], v[20:23]
 s_waitcnt lgkmcnt(2)
 v_mfma_f32_16x16x32_bf16 v[12:15], a[76:79], v[28:31], v[12:15]
 ds_read_b128 v[24:27], v71 offset:24576
 v_mfma_f32_16x16x32_bf16 v[16:19], a[80:83], v[28:31], v[16:19]
 v_mfma_f32_16x16x32_bf16 v[20:23], a[84:87], v[28:31], v[20:23]
 s_waitcnt lgkmcnt(2)
 v_mfma_f32_16x16x32_bf16 v[12:15], a[88:91], v[32:35], v[12:15]
 ds_read_b128 v[28:31], v71 offset:25600
 v_mfma_f32_16x16x32_bf16 v[16:19], a[92:95], v[32:35], v[16:19]
 v_mfma_f32_16x16x32_bf16 v[20:23], a[96:99], v[32:35], v[20:23]
 s_waitcnt lgkmcnt(2)
 v_mfma_f32_16x16x32_bf16 v[12:15], a[100:103], v[36:39], v[12:15]
 ds_read_b128 v[32:35], v71 offset:26624
 v_mfma_f32_16x16x32_bf16 v[16:19], a[104:107], v[36:39], v[16:19]
 v_mfma_f32_16x16x32_bf16 v[20:23], a[108:111], v[36:39], v[20:23]
 s_waitcnt lgkmcnt(2)
 v_mfma_f32_16x16x32_bf16 v[12:15], a[112:115], v[24:27], v[12:15]
 ds_read_b128 v[36:39], v71 offset:27648
 v_mfma_f32_16x16x32_bf16 v[16:19], a[116:119], v[24:27], v[16:19]
 v_mfma_f32_16x16x32_bf16 v[20:23], a[120:123], v[24:27], v[20:23]
 s_waitcnt lgkmcnt(2)
 v_mfma_f32_16x16x32_bf16 v[12:15], a[124:127], v[28:31], v[12:15]
 ds_read_b128 v[24:27], v71 offset:28672
 v_mfma_f32_16x16x32_bf16 v[16:19], a[128:131], v[28:31], v[16:19]
 v_mfma_f32_16x16x32_bf16 v[20:23], a[132:135], v[28:31], v[20:23]
 s_waitcnt lgkmcnt(2)
 v_mfma_f32_16x16x32_bf16 v[12:15], a[136:139], v[32:35], v[12:15]
 ds_read_b128 v[28:31], v71 offset:29696
 v_mfma_f32_16x16x32_bf16 v[16:19], a[140:143], v[32:35], v[16:19]
 v_mfma_f32_16x16x32_bf16 v[20:23], a[144:147], v[32:35], v[20:23]
 s_waitcnt lgkmcnt(2)
 v_mfma_f32_16x16x32_bf16 v[12:15], a[148:151], v[36:39], v[12:15]
 ds_read_b128 v[32:35], v71 offset:30720
 v_mfma_f32_16x16x32_bf16 v[16:19], a[152:155], v[36:39], v[16:19]
 v_mfma_f32_16x16x32_bf16 v[20:23], a[156:159], v[36:39], v[20:23]
 s_waitcnt lgkmcnt(2)
 v_mfma_f32_16x16x32_bf16 v[12:15], a[160:163], v[24:27], v[12:15]
 ds_read_b128 v[36:39], v71 offset:31744
 v_mfma_f32_16x16x32_bf16 v[16:19], a[164:167], v[24:27], v[16:19]
 v_mfma_f32_16x16x32_bf16 v[20:23], a[168:171], v[24:27], v[20:23]
 s_waitcnt lgkmcnt(2)
 v_mfma_f32_16x16x32_bf16 v[12:15], a[172:175], v[28:31], v[12:15]
 v_mfma_f32_16x16x32_bf16 v[16:19], a[176:179], v[28:31], v[16:19]
 v_mfma_f32_16x16x32_bf16 v[20:23], a[180:183], v[28:31], v[20:23]
 s_waitcnt lgkmcnt(1)
 v_mfma_f32_16x16x32_bf16 v[12:15], a[184:187], v[32:35], v[12:15]
 v_mfma_f32_16x16x32_bf16 v[16:19], a[188:191], v[32:35], v[16:19]
 v_mfma_f32_16x16x32_bf16 v[20:23], a[192:195], v[32:35], v[20:23]
 s_waitcnt lgkmcnt(0)
 v_mfma_f32_16x16x32_bf16 v[12:15], a[196:199], v[36:39], v[12:15]
 v_mfma_f32_16x16x32_bf16 v[16:19], a[200:203], v[36:39], v[16:19]
 v_mfma_f32_16x16x32_bf16 v[20:23], a[204:207], v[36:39], v[20:23]
 s_nop 7
 v_cvt_pk_bf16_f32 v58, v20, v21
 v_cvt_pk_bf16_f32 v59, v22, v23
 v_cvt_pk_bf16_f32 v52, v12, v13
 v_cvt_pk_bf16_f32 v53, v14, v15
 v_cvt_pk_bf16_f32 v54, v16, v17
 v_cvt_pk_bf16_f32 v55, v18, v19
 buffer_store_dwordx4 v[52:55], v73, s[8:11], s77 offen offset:1024 sc1
 v_permlane32_swap_b32 v56, v58
 v_permlane32_swap_b32 v57, v59
 buffer_store_dwordx4 v[56:59], v73, s[8:11], s77 offen offset:2048 sc1
 v_mov_b32 v76, s93
 s_waitcnt vmcnt(0)
 s_barrier
 buffer_store_dword v76, v77, s[8:11], s92 offen sc1
 s_cmp_ge_u32 s61, s91
 s_cbranch_scc1 L_wo_done
 s_branch L_wo_sl
L_wo_done:
 s_waitcnt vmcnt(0) lgkmcnt(0)
 s_endpgm
L_dn:
 s_cmp_lg_u32 s7, 0
 s_cbranch_scc1 Ld1_56
 v_mbcnt_lo_u32_b32 v1, -1, 0
 v_mbcnt_hi_u32_b32 v1, -1, v1
 s_mov_b32 s63, 104
 s_add_u32 s63, s63, s57
 s_lshl_b32 s63, s63, 2
 s_add_u32 s63, s63, s58
 s_lshl_b32 s63, s63, 10
 v_lshl_add_u32 v10, v1, 4, s63
 s_lshl_b32 s64, s58, 10
 s_mov_b32 m0, s64
 s_mov_b32 s65, 0
 buffer_load_dwordx4 v10, s[32:35], s65 offen lds
 buffer_load_dwordx4 v10, s[28:31], s65 offen lds
 s_mov_b32 s65, 524288
 buffer_load_dwordx4 v10, s[32:35], s65 offen lds
 buffer_load_dwordx4 v10, s[28:31], s65 offen lds
 s_mov_b32 s65, 1048576
 buffer_load_dwordx4 v10, s[32:35], s65 offen lds
 buffer_load_dwordx4 v10, s[28:31], s65 offen lds
 s_mov_b32 s65, 1572864
 buffer_load_dwordx4 v10, s[32:35], s65 offen lds
 buffer_load_dwordx4 v10, s[28:31], s65 offen lds
 s_cmp_lg_u32 s7, 0
 s_cbranch_scc1 Lln_57
 s_waitcnt vmcnt(11)
 v_lshlrev_b32 v52, 16, v40
 v_and_b32 v53, 0xffff0000, v40
 v_lshlrev_b32 v54, 16, v41
 v_and_b32 v55, 0xffff0000, v41
 v_lshlrev_b32 v56, 16, v42
 v_and_b32 v57, 0xffff0000, v42
 v_lshlrev_b32 v58, 16, v43
 v_and_b32 v59, 0xffff0000, v43
 v_lshlrev_b32 v60, 16, v44
 v_and_b32 v61, 0xffff0000, v44
 v_lshlrev_b32 v62, 16, v45
 v_and_b32 v63, 0xffff0000, v45
 v_lshlrev_b32 v64, 16, v46
 v_and_b32 v65, 0xffff0000, v46
 v_lshlrev_b32 v66, 16, v47
 v_and_b32 v67, 0xffff0000, v47
 v_lshlrev_b32 v68, 16, v48
 v_and_b32 v69, 0xffff0000, v48
 v_lshlrev_b32 v70, 16, v49
 v_and_b32 v71, 0xffff0000, v49
 v_lshlrev_b32 v72, 16, v50
 v_and_b32 v73, 0xffff0000, v50
 v_lshlrev_b32 v74, 16, v51
 v_and_b32 v75, 0xffff0000, v51
 v_pk_add_f32 v[20:21], v[52:53], v[54:55]
 v_pk_add_f32 v[20:21], v[20:21], v[56:57]
 v_pk_add_f32 v[20:21], v[20:21], v[58:59]
 v_pk_add_f32 v[20:21], v[20:21], v[60:61]
 v_pk_add_f32 v[20:21], v[20:21], v[62:63]
 v_pk_add_f32 v[20:21], v[20:21], v[64:65]
 v_pk_add_f32 v[20:21], v[20:21], v[66:67]
 v_pk_add_f32 v[20:21], v[20:21], v[68:69]
 v_pk_add_f32 v[20:21], v[20:21], v[70:71]
 v_pk_add_f32 v[20:21], v[20:21], v[72:73]
 v_pk_add_f32 v[20:21], v[20:21], v[74:75]
 v_add_f32 v20, v20, v21
 s_nop 1
 v_add_f32_dpp v20, v20, v20 quad_perm:[1,0,3,2] row_mask:0xf bank_mask:0xf
 s_nop 1
 v_add_f32_dpp v20, v20, v20 quad_perm:[2,3,0,1] row_mask:0xf bank_mask:0xf
 s_nop 1
 v_add_f32_dpp v20, v20, v20 row_half_mirror row_mask:0xf bank_mask:0xf
 s_nop 1
 v_add_f32_dpp v20, v20, v20 row_mirror row_mask:0xf bank_mask:0xf
 v_mov_b32 v21, v20
 s_nop 1
 v_permlane16_swap_b32 v20, v21
 v_add_f32 v20, v20, v21
 v_mul_f32 v20, v78, v20
 v_pk_add_f32 v[52:53], v[52:53], v[20:21] op_sel_hi:[1,0]
 v_pk_add_f32 v[54:55], v[54:55], v[20:21] op_sel_hi:[1,0]
 v_pk_add_f32 v[56:57], v[56:57], v[20:21] op_sel_hi:[1,0]
 v_pk_add_f32 v[58:59], v[58:59], v[20:21] op_sel_hi:[1,0]
 v_pk_add_f32 v[60:61], v[60:61], v[20:21] op_sel_hi:[1,0]
 v_pk_add_f32 v[62:63], v[62:63], v[20:21] op_sel_hi:[1,0]
 v_pk_add_f32 v[64:65], v[64:65], v[20:21] op_sel_hi:[1,0]
 v_pk_add_f32 v[66:67], v[66:67], v[20:21] op_sel_hi:[1,0]
 v_pk_add_f32 v[68:69], v[68:69], v[20:21] op_sel_hi:[1,0]
 v_pk_add_f32 v[70:71], v[70:71], v[20:21] op_sel_hi:[1,0]
 v_pk_add_f32 v[72:73], v[72:73], v[20:21] op_sel_hi:[1,0]
 v_pk_add_f32 v[74:75], v[74:75], v[20:21] op_sel_hi:[1,0]
 v_pk_mul_f32 v[22:23], v[52:53], v[52:53]
 v_pk_fma_f32 v[22:23], v[54:55], v[54:55], v[22:23]
 v_pk_fma_f32 v[22:23], v[56:57], v[56:57], v[22:23]
 v_pk_fma_f32 v[22:23], v[58:59], v[58:59], v[22:23]
 v_pk_fma_f32 v[22:23], v[60:61], v[60:61], v[22:23]
 v_pk_fma_f32 v[22:23], v[62:63], v[62:63], v[22:23]
 v_pk_fma_f32 v[22:23], v[64:65], v[64:65], v[22:23]
 v_pk_fma_f32 v[22:23], v[66:67], v[66:67], v[22:23]
 v_pk_fma_f32 v[22:23], v[68:69], v[68:69], v[22:23]
 v_pk_fma_f32 v[22:23], v[70:71], v[70:71], v[22:23]
 v_pk_fma_f32 v[22:23], v[72:73], v[72:73], v[22:23]
 v_pk_fma_f32 v[22:23], v[74:75], v[74:75], v[22:23]
 v_add_f32 v22, v22, v23
 s_nop 1
 v_add_f32_dpp v22, v22, v22 quad_perm:[1,0,3,2] row_mask:0xf bank_mask:0xf
 s_nop 1
 v_add_f32_dpp v22, v22, v22 quad_perm:[2,3,0,1] row_mask:0xf bank_mask:0xf
 s_nop 1
 v_add_f32_dpp v22, v22, v22 row_half_mirror row_mask:0xf bank_mask:0xf
 s_nop 1
 v_add_f32_dpp v22, v22, v22 row_mirror row_mask:0xf bank_mask:0xf
 v_mov_b32 v23, v22
 s_nop 1
 v_permlane16_swap_b32 v22, v23
 v_add_f32 v22, v22, v23
 v_mov_b32 v23, 0x3727c5ac
 v_fmac_f32 v23, 0x3ae38e39, v22
 v_rsq_f32 v22, v23
 v_sub_f32 v20, 0, v20
 v_mul_f32 v21, v23, v22
 v_lshrrev_b32 v76, 2, v0
 v_and_b32 v78, 31, v0
 v_cmp_eq_u32 vcc, 0, v78
 v_mov_b32 v78, 2147483632
 s_lshl_b32 s63, s2, 6
 v_cndmask_b32 v76, v78, v76, vcc
 s_add_u32 s63, s63, 12582912
 buffer_store_dwordx2 v[20:21], v76, s[8:11], s63 offen sc1
 s_add_u32 s63, s3, 3145728
 v_pk_mul_f32 v[52:53], v[52:53], v[22:23] op_sel_hi:[1,0]
 v_pk_mul_f32 v[54:55], v[54:55], v[22:23] op_sel_hi:[1,0]
 v_pk_mul_f32 v[56:57], v[56:57], v[22:23] op_sel_hi:[1,0]
 v_pk_mul_f32 v[58:59], v[58:59], v[22:23] op_sel_hi:[1,0]
 v_pk_mul_f32 v[60:61], v[60:61], v[22:23] op_sel_hi:[1,0]
 v_pk_mul_f32 v[62:63], v[62:63], v[22:23] op_sel_hi:[1,0]
 v_pk_mul_f32 v[64:65], v[64:65], v[22:23] op_sel_hi:[1,0]
 v_pk_mul_f32 v[66:67], v[66:67], v[22:23] op_sel_hi:[1,0]
 v_pk_mul_f32 v[68:69], v[68:69], v[22:23] op_sel_hi:[1,0]
 v_pk_mul_f32 v[70:71], v[70:71], v[22:23] op_sel_hi:[1,0]
 v_pk_mul_f32 v[72:73], v[72:73], v[22:23] op_sel_hi:[1,0]
 v_pk_mul_f32 v[74:75], v[74:75], v[22:23] op_sel_hi:[1,0]
 v_cvt_pk_bf16_f32 v40, v52, v53
 v_cvt_pk_bf16_f32 v41, v54, v55
 v_cvt_pk_bf16_f32 v42, v56, v57
 v_cvt_pk_bf16_f32 v43, v58, v59
 v_cvt_pk_bf16_f32 v44, v60, v61
 v_cvt_pk_bf16_f32 v45, v62, v63
 v_cvt_pk_bf16_f32 v46, v64, v65
 v_cvt_pk_bf16_f32 v47, v66, v67
 v_cvt_pk_bf16_f32 v48, v68, v69
 v_cvt_pk_bf16_f32 v49, v70, v71
 v_cvt_pk_bf16_f32 v50, v72, v73
 v_cvt_pk_bf16_f32 v51, v74, v75
 buffer_store_dwordx4 v[40:43], v77, s[8:11], s63 offen offset:0 sc1
 buffer_store_dwordx4 v[44:47], v77, s[8:11], s63 offen offset:384 sc1
 buffer_store_dwordx4 v[48:51], v77, s[8:11], s63 offen offset:768 sc1
Lln_57:
 s_mov_b32 s65, 2097152
 buffer_load_dwordx4 v10, s[32:35], s65 offen lds
 buffer_load_dwordx4 v10, s[28:31], s65 offen lds
 s_mov_b32 s65, 2621440
 buffer_load_dwordx4 v10, s[32:35], s65 offen lds
 buffer_load_dwordx4 v10, s[28:31], s65 offen lds
 s_mov_b32 s65, 3145728
 buffer_load_dwordx4 v10, s[32:35], s65 offen lds
 buffer_load_dwordx4 v10, s[28:31], s65 offen lds
 s_waitcnt vmcnt(6)
 s_cmp_lg_u32 s7, 0
 s_cbranch_scc1 Lar_58
 s_or_b32 s63, s6, 0x80
 v_mov_b32 v20, s63
 s_barrier
 buffer_store_byte v20, v79, s[20:23], 0 offen sc1
Lar_58:
 s_mov_b32 s65, 3670016
 buffer_load_dwordx4 v10, s[32:35], s65 offen lds
 buffer_load_dwordx4 v10, s[28:31], s65 offen lds
 s_mov_b32 s65, 4194304
 buffer_load_dwordx4 v10, s[32:35], s65 offen lds
 buffer_load_dwordx4 v10, s[28:31], s65 offen lds
 s_mov_b32 s65, 0
 buffer_load_dwordx4 v10, s[36:39], s65 offen lds
 buffer_load_dwordx4 v10, s[40:43], s65 offen lds
 s_mov_b32 s65, 524288
 buffer_load_dwordx4 v10, s[36:39], s65 offen lds
 buffer_load_dwordx4 v10, s[40:43], s65 offen lds
 s_mov_b32 s65, 1048576
 buffer_load_dwordx4 v10, s[36:39], s65 offen lds
 buffer_load_dwordx4 v10, s[40:43], s65 offen lds
 s_mov_b32 s65, 1572864
 buffer_load_dwordx4 v10, s[36:39], s65 offen lds
 buffer_load_dwordx4 v10, s[40:43], s65 offen lds
 s_mov_b32 s65, 2097152
 buffer_load_dwordx4 v10, s[36:39], s65 offen lds
 buffer_load_dwordx4 v10, s[40:43], s65 offen lds
 s_mov_b32 s65, 2621440
 buffer_load_dwordx4 v10, s[36:39], s65 offen lds
 buffer_load_dwordx4 v10, s[40:43], s65 offen lds
 s_mov_b32 s65, 3145728
 buffer_load_dwordx4 v10, s[36:39], s65 offen lds
 buffer_load_dwordx4 v10, s[40:43], s65 offen lds
 s_mov_b32 s65, 3670016
 buffer_load_dwordx4 v10, s[36:39], s65 offen lds
 buffer_load_dwordx4 v10, s[40:43], s65 offen lds
 s_mov_b32 s65, 4194304
 buffer_load_dwordx4 v10, s[36:39], s65 offen lds
 buffer_load_dwordx4 v10, s[40:43], s65 offen lds
 s_waitcnt vmcnt(0)
 s_mov_b32 s7, 2
 s_barrier
Ld1_56:
 s_mul_i32 s86, s57, 86
 s_lshr_b32 s86, s86, 8
 s_mul_i32 s63, s86, 3
 s_sub_u32 s80, s57, s63
 s_lshr_b32 s81, s86, 2
 s_and_b32 s86, s86, 3
 v_mbcnt_lo_u32_b32 v1, -1, 0
 v_mbcnt_hi_u32_b32 v1, -1, v1
 v_add_u32 v2, 0, v1
 v_mul_u32_u24 v3, 10923, v2
 v_lshrrev_b32 v3, 16, v3
 v_mul_u32_u24 v4, 6, v3
 v_sub_u32 v4, v2, v4
 v_mul_u32_u24 v3, 1152, v3
 v_lshl_add_u32 v10, v4, 4, v3
 v_add_u32 v2, 64, v1
 v_mul_u32_u24 v3, 10923, v2
 v_lshrrev_b32 v3, 16, v3
 v_mul_u32_u24 v4, 6, v3
 v_sub_u32 v4, v2, v4
 v_mul_u32_u24 v3, 1152, v3
 v_lshl_add_u32 v11, v4, 4, v3
 v_add_u32 v2, 128, v1
 v_mul_u32_u24 v3, 10923, v2
 v_lshrrev_b32 v3, 16, v3
 v_mul_u32_u24 v4, 6, v3
 v_sub_u32 v4, v2, v4
 v_mul_u32_u24 v3, 1152, v3
 v_lshl_add_u32 v12, v4, 4, v3
 v_lshrrev_b32 v2, 4, v1
 v_bfe_u32 v3, v1, 2, 2
 v_lshl_add_u32 v2, v2, 3, v3
 v_mul_u32_u24 v2, 96, v2
 s_mul_i32 s67, s58, 36864
 v_add_u32 v2, s67, v2
 v_and_b32 v3, 3, v1
 v_lshl_add_u32 v13, v3, 4, v2
 v_and_b32 v3, 1, v1
 v_lshl_add_u32 v2, v3, 4, v2
 v_bfe_u32 v3, v1, 1, 1
 v_lshl_add_u32 v14, v3, 3, v2
 s_mul_i32 s71, s80, 384
 s_mul_i32 s63, s58, 96
 s_add_u32 s71, s71, s63
 s_mul_i32 s65, s86, 1327104
 s_add_u32 s65, s65, s71
 s_cmp_lg_u32 s7, 0
 s_cbranch_scc1 Lln_59
 s_waitcnt vmcnt(3)
 v_lshlrev_b32 v52, 16, v40
 v_and_b32 v53, 0xffff0000, v40
 v_lshlrev_b32 v54, 16, v41
 v_and_b32 v55, 0xffff0000, v41
 v_lshlrev_b32 v56, 16, v42
 v_and_b32 v57, 0xffff0000, v42
 v_lshlrev_b32 v58, 16, v43
 v_and_b32 v59, 0xffff0000, v43
 v_lshlrev_b32 v60, 16, v44
 v_and_b32 v61, 0xffff0000, v44
 v_lshlrev_b32 v62, 16, v45
 v_and_b32 v63, 0xffff0000, v45
 v_lshlrev_b32 v64, 16, v46
 v_and_b32 v65, 0xffff0000, v46
 v_lshlrev_b32 v66, 16, v47
 v_and_b32 v67, 0xffff0000, v47
 v_lshlrev_b32 v68, 16, v48
 v_and_b32 v69, 0xffff0000, v48
 v_lshlrev_b32 v70, 16, v49
 v_and_b32 v71, 0xffff0000, v49
 v_lshlrev_b32 v72, 16, v50
 v_and_b32 v73, 0xffff0000, v50
 v_lshlrev_b32 v74, 16, v51
 v_and_b32 v75, 0xffff0000, v51
 v_pk_add_f32 v[20:21], v[52:53], v[54:55]
 v_pk_add_f32 v[20:21], v[20:21], v[56:57]
 v_pk_add_f32 v[20:21], v[20:21], v[58:59]
 v_pk_add_f32 v[20:21], v[20:21], v[60:61]
 v_pk_add_f32 v[20:21], v[20:21], v[62:63]
 v_pk_add_f32 v[20:21], v[20:21], v[64:65]
 v_pk_add_f32 v[20:21], v[20:21], v[66:67]
 v_pk_add_f32 v[20:21], v[20:21], v[68:69]
 v_pk_add_f32 v[20:21], v[20:21], v[70:71]
 v_pk_add_f32 v[20:21], v[20:21], v[72:73]
 v_pk_add_f32 v[20:21], v[20:21], v[74:75]
 v_add_f32 v20, v20, v21
 s_nop 1
 v_add_f32_dpp v20, v20, v20 quad_perm:[1,0,3,2] row_mask:0xf bank_mask:0xf
 s_nop 1
 v_add_f32_dpp v20, v20, v20 quad_perm:[2,3,0,1] row_mask:0xf bank_mask:0xf
 s_nop 1
 v_add_f32_dpp v20, v20, v20 row_half_mirror row_mask:0xf bank_mask:0xf
 s_nop 1
 v_add_f32_dpp v20, v20, v20 row_mirror row_mask:0xf bank_mask:0xf
 v_mov_b32 v21, v20
 s_nop 1
 v_permlane16_swap_b32 v20, v21
 v_add_f32 v20, v20, v21
 v_mul_f32 v20, v78, v20
 v_pk_add_f32 v[52:53], v[52:53], v[20:21] op_sel_hi:[1,0]
 v_pk_add_f32 v[54:55], v[54:55], v[20:21] op_sel_hi:[1,0]
 v_pk_add_f32 v[56:57], v[56:57], v[20:21] op_sel_hi:[1,0]
 v_pk_add_f32 v[58:59], v[58:59], v[20:21] op_sel_hi:[1,0]
 v_pk_add_f32 v[60:61], v[60:61], v[20:21] op_sel_hi:[1,0]
 v_pk_add_f32 v[62:63], v[62:63], v[20:21] op_sel_hi:[1,0]
 v_pk_add_f32 v[64:65], v[64:65], v[20:21] op_sel_hi:[1,0]
 v_pk_add_f32 v[66:67], v[66:67], v[20:21] op_sel_hi:[1,0]
 v_pk_add_f32 v[68:69], v[68:69], v[20:21] op_sel_hi:[1,0]
 v_pk_add_f32 v[70:71], v[70:71], v[20:21] op_sel_hi:[1,0]
 v_pk_add_f32 v[72:73], v[72:73], v[20:21] op_sel_hi:[1,0]
 v_pk_add_f32 v[74:75], v[74:75], v[20:21] op_sel_hi:[1,0]
 v_pk_mul_f32 v[22:23], v[52:53], v[52:53]
 v_pk_fma_f32 v[22:23], v[54:55], v[54:55], v[22:23]
 v_pk_fma_f32 v[22:23], v[56:57], v[56:57], v[22:23]
 v_pk_fma_f32 v[22:23], v[58:59], v[58:59], v[22:23]
 v_pk_fma_f32 v[22:23], v[60:61], v[60:61], v[22:23]
 v_pk_fma_f32 v[22:23], v[62:63], v[62:63], v[22:23]
 v_pk_fma_f32 v[22:23], v[64:65], v[64:65], v[22:23]
 v_pk_fma_f32 v[22:23], v[66:67], v[66:67], v[22:23]
 v_pk_fma_f32 v[22:23], v[68:69], v[68:69], v[22:23]
 v_pk_fma_f32 v[22:23], v[70:71], v[70:71], v[22:23]
 v_pk_fma_f32 v[22:23], v[72:73], v[72:73], v[22:23]
 v_pk_fma_f32 v[22:23], v[74:75], v[74:75], v[22:23]
 v_add_f32 v22, v22, v23
 s_nop 1
 v_add_f32_dpp v22, v22, v22 quad_perm:[1,0,3,2] row_mask:0xf bank_mask:0xf
 s_nop 1
 v_add_f32_dpp v22, v22, v22 quad_perm:[2,3,0,1] row_mask:0xf bank_mask:0xf
 s_nop 1
 v_add_f32_dpp v22, v22, v22 row_half_mirror row_mask:0xf bank_mask:0xf
 s_nop 1
 v_add_f32_dpp v22, v22, v22 row_mirror row_mask:0xf bank_mask:0xf
 v_mov_b32 v23, v22
 s_nop 1
 v_permlane16_swap_b32 v22, v23
 v_add_f32 v22, v22, v23
 v_mov_b32 v23, 0x3727c5ac
 v_fmac_f32 v23, 0x3ae38e39, v22
 v_rsq_f32 v22, v23
 v_sub_f32 v20, 0, v20
 v_mul_f32 v21, v23, v22
 v_lshrrev_b32 v76, 2, v0
 v_and_b32 v78, 31, v0
 v_cmp_eq_u32 vcc, 0, v78
 v_mov_b32 v78, 2147483632
 s_lshl_b32 s63, s2, 6
 v_cndmask_b32 v76, v78, v76, vcc
 s_add_u32 s63, s63, 12582912
 buffer_store_dwordx2 v[20:21], v76, s[8:11], s63 offen sc1
 s_add_u32 s63, s3, 3145728
 v_pk_mul_f32 v[52:53], v[52:53], v[22:23] op_sel_hi:[1,0]
 v_pk_mul_f32 v[54:55], v[54:55], v[22:23] op_sel_hi:[1,0]
 v_pk_mul_f32 v[56:57], v[56:57], v[22:23] op_sel_hi:[1,0]
 v_pk_mul_f32 v[58:59], v[58:59], v[22:23] op_sel_hi:[1,0]
 v_pk_mul_f32 v[60:61], v[60:61], v[22:23] op_sel_hi:[1,0]
 v_pk_mul_f32 v[62:63], v[62:63], v[22:23] op_sel_hi:[1,0]
 v_pk_mul_f32 v[64:65], v[64:65], v[22:23] op_sel_hi:[1,0]
 v_pk_mul_f32 v[66:67], v[66:67], v[22:23] op_sel_hi:[1,0]
 v_pk_mul_f32 v[68:69], v[68:69], v[22:23] op_sel_hi:[1,0]
 v_pk_mul_f32 v[70:71], v[70:71], v[22:23] op_sel_hi:[1,0]
 v_pk_mul_f32 v[72:73], v[72:73], v[22:23] op_sel_hi:[1,0]
 v_pk_mul_f32 v[74:75], v[74:75], v[22:23] op_sel_hi:[1,0]
 v_cvt_pk_bf16_f32 v40, v52, v53
 v_cvt_pk_bf16_f32 v41, v54, v55
 v_cvt_pk_bf16_f32 v42, v56, v57
 v_cvt_pk_bf16_f32 v43, v58, v59
 v_cvt_pk_bf16_f32 v44, v60, v61
 v_cvt_pk_bf16_f32 v45, v62, v63
 v_cvt_pk_bf16_f32 v46, v64, v65
 v_cvt_pk_bf16_f32 v47, v66, v67
 v_cvt_pk_bf16_f32 v48, v68, v69
 v_cvt_pk_bf16_f32 v49, v70, v71
 v_cvt_pk_bf16_f32 v50, v72, v73
 v_cvt_pk_bf16_f32 v51, v74, v75
 buffer_store_dwordx4 v[40:43], v77, s[8:11], s63 offen offset:0 sc1
 buffer_store_dwordx4 v[44:47], v77, s[8:11], s63 offen offset:384 sc1
 buffer_store_dwordx4 v[48:51], v77, s[8:11], s63 offen offset:768 sc1
Lln_59:
 s_add_u32 s69, s65, 0
 s_add_u32 m0, s67, 0
 s_nop 0
 buffer_load_dwordx4 v10, s[52:55], s69 offen lds
 s_add_u32 m0, s67, 1024
 s_nop 0
 buffer_load_dwordx4 v11, s[52:55], s69 offen lds
 s_add_u32 m0, s67, 2048
 s_nop 0
 buffer_load_dwordx4 v12, s[52:55], s69 offen lds
 s_waitcnt vmcnt(3)
 s_cmp_lg_u32 s7, 0
 s_cbranch_scc1 Lar_60
 s_or_b32 s63, s6, 0x80
 v_mov_b32 v20, s63
 s_barrier
 buffer_store_byte v20, v79, s[20:23], 0 offen sc1
Lar_60:
 s_add_u32 s69, s65, 36864
 s_add_u32 m0, s67, 3072
 s_nop 0
 buffer_load_dwordx4 v10, s[52:55], s69 offen lds
 s_add_u32 m0, s67, 4096
 s_nop 0
 buffer_load_dwordx4 v11, s[52:55], s69 offen lds
 s_add_u32 m0, s67, 5120
 s_nop 0
 buffer_load_dwordx4 v12, s[52:55], s69 offen lds
 s_add_u32 s69, s65, 73728
 s_add_u32 m0, s67, 6144
 s_nop 0
 buffer_load_dwordx4 v10, s[52:55], s69 offen lds
 s_add_u32 m0, s67, 7168
 s_nop 0
 buffer_load_dwordx4 v11, s[52:55], s69 offen lds
 s_add_u32 m0, s67, 8192
 s_nop 0
 buffer_load_dwordx4 v12, s[52:55], s69 offen lds
 s_add_u32 s69, s65, 110592
 s_add_u32 m0, s67, 9216
 s_nop 0
 buffer_load_dwordx4 v10, s[52:55], s69 offen lds
 s_add_u32 m0, s67, 10240
 s_nop 0
 buffer_load_dwordx4 v11, s[52:55], s69 offen lds
 s_add_u32 m0, s67, 11264
 s_nop 0
 buffer_load_dwordx4 v12, s[52:55], s69 offen lds
 s_add_u32 s69, s65, 147456
 s_add_u32 m0, s67, 12288
 s_nop 0
 buffer_load_dwordx4 v10, s[52:55], s69 offen lds
 s_add_u32 m0, s67, 13312
 s_nop 0
 buffer_load_dwordx4 v11, s[52:55], s69 offen lds
 s_add_u32 m0, s67, 14336
 s_nop 0
 buffer_load_dwordx4 v12, s[52:55], s69 offen lds
 s_add_u32 s69, s65, 184320
 s_add_u32 m0, s67, 15360
 s_nop 0
 buffer_load_dwordx4 v10, s[52:55], s69 offen lds
 s_add_u32 m0, s67, 16384
 s_nop 0
 buffer_load_dwordx4 v11, s[52:55], s69 offen lds
 s_add_u32 m0, s67, 17408
 s_nop 0
 buffer_load_dwordx4 v12, s[52:55], s69 offen lds
 s_add_u32 s69, s65, 221184
 s_add_u32 m0, s67, 18432
 s_nop 0
 buffer_load_dwordx4 v10, s[52:55], s69 offen lds
 s_add_u32 m0, s67, 19456
 s_nop 0
 buffer_load_dwordx4 v11, s[52:55], s69 offen lds
 s_add_u32 m0, s67, 20480
 s_nop 0
 buffer_load_dwordx4 v12, s[52:55], s69 offen lds
 s_add_u32 s69, s65, 258048
 s_add_u32 m0, s67, 21504
 s_nop 0
 buffer_load_dwordx4 v10, s[52:55], s69 offen lds
 s_add_u32 m0, s67, 22528
 s_nop 0
 buffer_load_dwordx4 v11, s[52:55], s69 offen lds
 s_add_u32 m0, s67, 23552
 s_nop 0
 buffer_load_dwordx4 v12, s[52:55], s69 offen lds
 s_add_u32 s69, s65, 294912
 s_add_u32 m0, s67, 24576
 s_nop 0
 buffer_load_dwordx4 v10, s[52:55], s69 offen lds
 s_add_u32 m0, s67, 25600
 s_nop 0
 buffer_load_dwordx4 v11, s[52:55], s69 offen lds
 s_add_u32 m0, s67, 26624
 s_nop 0
 buffer_load_dwordx4 v12, s[52:55], s69 offen lds
 s_add_u32 s69, s65, 331776
 s_add_u32 m0, s67, 27648
 s_nop 0
 buffer_load_dwordx4 v10, s[52:55], s69 offen lds
 s_add_u32 m0, s67, 28672
 s_nop 0
 buffer_load_dwordx4 v11, s[52:55], s69 offen lds
 s_add_u32 m0, s67, 29696
 s_nop 0
 buffer_load_dwordx4 v12, s[52:55], s69 offen lds
 s_add_u32 s69, s65, 368640
 s_add_u32 m0, s67, 30720
 s_nop 0
 buffer_load_dwordx4 v10, s[52:55], s69 offen lds
 s_add_u32 m0, s67, 31744
 s_nop 0
 buffer_load_dwordx4 v11, s[52:55], s69 offen lds
 s_add_u32 m0, s67, 32768
 s_nop 0
 buffer_load_dwordx4 v12, s[52:55], s69 offen lds
 s_add_u32 s69, s65, 405504
 s_add_u32 m0, s67, 33792
 s_nop 0
 buffer_load_dwordx4 v10, s[52:55], s69 offen lds
 s_add_u32 m0, s67, 34816
 s_nop 0
 buffer_load_dwordx4 v11, s[52:55], s69 offen lds
 s_add_u32 m0, s67, 35840
 s_nop 0
 buffer_load_dwordx4 v12, s[52:55], s69 offen lds
 s_waitcnt vmcnt(33)
 ds_read_b64_tr_b16 v[80:81], v13 offset:0
 ds_read_b64_tr_b16 v[82:83], v13 offset:384
 ds_read_b64_tr_b16 v[84:85], v13 offset:8
 ds_read_b64_tr_b16 v[86:87], v13 offset:392
 ds_read_b64_tr_b16 v[88:89], v14 offset:64
 ds_read_b64_tr_b16 v[90:91], v14 offset:448
 s_waitcnt lgkmcnt(0)
 s_add_u32 s69, s65, 442368
 s_add_u32 m0, s67, 0
 s_nop 0
 buffer_load_dwordx4 v10, s[52:55], s69 offen lds
 s_add_u32 m0, s67, 1024
 s_nop 0
 buffer_load_dwordx4 v11, s[52:55], s69 offen lds
 s_add_u32 m0, s67, 2048
 s_nop 0
 buffer_load_dwordx4 v12, s[52:55], s69 offen lds
 s_waitcnt vmcnt(33)
 ds_read_b64_tr_b16 v[92:93], v13 offset:3072
 ds_read_b64_tr_b16 v[94:95], v13 offset:3456
 ds_read_b64_tr_b16 v[96:97], v13 offset:3080
 ds_read_b64_tr_b16 v[98:99], v13 offset:3464
 ds_read_b64_tr_b16 v[100:101], v14 offset:3136
 ds_read_b64_tr_b16 v[102:103], v14 offset:3520
 s_waitcnt lgkmcnt(0)
 s_add_u32 s69, s65, 479232
 s_add_u32 m0, s67, 3072
 s_nop 0
 buffer_load_dwordx4 v10, s[52:55], s69 offen lds
 s_add_u32 m0, s67, 4096
 s_nop 0
 buffer_load_dwordx4 v11, s[52:55], s69 offen lds
 s_add_u32 m0, s67, 5120
 s_nop 0
 buffer_load_dwordx4 v12, s[52:55], s69 offen lds
 s_waitcnt vmcnt(33)
 ds_read_b64_tr_b16 v[104:105], v13 offset:6144
 ds_read_b64_tr_b16 v[106:107], v13 offset:6528
 ds_read_b64_tr_b16 v[108:109], v13 offset:6152
 ds_read_b64_tr_b16 v[110:111], v13 offset:6536
 ds_read_b64_tr_b16 v[112:113], v14 offset:6208
 ds_read_b64_tr_b16 v[114:115], v14 offset:6592
 s_waitcnt lgkmcnt(0)
 s_add_u32 s69, s65, 516096
 s_add_u32 m0, s67, 6144
 s_nop 0
 buffer_load_dwordx4 v10, s[52:55], s69 offen lds
 s_add_u32 m0, s67, 7168
 s_nop 0
 buffer_load_dwordx4 v11, s[52:55], s69 offen lds
 s_add_u32 m0, s67, 8192
 s_nop 0
 buffer_load_dwordx4 v12, s[52:55], s69 offen lds
 s_waitcnt vmcnt(33)
 ds_read_b64_tr_b16 v[116:117], v13 offset:9216
 ds_read_b64_tr_b16 v[118:119], v13 offset:9600
 ds_read_b64_tr_b16 v[120:121], v13 offset:9224
 ds_read_b64_tr_b16 v[122:123], v13 offset:9608
 ds_read_b64_tr_b16 v[124:125], v14 offset:9280
 ds_read_b64_tr_b16 v[126:127], v14 offset:9664
 s_waitcnt lgkmcnt(0)
 s_add_u32 s69, s65, 552960
 s_add_u32 m0, s67, 9216
 s_nop 0
 buffer_load_dwordx4 v10, s[52:55], s69 offen lds
 s_add_u32 m0, s67, 10240
 s_nop 0
 buffer_load_dwordx4 v11, s[52:55], s69 offen lds
 s_add_u32 m0, s67, 11264
 s_nop 0
 buffer_load_dwordx4 v12, s[52:55], s69 offen lds
 s_waitcnt vmcnt(33)
 ds_read_b64_tr_b16 v[128:129], v13 offset:12288
 ds_read_b64_tr_b16 v[130:131], v13 offset:12672
 ds_read_b64_tr_b16 v[132:133], v13 offset:12296
 ds_read_b64_tr_b16 v[134:135], v13 offset:12680
 ds_read_b64_tr_b16 v[136:137], v14 offset:12352
 ds_read_b64_tr_b16 v[138:139], v14 offset:12736
 s_waitcnt lgkmcnt(0)
 s_add_u32 s69, s65, 589824
 s_add_u32 m0, s67, 12288
 s_nop 0
 buffer_load_dwordx4 v10, s[52:55], s69 offen lds
 s_add_u32 m0, s67, 13312
 s_nop 0
 buffer_load_dwordx4 v11, s[52:55], s69 offen lds
 s_add_u32 m0, s67, 14336
 s_nop 0
 buffer_load_dwordx4 v12, s[52:55], s69 offen lds
 s_waitcnt vmcnt(33)
 ds_read_b64_tr_b16 v[140:141], v13 offset:15360
 ds_read_b64_tr_b16 v[142:143], v13 offset:15744
 ds_read_b64_tr_b16 v[144:145], v13 offset:15368
 ds_read_b64_tr_b16 v[146:147], v13 offset:15752
 ds_read_b64_tr_b16 v[148:149], v14 offset:15424
 ds_read_b64_tr_b16 v[150:151], v14 offset:15808
 s_waitcnt lgkmcnt(0)
 s_add_u32 s69, s65, 626688
 s_add_u32 m0, s67, 15360
 s_nop 0
 buffer_load_dwordx4 v10, s[52:55], s69 offen lds
 s_add_u32 m0, s67, 16384
 s_nop 0
 buffer_load_dwordx4 v11, s[52:55], s69 offen lds
 s_add_u32 m0, s67, 17408
 s_nop 0
 buffer_load_dwordx4 v12, s[52:55], s69 offen lds
 s_waitcnt vmcnt(33)
 ds_read_b64_tr_b16 v[152:153], v13 offset:18432
 ds_read_b64_tr_b16 v[154:155], v13 offset:18816
 ds_read_b64_tr_b16 v[156:157], v13 offset:18440
 ds_read_b64_tr_b16 v[158:159], v13 offset:18824
 ds_read_b64_tr_b16 v[160:161], v14 offset:18496
 ds_read_b64_tr_b16 v[162:163], v14 offset:18880
 s_waitcnt lgkmcnt(0)
 s_add_u32 s69, s65, 663552
 s_add_u32 m0, s67, 18432
 s_nop 0
 buffer_load_dwordx4 v10, s[52:55], s69 offen lds
 s_add_u32 m0, s67, 19456
 s_nop 0
 buffer_load_dwordx4 v11, s[52:55], s69 offen lds
 s_add_u32 m0, s67, 20480
 s_nop 0
 buffer_load_dwordx4 v12, s[52:55], s69 offen lds
 s_waitcnt vmcnt(33)
 ds_read_b64_tr_b16 v[164:165], v13 offset:21504
 ds_read_b64_tr_b16 v[166:167], v13 offset:21888
 ds_read_b64_tr_b16 v[168:169], v13 offset:21512
 ds_read_b64_tr_b16 v[170:171], v13 offset:21896
 ds_read_b64_tr_b16 v[172:173], v14 offset:21568
 ds_read_b64_tr_b16 v[174:175], v14 offset:21952
 s_waitcnt lgkmcnt(0)
 s_add_u32 s69, s65, 700416
 s_add_u32 m0, s67, 21504
 s_nop 0
 buffer_load_dwordx4 v10, s[52:55], s69 offen lds
 s_add_u32 m0, s67, 22528
 s_nop 0
 buffer_load_dwordx4 v11, s[52:55], s69 offen lds
 s_add_u32 m0, s67, 23552
 s_nop 0
 buffer_load_dwordx4 v12, s[52:55], s69 offen lds
 s_waitcnt vmcnt(33)
 ds_read_b64_tr_b16 v[176:177], v13 offset:24576
 ds_read_b64_tr_b16 v[178:179], v13 offset:24960
 ds_read_b64_tr_b16 v[180:181], v13 offset:24584
 ds_read_b64_tr_b16 v[182:183], v13 offset:24968
 ds_read_b64_tr_b16 v[184:185], v14 offset:24640
 ds_read_b64_tr_b16 v[186:187], v14 offset:25024
 s_waitcnt lgkmcnt(0)
 s_add_u32 s69, s65, 737280
 s_add_u32 m0, s67, 24576
 s_nop 0
 buffer_load_dwordx4 v10, s[52:55], s69 offen lds
 s_add_u32 m0, s67, 25600
 s_nop 0
 buffer_load_dwordx4 v11, s[52:55], s69 offen lds
 s_add_u32 m0, s67, 26624
 s_nop 0
 buffer_load_dwordx4 v12, s[52:55], s69 offen lds
 s_waitcnt vmcnt(33)
 ds_read_b64_tr_b16 v[188:189], v13 offset:27648
 ds_read_b64_tr_b16 v[190:191], v13 offset:28032
 ds_read_b64_tr_b16 v[192:193], v13 offset:27656
 ds_read_b64_tr_b16 v[194:195], v13 offset:28040
 ds_read_b64_tr_b16 v[196:197], v14 offset:27712
 ds_read_b64_tr_b16 v[198:199], v14 offset:28096
 s_waitcnt lgkmcnt(0)
 s_add_u32 s69, s65, 774144
 s_add_u32 m0, s67, 27648
 s_nop 0
 buffer_load_dwordx4 v10, s[52:55], s69 offen lds
 s_add_u32 m0, s67, 28672
 s_nop 0
 buffer_load_dwordx4 v11, s[52:55], s69 offen lds
 s_add_u32 m0, s67, 29696
 s_nop 0
 buffer_load_dwordx4 v12, s[52:55], s69 offen lds
 s_waitcnt vmcnt(33)
 ds_read_b64_tr_b16 v[200:201], v13 offset:30720
 ds_read_b64_tr_b16 v[202:203], v13 offset:31104
 ds_read_b64_tr_b16 v[204:205], v13 offset:30728
 ds_read_b64_tr_b16 v[206:207], v13 offset:31112
 ds_read_b64_tr_b16 v[208:209], v14 offset:30784
 ds_read_b64_tr_b16 v[210:211], v14 offset:31168
 s_waitcnt lgkmcnt(0)
 s_add_u32 s69, s65, 811008
 s_add_u32 m0, s67, 30720
 s_nop 0
 buffer_load_dwordx4 v10, s[52:55], s69 offen lds
 s_add_u32 m0, s67, 31744
 s_nop 0
 buffer_load_dwordx4 v11, s[52:55], s69 offen lds
 s_add_u32 m0, s67, 32768
 s_nop 0
 buffer_load_dwordx4 v12, s[52:55], s69 offen lds
 s_waitcnt vmcnt(33)
 ds_read_b64_tr_b16 v[212:213], v13 offset:33792
 ds_read_b64_tr_b16 v[214:215], v13 offset:34176
 ds_read_b64_tr_b16 v[216:217], v13 offset:33800
 ds_read_b64_tr_b16 v[218:219], v13 offset:34184
 ds_read_b64_tr_b16 v[220:221], v14 offset:33856
 ds_read_b64_tr_b16 v[222:223], v14 offset:34240
 s_waitcnt lgkmcnt(0)
 s_add_u32 s69, s65, 847872
 s_add_u32 m0, s67, 33792
 s_nop 0
 buffer_load_dwordx4 v10, s[52:55], s69 offen lds
 s_add_u32 m0, s67, 34816
 s_nop 0
 buffer_load_dwordx4 v11, s[52:55], s69 offen lds
 s_add_u32 m0, s67, 35840
 s_nop 0
 buffer_load_dwordx4 v12, s[52:55], s69 offen lds
 s_waitcnt vmcnt(33)
 ds_read_b64_tr_b16 v[224:225], v13 offset:0
 ds_read_b64_tr_b16 v[226:227], v13 offset:384
 ds_read_b64_tr_b16 v[228:229], v13 offset:8
 ds_read_b64_tr_b16 v[230:231], v13 offset:392
 ds_read_b64_tr_b16 v[232:233], v14 offset:64
 ds_read_b64_tr_b16 v[234:235], v14 offset:448
 s_waitcnt lgkmcnt(0)
 s_add_u32 s69, s65, 884736
 s_add_u32 m0, s67, 0
 s_nop 0
 buffer_load_dwordx4 v10, s[52:55], s69 offen lds
 s_add_u32 m0, s67, 1024
 s_nop 0
 buffer_load_dwordx4 v11, s[52:55], s69 offen lds
 s_add_u32 m0, s67, 2048
 s_nop 0
 buffer_load_dwordx4 v12, s[52:55], s69 offen lds
 s_waitcnt vmcnt(33)
 ds_read_b64_tr_b16 v[236:237], v13 offset:3072
 ds_read_b64_tr_b16 v[238:239], v13 offset:3456
 ds_read_b64_tr_b16 v[240:241], v13 offset:3080
 ds_read_b64_tr_b16 v[242:243], v13 offset:3464
 ds_read_b64_tr_b16 v[244:245], v14 offset:3136
 ds_read_b64_tr_b16 v[246:247], v14 offset:3520
 s_waitcnt lgkmcnt(0)
 s_add_u32 s69, s65, 921600
 s_add_u32 m0, s67, 3072
 s_nop 0
 buffer_load_dwordx4 v10, s[52:55], s69 offen lds
 s_add_u32 m0, s67, 4096
 s_nop 0
 buffer_load_dwordx4 v11, s[52:55], s69 offen lds
 s_add_u32 m0, s67, 5120
 s_nop 0
 buffer_load_dwordx4 v12, s[52:55], s69 offen lds
 s_waitcnt vmcnt(33)
 ds_read_b64_tr_b16 v[248:249], v13 offset:6144
 ds_read_b64_tr_b16 v[250:251], v13 offset:6528
 ds_read_b64_tr_b16 v[252:253], v13 offset:6152
 ds_read_b64_tr_b16 v[254:255], v13 offset:6536
 ds_read_b64_tr_b16 a[0:1], v14 offset:6208
 ds_read_b64_tr_b16 a[2:3], v14 offset:6592
 s_waitcnt lgkmcnt(0)
 s_add_u32 s69, s65, 958464
 s_add_u32 m0, s67, 6144
 s_nop 0
 buffer_load_dwordx4 v10, s[52:55], s69 offen lds
 s_add_u32 m0, s67, 7168
 s_nop 0
 buffer_load_dwordx4 v11, s[52:55], s69 offen lds
 s_add_u32 m0, s67, 8192
 s_nop 0
 buffer_load_dwordx4 v12, s[52:55], s69 offen lds
 s_waitcnt vmcnt(33)
 ds_read_b64_tr_b16 a[4:5], v13 offset:9216
 ds_read_b64_tr_b16 a[6:7], v13 offset:9600
 ds_read_b64_tr_b16 a[8:9], v13 offset:9224
 ds_read_b64_tr_b16 a[10:11], v13 offset:9608
 ds_read_b64_tr_b16 a[12:13], v14 offset:9280
 ds_read_b64_tr_b16 a[14:15], v14 offset:9664
 s_waitcnt lgkmcnt(0)
 s_add_u32 s69, s65, 995328
 s_add_u32 m0, s67, 9216
 s_nop 0
 buffer_load_dwordx4 v10, s[52:55], s69 offen lds
 s_add_u32 m0, s67, 10240
 s_nop 0
 buffer_load_dwordx4 v11, s[52:55], s69 offen lds
 s_add_u32 m0, s67, 11264
 s_nop 0
 buffer_load_dwordx4 v12, s[52:55], s69 offen lds
 s_waitcnt vmcnt(33)
 ds_read_b64_tr_b16 a[16:17], v13 offset:12288
 ds_read_b64_tr_b16 a[18:19], v13 offset:12672
 ds_read_b64_tr_b16 a[20:21], v13 offset:12296
 ds_read_b64_tr_b16 a[22:23], v13 offset:12680
 ds_read_b64_tr_b16 a[24:25], v14 offset:12352
 ds_read_b64_tr_b16 a[26:27], v14 offset:12736
 s_waitcnt lgkmcnt(0)
 s_add_u32 s69, s65, 1032192
 s_add_u32 m0, s67, 12288
 s_nop 0
 buffer_load_dwordx4 v10, s[52:55], s69 offen lds
 s_add_u32 m0, s67, 13312
 s_nop 0
 buffer_load_dwordx4 v11, s[52:55], s69 offen lds
 s_add_u32 m0, s67, 14336
 s_nop 0
 buffer_load_dwordx4 v12, s[52:55], s69 offen lds
 s_waitcnt vmcnt(33)
 ds_read_b64_tr_b16 a[28:29], v13 offset:15360
 ds_read_b64_tr_b16 a[30:31], v13 offset:15744
 ds_read_b64_tr_b16 a[32:33], v13 offset:15368
 ds_read_b64_tr_b16 a[34:35], v13 offset:15752
 ds_read_b64_tr_b16 a[36:37], v14 offset:15424
 ds_read_b64_tr_b16 a[38:39], v14 offset:15808
 s_waitcnt lgkmcnt(0)
 s_add_u32 s69, s65, 1069056
 s_add_u32 m0, s67, 15360
 s_nop 0
 buffer_load_dwordx4 v10, s[52:55], s69 offen lds
 s_add_u32 m0, s67, 16384
 s_nop 0
 buffer_load_dwordx4 v11, s[52:55], s69 offen lds
 s_add_u32 m0, s67, 17408
 s_nop 0
 buffer_load_dwordx4 v12, s[52:55], s69 offen lds
 s_waitcnt vmcnt(33)
 ds_read_b64_tr_b16 a[40:41], v13 offset:18432
 ds_read_b64_tr_b16 a[42:43], v13 offset:18816
 ds_read_b64_tr_b16 a[44:45], v13 offset:18440
 ds_read_b64_tr_b16 a[46:47], v13 offset:18824
 ds_read_b64_tr_b16 a[48:49], v14 offset:18496
 ds_read_b64_tr_b16 a[50:51], v14 offset:18880
 s_waitcnt lgkmcnt(0)
 s_add_u32 s69, s65, 1105920
 s_add_u32 m0, s67, 18432
 s_nop 0
 buffer_load_dwordx4 v10, s[52:55], s69 offen lds
 s_add_u32 m0, s67, 19456
 s_nop 0
 buffer_load_dwordx4 v11, s[52:55], s69 offen lds
 s_add_u32 m0, s67, 20480
 s_nop 0
 buffer_load_dwordx4 v12, s[52:55], s69 offen lds
 s_waitcnt vmcnt(33)
 ds_read_b64_tr_b16 a[52:53], v13 offset:21504
 ds_read_b64_tr_b16 a[54:55], v13 offset:21888
 ds_read_b64_tr_b16 a[56:57], v13 offset:21512
 ds_read_b64_tr_b16 a[58:59], v13 offset:21896
 ds_read_b64_tr_b16 a[60:61], v14 offset:21568
 ds_read_b64_tr_b16 a[62:63], v14 offset:21952
 s_waitcnt lgkmcnt(0)
 s_add_u32 s69, s65, 1142784
 s_add_u32 m0, s67, 21504
 s_nop 0
 buffer_load_dwordx4 v10, s[52:55], s69 offen lds
 s_add_u32 m0, s67, 22528
 s_nop 0
 buffer_load_dwordx4 v11, s[52:55], s69 offen lds
 s_add_u32 m0, s67, 23552
 s_nop 0
 buffer_load_dwordx4 v12, s[52:55], s69 offen lds
 s_waitcnt vmcnt(33)
 ds_read_b64_tr_b16 a[64:65], v13 offset:24576
 ds_read_b64_tr_b16 a[66:67], v13 offset:24960
 ds_read_b64_tr_b16 a[68:69], v13 offset:24584
 ds_read_b64_tr_b16 a[70:71], v13 offset:24968
 ds_read_b64_tr_b16 a[72:73], v14 offset:24640
 ds_read_b64_tr_b16 a[74:75], v14 offset:25024
 s_waitcnt lgkmcnt(0)
 s_add_u32 s69, s65, 1179648
 s_add_u32 m0, s67, 24576
 s_nop 0
 buffer_load_dwordx4 v10, s[52:55], s69 offen lds
 s_add_u32 m0, s67, 25600
 s_nop 0
 buffer_load_dwordx4 v11, s[52:55], s69 offen lds
 s_add_u32 m0, s67, 26624
 s_nop 0
 buffer_load_dwordx4 v12, s[52:55], s69 offen lds
 s_waitcnt vmcnt(33)
 ds_read_b64_tr_b16 a[76:77], v13 offset:27648
 ds_read_b64_tr_b16 a[78:79], v13 offset:28032
 ds_read_b64_tr_b16 a[80:81], v13 offset:27656
 ds_read_b64_tr_b16 a[82:83], v13 offset:28040
 ds_read_b64_tr_b16 a[84:85], v14 offset:27712
 ds_read_b64_tr_b16 a[86:87], v14 offset:28096
 s_waitcnt lgkmcnt(0)
 s_add_u32 s69, s65, 1216512
 s_add_u32 m0, s67, 27648
 s_nop 0
 buffer_load_dwordx4 v10, s[52:55], s69 offen lds
 s_add_u32 m0, s67, 28672
 s_nop 0
 buffer_load_dwordx4 v11, s[52:55], s69 offen lds
 s_add_u32 m0, s67, 29696
 s_nop 0
 buffer_load_dwordx4 v12, s[52:55], s69 offen lds
 s_waitcnt vmcnt(33)
 ds_read_b64_tr_b16 a[88:89], v13 offset:30720
 ds_read_b64_tr_b16 a[90:91], v13 offset:31104
 ds_read_b64_tr_b16 a[92:93], v13 offset:30728
 ds_read_b64_tr_b16 a[94:95], v13 offset:31112
 ds_read_b64_tr_b16 a[96:97], v14 offset:30784
 ds_read_b64_tr_b16 a[98:99], v14 offset:31168
 s_waitcnt lgkmcnt(0)
 s_add_u32 s69, s65, 1253376
 s_add_u32 m0, s67, 30720
 s_nop 0
 buffer_load_dwordx4 v10, s[52:55], s69 offen lds
 s_add_u32 m0, s67, 31744
 s_nop 0
 buffer_load_dwordx4 v11, s[52:55], s69 offen lds
 s_add_u32 m0, s67, 32768
 s_nop 0
 buffer_load_dwordx4 v12, s[52:55], s69 offen lds
 s_waitcnt vmcnt(33)
 ds_read_b64_tr_b16 a[100:101], v13 offset:33792
 ds_read_b64_tr_b16 a[102:103], v13 offset:34176
 ds_read_b64_tr_b16 a[104:105], v13 offset:33800
 ds_read_b64_tr_b16 a[106:107], v13 offset:34184
 ds_read_b64_tr_b16 a[108:109], v14 offset:33856
 ds_read_b64_tr_b16 a[110:111], v14 offset:34240
 s_waitcnt lgkmcnt(0)
 s_add_u32 s69, s65, 1290240
 s_add_u32 m0, s67, 33792
 s_nop 0
 buffer_load_dwordx4 v10, s[52:55], s69 offen lds
 s_add_u32 m0, s67, 34816
 s_nop 0
 buffer_load_dwordx4 v11, s[52:55], s69 offen lds
 s_add_u32 m0, s67, 35840
 s_nop 0
 buffer_load_dwordx4 v12, s[52:55], s69 offen lds
 s_waitcnt vmcnt(33)
 ds_read_b64_tr_b16 a[112:113], v13 offset:0
 ds_read_b64_tr_b16 a[114:115], v13 offset:384
 ds_read_b64_tr_b16 a[116:117], v13 offset:8
 ds_read_b64_tr_b16 a[118:119], v13 offset:392
 ds_read_b64_tr_b16 a[120:121], v14 offset:64
 ds_read_b64_tr_b16 a[122:123], v14 offset:448
 s_waitcnt vmcnt(30)
 ds_read_b64_tr_b16 a[124:125], v13 offset:3072
 ds_read_b64_tr_b16 a[126:127], v13 offset:3456
 ds_read_b64_tr_b16 a[128:129], v13 offset:3080
 ds_read_b64_tr_b16 a[130:131], v13 offset:3464
 ds_read_b64_tr_b16 a[132:133], v14 offset:3136
 ds_read_b64_tr_b16 a[134:135], v14 offset:3520
 s_waitcnt vmcnt(27)
 ds_read_b64_tr_b16 a[136:137], v13 offset:6144
 ds_read_b64_tr_b16 a[138:139], v13 offset:6528
 ds_read_b64_tr_b16 a[140:141], v13 offset:6152
 ds_read_b64_tr_b16 a[142:143], v13 offset:6536
 ds_read_b64_tr_b16 a[144:145], v14 offset:6208
 ds_read_b64_tr_b16 a[146:147], v14 offset:6592
 s_waitcnt vmcnt(24)
 ds_read_b64_tr_b16 a[148:149], v13 offset:9216
 ds_read_b64_tr_b16 a[150:151], v13 offset:9600
 ds_read_b64_tr_b16 a[152:153], v13 offset:9224
 ds_read_b64_tr_b16 a[154:155], v13 offset:9608
 ds_read_b64_tr_b16 a[156:157], v14 offset:9280
 ds_read_b64_tr_b16 a[158:159], v14 offset:9664
 s_waitcnt vmcnt(21)
 ds_read_b64_tr_b16 a[160:161], v13 offset:12288
 ds_read_b64_tr_b16 a[162:163], v13 offset:12672
 ds_read_b64_tr_b16 a[164:165], v13 offset:12296
 ds_read_b64_tr_b16 a[166:167], v13 offset:12680
 ds_read_b64_tr_b16 a[168:169], v14 offset:12352
 ds_read_b64_tr_b16 a[170:171], v14 offset:12736
 s_waitcnt vmcnt(18)
 ds_read_b64_tr_b16 a[172:173], v13 offset:15360
 ds_read_b64_tr_b16 a[174:175], v13 offset:15744
 ds_read_b64_tr_b16 a[176:177], v13 offset:15368
 ds_read_b64_tr_b16 a[178:179], v13 offset:15752
 ds_read_b64_tr_b16 a[180:181], v14 offset:15424
 ds_read_b64_tr_b16 a[182:183], v14 offset:15808
 s_waitcnt vmcnt(15)
 ds_read_b64_tr_b16 a[184:185], v13 offset:18432
 ds_read_b64_tr_b16 a[186:187], v13 offset:18816
 ds_read_b64_tr_b16 a[188:189], v13 offset:18440
 ds_read_b64_tr_b16 a[190:191], v13 offset:18824
 ds_read_b64_tr_b16 a[192:193], v14 offset:18496
 ds_read_b64_tr_b16 a[194:195], v14 offset:18880
 s_waitcnt vmcnt(12)
 ds_read_b64_tr_b16 a[196:197], v13 offset:21504
 ds_read_b64_tr_b16 a[198:199], v13 offset:21888
 ds_read_b64_tr_b16 a[200:201], v13 offset:21512
 ds_read_b64_tr_b16 a[202:203], v13 offset:21896
 ds_read_b64_tr_b16 a[204:205], v14 offset:21568
 ds_read_b64_tr_b16 a[206:207], v14 offset:21952
 s_waitcnt vmcnt(9)
 ds_read_b64_tr_b16 a[208:209], v13 offset:24576
 ds_read_b64_tr_b16 a[210:211], v13 offset:24960
 ds_read_b64_tr_b16 a[212:213], v13 offset:24584
 ds_read_b64_tr_b16 a[214:215], v13 offset:24968
 ds_read_b64_tr_b16 a[216:217], v14 offset:24640
 ds_read_b64_tr_b16 a[218:219], v14 offset:25024
 s_waitcnt vmcnt(6)
 ds_read_b64_tr_b16 a[220:221], v13 offset:27648
 ds_read_b64_tr_b16 a[222:223], v13 offset:28032
 ds_read_b64_tr_b16 a[224:225], v13 offset:27656
 ds_read_b64_tr_b16 a[226:227], v13 offset:28040
 ds_read_b64_tr_b16 a[228:229], v14 offset:27712
 ds_read_b64_tr_b16 a[230:231], v14 offset:28096
 s_waitcnt vmcnt(3)
 ds_read_b64_tr_b16 a[232:233], v13 offset:30720
 ds_read_b64_tr_b16 a[234:235], v13 offset:31104
 ds_read_b64_tr_b16 a[236:237], v13 offset:30728
 ds_read_b64_tr_b16 a[238:239], v13 offset:31112
 ds_read_b64_tr_b16 a[240:241], v14 offset:30784
 ds_read_b64_tr_b16 a[242:243], v14 offset:31168
 s_waitcnt vmcnt(0)
 ds_read_b64_tr_b16 a[244:245], v13 offset:33792
 ds_read_b64_tr_b16 a[246:247], v13 offset:34176
 ds_read_b64_tr_b16 a[248:249], v13 offset:33800
 ds_read_b64_tr_b16 a[250:251], v13 offset:34184
 ds_read_b64_tr_b16 a[252:253], v14 offset:33856
 ds_read_b64_tr_b16 a[254:255], v14 offset:34240
 s_waitcnt lgkmcnt(0)
 s_barrier
 s_cmp_eq_u32 s7, 1
 s_cbranch_scc1 Lvalok_63
 v_mbcnt_lo_u32_b32 v1, -1, 0
 v_mbcnt_hi_u32_b32 v1, -1, v1
 v_lshlrev_b32 v1, 2, v1
 s_mov_b32 s62, 0
 s_mov_b32 s63, 0x80808080
Lval_61:
 buffer_load_dword v2, v1, s[20:23], 0 offen sc1
 s_waitcnt vmcnt(0)
 v_and_b32 v3, s63, v2
 v_cmp_ne_u32 vcc, s63, v3
 s_cbranch_vccz Lvald_62
 s_add_u32 s62, s62, 1
 s_cmp_lt_u32 s62, 400000
 s_cbranch_scc1 Lval_61
Lvald_62:
 s_mov_b32 s63, 1
 s_cbranch_vccnz L_abort_b
 v_lshlrev_b32 v3, v2, 1
 v_lshrrev_b32 v4, 8, v2
 v_lshl_or_b32 v3, 1, v4, v3
 v_lshrrev_b32 v4, 16, v2
 v_lshl_or_b32 v3, 1, v4, v3
 v_lshrrev_b32 v4, 24, v2
 v_lshl_or_b32 v3, 1, v4, v3
 s_nop 1
 v_or_b32_dpp v3, v3, v3 quad_perm:[1,0,3,2] row_mask:0xf bank_mask:0xf
 v_cmp_ne_u32 vcc, 255, v3
 s_cbranch_vccnz L_rerank_b
 s_mov_b32 s7, 1
Lvalok_63:
 s_mul_i32 s64, s86, 3
 s_add_u32 s64, s64, s80
 s_lshl_b32 s63, s57, 2
 s_add_u32 s63, s63, 2048
 v_mbcnt_lo_u32_b32 v1, -1, 0
 v_mbcnt_hi_u32_b32 v1, -1, v1
 v_cmp_eq_u32 vcc, 0, v1
 v_mov_b32 v2, s63
 v_mov_b32 v77, 2147483632
 v_cndmask_b32 v77, v77, v2, vcc
 v_lshlrev_b32 v73, 4, v1
 s_lshl_b32 s87, s64, 2
 s_add_u32 s87, s87, s58
 s_mul_i32 s87, s87, 3072
 s_add_u32 s87, s87, 228589568
 s_mov_b32 s88, s87
 s_mov_b32 s89, s87
 s_mul_i32 s90, s86, 73728
 s_mov_b32 s91, 64
 s_mov_b32 s74, 1
 s_mov_b32 s75, 1
 v_lshrrev_b32 v2, 5, v1
 v_and_b32 v3, 31, v1
 s_add_u32 s74, s81, 1
 s_add_u32 s75, s81, 1
 s_cmp_eq_u32 s81, 0
 s_mov_b32 s44, 12
 s_mov_b32 s45, 2
 s_cselect_b32 s46, 1, 1000
 s_mov_b32 s47, 48
 s_mov_b32 s48, 1
 s_mov_b32 s49, 2
 s_cselect_b32 s75, 49, 1
 s_cselect_b32 s91, 66, 62
 s_sub_u32 s63, s75, 1
 v_mov_b32 v4, s81
 v_mov_b32 v5, s63
 buffer_store_dword v4, v77, s[8:11], 0 offen sc1
 buffer_store_dword v5, v77, s[8:11], 0 offen offset:512 sc1
 s_mul_i32 s65, s86, 6
 v_lshrrev_b32 v5, 1, v3
 v_min_u32 v5, 5, v5
 v_add_u32 v5, s65, v5
 v_and_b32 v4, 1, v3
 v_lshlrev_b32 v4, 2, v4
 v_lshl_add_u32 v4, v5, 7, v4
 v_lshl_add_u32 v4, v2, 12, v4
 v_add_u32 v74, 4096, v4
 v_and_b32 v4, 3, v3
 v_lshlrev_b32 v4, 2, v4
 v_lshl_add_u32 v4, v2, 7, v4
 v_add_u32 v4, 768, v4
 v_cmp_gt_u32 vcc, 16, v3
 v_mov_b64 v[8:9], 0
 v_mov_b64 v[10:11], 0
 v_cndmask_b32 v74, v4, v74, vcc
 v_mul_i32_i24 v65, 0, v2
 v_add_u32 v65, 4, v65
 v_cndmask_b32 v65, v65, 0, vcc
 v_mbcnt_lo_u32_b32 v1, -1, 0
 v_mbcnt_hi_u32_b32 v1, -1, v1
 v_lshlrev_b32 v70, 4, v1
 v_add_u32 v70, 81920, v70
 v_add_u32 v71, 36864, v70
 s_lshl_b32 s70, s58, 10
 v_lshl_add_u32 v72, v1, 4, s70
 s_add_u32 s70, s70, 8192
 s_mov_b32 s85, -73728
 s_mov_b32 s3, 4096
 s_mov_b32 s84, 1
 s_mov_b32 s4, 36864
 s_mov_b32 s5, 36864
 s_mov_b32 s61, 0
 s_mov_b32 s77, 0
 s_mov_b32 s78, 0
 s_mov_b32 s79, 0
 s_mov_b32 s92, 2147483632
 s_mov_b32 s93, 0
 s_cmp_eq_u32 s58, 0
 s_cbranch_scc1 Lw0_64
 v_mov_b32 v74, 2147483632
 v_mov_b32 v77, 2147483632
Lw0_64:
 s_add_u32 s90, s90, 171671552
 s_cmp_lg_u32 s59, 0
 s_cbranch_scc1 L_dn_sl
L_dn_idle:
 s_cmp_lg_u32 s58, 0
 s_cbranch_scc1 Lspd_66
 s_mov_b32 s62, 0
Lsp_65:
 buffer_load_dword v75, v74, s[8:11], 0 offen sc1
 s_waitcnt vmcnt(0)
 v_add_u32 v64, v65, v75
 v_cmp_gt_u32 vcc, s74, v64
 v_cmp_gt_u32 s[66:67], s75, v64
 s_cmp_eq_u32 s67, 0
 s_cselect_b32 s72, 2, 0
 s_cmp_eq_u32 vcc_lo, 0
 s_cselect_b32 s72, 1, s72
 v_mov_b32 v76, s72
 ds_write_b32 v72, v76 offset:4096
 s_cmp_lg_u32 s72, 0
 s_cbranch_scc1 Lspd_66
 s_add_u32 s62, s62, 1
 s_cmp_lt_u32 s62, 400000
 s_cbranch_scc1 Lsp_65
Lspd_66:
 s_waitcnt lgkmcnt(0)
 s_barrier
 ds_read_b32 v76, v73 offset:4096
 s_waitcnt lgkmcnt(0)
 v_readfirstlane_b32 s72, v76
 s_mov_b32 s63, 51
 s_cmp_eq_u32 s72, 0
 s_cbranch_scc1 L_abort_b
 s_sub_u32 s68, s72, 1
 s_cmp_eq_u32 s68, 0
 s_cselect_b32 s69, s74, s75
 s_cselect_b32 s63, s44, s47
 s_cselect_b32 s64, s45, s48
 s_cselect_b32 s80, s46, s49
 s_cmp_lt_u32 s69, s63
 s_cselect_b32 s80, s64, s80
 s_add_u32 s80, s80, s69
 s_cmp_eq_u32 s68, 0
 s_cselect_b32 s74, s80, s74
 s_cselect_b32 s75, s75, s80
 s_mul_i32 s73, s69, 294912
 s_mul_i32 s63, s68, 18874368
 s_add_u32 s73, s73, s63
 s_add_u32 s73, s73, s90
 s_mov_b32 m0, s70
 s_nop 0
 buffer_load_dwordx4 v72, s[8:11], s73 offen sc1 lds
 s_add_u32 m0, m0, s3
 s_add_u32 s73, s73, s3
 buffer_load_dwordx4 v72, s[8:11], s73 offen sc1 lds
 s_add_u32 m0, m0, s3
 s_add_u32 s73, s73, s3
 buffer_load_dwordx4 v72, s[8:11], s73 offen sc1 lds
 s_add_u32 m0, m0, s3
 s_add_u32 s73, s73, s3
 buffer_load_dwordx4 v72, s[8:11], s73 offen sc1 lds
 s_add_u32 m0, m0, s3
 s_add_u32 s73, s73, s3
 buffer_load_dwordx4 v72, s[8:11], s73 offen sc1 lds
 s_add_u32 m0, m0, s3
 s_add_u32 s73, s73, s3
 buffer_load_dwordx4 v72, s[8:11], s73 offen sc1 lds
 s_add_u32 m0, m0, s3
 s_add_u32 s73, s73, s3
 buffer_load_dwordx4 v72, s[8:11], s73 offen sc1 lds
 s_add_u32 m0, m0, s3
 s_add_u32 s73, s73, s3
 buffer_load_dwordx4 v72, s[8:11], s73 offen sc1 lds
 s_add_u32 m0, m0, s3
 s_add_u32 s73, s73, s3
 buffer_load_dwordx4 v72, s[8:11], s73 offen sc1 lds
 s_add_u32 m0, m0, s3
 s_add_u32 s73, s73, s3
 buffer_load_dwordx4 v72, s[8:11], s73 offen sc1 lds
 s_add_u32 m0, m0, s3
 s_add_u32 s73, s73, s3
 buffer_load_dwordx4 v72, s[8:11], s73 offen sc1 lds
 s_add_u32 m0, m0, s3
 s_add_u32 s73, s73, s3
 buffer_load_dwordx4 v72, s[8:11], s73 offen sc1 lds
 s_add_u32 m0, m0, s3
 s_add_u32 s73, s73, s3
 buffer_load_dwordx4 v72, s[8:11], s73 offen sc1 lds
 s_add_u32 m0, m0, s3
 s_add_u32 s73, s73, s3
 buffer_load_dwordx4 v72, s[8:11], s73 offen sc1 lds
 s_add_u32 m0, m0, s3
 s_add_u32 s73, s73, s3
 buffer_load_dwordx4 v72, s[8:11], s73 offen sc1 lds
 s_add_u32 m0, m0, s3
 s_add_u32 s73, s73, s3
 buffer_load_dwordx4 v72, s[8:11], s73 offen sc1 lds
 s_add_u32 m0, m0, s3
 s_add_u32 s73, s73, s3
 buffer_load_dwordx4 v72, s[8:11], s73 offen sc1 lds
 s_add_u32 m0, m0, s3
 s_add_u32 s73, s73, s3
 buffer_load_dwordx4 v72, s[8:11], s73 offen sc1 lds
 s_mov_b32 s5, s85
 s_sub_u32 s85, 0, s85
 s_add_u32 s70, s70, s85
 s_mov_b32 s81, s77
 s_mov_b32 s82, s78
 s_mov_b32 s83, s79
 s_mov_b32 s94, s92
 s_mov_b32 s95, s93
 s_mul_i32 s64, s68, 0
 s_add_u32 s64, s64, 4
 s_mul_i32 s63, s68, 0
 s_add_u32 s63, s63, 128
 s_mul_i32 s63, s69, s63
 s_lshr_b32 s63, s63, 9
 s_mul_i32 s63, s63, s64
 s_sub_u32 s63, s69, s63
 s_mul_i32 s63, s63, 294912
 s_mul_i32 s64, s68, 1179648
 s_add_u32 s63, s63, s64
 s_add_u32 s77, s63, s87
 s_add_u32 s78, s63, s88
 s_add_u32 s79, s63, s89
 s_mul_i32 s92, s68, 512
 s_sub_u32 s93, s80, 1
 s_min_u32 s93, s93, 64
 s_add_u32 s61, s61, 1
 v_add_u32 v70, s5, v70
 v_add_u32 v71, s5, v71
 v_add_u32 v64, v65, v75
 v_cmp_gt_u32 vcc, s74, v64
 v_cmp_gt_u32 s[66:67], s75, v64
 s_cmp_eq_u32 s67, 0
 s_cselect_b32 s72, 2, 0
 s_cmp_eq_u32 vcc_lo, 0
 s_cselect_b32 s72, 1, s72
 v_mov_b32 v76, s72
 ds_write_b32 v72, v76 offset:12
 s_waitcnt vmcnt(9) lgkmcnt(0)
 s_barrier
 ds_read_b32 v76, v73 offset:12
 ds_read_b128 v[24:27], v70 offset:0
 ds_read_b128 v[28:31], v70 offset:1024
 ds_read_b128 v[32:35], v70 offset:2048
 s_waitcnt lgkmcnt(3)
 v_readfirstlane_b32 s72, v76
 s_cmp_lg_u32 s72, 0
L_dn_slow:
 s_cbranch_scc1 L_dn_p0d
 s_waitcnt lgkmcnt(2)
 v_mfma_f32_16x16x32_bf16 v[0:3], v[80:83], v[24:27], 0
 ds_read_b128 v[36:39], v70 offset:3072
 v_mfma_f32_16x16x32_bf16 v[4:7], v[84:87], v[24:27], 0
 v_mfma_f32_16x16x32_bf16 v[8:11], v[88:91], v[24:27], 0
 s_waitcnt lgkmcnt(2)
 v_mfma_f32_16x16x32_bf16 v[0:3], v[92:95], v[28:31], v[0:3]
 ds_read_b128 v[24:27], v70 offset:4096
 v_mfma_f32_16x16x32_bf16 v[4:7], v[96:99], v[28:31], v[4:7]
 v_mfma_f32_16x16x32_bf16 v[8:11], v[100:103], v[28:31], v[8:11]
 s_waitcnt lgkmcnt(2)
 v_mfma_f32_16x16x32_bf16 v[0:3], v[104:107], v[32:35], v[0:3]
 ds_read_b128 v[28:31], v70 offset:5120
 v_mfma_f32_16x16x32_bf16 v[4:7], v[108:111], v[32:35], v[4:7]
 v_mfma_f32_16x16x32_bf16 v[8:11], v[112:115], v[32:35], v[8:11]
 s_waitcnt lgkmcnt(2)
 v_mfma_f32_16x16x32_bf16 v[0:3], v[116:119], v[36:39], v[0:3]
 ds_read_b128 v[32:35], v70 offset:6144
 v_mfma_f32_16x16x32_bf16 v[4:7], v[120:123], v[36:39], v[4:7]
 v_mfma_f32_16x16x32_bf16 v[8:11], v[124:127], v[36:39], v[8:11]
 s_waitcnt lgkmcnt(2)
 v_mfma_f32_16x16x32_bf16 v[0:3], v[128:131], v[24:27], v[0:3]
 ds_read_b128 v[36:39], v70 offset:7168
 v_mfma_f32_16x16x32_bf16 v[4:7], v[132:135], v[24:27], v[4:7]
 v_mfma_f32_16x16x32_bf16 v[8:11], v[136:139], v[24:27], v[8:11]
 s_waitcnt lgkmcnt(2)
 v_mfma_f32_16x16x32_bf16 v[0:3], v[140:143], v[28:31], v[0:3]
 ds_read_b128 v[24:27], v70 offset:8192
 v_mfma_f32_16x16x32_bf16 v[4:7], v[144:147], v[28:31], v[4:7]
 v_mfma_f32_16x16x32_bf16 v[8:11], v[148:151], v[28:31], v[8:11]
 s_waitcnt lgkmcnt(2)
 v_mfma_f32_16x16x32_bf16 v[0:3], v[152:155], v[32:35], v[0:3]
 ds_read_b128 v[28:31], v70 offset:9216
 v_mfma_f32_16x16x32_bf16 v[4:7], v[156:159], v[32:35], v[4:7]
 v_mfma_f32_16x16x32_bf16 v[8:11], v[160:163], v[32:35], v[8:11]
 s_waitcnt lgkmcnt(2)
 v_mfma_f32_16x16x32_bf16 v[0:3], v[164:167], v[36:39], v[0:3]
 ds_read_b128 v[32:35], v70 offset:10240
 v_mfma_f32_16x16x32_bf16 v[4:7], v[168:171], v[36:39], v[4:7]
 v_mfma_f32_16x16x32_bf16 v[8:11], v[172:175], v[36:39], v[8:11]
 s_waitcnt lgkmcnt(2)
 v_mfma_f32_16x16x32_bf16 v[0:3], v[176:179], v[24:27], v[0:3]
 ds_read_b128 v[36:39], v70 offset:11264
 v_mfma_f32_16x16x32_bf16 v[4:7], v[180:183], v[24:27], v[4:7]
 v_mfma_f32_16x16x32_bf16 v[8:11], v[184:187], v[24:27], v[8:11]
 s_waitcnt lgkmcnt(2)
 v_mfma_f32_16x16x32_bf16 v[0:3], v[188:191], v[28:31], v[0:3]
 ds_read_b128 v[24:27], v70 offset:12288
 v_mfma_f32_16x16x32_bf16 v[4:7], v[192:195], v[28:31], v[4:7]
 v_mfma_f32_16x16x32_bf16 v[8:11], v[196:199], v[28:31], v[8:11]
 s_waitcnt lgkmcnt(2)
 v_mfma_f32_16x16x32_bf16 v[0:3], v[200:203], v[32:35], v[0:3]
 ds_read_b128 v[28:31], v70 offset:13312
 v_mfma_f32_16x16x32_bf16 v[4:7], v[204:207], v[32:35], v[4:7]
 v_mfma_f32_16x16x32_bf16 v[8:11], v[208:211], v[32:35], v[8:11]
 s_waitcnt lgkmcnt(2)
 v_mfma_f32_16x16x32_bf16 v[0:3], v[212:215], v[36:39], v[0:3]
 ds_read_b128 v[32:35], v70 offset:14336
 v_mfma_f32_16x16x32_bf16 v[4:7], v[216:219], v[36:39], v[4:7]
 v_mfma_f32_16x16x32_bf16 v[8:11], v[220:223], v[36:39], v[8:11]
 s_waitcnt lgkmcnt(2)
 v_mfma_f32_16x16x32_bf16 v[0:3], v[224:227], v[24:27], v[0:3]
 ds_read_b128 v[36:39], v70 offset:15360
 v_mfma_f32_16x16x32_bf16 v[4:7], v[228:231], v[24:27], v[4:7]
 v_mfma_f32_16x16x32_bf16 v[8:11], v[232:235], v[24:27], v[8:11]
 s_waitcnt lgkmcnt(2)
 v_mfma_f32_16x16x32_bf16 v[0:3], v[236:239], v[28:31], v[0:3]
 ds_read_b128 v[24:27], v70 offset:16384
 v_mfma_f32_16x16x32_bf16 v[4:7], v[240:243], v[28:31], v[4:7]
 buffer_load_dword v75, v74, s[8:11], 0 offen sc1
 v_mfma_f32_16x16x32_bf16 v[8:11], v[244:247], v[28:31], v[8:11]
 s_waitcnt lgkmcnt(2)
 v_mfma_f32_16x16x32_bf16 v[0:3], v[248:251], v[32:35], v[0:3]
 ds_read_b128 v[28:31], v70 offset:17408
 v_mfma_f32_16x16x32_bf16 v[4:7], v[252:255], v[32:35], v[4:7]
 v_mfma_f32_16x16x32_bf16 v[8:11], a[0:3], v[32:35], v[8:11]
 s_waitcnt lgkmcnt(2)
 v_mfma_f32_16x16x32_bf16 v[0:3], a[4:7], v[36:39], v[0:3]
 ds_read_b128 v[32:35], v70 offset:18432
 v_mfma_f32_16x16x32_bf16 v[4:7], a[8:11], v[36:39], v[4:7]
 v_mfma_f32_16x16x32_bf16 v[8:11], a[12:15], v[36:39], v[8:11]
 s_waitcnt lgkmcnt(2)
 v_mfma_f32_16x16x32_bf16 v[0:3], a[16:19], v[24:27], v[0:3]
 ds_read_b128 v[36:39], v70 offset:19456
 v_mfma_f32_16x16x32_bf16 v[4:7], a[20:23], v[24:27], v[4:7]
 v_mfma_f32_16x16x32_bf16 v[8:11], a[24:27], v[24:27], v[8:11]
 s_waitcnt lgkmcnt(2)
 v_mfma_f32_16x16x32_bf16 v[0:3], a[28:31], v[28:31], v[0:3]
 ds_read_b128 v[24:27], v70 offset:20480
 v_mfma_f32_16x16x32_bf16 v[4:7], a[32:35], v[28:31], v[4:7]
 v_mfma_f32_16x16x32_bf16 v[8:11], a[36:39], v[28:31], v[8:11]
 s_waitcnt lgkmcnt(2)
 v_mfma_f32_16x16x32_bf16 v[0:3], a[40:43], v[32:35], v[0:3]
 ds_read_b128 v[28:31], v70 offset:21504
 v_mfma_f32_16x16x32_bf16 v[4:7], a[44:47], v[32:35], v[4:7]
 v_mfma_f32_16x16x32_bf16 v[8:11], a[48:51], v[32:35], v[8:11]
 s_waitcnt lgkmcnt(2)
 v_mfma_f32_16x16x32_bf16 v[0:3], a[52:55], v[36:39], v[0:3]
 ds_read_b128 v[32:35], v70 offset:22528
 v_mfma_f32_16x16x32_bf16 v[4:7], a[56:59], v[36:39], v[4:7]
 v_mfma_f32_16x16x32_bf16 v[8:11], a[60:63], v[36:39], v[8:11]
 s_waitcnt lgkmcnt(2)
 v_mfma_f32_16x16x32_bf16 v[0:3], a[64:67], v[24:27], v[0:3]
 ds_read_b128 v[36:39], v70 offset:23552
 v_mfma_f32_16x16x32_bf16 v[4:7], a[68:71], v[24:27], v[4:7]
 v_mfma_f32_16x16x32_bf16 v[8:11], a[72:75], v[24:27], v[8:11]
 s_waitcnt lgkmcnt(2)
 v_mfma_f32_16x16x32_bf16 v[0:3], a[76:79], v[28:31], v[0:3]
 ds_read_b128 v[24:27], v70 offset:24576
 v_mfma_f32_16x16x32_bf16 v[4:7], a[80:83], v[28:31], v[4:7]
 v_mfma_f32_16x16x32_bf16 v[8:11], a[84:87], v[28:31], v[8:11]
 s_waitcnt lgkmcnt(2)
 v_mfma_f32_16x16x32_bf16 v[0:3], a[88:91], v[32:35], v[0:3]
 ds_read_b128 v[28:31], v70 offset:25600
 v_mfma_f32_16x16x32_bf16 v[4:7], a[92:95], v[32:35], v[4:7]
 v_mfma_f32_16x16x32_bf16 v[8:11], a[96:99], v[32:35], v[8:11]
 s_waitcnt lgkmcnt(2)
 v_mfma_f32_16x16x32_bf16 v[0:3], a[100:103], v[36:39], v[0:3]
 ds_read_b128 v[32:35], v70 offset:26624
 v_mfma_f32_16x16x32_bf16 v[4:7], a[104:107], v[36:39], v[4:7]
 v_mfma_f32_16x16x32_bf16 v[8:11], a[108:111], v[36:39], v[8:11]
 s_waitcnt lgkmcnt(2)
 v_mfma_f32_16x16x32_bf16 v[0:3], a[112:115], v[24:27], v[0:3]
 ds_read_b128 v[36:39], v70 offset:27648
 v_mfma_f32_16x16x32_bf16 v[4:7], a[116:119], v[24:27], v[4:7]
 v_mfma_f32_16x16x32_bf16 v[8:11], a[120:123], v[24:27], v[8:11]
 s_waitcnt lgkmcnt(2)
 v_mfma_f32_16x16x32_bf16 v[0:3], a[124:127], v[28:31], v[0:3]
 ds_read_b128 v[24:27], v70 offset:28672
 v_mfma_f32_16x16x32_bf16 v[4:7], a[128:131], v[28:31], v[4:7]
 v_mfma_f32_16x16x32_bf16 v[8:11], a[132:135], v[28:31], v[8:11]
 s_waitcnt lgkmcnt(2)
 v_mfma_f32_16x16x32_bf16 v[0:3], a[136:139], v[32:35], v[0:3]
 ds_read_b128 v[28:31], v70 offset:29696
 v_mfma_f32_16x16x32_bf16 v[4:7], a[140:143], v[32:35], v[4:7]
 v_mfma_f32_16x16x32_bf16 v[8:11], a[144:147], v[32:35], v[8:11]
 s_waitcnt lgkmcnt(2)
 v_mfma_f32_16x16x32_bf16 v[0:3], a[148:151], v[36:39], v[0:3]
 ds_read_b128 v[32:35], v70 offset:30720
 v_mfma_f32_16x16x32_bf16 v[4:7], a[152:155], v[36:39], v[4:7]
 v_mfma_f32_16x16x32_bf16 v[8:11], a[156:159], v[36:39], v[8:11]
 s_waitcnt lgkmcnt(2)
 v_mfma_f32_16x16x32_bf16 v[0:3], a[160:163], v[24:27], v[0:3]
 ds_read_b128 v[36:39], v70 offset:31744
 v_mfma_f32_16x16x32_bf16 v[4:7], a[164:167], v[24:27], v[4:7]
 v_mfma_f32_16x16x32_bf16 v[8:11], a[168:171], v[24:27], v[8:11]
 s_waitcnt vmcnt(0)
 v_add_u32 v64, v65, v75
 v_cmp_gt_u32 vcc, s74, v64
 s_waitcnt lgkmcnt(2)
 v_mfma_f32_16x16x32_bf16 v[0:3], a[172:175], v[28:31], v[0:3]
 ds_read_b128 v[24:27], v70 offset:32768
 v_cmp_gt_u32 s[66:67], s75, v64
 v_mfma_f32_16x16x32_bf16 v[4:7], a[176:179], v[28:31], v[4:7]
 v_mfma_f32_16x16x32_bf16 v[8:11], a[180:183], v[28:31], v[8:11]
 s_waitcnt lgkmcnt(2)
 v_mfma_f32_16x16x32_bf16 v[0:3], a[184:187], v[32:35], v[0:3]
 ds_read_b128 v[28:31], v70 offset:33792
 s_cmp_eq_u32 s67, 0
 s_cselect_b32 s72, 2, 0
 s_cmp_eq_u32 vcc_lo, 0
 s_cselect_b32 s72, 1, s72
 v_mfma_f32_16x16x32_bf16 v[4:7], a[188:191], v[32:35], v[4:7]
 v_mov_b32 v76, s72
 v_mfma_f32_16x16x32_bf16 v[8:11], a[192:195], v[32:35], v[8:11]
 ds_write_b32 v72, v76 offset:0
 s_waitcnt lgkmcnt(3)
 v_mfma_f32_16x16x32_bf16 v[0:3], a[196:199], v[36:39], v[0:3]
 ds_read_b128 v[32:35], v70 offset:34816
 v_mfma_f32_16x16x32_bf16 v[4:7], a[200:203], v[36:39], v[4:7]
 v_mfma_f32_16x16x32_bf16 v[8:11], a[204:207], v[36:39], v[8:11]
 s_waitcnt lgkmcnt(3)
 v_mfma_f32_16x16x32_bf16 v[0:3], a[208:211], v[24:27], v[0:3]
 ds_read_b128 v[36:39], v70 offset:35840
 v_mfma_f32_16x16x32_bf16 v[4:7], a[212:215], v[24:27], v[4:7]
 v_mfma_f32_16x16x32_bf16 v[8:11], a[216:219], v[24:27], v[8:11]
 s_waitcnt vmcnt(1)
 s_waitcnt lgkmcnt(2)
 s_barrier
 ds_read_b32 v76, v73 offset:0
 v_mfma_f32_16x16x32_bf16 v[0:3], a[220:223], v[28:31], v[0:3]
 ds_read_b128 v[24:27], v71 offset:0
 v_mfma_f32_16x16x32_bf16 v[4:7], a[224:227], v[28:31], v[4:7]
 v_mfma_f32_16x16x32_bf16 v[8:11], a[228:231], v[28:31], v[8:11]
 s_waitcnt lgkmcnt(3)
 v_mfma_f32_16x16x32_bf16 v[0:3], a[232:235], v[32:35], v[0:3]
 ds_read_b128 v[28:31], v71 offset:1024
 v_mfma_f32_16x16x32_bf16 v[4:7], a[236:239], v[32:35], v[4:7]
 v_mfma_f32_16x16x32_bf16 v[8:11], a[240:243], v[32:35], v[8:11]
 s_waitcnt lgkmcnt(2)
 v_readfirstlane_b32 s72, v76
 v_mfma_f32_16x16x32_bf16 v[0:3], a[244:247], v[36:39], v[0:3]
 ds_read_b128 v[32:35], v71 offset:2048
 v_mfma_f32_16x16x32_bf16 v[4:7], a[248:251], v[36:39], v[4:7]
 v_mfma_f32_16x16x32_bf16 v[8:11], a[252:255], v[36:39], v[8:11]
 s_cmp_lg_u32 s72, 0
 s_cbranch_scc1 L_dn_p1d
 s_branch L_dn_p1n
L_dn_p0d:
 s_waitcnt lgkmcnt(2)
 v_mfma_f32_16x16x32_bf16 v[0:3], v[80:83], v[24:27], 0
 ds_read_b128 v[36:39], v70 offset:3072
 s_sub_u32 s68, s72, 1
 s_cmp_eq_u32 s68, 0
 s_cselect_b32 s69, s74, s75
 v_mfma_f32_16x16x32_bf16 v[4:7], v[84:87], v[24:27], 0
 s_cselect_b32 s63, s44, s47
 s_cselect_b32 s64, s45, s48
 s_cselect_b32 s80, s46, s49
 v_mfma_f32_16x16x32_bf16 v[8:11], v[88:91], v[24:27], 0
 s_cmp_lt_u32 s69, s63
 s_cselect_b32 s80, s64, s80
 s_add_u32 s80, s80, s69
 s_waitcnt lgkmcnt(2)
 v_mfma_f32_16x16x32_bf16 v[0:3], v[92:95], v[28:31], v[0:3]
 ds_read_b128 v[24:27], v70 offset:4096
 s_cmp_eq_u32 s68, 0
 s_cselect_b32 s74, s80, s74
 s_cselect_b32 s75, s75, s80
 v_mfma_f32_16x16x32_bf16 v[4:7], v[96:99], v[28:31], v[4:7]
 s_mul_i32 s73, s69, 294912
 s_mul_i32 s63, s68, 18874368
 s_add_u32 s73, s73, s63
 s_add_u32 s73, s73, s90
 v_mfma_f32_16x16x32_bf16 v[8:11], v[100:103], v[28:31], v[8:11]
 s_mov_b32 m0, s70
 s_waitcnt lgkmcnt(2)
 v_mfma_f32_16x16x32_bf16 v[0:3], v[104:107], v[32:35], v[0:3]
 ds_read_b128 v[28:31], v70 offset:5120
 v_mfma_f32_16x16x32_bf16 v[4:7], v[108:111], v[32:35], v[4:7]
 buffer_load_dwordx4 v72, s[8:11], s73 offen sc1 lds
 v_mfma_f32_16x16x32_bf16 v[8:11], v[112:115], v[32:35], v[8:11]
 s_waitcnt lgkmcnt(2)
 v_mfma_f32_16x16x32_bf16 v[0:3], v[116:119], v[36:39], v[0:3]
 ds_read_b128 v[32:35], v70 offset:6144
 v_mfma_f32_16x16x32_bf16 v[4:7], v[120:123], v[36:39], v[4:7]
 s_add_u32 m0, m0, s3
 s_add_u32 s73, s73, s3
 v_mfma_f32_16x16x32_bf16 v[8:11], v[124:127], v[36:39], v[8:11]
 buffer_load_dwordx4 v72, s[8:11], s73 offen sc1 lds
 s_waitcnt lgkmcnt(2)
 v_mfma_f32_16x16x32_bf16 v[0:3], v[128:131], v[24:27], v[0:3]
 ds_read_b128 v[36:39], v70 offset:7168
 v_mfma_f32_16x16x32_bf16 v[4:7], v[132:135], v[24:27], v[4:7]
 v_mfma_f32_16x16x32_bf16 v[8:11], v[136:139], v[24:27], v[8:11]
 s_add_u32 m0, m0, s3
 s_add_u32 s73, s73, s3
 s_waitcnt lgkmcnt(2)
 v_mfma_f32_16x16x32_bf16 v[0:3], v[140:143], v[28:31], v[0:3]
 ds_read_b128 v[24:27], v70 offset:8192
 v_mfma_f32_16x16x32_bf16 v[4:7], v[144:147], v[28:31], v[4:7]
 buffer_load_dwordx4 v72, s[8:11], s73 offen sc1 lds
 v_mfma_f32_16x16x32_bf16 v[8:11], v[148:151], v[28:31], v[8:11]
 s_waitcnt lgkmcnt(2)
 v_mfma_f32_16x16x32_bf16 v[0:3], v[152:155], v[32:35], v[0:3]
 ds_read_b128 v[28:31], v70 offset:9216
 v_mfma_f32_16x16x32_bf16 v[4:7], v[156:159], v[32:35], v[4:7]
 v_mfma_f32_16x16x32_bf16 v[8:11], v[160:163], v[32:35], v[8:11]
 s_add_u32 m0, m0, s3
 s_add_u32 s73, s73, s3
 s_waitcnt lgkmcnt(2)
 v_mfma_f32_16x16x32_bf16 v[0:3], v[164:167], v[36:39], v[0:3]
 ds_read_b128 v[32:35], v70 offset:10240
 v_mfma_f32_16x16x32_bf16 v[4:7], v[168:171], v[36:39], v[4:7]
 buffer_load_dwordx4 v72, s[8:11], s73 offen sc1 lds
 v_mfma_f32_16x16x32_bf16 v[8:11], v[172:175], v[36:39], v[8:11]
 s_waitcnt lgkmcnt(2)
 v_mfma_f32_16x16x32_bf16 v[0:3], v[176:179], v[24:27], v[0:3]
 ds_read_b128 v[36:39], v70 offset:11264
 v_mfma_f32_16x16x32_bf16 v[4:7], v[180:183], v[24:27], v[4:7]
 s_add_u32 m0, m0, s3
 s_add_u32 s73, s73, s3
 v_mfma_f32_16x16x32_bf16 v[8:11], v[184:187], v[24:27], v[8:11]
 buffer_load_dwordx4 v72, s[8:11], s73 offen sc1 lds
 s_waitcnt lgkmcnt(2)
 v_mfma_f32_16x16x32_bf16 v[0:3], v[188:191], v[28:31], v[0:3]
 ds_read_b128 v[24:27], v70 offset:12288
 v_mfma_f32_16x16x32_bf16 v[4:7], v[192:195], v[28:31], v[4:7]
 v_mfma_f32_16x16x32_bf16 v[8:11], v[196:199], v[28:31], v[8:11]
 s_add_u32 m0, m0, s3
 s_add_u32 s73, s73, s3
 s_waitcnt lgkmcnt(2)
 v_mfma_f32_16x16x32_bf16 v[0:3], v[200:203], v[32:35], v[0:3]
 ds_read_b128 v[28:31], v70 offset:13312
 v_mfma_f32_16x16x32_bf16 v[4:7], v[204:207], v[32:35], v[4:7]
 buffer_load_dwordx4 v72, s[8:11], s73 offen sc1 lds
 v_mfma_f32_16x16x32_bf16 v[8:11], v[208:211], v[32:35], v[8:11]
 s_waitcnt lgkmcnt(2)
 v_mfma_f32_16x16x32_bf16 v[0:3], v[212:215], v[36:39], v[0:3]
 ds_read_b128 v[32:35], v70 offset:14336
 v_mfma_f32_16x16x32_bf16 v[4:7], v[216:219], v[36:39], v[4:7]
 v_mfma_f32_16x16x32_bf16 v[8:11], v[220:223], v[36:39], v[8:11]
 s_add_u32 m0, m0, s3
 s_add_u32 s73, s73, s3
 s_waitcnt lgkmcnt(2)
 v_mfma_f32_16x16x32_bf16 v[0:3], v[224:227], v[24:27], v[0:3]
 ds_read_b128 v[36:39], v70 offset:15360
 v_mfma_f32_16x16x32_bf16 v[4:7], v[228:231], v[24:27], v[4:7]
 buffer_load_dwordx4 v72, s[8:11], s73 offen sc1 lds
 v_mfma_f32_16x16x32_bf16 v[8:11], v[232:235], v[24:27], v[8:11]
 s_waitcnt lgkmcnt(2)
 v_mfma_f32_16x16x32_bf16 v[0:3], v[236:239], v[28:31], v[0:3]
 ds_read_b128 v[24:27], v70 offset:16384
 v_mfma_f32_16x16x32_bf16 v[4:7], v[240:243], v[28:31], v[4:7]
 s_add_u32 m0, m0, s3
 s_add_u32 s73, s73, s3
 v_mfma_f32_16x16x32_bf16 v[8:11], v[244:247], v[28:31], v[8:11]
 buffer_load_dwordx4 v72, s[8:11], s73 offen sc1 lds
 s_waitcnt lgkmcnt(2)
 v_mfma_f32_16x16x32_bf16 v[0:3], v[248:251], v[32:35], v[0:3]
 ds_read_b128 v[28:31], v70 offset:17408
 v_mfma_f32_16x16x32_bf16 v[4:7], v[252:255], v[32:35], v[4:7]
 v_mfma_f32_16x16x32_bf16 v[8:11], a[0:3], v[32:35], v[8:11]
 s_add_u32 m0, m0, s3
 s_add_u32 s73, s73, s3
 s_waitcnt lgkmcnt(2)
 v_mfma_f32_16x16x32_bf16 v[0:3], a[4:7], v[36:39], v[0:3]
 ds_read_b128 v[32:35], v70 offset:18432
 v_mfma_f32_16x16x32_bf16 v[4:7], a[8:11], v[36:39], v[4:7]
 buffer_load_dwordx4 v72, s[8:11], s73 offen sc1 lds
 v_mfma_f32_16x16x32_bf16 v[8:11], a[12:15], v[36:39], v[8:11]
 s_waitcnt lgkmcnt(2)
 v_mfma_f32_16x16x32_bf16 v[0:3], a[16:19], v[24:27], v[0:3]
 ds_read_b128 v[36:39], v70 offset:19456
 v_mfma_f32_16x16x32_bf16 v[4:7], a[20:23], v[24:27], v[4:7]
 v_mfma_f32_16x16x32_bf16 v[8:11], a[24:27], v[24:27], v[8:11]
 s_waitcnt lgkmcnt(2)
 v_mfma_f32_16x16x32_bf16 v[0:3], a[28:31], v[28:31], v[0:3]
 ds_read_b128 v[24:27], v70 offset:20480
 v_mfma_f32_16x16x32_bf16 v[4:7], a[32:35], v[28:31], v[4:7]
 v_mfma_f32_16x16x32_bf16 v[8:11], a[36:39], v[28:31], v[8:11]
 s_waitcnt lgkmcnt(2)
 v_mfma_f32_16x16x32_bf16 v[0:3], a[40:43], v[32:35], v[0:3]
 ds_read_b128 v[28:31], v70 offset:21504
 v_mfma_f32_16x16x32_bf16 v[4:7], a[44:47], v[32:35], v[4:7]
 v_mfma_f32_16x16x32_bf16 v[8:11], a[48:51], v[32:35], v[8:11]
 s_waitcnt lgkmcnt(2)
 v_mfma_f32_16x16x32_bf16 v[0:3], a[52:55], v[36:39], v[0:3]
 ds_read_b128 v[32:35], v70 offset:22528
 v_mfma_f32_16x16x32_bf16 v[4:7], a[56:59], v[36:39], v[4:7]
 v_mfma_f32_16x16x32_bf16 v[8:11], a[60:63], v[36:39], v[8:11]
 s_waitcnt lgkmcnt(2)
 v_mfma_f32_16x16x32_bf16 v[0:3], a[64:67], v[24:27], v[0:3]
 ds_read_b128 v[36:39], v70 offset:23552
 v_mfma_f32_16x16x32_bf16 v[4:7], a[68:71], v[24:27], v[4:7]
 v_mfma_f32_16x16x32_bf16 v[8:11], a[72:75], v[24:27], v[8:11]
 s_waitcnt lgkmcnt(2)
 v_mfma_f32_16x16x32_bf16 v[0:3], a[76:79], v[28:31], v[0:3]
 ds_read_b128 v[24:27], v70 offset:24576
 v_mfma_f32_16x16x32_bf16 v[4:7], a[80:83], v[28:31], v[4:7]
 v_mfma_f32_16x16x32_bf16 v[8:11], a[84:87], v[28:31], v[8:11]
 s_waitcnt lgkmcnt(2)
 v_mfma_f32_16x16x32_bf16 v[0:3], a[88:91], v[32:35], v[0:3]
 ds_read_b128 v[28:31], v70 offset:25600
 v_mfma_f32_16x16x32_bf16 v[4:7], a[92:95], v[32:35], v[4:7]
 v_mfma_f32_16x16x32_bf16 v[8:11], a[96:99], v[32:35], v[8:11]
 s_waitcnt lgkmcnt(2)
 v_mfma_f32_16x16x32_bf16 v[0:3], a[100:103], v[36:39], v[0:3]
 ds_read_b128 v[32:35], v70 offset:26624
 v_mfma_f32_16x16x32_bf16 v[4:7], a[104:107], v[36:39], v[4:7]
 v_mfma_f32_16x16x32_bf16 v[8:11], a[108:111], v[36:39], v[8:11]
 s_waitcnt lgkmcnt(2)
 v_mfma_f32_16x16x32_bf16 v[0:3], a[112:115], v[24:27], v[0:3]
 ds_read_b128 v[36:39], v70 offset:27648
 v_mfma_f32_16x16x32_bf16 v[4:7], a[116:119], v[24:27], v[4:7]
 v_mfma_f32_16x16x32_bf16 v[8:11], a[120:123], v[24:27], v[8:11]
 s_waitcnt lgkmcnt(2)
 v_mfma_f32_16x16x32_bf16 v[0:3], a[124:127], v[28:31], v[0:3]
 ds_read_b128 v[24:27], v70 offset:28672
 v_mfma_f32_16x16x32_bf16 v[4:7], a[128:131], v[28:31], v[4:7]
 v_mfma_f32_16x16x32_bf16 v[8:11], a[132:135], v[28:31], v[8:11]
 s_waitcnt lgkmcnt(2)
 v_mfma_f32_16x16x32_bf16 v[0:3], a[136:139], v[32:35], v[0:3]
 ds_read_b128 v[28:31], v70 offset:29696
 v_mfma_f32_16x16x32_bf16 v[4:7], a[140:143], v[32:35], v[4:7]
 v_mfma_f32_16x16x32_bf16 v[8:11], a[144:147], v[32:35], v[8:11]
 s_waitcnt lgkmcnt(2)
 v_mfma_f32_16x16x32_bf16 v[0:3], a[148:151], v[36:39], v[0:3]
 ds_read_b128 v[32:35], v70 offset:30720
 v_mfma_f32_16x16x32_bf16 v[4:7], a[152:155], v[36:39], v[4:7]
 v_mfma_f32_16x16x32_bf16 v[8:11], a[156:159], v[36:39], v[8:11]
 s_waitcnt lgkmcnt(2)
 v_mfma_f32_16x16x32_bf16 v[0:3], a[160:163], v[24:27], v[0:3]
 ds_read_b128 v[36:39], v70 offset:31744
 v_mfma_f32_16x16x32_bf16 v[4:7], a[164:167], v[24:27], v[4:7]
 v_mfma_f32_16x16x32_bf16 v[8:11], a[168:171], v[24:27], v[8:11]
 s_waitcnt lgkmcnt(2)
 v_mfma_f32_16x16x32_bf16 v[0:3], a[172:175], v[28:31], v[0:3]
 ds_read_b128 v[24:27], v70 offset:32768
 v_mfma_f32_16x16x32_bf16 v[4:7], a[176:179], v[28:31], v[4:7]
 v_mfma_f32_16x16x32_bf16 v[8:11], a[180:183], v[28:31], v[8:11]
 s_waitcnt lgkmcnt(2)
 v_mfma_f32_16x16x32_bf16 v[0:3], a[184:187], v[32:35], v[0:3]
 ds_read_b128 v[28:31], v70 offset:33792
 v_mfma_f32_16x16x32_bf16 v[4:7], a[188:191], v[32:35], v[4:7]
 v_mfma_f32_16x16x32_bf16 v[8:11], a[192:195], v[32:35], v[8:11]
 s_waitcnt lgkmcnt(2)
 v_mfma_f32_16x16x32_bf16 v[0:3], a[196:199], v[36:39], v[0:3]
 ds_read_b128 v[32:35], v70 offset:34816
 v_mfma_f32_16x16x32_bf16 v[4:7], a[200:203], v[36:39], v[4:7]
 v_mfma_f32_16x16x32_bf16 v[8:11], a[204:207], v[36:39], v[8:11]
 s_waitcnt lgkmcnt(2)
 v_mfma_f32_16x16x32_bf16 v[0:3], a[208:211], v[24:27], v[0:3]
 ds_read_b128 v[36:39], v70 offset:35840
 v_mfma_f32_16x16x32_bf16 v[4:7], a[212:215], v[24:27], v[4:7]
 v_mfma_f32_16x16x32_bf16 v[8:11], a[216:219], v[24:27], v[8:11]
 s_waitcnt vmcnt(9)
 s_barrier
 s_waitcnt lgkmcnt(2)
 v_mfma_f32_16x16x32_bf16 v[0:3], a[220:223], v[28:31], v[0:3]
 ds_read_b128 v[24:27], v71 offset:0
 v_mfma_f32_16x16x32_bf16 v[4:7], a[224:227], v[28:31], v[4:7]
 s_add_u32 m0, m0, s3
 s_add_u32 s73, s73, s3
 v_mfma_f32_16x16x32_bf16 v[8:11], a[228:231], v[28:31], v[8:11]
 buffer_load_dwordx4 v72, s[8:11], s73 offen sc1 lds
 s_waitcnt lgkmcnt(2)
 v_mfma_f32_16x16x32_bf16 v[0:3], a[232:235], v[32:35], v[0:3]
 ds_read_b128 v[28:31], v71 offset:1024
 v_mfma_f32_16x16x32_bf16 v[4:7], a[236:239], v[32:35], v[4:7]
 v_mfma_f32_16x16x32_bf16 v[8:11], a[240:243], v[32:35], v[8:11]
 s_add_u32 m0, m0, s3
 s_add_u32 s73, s73, s3
 s_waitcnt lgkmcnt(2)
 v_mfma_f32_16x16x32_bf16 v[0:3], a[244:247], v[36:39], v[0:3]
 ds_read_b128 v[32:35], v71 offset:2048
 v_mfma_f32_16x16x32_bf16 v[4:7], a[248:251], v[36:39], v[4:7]
 buffer_load_dwordx4 v72, s[8:11], s73 offen sc1 lds
 v_mfma_f32_16x16x32_bf16 v[8:11], a[252:255], v[36:39], v[8:11]
 s_waitcnt lgkmcnt(2)
 v_mfma_f32_16x16x32_bf16 v[12:15], v[80:83], v[24:27], 0
 ds_read_b128 v[36:39], v71 offset:3072
 v_mfma_f32_16x16x32_bf16 v[16:19], v[84:87], v[24:27], 0
 v_mfma_f32_16x16x32_bf16 v[20:23], v[88:91], v[24:27], 0
 s_add_u32 m0, m0, s3
 s_add_u32 s73, s73, s3
 s_waitcnt lgkmcnt(2)
 v_mfma_f32_16x16x32_bf16 v[12:15], v[92:95], v[28:31], v[12:15]
 ds_read_b128 v[24:27], v71 offset:4096
 v_mfma_f32_16x16x32_bf16 v[16:19], v[96:99], v[28:31], v[16:19]
 buffer_load_dwordx4 v72, s[8:11], s73 offen sc1 lds
 v_mfma_f32_16x16x32_bf16 v[20:23], v[100:103], v[28:31], v[20:23]
 v_cvt_pk_bf16_f32 v48, v0, v1
 s_waitcnt lgkmcnt(2)
 v_mfma_f32_16x16x32_bf16 v[12:15], v[104:107], v[32:35], v[12:15]
 ds_read_b128 v[28:31], v71 offset:5120
 v_cvt_pk_bf16_f32 v49, v2, v3
 v_mfma_f32_16x16x32_bf16 v[16:19], v[108:111], v[32:35], v[16:19]
 s_add_u32 m0, m0, s3
 s_add_u32 s73, s73, s3
 v_mfma_f32_16x16x32_bf16 v[20:23], v[112:115], v[32:35], v[20:23]
 buffer_load_dwordx4 v72, s[8:11], s73 offen sc1 lds
 s_waitcnt lgkmcnt(2)
 v_mfma_f32_16x16x32_bf16 v[12:15], v[116:119], v[36:39], v[12:15]
 ds_read_b128 v[32:35], v71 offset:6144
 v_cvt_pk_bf16_f32 v50, v4, v5
 v_mfma_f32_16x16x32_bf16 v[16:19], v[120:123], v[36:39], v[16:19]
 v_cvt_pk_bf16_f32 v51, v6, v7
 v_cvt_pk_bf16_f32 v56, v8, v9
 v_mfma_f32_16x16x32_bf16 v[20:23], v[124:127], v[36:39], v[20:23]
 s_add_u32 m0, m0, s3
 s_add_u32 s73, s73, s3
 s_waitcnt lgkmcnt(2)
 v_mfma_f32_16x16x32_bf16 v[12:15], v[128:131], v[24:27], v[12:15]
 ds_read_b128 v[36:39], v71 offset:7168
 v_cvt_pk_bf16_f32 v57, v10, v11
 v_mfma_f32_16x16x32_bf16 v[16:19], v[132:135], v[24:27], v[16:19]
 buffer_load_dwordx4 v72, s[8:11], s73 offen sc1 lds
 v_mfma_f32_16x16x32_bf16 v[20:23], v[136:139], v[24:27], v[20:23]
 s_waitcnt lgkmcnt(2)
 v_mfma_f32_16x16x32_bf16 v[12:15], v[140:143], v[28:31], v[12:15]
 ds_read_b128 v[24:27], v71 offset:8192
 v_mfma_f32_16x16x32_bf16 v[16:19], v[144:147], v[28:31], v[16:19]
 v_mfma_f32_16x16x32_bf16 v[20:23], v[148:151], v[28:31], v[20:23]
 s_add_u32 m0, m0, s3
 s_add_u32 s73, s73, s3
 s_waitcnt lgkmcnt(2)
 v_mfma_f32_16x16x32_bf16 v[12:15], v[152:155], v[32:35], v[12:15]
 ds_read_b128 v[28:31], v71 offset:9216
 v_mfma_f32_16x16x32_bf16 v[16:19], v[156:159], v[32:35], v[16:19]
 buffer_load_dwordx4 v72, s[8:11], s73 offen sc1 lds
 v_mfma_f32_16x16x32_bf16 v[20:23], v[160:163], v[32:35], v[20:23]
 s_waitcnt lgkmcnt(2)
 v_mfma_f32_16x16x32_bf16 v[12:15], v[164:167], v[36:39], v[12:15]
 ds_read_b128 v[32:35], v71 offset:10240
 v_mfma_f32_16x16x32_bf16 v[16:19], v[168:171], v[36:39], v[16:19]
 s_add_u32 m0, m0, s3
 s_add_u32 s73, s73, s3
 v_mfma_f32_16x16x32_bf16 v[20:23], v[172:175], v[36:39], v[20:23]
 buffer_load_dwordx4 v72, s[8:11], s73 offen sc1 lds
 s_waitcnt lgkmcnt(2)
 v_mfma_f32_16x16x32_bf16 v[12:15], v[176:179], v[24:27], v[12:15]
 ds_read_b128 v[36:39], v71 offset:11264
 v_mfma_f32_16x16x32_bf16 v[16:19], v[180:183], v[24:27], v[16:19]
 v_mfma_f32_16x16x32_bf16 v[20:23], v[184:187], v[24:27], v[20:23]
 s_add_u32 m0, m0, s3
 s_add_u32 s73, s73, s3
 s_waitcnt lgkmcnt(2)
 v_mfma_f32_16x16x32_bf16 v[12:15], v[188:191], v[28:31], v[12:15]
 ds_read_b128 v[24:27], v71 offset:12288
 v_mfma_f32_16x16x32_bf16 v[16:19], v[192:195], v[28:31], v[16:19]
 buffer_load_dwordx4 v72, s[8:11], s73 offen sc1 lds
 v_mfma_f32_16x16x32_bf16 v[20:23], v[196:199], v[28:31], v[20:23]
 s_waitcnt lgkmcnt(2)
 v_mfma_f32_16x16x32_bf16 v[12:15], v[200:203], v[32:35], v[12:15]
 ds_read_b128 v[28:31], v71 offset:13312
 buffer_load_dword v75, v74, s[8:11], 0 offen sc1
 v_mfma_f32_16x16x32_bf16 v[16:19], v[204:207], v[32:35], v[16:19]
 v_mfma_f32_16x16x32_bf16 v[20:23], v[208:211], v[32:35], v[20:23]
 s_add_u32 m0, m0, s3
 s_add_u32 s73, s73, s3
 s_waitcnt lgkmcnt(2)
 v_mfma_f32_16x16x32_bf16 v[12:15], v[212:215], v[36:39], v[12:15]
 ds_read_b128 v[32:35], v71 offset:14336
 v_mfma_f32_16x16x32_bf16 v[16:19], v[216:219], v[36:39], v[16:19]
 buffer_load_dwordx4 v72, s[8:11], s73 offen sc1 lds
 v_mfma_f32_16x16x32_bf16 v[20:23], v[220:223], v[36:39], v[20:23]
 s_waitcnt lgkmcnt(2)
 v_mfma_f32_16x16x32_bf16 v[12:15], v[224:227], v[24:27], v[12:15]
 ds_read_b128 v[36:39], v71 offset:15360
 v_mfma_f32_16x16x32_bf16 v[16:19], v[228:231], v[24:27], v[16:19]
 v_mfma_f32_16x16x32_bf16 v[20:23], v[232:235], v[24:27], v[20:23]
 s_waitcnt lgkmcnt(2)
 v_mfma_f32_16x16x32_bf16 v[12:15], v[236:239], v[28:31], v[12:15]
 ds_read_b128 v[24:27], v71 offset:16384
 v_mfma_f32_16x16x32_bf16 v[16:19], v[240:243], v[28:31], v[16:19]
 buffer_store_dwordx4 v[48:51], v73, s[8:11], s77 offen offset:0
 v_mfma_f32_16x16x32_bf16 v[20:23], v[244:247], v[28:31], v[20:23]
 s_mov_b32 s5, s85
 s_sub_u32 s85, 0, s85
 s_waitcnt lgkmcnt(2)
 v_mfma_f32_16x16x32_bf16 v[12:15], v[248:251], v[32:35], v[12:15]
 ds_read_b128 v[28:31], v71 offset:17408
 s_add_u32 s70, s70, s85
 v_mfma_f32_16x16x32_bf16 v[16:19], v[252:255], v[32:35], v[16:19]
 s_mov_b32 s81, s77
 s_mov_b32 s82, s78
 s_mov_b32 s83, s79
 v_mfma_f32_16x16x32_bf16 v[20:23], a[0:3], v[32:35], v[20:23]
 s_mov_b32 s94, s92
 s_mov_b32 s95, s93
 s_waitcnt lgkmcnt(2)
 v_mfma_f32_16x16x32_bf16 v[12:15], a[4:7], v[36:39], v[12:15]
 ds_read_b128 v[32:35], v71 offset:18432
 s_mul_i32 s64, s68, 0
 v_mfma_f32_16x16x32_bf16 v[16:19], a[8:11], v[36:39], v[16:19]
 s_add_u32 s64, s64, 4
 s_mul_i32 s63, s68, 0
 v_mfma_f32_16x16x32_bf16 v[20:23], a[12:15], v[36:39], v[20:23]
 s_add_u32 s63, s63, 128
 s_waitcnt lgkmcnt(2)
 v_mfma_f32_16x16x32_bf16 v[12:15], a[16:19], v[24:27], v[12:15]
 ds_read_b128 v[36:39], v71 offset:19456
 s_mul_i32 s63, s69, s63
 v_mfma_f32_16x16x32_bf16 v[16:19], a[20:23], v[24:27], v[16:19]
 s_lshr_b32 s63, s63, 9
 s_mul_i32 s63, s63, s64
 s_sub_u32 s63, s69, s63
 v_mfma_f32_16x16x32_bf16 v[20:23], a[24:27], v[24:27], v[20:23]
 s_mul_i32 s63, s63, 294912
 s_waitcnt lgkmcnt(2)
 v_mfma_f32_16x16x32_bf16 v[12:15], a[28:31], v[28:31], v[12:15]
 ds_read_b128 v[24:27], v71 offset:20480
 s_mul_i32 s64, s68, 1179648
 v_mfma_f32_16x16x32_bf16 v[16:19], a[32:35], v[28:31], v[16:19]
 s_add_u32 s63, s63, s64
 s_add_u32 s77, s63, s87
 s_add_u32 s78, s63, s88
 v_mfma_f32_16x16x32_bf16 v[20:23], a[36:39], v[28:31], v[20:23]
 s_add_u32 s79, s63, s89
 s_waitcnt lgkmcnt(2)
 v_mfma_f32_16x16x32_bf16 v[12:15], a[40:43], v[32:35], v[12:15]
 ds_read_b128 v[28:31], v71 offset:21504
 s_mul_i32 s92, s68, 512
 v_mfma_f32_16x16x32_bf16 v[16:19], a[44:47], v[32:35], v[16:19]
 s_sub_u32 s93, s80, 1
 s_min_u32 s93, s93, 64
 s_add_u32 s61, s61, 1
 v_mfma_f32_16x16x32_bf16 v[20:23], a[48:51], v[32:35], v[20:23]
 s_waitcnt lgkmcnt(2)
 v_mfma_f32_16x16x32_bf16 v[12:15], a[52:55], v[36:39], v[12:15]
 ds_read_b128 v[32:35], v71 offset:22528
 v_mfma_f32_16x16x32_bf16 v[16:19], a[56:59], v[36:39], v[16:19]
 v_mfma_f32_16x16x32_bf16 v[20:23], a[60:63], v[36:39], v[20:23]
 s_waitcnt lgkmcnt(2)
 v_mfma_f32_16x16x32_bf16 v[12:15], a[64:67], v[24:27], v[12:15]
 ds_read_b128 v[36:39], v71 offset:23552
 v_mfma_f32_16x16x32_bf16 v[16:19], a[68:71], v[24:27], v[16:19]
 v_mfma_f32_16x16x32_bf16 v[20:23], a[72:75], v[24:27], v[20:23]
 s_waitcnt lgkmcnt(2)
 v_mfma_f32_16x16x32_bf16 v[12:15], a[76:79], v[28:31], v[12:15]
 ds_read_b128 v[24:27], v71 offset:24576
 v_mfma_f32_16x16x32_bf16 v[16:19], a[80:83], v[28:31], v[16:19]
 v_mfma_f32_16x16x32_bf16 v[20:23], a[84:87], v[28:31], v[20:23]
 s_waitcnt lgkmcnt(2)
 v_mfma_f32_16x16x32_bf16 v[12:15], a[88:91], v[32:35], v[12:15]
 ds_read_b128 v[28:31], v71 offset:25600
 v_mfma_f32_16x16x32_bf16 v[16:19], a[92:95], v[32:35], v[16:19]
 v_mfma_f32_16x16x32_bf16 v[20:23], a[96:99], v[32:35], v[20:23]
 s_waitcnt lgkmcnt(2)
 v_mfma_f32_16x16x32_bf16 v[12:15], a[100:103], v[36:39], v[12:15]
 ds_read_b128 v[32:35], v71 offset:26624
 v_mfma_f32_16x16x32_bf16 v[16:19], a[104:107], v[36:39], v[16:19]
 v_mfma_f32_16x16x32_bf16 v[20:23], a[108:111], v[36:39], v[20:23]
 s_waitcnt lgkmcnt(2)
 v_mfma_f32_16x16x32_bf16 v[12:15], a[112:115], v[24:27], v[12:15]
 ds_read_b128 v[36:39], v71 offset:27648
 v_mfma_f32_16x16x32_bf16 v[16:19], a[116:119], v[24:27], v[16:19]
 v_mfma_f32_16x16x32_bf16 v[20:23], a[120:123], v[24:27], v[20:23]
 s_waitcnt lgkmcnt(2)
 v_mfma_f32_16x16x32_bf16 v[12:15], a[124:127], v[28:31], v[12:15]
 ds_read_b128 v[24:27], v71 offset:28672
 v_mfma_f32_16x16x32_bf16 v[16:19], a[128:131], v[28:31], v[16:19]
 v_mfma_f32_16x16x32_bf16 v[20:23], a[132:135], v[28:31], v[20:23]
 s_waitcnt lgkmcnt(2)
 v_mfma_f32_16x16x32_bf16 v[12:15], a[136:139], v[32:35], v[12:15]
 ds_read_b128 v[28:31], v71 offset:29696
 v_mfma_f32_16x16x32_bf16 v[16:19], a[140:143], v[32:35], v[16:19]
 v_mfma_f32_16x16x32_bf16 v[20:23], a[144:147], v[32:35], v[20:23]
 s_waitcnt lgkmcnt(2)
 v_mfma_f32_16x16x32_bf16 v[12:15], a[148:151], v[36:39], v[12:15]
 ds_read_b128 v[32:35], v71 offset:30720
 v_mfma_f32_16x16x32_bf16 v[16:19], a[152:155], v[36:39], v[16:19]
 v_mfma_f32_16x16x32_bf16 v[20:23], a[156:159], v[36:39], v[20:23]
 s_waitcnt lgkmcnt(2)
 v_mfma_f32_16x16x32_bf16 v[12:15], a[160:163], v[24:27], v[12:15]
 ds_read_b128 v[36:39], v71 offset:31744
 v_mfma_f32_16x16x32_bf16 v[16:19], a[164:167], v[24:27], v[16:19]
 v_mfma_f32_16x16x32_bf16 v[20:23], a[168:171], v[24:27], v[20:23]
 s_waitcnt vmcnt(2)
 v_add_u32 v64, v65, v75
 v_cmp_gt_u32 vcc, s74, v64
 s_waitcnt lgkmcnt(2)
 v_mfma_f32_16x16x32_bf16 v[12:15], a[172:175], v[28:31], v[12:15]
 ds_read_b128 v[24:27], v71 offset:32768
 v_cmp_gt_u32 s[66:67], s75, v64
 v_mfma_f32_16x16x32_bf16 v[16:19], a[176:179], v[28:31], v[16:19]
 v_mfma_f32_16x16x32_bf16 v[20:23], a[180:183], v[28:31], v[20:23]
 s_waitcnt lgkmcnt(2)
 v_mfma_f32_16x16x32_bf16 v[12:15], a[184:187], v[32:35], v[12:15]
 ds_read_b128 v[28:31], v71 offset:33792
 s_cmp_eq_u32 s67, 0
 s_cselect_b32 s72, 2, 0
 s_cmp_eq_u32 vcc_lo, 0
 s_cselect_b32 s72, 1, s72
 v_mfma_f32_16x16x32_bf16 v[16:19], a[188:191], v[32:35], v[16:19]
 v_mov_b32 v76, s72
 v_mfma_f32_16x16x32_bf16 v[20:23], a[192:195], v[32:35], v[20:23]
 ds_write_b32 v72, v76 offset:4
 s_waitcnt lgkmcnt(3)
 v_mfma_f32_16x16x32_bf16 v[12:15], a[196:199], v[36:39], v[12:15]
 ds_read_b128 v[32:35], v71 offset:34816
 v_mfma_f32_16x16x32_bf16 v[16:19], a[200:203], v[36:39], v[16:19]
 v_mfma_f32_16x16x32_bf16 v[20:23], a[204:207], v[36:39], v[20:23]
 s_waitcnt lgkmcnt(3)
 v_mfma_f32_16x16x32_bf16 v[12:15], a[208:211], v[24:27], v[12:15]
 ds_read_b128 v[36:39], v71 offset:35840
 v_mfma_f32_16x16x32_bf16 v[16:19], a[212:215], v[24:27], v[16:19]
 v_mfma_f32_16x16x32_bf16 v[20:23], a[216:219], v[24:27], v[20:23]
 s_waitcnt lgkmcnt(2)
 s_branch L_dn_fe
L_dn_p0e:
 s_waitcnt lgkmcnt(2)
 v_mfma_f32_16x16x32_bf16 v[0:3], v[80:83], v[24:27], 0
 ds_read_b128 v[36:39], v70 offset:3072
 v_mfma_f32_16x16x32_bf16 v[4:7], v[84:87], v[24:27], 0
 v_mfma_f32_16x16x32_bf16 v[8:11], v[88:91], v[24:27], 0
 s_waitcnt lgkmcnt(2)
 v_mfma_f32_16x16x32_bf16 v[0:3], v[92:95], v[28:31], v[0:3]
 ds_read_b128 v[24:27], v70 offset:4096
 v_mfma_f32_16x16x32_bf16 v[4:7], v[96:99], v[28:31], v[4:7]
 v_cvt_pk_bf16_f32 v58, v20, v21
 v_cvt_pk_bf16_f32 v59, v22, v23
 v_mfma_f32_16x16x32_bf16 v[8:11], v[100:103], v[28:31], v[8:11]
 v_cvt_pk_bf16_f32 v52, v12, v13
 s_waitcnt lgkmcnt(2)
 v_mfma_f32_16x16x32_bf16 v[0:3], v[104:107], v[32:35], v[0:3]
 ds_read_b128 v[28:31], v70 offset:5120
 v_cvt_pk_bf16_f32 v53, v14, v15
 v_mfma_f32_16x16x32_bf16 v[4:7], v[108:111], v[32:35], v[4:7]
 v_cvt_pk_bf16_f32 v54, v16, v17
 v_cvt_pk_bf16_f32 v55, v18, v19
 v_mfma_f32_16x16x32_bf16 v[8:11], v[112:115], v[32:35], v[8:11]
 s_waitcnt lgkmcnt(2)
 v_mfma_f32_16x16x32_bf16 v[0:3], v[116:119], v[36:39], v[0:3]
 ds_read_b128 v[32:35], v70 offset:6144
 v_mfma_f32_16x16x32_bf16 v[4:7], v[120:123], v[36:39], v[4:7]
 buffer_store_dwordx4 v[52:55], v73, s[8:11], s81 offen offset:1024
 v_mfma_f32_16x16x32_bf16 v[8:11], v[124:127], v[36:39], v[8:11]
 s_waitcnt lgkmcnt(2)
 v_mfma_f32_16x16x32_bf16 v[0:3], v[128:131], v[24:27], v[0:3]
 ds_read_b128 v[36:39], v70 offset:7168
 v_mfma_f32_16x16x32_bf16 v[4:7], v[132:135], v[24:27], v[4:7]
 v_permlane32_swap_b32 v56, v58
 v_mfma_f32_16x16x32_bf16 v[8:11], v[136:139], v[24:27], v[8:11]
 s_waitcnt lgkmcnt(2)
 v_mfma_f32_16x16x32_bf16 v[0:3], v[140:143], v[28:31], v[0:3]
 ds_read_b128 v[24:27], v70 offset:8192
 v_mfma_f32_16x16x32_bf16 v[4:7], v[144:147], v[28:31], v[4:7]
 v_permlane32_swap_b32 v57, v59
 v_mfma_f32_16x16x32_bf16 v[8:11], v[148:151], v[28:31], v[8:11]
 s_waitcnt lgkmcnt(2)
 v_mfma_f32_16x16x32_bf16 v[0:3], v[152:155], v[32:35], v[0:3]
 ds_read_b128 v[28:31], v70 offset:9216
 v_mfma_f32_16x16x32_bf16 v[4:7], v[156:159], v[32:35], v[4:7]
 buffer_store_dwordx4 v[56:59], v73, s[8:11], s81 offen offset:2048
 v_mfma_f32_16x16x32_bf16 v[8:11], v[160:163], v[32:35], v[8:11]
 s_waitcnt lgkmcnt(2)
 v_mfma_f32_16x16x32_bf16 v[0:3], v[164:167], v[36:39], v[0:3]
 ds_read_b128 v[32:35], v70 offset:10240
 v_mfma_f32_16x16x32_bf16 v[4:7], v[168:171], v[36:39], v[4:7]
 v_mfma_f32_16x16x32_bf16 v[8:11], v[172:175], v[36:39], v[8:11]
 s_waitcnt lgkmcnt(2)
 v_mfma_f32_16x16x32_bf16 v[0:3], v[176:179], v[24:27], v[0:3]
 ds_read_b128 v[36:39], v70 offset:11264
 v_mfma_f32_16x16x32_bf16 v[4:7], v[180:183], v[24:27], v[4:7]
 v_mfma_f32_16x16x32_bf16 v[8:11], v[184:187], v[24:27], v[8:11]
 s_waitcnt lgkmcnt(2)
 v_mfma_f32_16x16x32_bf16 v[0:3], v[188:191], v[28:31], v[0:3]
 ds_read_b128 v[24:27], v70 offset:12288
 v_mfma_f32_16x16x32_bf16 v[4:7], v[192:195], v[28:31], v[4:7]
 v_mfma_f32_16x16x32_bf16 v[8:11], v[196:199], v[28:31], v[8:11]
 s_waitcnt lgkmcnt(2)
 v_mfma_f32_16x16x32_bf16 v[0:3], v[200:203], v[32:35], v[0:3]
 ds_read_b128 v[28:31], v70 offset:13312
 v_mfma_f32_16x16x32_bf16 v[4:7], v[204:207], v[32:35], v[4:7]
 v_mfma_f32_16x16x32_bf16 v[8:11], v[208:211], v[32:35], v[8:11]
 s_waitcnt lgkmcnt(2)
 v_mfma_f32_16x16x32_bf16 v[0:3], v[212:215], v[36:39], v[0:3]
 ds_read_b128 v[32:35], v70 offset:14336
 v_mfma_f32_16x16x32_bf16 v[4:7], v[216:219], v[36:39], v[4:7]
 v_mfma_f32_16x16x32_bf16 v[8:11], v[220:223], v[36:39], v[8:11]
 s_waitcnt lgkmcnt(2)
 v_mfma_f32_16x16x32_bf16 v[0:3], v[224:227], v[24:27], v[0:3]
 ds_read_b128 v[36:39], v70 offset:15360
 v_mfma_f32_16x16x32_bf16 v[4:7], v[228:231], v[24:27], v[4:7]
 v_mfma_f32_16x16x32_bf16 v[8:11], v[232:235], v[24:27], v[8:11]
 s_waitcnt lgkmcnt(2)
 v_mfma_f32_16x16x32_bf16 v[0:3], v[236:239], v[28:31], v[0:3]
 ds_read_b128 v[24:27], v70 offset:16384
 v_mfma_f32_16x16x32_bf16 v[4:7], v[240:243], v[28:31], v[4:7]
 buffer_load_dword v75, v74, s[8:11], 0 offen sc1
 v_mov_b32 v76, s95
 v_mfma_f32_16x16x32_bf16 v[8:11], v[244:247], v[28:31], v[8:11]
 s_waitcnt vmcnt(1)
 s_barrier
 buffer_store_dword v76, v77, s[8:11], s94 offen
 s_waitcnt lgkmcnt(2)
 v_mfma_f32_16x16x32_bf16 v[0:3], v[248:251], v[32:35], v[0:3]
 ds_read_b128 v[28:31], v70 offset:17408
 v_mfma_f32_16x16x32_bf16 v[4:7], v[252:255], v[32:35], v[4:7]
 v_mfma_f32_16x16x32_bf16 v[8:11], a[0:3], v[32:35], v[8:11]
 s_waitcnt lgkmcnt(2)
 v_mfma_f32_16x16x32_bf16 v[0:3], a[4:7], v[36:39], v[0:3]
 ds_read_b128 v[32:35], v70 offset:18432
 v_mfma_f32_16x16x32_bf16 v[4:7], a[8:11], v[36:39], v[4:7]
 v_mfma_f32_16x16x32_bf16 v[8:11], a[12:15], v[36:39], v[8:11]
 s_waitcnt lgkmcnt(2)
 v_mfma_f32_16x16x32_bf16 v[0:3], a[16:19], v[24:27], v[0:3]
 ds_read_b128 v[36:39], v70 offset:19456
 v_mfma_f32_16x16x32_bf16 v[4:7], a[20:23], v[24:27], v[4:7]
 v_mfma_f32_16x16x32_bf16 v[8:11], a[24:27], v[24:27], v[8:11]
 s_waitcnt lgkmcnt(2)
 v_mfma_f32_16x16x32_bf16 v[0:3], a[28:31], v[28:31], v[0:3]
 ds_read_b128 v[24:27], v70 offset:20480
 v_mfma_f32_16x16x32_bf16 v[4:7], a[32:35], v[28:31], v[4:7]
 v_mfma_f32_16x16x32_bf16 v[8:11], a[36:39], v[28:31], v[8:11]
 s_waitcnt lgkmcnt(2)
 v_mfma_f32_16x16x32_bf16 v[0:3], a[40:43], v[32:35], v[0:3]
 ds_read_b128 v[28:31], v70 offset:21504
 v_mfma_f32_16x16x32_bf16 v[4:7], a[44:47], v[32:35], v[4:7]
 v_mfma_f32_16x16x32_bf16 v[8:11], a[48:51], v[32:35], v[8:11]
 s_waitcnt lgkmcnt(2)
 v_mfma_f32_16x16x32_bf16 v[0:3], a[52:55], v[36:39], v[0:3]
 ds_read_b128 v[32:35], v70 offset:22528
 v_mfma_f32_16x16x32_bf16 v[4:7], a[56:59], v[36:39], v[4:7]
 v_mfma_f32_16x16x32_bf16 v[8:11], a[60:63], v[36:39], v[8:11]
 s_waitcnt lgkmcnt(2)
 v_mfma_f32_16x16x32_bf16 v[0:3], a[64:67], v[24:27], v[0:3]
 ds_read_b128 v[36:39], v70 offset:23552
 v_mfma_f32_16x16x32_bf16 v[4:7], a[68:71], v[24:27], v[4:7]
 v_mfma_f32_16x16x32_bf16 v[8:11], a[72:75], v[24:27], v[8:11]
 s_waitcnt lgkmcnt(2)
 v_mfma_f32_16x16x32_bf16 v[0:3], a[76:79], v[28:31], v[0:3]
 ds_read_b128 v[24:27], v70 offset:24576
 v_mfma_f32_16x16x32_bf16 v[4:7], a[80:83], v[28:31], v[4:7]
 v_mfma_f32_16x16x32_bf16 v[8:11], a[84:87], v[28:31], v[8:11]
 s_waitcnt lgkmcnt(2)
 v_mfma_f32_16x16x32_bf16 v[0:3], a[88:91], v[32:35], v[0:3]
 ds_read_b128 v[28:31], v70 offset:25600
 v_mfma_f32_16x16x32_bf16 v[4:7], a[92:95], v[32:35], v[4:7]
 v_mfma_f32_16x16x32_bf16 v[8:11], a[96:99], v[32:35], v[8:11]
 s_waitcnt lgkmcnt(2)
 v_mfma_f32_16x16x32_bf16 v[0:3], a[100:103], v[36:39], v[0:3]
 ds_read_b128 v[32:35], v70 offset:26624
 v_mfma_f32_16x16x32_bf16 v[4:7], a[104:107], v[36:39], v[4:7]
 v_mfma_f32_16x16x32_bf16 v[8:11], a[108:111], v[36:39], v[8:11]
 s_waitcnt lgkmcnt(2)
 v_mfma_f32_16x16x32_bf16 v[0:3], a[112:115], v[24:27], v[0:3]
 ds_read_b128 v[36:39], v70 offset:27648
 v_mfma_f32_16x16x32_bf16 v[4:7], a[116:119], v[24:27], v[4:7]
 v_mfma_f32_16x16x32_bf16 v[8:11], a[120:123], v[24:27], v[8:11]
 s_waitcnt lgkmcnt(2)
 v_mfma_f32_16x16x32_bf16 v[0:3], a[124:127], v[28:31], v[0:3]
 ds_read_b128 v[24:27], v70 offset:28672
 v_mfma_f32_16x16x32_bf16 v[4:7], a[128:131], v[28:31], v[4:7]
 v_mfma_f32_16x16x32_bf16 v[8:11], a[132:135], v[28:31], v[8:11]
 s_waitcnt lgkmcnt(2)
 v_mfma_f32_16x16x32_bf16 v[0:3], a[136:139], v[32:35], v[0:3]
 ds_read_b128 v[28:31], v70 offset:29696
 v_mfma_f32_16x16x32_bf16 v[4:7], a[140:143], v[32:35], v[4:7]
 v_mfma_f32_16x16x32_bf16 v[8:11], a[144:147], v[32:35], v[8:11]
 s_waitcnt lgkmcnt(2)
 v_mfma_f32_16x16x32_bf16 v[0:3], a[148:151], v[36:39], v[0:3]
 ds_read_b128 v[32:35], v70 offset:30720
 v_mfma_f32_16x16x32_bf16 v[4:7], a[152:155], v[36:39], v[4:7]
 v_mfma_f32_16x16x32_bf16 v[8:11], a[156:159], v[36:39], v[8:11]
 s_waitcnt lgkmcnt(2)
 v_mfma_f32_16x16x32_bf16 v[0:3], a[160:163], v[24:27], v[0:3]
 ds_read_b128 v[36:39], v70 offset:31744
 v_mfma_f32_16x16x32_bf16 v[4:7], a[164:167], v[24:27], v[4:7]
 v_mfma_f32_16x16x32_bf16 v[8:11], a[168:171], v[24:27], v[8:11]
 s_waitcnt vmcnt(1)
 v_add_u32 v64, v65, v75
 v_cmp_gt_u32 vcc, s74, v64
 s_waitcnt lgkmcnt(2)
 v_mfma_f32_16x16x32_bf16 v[0:3], a[172:175], v[28:31], v[0:3]
 ds_read_b128 v[24:27], v70 offset:32768
 v_cmp_gt_u32 s[66:67], s75, v64
 v_mfma_f32_16x16x32_bf16 v[4:7], a[176:179], v[28:31], v[4:7]
 v_mfma_f32_16x16x32_bf16 v[8:11], a[180:183], v[28:31], v[8:11]
 s_waitcnt lgkmcnt(2)
 v_mfma_f32_16x16x32_bf16 v[0:3], a[184:187], v[32:35], v[0:3]
 ds_read_b128 v[28:31], v70 offset:33792
 s_cmp_eq_u32 s67, 0
 s_cselect_b32 s72, 2, 0
 s_cmp_eq_u32 vcc_lo, 0
 s_cselect_b32 s72, 1, s72
 v_mfma_f32_16x16x32_bf16 v[4:7], a[188:191], v[32:35], v[4:7]
 v_mov_b32 v76, s72
 v_mfma_f32_16x16x32_bf16 v[8:11], a[192:195], v[32:35], v[8:11]
 ds_write_b32 v72, v76 offset:0
 s_waitcnt lgkmcnt(3)
 v_mfma_f32_16x16x32_bf16 v[0:3], a[196:199], v[36:39], v[0:3]
 ds_read_b128 v[32:35], v70 offset:34816
 v_mfma_f32_16x16x32_bf16 v[4:7], a[200:203], v[36:39], v[4:7]
 v_mfma_f32_16x16x32_bf16 v[8:11], a[204:207], v[36:39], v[8:11]
 s_waitcnt lgkmcnt(3)
 v_mfma_f32_16x16x32_bf16 v[0:3], a[208:211], v[24:27], v[0:3]
 ds_read_b128 v[36:39], v70 offset:35840
 v_mfma_f32_16x16x32_bf16 v[4:7], a[212:215], v[24:27], v[4:7]
 v_mfma_f32_16x16x32_bf16 v[8:11], a[216:219], v[24:27], v[8:11]
 s_waitcnt vmcnt(4)
 s_waitcnt lgkmcnt(2)
 s_barrier
 ds_read_b32 v76, v73 offset:0
 v_mfma_f32_16x16x32_bf16 v[0:3], a[220:223], v[28:31], v[0:3]
 ds_read_b128 v[24:27], v71 offset:0
 v_mfma_f32_16x16x32_bf16 v[4:7], a[224:227], v[28:31], v[4:7]
 v_mfma_f32_16x16x32_bf16 v[8:11], a[228:231], v[28:31], v[8:11]
 s_waitcnt lgkmcnt(3)
 v_mfma_f32_16x16x32_bf16 v[0:3], a[232:235], v[32:35], v[0:3]
 ds_read_b128 v[28:31], v71 offset:1024
 v_mfma_f32_16x16x32_bf16 v[4:7], a[236:239], v[32:35], v[4:7]
 v_mfma_f32_16x16x32_bf16 v[8:11], a[240:243], v[32:35], v[8:11]
 s_waitcnt lgkmcnt(2)
 v_readfirstlane_b32 s72, v76
 v_mfma_f32_16x16x32_bf16 v[0:3], a[244:247], v[36:39], v[0:3]
 ds_read_b128 v[32:35], v71 offset:2048
 v_mfma_f32_16x16x32_bf16 v[4:7], a[248:251], v[36:39], v[4:7]
 v_mfma_f32_16x16x32_bf16 v[8:11], a[252:255], v[36:39], v[8:11]
 s_cmp_lg_u32 s72, 0
 s_cbranch_scc1 L_dn_p1d
 s_branch L_dn_p1n
L_dn_p1d:
 s_waitcnt lgkmcnt(2)
 v_mfma_f32_16x16x32_bf16 v[12:15], v[80:83], v[24:27], 0
 ds_read_b128 v[36:39], v71 offset:3072
 buffer_load_dword v75, v74, s[8:11], 0 offen sc1
 v_mfma_f32_16x16x32_bf16 v[16:19], v[84:87], v[24:27], 0
 s_sub_u32 s68, s72, 1
 s_cmp_eq_u32 s68, 0
 s_cselect_b32 s69, s74, s75
 s_cselect_b32 s63, s44, s47
 s_cselect_b32 s64, s45, s48
 s_cselect_b32 s80, s46, s49
 v_mfma_f32_16x16x32_bf16 v[20:23], v[88:91], v[24:27], 0
 s_cmp_lt_u32 s69, s63
 s_cselect_b32 s80, s64, s80
 s_add_u32 s80, s80, s69
 s_waitcnt lgkmcnt(2)
 v_mfma_f32_16x16x32_bf16 v[12:15], v[92:95], v[28:31], v[12:15]
 ds_read_b128 v[24:27], v71 offset:4096
 s_cmp_eq_u32 s68, 0
 s_cselect_b32 s74, s80, s74
 s_cselect_b32 s75, s75, s80
 v_mfma_f32_16x16x32_bf16 v[16:19], v[96:99], v[28:31], v[16:19]
 s_mul_i32 s73, s69, 294912
 s_mul_i32 s63, s68, 18874368
 s_add_u32 s73, s73, s63
 s_add_u32 s73, s73, s90
 v_mfma_f32_16x16x32_bf16 v[20:23], v[100:103], v[28:31], v[20:23]
 s_mov_b32 m0, s70
 s_waitcnt lgkmcnt(2)
 v_mfma_f32_16x16x32_bf16 v[12:15], v[104:107], v[32:35], v[12:15]
 ds_read_b128 v[28:31], v71 offset:5120
 v_cvt_pk_bf16_f32 v48, v0, v1
 v_mfma_f32_16x16x32_bf16 v[16:19], v[108:111], v[32:35], v[16:19]
 buffer_load_dwordx4 v72, s[8:11], s73 offen sc1 lds
 v_mfma_f32_16x16x32_bf16 v[20:23], v[112:115], v[32:35], v[20:23]
 v_cvt_pk_bf16_f32 v49, v2, v3
 s_waitcnt lgkmcnt(2)
 v_mfma_f32_16x16x32_bf16 v[12:15], v[116:119], v[36:39], v[12:15]
 ds_read_b128 v[32:35], v71 offset:6144
 v_cvt_pk_bf16_f32 v50, v4, v5
 v_mfma_f32_16x16x32_bf16 v[16:19], v[120:123], v[36:39], v[16:19]
 s_add_u32 m0, m0, s3
 s_add_u32 s73, s73, s3
 v_mfma_f32_16x16x32_bf16 v[20:23], v[124:127], v[36:39], v[20:23]
 buffer_load_dwordx4 v72, s[8:11], s73 offen sc1 lds
 s_waitcnt lgkmcnt(2)
 v_mfma_f32_16x16x32_bf16 v[12:15], v[128:131], v[24:27], v[12:15]
 ds_read_b128 v[36:39], v71 offset:7168
 v_cvt_pk_bf16_f32 v51, v6, v7
 v_mfma_f32_16x16x32_bf16 v[16:19], v[132:135], v[24:27], v[16:19]
 buffer_store_dwordx4 v[48:51], v73, s[8:11], s77 offen offset:0
 v_mfma_f32_16x16x32_bf16 v[20:23], v[136:139], v[24:27], v[20:23]
 s_add_u32 m0, m0, s3
 s_add_u32 s73, s73, s3
 s_waitcnt lgkmcnt(2)
 v_mfma_f32_16x16x32_bf16 v[12:15], v[140:143], v[28:31], v[12:15]
 ds_read_b128 v[24:27], v71 offset:8192
 v_cvt_pk_bf16_f32 v56, v8, v9
 v_mfma_f32_16x16x32_bf16 v[16:19], v[144:147], v[28:31], v[16:19]
 buffer_load_dwordx4 v72, s[8:11], s73 offen sc1 lds
 v_mfma_f32_16x16x32_bf16 v[20:23], v[148:151], v[28:31], v[20:23]
 v_cvt_pk_bf16_f32 v57, v10, v11
 s_waitcnt lgkmcnt(2)
 v_mfma_f32_16x16x32_bf16 v[12:15], v[152:155], v[32:35], v[12:15]
 ds_read_b128 v[28:31], v71 offset:9216
 v_mfma_f32_16x16x32_bf16 v[16:19], v[156:159], v[32:35], v[16:19]
 v_mfma_f32_16x16x32_bf16 v[20:23], v[160:163], v[32:35], v[20:23]
 s_add_u32 m0, m0, s3
 s_add_u32 s73, s73, s3
 s_waitcnt lgkmcnt(2)
 v_mfma_f32_16x16x32_bf16 v[12:15], v[164:167], v[36:39], v[12:15]
 ds_read_b128 v[32:35], v71 offset:10240
 v_mfma_f32_16x16x32_bf16 v[16:19], v[168:171], v[36:39], v[16:19]
 buffer_load_dwordx4 v72, s[8:11], s73 offen sc1 lds
 v_mfma_f32_16x16x32_bf16 v[20:23], v[172:175], v[36:39], v[20:23]
 s_waitcnt lgkmcnt(2)
 v_mfma_f32_16x16x32_bf16 v[12:15], v[176:179], v[24:27], v[12:15]
 ds_read_b128 v[36:39], v71 offset:11264
 v_mfma_f32_16x16x32_bf16 v[16:19], v[180:183], v[24:27], v[16:19]
 s_add_u32 m0, m0, s3
 s_add_u32 s73, s73, s3
 v_mfma_f32_16x16x32_bf16 v[20:23], v[184:187], v[24:27], v[20:23]
 buffer_load_dwordx4 v72, s[8:11], s73 offen sc1 lds
 s_waitcnt lgkmcnt(2)
 v_mfma_f32_16x16x32_bf16 v[12:15], v[188:191], v[28:31], v[12:15]
 ds_read_b128 v[24:27], v71 offset:12288
 v_mfma_f32_16x16x32_bf16 v[16:19], v[192:195], v[28:31], v[16:19]
 v_mfma_f32_16x16x32_bf16 v[20:23], v[196:199], v[28:31], v[20:23]
 s_add_u32 m0, m0, s3
 s_add_u32 s73, s73, s3
 s_waitcnt lgkmcnt(2)
 v_mfma_f32_16x16x32_bf16 v[12:15], v[200:203], v[32:35], v[12:15]
 ds_read_b128 v[28:31], v71 offset:13312
 v_mfma_f32_16x16x32_bf16 v[16:19], v[204:207], v[32:35], v[16:19]
 buffer_load_dwordx4 v72, s[8:11], s73 offen sc1 lds
 v_mfma_f32_16x16x32_bf16 v[20:23], v[208:211], v[32:35], v[20:23]
 s_waitcnt lgkmcnt(2)
 v_mfma_f32_16x16x32_bf16 v[12:15], v[212:215], v[36:39], v[12:15]
 ds_read_b128 v[32:35], v71 offset:14336
 v_mfma_f32_16x16x32_bf16 v[16:19], v[216:219], v[36:39], v[16:19]
 v_mfma_f32_16x16x32_bf16 v[20:23], v[220:223], v[36:39], v[20:23]
 s_add_u32 m0, m0, s3
 s_add_u32 s73, s73, s3
 s_waitcnt lgkmcnt(2)
 v_mfma_f32_16x16x32_bf16 v[12:15], v[224:227], v[24:27], v[12:15]
 ds_read_b128 v[36:39], v71 offset:15360
 v_mfma_f32_16x16x32_bf16 v[16:19], v[228:231], v[24:27], v[16:19]
 buffer_load_dwordx4 v72, s[8:11], s73 offen sc1 lds
 v_mfma_f32_16x16x32_bf16 v[20:23], v[232:235], v[24:27], v[20:23]
 s_waitcnt lgkmcnt(2)
 v_mfma_f32_16x16x32_bf16 v[12:15], v[236:239], v[28:31], v[12:15]
 ds_read_b128 v[24:27], v71 offset:16384
 v_mfma_f32_16x16x32_bf16 v[16:19], v[240:243], v[28:31], v[16:19]
 s_add_u32 m0, m0, s3
 s_add_u32 s73, s73, s3
 v_mfma_f32_16x16x32_bf16 v[20:23], v[244:247], v[28:31], v[20:23]
 buffer_load_dwordx4 v72, s[8:11], s73 offen sc1 lds
 s_waitcnt lgkmcnt(2)
 v_mfma_f32_16x16x32_bf16 v[12:15], v[248:251], v[32:35], v[12:15]
 ds_read_b128 v[28:31], v71 offset:17408
 v_mfma_f32_16x16x32_bf16 v[16:19], v[252:255], v[32:35], v[16:19]
 v_mfma_f32_16x16x32_bf16 v[20:23], a[0:3], v[32:35], v[20:23]
 s_add_u32 m0, m0, s3
 s_add_u32 s73, s73, s3
 s_waitcnt lgkmcnt(2)
 v_mfma_f32_16x16x32_bf16 v[12:15], a[4:7], v[36:39], v[12:15]
 ds_read_b128 v[32:35], v71 offset:18432
 v_mfma_f32_16x16x32_bf16 v[16:19], a[8:11], v[36:39], v[16:19]
 buffer_load_dwordx4 v72, s[8:11], s73 offen sc1 lds
 v_mfma_f32_16x16x32_bf16 v[20:23], a[12:15], v[36:39], v[20:23]
 s_waitcnt lgkmcnt(2)
 v_mfma_f32_16x16x32_bf16 v[12:15], a[16:19], v[24:27], v[12:15]
 ds_read_b128 v[36:39], v71 offset:19456
 v_mfma_f32_16x16x32_bf16 v[16:19], a[20:23], v[24:27], v[16:19]
 v_mfma_f32_16x16x32_bf16 v[20:23], a[24:27], v[24:27], v[20:23]
 s_add_u32 m0, m0, s3
 s_add_u32 s73, s73, s3
 s_waitcnt lgkmcnt(2)
 v_mfma_f32_16x16x32_bf16 v[12:15], a[28:31], v[28:31], v[12:15]
 ds_read_b128 v[24:27], v71 offset:20480
 v_mfma_f32_16x16x32_bf16 v[16:19], a[32:35], v[28:31], v[16:19]
 buffer_load_dwordx4 v72, s[8:11], s73 offen sc1 lds
 v_mfma_f32_16x16x32_bf16 v[20:23], a[36:39], v[28:31], v[20:23]
 s_waitcnt lgkmcnt(2)
 v_mfma_f32_16x16x32_bf16 v[12:15], a[40:43], v[32:35], v[12:15]
 ds_read_b128 v[28:31], v71 offset:21504
 v_mfma_f32_16x16x32_bf16 v[16:19], a[44:47], v[32:35], v[16:19]
 s_add_u32 m0, m0, s3
 s_add_u32 s73, s73, s3
 v_mfma_f32_16x16x32_bf16 v[20:23], a[48:51], v[32:35], v[20:23]
 buffer_load_dwordx4 v72, s[8:11], s73 offen sc1 lds
 s_waitcnt lgkmcnt(2)
 v_mfma_f32_16x16x32_bf16 v[12:15], a[52:55], v[36:39], v[12:15]
 ds_read_b128 v[32:35], v71 offset:22528
 v_mfma_f32_16x16x32_bf16 v[16:19], a[56:59], v[36:39], v[16:19]
 v_mfma_f32_16x16x32_bf16 v[20:23], a[60:63], v[36:39], v[20:23]
 s_add_u32 m0, m0, s3
 s_add_u32 s73, s73, s3
 s_waitcnt lgkmcnt(2)
 v_mfma_f32_16x16x32_bf16 v[12:15], a[64:67], v[24:27], v[12:15]
 ds_read_b128 v[36:39], v71 offset:23552
 v_mfma_f32_16x16x32_bf16 v[16:19], a[68:71], v[24:27], v[16:19]
 buffer_load_dwordx4 v72, s[8:11], s73 offen sc1 lds
 v_mfma_f32_16x16x32_bf16 v[20:23], a[72:75], v[24:27], v[20:23]
 s_waitcnt lgkmcnt(2)
 v_mfma_f32_16x16x32_bf16 v[12:15], a[76:79], v[28:31], v[12:15]
 ds_read_b128 v[24:27], v71 offset:24576
 v_mfma_f32_16x16x32_bf16 v[16:19], a[80:83], v[28:31], v[16:19]
 v_mfma_f32_16x16x32_bf16 v[20:23], a[84:87], v[28:31], v[20:23]
 s_add_u32 m0, m0, s3
 s_add_u32 s73, s73, s3
 s_waitcnt lgkmcnt(2)
 v_mfma_f32_16x16x32_bf16 v[12:15], a[88:91], v[32:35], v[12:15]
 ds_read_b128 v[28:31], v71 offset:25600
 v_mfma_f32_16x16x32_bf16 v[16:19], a[92:95], v[32:35], v[16:19]
 buffer_load_dwordx4 v72, s[8:11], s73 offen sc1 lds
 v_mfma_f32_16x16x32_bf16 v[20:23], a[96:99], v[32:35], v[20:23]
 s_waitcnt lgkmcnt(2)
 v_mfma_f32_16x16x32_bf16 v[12:15], a[100:103], v[36:39], v[12:15]
 ds_read_b128 v[32:35], v71 offset:26624
 v_mfma_f32_16x16x32_bf16 v[16:19], a[104:107], v[36:39], v[16:19]
 s_add_u32 m0, m0, s3
 s_add_u32 s73, s73, s3
 v_mfma_f32_16x16x32_bf16 v[20:23], a[108:111], v[36:39], v[20:23]
 buffer_load_dwordx4 v72, s[8:11], s73 offen sc1 lds
 s_waitcnt lgkmcnt(2)
 v_mfma_f32_16x16x32_bf16 v[12:15], a[112:115], v[24:27], v[12:15]
 ds_read_b128 v[36:39], v71 offset:27648
 v_mfma_f32_16x16x32_bf16 v[16:19], a[116:119], v[24:27], v[16:19]
 v_mfma_f32_16x16x32_bf16 v[20:23], a[120:123], v[24:27], v[20:23]
 s_add_u32 m0, m0, s3
 s_add_u32 s73, s73, s3
 s_waitcnt lgkmcnt(2)
 v_mfma_f32_16x16x32_bf16 v[12:15], a[124:127], v[28:31], v[12:15]
 ds_read_b128 v[24:27], v71 offset:28672
 v_mfma_f32_16x16x32_bf16 v[16:19], a[128:131], v[28:31], v[16:19]
 buffer_load_dwordx4 v72, s[8:11], s73 offen sc1 lds
 v_mfma_f32_16x16x32_bf16 v[20:23], a[132:135], v[28:31], v[20:23]
 s_waitcnt lgkmcnt(2)
 v_mfma_f32_16x16x32_bf16 v[12:15], a[136:139], v[32:35], v[12:15]
 ds_read_b128 v[28:31], v71 offset:29696
 v_mfma_f32_16x16x32_bf16 v[16:19], a[140:143], v[32:35], v[16:19]
 v_mfma_f32_16x16x32_bf16 v[20:23], a[144:147], v[32:35], v[20:23]
 s_add_u32 m0, m0, s3
 s_add_u32 s73, s73, s3
 s_waitcnt lgkmcnt(2)
 v_mfma_f32_16x16x32_bf16 v[12:15], a[148:151], v[36:39], v[12:15]
 ds_read_b128 v[32:35], v71 offset:30720
 v_mfma_f32_16x16x32_bf16 v[16:19], a[152:155], v[36:39], v[16:19]
 buffer_load_dwordx4 v72, s[8:11], s73 offen sc1 lds
 v_mfma_f32_16x16x32_bf16 v[20:23], a[156:159], v[36:39], v[20:23]
 s_waitcnt lgkmcnt(2)
 v_mfma_f32_16x16x32_bf16 v[12:15], a[160:163], v[24:27], v[12:15]
 ds_read_b128 v[36:39], v71 offset:31744
 v_mfma_f32_16x16x32_bf16 v[16:19], a[164:167], v[24:27], v[16:19]
 s_add_u32 m0, m0, s3
 s_add_u32 s73, s73, s3
 v_mfma_f32_16x16x32_bf16 v[20:23], a[168:171], v[24:27], v[20:23]
 buffer_load_dwordx4 v72, s[8:11], s73 offen sc1 lds
 s_waitcnt vmcnt(18)
 v_add_u32 v64, v65, v75
 v_cmp_gt_u32 vcc, s74, v64
 s_waitcnt lgkmcnt(2)
 v_mfma_f32_16x16x32_bf16 v[12:15], a[172:175], v[28:31], v[12:15]
 ds_read_b128 v[24:27], v71 offset:32768
 v_cmp_gt_u32 s[66:67], s75, v64
 v_mfma_f32_16x16x32_bf16 v[16:19], a[176:179], v[28:31], v[16:19]
 v_mfma_f32_16x16x32_bf16 v[20:23], a[180:183], v[28:31], v[20:23]
 s_add_u32 m0, m0, s3
 s_add_u32 s73, s73, s3
 s_waitcnt lgkmcnt(2)
 v_mfma_f32_16x16x32_bf16 v[12:15], a[184:187], v[32:35], v[12:15]
 ds_read_b128 v[28:31], v71 offset:33792
 s_cmp_eq_u32 s67, 0
 s_cselect_b32 s72, 2, 0
 s_cmp_eq_u32 vcc_lo, 0
 s_cselect_b32 s72, 1, s72
 v_mfma_f32_16x16x32_bf16 v[16:19], a[188:191], v[32:35], v[16:19]
 buffer_load_dwordx4 v72, s[8:11], s73 offen sc1 lds
 v_mov_b32 v76, s72
 v_mfma_f32_16x16x32_bf16 v[20:23], a[192:195], v[32:35], v[20:23]
 ds_write_b32 v72, v76 offset:4
 s_mov_b32 s5, s85
 s_sub_u32 s85, 0, s85
 s_add_u32 s70, s70, s85
 s_waitcnt lgkmcnt(3)
 v_mfma_f32_16x16x32_bf16 v[12:15], a[196:199], v[36:39], v[12:15]
 ds_read_b128 v[32:35], v71 offset:34816
 s_mov_b32 s81, s77
 s_mov_b32 s82, s78
 s_mov_b32 s83, s79
 s_mov_b32 s94, s92
 v_mfma_f32_16x16x32_bf16 v[16:19], a[200:203], v[36:39], v[16:19]
 s_mov_b32 s95, s93
 s_mul_i32 s64, s68, 0
 s_add_u32 s64, s64, 4
 s_mul_i32 s63, s68, 0
 s_add_u32 s63, s63, 128
 v_mfma_f32_16x16x32_bf16 v[20:23], a[204:207], v[36:39], v[20:23]
 s_mul_i32 s63, s69, s63
 s_lshr_b32 s63, s63, 9
 s_mul_i32 s63, s63, s64
 s_sub_u32 s63, s69, s63
 s_waitcnt lgkmcnt(3)
 v_mfma_f32_16x16x32_bf16 v[12:15], a[208:211], v[24:27], v[12:15]
 ds_read_b128 v[36:39], v71 offset:35840
 s_mul_i32 s63, s63, 294912
 s_mul_i32 s64, s68, 1179648
 v_mfma_f32_16x16x32_bf16 v[16:19], a[212:215], v[24:27], v[16:19]
 s_add_u32 s63, s63, s64
 s_add_u32 s77, s63, s87
 s_add_u32 s78, s63, s88
 s_add_u32 s79, s63, s89
 s_mul_i32 s92, s68, 512
 v_mfma_f32_16x16x32_bf16 v[20:23], a[216:219], v[24:27], v[20:23]
 s_sub_u32 s93, s80, 1
 s_min_u32 s93, s93, 64
 s_add_u32 s61, s61, 1
 s_waitcnt lgkmcnt(2)
 s_waitcnt vmcnt(9)
 s_branch L_dn_fe
L_dn_p0ed:
 s_waitcnt lgkmcnt(2)
 v_mfma_f32_16x16x32_bf16 v[0:3], v[80:83], v[24:27], 0
 ds_read_b128 v[36:39], v70 offset:3072
 v_mfma_f32_16x16x32_bf16 v[4:7], v[84:87], v[24:27], 0
 s_sub_u32 s68, s72, 1
 s_cmp_eq_u32 s68, 0
 s_cselect_b32 s69, s74, s75
 v_mfma_f32_16x16x32_bf16 v[8:11], v[88:91], v[24:27], 0
 s_waitcnt lgkmcnt(2)
 v_mfma_f32_16x16x32_bf16 v[0:3], v[92:95], v[28:31], v[0:3]
 ds_read_b128 v[24:27], v70 offset:4096
 v_mfma_f32_16x16x32_bf16 v[4:7], v[96:99], v[28:31], v[4:7]
 s_cselect_b32 s63, s44, s47
 s_cselect_b32 s64, s45, s48
 s_cselect_b32 s80, s46, s49
 v_mfma_f32_16x16x32_bf16 v[8:11], v[100:103], v[28:31], v[8:11]
 v_cvt_pk_bf16_f32 v58, v20, v21
 v_cvt_pk_bf16_f32 v59, v22, v23
 s_waitcnt lgkmcnt(2)
 v_mfma_f32_16x16x32_bf16 v[0:3], v[104:107], v[32:35], v[0:3]
 ds_read_b128 v[28:31], v70 offset:5120
 v_cvt_pk_bf16_f32 v52, v12, v13
 v_mfma_f32_16x16x32_bf16 v[4:7], v[108:111], v[32:35], v[4:7]
 s_cmp_lt_u32 s69, s63
 s_cselect_b32 s80, s64, s80
 s_add_u32 s80, s80, s69
 v_mfma_f32_16x16x32_bf16 v[8:11], v[112:115], v[32:35], v[8:11]
 v_cvt_pk_bf16_f32 v53, v14, v15
 v_cvt_pk_bf16_f32 v54, v16, v17
 s_waitcnt lgkmcnt(2)
 v_mfma_f32_16x16x32_bf16 v[0:3], v[116:119], v[36:39], v[0:3]
 ds_read_b128 v[32:35], v70 offset:6144
 v_cvt_pk_bf16_f32 v55, v18, v19
 v_mfma_f32_16x16x32_bf16 v[4:7], v[120:123], v[36:39], v[4:7]
 s_cmp_eq_u32 s68, 0
 s_cselect_b32 s74, s80, s74
 s_cselect_b32 s75, s75, s80
 v_mfma_f32_16x16x32_bf16 v[8:11], v[124:127], v[36:39], v[8:11]
 s_mul_i32 s73, s69, 294912
 s_waitcnt lgkmcnt(2)
 v_mfma_f32_16x16x32_bf16 v[0:3], v[128:131], v[24:27], v[0:3]
 ds_read_b128 v[36:39], v70 offset:7168
 s_mul_i32 s63, s68, 18874368
 v_mfma_f32_16x16x32_bf16 v[4:7], v[132:135], v[24:27], v[4:7]
 s_add_u32 s73, s73, s63
 s_add_u32 s73, s73, s90
 buffer_store_dwordx4 v[52:55], v73, s[8:11], s81 offen offset:1024
 v_mfma_f32_16x16x32_bf16 v[8:11], v[136:139], v[24:27], v[8:11]
 v_permlane32_swap_b32 v56, v58
 s_waitcnt lgkmcnt(2)
 v_mfma_f32_16x16x32_bf16 v[0:3], v[140:143], v[28:31], v[0:3]
 ds_read_b128 v[24:27], v70 offset:8192
 v_permlane32_swap_b32 v57, v59
 v_mfma_f32_16x16x32_bf16 v[4:7], v[144:147], v[28:31], v[4:7]
 v_mfma_f32_16x16x32_bf16 v[8:11], v[148:151], v[28:31], v[8:11]
 s_waitcnt lgkmcnt(2)
 v_mfma_f32_16x16x32_bf16 v[0:3], v[152:155], v[32:35], v[0:3]
 ds_read_b128 v[28:31], v70 offset:9216
 v_mfma_f32_16x16x32_bf16 v[4:7], v[156:159], v[32:35], v[4:7]
 v_mfma_f32_16x16x32_bf16 v[8:11], v[160:163], v[32:35], v[8:11]
 s_waitcnt lgkmcnt(2)
 v_mfma_f32_16x16x32_bf16 v[0:3], v[164:167], v[36:39], v[0:3]
 ds_read_b128 v[32:35], v70 offset:10240
 buffer_store_dwordx4 v[56:59], v73, s[8:11], s81 offen offset:2048
 v_mfma_f32_16x16x32_bf16 v[4:7], v[168:171], v[36:39], v[4:7]
 v_mfma_f32_16x16x32_bf16 v[8:11], v[172:175], v[36:39], v[8:11]
 s_mov_b32 m0, s70
 s_waitcnt lgkmcnt(2)
 v_mfma_f32_16x16x32_bf16 v[0:3], v[176:179], v[24:27], v[0:3]
 ds_read_b128 v[36:39], v70 offset:11264
 v_mfma_f32_16x16x32_bf16 v[4:7], v[180:183], v[24:27], v[4:7]
 buffer_load_dwordx4 v72, s[8:11], s73 offen sc1 lds
 v_mfma_f32_16x16x32_bf16 v[8:11], v[184:187], v[24:27], v[8:11]
 s_waitcnt lgkmcnt(2)
 v_mfma_f32_16x16x32_bf16 v[0:3], v[188:191], v[28:31], v[0:3]
 ds_read_b128 v[24:27], v70 offset:12288
 v_mfma_f32_16x16x32_bf16 v[4:7], v[192:195], v[28:31], v[4:7]
 v_mfma_f32_16x16x32_bf16 v[8:11], v[196:199], v[28:31], v[8:11]
 s_add_u32 m0, m0, s3
 s_add_u32 s73, s73, s3
 s_waitcnt lgkmcnt(2)
 v_mfma_f32_16x16x32_bf16 v[0:3], v[200:203], v[32:35], v[0:3]
 ds_read_b128 v[28:31], v70 offset:13312
 v_mfma_f32_16x16x32_bf16 v[4:7], v[204:207], v[32:35], v[4:7]
 buffer_load_dwordx4 v72, s[8:11], s73 offen sc1 lds
 v_mfma_f32_16x16x32_bf16 v[8:11], v[208:211], v[32:35], v[8:11]
 s_waitcnt lgkmcnt(2)
 v_mfma_f32_16x16x32_bf16 v[0:3], v[212:215], v[36:39], v[0:3]
 ds_read_b128 v[32:35], v70 offset:14336
 v_mfma_f32_16x16x32_bf16 v[4:7], v[216:219], v[36:39], v[4:7]
 s_add_u32 m0, m0, s3
 s_add_u32 s73, s73, s3
 v_mfma_f32_16x16x32_bf16 v[8:11], v[220:223], v[36:39], v[8:11]
 buffer_load_dwordx4 v72, s[8:11], s73 offen sc1 lds
 s_waitcnt lgkmcnt(2)
 v_mfma_f32_16x16x32_bf16 v[0:3], v[224:227], v[24:27], v[0:3]
 ds_read_b128 v[36:39], v70 offset:15360
 v_mfma_f32_16x16x32_bf16 v[4:7], v[228:231], v[24:27], v[4:7]
 v_mfma_f32_16x16x32_bf16 v[8:11], v[232:235], v[24:27], v[8:11]
 s_add_u32 m0, m0, s3
 s_add_u32 s73, s73, s3
 s_waitcnt lgkmcnt(2)
 v_mfma_f32_16x16x32_bf16 v[0:3], v[236:239], v[28:31], v[0:3]
 ds_read_b128 v[24:27], v70 offset:16384
 v_mfma_f32_16x16x32_bf16 v[4:7], v[240:243], v[28:31], v[4:7]
 buffer_load_dwordx4 v72, s[8:11], s73 offen sc1 lds
 v_mov_b32 v76, s95
 v_mfma_f32_16x16x32_bf16 v[8:11], v[244:247], v[28:31], v[8:11]
 s_waitcnt vmcnt(4)
 s_barrier
 buffer_store_dword v76, v77, s[8:11], s94 offen
 s_waitcnt lgkmcnt(2)
 v_mfma_f32_16x16x32_bf16 v[0:3], v[248:251], v[32:35], v[0:3]
 ds_read_b128 v[28:31], v70 offset:17408
 v_mfma_f32_16x16x32_bf16 v[4:7], v[252:255], v[32:35], v[4:7]
 v_mfma_f32_16x16x32_bf16 v[8:11], a[0:3], v[32:35], v[8:11]
 s_add_u32 m0, m0, s3
 s_add_u32 s73, s73, s3
 s_waitcnt lgkmcnt(2)
 v_mfma_f32_16x16x32_bf16 v[0:3], a[4:7], v[36:39], v[0:3]
 ds_read_b128 v[32:35], v70 offset:18432
 v_mfma_f32_16x16x32_bf16 v[4:7], a[8:11], v[36:39], v[4:7]
 buffer_load_dwordx4 v72, s[8:11], s73 offen sc1 lds
 v_mfma_f32_16x16x32_bf16 v[8:11], a[12:15], v[36:39], v[8:11]
 s_waitcnt lgkmcnt(2)
 v_mfma_f32_16x16x32_bf16 v[0:3], a[16:19], v[24:27], v[0:3]
 ds_read_b128 v[36:39], v70 offset:19456
 v_mfma_f32_16x16x32_bf16 v[4:7], a[20:23], v[24:27], v[4:7]
 s_add_u32 m0, m0, s3
 s_add_u32 s73, s73, s3
 v_mfma_f32_16x16x32_bf16 v[8:11], a[24:27], v[24:27], v[8:11]
 buffer_load_dwordx4 v72, s[8:11], s73 offen sc1 lds
 s_waitcnt lgkmcnt(2)
 v_mfma_f32_16x16x32_bf16 v[0:3], a[28:31], v[28:31], v[0:3]
 ds_read_b128 v[24:27], v70 offset:20480
 v_mfma_f32_16x16x32_bf16 v[4:7], a[32:35], v[28:31], v[4:7]
 v_mfma_f32_16x16x32_bf16 v[8:11], a[36:39], v[28:31], v[8:11]
 s_add_u32 m0, m0, s3
 s_add_u32 s73, s73, s3
 s_waitcnt lgkmcnt(2)
 v_mfma_f32_16x16x32_bf16 v[0:3], a[40:43], v[32:35], v[0:3]
 ds_read_b128 v[28:31], v70 offset:21504
 v_mfma_f32_16x16x32_bf16 v[4:7], a[44:47], v[32:35], v[4:7]
 buffer_load_dwordx4 v72, s[8:11], s73 offen sc1 lds
 v_mfma_f32_16x16x32_bf16 v[8:11], a[48:51], v[32:35], v[8:11]
 s_waitcnt lgkmcnt(2)
 v_mfma_f32_16x16x32_bf16 v[0:3], a[52:55], v[36:39], v[0:3]
 ds_read_b128 v[32:35], v70 offset:22528
 v_mfma_f32_16x16x32_bf16 v[4:7], a[56:59], v[36:39], v[4:7]
 v_mfma_f32_16x16x32_bf16 v[8:11], a[60:63], v[36:39], v[8:11]
 s_add_u32 m0, m0, s3
 s_add_u32 s73, s73, s3
 s_waitcnt lgkmcnt(2)
 v_mfma_f32_16x16x32_bf16 v[0:3], a[64:67], v[24:27], v[0:3]
 ds_read_b128 v[36:39], v70 offset:23552
 v_mfma_f32_16x16x32_bf16 v[4:7], a[68:71], v[24:27], v[4:7]
 buffer_load_dwordx4 v72, s[8:11], s73 offen sc1 lds
 v_mfma_f32_16x16x32_bf16 v[8:11], a[72:75], v[24:27], v[8:11]
 s_waitcnt lgkmcnt(2)
 v_mfma_f32_16x16x32_bf16 v[0:3], a[76:79], v[28:31], v[0:3]
 ds_read_b128 v[24:27], v70 offset:24576
 v_mfma_f32_16x16x32_bf16 v[4:7], a[80:83], v[28:31], v[4:7]
 s_add_u32 m0, m0, s3
 s_add_u32 s73, s73, s3
 v_mfma_f32_16x16x32_bf16 v[8:11], a[84:87], v[28:31], v[8:11]
 buffer_load_dwordx4 v72, s[8:11], s73 offen sc1 lds
 s_waitcnt lgkmcnt(2)
 v_mfma_f32_16x16x32_bf16 v[0:3], a[88:91], v[32:35], v[0:3]
 ds_read_b128 v[28:31], v70 offset:25600
 v_mfma_f32_16x16x32_bf16 v[4:7], a[92:95], v[32:35], v[4:7]
 v_mfma_f32_16x16x32_bf16 v[8:11], a[96:99], v[32:35], v[8:11]
 s_add_u32 m0, m0, s3
 s_add_u32 s73, s73, s3
 s_waitcnt lgkmcnt(2)
 v_mfma_f32_16x16x32_bf16 v[0:3], a[100:103], v[36:39], v[0:3]
 ds_read_b128 v[32:35], v70 offset:26624
 v_mfma_f32_16x16x32_bf16 v[4:7], a[104:107], v[36:39], v[4:7]
 buffer_load_dwordx4 v72, s[8:11], s73 offen sc1 lds
 v_mfma_f32_16x16x32_bf16 v[8:11], a[108:111], v[36:39], v[8:11]
 s_waitcnt lgkmcnt(2)
 v_mfma_f32_16x16x32_bf16 v[0:3], a[112:115], v[24:27], v[0:3]
 ds_read_b128 v[36:39], v70 offset:27648
 v_mfma_f32_16x16x32_bf16 v[4:7], a[116:119], v[24:27], v[4:7]
 v_mfma_f32_16x16x32_bf16 v[8:11], a[120:123], v[24:27], v[8:11]
 s_add_u32 m0, m0, s3
 s_add_u32 s73, s73, s3
 s_waitcnt lgkmcnt(2)
 v_mfma_f32_16x16x32_bf16 v[0:3], a[124:127], v[28:31], v[0:3]
 ds_read_b128 v[24:27], v70 offset:28672
 v_mfma_f32_16x16x32_bf16 v[4:7], a[128:131], v[28:31], v[4:7]
 buffer_load_dwordx4 v72, s[8:11], s73 offen sc1 lds
 v_mfma_f32_16x16x32_bf16 v[8:11], a[132:135], v[28:31], v[8:11]
 s_waitcnt lgkmcnt(2)
 v_mfma_f32_16x16x32_bf16 v[0:3], a[136:139], v[32:35], v[0:3]
 ds_read_b128 v[28:31], v70 offset:29696
 v_mfma_f32_16x16x32_bf16 v[4:7], a[140:143], v[32:35], v[4:7]
 s_add_u32 m0, m0, s3
 s_add_u32 s73, s73, s3
 v_mfma_f32_16x16x32_bf16 v[8:11], a[144:147], v[32:35], v[8:11]
 buffer_load_dwordx4 v72, s[8:11], s73 offen sc1 lds
 s_waitcnt lgkmcnt(2)
 v_mfma_f32_16x16x32_bf16 v[0:3], a[148:151], v[36:39], v[0:3]
 ds_read_b128 v[32:35], v70 offset:30720
 v_mfma_f32_16x16x32_bf16 v[4:7], a[152:155], v[36:39], v[4:7]
 v_mfma_f32_16x16x32_bf16 v[8:11], a[156:159], v[36:39], v[8:11]
 s_add_u32 m0, m0, s3
 s_add_u32 s73, s73, s3
 s_waitcnt lgkmcnt(2)
 v_mfma_f32_16x16x32_bf16 v[0:3], a[160:163], v[24:27], v[0:3]
 ds_read_b128 v[36:39], v70 offset:31744
 v_mfma_f32_16x16x32_bf16 v[4:7], a[164:167], v[24:27], v[4:7]
 buffer_load_dwordx4 v72, s[8:11], s73 offen sc1 lds
 v_mfma_f32_16x16x32_bf16 v[8:11], a[168:171], v[24:27], v[8:11]
 s_waitcnt lgkmcnt(2)
 v_mfma_f32_16x16x32_bf16 v[0:3], a[172:175], v[28:31], v[0:3]
 ds_read_b128 v[24:27], v70 offset:32768
 v_mfma_f32_16x16x32_bf16 v[4:7], a[176:179], v[28:31], v[4:7]
 v_mfma_f32_16x16x32_bf16 v[8:11], a[180:183], v[28:31], v[8:11]
 s_add_u32 m0, m0, s3
 s_add_u32 s73, s73, s3
 s_waitcnt lgkmcnt(2)
 v_mfma_f32_16x16x32_bf16 v[0:3], a[184:187], v[32:35], v[0:3]
 ds_read_b128 v[28:31], v70 offset:33792
 v_mfma_f32_16x16x32_bf16 v[4:7], a[188:191], v[32:35], v[4:7]
 buffer_load_dwordx4 v72, s[8:11], s73 offen sc1 lds
 v_mfma_f32_16x16x32_bf16 v[8:11], a[192:195], v[32:35], v[8:11]
 s_waitcnt lgkmcnt(2)
 v_mfma_f32_16x16x32_bf16 v[0:3], a[196:199], v[36:39], v[0:3]
 ds_read_b128 v[32:35], v70 offset:34816
 v_mfma_f32_16x16x32_bf16 v[4:7], a[200:203], v[36:39], v[4:7]
 s_add_u32 m0, m0, s3
 s_add_u32 s73, s73, s3
 v_mfma_f32_16x16x32_bf16 v[8:11], a[204:207], v[36:39], v[8:11]
 buffer_load_dwordx4 v72, s[8:11], s73 offen sc1 lds
 s_waitcnt lgkmcnt(2)
 v_mfma_f32_16x16x32_bf16 v[0:3], a[208:211], v[24:27], v[0:3]
 ds_read_b128 v[36:39], v70 offset:35840
 v_mfma_f32_16x16x32_bf16 v[4:7], a[212:215], v[24:27], v[4:7]
 v_mfma_f32_16x16x32_bf16 v[8:11], a[216:219], v[24:27], v[8:11]
 s_add_u32 m0, m0, s3
 s_add_u32 s73, s73, s3
 s_waitcnt lgkmcnt(2)
 v_mfma_f32_16x16x32_bf16 v[0:3], a[220:223], v[28:31], v[0:3]
 ds_read_b128 v[24:27], v71 offset:0
 v_mfma_f32_16x16x32_bf16 v[4:7], a[224:227], v[28:31], v[4:7]
 buffer_load_dwordx4 v72, s[8:11], s73 offen sc1 lds
 v_mfma_f32_16x16x32_bf16 v[8:11], a[228:231], v[28:31], v[8:11]
 s_waitcnt lgkmcnt(2)
 v_mfma_f32_16x16x32_bf16 v[0:3], a[232:235], v[32:35], v[0:3]
 ds_read_b128 v[28:31], v71 offset:1024
 v_mfma_f32_16x16x32_bf16 v[4:7], a[236:239], v[32:35], v[4:7]
 v_mfma_f32_16x16x32_bf16 v[8:11], a[240:243], v[32:35], v[8:11]
 s_add_u32 m0, m0, s3
 s_add_u32 s73, s73, s3
 s_waitcnt lgkmcnt(2)
 v_mfma_f32_16x16x32_bf16 v[0:3], a[244:247], v[36:39], v[0:3]
 ds_read_b128 v[32:35], v71 offset:2048
 v_mfma_f32_16x16x32_bf16 v[4:7], a[248:251], v[36:39], v[4:7]
 buffer_load_dwordx4 v72, s[8:11], s73 offen sc1 lds
 v_mfma_f32_16x16x32_bf16 v[8:11], a[252:255], v[36:39], v[8:11]
 s_waitcnt lgkmcnt(2)
 v_mfma_f32_16x16x32_bf16 v[12:15], v[80:83], v[24:27], 0
 ds_read_b128 v[36:39], v71 offset:3072
 v_mfma_f32_16x16x32_bf16 v[16:19], v[84:87], v[24:27], 0
 s_add_u32 m0, m0, s3
 s_add_u32 s73, s73, s3
 v_mfma_f32_16x16x32_bf16 v[20:23], v[88:91], v[24:27], 0
 buffer_load_dwordx4 v72, s[8:11], s73 offen sc1 lds
 s_waitcnt lgkmcnt(2)
 v_mfma_f32_16x16x32_bf16 v[12:15], v[92:95], v[28:31], v[12:15]
 ds_read_b128 v[24:27], v71 offset:4096
 v_mfma_f32_16x16x32_bf16 v[16:19], v[96:99], v[28:31], v[16:19]
 v_cvt_pk_bf16_f32 v48, v0, v1
 v_cvt_pk_bf16_f32 v49, v2, v3
 v_mfma_f32_16x16x32_bf16 v[20:23], v[100:103], v[28:31], v[20:23]
 v_cvt_pk_bf16_f32 v50, v4, v5
 s_waitcnt lgkmcnt(2)
 v_mfma_f32_16x16x32_bf16 v[12:15], v[104:107], v[32:35], v[12:15]
 ds_read_b128 v[28:31], v71 offset:5120
 v_cvt_pk_bf16_f32 v51, v6, v7
 v_mfma_f32_16x16x32_bf16 v[16:19], v[108:111], v[32:35], v[16:19]
 buffer_store_dwordx4 v[48:51], v73, s[8:11], s77 offen offset:0
 v_mfma_f32_16x16x32_bf16 v[20:23], v[112:115], v[32:35], v[20:23]
 v_cvt_pk_bf16_f32 v56, v8, v9
 s_waitcnt lgkmcnt(2)
 v_mfma_f32_16x16x32_bf16 v[12:15], v[116:119], v[36:39], v[12:15]
 ds_read_b128 v[32:35], v71 offset:6144
 v_cvt_pk_bf16_f32 v57, v10, v11
 v_mfma_f32_16x16x32_bf16 v[16:19], v[120:123], v[36:39], v[16:19]
 s_mov_b32 s5, s85
 s_sub_u32 s85, 0, s85
 s_add_u32 s70, s70, s85
 v_mfma_f32_16x16x32_bf16 v[20:23], v[124:127], v[36:39], v[20:23]
 s_mov_b32 s81, s77
 s_mov_b32 s82, s78
 s_waitcnt lgkmcnt(2)
 v_mfma_f32_16x16x32_bf16 v[12:15], v[128:131], v[24:27], v[12:15]
 ds_read_b128 v[36:39], v71 offset:7168
 s_mov_b32 s83, s79
 v_mfma_f32_16x16x32_bf16 v[16:19], v[132:135], v[24:27], v[16:19]
 s_mov_b32 s94, s92
 s_mov_b32 s95, s93
 s_mul_i32 s64, s68, 0
 v_mfma_f32_16x16x32_bf16 v[20:23], v[136:139], v[24:27], v[20:23]
 s_add_u32 s64, s64, 4
 s_mul_i32 s63, s68, 0
 s_waitcnt lgkmcnt(2)
 v_mfma_f32_16x16x32_bf16 v[12:15], v[140:143], v[28:31], v[12:15]
 ds_read_b128 v[24:27], v71 offset:8192
 s_add_u32 s63, s63, 128
 v_mfma_f32_16x16x32_bf16 v[16:19], v[144:147], v[28:31], v[16:19]
 s_mul_i32 s63, s69, s63
 s_lshr_b32 s63, s63, 9
 s_mul_i32 s63, s63, s64
 v_mfma_f32_16x16x32_bf16 v[20:23], v[148:151], v[28:31], v[20:23]
 s_sub_u32 s63, s69, s63
 s_waitcnt lgkmcnt(2)
 v_mfma_f32_16x16x32_bf16 v[12:15], v[152:155], v[32:35], v[12:15]
 ds_read_b128 v[28:31], v71 offset:9216
 s_mul_i32 s63, s63, 294912
 v_mfma_f32_16x16x32_bf16 v[16:19], v[156:159], v[32:35], v[16:19]
 s_mul_i32 s64, s68, 1179648
 s_add_u32 s63, s63, s64
 v_mfma_f32_16x16x32_bf16 v[20:23], v[160:163], v[32:35], v[20:23]
 s_add_u32 s77, s63, s87
 s_add_u32 s78, s63, s88
 s_waitcnt lgkmcnt(2)
 v_mfma_f32_16x16x32_bf16 v[12:15], v[164:167], v[36:39], v[12:15]
 ds_read_b128 v[32:35], v71 offset:10240
 s_add_u32 s79, s63, s89
 v_mfma_f32_16x16x32_bf16 v[16:19], v[168:171], v[36:39], v[16:19]
 s_mul_i32 s92, s68, 512
 s_sub_u32 s93, s80, 1
 v_mfma_f32_16x16x32_bf16 v[20:23], v[172:175], v[36:39], v[20:23]
 s_min_u32 s93, s93, 64
 s_add_u32 s61, s61, 1
 s_waitcnt lgkmcnt(2)
 v_mfma_f32_16x16x32_bf16 v[12:15], v[176:179], v[24:27], v[12:15]
 ds_read_b128 v[36:39], v71 offset:11264
 v_mfma_f32_16x16x32_bf16 v[16:19], v[180:183], v[24:27], v[16:19]
 v_mfma_f32_16x16x32_bf16 v[20:23], v[184:187], v[24:27], v[20:23]
 s_waitcnt lgkmcnt(2)
 v_mfma_f32_16x16x32_bf16 v[12:15], v[188:191], v[28:31], v[12:15]
 ds_read_b128 v[24:27], v71 offset:12288
 v_mfma_f32_16x16x32_bf16 v[16:19], v[192:195], v[28:31], v[16:19]
 v_mfma_f32_16x16x32_bf16 v[20:23], v[196:199], v[28:31], v[20:23]
 s_waitcnt lgkmcnt(2)
 v_mfma_f32_16x16x32_bf16 v[12:15], v[200:203], v[32:35], v[12:15]
 ds_read_b128 v[28:31], v71 offset:13312
 buffer_load_dword v75, v74, s[8:11], 0 offen sc1
 v_mfma_f32_16x16x32_bf16 v[16:19], v[204:207], v[32:35], v[16:19]
 v_mfma_f32_16x16x32_bf16 v[20:23], v[208:211], v[32:35], v[20:23]
 s_waitcnt lgkmcnt(2)
 v_mfma_f32_16x16x32_bf16 v[12:15], v[212:215], v[36:39], v[12:15]
 ds_read_b128 v[32:35], v71 offset:14336
 v_mfma_f32_16x16x32_bf16 v[16:19], v[216:219], v[36:39], v[16:19]
 v_mfma_f32_16x16x32_bf16 v[20:23], v[220:223], v[36:39], v[20:23]
 s_waitcnt lgkmcnt(2)
 v_mfma_f32_16x16x32_bf16 v[12:15], v[224:227], v[24:27], v[12:15]
 ds_read_b128 v[36:39], v71 offset:15360
 v_mfma_f32_16x16x32_bf16 v[16:19], v[228:231], v[24:27], v[16:19]
 v_mfma_f32_16x16x32_bf16 v[20:23], v[232:235], v[24:27], v[20:23]
 s_waitcnt lgkmcnt(2)
 v_mfma_f32_16x16x32_bf16 v[12:15], v[236:239], v[28:31], v[12:15]
 ds_read_b128 v[24:27], v71 offset:16384
 v_mfma_f32_16x16x32_bf16 v[16:19], v[240:243], v[28:31], v[16:19]
 v_mfma_f32_16x16x32_bf16 v[20:23], v[244:247], v[28:31], v[20:23]
 s_waitcnt lgkmcnt(2)
 v_mfma_f32_16x16x32_bf16 v[12:15], v[248:251], v[32:35], v[12:15]
 ds_read_b128 v[28:31], v71 offset:17408
 v_mfma_f32_16x16x32_bf16 v[16:19], v[252:255], v[32:35], v[16:19]
 v_mfma_f32_16x16x32_bf16 v[20:23], a[0:3], v[32:35], v[20:23]
 s_waitcnt lgkmcnt(2)
 v_mfma_f32_16x16x32_bf16 v[12:15], a[4:7], v[36:39], v[12:15]
 ds_read_b128 v[32:35], v71 offset:18432
 v_mfma_f32_16x16x32_bf16 v[16:19], a[8:11], v[36:39], v[16:19]
 v_mfma_f32_16x16x32_bf16 v[20:23], a[12:15], v[36:39], v[20:23]
 s_waitcnt lgkmcnt(2)
 v_mfma_f32_16x16x32_bf16 v[12:15], a[16:19], v[24:27], v[12:15]
 ds_read_b128 v[36:39], v71 offset:19456
 v_mfma_f32_16x16x32_bf16 v[16:19], a[20:23], v[24:27], v[16:19]
 v_mfma_f32_16x16x32_bf16 v[20:23], a[24:27], v[24:27], v[20:23]
 s_waitcnt lgkmcnt(2)
 v_mfma_f32_16x16x32_bf16 v[12:15], a[28:31], v[28:31], v[12:15]
 ds_read_b128 v[24:27], v71 offset:20480
 v_mfma_f32_16x16x32_bf16 v[16:19], a[32:35], v[28:31], v[16:19]
 v_mfma_f32_16x16x32_bf16 v[20:23], a[36:39], v[28:31], v[20:23]
 s_waitcnt lgkmcnt(2)
 v_mfma_f32_16x16x32_bf16 v[12:15], a[40:43], v[32:35], v[12:15]
 ds_read_b128 v[28:31], v71 offset:21504
 v_mfma_f32_16x16x32_bf16 v[16:19], a[44:47], v[32:35], v[16:19]
 v_mfma_f32_16x16x32_bf16 v[20:23], a[48:51], v[32:35], v[20:23]
 s_waitcnt lgkmcnt(2)
 v_mfma_f32_16x16x32_bf16 v[12:15], a[52:55], v[36:39], v[12:15]
 ds_read_b128 v[32:35], v71 offset:22528
 v_mfma_f32_16x16x32_bf16 v[16:19], a[56:59], v[36:39], v[16:19]
 v_mfma_f32_16x16x32_bf16 v[20:23], a[60:63], v[36:39], v[20:23]
 s_waitcnt lgkmcnt(2)
 v_mfma_f32_16x16x32_bf16 v[12:15], a[64:67], v[24:27], v[12:15]
 ds_read_b128 v[36:39], v71 offset:23552
 v_mfma_f32_16x16x32_bf16 v[16:19], a[68:71], v[24:27], v[16:19]
 v_mfma_f32_16x16x32_bf16 v[20:23], a[72:75], v[24:27], v[20:23]
 s_waitcnt lgkmcnt(2)
 v_mfma_f32_16x16x32_bf16 v[12:15], a[76:79], v[28:31], v[12:15]
 ds_read_b128 v[24:27], v71 offset:24576
 v_mfma_f32_16x16x32_bf16 v[16:19], a[80:83], v[28:31], v[16:19]
 v_mfma_f32_16x16x32_bf16 v[20:23], a[84:87], v[28:31], v[20:23]
 s_waitcnt lgkmcnt(2)
 v_mfma_f32_16x16x32_bf16 v[12:15], a[88:91], v[32:35], v[12:15]
 ds_read_b128 v[28:31], v71 offset:25600
 v_mfma_f32_16x16x32_bf16 v[16:19], a[92:95], v[32:35], v[16:19]
 v_mfma_f32_16x16x32_bf16 v[20:23], a[96:99], v[32:35], v[20:23]
 s_waitcnt lgkmcnt(2)
 v_mfma_f32_16x16x32_bf16 v[12:15], a[100:103], v[36:39], v[12:15]
 ds_read_b128 v[32:35], v71 offset:26624
 v_mfma_f32_16x16x32_bf16 v[16:19], a[104:107], v[36:39], v[16:19]
 v_mfma_f32_16x16x32_bf16 v[20:23], a[108:111], v[36:39], v[20:23]
 s_waitcnt lgkmcnt(2)
 v_mfma_f32_16x16x32_bf16 v[12:15], a[112:115], v[24:27], v[12:15]
 ds_read_b128 v[36:39], v71 offset:27648
 v_mfma_f32_16x16x32_bf16 v[16:19], a[116:119], v[24:27], v[16:19]
 v_mfma_f32_16x16x32_bf16 v[20:23], a[120:123], v[24:27], v[20:23]
 s_waitcnt lgkmcnt(2)
 v_mfma_f32_16x16x32_bf16 v[12:15], a[124:127], v[28:31], v[12:15]
 ds_read_b128 v[24:27], v71 offset:28672
 v_mfma_f32_16x16x32_bf16 v[16:19], a[128:131], v[28:31], v[16:19]
 v_mfma_f32_16x16x32_bf16 v[20:23], a[132:135], v[28:31], v[20:23]
 s_waitcnt lgkmcnt(2)
 v_mfma_f32_16x16x32_bf16 v[12:15], a[136:139], v[32:35], v[12:15]
 ds_read_b128 v[28:31], v71 offset:29696
 v_mfma_f32_16x16x32_bf16 v[16:19], a[140:143], v[32:35], v[16:19]
 v_mfma_f32_16x16x32_bf16 v[20:23], a[144:147], v[32:35], v[20:23]
 s_waitcnt lgkmcnt(2)
 v_mfma_f32_16x16x32_bf16 v[12:15], a[148:151], v[36:39], v[12:15]
 ds_read_b128 v[32:35], v71 offset:30720
 v_mfma_f32_16x16x32_bf16 v[16:19], a[152:155], v[36:39], v[16:19]
 v_mfma_f32_16x16x32_bf16 v[20:23], a[156:159], v[36:39], v[20:23]
 s_waitcnt lgkmcnt(2)
 v_mfma_f32_16x16x32_bf16 v[12:15], a[160:163], v[24:27], v[12:15]
 ds_read_b128 v[36:39], v71 offset:31744
 v_mfma_f32_16x16x32_bf16 v[16:19], a[164:167], v[24:27], v[16:19]
 v_mfma_f32_16x16x32_bf16 v[20:23], a[168:171], v[24:27], v[20:23]
 s_waitcnt vmcnt(0)
 v_add_u32 v64, v65, v75
 v_cmp_gt_u32 vcc, s74, v64
 s_waitcnt lgkmcnt(2)
 v_mfma_f32_16x16x32_bf16 v[12:15], a[172:175], v[28:31], v[12:15]
 ds_read_b128 v[24:27], v71 offset:32768
 v_cmp_gt_u32 s[66:67], s75, v64
 v_mfma_f32_16x16x32_bf16 v[16:19], a[176:179], v[28:31], v[16:19]
 v_mfma_f32_16x16x32_bf16 v[20:23], a[180:183], v[28:31], v[20:23]
 s_waitcnt lgkmcnt(2)
 v_mfma_f32_16x16x32_bf16 v[12:15], a[184:187], v[32:35], v[12:15]
 ds_read_b128 v[28:31], v71 offset:33792
 s_cmp_eq_u32 s67, 0
 s_cselect_b32 s72, 2, 0
 s_cmp_eq_u32 vcc_lo, 0
 s_cselect_b32 s72, 1, s72
 v_mfma_f32_16x16x32_bf16 v[16:19], a[188:191], v[32:35], v[16:19]
 v_mov_b32 v76, s72
 v_mfma_f32_16x16x32_bf16 v[20:23], a[192:195], v[32:35], v[20:23]
 ds_write_b32 v72, v76 offset:4
 s_waitcnt lgkmcnt(3)
 v_mfma_f32_16x16x32_bf16 v[12:15], a[196:199], v[36:39], v[12:15]
 ds_read_b128 v[32:35], v71 offset:34816
 v_mfma_f32_16x16x32_bf16 v[16:19], a[200:203], v[36:39], v[16:19]
 v_mfma_f32_16x16x32_bf16 v[20:23], a[204:207], v[36:39], v[20:23]
 s_waitcnt lgkmcnt(3)
 v_mfma_f32_16x16x32_bf16 v[12:15], a[208:211], v[24:27], v[12:15]
 ds_read_b128 v[36:39], v71 offset:35840
 v_mfma_f32_16x16x32_bf16 v[16:19], a[212:215], v[24:27], v[16:19]
 v_mfma_f32_16x16x32_bf16 v[20:23], a[216:219], v[24:27], v[20:23]
 s_waitcnt lgkmcnt(2)
L_dn_fe:
 s_barrier
 ds_read_b32 v76, v73 offset:4
 s_waitcnt lgkmcnt(3)
 v_mfma_f32_16x16x32_bf16 v[12:15], a[220:223], v[28:31], v[12:15]
 v_add_u32 v70, s5, v70
 v_add_u32 v71, s5, v71
 ds_read_b128 v[24:27], v70 offset:0
 v_mfma_f32_16x16x32_bf16 v[16:19], a[224:227], v[28:31], v[16:19]
 v_mfma_f32_16x16x32_bf16 v[20:23], a[228:231], v[28:31], v[20:23]
 s_waitcnt lgkmcnt(3)
 v_mfma_f32_16x16x32_bf16 v[12:15], a[232:235], v[32:35], v[12:15]
 ds_read_b128 v[28:31], v70 offset:1024
 v_mfma_f32_16x16x32_bf16 v[16:19], a[236:239], v[32:35], v[16:19]
 v_mfma_f32_16x16x32_bf16 v[20:23], a[240:243], v[32:35], v[20:23]
 s_waitcnt lgkmcnt(2)
 v_readfirstlane_b32 s72, v76
 v_mfma_f32_16x16x32_bf16 v[12:15], a[244:247], v[36:39], v[12:15]
 ds_read_b128 v[32:35], v70 offset:2048
 v_mfma_f32_16x16x32_bf16 v[16:19], a[248:251], v[36:39], v[16:19]
 v_mfma_f32_16x16x32_bf16 v[20:23], a[252:255], v[36:39], v[20:23]
 s_cmp_lg_u32 s72, 0
 s_cbranch_scc1 L_dn_p0ed
 s_branch L_dn_p0e
L_dn_p1n:
 s_waitcnt lgkmcnt(2)
 v_mfma_f32_16x16x32_bf16 v[12:15], v[80:83], v[24:27], 0
 ds_read_b128 v[36:39], v71 offset:3072
 v_mfma_f32_16x16x32_bf16 v[16:19], v[84:87], v[24:27], 0
 v_mfma_f32_16x16x32_bf16 v[20:23], v[88:91], v[24:27], 0
 s_waitcnt lgkmcnt(2)
 v_mfma_f32_16x16x32_bf16 v[12:15], v[92:95], v[28:31], v[12:15]
 ds_read_b128 v[24:27], v71 offset:4096
 v_mfma_f32_16x16x32_bf16 v[16:19], v[96:99], v[28:31], v[16:19]
 v_cvt_pk_bf16_f32 v48, v0, v1
 v_cvt_pk_bf16_f32 v49, v2, v3
 v_mfma_f32_16x16x32_bf16 v[20:23], v[100:103], v[28:31], v[20:23]
 v_cvt_pk_bf16_f32 v50, v4, v5
 s_waitcnt lgkmcnt(2)
 v_mfma_f32_16x16x32_bf16 v[12:15], v[104:107], v[32:35], v[12:15]
 ds_read_b128 v[28:31], v71 offset:5120
 v_cvt_pk_bf16_f32 v51, v6, v7
 v_mfma_f32_16x16x32_bf16 v[16:19], v[108:111], v[32:35], v[16:19]
 buffer_store_dwordx4 v[48:51], v73, s[8:11], s77 offen offset:0
 v_mfma_f32_16x16x32_bf16 v[20:23], v[112:115], v[32:35], v[20:23]
 v_cvt_pk_bf16_f32 v56, v8, v9
 s_waitcnt lgkmcnt(2)
 v_mfma_f32_16x16x32_bf16 v[12:15], v[116:119], v[36:39], v[12:15]
 ds_read_b128 v[32:35], v71 offset:6144
 v_cvt_pk_bf16_f32 v57, v10, v11
 v_mfma_f32_16x16x32_bf16 v[16:19], v[120:123], v[36:39], v[16:19]
 v_mfma_f32_16x16x32_bf16 v[20:23], v[124:127], v[36:39], v[20:23]
 s_waitcnt lgkmcnt(2)
 v_mfma_f32_16x16x32_bf16 v[12:15], v[128:131], v[24:27], v[12:15]
 ds_read_b128 v[36:39], v71 offset:7168
 v_mfma_f32_16x16x32_bf16 v[16:19], v[132:135], v[24:27], v[16:19]
 v_mfma_f32_16x16x32_bf16 v[20:23], v[136:139], v[24:27], v[20:23]
 s_waitcnt lgkmcnt(2)
 v_mfma_f32_16x16x32_bf16 v[12:15], v[140:143], v[28:31], v[12:15]
 ds_read_b128 v[24:27], v71 offset:8192
 v_mfma_f32_16x16x32_bf16 v[16:19], v[144:147], v[28:31], v[16:19]
 v_mfma_f32_16x16x32_bf16 v[20:23], v[148:151], v[28:31], v[20:23]
 s_waitcnt lgkmcnt(2)
 v_mfma_f32_16x16x32_bf16 v[12:15], v[152:155], v[32:35], v[12:15]
 ds_read_b128 v[28:31], v71 offset:9216
 v_mfma_f32_16x16x32_bf16 v[16:19], v[156:159], v[32:35], v[16:19]
 v_mfma_f32_16x16x32_bf16 v[20:23], v[160:163], v[32:35], v[20:23]
 s_waitcnt lgkmcnt(2)
 v_mfma_f32_16x16x32_bf16 v[12:15], v[164:167], v[36:39], v[12:15]
 ds_read_b128 v[32:35], v71 offset:10240
 v_mfma_f32_16x16x32_bf16 v[16:19], v[168:171], v[36:39], v[16:19]
 v_mfma_f32_16x16x32_bf16 v[20:23], v[172:175], v[36:39], v[20:23]
 s_waitcnt lgkmcnt(2)
 v_mfma_f32_16x16x32_bf16 v[12:15], v[176:179], v[24:27], v[12:15]
 ds_read_b128 v[36:39], v71 offset:11264
 v_mfma_f32_16x16x32_bf16 v[16:19], v[180:183], v[24:27], v[16:19]
 v_mfma_f32_16x16x32_bf16 v[20:23], v[184:187], v[24:27], v[20:23]
 s_waitcnt lgkmcnt(2)
 v_mfma_f32_16x16x32_bf16 v[12:15], v[188:191], v[28:31], v[12:15]
 ds_read_b128 v[24:27], v71 offset:12288
 v_mfma_f32_16x16x32_bf16 v[16:19], v[192:195], v[28:31], v[16:19]
 v_mfma_f32_16x16x32_bf16 v[20:23], v[196:199], v[28:31], v[20:23]
 s_waitcnt lgkmcnt(2)
 v_mfma_f32_16x16x32_bf16 v[12:15], v[200:203], v[32:35], v[12:15]
 ds_read_b128 v[28:31], v71 offset:13312
 v_mfma_f32_16x16x32_bf16 v[16:19], v[204:207], v[32:35], v[16:19]
 v_mfma_f32_16x16x32_bf16 v[20:23], v[208:211], v[32:35], v[20:23]
 s_waitcnt lgkmcnt(2)
 v_mfma_f32_16x16x32_bf16 v[12:15], v[212:215], v[36:39], v[12:15]
 ds_read_b128 v[32:35], v71 offset:14336
 v_mfma_f32_16x16x32_bf16 v[16:19], v[216:219], v[36:39], v[16:19]
 v_mfma_f32_16x16x32_bf16 v[20:23], v[220:223], v[36:39], v[20:23]
 s_waitcnt lgkmcnt(2)
 v_mfma_f32_16x16x32_bf16 v[12:15], v[224:227], v[24:27], v[12:15]
 ds_read_b128 v[36:39], v71 offset:15360
 v_mfma_f32_16x16x32_bf16 v[16:19], v[228:231], v[24:27], v[16:19]
 v_mfma_f32_16x16x32_bf16 v[20:23], v[232:235], v[24:27], v[20:23]
 s_waitcnt lgkmcnt(2)
 v_mfma_f32_16x16x32_bf16 v[12:15], v[236:239], v[28:31], v[12:15]
 ds_read_b128 v[24:27], v71 offset:16384
 v_mfma_f32_16x16x32_bf16 v[16:19], v[240:243], v[28:31], v[16:19]
 buffer_load_dword v75, v74, s[8:11], 0 offen sc1
 v_mfma_f32_16x16x32_bf16 v[20:23], v[244:247], v[28:31], v[20:23]
 s_waitcnt lgkmcnt(2)
 v_mfma_f32_16x16x32_bf16 v[12:15], v[248:251], v[32:35], v[12:15]
 ds_read_b128 v[28:31], v71 offset:17408
 v_mfma_f32_16x16x32_bf16 v[16:19], v[252:255], v[32:35], v[16:19]
 v_mfma_f32_16x16x32_bf16 v[20:23], a[0:3], v[32:35], v[20:23]
 s_waitcnt lgkmcnt(2)
 v_mfma_f32_16x16x32_bf16 v[12:15], a[4:7], v[36:39], v[12:15]
 ds_read_b128 v[32:35], v71 offset:18432
 v_mfma_f32_16x16x32_bf16 v[16:19], a[8:11], v[36:39], v[16:19]
 v_mfma_f32_16x16x32_bf16 v[20:23], a[12:15], v[36:39], v[20:23]
 s_waitcnt lgkmcnt(2)
 v_mfma_f32_16x16x32_bf16 v[12:15], a[16:19], v[24:27], v[12:15]
 ds_read_b128 v[36:39], v71 offset:19456
 v_mfma_f32_16x16x32_bf16 v[16:19], a[20:23], v[24:27], v[16:19]
 v_mfma_f32_16x16x32_bf16 v[20:23], a[24:27], v[24:27], v[20:23]
 s_waitcnt lgkmcnt(2)
 v_mfma_f32_16x16x32_bf16 v[12:15], a[28:31], v[28:31], v[12:15]
 ds_read_b128 v[24:27], v71 offset:20480
 v_mfma_f32_16x16x32_bf16 v[16:19], a[32:35], v[28:31], v[16:19]
 v_mfma_f32_16x16x32_bf16 v[20:23], a[36:39], v[28:31], v[20:23]
 s_waitcnt lgkmcnt(2)
 v_mfma_f32_16x16x32_bf16 v[12:15], a[40:43], v[32:35], v[12:15]
 ds_read_b128 v[28:31], v71 offset:21504
 v_mfma_f32_16x16x32_bf16 v[16:19], a[44:47], v[32:35], v[16:19]
 v_mfma_f32_16x16x32_bf16 v[20:23], a[48:51], v[32:35], v[20:23]
 s_waitcnt lgkmcnt(2)
 v_mfma_f32_16x16x32_bf16 v[12:15], a[52:55], v[36:39], v[12:15]
 ds_read_b128 v[32:35], v71 offset:22528
 v_mfma_f32_16x16x32_bf16 v[16:19], a[56:59], v[36:39], v[16:19]
 v_mfma_f32_16x16x32_bf16 v[20:23], a[60:63], v[36:39], v[20:23]
 s_waitcnt lgkmcnt(2)
 v_mfma_f32_16x16x32_bf16 v[12:15], a[64:67], v[24:27], v[12:15]
 ds_read_b128 v[36:39], v71 offset:23552
 v_mfma_f32_16x16x32_bf16 v[16:19], a[68:71], v[24:27], v[16:19]
 v_mfma_f32_16x16x32_bf16 v[20:23], a[72:75], v[24:27], v[20:23]
 s_waitcnt lgkmcnt(2)
 v_mfma_f32_16x16x32_bf16 v[12:15], a[76:79], v[28:31], v[12:15]
 ds_read_b128 v[24:27], v71 offset:24576
 v_mfma_f32_16x16x32_bf16 v[16:19], a[80:83], v[28:31], v[16:19]
 v_mfma_f32_16x16x32_bf16 v[20:23], a[84:87], v[28:31], v[20:23]
 s_waitcnt lgkmcnt(2)
 v_mfma_f32_16x16x32_bf16 v[12:15], a[88:91], v[32:35], v[12:15]
 ds_read_b128 v[28:31], v71 offset:25600
 v_mfma_f32_16x16x32_bf16 v[16:19], a[92:95], v[32:35], v[16:19]
 v_mfma_f32_16x16x32_bf16 v[20:23], a[96:99], v[32:35], v[20:23]
 s_waitcnt lgkmcnt(2)
 v_mfma_f32_16x16x32_bf16 v[12:15], a[100:103], v[36:39], v[12:15]
 ds_read_b128 v[32:35], v71 offset:26624
 v_mfma_f32_16x16x32_bf16 v[16:19], a[104:107], v[36:39], v[16:19]
 v_mfma_f32_16x16x32_bf16 v[20:23], a[108:111], v[36:39], v[20:23]
 s_waitcnt lgkmcnt(2)
 v_mfma_f32_16x16x32_bf16 v[12:15], a[112:115], v[24:27], v[12:15]
 ds_read_b128 v[36:39], v71 offset:27648
 v_mfma_f32_16x16x32_bf16 v[16:19], a[116:119], v[24:27], v[16:19]
 v_mfma_f32_16x16x32_bf16 v[20:23], a[120:123], v[24:27], v[20:23]
 s_waitcnt lgkmcnt(2)
 v_mfma_f32_16x16x32_bf16 v[12:15], a[124:127], v[28:31], v[12:15]
 ds_read_b128 v[24:27], v71 offset:28672
 v_mfma_f32_16x16x32_bf16 v[16:19], a[128:131], v[28:31], v[16:19]
 v_mfma_f32_16x16x32_bf16 v[20:23], a[132:135], v[28:31], v[20:23]
 s_waitcnt lgkmcnt(2)
 v_mfma_f32_16x16x32_bf16 v[12:15], a[136:139], v[32:35], v[12:15]
 ds_read_b128 v[28:31], v71 offset:29696
 v_mfma_f32_16x16x32_bf16 v[16:19], a[140:143], v[32:35], v[16:19]
 v_mfma_f32_16x16x32_bf16 v[20:23], a[144:147], v[32:35], v[20:23]
 s_waitcnt lgkmcnt(2)
 v_mfma_f32_16x16x32_bf16 v[12:15], a[148:151], v[36:39], v[12:15]
 ds_read_b128 v[32:35], v71 offset:30720
 v_mfma_f32_16x16x32_bf16 v[16:19], a[152:155], v[36:39], v[16:19]
 v_mfma_f32_16x16x32_bf16 v[20:23], a[156:159], v[36:39], v[20:23]
 s_waitcnt lgkmcnt(2)
 v_mfma_f32_16x16x32_bf16 v[12:15], a[160:163], v[24:27], v[12:15]
 ds_read_b128 v[36:39], v71 offset:31744
 v_mfma_f32_16x16x32_bf16 v[16:19], a[164:167], v[24:27], v[16:19]
 v_mfma_f32_16x16x32_bf16 v[20:23], a[168:171], v[24:27], v[20:23]
 s_waitcnt vmcnt(0)
 v_add_u32 v64, v65, v75
 v_cmp_gt_u32 vcc, s74, v64
 s_waitcnt lgkmcnt(2)
 v_mfma_f32_16x16x32_bf16 v[12:15], a[172:175], v[28:31], v[12:15]
 ds_read_b128 v[24:27], v71 offset:32768
 v_cmp_gt_u32 s[66:67], s75, v64
 v_mfma_f32_16x16x32_bf16 v[16:19], a[176:179], v[28:31], v[16:19]
 v_mfma_f32_16x16x32_bf16 v[20:23], a[180:183], v[28:31], v[20:23]
 s_waitcnt lgkmcnt(2)
 v_mfma_f32_16x16x32_bf16 v[12:15], a[184:187], v[32:35], v[12:15]
 ds_read_b128 v[28:31], v71 offset:33792
 s_cmp_eq_u32 s67, 0
 s_cselect_b32 s72, 2, 0
 s_cmp_eq_u32 vcc_lo, 0
 s_cselect_b32 s72, 1, s72
 v_mfma_f32_16x16x32_bf16 v[16:19], a[188:191], v[32:35], v[16:19]
 v_mov_b32 v76, s72
 v_mfma_f32_16x16x32_bf16 v[20:23], a[192:195], v[32:35], v[20:23]
 ds_write_b32 v72, v76 offset:4
 s_waitcnt lgkmcnt(3)
 v_mfma_f32_16x16x32_bf16 v[12:15], a[196:199], v[36:39], v[12:15]
 ds_read_b128 v[32:35], v71 offset:34816
 v_mfma_f32_16x16x32_bf16 v[16:19], a[200:203], v[36:39], v[16:19]
 v_mfma_f32_16x16x32_bf16 v[20:23], a[204:207], v[36:39], v[20:23]
 s_waitcnt lgkmcnt(3)
 v_mfma_f32_16x16x32_bf16 v[12:15], a[208:211], v[24:27], v[12:15]
 ds_read_b128 v[36:39], v71 offset:35840
 v_mfma_f32_16x16x32_bf16 v[16:19], a[212:215], v[24:27], v[16:19]
 v_mfma_f32_16x16x32_bf16 v[20:23], a[216:219], v[24:27], v[20:23]
 s_waitcnt lgkmcnt(2)
 s_barrier
 ds_read_b32 v76, v73 offset:4
 s_waitcnt lgkmcnt(3)
 v_mfma_f32_16x16x32_bf16 v[12:15], a[220:223], v[28:31], v[12:15]
 v_mfma_f32_16x16x32_bf16 v[16:19], a[224:227], v[28:31], v[16:19]
 v_mfma_f32_16x16x32_bf16 v[20:23], a[228:231], v[28:31], v[20:23]
 s_waitcnt lgkmcnt(2)
 v_mfma_f32_16x16x32_bf16 v[12:15], a[232:235], v[32:35], v[12:15]
 v_mfma_f32_16x16x32_bf16 v[16:19], a[236:239], v[32:35], v[16:19]
 v_mfma_f32_16x16x32_bf16 v[20:23], a[240:243], v[32:35], v[20:23]
 s_waitcnt lgkmcnt(0)
 v_readfirstlane_b32 s72, v76
 v_mfma_f32_16x16x32_bf16 v[12:15], a[244:247], v[36:39], v[12:15]
 v_mfma_f32_16x16x32_bf16 v[16:19], a[248:251], v[36:39], v[16:19]
 v_mfma_f32_16x16x32_bf16 v[20:23], a[252:255], v[36:39], v[20:23]
 s_cmp_lg_u32 s72, 0
 s_cbranch_scc0 L_dn_t2
 s_nop 7
 v_cvt_pk_bf16_f32 v58, v20, v21
 v_cvt_pk_bf16_f32 v59, v22, v23
 v_cvt_pk_bf16_f32 v52, v12, v13
 v_cvt_pk_bf16_f32 v53, v14, v15
 v_cvt_pk_bf16_f32 v54, v16, v17
 v_cvt_pk_bf16_f32 v55, v18, v19
 buffer_store_dwordx4 v[52:55], v73, s[8:11], s77 offen offset:1024
 v_permlane32_swap_b32 v56, v58
 v_permlane32_swap_b32 v57, v59
 buffer_store_dwordx4 v[56:59], v73, s[8:11], s77 offen offset:2048
 s_sub_u32 s68, s72, 1
 s_cmp_eq_u32 s68, 0
 s_cselect_b32 s69, s74, s75
 s_cselect_b32 s63, s44, s47
 s_cselect_b32 s64, s45, s48
 s_cselect_b32 s80, s46, s49
 s_cmp_lt_u32 s69, s63
 s_cselect_b32 s80, s64, s80
 s_add_u32 s80, s80, s69
 s_cmp_eq_u32 s68, 0
 s_cselect_b32 s74, s80, s74
 s_cselect_b32 s75, s75, s80
 s_mul_i32 s73, s69, 294912
 s_mul_i32 s63, s68, 18874368
 s_add_u32 s73, s73, s63
 s_add_u32 s73, s73, s90
 s_mov_b32 m0, s70
 s_nop 0
 buffer_load_dwordx4 v72, s[8:11], s73 offen sc1 lds
 s_add_u32 m0, m0, s3
 s_add_u32 s73, s73, s3
 buffer_load_dwordx4 v72, s[8:11], s73 offen sc1 lds
 s_add_u32 m0, m0, s3
 s_add_u32 s73, s73, s3
 buffer_load_dwordx4 v72, s[8:11], s73 offen sc1 lds
 s_add_u32 m0, m0, s3
 s_add_u32 s73, s73, s3
 buffer_load_dwordx4 v72, s[8:11], s73 offen sc1 lds
 s_add_u32 m0, m0, s3
 s_add_u32 s73, s73, s3
 buffer_load_dwordx4 v72, s[8:11], s73 offen sc1 lds
 s_add_u32 m0, m0, s3
 s_add_u32 s73, s73, s3
 buffer_load_dwordx4 v72, s[8:11], s73 offen sc1 lds
 s_add_u32 m0, m0, s3
 s_add_u32 s73, s73, s3
 buffer_load_dwordx4 v72, s[8:11], s73 offen sc1 lds
 s_add_u32 m0, m0, s3
 s_add_u32 s73, s73, s3
 buffer_load_dwordx4 v72, s[8:11], s73 offen sc1 lds
 s_add_u32 m0, m0, s3
 s_add_u32 s73, s73, s3
 buffer_load_dwordx4 v72, s[8:11], s73 offen sc1 lds
 s_add_u32 m0, m0, s3
 s_add_u32 s73, s73, s3
 buffer_load_dwordx4 v72, s[8:11], s73 offen sc1 lds
 s_add_u32 m0, m0, s3
 s_add_u32 s73, s73, s3
 buffer_load_dwordx4 v72, s[8:11], s73 offen sc1 lds
 s_add_u32 m0, m0, s3
 s_add_u32 s73, s73, s3
 buffer_load_dwordx4 v72, s[8:11], s73 offen sc1 lds
 s_add_u32 m0, m0, s3
 s_add_u32 s73, s73, s3
 buffer_load_dwordx4 v72, s[8:11], s73 offen sc1 lds
 s_add_u32 m0, m0, s3
 s_add_u32 s73, s73, s3
 buffer_load_dwordx4 v72, s[8:11], s73 offen sc1 lds
 s_add_u32 m0, m0, s3
 s_add_u32 s73, s73, s3
 buffer_load_dwordx4 v72, s[8:11], s73 offen sc1 lds
 s_add_u32 m0, m0, s3
 s_add_u32 s73, s73, s3
 buffer_load_dwordx4 v72, s[8:11], s73 offen sc1 lds
 s_add_u32 m0, m0, s3
 s_add_u32 s73, s73, s3
 buffer_load_dwordx4 v72, s[8:11], s73 offen sc1 lds
 s_add_u32 m0, m0, s3
 s_add_u32 s73, s73, s3
 buffer_load_dwordx4 v72, s[8:11], s73 offen sc1 lds
 v_mov_b32 v76, s93
 s_waitcnt vmcnt(18)
 s_barrier
 buffer_store_dword v76, v77, s[8:11], s92 offen
 s_mov_b32 s5, s85
 s_sub_u32 s85, 0, s85
 s_add_u32 s70, s70, s85
 s_mov_b32 s81, s77
 s_mov_b32 s82, s78
 s_mov_b32 s83, s79
 s_mov_b32 s94, s92
 s_mov_b32 s95, s93
 s_mul_i32 s64, s68, 0
 s_add_u32 s64, s64, 4
 s_mul_i32 s63, s68, 0
 s_add_u32 s63, s63, 128
 s_mul_i32 s63, s69, s63
 s_lshr_b32 s63, s63, 9
 s_mul_i32 s63, s63, s64
 s_sub_u32 s63, s69, s63
 s_mul_i32 s63, s63, 294912
 s_mul_i32 s64, s68, 1179648
 s_add_u32 s63, s63, s64
 s_add_u32 s77, s63, s87
 s_add_u32 s78, s63, s88
 s_add_u32 s79, s63, s89
 s_mul_i32 s92, s68, 512
 s_sub_u32 s93, s80, 1
 s_min_u32 s93, s93, 64
 s_add_u32 s61, s61, 1
 v_add_u32 v70, s5, v70
 v_add_u32 v71, s5, v71
 v_add_u32 v64, v65, v75
 v_cmp_gt_u32 vcc, s74, v64
 v_cmp_gt_u32 s[66:67], s75, v64
 s_cmp_eq_u32 s67, 0
 s_cselect_b32 s72, 2, 0
 s_cmp_eq_u32 vcc_lo, 0
 s_cselect_b32 s72, 1, s72
 v_mov_b32 v76, s72
 ds_write_b32 v72, v76 offset:12
 s_waitcnt vmcnt(10) lgkmcnt(0)
 s_barrier
 ds_read_b32 v76, v73 offset:12
 ds_read_b128 v[24:27], v70 offset:0
 ds_read_b128 v[28:31], v70 offset:1024
 ds_read_b128 v[32:35], v70 offset:2048
 s_waitcnt lgkmcnt(3)
 v_readfirstlane_b32 s72, v76
 s_cmp_lg_u32 s72, 0
 s_branch L_dn_slow
L_dn_t2:
 s_nop 7
 v_cvt_pk_bf16_f32 v58, v20, v21
 v_cvt_pk_bf16_f32 v59, v22, v23
 v_cvt_pk_bf16_f32 v52, v12, v13
 v_cvt_pk_bf16_f32 v53, v14, v15
 v_cvt_pk_bf16_f32 v54, v16, v17
 v_cvt_pk_bf16_f32 v55, v18, v19
 buffer_store_dwordx4 v[52:55], v73, s[8:11], s77 offen offset:1024
 v_permlane32_swap_b32 v56, v58
 v_permlane32_swap_b32 v57, v59
 buffer_store_dwordx4 v[56:59], v73, s[8:11], s77 offen offset:2048
 v_mov_b32 v76, s93
 s_waitcnt vmcnt(0)
 s_barrier
 buffer_store_dword v76, v77, s[8:11], s92 offen
 s_cmp_ge_u32 s61, s91
 s_cbranch_scc1 L_dn_done
 s_branch L_dn_idle
L_dn_sl:
 s_cmp_lg_u32 s58, 0
 s_cbranch_scc1 Lspd_68
 s_mov_b32 s62, 0
Lsp_67:
 buffer_load_dword v75, v74, s[8:11], 0 offen sc1
 s_waitcnt vmcnt(0)
 v_add_u32 v64, v65, v75
 v_cmp_gt_u32 vcc, s74, v64
 v_cmp_gt_u32 s[66:67], s75, v64
 s_cmp_eq_u32 s67, 0
 s_cselect_b32 s72, 2, 0
 s_cmp_eq_u32 vcc_lo, 0
 s_cselect_b32 s72, 1, s72
 v_mov_b32 v76, s72
 ds_write_b32 v72, v76 offset:4096
 s_cmp_lg_u32 s72, 0
 s_cbranch_scc1 Lspd_68
 s_add_u32 s62, s62, 1
 s_cmp_lt_u32 s62, 400000
 s_cbranch_scc1 Lsp_67
Lspd_68:
 s_waitcnt lgkmcnt(0)
 s_barrier
 ds_read_b32 v76, v73 offset:4096
 s_waitcnt lgkmcnt(0)
 v_readfirstlane_b32 s72, v76
 s_mov_b32 s63, 51
 s_cmp_eq_u32 s72, 0
 s_cbranch_scc1 L_abort_b
 s_sub_u32 s68, s72, 1
 s_cmp_eq_u32 s68, 0
 s_cselect_b32 s69, s74, s75
 s_cselect_b32 s63, s44, s47
 s_cselect_b32 s64, s45, s48
 s_cselect_b32 s80, s46, s49
 s_cmp_lt_u32 s69, s63
 s_cselect_b32 s80, s64, s80
 s_add_u32 s80, s80, s69
 s_cmp_eq_u32 s68, 0
 s_cselect_b32 s74, s80, s74
 s_cselect_b32 s75, s75, s80
 s_mul_i32 s73, s69, 294912
 s_mul_i32 s63, s68, 18874368
 s_add_u32 s73, s73, s63
 s_add_u32 s73, s73, s90
 s_mov_b32 m0, s70
 s_nop 0
 buffer_load_dwordx4 v72, s[8:11], s73 offen sc1 lds
 s_add_u32 m0, m0, s3
 s_add_u32 s73, s73, s3
 buffer_load_dwordx4 v72, s[8:11], s73 offen sc1 lds
 s_add_u32 m0, m0, s3
 s_add_u32 s73, s73, s3
 buffer_load_dwordx4 v72, s[8:11], s73 offen sc1 lds
 s_add_u32 m0, m0, s3
 s_add_u32 s73, s73, s3
 buffer_load_dwordx4 v72, s[8:11], s73 offen sc1 lds
 s_add_u32 m0, m0, s3
 s_add_u32 s73, s73, s3
 buffer_load_dwordx4 v72, s[8:11], s73 offen sc1 lds
 s_add_u32 m0, m0, s3
 s_add_u32 s73, s73, s3
 buffer_load_dwordx4 v72, s[8:11], s73 offen sc1 lds
 s_add_u32 m0, m0, s3
 s_add_u32 s73, s73, s3
 buffer_load_dwordx4 v72, s[8:11], s73 offen sc1 lds
 s_add_u32 m0, m0, s3
 s_add_u32 s73, s73, s3
 buffer_load_dwordx4 v72, s[8:11], s73 offen sc1 lds
 s_add_u32 m0, m0, s3
 s_add_u32 s73, s73, s3
 buffer_load_dwordx4 v72, s[8:11], s73 offen sc1 lds
 s_add_u32 m0, m0, s3
 s_add_u32 s73, s73, s3
 buffer_load_dwordx4 v72, s[8:11], s73 offen sc1 lds
 s_add_u32 m0, m0, s3
 s_add_u32 s73, s73, s3
 buffer_load_dwordx4 v72, s[8:11], s73 offen sc1 lds
 s_add_u32 m0, m0, s3
 s_add_u32 s73, s73, s3
 buffer_load_dwordx4 v72, s[8:11], s73 offen sc1 lds
 s_add_u32 m0, m0, s3
 s_add_u32 s73, s73, s3
 buffer_load_dwordx4 v72, s[8:11], s73 offen sc1 lds
 s_add_u32 m0, m0, s3
 s_add_u32 s73, s73, s3
 buffer_load_dwordx4 v72, s[8:11], s73 offen sc1 lds
 s_add_u32 m0, m0, s3
 s_add_u32 s73, s73, s3
 buffer_load_dwordx4 v72, s[8:11], s73 offen sc1 lds
 s_add_u32 m0, m0, s3
 s_add_u32 s73, s73, s3
 buffer_load_dwordx4 v72, s[8:11], s73 offen sc1 lds
 s_add_u32 m0, m0, s3
 s_add_u32 s73, s73, s3
 buffer_load_dwordx4 v72, s[8:11], s73 offen sc1 lds
 s_add_u32 m0, m0, s3
 s_add_u32 s73, s73, s3
 buffer_load_dwordx4 v72, s[8:11], s73 offen sc1 lds
 s_mov_b32 s5, s85
 s_sub_u32 s85, 0, s85
 s_add_u32 s70, s70, s85
 s_mov_b32 s81, s77
 s_mov_b32 s82, s78
 s_mov_b32 s83, s79
 s_mov_b32 s94, s92
 s_mov_b32 s95, s93
 s_mul_i32 s64, s68, 0
 s_add_u32 s64, s64, 4
 s_mul_i32 s63, s68, 0
 s_add_u32 s63, s63, 128
 s_mul_i32 s63, s69, s63
 s_lshr_b32 s63, s63, 9
 s_mul_i32 s63, s63, s64
 s_sub_u32 s63, s69, s63
 s_mul_i32 s63, s63, 294912
 s_mul_i32 s64, s68, 1179648
 s_add_u32 s63, s63, s64
 s_add_u32 s77, s63, s87
 s_add_u32 s78, s63, s88
 s_add_u32 s79, s63, s89
 s_mul_i32 s92, s68, 512
 s_sub_u32 s93, s80, 1
 s_min_u32 s93, s93, 64
 s_add_u32 s61, s61, 1
 v_add_u32 v70, s5, v70
 v_add_u32 v71, s5, v71
 s_waitcnt vmcnt(0)
 s_barrier
 ds_read_b128 v[24:27], v70 offset:0
 ds_read_b128 v[28:31], v70 offset:1024
 ds_read_b128 v[32:35], v70 offset:2048
 s_waitcnt lgkmcnt(2)
 v_mfma_f32_16x16x32_bf16 v[0:3], v[80:83], v[24:27], 0
 ds_read_b128 v[36:39], v70 offset:3072
 v_mfma_f32_16x16x32_bf16 v[4:7], v[84:87], v[24:27], 0
 v_mfma_f32_16x16x32_bf16 v[8:11], v[88:91], v[24:27], 0
 s_waitcnt lgkmcnt(2)
 v_mfma_f32_16x16x32_bf16 v[0:3], v[92:95], v[28:31], v[0:3]
 ds_read_b128 v[24:27], v70 offset:4096
 v_mfma_f32_16x16x32_bf16 v[4:7], v[96:99], v[28:31], v[4:7]
 v_mfma_f32_16x16x32_bf16 v[8:11], v[100:103], v[28:31], v[8:11]
 s_waitcnt lgkmcnt(2)
 v_mfma_f32_16x16x32_bf16 v[0:3], v[104:107], v[32:35], v[0:3]
 ds_read_b128 v[28:31], v70 offset:5120
 v_mfma_f32_16x16x32_bf16 v[4:7], v[108:111], v[32:35], v[4:7]
 v_mfma_f32_16x16x32_bf16 v[8:11], v[112:115], v[32:35], v[8:11]
 s_waitcnt lgkmcnt(2)
 v_mfma_f32_16x16x32_bf16 v[0:3], v[116:119], v[36:39], v[0:3]
 ds_read_b128 v[32:35], v70 offset:6144
 v_mfma_f32_16x16x32_bf16 v[4:7], v[120:123], v[36:39], v[4:7]
 v_mfma_f32_16x16x32_bf16 v[8:11], v[124:127], v[36:39], v[8:11]
 s_waitcnt lgkmcnt(2)
 v_mfma_f32_16x16x32_bf16 v[0:3], v[128:131], v[24:27], v[0:3]
 ds_read_b128 v[36:39], v70 offset:7168
 v_mfma_f32_16x16x32_bf16 v[4:7], v[132:135], v[24:27], v[4:7]
 v_mfma_f32_16x16x32_bf16 v[8:11], v[136:139], v[24:27], v[8:11]
 s_waitcnt lgkmcnt(2)
 v_mfma_f32_16x16x32_bf16 v[0:3], v[140:143], v[28:31], v[0:3]
 ds_read_b128 v[24:27], v70 offset:8192
 v_mfma_f32_16x16x32_bf16 v[4:7], v[144:147], v[28:31], v[4:7]
 v_mfma_f32_16x16x32_bf16 v[8:11], v[148:151], v[28:31], v[8:11]
 s_waitcnt lgkmcnt(2)
 v_mfma_f32_16x16x32_bf16 v[0:3], v[152:155], v[32:35], v[0:3]
 ds_read_b128 v[28:31], v70 offset:9216
 v_mfma_f32_16x16x32_bf16 v[4:7], v[156:159], v[32:35], v[4:7]
 v_mfma_f32_16x16x32_bf16 v[8:11], v[160:163], v[32:35], v[8:11]
 s_waitcnt lgkmcnt(2)
 v_mfma_f32_16x16x32_bf16 v[0:3], v[164:167], v[36:39], v[0:3]
 ds_read_b128 v[32:35], v70 offset:10240
 v_mfma_f32_16x16x32_bf16 v[4:7], v[168:171], v[36:39], v[4:7]
 v_mfma_f32_16x16x32_bf16 v[8:11], v[172:175], v[36:39], v[8:11]
 s_waitcnt lgkmcnt(2)
 v_mfma_f32_16x16x32_bf16 v[0:3], v[176:179], v[24:27], v[0:3]
 ds_read_b128 v[36:39], v70 offset:11264
 v_mfma_f32_16x16x32_bf16 v[4:7], v[180:183], v[24:27], v[4:7]
 v_mfma_f32_16x16x32_bf16 v[8:11], v[184:187], v[24:27], v[8:11]
 s_waitcnt lgkmcnt(2)
 v_mfma_f32_16x16x32_bf16 v[0:3], v[188:191], v[28:31], v[0:3]
 ds_read_b128 v[24:27], v70 offset:12288
 v_mfma_f32_16x16x32_bf16 v[4:7], v[192:195], v[28:31], v[4:7]
 v_mfma_f32_16x16x32_bf16 v[8:11], v[196:199], v[28:31], v[8:11]
 s_waitcnt lgkmcnt(2)
 v_mfma_f32_16x16x32_bf16 v[0:3], v[200:203], v[32:35], v[0:3]
 ds_read_b128 v[28:31], v70 offset:13312
 v_mfma_f32_16x16x32_bf16 v[4:7], v[204:207], v[32:35], v[4:7]
 v_mfma_f32_16x16x32_bf16 v[8:11], v[208:211], v[32:35], v[8:11]
 s_waitcnt lgkmcnt(2)
 v_mfma_f32_16x16x32_bf16 v[0:3], v[212:215], v[36:39], v[0:3]
 ds_read_b128 v[32:35], v70 offset:14336
 v_mfma_f32_16x16x32_bf16 v[4:7], v[216:219], v[36:39], v[4:7]
 v_mfma_f32_16x16x32_bf16 v[8:11], v[220:223], v[36:39], v[8:11]
 s_waitcnt lgkmcnt(2)
 v_mfma_f32_16x16x32_bf16 v[0:3], v[224:227], v[24:27], v[0:3]
 ds_read_b128 v[36:39], v70 offset:15360
 v_mfma_f32_16x16x32_bf16 v[4:7], v[228:231], v[24:27], v[4:7]
 v_mfma_f32_16x16x32_bf16 v[8:11], v[232:235], v[24:27], v[8:11]
 s_waitcnt lgkmcnt(2)
 v_mfma_f32_16x16x32_bf16 v[0:3], v[236:239], v[28:31], v[0:3]
 ds_read_b128 v[24:27], v70 offset:16384
 v_mfma_f32_16x16x32_bf16 v[4:7], v[240:243], v[28:31], v[4:7]
 v_mfma_f32_16x16x32_bf16 v[8:11], v[244:247], v[28:31], v[8:11]
 s_waitcnt lgkmcnt(2)
 v_mfma_f32_16x16x32_bf16 v[0:3], v[248:251], v[32:35], v[0:3]
 ds_read_b128 v[28:31], v70 offset:17408
 v_mfma_f32_16x16x32_bf16 v[4:7], v[252:255], v[32:35], v[4:7]
 v_mfma_f32_16x16x32_bf16 v[8:11], a[0:3], v[32:35], v[8:11]
 s_waitcnt lgkmcnt(2)
 v_mfma_f32_16x16x32_bf16 v[0:3], a[4:7], v[36:39], v[0:3]
 ds_read_b128 v[32:35], v70 offset:18432
 v_mfma_f32_16x16x32_bf16 v[4:7], a[8:11], v[36:39], v[4:7]
 v_mfma_f32_16x16x32_bf16 v[8:11], a[12:15], v[36:39], v[8:11]
 s_waitcnt lgkmcnt(2)
 v_mfma_f32_16x16x32_bf16 v[0:3], a[16:19], v[24:27], v[0:3]
 ds_read_b128 v[36:39], v70 offset:19456
 v_mfma_f32_16x16x32_bf16 v[4:7], a[20:23], v[24:27], v[4:7]
 v_mfma_f32_16x16x32_bf16 v[8:11], a[24:27], v[24:27], v[8:11]
 s_waitcnt lgkmcnt(2)
 v_mfma_f32_16x16x32_bf16 v[0:3], a[28:31], v[28:31], v[0:3]
 ds_read_b128 v[24:27], v70 offset:20480
 v_mfma_f32_16x16x32_bf16 v[4:7], a[32:35], v[28:31], v[4:7]
 v_mfma_f32_16x16x32_bf16 v[8:11], a[36:39], v[28:31], v[8:11]
 s_waitcnt lgkmcnt(2)
 v_mfma_f32_16x16x32_bf16 v[0:3], a[40:43], v[32:35], v[0:3]
 ds_read_b128 v[28:31], v70 offset:21504
 v_mfma_f32_16x16x32_bf16 v[4:7], a[44:47], v[32:35], v[4:7]
 v_mfma_f32_16x16x32_bf16 v[8:11], a[48:51], v[32:35], v[8:11]
 s_waitcnt lgkmcnt(2)
 v_mfma_f32_16x16x32_bf16 v[0:3], a[52:55], v[36:39], v[0:3]
 ds_read_b128 v[32:35], v70 offset:22528
 v_mfma_f32_16x16x32_bf16 v[4:7], a[56:59], v[36:39], v[4:7]
 v_mfma_f32_16x16x32_bf16 v[8:11], a[60:63], v[36:39], v[8:11]
 s_waitcnt lgkmcnt(2)
 v_mfma_f32_16x16x32_bf16 v[0:3], a[64:67], v[24:27], v[0:3]
 ds_read_b128 v[36:39], v70 offset:23552
 v_mfma_f32_16x16x32_bf16 v[4:7], a[68:71], v[24:27], v[4:7]
 v_mfma_f32_16x16x32_bf16 v[8:11], a[72:75], v[24:27], v[8:11]
 s_waitcnt lgkmcnt(2)
 v_mfma_f32_16x16x32_bf16 v[0:3], a[76:79], v[28:31], v[0:3]
 ds_read_b128 v[24:27], v70 offset:24576
 v_mfma_f32_16x16x32_bf16 v[4:7], a[80:83], v[28:31], v[4:7]
 v_mfma_f32_16x16x32_bf16 v[8:11], a[84:87], v[28:31], v[8:11]
 s_waitcnt lgkmcnt(2)
 v_mfma_f32_16x16x32_bf16 v[0:3], a[88:91], v[32:35], v[0:3]
 ds_read_b128 v[28:31], v70 offset:25600
 v_mfma_f32_16x16x32_bf16 v[4:7], a[92:95], v[32:35], v[4:7]
 v_mfma_f32_16x16x32_bf16 v[8:11], a[96:99], v[32:35], v[8:11]
 s_waitcnt lgkmcnt(2)
 v_mfma_f32_16x16x32_bf16 v[0:3], a[100:103], v[36:39], v[0:3]
 ds_read_b128 v[32:35], v70 offset:26624
 v_mfma_f32_16x16x32_bf16 v[4:7], a[104:107], v[36:39], v[4:7]
 v_mfma_f32_16x16x32_bf16 v[8:11], a[108:111], v[36:39], v[8:11]
 s_waitcnt lgkmcnt(2)
 v_mfma_f32_16x16x32_bf16 v[0:3], a[112:115], v[24:27], v[0:3]
 ds_read_b128 v[36:39], v70 offset:27648
 v_mfma_f32_16x16x32_bf16 v[4:7], a[116:119], v[24:27], v[4:7]
 v_mfma_f32_16x16x32_bf16 v[8:11], a[120:123], v[24:27], v[8:11]
 s_waitcnt lgkmcnt(2)
 v_mfma_f32_16x16x32_bf16 v[0:3], a[124:127], v[28:31], v[0:3]
 ds_read_b128 v[24:27], v70 offset:28672
 v_mfma_f32_16x16x32_bf16 v[4:7], a[128:131], v[28:31], v[4:7]
 v_mfma_f32_16x16x32_bf16 v[8:11], a[132:135], v[28:31], v[8:11]
 s_waitcnt lgkmcnt(2)
 v_mfma_f32_16x16x32_bf16 v[0:3], a[136:139], v[32:35], v[0:3]
 ds_read_b128 v[28:31], v70 offset:29696
 v_mfma_f32_16x16x32_bf16 v[4:7], a[140:143], v[32:35], v[4:7]
 v_mfma_f32_16x16x32_bf16 v[8:11], a[144:147], v[32:35], v[8:11]
 s_waitcnt lgkmcnt(2)
 v_mfma_f32_16x16x32_bf16 v[0:3], a[148:151], v[36:39], v[0:3]
 ds_read_b128 v[32:35], v70 offset:30720
 v_mfma_f32_16x16x32_bf16 v[4:7], a[152:155], v[36:39], v[4:7]
 v_mfma_f32_16x16x32_bf16 v[8:11], a[156:159], v[36:39], v[8:11]
 s_waitcnt lgkmcnt(2)
 v_mfma_f32_16x16x32_bf16 v[0:3], a[160:163], v[24:27], v[0:3]
 ds_read_b128 v[36:39], v70 offset:31744
 v_mfma_f32_16x16x32_bf16 v[4:7], a[164:167], v[24:27], v[4:7]
 v_mfma_f32_16x16x32_bf16 v[8:11], a[168:171], v[24:27], v[8:11]
 s_waitcnt lgkmcnt(2)
 v_mfma_f32_16x16x32_bf16 v[0:3], a[172:175], v[28:31], v[0:3]
 ds_read_b128 v[24:27], v70 offset:32768
 v_mfma_f32_16x16x32_bf16 v[4:7], a[176:179], v[28:31], v[4:7]
 v_mfma_f32_16x16x32_bf16 v[8:11], a[180:183], v[28:31], v[8:11]
 s_waitcnt lgkmcnt(2)
 v_mfma_f32_16x16x32_bf16 v[0:3], a[184:187], v[32:35], v[0:3]
 ds_read_b128 v[28:31], v70 offset:33792
 v_mfma_f32_16x16x32_bf16 v[4:7], a[188:191], v[32:35], v[4:7]
 v_mfma_f32_16x16x32_bf16 v[8:11], a[192:195], v[32:35], v[8:11]
 s_waitcnt lgkmcnt(2)
 v_mfma_f32_16x16x32_bf16 v[0:3], a[196:199], v[36:39], v[0:3]
 ds_read_b128 v[32:35], v70 offset:34816
 v_mfma_f32_16x16x32_bf16 v[4:7], a[200:203], v[36:39], v[4:7]
 v_mfma_f32_16x16x32_bf16 v[8:11], a[204:207], v[36:39], v[8:11]
 s_waitcnt lgkmcnt(2)
 v_mfma_f32_16x16x32_bf16 v[0:3], a[208:211], v[24:27], v[0:3]
 ds_read_b128 v[36:39], v70 offset:35840
 v_mfma_f32_16x16x32_bf16 v[4:7], a[212:215], v[24:27], v[4:7]
 v_mfma_f32_16x16x32_bf16 v[8:11], a[216:219], v[24:27], v[8:11]
 s_waitcnt lgkmcnt(2)
 v_mfma_f32_16x16x32_bf16 v[0:3], a[220:223], v[28:31], v[0:3]
 ds_read_b128 v[24:27], v71 offset:0
 v_mfma_f32_16x16x32_bf16 v[4:7], a[224:227], v[28:31], v[4:7]
 v_mfma_f32_16x16x32_bf16 v[8:11], a[228:231], v[28:31], v[8:11]
 s_waitcnt lgkmcnt(2)
 v_mfma_f32_16x16x32_bf16 v[0:3], a[232:235], v[32:35], v[0:3]
 ds_read_b128 v[28:31], v71 offset:1024
 v_mfma_f32_16x16x32_bf16 v[4:7], a[236:239], v[32:35], v[4:7]
 v_mfma_f32_16x16x32_bf16 v[8:11], a[240:243], v[32:35], v[8:11]
 s_waitcnt lgkmcnt(2)
 v_mfma_f32_16x16x32_bf16 v[0:3], a[244:247], v[36:39], v[0:3]
 ds_read_b128 v[32:35], v71 offset:2048
 v_mfma_f32_16x16x32_bf16 v[4:7], a[248:251], v[36:39], v[4:7]
 v_mfma_f32_16x16x32_bf16 v[8:11], a[252:255], v[36:39], v[8:11]
 s_waitcnt lgkmcnt(2)
 v_mfma_f32_16x16x32_bf16 v[12:15], v[80:83], v[24:27], 0
 ds_read_b128 v[36:39], v71 offset:3072
 v_mfma_f32_16x16x32_bf16 v[16:19], v[84:87], v[24:27], 0
 v_mfma_f32_16x16x32_bf16 v[20:23], v[88:91], v[24:27], 0
 s_waitcnt lgkmcnt(2)
 v_mfma_f32_16x16x32_bf16 v[12:15], v[92:95], v[28:31], v[12:15]
 ds_read_b128 v[24:27], v71 offset:4096
 v_mfma_f32_16x16x32_bf16 v[16:19], v[96:99], v[28:31], v[16:19]
 v_cvt_pk_bf16_f32 v48, v0, v1
 v_mfma_f32_16x16x32_bf16 v[20:23], v[100:103], v[28:31], v[20:23]
 v_cvt_pk_bf16_f32 v49, v2, v3
 s_waitcnt lgkmcnt(2)
 v_mfma_f32_16x16x32_bf16 v[12:15], v[104:107], v[32:35], v[12:15]
 ds_read_b128 v[28:31], v71 offset:5120
 v_cvt_pk_bf16_f32 v50, v4, v5
 v_mfma_f32_16x16x32_bf16 v[16:19], v[108:111], v[32:35], v[16:19]
 v_cvt_pk_bf16_f32 v51, v6, v7
 v_mfma_f32_16x16x32_bf16 v[20:23], v[112:115], v[32:35], v[20:23]
 buffer_store_dwordx4 v[48:51], v73, s[8:11], s77 offen offset:0 sc1
 v_cvt_pk_bf16_f32 v56, v8, v9
 s_waitcnt lgkmcnt(2)
 v_mfma_f32_16x16x32_bf16 v[12:15], v[116:119], v[36:39], v[12:15]
 ds_read_b128 v[32:35], v71 offset:6144
 v_cvt_pk_bf16_f32 v57, v10, v11
 v_mfma_f32_16x16x32_bf16 v[16:19], v[120:123], v[36:39], v[16:19]
 v_mfma_f32_16x16x32_bf16 v[20:23], v[124:127], v[36:39], v[20:23]
 s_waitcnt lgkmcnt(2)
 v_mfma_f32_16x16x32_bf16 v[12:15], v[128:131], v[24:27], v[12:15]
 ds_read_b128 v[36:39], v71 offset:7168
 v_mfma_f32_16x16x32_bf16 v[16:19], v[132:135], v[24:27], v[16:19]
 v_mfma_f32_16x16x32_bf16 v[20:23], v[136:139], v[24:27], v[20:23]
 s_waitcnt lgkmcnt(2)
 v_mfma_f32_16x16x32_bf16 v[12:15], v[140:143], v[28:31], v[12:15]
 ds_read_b128 v[24:27], v71 offset:8192
 v_mfma_f32_16x16x32_bf16 v[16:19], v[144:147], v[28:31], v[16:19]
 v_mfma_f32_16x16x32_bf16 v[20:23], v[148:151], v[28:31], v[20:23]
 s_waitcnt lgkmcnt(2)
 v_mfma_f32_16x16x32_bf16 v[12:15], v[152:155], v[32:35], v[12:15]
 ds_read_b128 v[28:31], v71 offset:9216
 v_mfma_f32_16x16x32_bf16 v[16:19], v[156:159], v[32:35], v[16:19]
 v_mfma_f32_16x16x32_bf16 v[20:23], v[160:163], v[32:35], v[20:23]
 s_waitcnt lgkmcnt(2)
 v_mfma_f32_16x16x32_bf16 v[12:15], v[164:167], v[36:39], v[12:15]
 ds_read_b128 v[32:35], v71 offset:10240
 v_mfma_f32_16x16x32_bf16 v[16:19], v[168:171], v[36:39], v[16:19]
 v_mfma_f32_16x16x32_bf16 v[20:23], v[172:175], v[36:39], v[20:23]
 s_waitcnt lgkmcnt(2)
 v_mfma_f32_16x16x32_bf16 v[12:15], v[176:179], v[24:27], v[12:15]
 ds_read_b128 v[36:39], v71 offset:11264
 v_mfma_f32_16x16x32_bf16 v[16:19], v[180:183], v[24:27], v[16:19]
 v_mfma_f32_16x16x32_bf16 v[20:23], v[184:187], v[24:27], v[20:23]
 s_waitcnt lgkmcnt(2)
 v_mfma_f32_16x16x32_bf16 v[12:15], v[188:191], v[28:31], v[12:15]
 ds_read_b128 v[24:27], v71 offset:12288
 v_mfma_f32_16x16x32_bf16 v[16:19], v[192:195], v[28:31], v[16:19]
 v_mfma_f32_16x16x32_bf16 v[20:23], v[196:199], v[28:31], v[20:23]
 s_waitcnt lgkmcnt(2)
 v_mfma_f32_16x16x32_bf16 v[12:15], v[200:203], v[32:35], v[12:15]
 ds_read_b128 v[28:31], v71 offset:13312
 v_mfma_f32_16x16x32_bf16 v[16:19], v[204:207], v[32:35], v[16:19]
 v_mfma_f32_16x16x32_bf16 v[20:23], v[208:211], v[32:35], v[20:23]
 s_waitcnt lgkmcnt(2)
 v_mfma_f32_16x16x32_bf16 v[12:15], v[212:215], v[36:39], v[12:15]
 ds_read_b128 v[32:35], v71 offset:14336
 v_mfma_f32_16x16x32_bf16 v[16:19], v[216:219], v[36:39], v[16:19]
 v_mfma_f32_16x16x32_bf16 v[20:23], v[220:223], v[36:39], v[20:23]
 s_waitcnt lgkmcnt(2)
 v_mfma_f32_16x16x32_bf16 v[12:15], v[224:227], v[24:27], v[12:15]
 ds_read_b128 v[36:39], v71 offset:15360
 v_mfma_f32_16x16x32_bf16 v[16:19], v[228:231], v[24:27], v[16:19]
 v_mfma_f32_16x16x32_bf16 v[20:23], v[232:235], v[24:27], v[20:23]
 s_waitcnt lgkmcnt(2)
 v_mfma_f32_16x16x32_bf16 v[12:15], v[236:239], v[28:31], v[12:15]
 ds_read_b128 v[24:27], v71 offset:16384
 v_mfma_f32_16x16x32_bf16 v[16:19], v[240:243], v[28:31], v[16:19]
 v_mfma_f32_16x16x32_bf16 v[20:23], v[244:247], v[28:31], v[20:23]
 s_waitcnt lgkmcnt(2)
 v_mfma_f32_16x16x32_bf16 v[12:15], v[248:251], v[32:35], v[12:15]
 ds_read_b128 v[28:31], v71 offset:17408
 v_mfma_f32_16x16x32_bf16 v[16:19], v[252:255], v[32:35], v[16:19]
 v_mfma_f32_16x16x32_bf16 v[20:23], a[0:3], v[32:35], v[20:23]
 s_waitcnt lgkmcnt(2)
 v_mfma_f32_16x16x32_bf16 v[12:15], a[4:7], v[36:39], v[12:15]
 ds_read_b128 v[32:35], v71 offset:18432
 v_mfma_f32_16x16x32_bf16 v[16:19], a[8:11], v[36:39], v[16:19]
 v_mfma_f32_16x16x32_bf16 v[20:23], a[12:15], v[36:39], v[20:23]
 s_waitcnt lgkmcnt(2)
 v_mfma_f32_16x16x32_bf16 v[12:15], a[16:19], v[24:27], v[12:15]
 ds_read_b128 v[36:39], v71 offset:19456
 v_mfma_f32_16x16x32_bf16 v[16:19], a[20:23], v[24:27], v[16:19]
 v_mfma_f32_16x16x32_bf16 v[20:23], a[24:27], v[24:27], v[20:23]
 s_waitcnt lgkmcnt(2)
 v_mfma_f32_16x16x32_bf16 v[12:15], a[28:31], v[28:31], v[12:15]
 ds_read_b128 v[24:27], v71 offset:20480
 v_mfma_f32_16x16x32_bf16 v[16:19], a[32:35], v[28:31], v[16:19]
 v_mfma_f32_16x16x32_bf16 v[20:23], a[36:39], v[28:31], v[20:23]
 s_waitcnt lgkmcnt(2)
 v_mfma_f32_16x16x32_bf16 v[12:15], a[40:43], v[32:35], v[12:15]
 ds_read_b128 v[28:31], v71 offset:21504
 v_mfma_f32_16x16x32_bf16 v[16:19], a[44:47], v[32:35], v[16:19]
 v_mfma_f32_16x16x32_bf16 v[20:23], a[48:51], v[32:35], v[20:23]
 s_waitcnt lgkmcnt(2)
 v_mfma_f32_16x16x32_bf16 v[12:15], a[52:55], v[36:39], v[12:15]
 ds_read_b128 v[32:35], v71 offset:22528
 v_mfma_f32_16x16x32_bf16 v[16:19], a[56:59], v[36:39], v[16:19]
 v_mfma_f32_16x16x32_bf16 v[20:23], a[60:63], v[36:39], v[20:23]
 s_waitcnt lgkmcnt(2)
 v_mfma_f32_16x16x32_bf16 v[12:15], a[64:67], v[24:27], v[12:15]
 ds_read_b128 v[36:39], v71 offset:23552
 v_mfma_f32_16x16x32_bf16 v[16:19], a[68:71], v[24:27], v[16:19]
 v_mfma_f32_16x16x32_bf16 v[20:23], a[72:75], v[24:27], v[20:23]
 s_waitcnt lgkmcnt(2)
 v_mfma_f32_16x16x32_bf16 v[12:15], a[76:79], v[28:31], v[12:15]
 ds_read_b128 v[24:27], v71 offset:24576
 v_mfma_f32_16x16x32_bf16 v[16:19], a[80:83], v[28:31], v[16:19]
 v_mfma_f32_16x16x32_bf16 v[20:23], a[84:87], v[28:31], v[20:23]
 s_waitcnt lgkmcnt(2)
 v_mfma_f32_16x16x32_bf16 v[12:15], a[88:91], v[32:35], v[12:15]
 ds_read_b128 v[28:31], v71 offset:25600
 v_mfma_f32_16x16x32_bf16 v[16:19], a[92:95], v[32:35], v[16:19]
 v_mfma_f32_16x16x32_bf16 v[20:23], a[96:99], v[32:35], v[20:23]
 s_waitcnt lgkmcnt(2)
 v_mfma_f32_16x16x32_bf16 v[12:15], a[100:103], v[36:39], v[12:15]
 ds_read_b128 v[32:35], v71 offset:26624
 v_mfma_f32_16x16x32_bf16 v[16:19], a[104:107], v[36:39], v[16:19]
 v_mfma_f32_16x16x32_bf16 v[20:23], a[108:111], v[36:39], v[20:23]
 s_waitcnt lgkmcnt(2)
 v_mfma_f32_16x16x32_bf16 v[12:15], a[112:115], v[24:27], v[12:15]
 ds_read_b128 v[36:39], v71 offset:27648
 v_mfma_f32_16x16x32_bf16 v[16:19], a[116:119], v[24:27], v[16:19]
 v_mfma_f32_16x16x32_bf16 v[20:23], a[120:123], v[24:27], v[20:23]
 s_waitcnt lgkmcnt(2)
 v_mfma_f32_16x16x32_bf16 v[12:15], a[124:127], v[28:31], v[12:15]
 ds_read_b128 v[24:27], v71 offset:28672
 v_mfma_f32_16x16x32_bf16 v[16:19], a[128:131], v[28:31], v[16:19]
 v_mfma_f32_16x16x32_bf16 v[20:23], a[132:135], v[28:31], v[20:23]
 s_waitcnt lgkmcnt(2)
 v_mfma_f32_16x16x32_bf16 v[12:15], a[136:139], v[32:35], v[12:15]
 ds_read_b128 v[28:31], v71 offset:29696
 v_mfma_f32_16x16x32_bf16 v[16:19], a[140:143], v[32:35], v[16:19]
 v_mfma_f32_16x16x32_bf16 v[20:23], a[144:147], v[32:35], v[20:23]
 s_waitcnt lgkmcnt(2)
 v_mfma_f32_16x16x32_bf16 v[12:15], a[148:151], v[36:39], v[12:15]
 ds_read_b128 v[32:35], v71 offset:30720
 v_mfma_f32_16x16x32_bf16 v[16:19], a[152:155], v[36:39], v[16:19]
 v_mfma_f32_16x16x32_bf16 v[20:23], a[156:159], v[36:39], v[20:23]
 s_waitcnt lgkmcnt(2)
 v_mfma_f32_16x16x32_bf16 v[12:15], a[160:163], v[24:27], v[12:15]
 ds_read_b128 v[36:39], v71 offset:31744
 v_mfma_f32_16x16x32_bf16 v[16:19], a[164:167], v[24:27], v[16:19]
 v_mfma_f32_16x16x32_bf16 v[20:23], a[168:171], v[24:27], v[20:23]
 s_waitcnt lgkmcnt(2)
 v_mfma_f32_16x16x32_bf16 v[12:15], a[172:175], v[28:31], v[12:15]
 ds_read_b128 v[24:27], v71 offset:32768
 v_mfma_f32_16x16x32_bf16 v[16:19], a[176:179], v[28:31], v[16:19]
 v_mfma_f32_16x16x32_bf16 v[20:23], a[180:183], v[28:31], v[20:23]
 s_waitcnt lgkmcnt(2)
 v_mfma_f32_16x16x32_bf16 v[12:15], a[184:187], v[32:35], v[12:15]
 ds_read_b128 v[28:31], v71 offset:33792
 v_mfma_f32_16x16x32_bf16 v[16:19], a[188:191], v[32:35], v[16:19]
 v_mfma_f32_16x16x32_bf16 v[20:23], a[192:195], v[32:35], v[20:23]
 s_waitcnt lgkmcnt(2)
 v_mfma_f32_16x16x32_bf16 v[12:15], a[196:199], v[36:39], v[12:15]
 ds_read_b128 v[32:35], v71 offset:34816
 v_mfma_f32_16x16x32_bf16 v[16:19], a[200:203], v[36:39], v[16:19]
 v_mfma_f32_16x16x32_bf16 v[20:23], a[204:207], v[36:39], v[20:23]
 s_waitcnt lgkmcnt(2)
 v_mfma_f32_16x16x32_bf16 v[12:15], a[208:211], v[24:27], v[12:15]
 ds_read_b128 v[36:39], v71 offset:35840
 v_mfma_f32_16x16x32_bf16 v[16:19], a[212:215], v[24:27], v[16:19]
 v_mfma_f32_16x16x32_bf16 v[20:23], a[216:219], v[24:27], v[20:23]
 s_waitcnt lgkmcnt(2)
 v_mfma_f32_16x16x32_bf16 v[12:15], a[220:223], v[28:31], v[12:15]
 v_mfma_f32_16x16x32_bf16 v[16:19], a[224:227], v[28:31], v[16:19]
 v_mfma_f32_16x16x32_bf16 v[20:23], a[228:231], v[28:31], v[20:23]
 s_waitcnt lgkmcnt(1)
 v_mfma_f32_16x16x32_bf16 v[12:15], a[232:235], v[32:35], v[12:15]
 v_mfma_f32_16x16x32_bf16 v[16:19], a[236:239], v[32:35], v[16:19]
 v_mfma_f32_16x16x32_bf16 v[20:23], a[240:243], v[32:35], v[20:23]
 s_waitcnt lgkmcnt(0)
 v_mfma_f32_16x16x32_bf16 v[12:15], a[244:247], v[36:39], v[12:15]
 v_mfma_f32_16x16x32_bf16 v[16:19], a[248:251], v[36:39], v[16:19]
 v_mfma_f32_16x16x32_bf16 v[20:23], a[252:255], v[36:39], v[20:23]
 s_nop 7
 v_cvt_pk_bf16_f32 v58, v20, v21
 v_cvt_pk_bf16_f32 v59, v22, v23
 v_cvt_pk_bf16_f32 v52, v12, v13
 v_cvt_pk_bf16_f32 v53, v14, v15
 v_cvt_pk_bf16_f32 v54, v16, v17
 v_cvt_pk_bf16_f32 v55, v18, v19
 buffer_store_dwordx4 v[52:55], v73, s[8:11], s77 offen offset:1024 sc1
 v_permlane32_swap_b32 v56, v58
 v_permlane32_swap_b32 v57, v59
 buffer_store_dwordx4 v[56:59], v73, s[8:11], s77 offen offset:2048 sc1
 v_mov_b32 v76, s93
 s_waitcnt vmcnt(0)
 s_barrier
 buffer_store_dword v76, v77, s[8:11], s92 offen sc1
 s_cmp_ge_u32 s61, s91
 s_cbranch_scc1 L_dn_done
 s_branch L_dn_sl
L_dn_done:
 s_waitcnt vmcnt(0) lgkmcnt(0)
 s_endpgm
L_att_b:
 s_cmp_lg_u32 s7, 0
 s_cbranch_scc1 Lln_69
 s_waitcnt vmcnt(3)
 v_lshlrev_b32 v52, 16, v40
 v_and_b32 v53, 0xffff0000, v40
 v_lshlrev_b32 v54, 16, v41
 v_and_b32 v55, 0xffff0000, v41
 v_lshlrev_b32 v56, 16, v42
 v_and_b32 v57, 0xffff0000, v42
 v_lshlrev_b32 v58, 16, v43
 v_and_b32 v59, 0xffff0000, v43
 v_lshlrev_b32 v60, 16, v44
 v_and_b32 v61, 0xffff0000, v44
 v_lshlrev_b32 v62, 16, v45
 v_and_b32 v63, 0xffff0000, v45
 v_lshlrev_b32 v64, 16, v46
 v_and_b32 v65, 0xffff0000, v46
 v_lshlrev_b32 v66, 16, v47
 v_and_b32 v67, 0xffff0000, v47
 v_lshlrev_b32 v68, 16, v48
 v_and_b32 v69, 0xffff0000, v48
 v_lshlrev_b32 v70, 16, v49
 v_and_b32 v71, 0xffff0000, v49
 v_lshlrev_b32 v72, 16, v50
 v_and_b32 v73, 0xffff0000, v50
 v_lshlrev_b32 v74, 16, v51
 v_and_b32 v75, 0xffff0000, v51
 v_pk_add_f32 v[20:21], v[52:53], v[54:55]
 v_pk_add_f32 v[20:21], v[20:21], v[56:57]
 v_pk_add_f32 v[20:21], v[20:21], v[58:59]
 v_pk_add_f32 v[20:21], v[20:21], v[60:61]
 v_pk_add_f32 v[20:21], v[20:21], v[62:63]
 v_pk_add_f32 v[20:21], v[20:21], v[64:65]
 v_pk_add_f32 v[20:21], v[20:21], v[66:67]
 v_pk_add_f32 v[20:21], v[20:21], v[68:69]
 v_pk_add_f32 v[20:21], v[20:21], v[70:71]
 v_pk_add_f32 v[20:21], v[20:21], v[72:73]
 v_pk_add_f32 v[20:21], v[20:21], v[74:75]
 v_add_f32 v20, v20, v21
 s_nop 1
 v_add_f32_dpp v20, v20, v20 quad_perm:[1,0,3,2] row_mask:0xf bank_mask:0xf
 s_nop 1
 v_add_f32_dpp v20, v20, v20 quad_perm:[2,3,0,1] row_mask:0xf bank_mask:0xf
 s_nop 1
 v_add_f32_dpp v20, v20, v20 row_half_mirror row_mask:0xf bank_mask:0xf
 s_nop 1
 v_add_f32_dpp v20, v20, v20 row_mirror row_mask:0xf bank_mask:0xf
 v_mov_b32 v21, v20
 s_nop 1
 v_permlane16_swap_b32 v20, v21
 v_add_f32 v20, v20, v21
 v_mul_f32 v20, v78, v20
 v_pk_add_f32 v[52:53], v[52:53], v[20:21] op_sel_hi:[1,0]
 v_pk_add_f32 v[54:55], v[54:55], v[20:21] op_sel_hi:[1,0]
 v_pk_add_f32 v[56:57], v[56:57], v[20:21] op_sel_hi:[1,0]
 v_pk_add_f32 v[58:59], v[58:59], v[20:21] op_sel_hi:[1,0]
 v_pk_add_f32 v[60:61], v[60:61], v[20:21] op_sel_hi:[1,0]
 v_pk_add_f32 v[62:63], v[62:63], v[20:21] op_sel_hi:[1,0]
 v_pk_add_f32 v[64:65], v[64:65], v[20:21] op_sel_hi:[1,0]
 v_pk_add_f32 v[66:67], v[66:67], v[20:21] op_sel_hi:[1,0]
 v_pk_add_f32 v[68:69], v[68:69], v[20:21] op_sel_hi:[1,0]
 v_pk_add_f32 v[70:71], v[70:71], v[20:21] op_sel_hi:[1,0]
 v_pk_add_f32 v[72:73], v[72:73], v[20:21] op_sel_hi:[1,0]
 v_pk_add_f32 v[74:75], v[74:75], v[20:21] op_sel_hi:[1,0]
 v_pk_mul_f32 v[22:23], v[52:53], v[52:53]
 v_pk_fma_f32 v[22:23], v[54:55], v[54:55], v[22:23]
 v_pk_fma_f32 v[22:23], v[56:57], v[56:57], v[22:23]
 v_pk_fma_f32 v[22:23], v[58:59], v[58:59], v[22:23]
 v_pk_fma_f32 v[22:23], v[60:61], v[60:61], v[22:23]
 v_pk_fma_f32 v[22:23], v[62:63], v[62:63], v[22:23]
 v_pk_fma_f32 v[22:23], v[64:65], v[64:65], v[22:23]
 v_pk_fma_f32 v[22:23], v[66:67], v[66:67], v[22:23]
 v_pk_fma_f32 v[22:23], v[68:69], v[68:69], v[22:23]
 v_pk_fma_f32 v[22:23], v[70:71], v[70:71], v[22:23]
 v_pk_fma_f32 v[22:23], v[72:73], v[72:73], v[22:23]
 v_pk_fma_f32 v[22:23], v[74:75], v[74:75], v[22:23]
 v_add_f32 v22, v22, v23
 s_nop 1
 v_add_f32_dpp v22, v22, v22 quad_perm:[1,0,3,2] row_mask:0xf bank_mask:0xf
 s_nop 1
 v_add_f32_dpp v22, v22, v22 quad_perm:[2,3,0,1] row_mask:0xf bank_mask:0xf
 s_nop 1
 v_add_f32_dpp v22, v22, v22 row_half_mirror row_mask:0xf bank_mask:0xf
 s_nop 1
 v_add_f32_dpp v22, v22, v22 row_mirror row_mask:0xf bank_mask:0xf
 v_mov_b32 v23, v22
 s_nop 1
 v_permlane16_swap_b32 v22, v23
 v_add_f32 v22, v22, v23
 v_mov_b32 v23, 0x3727c5ac
 v_fmac_f32 v23, 0x3ae38e39, v22
 v_rsq_f32 v22, v23
 v_sub_f32 v20, 0, v20
 v_mul_f32 v21, v23, v22
 v_lshrrev_b32 v76, 2, v0
 v_and_b32 v78, 31, v0
 v_cmp_eq_u32 vcc, 0, v78
 v_mov_b32 v78, 2147483632
 s_lshl_b32 s63, s2, 6
 v_cndmask_b32 v76, v78, v76, vcc
 s_add_u32 s63, s63, 12582912
 buffer_store_dwordx2 v[20:21], v76, s[8:11], s63 offen sc1
 s_add_u32 s63, s3, 3145728
 v_pk_mul_f32 v[52:53], v[52:53], v[22:23] op_sel_hi:[1,0]
 v_pk_mul_f32 v[54:55], v[54:55], v[22:23] op_sel_hi:[1,0]
 v_pk_mul_f32 v[56:57], v[56:57], v[22:23] op_sel_hi:[1,0]
 v_pk_mul_f32 v[58:59], v[58:59], v[22:23] op_sel_hi:[1,0]
 v_pk_mul_f32 v[60:61], v[60:61], v[22:23] op_sel_hi:[1,0]
 v_pk_mul_f32 v[62:63], v[62:63], v[22:23] op_sel_hi:[1,0]
 v_pk_mul_f32 v[64:65], v[64:65], v[22:23] op_sel_hi:[1,0]
 v_pk_mul_f32 v[66:67], v[66:67], v[22:23] op_sel_hi:[1,0]
 v_pk_mul_f32 v[68:69], v[68:69], v[22:23] op_sel_hi:[1,0]
 v_pk_mul_f32 v[70:71], v[70:71], v[22:23] op_sel_hi:[1,0]
 v_pk_mul_f32 v[72:73], v[72:73], v[22:23] op_sel_hi:[1,0]
 v_pk_mul_f32 v[74:75], v[74:75], v[22:23] op_sel_hi:[1,0]
 v_cvt_pk_bf16_f32 v40, v52, v53
 v_cvt_pk_bf16_f32 v41, v54, v55
 v_cvt_pk_bf16_f32 v42, v56, v57
 v_cvt_pk_bf16_f32 v43, v58, v59
 v_cvt_pk_bf16_f32 v44, v60, v61
 v_cvt_pk_bf16_f32 v45, v62, v63
 v_cvt_pk_bf16_f32 v46, v64, v65
 v_cvt_pk_bf16_f32 v47, v66, v67
 v_cvt_pk_bf16_f32 v48, v68, v69
 v_cvt_pk_bf16_f32 v49, v70, v71
 v_cvt_pk_bf16_f32 v50, v72, v73
 v_cvt_pk_bf16_f32 v51, v74, v75
 buffer_store_dwordx4 v[40:43], v77, s[8:11], s63 offen offset:0 sc1
 buffer_store_dwordx4 v[44:47], v77, s[8:11], s63 offen offset:384 sc1
 buffer_store_dwordx4 v[48:51], v77, s[8:11], s63 offen offset:768 sc1
Lln_69:
 s_waitcnt vmcnt(0)
 s_cmp_lg_u32 s7, 0
 s_cbranch_scc1 Lar_70
 s_or_b32 s63, s6, 0x80
 v_mov_b32 v20, s63
 s_barrier
 buffer_store_byte v20, v79, s[20:23], 0 offen sc1
Lar_70:
 s_cmp_eq_u32 s7, 1
 s_cbranch_scc1 Lvalok_73
 v_mbcnt_lo_u32_b32 v1, -1, 0
 v_mbcnt_hi_u32_b32 v1, -1, v1
 v_lshlrev_b32 v1, 2, v1
 s_mov_b32 s62, 0
 s_mov_b32 s63, 0x80808080
 s_cmp_lg_u32 s58, 0
 s_cbranch_scc1 Lvald_72
Lval_71:
 buffer_load_dword v2, v1, s[20:23], 0 offen sc1
 s_waitcnt vmcnt(0)
 v_and_b32 v3, s63, v2
 v_cmp_ne_u32 vcc, s63, v3
 s_cbranch_vccz Lvald_72
 s_add_u32 s62, s62, 1
 s_cmp_lt_u32 s62, 400000
 s_cbranch_scc1 Lval_71
Lvald_72:
 s_barrier
 buffer_load_dword v2, v1, s[20:23], 0 offen sc1
 s_waitcnt vmcnt(0)
 v_and_b32 v3, s63, v2
 v_cmp_ne_u32 vcc, s63, v3
 s_mov_b32 s63, 1
 s_cbranch_vccnz L_abort_b
 v_lshlrev_b32 v3, v2, 1
 v_lshrrev_b32 v4, 8, v2
 v_lshl_or_b32 v3, 1, v4, v3
 v_lshrrev_b32 v4, 16, v2
 v_lshl_or_b32 v3, 1, v4, v3
 v_lshrrev_b32 v4, 24, v2
 v_lshl_or_b32 v3, 1, v4, v3
 s_nop 1
 v_or_b32_dpp v3, v3, v3 quad_perm:[1,0,3,2] row_mask:0xf bank_mask:0xf
 v_cmp_ne_u32 vcc, 255, v3
 s_cbranch_vccnz L_rerank_b
 s_mov_b32 s7, 1
Lvalok_73:
 s_sub_u32 s70, s57, 24
 s_lshl_b32 s70, s70, 2
 s_add_u32 s70, s70, s58
 s_lshl_b32 s71, s60, 5
 s_add_u32 s71, s71, s70
 s_lshl_b32 s71, s71, 7
 s_sub_u32 s63, s57, 24
 s_lshl_b32 s63, s63, 7
 s_lshl_b32 s64, s60, 12
 s_add_u32 s63, s63, s64
 s_lshl_b32 s64, s58, 2
 s_add_u32 s63, s63, s64
 s_add_u32 s63, s63, 28672
 s_mov_b32 s78, s63
 v_mbcnt_lo_u32_b32 v1, -1, 0
 v_mbcnt_hi_u32_b32 v1, -1, v1
 v_cmp_eq_u32 vcc, 0, v1
 v_mov_b32 v2, s63
 v_mov_b32 v9, 2147483632
 v_cndmask_b32 v9, v9, v2, vcc
 v_lshlrev_b32 v4, 4, v1
 v_and_b32 v2, 15, v1
 v_lshrrev_b32 v3, 4, v1
 v_lshrrev_b32 v11, 2, v2
 v_and_b32 v12, 1, v2
 v_lshl_add_u32 v11, v11, 1, v12
 v_lshlrev_b32 v11, 4, v11
 v_lshl_add_u32 v5, v3, 7, v11
 v_lshlrev_b32 v6, 3, v1
 v_and_b32 v11, 1, v1
 v_lshlrev_b32 v11, 2, v11
 s_add_u32 s63, s71, 12288
 v_add_u32 v11, s63, v11
 s_add_u32 s63, s71, 20480
 v_mov_b32 v12, s63
 v_cmp_gt_u32 vcc, 8, v1
 s_nop 1
 v_cndmask_b32 v7, v12, v11, vcc
 v_lshlrev_b32 v3, 2, v3
 v_sub_u32 v2, v2, v3
 v_mov_b32 v12, 0xf149f2ca
 s_mul_i32 s72, s60, 2048
 s_add_u32 s72, s72, s70
 s_mul_i32 s73, s72, 4096
 s_add_u32 s73, s73, 121634816
 s_mul_i32 s72, s72, 24576
 s_add_u32 s72, s72, 20971520
 s_mul_i32 s74, s60, 16777216
 s_lshr_b32 s63, s70, 3
 s_lshl_b32 s63, s63, 16
 s_add_u32 s74, s74, s63
 s_and_b32 s63, s70, 7
 s_lshl_b32 s63, s63, 12
 s_add_u32 s74, s74, s63
 s_add_u32 s74, s74, 138412032
 s_mov_b32 s75, 0x3e0293ee
 v_cmp_le_i32 vcc, 0, v2
 s_nop 1
 v_cndmask_b32 v16, v12, 0, vcc
 v_cmp_le_i32 vcc, 1, v2
 s_nop 1
 v_cndmask_b32 v17, v12, 0, vcc
 v_cmp_le_i32 vcc, 2, v2
 s_nop 1
 v_cndmask_b32 v18, v12, 0, vcc
 v_cmp_le_i32 vcc, 3, v2
 s_nop 1
 v_cndmask_b32 v19, v12, 0, vcc
 v_mov_b32 v42, 0
 v_mov_b32 v43, 0
 v_mov_b32 v49, 0
 v_mov_b32 v50, 0
 v_mov_b32 v53, 0
 v_mov_b32 v54, 0
 s_mov_b32 s79, 0
 v_accvgpr_write_b32 a96, 0
 v_accvgpr_write_b32 a97, 0
 v_accvgpr_write_b32 a98, 0
 v_accvgpr_write_b32 a99, 0
 v_accvgpr_write_b32 a100, 0
 v_accvgpr_write_b32 a101, 0
 v_accvgpr_write_b32 a102, 0
 v_accvgpr_write_b32 a103, 0
 v_accvgpr_write_b32 a104, 0
 v_accvgpr_write_b32 a105, 0
 v_accvgpr_write_b32 a106, 0
 v_accvgpr_write_b32 a107, 0
 v_accvgpr_write_b32 a108, 0
 v_accvgpr_write_b32 a109, 0
 v_accvgpr_write_b32 a110, 0
 v_accvgpr_write_b32 a111, 0
 v_accvgpr_write_b32 a224, 0
 v_accvgpr_write_b32 a225, 0
 v_accvgpr_write_b32 a226, 0
 v_accvgpr_write_b32 a227, 0
 v_accvgpr_write_b32 a228, 0
 v_accvgpr_write_b32 a229, 0
 v_accvgpr_write_b32 a230, 0
 v_accvgpr_write_b32 a231, 0
 v_accvgpr_write_b32 a232, 0
 v_accvgpr_write_b32 a233, 0
 v_accvgpr_write_b32 a234, 0
 v_accvgpr_write_b32 a235, 0
 v_accvgpr_write_b32 a236, 0
 v_accvgpr_write_b32 a237, 0
 v_accvgpr_write_b32 a238, 0
 v_accvgpr_write_b32 a239, 0
 s_cmp_eq_u32 s60, 0
 s_cselect_b32 s80, 1000, 45
 s_cbranch_scc0 La_74
 s_add_u32 s81, s78, 4112
 s_mov_b32 s82, 46
 s_atomic_umax s82, s[8:9], s81
La_74:
 s_mov_b32 s61, 0
 s_mov_b32 s66, 0
 s_branch L_a_wait0
L_a_wait0:
 s_mov_b32 s62, 0
L_a_spin0:
 buffer_load_dword v8, v7, s[8:11], 0 offen sc1
 s_waitcnt vmcnt(0)
L_a_chk0:
 v_cmp_ge_u32 vcc, s61, v8
 s_bitcmp1_b32 s66, 1
 s_cbranch_scc1 La_75
 s_cmp_lg_u32 vcc_hi, 0
 s_cbranch_scc1 La_75
 s_mul_i32 s68, s61, 131072
 s_add_u32 s68, s68, s73
 buffer_load_dwordx4 a[96:99], v5, s[8:11], s68 offen offset:0 sc1
 buffer_load_dwordx4 a[100:103], v5, s[8:11], s68 offen offset:512 sc1
 buffer_load_dwordx4 a[104:107], v5, s[8:11], s68 offen offset:1024 sc1
 buffer_load_dwordx4 a[108:111], v5, s[8:11], s68 offen offset:1536 sc1
 buffer_load_dwordx2 a[112:113], v6, s[8:11], s68 offen offset:2048 sc1
 buffer_load_dwordx2 a[114:115], v6, s[8:11], s68 offen offset:2560 sc1
 buffer_load_dwordx2 a[116:117], v6, s[8:11], s68 offen offset:3072 sc1
 buffer_load_dwordx2 a[118:119], v6, s[8:11], s68 offen offset:3584 sc1
 s_or_b32 s66, s66, 2
La_75:
 s_bitcmp1_b32 s66, 0
 s_cbranch_scc1 La_76
 s_and_b32 s63, vcc_lo, 0xff
 s_cbranch_scc1 La_76
 s_mov_b32 s64, s61
 s_mul_i32 s67, s64, 786432
 s_add_u32 s67, s67, s72
 buffer_load_dwordx4 a[0:3], v4, s[8:11], s67 offen offset:0 sc1
 buffer_load_dwordx4 a[4:7], v4, s[8:11], s67 offen offset:1024 sc1
 buffer_load_dwordx4 a[8:11], v4, s[8:11], s67 offen offset:2048 sc1
 buffer_load_dwordx4 a[12:15], v4, s[8:11], s67 offen offset:3072 sc1
 s_add_u32 s67, s67, 4096
 buffer_load_dwordx4 a[16:19], v4, s[8:11], s67 offen offset:0 sc1
 buffer_load_dwordx4 a[20:23], v4, s[8:11], s67 offen offset:1024 sc1
 buffer_load_dwordx4 a[24:27], v4, s[8:11], s67 offen offset:2048 sc1
 buffer_load_dwordx4 a[28:31], v4, s[8:11], s67 offen offset:3072 sc1
 s_add_u32 s67, s67, 4096
 buffer_load_dwordx4 a[32:35], v4, s[8:11], s67 offen offset:0 sc1
 buffer_load_dwordx4 a[36:39], v4, s[8:11], s67 offen offset:1024 sc1
 buffer_load_dwordx4 a[40:43], v4, s[8:11], s67 offen offset:2048 sc1
 buffer_load_dwordx4 a[44:47], v4, s[8:11], s67 offen offset:3072 sc1
 s_add_u32 s67, s67, 4096
 buffer_load_dwordx4 a[48:51], v4, s[8:11], s67 offen offset:0 sc1
 buffer_load_dwordx4 a[52:55], v4, s[8:11], s67 offen offset:1024 sc1
 buffer_load_dwordx4 a[56:59], v4, s[8:11], s67 offen offset:2048 sc1
 buffer_load_dwordx4 a[60:63], v4, s[8:11], s67 offen offset:3072 sc1
 s_add_u32 s67, s67, 4096
 buffer_load_dwordx4 a[64:67], v4, s[8:11], s67 offen offset:0 sc1
 buffer_load_dwordx4 a[68:71], v4, s[8:11], s67 offen offset:1024 sc1
 buffer_load_dwordx4 a[72:75], v4, s[8:11], s67 offen offset:2048 sc1
 buffer_load_dwordx4 a[76:79], v4, s[8:11], s67 offen offset:3072 sc1
 s_add_u32 s67, s67, 4096
 buffer_load_dwordx4 a[80:83], v4, s[8:11], s67 offen offset:0 sc1
 buffer_load_dwordx4 a[84:87], v4, s[8:11], s67 offen offset:1024 sc1
 buffer_load_dwordx4 a[88:91], v4, s[8:11], s67 offen offset:2048 sc1
 buffer_load_dwordx4 a[92:95], v4, s[8:11], s67 offen offset:3072 sc1
 s_or_b32 s66, s66, 1
La_76:
 s_cmp_eq_u32 s66, 3
 s_cbranch_scc1 L_a_top0
 s_add_u32 s62, s62, 1
 s_cmp_lt_u32 s62, 400000
 s_cbranch_scc1 L_a_spin0
 s_mov_b32 s63, 30
 s_branch L_abort_b
L_a_topf0:
 s_waitcnt vmcnt(8)
 s_cmp_eq_u32 s79, s61
 s_cbranch_scc1 Lfa_77
 s_waitcnt lgkmcnt(0)
 s_mov_b32 s79, s61
 s_atomic_umax s79, s[8:9], s78
Lfa_77:
 s_waitcnt vmcnt(0)
 s_branch L_a_top20
L_a_top0:
 s_waitcnt vmcnt(0)
L_a_top20:
 s_cmp_ge_u32 s61, s80
 s_addc_u32 s64, s61, 1
 v_cmp_ge_u32 vcc, s64, v8
 s_and_b32 s63, vcc_lo, 0xff
 s_cbranch_scc0 L_a_w0
 s_mov_b32 s66, 0
 v_mfma_f32_16x16x32_bf16 v[20:23], a[32:35], a[0:3], v[16:19]
 v_mfma_f32_16x16x32_bf16 v[24:27], a[96:99], a[0:3], 0
 v_mfma_f32_16x16x32_bf16 v[28:31], a[32:35], a[4:7], 0
 v_mfma_f32_16x16x32_bf16 v[32:35], a[36:39], a[4:7], v[16:19]
 v_mfma_f32_16x16x32_bf16 v[36:39], a[96:99], a[4:7], 0
 v_mfma_f32_16x16x32_bf16 v[20:23], a[40:43], a[8:11], v[20:23]
 v_mfma_f32_16x16x32_bf16 v[24:27], a[100:103], a[8:11], v[24:27]
 v_mfma_f32_16x16x32_bf16 v[28:31], a[40:43], a[12:15], v[28:31]
 v_mfma_f32_16x16x32_bf16 v[32:35], a[44:47], a[12:15], v[32:35]
 v_mfma_f32_16x16x32_bf16 v[36:39], a[100:103], a[12:15], v[36:39]
 v_mfma_f32_16x16x32_bf16 v[20:23], a[48:51], a[16:19], v[20:23]
 v_mfma_f32_16x16x32_bf16 v[24:27], a[104:107], a[16:19], v[24:27]
 v_mfma_f32_16x16x32_bf16 v[28:31], a[48:51], a[20:23], v[28:31]
 v_mfma_f32_16x16x32_bf16 v[32:35], a[52:55], a[20:23], v[32:35]
 v_mfma_f32_16x16x32_bf16 v[36:39], a[104:107], a[20:23], v[36:39]
 v_mfma_f32_16x16x32_bf16 v[20:23], a[56:59], a[24:27], v[20:23]
 v_mfma_f32_16x16x32_bf16 v[24:27], a[108:111], a[24:27], v[24:27]
 v_mfma_f32_16x16x32_bf16 v[28:31], a[56:59], a[28:31], v[28:31]
 v_mfma_f32_16x16x32_bf16 v[32:35], a[60:63], a[28:31], v[32:35]
 v_mfma_f32_16x16x32_bf16 v[36:39], a[108:111], a[28:31], v[36:39]
 s_nop 4
 v_max3_f32 v160, v20, v21, v22
 v_max3_f32 v160, v160, v23, v24
 v_max_f32 v160, v160, v25
 v_max_f32 v161, v28, v29
 v_max3_f32 v161, v161, v30, v31
 v_max3_f32 v161, v161, v32, v33
 v_max3_f32 v161, v161, v34, v35
 v_max3_f32 v161, v161, v36, v37
 v_mov_b32 v162, v160
 v_mov_b32 v163, v161
 s_nop 0
 v_permlane16_swap_b32 v160, v162
 v_permlane16_swap_b32 v161, v163
 v_max_f32 v160, v160, v162
 v_max_f32 v161, v161, v163
 v_mov_b32 v162, v160
 v_mov_b32 v163, v161
 s_nop 0
 v_permlane32_swap_b32 v160, v162
 v_permlane32_swap_b32 v161, v163
 v_max_f32 v160, v160, v162
 v_max_f32 v161, v161, v163
 v_mul_f32 v160, s75, v160
 v_mul_f32 v161, s75, v161
 v_fma_f32 v20, v20, s75, -v160
 v_fma_f32 v21, v21, s75, -v160
 v_fma_f32 v22, v22, s75, -v160
 v_fma_f32 v23, v23, s75, -v160
 v_fma_f32 v24, v24, s75, -v160
 v_fma_f32 v25, v25, s75, -v160
 v_fma_f32 v28, v28, s75, -v161
 v_fma_f32 v29, v29, s75, -v161
 v_fma_f32 v30, v30, s75, -v161
 v_fma_f32 v31, v31, s75, -v161
 v_fma_f32 v32, v32, s75, -v161
 v_fma_f32 v33, v33, s75, -v161
 v_fma_f32 v34, v34, s75, -v161
 v_fma_f32 v35, v35, s75, -v161
 v_fma_f32 v36, v36, s75, -v161
 v_fma_f32 v37, v37, s75, -v161
 v_exp_f32 v20, v20
 v_exp_f32 v21, v21
 v_exp_f32 v22, v22
 v_exp_f32 v23, v23
 v_exp_f32 v24, v24
 v_exp_f32 v25, v25
 v_exp_f32 v28, v28
 v_exp_f32 v29, v29
 v_exp_f32 v30, v30
 v_exp_f32 v31, v31
 v_exp_f32 v32, v32
 v_exp_f32 v33, v33
 v_exp_f32 v34, v34
 v_exp_f32 v35, v35
 v_exp_f32 v36, v36
 v_exp_f32 v37, v37
 v_add_f32 v160, v20, v21
 v_add_f32 v160, v160, v22
 v_add_f32 v160, v160, v23
 v_add_f32 v160, v160, v24
 v_add_f32 v160, v160, v25
 v_add_f32 v161, v28, v29
 v_add_f32 v161, v161, v30
 s_waitcnt vmcnt(0)
 s_cmp_eq_u32 s79, s61
 s_cbranch_scc1 Lfa_78
 s_waitcnt lgkmcnt(0)
 s_mov_b32 s79, s61
 s_atomic_umax s79, s[8:9], s78
Lfa_78:
 v_add_f32 v161, v161, v31
 v_add_f32 v161, v161, v32
 v_add_f32 v161, v161, v33
 v_add_f32 v161, v161, v34
 v_add_f32 v161, v161, v35
 v_add_f32 v161, v161, v36
 v_add_f32 v161, v161, v37
 v_mov_b32 v162, v160
 v_mov_b32 v163, v161
 s_nop 0
 v_permlane16_swap_b32 v160, v162
 v_permlane16_swap_b32 v161, v163
 v_add_f32 v160, v160, v162
 v_add_f32 v161, v161, v163
 v_mov_b32 v162, v160
 v_mov_b32 v163, v161
 s_nop 0
 v_permlane32_swap_b32 v160, v162
 v_permlane32_swap_b32 v161, v163
 v_add_f32 v160, v160, v162
 v_add_f32 v161, v161, v163
 v_rcp_f32 v160, v160
 v_rcp_f32 v161, v161
 v_mul_f32 v20, v20, v160
 v_mul_f32 v21, v21, v160
 v_mul_f32 v22, v22, v160
 v_mul_f32 v23, v23, v160
 v_mul_f32 v24, v24, v160
 v_mul_f32 v25, v25, v160
 v_mul_f32 v28, v28, v161
 v_mul_f32 v29, v29, v161
 v_mul_f32 v30, v30, v161
 v_mul_f32 v31, v31, v161
 v_mul_f32 v32, v32, v161
 v_mul_f32 v33, v33, v161
 v_mul_f32 v34, v34, v161
 v_mul_f32 v35, v35, v161
 v_mul_f32 v36, v36, v161
 v_mul_f32 v37, v37, v161
 v_cvt_pk_bf16_f32 v40, v20, v21
 v_cvt_pk_bf16_f32 v41, v22, v23
 v_cvt_pk_bf16_f32 v44, v28, v29
 v_cvt_pk_bf16_f32 v45, v30, v31
 v_cvt_pk_bf16_f32 v46, v32, v33
 v_cvt_pk_bf16_f32 v47, v34, v35
 v_cvt_pk_bf16_f32 v48, v24, v25
 v_cvt_pk_bf16_f32 v51, v24, v25
 v_cvt_pk_bf16_f32 v52, v36, v37
 v_cvt_pk_bf16_f32 v55, v36, v37
 v_mfma_f32_16x16x32_bf16 v[64:67], a[64:67], v[40:43], 0
 v_mfma_f32_16x16x32_bf16 v[68:71], a[68:71], v[40:43], 0
 v_mfma_f32_16x16x32_bf16 v[72:75], a[72:75], v[40:43], 0
 v_mfma_f32_16x16x32_bf16 v[76:79], a[76:79], v[40:43], 0
 v_mfma_f32_16x16x32_bf16 v[80:83], a[80:83], v[40:43], 0
 v_mfma_f32_16x16x32_bf16 v[84:87], a[84:87], v[40:43], 0
 v_mfma_f32_16x16x32_bf16 v[88:91], a[88:91], v[40:43], 0
 v_mfma_f32_16x16x32_bf16 v[92:95], a[92:95], v[40:43], 0
 v_mfma_f32_16x16x32_bf16 v[96:99], a[64:67], v[44:47], 0
 v_mfma_f32_16x16x32_bf16 v[100:103], a[68:71], v[44:47], 0
 v_mfma_f32_16x16x32_bf16 v[104:107], a[72:75], v[44:47], 0
 v_mfma_f32_16x16x32_bf16 v[108:111], a[76:79], v[44:47], 0
 v_mfma_f32_16x16x32_bf16 v[112:115], a[80:83], v[44:47], 0
 v_mfma_f32_16x16x32_bf16 v[116:119], a[84:87], v[44:47], 0
 v_mfma_f32_16x16x32_bf16 v[120:123], a[88:91], v[44:47], 0
 v_mfma_f32_16x16x32_bf16 v[124:127], a[92:95], v[44:47], 0
 v_mfma_f32_16x16x16_bf16 v[64:67], a[112:113], v[48:49], v[64:67]
 v_mfma_f32_16x16x16_bf16 v[68:71], a[112:113], v[50:51], v[68:71]
 v_mfma_f32_16x16x16_bf16 v[72:75], a[114:115], v[48:49], v[72:75]
 v_mfma_f32_16x16x16_bf16 v[76:79], a[114:115], v[50:51], v[76:79]
 v_mfma_f32_16x16x16_bf16 v[80:83], a[116:117], v[48:49], v[80:83]
 v_mfma_f32_16x16x16_bf16 v[84:87], a[116:117], v[50:51], v[84:87]
 v_mfma_f32_16x16x16_bf16 v[88:91], a[118:119], v[48:49], v[88:91]
 v_mfma_f32_16x16x16_bf16 v[92:95], a[118:119], v[50:51], v[92:95]
 v_mfma_f32_16x16x16_bf16 v[96:99], a[112:113], v[52:53], v[96:99]
 v_mfma_f32_16x16x16_bf16 v[100:103], a[112:113], v[54:55], v[100:103]
 v_mfma_f32_16x16x16_bf16 v[104:107], a[114:115], v[52:53], v[104:107]
 v_mfma_f32_16x16x16_bf16 v[108:111], a[114:115], v[54:55], v[108:111]
 v_mfma_f32_16x16x16_bf16 v[112:115], a[116:117], v[52:53], v[112:115]
 v_mfma_f32_16x16x16_bf16 v[116:119], a[116:117], v[54:55], v[116:119]
 v_mfma_f32_16x16x16_bf16 v[120:123], a[118:119], v[52:53], v[120:123]
 v_mfma_f32_16x16x16_bf16 v[124:127], a[118:119], v[54:55], v[124:127]
 s_branch L_a_e0
L_a_w0:
 s_cmp_eq_u32 vcc_hi, 0
 s_cbranch_scc1 L_a_ww0
 s_mov_b32 s66, 1
 v_mfma_f32_16x16x32_bf16 v[20:23], a[32:35], a[0:3], v[16:19]
 v_mfma_f32_16x16x32_bf16 v[24:27], a[96:99], a[0:3], 0
 v_mfma_f32_16x16x32_bf16 v[28:31], a[32:35], a[4:7], 0
 v_mfma_f32_16x16x32_bf16 v[32:35], a[36:39], a[4:7], v[16:19]
 s_mul_i32 s67, s64, 786432
 s_add_u32 s67, s67, s72
 buffer_load_dwordx4 a[128:131], v4, s[8:11], s67 offen offset:0 sc1
 v_mfma_f32_16x16x32_bf16 v[36:39], a[96:99], a[4:7], 0
 v_mfma_f32_16x16x32_bf16 v[20:23], a[40:43], a[8:11], v[20:23]
 v_mfma_f32_16x16x32_bf16 v[24:27], a[100:103], a[8:11], v[24:27]
 v_mfma_f32_16x16x32_bf16 v[28:31], a[40:43], a[12:15], v[28:31]
 buffer_load_dwordx4 a[132:135], v4, s[8:11], s67 offen offset:1024 sc1
 v_mfma_f32_16x16x32_bf16 v[32:35], a[44:47], a[12:15], v[32:35]
 v_mfma_f32_16x16x32_bf16 v[36:39], a[100:103], a[12:15], v[36:39]
 v_mfma_f32_16x16x32_bf16 v[20:23], a[48:51], a[16:19], v[20:23]
 v_mfma_f32_16x16x32_bf16 v[24:27], a[104:107], a[16:19], v[24:27]
 buffer_load_dwordx4 a[136:139], v4, s[8:11], s67 offen offset:2048 sc1
 v_mfma_f32_16x16x32_bf16 v[28:31], a[48:51], a[20:23], v[28:31]
 v_mfma_f32_16x16x32_bf16 v[32:35], a[52:55], a[20:23], v[32:35]
 v_mfma_f32_16x16x32_bf16 v[36:39], a[104:107], a[20:23], v[36:39]
 v_mfma_f32_16x16x32_bf16 v[20:23], a[56:59], a[24:27], v[20:23]
 buffer_load_dwordx4 a[140:143], v4, s[8:11], s67 offen offset:3072 sc1
 v_mfma_f32_16x16x32_bf16 v[24:27], a[108:111], a[24:27], v[24:27]
 v_mfma_f32_16x16x32_bf16 v[28:31], a[56:59], a[28:31], v[28:31]
 v_mfma_f32_16x16x32_bf16 v[32:35], a[60:63], a[28:31], v[32:35]
 v_mfma_f32_16x16x32_bf16 v[36:39], a[108:111], a[28:31], v[36:39]
 s_add_u32 s67, s67, 4096
 buffer_load_dwordx4 a[144:147], v4, s[8:11], s67 offen offset:0 sc1
 s_nop 4
 v_max3_f32 v160, v20, v21, v22
 v_max3_f32 v160, v160, v23, v24
 v_max_f32 v160, v160, v25
 v_max_f32 v161, v28, v29
 v_max3_f32 v161, v161, v30, v31
 v_max3_f32 v161, v161, v32, v33
 v_max3_f32 v161, v161, v34, v35
 v_max3_f32 v161, v161, v36, v37
 v_mov_b32 v162, v160
 buffer_load_dwordx4 a[148:151], v4, s[8:11], s67 offen offset:1024 sc1
 v_mov_b32 v163, v161
 s_nop 0
 v_permlane16_swap_b32 v160, v162
 v_permlane16_swap_b32 v161, v163
 v_max_f32 v160, v160, v162
 v_max_f32 v161, v161, v163
 v_mov_b32 v162, v160
 v_mov_b32 v163, v161
 s_nop 0
 v_permlane32_swap_b32 v160, v162
 buffer_load_dwordx4 a[152:155], v4, s[8:11], s67 offen offset:2048 sc1
 v_permlane32_swap_b32 v161, v163
 v_max_f32 v160, v160, v162
 v_max_f32 v161, v161, v163
 v_mul_f32 v160, s75, v160
 v_mul_f32 v161, s75, v161
 v_fma_f32 v20, v20, s75, -v160
 v_fma_f32 v21, v21, s75, -v160
 v_fma_f32 v22, v22, s75, -v160
 v_fma_f32 v23, v23, s75, -v160
 v_fma_f32 v24, v24, s75, -v160
 buffer_load_dwordx4 a[156:159], v4, s[8:11], s67 offen offset:3072 sc1
 v_fma_f32 v25, v25, s75, -v160
 v_fma_f32 v28, v28, s75, -v161
 v_fma_f32 v29, v29, s75, -v161
 v_fma_f32 v30, v30, s75, -v161
 v_fma_f32 v31, v31, s75, -v161
 v_fma_f32 v32, v32, s75, -v161
 v_fma_f32 v33, v33, s75, -v161
 v_fma_f32 v34, v34, s75, -v161
 v_fma_f32 v35, v35, s75, -v161
 v_fma_f32 v36, v36, s75, -v161
 s_add_u32 s67, s67, 4096
 buffer_load_dwordx4 a[160:163], v4, s[8:11], s67 offen offset:0 sc1
 v_fma_f32 v37, v37, s75, -v161
 v_exp_f32 v20, v20
 v_exp_f32 v21, v21
 v_exp_f32 v22, v22
 v_exp_f32 v23, v23
 v_exp_f32 v24, v24
 v_exp_f32 v25, v25
 v_exp_f32 v28, v28
 v_exp_f32 v29, v29
 v_exp_f32 v30, v30
 buffer_load_dwordx4 a[164:167], v4, s[8:11], s67 offen offset:1024 sc1
 v_exp_f32 v31, v31
 v_exp_f32 v32, v32
 v_exp_f32 v33, v33
 v_exp_f32 v34, v34
 v_exp_f32 v35, v35
 v_exp_f32 v36, v36
 v_exp_f32 v37, v37
 v_add_f32 v160, v20, v21
 v_add_f32 v160, v160, v22
 v_add_f32 v160, v160, v23
 buffer_load_dwordx4 a[168:171], v4, s[8:11], s67 offen offset:2048 sc1
 v_add_f32 v160, v160, v24
 v_add_f32 v160, v160, v25
 v_add_f32 v161, v28, v29
 v_add_f32 v161, v161, v30
 s_waitcnt vmcnt(11)
 s_cmp_eq_u32 s79, s61
 s_cbranch_scc1 Lfa_79
 s_waitcnt lgkmcnt(0)
 s_mov_b32 s79, s61
 s_atomic_umax s79, s[8:9], s78
Lfa_79:
 v_add_f32 v161, v161, v31
 v_add_f32 v161, v161, v32
 v_add_f32 v161, v161, v33
 v_add_f32 v161, v161, v34
 v_add_f32 v161, v161, v35
 v_add_f32 v161, v161, v36
 buffer_load_dwordx4 a[172:175], v4, s[8:11], s67 offen offset:3072 sc1
 v_add_f32 v161, v161, v37
 v_mov_b32 v162, v160
 v_mov_b32 v163, v161
 s_nop 0
 v_permlane16_swap_b32 v160, v162
 v_permlane16_swap_b32 v161, v163
 v_add_f32 v160, v160, v162
 v_add_f32 v161, v161, v163
 v_mov_b32 v162, v160
 v_mov_b32 v163, v161
 s_add_u32 s67, s67, 4096
 buffer_load_dwordx4 a[176:179], v4, s[8:11], s67 offen offset:0 sc1
 s_nop 0
 v_permlane32_swap_b32 v160, v162
 v_permlane32_swap_b32 v161, v163
 v_add_f32 v160, v160, v162
 v_add_f32 v161, v161, v163
 v_rcp_f32 v160, v160
 v_rcp_f32 v161, v161
 v_mul_f32 v20, v20, v160
 v_mul_f32 v21, v21, v160
 v_mul_f32 v22, v22, v160
 buffer_load_dwordx4 a[180:183], v4, s[8:11], s67 offen offset:1024 sc1
 v_mul_f32 v23, v23, v160
 v_mul_f32 v24, v24, v160
 v_mul_f32 v25, v25, v160
 v_mul_f32 v28, v28, v161
 v_mul_f32 v29, v29, v161
 v_mul_f32 v30, v30, v161
 v_mul_f32 v31, v31, v161
 v_mul_f32 v32, v32, v161
 v_mul_f32 v33, v33, v161
 v_mul_f32 v34, v34, v161
 buffer_load_dwordx4 a[184:187], v4, s[8:11], s67 offen offset:2048 sc1
 v_mul_f32 v35, v35, v161
 v_mul_f32 v36, v36, v161
 v_mul_f32 v37, v37, v161
 v_cvt_pk_bf16_f32 v40, v20, v21
 v_cvt_pk_bf16_f32 v41, v22, v23
 v_cvt_pk_bf16_f32 v44, v28, v29
 v_cvt_pk_bf16_f32 v45, v30, v31
 v_cvt_pk_bf16_f32 v46, v32, v33
 v_cvt_pk_bf16_f32 v47, v34, v35
 v_cvt_pk_bf16_f32 v48, v24, v25
 buffer_load_dwordx4 a[188:191], v4, s[8:11], s67 offen offset:3072 sc1
 v_cvt_pk_bf16_f32 v51, v24, v25
 v_cvt_pk_bf16_f32 v52, v36, v37
 v_cvt_pk_bf16_f32 v55, v36, v37
 v_mfma_f32_16x16x32_bf16 v[64:67], a[64:67], v[40:43], 0
 v_mfma_f32_16x16x32_bf16 v[68:71], a[68:71], v[40:43], 0
 v_mfma_f32_16x16x32_bf16 v[72:75], a[72:75], v[40:43], 0
 s_add_u32 s67, s67, 4096
 buffer_load_dwordx4 a[192:195], v4, s[8:11], s67 offen offset:0 sc1
 v_mfma_f32_16x16x32_bf16 v[76:79], a[76:79], v[40:43], 0
 v_mfma_f32_16x16x32_bf16 v[80:83], a[80:83], v[40:43], 0
 v_mfma_f32_16x16x32_bf16 v[84:87], a[84:87], v[40:43], 0
 v_mfma_f32_16x16x32_bf16 v[88:91], a[88:91], v[40:43], 0
 buffer_load_dwordx4 a[196:199], v4, s[8:11], s67 offen offset:1024 sc1
 v_mfma_f32_16x16x32_bf16 v[92:95], a[92:95], v[40:43], 0
 v_mfma_f32_16x16x32_bf16 v[96:99], a[64:67], v[44:47], 0
 v_mfma_f32_16x16x32_bf16 v[100:103], a[68:71], v[44:47], 0
 v_mfma_f32_16x16x32_bf16 v[104:107], a[72:75], v[44:47], 0
 buffer_load_dwordx4 a[200:203], v4, s[8:11], s67 offen offset:2048 sc1
 v_mfma_f32_16x16x32_bf16 v[108:111], a[76:79], v[44:47], 0
 v_mfma_f32_16x16x32_bf16 v[112:115], a[80:83], v[44:47], 0
 v_mfma_f32_16x16x32_bf16 v[116:119], a[84:87], v[44:47], 0
 v_mfma_f32_16x16x32_bf16 v[120:123], a[88:91], v[44:47], 0
 buffer_load_dwordx4 a[204:207], v4, s[8:11], s67 offen offset:3072 sc1
 v_mfma_f32_16x16x32_bf16 v[124:127], a[92:95], v[44:47], 0
 v_mfma_f32_16x16x16_bf16 v[64:67], a[112:113], v[48:49], v[64:67]
 v_mfma_f32_16x16x16_bf16 v[68:71], a[112:113], v[50:51], v[68:71]
 v_mfma_f32_16x16x16_bf16 v[72:75], a[114:115], v[48:49], v[72:75]
 s_add_u32 s67, s67, 4096
 buffer_load_dwordx4 a[208:211], v4, s[8:11], s67 offen offset:0 sc1
 v_mfma_f32_16x16x16_bf16 v[76:79], a[114:115], v[50:51], v[76:79]
 v_mfma_f32_16x16x16_bf16 v[80:83], a[116:117], v[48:49], v[80:83]
 v_mfma_f32_16x16x16_bf16 v[84:87], a[116:117], v[50:51], v[84:87]
 v_mfma_f32_16x16x16_bf16 v[88:91], a[118:119], v[48:49], v[88:91]
 buffer_load_dwordx4 a[212:215], v4, s[8:11], s67 offen offset:1024 sc1
 v_mfma_f32_16x16x16_bf16 v[92:95], a[118:119], v[50:51], v[92:95]
 v_mfma_f32_16x16x16_bf16 v[96:99], a[112:113], v[52:53], v[96:99]
 v_mfma_f32_16x16x16_bf16 v[100:103], a[112:113], v[54:55], v[100:103]
 v_mfma_f32_16x16x16_bf16 v[104:107], a[114:115], v[52:53], v[104:107]
 buffer_load_dwordx4 a[216:219], v4, s[8:11], s67 offen offset:2048 sc1
 v_mfma_f32_16x16x16_bf16 v[108:111], a[114:115], v[54:55], v[108:111]
 v_mfma_f32_16x16x16_bf16 v[112:115], a[116:117], v[52:53], v[112:115]
 v_mfma_f32_16x16x16_bf16 v[116:119], a[116:117], v[54:55], v[116:119]
 v_mfma_f32_16x16x16_bf16 v[120:123], a[118:119], v[52:53], v[120:123]
 buffer_load_dwordx4 a[220:223], v4, s[8:11], s67 offen offset:3072 sc1
 v_mfma_f32_16x16x16_bf16 v[124:127], a[118:119], v[54:55], v[124:127]
 s_branch L_a_e0
L_a_ww0:
 s_mov_b32 s66, 3
 v_mfma_f32_16x16x32_bf16 v[20:23], a[32:35], a[0:3], v[16:19]
 v_mfma_f32_16x16x32_bf16 v[24:27], a[96:99], a[0:3], 0
 v_mfma_f32_16x16x32_bf16 v[28:31], a[32:35], a[4:7], 0
 s_mul_i32 s67, s64, 786432
 s_add_u32 s67, s67, s72
 buffer_load_dwordx4 a[128:131], v4, s[8:11], s67 offen offset:0 sc1
 v_mfma_f32_16x16x32_bf16 v[32:35], a[36:39], a[4:7], v[16:19]
 v_mfma_f32_16x16x32_bf16 v[36:39], a[96:99], a[4:7], 0
 v_mfma_f32_16x16x32_bf16 v[20:23], a[40:43], a[8:11], v[20:23]
 buffer_load_dwordx4 a[132:135], v4, s[8:11], s67 offen offset:1024 sc1
 v_mfma_f32_16x16x32_bf16 v[24:27], a[100:103], a[8:11], v[24:27]
 v_mfma_f32_16x16x32_bf16 v[28:31], a[40:43], a[12:15], v[28:31]
 v_mfma_f32_16x16x32_bf16 v[32:35], a[44:47], a[12:15], v[32:35]
 buffer_load_dwordx4 a[136:139], v4, s[8:11], s67 offen offset:2048 sc1
 v_mfma_f32_16x16x32_bf16 v[36:39], a[100:103], a[12:15], v[36:39]
 v_mfma_f32_16x16x32_bf16 v[20:23], a[48:51], a[16:19], v[20:23]
 v_mfma_f32_16x16x32_bf16 v[24:27], a[104:107], a[16:19], v[24:27]
 buffer_load_dwordx4 a[140:143], v4, s[8:11], s67 offen offset:3072 sc1
 v_mfma_f32_16x16x32_bf16 v[28:31], a[48:51], a[20:23], v[28:31]
 v_mfma_f32_16x16x32_bf16 v[32:35], a[52:55], a[20:23], v[32:35]
 v_mfma_f32_16x16x32_bf16 v[36:39], a[104:107], a[20:23], v[36:39]
 s_add_u32 s67, s67, 4096
 buffer_load_dwordx4 a[144:147], v4, s[8:11], s67 offen offset:0 sc1
 v_mfma_f32_16x16x32_bf16 v[20:23], a[56:59], a[24:27], v[20:23]
 v_mfma_f32_16x16x32_bf16 v[24:27], a[108:111], a[24:27], v[24:27]
 v_mfma_f32_16x16x32_bf16 v[28:31], a[56:59], a[28:31], v[28:31]
 buffer_load_dwordx4 a[148:151], v4, s[8:11], s67 offen offset:1024 sc1
 v_mfma_f32_16x16x32_bf16 v[32:35], a[60:63], a[28:31], v[32:35]
 v_mfma_f32_16x16x32_bf16 v[36:39], a[108:111], a[28:31], v[36:39]
 s_nop 4
 v_max3_f32 v160, v20, v21, v22
 buffer_load_dwordx4 a[152:155], v4, s[8:11], s67 offen offset:2048 sc1
 v_max3_f32 v160, v160, v23, v24
 v_max_f32 v160, v160, v25
 v_max_f32 v161, v28, v29
 v_max3_f32 v161, v161, v30, v31
 v_max3_f32 v161, v161, v32, v33
 v_max3_f32 v161, v161, v34, v35
 v_max3_f32 v161, v161, v36, v37
 buffer_load_dwordx4 a[156:159], v4, s[8:11], s67 offen offset:3072 sc1
 v_mov_b32 v162, v160
 v_mov_b32 v163, v161
 s_nop 0
 v_permlane16_swap_b32 v160, v162
 v_permlane16_swap_b32 v161, v163
 v_max_f32 v160, v160, v162
 v_max_f32 v161, v161, v163
 s_add_u32 s67, s67, 4096
 buffer_load_dwordx4 a[160:163], v4, s[8:11], s67 offen offset:0 sc1
 v_mov_b32 v162, v160
 v_mov_b32 v163, v161
 s_nop 0
 v_permlane32_swap_b32 v160, v162
 v_permlane32_swap_b32 v161, v163
 v_max_f32 v160, v160, v162
 v_max_f32 v161, v161, v163
 buffer_load_dwordx4 a[164:167], v4, s[8:11], s67 offen offset:1024 sc1
 v_mul_f32 v160, s75, v160
 v_mul_f32 v161, s75, v161
 v_fma_f32 v20, v20, s75, -v160
 v_fma_f32 v21, v21, s75, -v160
 v_fma_f32 v22, v22, s75, -v160
 v_fma_f32 v23, v23, s75, -v160
 v_fma_f32 v24, v24, s75, -v160
 buffer_load_dwordx4 a[168:171], v4, s[8:11], s67 offen offset:2048 sc1
 v_fma_f32 v25, v25, s75, -v160
 v_fma_f32 v28, v28, s75, -v161
 v_fma_f32 v29, v29, s75, -v161
 v_fma_f32 v30, v30, s75, -v161
 v_fma_f32 v31, v31, s75, -v161
 v_fma_f32 v32, v32, s75, -v161
 v_fma_f32 v33, v33, s75, -v161
 buffer_load_dwordx4 a[172:175], v4, s[8:11], s67 offen offset:3072 sc1
 v_fma_f32 v34, v34, s75, -v161
 v_fma_f32 v35, v35, s75, -v161
 v_fma_f32 v36, v36, s75, -v161
 v_fma_f32 v37, v37, s75, -v161
 v_exp_f32 v20, v20
 v_exp_f32 v21, v21
 v_exp_f32 v22, v22
 s_add_u32 s67, s67, 4096
 buffer_load_dwordx4 a[176:179], v4, s[8:11], s67 offen offset:0 sc1
 v_exp_f32 v23, v23
 v_exp_f32 v24, v24
 v_exp_f32 v25, v25
 v_exp_f32 v28, v28
 v_exp_f32 v29, v29
 v_exp_f32 v30, v30
 v_exp_f32 v31, v31
 buffer_load_dwordx4 a[180:183], v4, s[8:11], s67 offen offset:1024 sc1
 v_exp_f32 v32, v32
 v_exp_f32 v33, v33
 v_exp_f32 v34, v34
 v_exp_f32 v35, v35
 v_exp_f32 v36, v36
 v_exp_f32 v37, v37
 v_add_f32 v160, v20, v21
 buffer_load_dwordx4 a[184:187], v4, s[8:11], s67 offen offset:2048 sc1
 v_add_f32 v160, v160, v22
 v_add_f32 v160, v160, v23
 v_add_f32 v160, v160, v24
 v_add_f32 v160, v160, v25
 v_add_f32 v161, v28, v29
 v_add_f32 v161, v161, v30
 s_waitcnt vmcnt(15)
 s_cmp_eq_u32 s79, s61
 s_cbranch_scc1 Lfa_80
 s_waitcnt lgkmcnt(0)
 s_mov_b32 s79, s61
 s_atomic_umax s79, s[8:9], s78
Lfa_80:
 v_add_f32 v161, v161, v31
 buffer_load_dwordx4 a[188:191], v4, s[8:11], s67 offen offset:3072 sc1
 v_add_f32 v161, v161, v32
 v_add_f32 v161, v161, v33
 v_add_f32 v161, v161, v34
 v_add_f32 v161, v161, v35
 v_add_f32 v161, v161, v36
 v_add_f32 v161, v161, v37
 v_mov_b32 v162, v160
 s_add_u32 s67, s67, 4096
 buffer_load_dwordx4 a[192:195], v4, s[8:11], s67 offen offset:0 sc1
 v_mov_b32 v163, v161
 s_nop 0
 v_permlane16_swap_b32 v160, v162
 v_permlane16_swap_b32 v161, v163
 v_add_f32 v160, v160, v162
 v_add_f32 v161, v161, v163
 v_mov_b32 v162, v160
 buffer_load_dwordx4 a[196:199], v4, s[8:11], s67 offen offset:1024 sc1
 v_mov_b32 v163, v161
 s_nop 0
 v_permlane32_swap_b32 v160, v162
 v_permlane32_swap_b32 v161, v163
 v_add_f32 v160, v160, v162
 v_add_f32 v161, v161, v163
 v_rcp_f32 v160, v160
 buffer_load_dwordx4 a[200:203], v4, s[8:11], s67 offen offset:2048 sc1
 v_rcp_f32 v161, v161
 v_mul_f32 v20, v20, v160
 v_mul_f32 v21, v21, v160
 v_mul_f32 v22, v22, v160
 v_mul_f32 v23, v23, v160
 v_mul_f32 v24, v24, v160
 v_mul_f32 v25, v25, v160
 buffer_load_dwordx4 a[204:207], v4, s[8:11], s67 offen offset:3072 sc1
 v_mul_f32 v28, v28, v161
 v_mul_f32 v29, v29, v161
 v_mul_f32 v30, v30, v161
 v_mul_f32 v31, v31, v161
 v_mul_f32 v32, v32, v161
 v_mul_f32 v33, v33, v161
 v_mul_f32 v34, v34, v161
 s_add_u32 s67, s67, 4096
 buffer_load_dwordx4 a[208:211], v4, s[8:11], s67 offen offset:0 sc1
 v_mul_f32 v35, v35, v161
 v_mul_f32 v36, v36, v161
 v_mul_f32 v37, v37, v161
 v_cvt_pk_bf16_f32 v40, v20, v21
 v_cvt_pk_bf16_f32 v41, v22, v23
 v_cvt_pk_bf16_f32 v44, v28, v29
 v_cvt_pk_bf16_f32 v45, v30, v31
 buffer_load_dwordx4 a[212:215], v4, s[8:11], s67 offen offset:1024 sc1
 v_cvt_pk_bf16_f32 v46, v32, v33
 v_cvt_pk_bf16_f32 v47, v34, v35
 v_cvt_pk_bf16_f32 v48, v24, v25
 v_cvt_pk_bf16_f32 v51, v24, v25
 v_cvt_pk_bf16_f32 v52, v36, v37
 v_cvt_pk_bf16_f32 v55, v36, v37
 v_mfma_f32_16x16x32_bf16 v[64:67], a[64:67], v[40:43], 0
 buffer_load_dwordx4 a[216:219], v4, s[8:11], s67 offen offset:2048 sc1
 v_mfma_f32_16x16x32_bf16 v[68:71], a[68:71], v[40:43], 0
 v_mfma_f32_16x16x32_bf16 v[72:75], a[72:75], v[40:43], 0
 v_mfma_f32_16x16x32_bf16 v[76:79], a[76:79], v[40:43], 0
 buffer_load_dwordx4 a[220:223], v4, s[8:11], s67 offen offset:3072 sc1
 v_mfma_f32_16x16x32_bf16 v[80:83], a[80:83], v[40:43], 0
 v_mfma_f32_16x16x32_bf16 v[84:87], a[84:87], v[40:43], 0
 v_mfma_f32_16x16x32_bf16 v[88:91], a[88:91], v[40:43], 0
 s_mul_i32 s68, s64, 131072
 s_add_u32 s68, s68, s73
 buffer_load_dwordx4 a[224:227], v5, s[8:11], s68 offen offset:0 sc1
 v_mfma_f32_16x16x32_bf16 v[92:95], a[92:95], v[40:43], 0
 v_mfma_f32_16x16x32_bf16 v[96:99], a[64:67], v[44:47], 0
 v_mfma_f32_16x16x32_bf16 v[100:103], a[68:71], v[44:47], 0
 buffer_load_dwordx4 a[228:231], v5, s[8:11], s68 offen offset:512 sc1
 v_mfma_f32_16x16x32_bf16 v[104:107], a[72:75], v[44:47], 0
 v_mfma_f32_16x16x32_bf16 v[108:111], a[76:79], v[44:47], 0
 v_mfma_f32_16x16x32_bf16 v[112:115], a[80:83], v[44:47], 0
 buffer_load_dwordx4 a[232:235], v5, s[8:11], s68 offen offset:1024 sc1
 v_mfma_f32_16x16x32_bf16 v[116:119], a[84:87], v[44:47], 0
 v_mfma_f32_16x16x32_bf16 v[120:123], a[88:91], v[44:47], 0
 v_mfma_f32_16x16x32_bf16 v[124:127], a[92:95], v[44:47], 0
 buffer_load_dwordx4 a[236:239], v5, s[8:11], s68 offen offset:1536 sc1
 v_mfma_f32_16x16x16_bf16 v[64:67], a[112:113], v[48:49], v[64:67]
 v_mfma_f32_16x16x16_bf16 v[68:71], a[112:113], v[50:51], v[68:71]
 v_mfma_f32_16x16x16_bf16 v[72:75], a[114:115], v[48:49], v[72:75]
 buffer_load_dwordx2 a[240:241], v6, s[8:11], s68 offen offset:2048 sc1
 v_mfma_f32_16x16x16_bf16 v[76:79], a[114:115], v[50:51], v[76:79]
 v_mfma_f32_16x16x16_bf16 v[80:83], a[116:117], v[48:49], v[80:83]
 v_mfma_f32_16x16x16_bf16 v[84:87], a[116:117], v[50:51], v[84:87]
 buffer_load_dwordx2 a[242:243], v6, s[8:11], s68 offen offset:2560 sc1
 v_mfma_f32_16x16x16_bf16 v[88:91], a[118:119], v[48:49], v[88:91]
 v_mfma_f32_16x16x16_bf16 v[92:95], a[118:119], v[50:51], v[92:95]
 v_mfma_f32_16x16x16_bf16 v[96:99], a[112:113], v[52:53], v[96:99]
 buffer_load_dwordx2 a[244:245], v6, s[8:11], s68 offen offset:3072 sc1
 v_mfma_f32_16x16x16_bf16 v[100:103], a[112:113], v[54:55], v[100:103]
 v_mfma_f32_16x16x16_bf16 v[104:107], a[114:115], v[52:53], v[104:107]
 v_mfma_f32_16x16x16_bf16 v[108:111], a[114:115], v[54:55], v[108:111]
 buffer_load_dwordx2 a[246:247], v6, s[8:11], s68 offen offset:3584 sc1
 v_mfma_f32_16x16x16_bf16 v[112:115], a[116:117], v[52:53], v[112:115]
 v_mfma_f32_16x16x16_bf16 v[116:119], a[116:117], v[54:55], v[116:119]
 v_mfma_f32_16x16x16_bf16 v[120:123], a[118:119], v[52:53], v[120:123]
 v_mfma_f32_16x16x16_bf16 v[124:127], a[118:119], v[54:55], v[124:127]
L_a_e0:
 buffer_load_dword v8, v7, s[8:11], 0 offen sc1
 v_cvt_pk_bf16_f32 v128, v64, v65
 v_cvt_pk_bf16_f32 v129, v66, v67
 v_cvt_pk_bf16_f32 v130, v68, v69
 v_cvt_pk_bf16_f32 v131, v70, v71
 v_cvt_pk_bf16_f32 v132, v72, v73
 v_cvt_pk_bf16_f32 v133, v74, v75
 v_cvt_pk_bf16_f32 v134, v76, v77
 v_cvt_pk_bf16_f32 v135, v78, v79
 v_cvt_pk_bf16_f32 v136, v80, v81
 v_cvt_pk_bf16_f32 v137, v82, v83
 v_cvt_pk_bf16_f32 v138, v84, v85
 v_cvt_pk_bf16_f32 v139, v86, v87
 v_cvt_pk_bf16_f32 v140, v88, v89
 v_cvt_pk_bf16_f32 v141, v90, v91
 v_cvt_pk_bf16_f32 v142, v92, v93
 v_cvt_pk_bf16_f32 v143, v94, v95
 v_cvt_pk_bf16_f32 v144, v96, v97
 v_cvt_pk_bf16_f32 v145, v98, v99
 v_cvt_pk_bf16_f32 v146, v100, v101
 v_cvt_pk_bf16_f32 v147, v102, v103
 v_cvt_pk_bf16_f32 v148, v104, v105
 v_cvt_pk_bf16_f32 v149, v106, v107
 v_cvt_pk_bf16_f32 v150, v108, v109
 v_cvt_pk_bf16_f32 v151, v110, v111
 v_cvt_pk_bf16_f32 v152, v112, v113
 v_cvt_pk_bf16_f32 v153, v114, v115
 v_cvt_pk_bf16_f32 v154, v116, v117
 v_cvt_pk_bf16_f32 v155, v118, v119
 v_cvt_pk_bf16_f32 v156, v120, v121
 v_cvt_pk_bf16_f32 v157, v122, v123
 v_cvt_pk_bf16_f32 v158, v124, v125
 v_cvt_pk_bf16_f32 v159, v126, v127
 s_mul_i32 s67, s61, 262144
 s_add_u32 s67, s67, s74
 buffer_store_dwordx4 v[128:131], v4, s[8:11], s67 offen offset:0 sc1
 buffer_store_dwordx4 v[132:135], v4, s[8:11], s67 offen offset:1024 sc1
 buffer_store_dwordx4 v[136:139], v4, s[8:11], s67 offen offset:2048 sc1
 buffer_store_dwordx4 v[140:143], v4, s[8:11], s67 offen offset:3072 sc1
 s_add_u32 s67, s67, 32768
 buffer_store_dwordx4 v[144:147], v4, s[8:11], s67 offen offset:0 sc1
 buffer_store_dwordx4 v[148:151], v4, s[8:11], s67 offen offset:1024 sc1
 buffer_store_dwordx4 v[152:155], v4, s[8:11], s67 offen offset:2048 sc1
 buffer_store_dwordx4 v[156:159], v4, s[8:11], s67 offen offset:3072 sc1
 s_mov_b32 s61, s64
 s_waitcnt vmcnt(8)
 v_cmp_ge_u32 vcc, s61, v8
 s_cmp_eq_u32 s66, 3
 s_cbranch_scc1 L_a_top21
 s_cmp_eq_u32 s66, 0
 s_cbranch_scc1 L_a_idle0
 s_cmp_lg_u32 vcc_hi, 0
 s_cbranch_scc1 L_a_idle0
 s_mul_i32 s68, s61, 131072
 s_add_u32 s68, s68, s73
 buffer_load_dwordx4 a[224:227], v5, s[8:11], s68 offen offset:0 sc1
 buffer_load_dwordx4 a[228:231], v5, s[8:11], s68 offen offset:512 sc1
 buffer_load_dwordx4 a[232:235], v5, s[8:11], s68 offen offset:1024 sc1
 buffer_load_dwordx4 a[236:239], v5, s[8:11], s68 offen offset:1536 sc1
 buffer_load_dwordx2 a[240:241], v6, s[8:11], s68 offen offset:2048 sc1
 buffer_load_dwordx2 a[242:243], v6, s[8:11], s68 offen offset:2560 sc1
 buffer_load_dwordx2 a[244:245], v6, s[8:11], s68 offen offset:3072 sc1
 buffer_load_dwordx2 a[246:247], v6, s[8:11], s68 offen offset:3584 sc1
 s_branch L_a_topf1
L_a_idle0:
 buffer_load_dword v8, v7, s[8:11], 0 offen sc1
 s_waitcnt vmcnt(0)
 s_cmp_eq_u32 s79, s61
 s_cbranch_scc1 Lfa_81
 s_waitcnt lgkmcnt(0)
 s_mov_b32 s79, s61
 s_atomic_umax s79, s[8:9], s78
Lfa_81:
 s_cmp_ge_u32 s61, 64
 s_cbranch_scc1 L_a_done
 s_mov_b32 s62, 0
 s_branch L_a_chk1
L_a_wait1:
 s_mov_b32 s62, 0
L_a_spin1:
 buffer_load_dword v8, v7, s[8:11], 0 offen sc1
 s_waitcnt vmcnt(0)
L_a_chk1:
 v_cmp_ge_u32 vcc, s61, v8
 s_bitcmp1_b32 s66, 1
 s_cbranch_scc1 La_82
 s_cmp_lg_u32 vcc_hi, 0
 s_cbranch_scc1 La_82
 s_mul_i32 s68, s61, 131072
 s_add_u32 s68, s68, s73
 buffer_load_dwordx4 a[224:227], v5, s[8:11], s68 offen offset:0 sc1
 buffer_load_dwordx4 a[228:231], v5, s[8:11], s68 offen offset:512 sc1
 buffer_load_dwordx4 a[232:235], v5, s[8:11], s68 offen offset:1024 sc1
 buffer_load_dwordx4 a[236:239], v5, s[8:11], s68 offen offset:1536 sc1
 buffer_load_dwordx2 a[240:241], v6, s[8:11], s68 offen offset:2048 sc1
 buffer_load_dwordx2 a[242:243], v6, s[8:11], s68 offen offset:2560 sc1
 buffer_load_dwordx2 a[244:245], v6, s[8:11], s68 offen offset:3072 sc1
 buffer_load_dwordx2 a[246:247], v6, s[8:11], s68 offen offset:3584 sc1
 s_or_b32 s66, s66, 2
La_82:
 s_bitcmp1_b32 s66, 0
 s_cbranch_scc1 La_83
 s_and_b32 s63, vcc_lo, 0xff
 s_cbranch_scc1 La_83
 s_mov_b32 s64, s61
 s_mul_i32 s67, s64, 786432
 s_add_u32 s67, s67, s72
 buffer_load_dwordx4 a[128:131], v4, s[8:11], s67 offen offset:0 sc1
 buffer_load_dwordx4 a[132:135], v4, s[8:11], s67 offen offset:1024 sc1
 buffer_load_dwordx4 a[136:139], v4, s[8:11], s67 offen offset:2048 sc1
 buffer_load_dwordx4 a[140:143], v4, s[8:11], s67 offen offset:3072 sc1
 s_add_u32 s67, s67, 4096
 buffer_load_dwordx4 a[144:147], v4, s[8:11], s67 offen offset:0 sc1
 buffer_load_dwordx4 a[148:151], v4, s[8:11], s67 offen offset:1024 sc1
 buffer_load_dwordx4 a[152:155], v4, s[8:11], s67 offen offset:2048 sc1
 buffer_load_dwordx4 a[156:159], v4, s[8:11], s67 offen offset:3072 sc1
 s_add_u32 s67, s67, 4096
 buffer_load_dwordx4 a[160:163], v4, s[8:11], s67 offen offset:0 sc1
 buffer_load_dwordx4 a[164:167], v4, s[8:11], s67 offen offset:1024 sc1
 buffer_load_dwordx4 a[168:171], v4, s[8:11], s67 offen offset:2048 sc1
 buffer_load_dwordx4 a[172:175], v4, s[8:11], s67 offen offset:3072 sc1
 s_add_u32 s67, s67, 4096
 buffer_load_dwordx4 a[176:179], v4, s[8:11], s67 offen offset:0 sc1
 buffer_load_dwordx4 a[180:183], v4, s[8:11], s67 offen offset:1024 sc1
 buffer_load_dwordx4 a[184:187], v4, s[8:11], s67 offen offset:2048 sc1
 buffer_load_dwordx4 a[188:191], v4, s[8:11], s67 offen offset:3072 sc1
 s_add_u32 s67, s67, 4096
 buffer_load_dwordx4 a[192:195], v4, s[8:11], s67 offen offset:0 sc1
 buffer_load_dwordx4 a[196:199], v4, s[8:11], s67 offen offset:1024 sc1
 buffer_load_dwordx4 a[200:203], v4, s[8:11], s67 offen offset:2048 sc1
 buffer_load_dwordx4 a[204:207], v4, s[8:11], s67 offen offset:3072 sc1
 s_add_u32 s67, s67, 4096
 buffer_load_dwordx4 a[208:211], v4, s[8:11], s67 offen offset:0 sc1
 buffer_load_dwordx4 a[212:215], v4, s[8:11], s67 offen offset:1024 sc1
 buffer_load_dwordx4 a[216:219], v4, s[8:11], s67 offen offset:2048 sc1
 buffer_load_dwordx4 a[220:223], v4, s[8:11], s67 offen offset:3072 sc1
 s_or_b32 s66, s66, 1
La_83:
 s_cmp_eq_u32 s66, 3
 s_cbranch_scc1 L_a_top1
 s_add_u32 s62, s62, 1
 s_cmp_lt_u32 s62, 400000
 s_cbranch_scc1 L_a_spin1
 s_mov_b32 s63, 30
 s_branch L_abort_b
L_a_topf1:
 s_waitcnt vmcnt(8)
 s_cmp_eq_u32 s79, s61
 s_cbranch_scc1 Lfa_84
 s_waitcnt lgkmcnt(0)
 s_mov_b32 s79, s61
 s_atomic_umax s79, s[8:9], s78
Lfa_84:
 s_waitcnt vmcnt(0)
 s_branch L_a_top21
L_a_top1:
 s_waitcnt vmcnt(0)
L_a_top21:
 s_cmp_ge_u32 s61, s80
 s_addc_u32 s64, s61, 1
 v_cmp_ge_u32 vcc, s64, v8
 s_and_b32 s63, vcc_lo, 0xff
 s_cbranch_scc0 L_a_w1
 s_mov_b32 s66, 0
 v_mfma_f32_16x16x32_bf16 v[20:23], a[160:163], a[128:131], v[16:19]
 v_mfma_f32_16x16x32_bf16 v[24:27], a[224:227], a[128:131], 0
 v_mfma_f32_16x16x32_bf16 v[28:31], a[160:163], a[132:135], 0
 v_mfma_f32_16x16x32_bf16 v[32:35], a[164:167], a[132:135], v[16:19]
 v_mfma_f32_16x16x32_bf16 v[36:39], a[224:227], a[132:135], 0
 v_mfma_f32_16x16x32_bf16 v[20:23], a[168:171], a[136:139], v[20:23]
 v_mfma_f32_16x16x32_bf16 v[24:27], a[228:231], a[136:139], v[24:27]
 v_mfma_f32_16x16x32_bf16 v[28:31], a[168:171], a[140:143], v[28:31]
 v_mfma_f32_16x16x32_bf16 v[32:35], a[172:175], a[140:143], v[32:35]
 v_mfma_f32_16x16x32_bf16 v[36:39], a[228:231], a[140:143], v[36:39]
 v_mfma_f32_16x16x32_bf16 v[20:23], a[176:179], a[144:147], v[20:23]
 v_mfma_f32_16x16x32_bf16 v[24:27], a[232:235], a[144:147], v[24:27]
 v_mfma_f32_16x16x32_bf16 v[28:31], a[176:179], a[148:151], v[28:31]
 v_mfma_f32_16x16x32_bf16 v[32:35], a[180:183], a[148:151], v[32:35]
 v_mfma_f32_16x16x32_bf16 v[36:39], a[232:235], a[148:151], v[36:39]
 v_mfma_f32_16x16x32_bf16 v[20:23], a[184:187], a[152:155], v[20:23]
 v_mfma_f32_16x16x32_bf16 v[24:27], a[236:239], a[152:155], v[24:27]
 v_mfma_f32_16x16x32_bf16 v[28:31], a[184:187], a[156:159], v[28:31]
 v_mfma_f32_16x16x32_bf16 v[32:35], a[188:191], a[156:159], v[32:35]
 v_mfma_f32_16x16x32_bf16 v[36:39], a[236:239], a[156:159], v[36:39]
 s_nop 4
 v_max3_f32 v160, v20, v21, v22
 v_max3_f32 v160, v160, v23, v24
 v_max_f32 v160, v160, v25
 v_max_f32 v161, v28, v29
 v_max3_f32 v161, v161, v30, v31
 v_max3_f32 v161, v161, v32, v33
 v_max3_f32 v161, v161, v34, v35
 v_max3_f32 v161, v161, v36, v37
 v_mov_b32 v162, v160
 v_mov_b32 v163, v161
 s_nop 0
 v_permlane16_swap_b32 v160, v162
 v_permlane16_swap_b32 v161, v163
 v_max_f32 v160, v160, v162
 v_max_f32 v161, v161, v163
 v_mov_b32 v162, v160
 v_mov_b32 v163, v161
 s_nop 0
 v_permlane32_swap_b32 v160, v162
 v_permlane32_swap_b32 v161, v163
 v_max_f32 v160, v160, v162
 v_max_f32 v161, v161, v163
 v_mul_f32 v160, s75, v160
 v_mul_f32 v161, s75, v161
 v_fma_f32 v20, v20, s75, -v160
 v_fma_f32 v21, v21, s75, -v160
 v_fma_f32 v22, v22, s75, -v160
 v_fma_f32 v23, v23, s75, -v160
 v_fma_f32 v24, v24, s75, -v160
 v_fma_f32 v25, v25, s75, -v160
 v_fma_f32 v28, v28, s75, -v161
 v_fma_f32 v29, v29, s75, -v161
 v_fma_f32 v30, v30, s75, -v161
 v_fma_f32 v31, v31, s75, -v161
 v_fma_f32 v32, v32, s75, -v161
 v_fma_f32 v33, v33, s75, -v161
 v_fma_f32 v34, v34, s75, -v161
 v_fma_f32 v35, v35, s75, -v161
 v_fma_f32 v36, v36, s75, -v161
 v_fma_f32 v37, v37, s75, -v161
 v_exp_f32 v20, v20
 v_exp_f32 v21, v21
 v_exp_f32 v22, v22
 v_exp_f32 v23, v23
 v_exp_f32 v24, v24
 v_exp_f32 v25, v25
 v_exp_f32 v28, v28
 v_exp_f32 v29, v29
 v_exp_f32 v30, v30
 v_exp_f32 v31, v31
 v_exp_f32 v32, v32
 v_exp_f32 v33, v33
 v_exp_f32 v34, v34
 v_exp_f32 v35, v35
 v_exp_f32 v36, v36
 v_exp_f32 v37, v37
 v_add_f32 v160, v20, v21
 v_add_f32 v160, v160, v22
 v_add_f32 v160, v160, v23
 v_add_f32 v160, v160, v24
 v_add_f32 v160, v160, v25
 v_add_f32 v161, v28, v29
 v_add_f32 v161, v161, v30
 s_waitcnt vmcnt(0)
 s_cmp_eq_u32 s79, s61
 s_cbranch_scc1 Lfa_85
 s_waitcnt lgkmcnt(0)
 s_mov_b32 s79, s61
 s_atomic_umax s79, s[8:9], s78
Lfa_85:
 v_add_f32 v161, v161, v31
 v_add_f32 v161, v161, v32
 v_add_f32 v161, v161, v33
 v_add_f32 v161, v161, v34
 v_add_f32 v161, v161, v35
 v_add_f32 v161, v161, v36
 v_add_f32 v161, v161, v37
 v_mov_b32 v162, v160
 v_mov_b32 v163, v161
 s_nop 0
 v_permlane16_swap_b32 v160, v162
 v_permlane16_swap_b32 v161, v163
 v_add_f32 v160, v160, v162
 v_add_f32 v161, v161, v163
 v_mov_b32 v162, v160
 v_mov_b32 v163, v161
 s_nop 0
 v_permlane32_swap_b32 v160, v162
 v_permlane32_swap_b32 v161, v163
 v_add_f32 v160, v160, v162
 v_add_f32 v161, v161, v163
 v_rcp_f32 v160, v160
 v_rcp_f32 v161, v161
 v_mul_f32 v20, v20, v160
 v_mul_f32 v21, v21, v160
 v_mul_f32 v22, v22, v160
 v_mul_f32 v23, v23, v160
 v_mul_f32 v24, v24, v160
 v_mul_f32 v25, v25, v160
 v_mul_f32 v28, v28, v161
 v_mul_f32 v29, v29, v161
 v_mul_f32 v30, v30, v161
 v_mul_f32 v31, v31, v161
 v_mul_f32 v32, v32, v161
 v_mul_f32 v33, v33, v161
 v_mul_f32 v34, v34, v161
 v_mul_f32 v35, v35, v161
 v_mul_f32 v36, v36, v161
 v_mul_f32 v37, v37, v161
 v_cvt_pk_bf16_f32 v40, v20, v21
 v_cvt_pk_bf16_f32 v41, v22, v23
 v_cvt_pk_bf16_f32 v44, v28, v29
 v_cvt_pk_bf16_f32 v45, v30, v31
 v_cvt_pk_bf16_f32 v46, v32, v33
 v_cvt_pk_bf16_f32 v47, v34, v35
 v_cvt_pk_bf16_f32 v48, v24, v25
 v_cvt_pk_bf16_f32 v51, v24, v25
 v_cvt_pk_bf16_f32 v52, v36, v37
 v_cvt_pk_bf16_f32 v55, v36, v37
 v_mfma_f32_16x16x32_bf16 v[64:67], a[192:195], v[40:43], 0
 v_mfma_f32_16x16x32_bf16 v[68:71], a[196:199], v[40:43], 0
 v_mfma_f32_16x16x32_bf16 v[72:75], a[200:203], v[40:43], 0
 v_mfma_f32_16x16x32_bf16 v[76:79], a[204:207], v[40:43], 0
 v_mfma_f32_16x16x32_bf16 v[80:83], a[208:211], v[40:43], 0
 v_mfma_f32_16x16x32_bf16 v[84:87], a[212:215], v[40:43], 0
 v_mfma_f32_16x16x32_bf16 v[88:91], a[216:219], v[40:43], 0
 v_mfma_f32_16x16x32_bf16 v[92:95], a[220:223], v[40:43], 0
 v_mfma_f32_16x16x32_bf16 v[96:99], a[192:195], v[44:47], 0
 v_mfma_f32_16x16x32_bf16 v[100:103], a[196:199], v[44:47], 0
 v_mfma_f32_16x16x32_bf16 v[104:107], a[200:203], v[44:47], 0
 v_mfma_f32_16x16x32_bf16 v[108:111], a[204:207], v[44:47], 0
 v_mfma_f32_16x16x32_bf16 v[112:115], a[208:211], v[44:47], 0
 v_mfma_f32_16x16x32_bf16 v[116:119], a[212:215], v[44:47], 0
 v_mfma_f32_16x16x32_bf16 v[120:123], a[216:219], v[44:47], 0
 v_mfma_f32_16x16x32_bf16 v[124:127], a[220:223], v[44:47], 0
 v_mfma_f32_16x16x16_bf16 v[64:67], a[240:241], v[48:49], v[64:67]
 v_mfma_f32_16x16x16_bf16 v[68:71], a[240:241], v[50:51], v[68:71]
 v_mfma_f32_16x16x16_bf16 v[72:75], a[242:243], v[48:49], v[72:75]
 v_mfma_f32_16x16x16_bf16 v[76:79], a[242:243], v[50:51], v[76:79]
 v_mfma_f32_16x16x16_bf16 v[80:83], a[244:245], v[48:49], v[80:83]
 v_mfma_f32_16x16x16_bf16 v[84:87], a[244:245], v[50:51], v[84:87]
 v_mfma_f32_16x16x16_bf16 v[88:91], a[246:247], v[48:49], v[88:91]
 v_mfma_f32_16x16x16_bf16 v[92:95], a[246:247], v[50:51], v[92:95]
 v_mfma_f32_16x16x16_bf16 v[96:99], a[240:241], v[52:53], v[96:99]
 v_mfma_f32_16x16x16_bf16 v[100:103], a[240:241], v[54:55], v[100:103]
 v_mfma_f32_16x16x16_bf16 v[104:107], a[242:243], v[52:53], v[104:107]
 v_mfma_f32_16x16x16_bf16 v[108:111], a[242:243], v[54:55], v[108:111]
 v_mfma_f32_16x16x16_bf16 v[112:115], a[244:245], v[52:53], v[112:115]
 v_mfma_f32_16x16x16_bf16 v[116:119], a[244:245], v[54:55], v[116:119]
 v_mfma_f32_16x16x16_bf16 v[120:123], a[246:247], v[52:53], v[120:123]
 v_mfma_f32_16x16x16_bf16 v[124:127], a[246:247], v[54:55], v[124:127]
 s_branch L_a_e1
L_a_w1:
 s_cmp_eq_u32 vcc_hi, 0
 s_cbranch_scc1 L_a_ww1
 s_mov_b32 s66, 1
 v_mfma_f32_16x16x32_bf16 v[20:23], a[160:163], a[128:131], v[16:19]
 v_mfma_f32_16x16x32_bf16 v[24:27], a[224:227], a[128:131], 0
 v_mfma_f32_16x16x32_bf16 v[28:31], a[160:163], a[132:135], 0
 v_mfma_f32_16x16x32_bf16 v[32:35], a[164:167], a[132:135], v[16:19]
 s_mul_i32 s67, s64, 786432
 s_add_u32 s67, s67, s72
 buffer_load_dwordx4 a[0:3], v4, s[8:11], s67 offen offset:0 sc1
 v_mfma_f32_16x16x32_bf16 v[36:39], a[224:227], a[132:135], 0
 v_mfma_f32_16x16x32_bf16 v[20:23], a[168:171], a[136:139], v[20:23]
 v_mfma_f32_16x16x32_bf16 v[24:27], a[228:231], a[136:139], v[24:27]
 v_mfma_f32_16x16x32_bf16 v[28:31], a[168:171], a[140:143], v[28:31]
 buffer_load_dwordx4 a[4:7], v4, s[8:11], s67 offen offset:1024 sc1
 v_mfma_f32_16x16x32_bf16 v[32:35], a[172:175], a[140:143], v[32:35]
 v_mfma_f32_16x16x32_bf16 v[36:39], a[228:231], a[140:143], v[36:39]
 v_mfma_f32_16x16x32_bf16 v[20:23], a[176:179], a[144:147], v[20:23]
 v_mfma_f32_16x16x32_bf16 v[24:27], a[232:235], a[144:147], v[24:27]
 buffer_load_dwordx4 a[8:11], v4, s[8:11], s67 offen offset:2048 sc1
 v_mfma_f32_16x16x32_bf16 v[28:31], a[176:179], a[148:151], v[28:31]
 v_mfma_f32_16x16x32_bf16 v[32:35], a[180:183], a[148:151], v[32:35]
 v_mfma_f32_16x16x32_bf16 v[36:39], a[232:235], a[148:151], v[36:39]
 v_mfma_f32_16x16x32_bf16 v[20:23], a[184:187], a[152:155], v[20:23]
 buffer_load_dwordx4 a[12:15], v4, s[8:11], s67 offen offset:3072 sc1
 v_mfma_f32_16x16x32_bf16 v[24:27], a[236:239], a[152:155], v[24:27]
 v_mfma_f32_16x16x32_bf16 v[28:31], a[184:187], a[156:159], v[28:31]
 v_mfma_f32_16x16x32_bf16 v[32:35], a[188:191], a[156:159], v[32:35]
 v_mfma_f32_16x16x32_bf16 v[36:39], a[236:239], a[156:159], v[36:39]
 s_add_u32 s67, s67, 4096
 buffer_load_dwordx4 a[16:19], v4, s[8:11], s67 offen offset:0 sc1
 s_nop 4
 v_max3_f32 v160, v20, v21, v22
 v_max3_f32 v160, v160, v23, v24
 v_max_f32 v160, v160, v25
 v_max_f32 v161, v28, v29
 v_max3_f32 v161, v161, v30, v31
 v_max3_f32 v161, v161, v32, v33
 v_max3_f32 v161, v161, v34, v35
 v_max3_f32 v161, v161, v36, v37
 v_mov_b32 v162, v160
 buffer_load_dwordx4 a[20:23], v4, s[8:11], s67 offen offset:1024 sc1
 v_mov_b32 v163, v161
 s_nop 0
 v_permlane16_swap_b32 v160, v162
 v_permlane16_swap_b32 v161, v163
 v_max_f32 v160, v160, v162
 v_max_f32 v161, v161, v163
 v_mov_b32 v162, v160
 v_mov_b32 v163, v161
 s_nop 0
 v_permlane32_swap_b32 v160, v162
 buffer_load_dwordx4 a[24:27], v4, s[8:11], s67 offen offset:2048 sc1
 v_permlane32_swap_b32 v161, v163
 v_max_f32 v160, v160, v162
 v_max_f32 v161, v161, v163
 v_mul_f32 v160, s75, v160
 v_mul_f32 v161, s75, v161
 v_fma_f32 v20, v20, s75, -v160
 v_fma_f32 v21, v21, s75, -v160
 v_fma_f32 v22, v22, s75, -v160
 v_fma_f32 v23, v23, s75, -v160
 v_fma_f32 v24, v24, s75, -v160
 buffer_load_dwordx4 a[28:31], v4, s[8:11], s67 offen offset:3072 sc1
 v_fma_f32 v25, v25, s75, -v160
 v_fma_f32 v28, v28, s75, -v161
 v_fma_f32 v29, v29, s75, -v161
 v_fma_f32 v30, v30, s75, -v161
 v_fma_f32 v31, v31, s75, -v161
 v_fma_f32 v32, v32, s75, -v161
 v_fma_f32 v33, v33, s75, -v161
 v_fma_f32 v34, v34, s75, -v161
 v_fma_f32 v35, v35, s75, -v161
 v_fma_f32 v36, v36, s75, -v161
 s_add_u32 s67, s67, 4096
 buffer_load_dwordx4 a[32:35], v4, s[8:11], s67 offen offset:0 sc1
 v_fma_f32 v37, v37, s75, -v161
 v_exp_f32 v20, v20
 v_exp_f32 v21, v21
 v_exp_f32 v22, v22
 v_exp_f32 v23, v23
 v_exp_f32 v24, v24
 v_exp_f32 v25, v25
 v_exp_f32 v28, v28
 v_exp_f32 v29, v29
 v_exp_f32 v30, v30
 buffer_load_dwordx4 a[36:39], v4, s[8:11], s67 offen offset:1024 sc1
 v_exp_f32 v31, v31
 v_exp_f32 v32, v32
 v_exp_f32 v33, v33
 v_exp_f32 v34, v34
 v_exp_f32 v35, v35
 v_exp_f32 v36, v36
 v_exp_f32 v37, v37
 v_add_f32 v160, v20, v21
 v_add_f32 v160, v160, v22
 v_add_f32 v160, v160, v23
 buffer_load_dwordx4 a[40:43], v4, s[8:11], s67 offen offset:2048 sc1
 v_add_f32 v160, v160, v24
 v_add_f32 v160, v160, v25
 v_add_f32 v161, v28, v29
 v_add_f32 v161, v161, v30
 s_waitcnt vmcnt(11)
 s_cmp_eq_u32 s79, s61
 s_cbranch_scc1 Lfa_86
 s_waitcnt lgkmcnt(0)
 s_mov_b32 s79, s61
 s_atomic_umax s79, s[8:9], s78
Lfa_86:
 v_add_f32 v161, v161, v31
 v_add_f32 v161, v161, v32
 v_add_f32 v161, v161, v33
 v_add_f32 v161, v161, v34
 v_add_f32 v161, v161, v35
 v_add_f32 v161, v161, v36
 buffer_load_dwordx4 a[44:47], v4, s[8:11], s67 offen offset:3072 sc1
 v_add_f32 v161, v161, v37
 v_mov_b32 v162, v160
 v_mov_b32 v163, v161
 s_nop 0
 v_permlane16_swap_b32 v160, v162
 v_permlane16_swap_b32 v161, v163
 v_add_f32 v160, v160, v162
 v_add_f32 v161, v161, v163
 v_mov_b32 v162, v160
 v_mov_b32 v163, v161
 s_add_u32 s67, s67, 4096
 buffer_load_dwordx4 a[48:51], v4, s[8:11], s67 offen offset:0 sc1
 s_nop 0
 v_permlane32_swap_b32 v160, v162
 v_permlane32_swap_b32 v161, v163
 v_add_f32 v160, v160, v162
 v_add_f32 v161, v161, v163
 v_rcp_f32 v160, v160
 v_rcp_f32 v161, v161
 v_mul_f32 v20, v20, v160
 v_mul_f32 v21, v21, v160
 v_mul_f32 v22, v22, v160
 buffer_load_dwordx4 a[52:55], v4, s[8:11], s67 offen offset:1024 sc1
 v_mul_f32 v23, v23, v160
 v_mul_f32 v24, v24, v160
 v_mul_f32 v25, v25, v160
 v_mul_f32 v28, v28, v161
 v_mul_f32 v29, v29, v161
 v_mul_f32 v30, v30, v161
 v_mul_f32 v31, v31, v161
 v_mul_f32 v32, v32, v161
 v_mul_f32 v33, v33, v161
 v_mul_f32 v34, v34, v161
 buffer_load_dwordx4 a[56:59], v4, s[8:11], s67 offen offset:2048 sc1
 v_mul_f32 v35, v35, v161
 v_mul_f32 v36, v36, v161
 v_mul_f32 v37, v37, v161
 v_cvt_pk_bf16_f32 v40, v20, v21
 v_cvt_pk_bf16_f32 v41, v22, v23
 v_cvt_pk_bf16_f32 v44, v28, v29
 v_cvt_pk_bf16_f32 v45, v30, v31
 v_cvt_pk_bf16_f32 v46, v32, v33
 v_cvt_pk_bf16_f32 v47, v34, v35
 v_cvt_pk_bf16_f32 v48, v24, v25
 buffer_load_dwordx4 a[60:63], v4, s[8:11], s67 offen offset:3072 sc1
 v_cvt_pk_bf16_f32 v51, v24, v25
 v_cvt_pk_bf16_f32 v52, v36, v37
 v_cvt_pk_bf16_f32 v55, v36, v37
 v_mfma_f32_16x16x32_bf16 v[64:67], a[192:195], v[40:43], 0
 v_mfma_f32_16x16x32_bf16 v[68:71], a[196:199], v[40:43], 0
 v_mfma_f32_16x16x32_bf16 v[72:75], a[200:203], v[40:43], 0
 s_add_u32 s67, s67, 4096
 buffer_load_dwordx4 a[64:67], v4, s[8:11], s67 offen offset:0 sc1
 v_mfma_f32_16x16x32_bf16 v[76:79], a[204:207], v[40:43], 0
 v_mfma_f32_16x16x32_bf16 v[80:83], a[208:211], v[40:43], 0
 v_mfma_f32_16x16x32_bf16 v[84:87], a[212:215], v[40:43], 0
 v_mfma_f32_16x16x32_bf16 v[88:91], a[216:219], v[40:43], 0
 buffer_load_dwordx4 a[68:71], v4, s[8:11], s67 offen offset:1024 sc1
 v_mfma_f32_16x16x32_bf16 v[92:95], a[220:223], v[40:43], 0
 v_mfma_f32_16x16x32_bf16 v[96:99], a[192:195], v[44:47], 0
 v_mfma_f32_16x16x32_bf16 v[100:103], a[196:199], v[44:47], 0
 v_mfma_f32_16x16x32_bf16 v[104:107], a[200:203], v[44:47], 0
 buffer_load_dwordx4 a[72:75], v4, s[8:11], s67 offen offset:2048 sc1
 v_mfma_f32_16x16x32_bf16 v[108:111], a[204:207], v[44:47], 0
 v_mfma_f32_16x16x32_bf16 v[112:115], a[208:211], v[44:47], 0
 v_mfma_f32_16x16x32_bf16 v[116:119], a[212:215], v[44:47], 0
 v_mfma_f32_16x16x32_bf16 v[120:123], a[216:219], v[44:47], 0
 buffer_load_dwordx4 a[76:79], v4, s[8:11], s67 offen offset:3072 sc1
 v_mfma_f32_16x16x32_bf16 v[124:127], a[220:223], v[44:47], 0
 v_mfma_f32_16x16x16_bf16 v[64:67], a[240:241], v[48:49], v[64:67]
 v_mfma_f32_16x16x16_bf16 v[68:71], a[240:241], v[50:51], v[68:71]
 v_mfma_f32_16x16x16_bf16 v[72:75], a[242:243], v[48:49], v[72:75]
 s_add_u32 s67, s67, 4096
 buffer_load_dwordx4 a[80:83], v4, s[8:11], s67 offen offset:0 sc1
 v_mfma_f32_16x16x16_bf16 v[76:79], a[242:243], v[50:51], v[76:79]
 v_mfma_f32_16x16x16_bf16 v[80:83], a[244:245], v[48:49], v[80:83]
 v_mfma_f32_16x16x16_bf16 v[84:87], a[244:245], v[50:51], v[84:87]
 v_mfma_f32_16x16x16_bf16 v[88:91], a[246:247], v[48:49], v[88:91]
 buffer_load_dwordx4 a[84:87], v4, s[8:11], s67 offen offset:1024 sc1
 v_mfma_f32_16x16x16_bf16 v[92:95], a[246:247], v[50:51], v[92:95]
 v_mfma_f32_16x16x16_bf16 v[96:99], a[240:241], v[52:53], v[96:99]
 v_mfma_f32_16x16x16_bf16 v[100:103], a[240:241], v[54:55], v[100:103]
 v_mfma_f32_16x16x16_bf16 v[104:107], a[242:243], v[52:53], v[104:107]
 buffer_load_dwordx4 a[88:91], v4, s[8:11], s67 offen offset:2048 sc1
 v_mfma_f32_16x16x16_bf16 v[108:111], a[242:243], v[54:55], v[108:111]
 v_mfma_f32_16x16x16_bf16 v[112:115], a[244:245], v[52:53], v[112:115]
 v_mfma_f32_16x16x16_bf16 v[116:119], a[244:245], v[54:55], v[116:119]
 v_mfma_f32_16x16x16_bf16 v[120:123], a[246:247], v[52:53], v[120:123]
 buffer_load_dwordx4 a[92:95], v4, s[8:11], s67 offen offset:3072 sc1
 v_mfma_f32_16x16x16_bf16 v[124:127], a[246:247], v[54:55], v[124:127]
 s_branch L_a_e1
L_a_ww1:
 s_mov_b32 s66, 3
 v_mfma_f32_16x16x32_bf16 v[20:23], a[160:163], a[128:131], v[16:19]
 v_mfma_f32_16x16x32_bf16 v[24:27], a[224:227], a[128:131], 0
 v_mfma_f32_16x16x32_bf16 v[28:31], a[160:163], a[132:135], 0
 s_mul_i32 s67, s64, 786432
 s_add_u32 s67, s67, s72
 buffer_load_dwordx4 a[0:3], v4, s[8:11], s67 offen offset:0 sc1
 v_mfma_f32_16x16x32_bf16 v[32:35], a[164:167], a[132:135], v[16:19]
 v_mfma_f32_16x16x32_bf16 v[36:39], a[224:227], a[132:135], 0
 v_mfma_f32_16x16x32_bf16 v[20:23], a[168:171], a[136:139], v[20:23]
 buffer_load_dwordx4 a[4:7], v4, s[8:11], s67 offen offset:1024 sc1
 v_mfma_f32_16x16x32_bf16 v[24:27], a[228:231], a[136:139], v[24:27]
 v_mfma_f32_16x16x32_bf16 v[28:31], a[168:171], a[140:143], v[28:31]
 v_mfma_f32_16x16x32_bf16 v[32:35], a[172:175], a[140:143], v[32:35]
 buffer_load_dwordx4 a[8:11], v4, s[8:11], s67 offen offset:2048 sc1
 v_mfma_f32_16x16x32_bf16 v[36:39], a[228:231], a[140:143], v[36:39]
 v_mfma_f32_16x16x32_bf16 v[20:23], a[176:179], a[144:147], v[20:23]
 v_mfma_f32_16x16x32_bf16 v[24:27], a[232:235], a[144:147], v[24:27]
 buffer_load_dwordx4 a[12:15], v4, s[8:11], s67 offen offset:3072 sc1
 v_mfma_f32_16x16x32_bf16 v[28:31], a[176:179], a[148:151], v[28:31]
 v_mfma_f32_16x16x32_bf16 v[32:35], a[180:183], a[148:151], v[32:35]
 v_mfma_f32_16x16x32_bf16 v[36:39], a[232:235], a[148:151], v[36:39]
 s_add_u32 s67, s67, 4096
 buffer_load_dwordx4 a[16:19], v4, s[8:11], s67 offen offset:0 sc1
 v_mfma_f32_16x16x32_bf16 v[20:23], a[184:187], a[152:155], v[20:23]
 v_mfma_f32_16x16x32_bf16 v[24:27], a[236:239], a[152:155], v[24:27]
 v_mfma_f32_16x16x32_bf16 v[28:31], a[184:187], a[156:159], v[28:31]
 buffer_load_dwordx4 a[20:23], v4, s[8:11], s67 offen offset:1024 sc1
 v_mfma_f32_16x16x32_bf16 v[32:35], a[188:191], a[156:159], v[32:35]
 v_mfma_f32_16x16x32_bf16 v[36:39], a[236:239], a[156:159], v[36:39]
 s_nop 4
 v_max3_f32 v160, v20, v21, v22
 buffer_load_dwordx4 a[24:27], v4, s[8:11], s67 offen offset:2048 sc1
 v_max3_f32 v160, v160, v23, v24
 v_max_f32 v160, v160, v25
 v_max_f32 v161, v28, v29
 v_max3_f32 v161, v161, v30, v31
 v_max3_f32 v161, v161, v32, v33
 v_max3_f32 v161, v161, v34, v35
 v_max3_f32 v161, v161, v36, v37
 buffer_load_dwordx4 a[28:31], v4, s[8:11], s67 offen offset:3072 sc1
 v_mov_b32 v162, v160
 v_mov_b32 v163, v161
 s_nop 0
 v_permlane16_swap_b32 v160, v162
 v_permlane16_swap_b32 v161, v163
 v_max_f32 v160, v160, v162
 v_max_f32 v161, v161, v163
 s_add_u32 s67, s67, 4096
 buffer_load_dwordx4 a[32:35], v4, s[8:11], s67 offen offset:0 sc1
 v_mov_b32 v162, v160
 v_mov_b32 v163, v161
 s_nop 0
 v_permlane32_swap_b32 v160, v162
 v_permlane32_swap_b32 v161, v163
 v_max_f32 v160, v160, v162
 v_max_f32 v161, v161, v163
 buffer_load_dwordx4 a[36:39], v4, s[8:11], s67 offen offset:1024 sc1
 v_mul_f32 v160, s75, v160
 v_mul_f32 v161, s75, v161
 v_fma_f32 v20, v20, s75, -v160
 v_fma_f32 v21, v21, s75, -v160
 v_fma_f32 v22, v22, s75, -v160
 v_fma_f32 v23, v23, s75, -v160
 v_fma_f32 v24, v24, s75, -v160
 buffer_load_dwordx4 a[40:43], v4, s[8:11], s67 offen offset:2048 sc1
 v_fma_f32 v25, v25, s75, -v160
 v_fma_f32 v28, v28, s75, -v161
 v_fma_f32 v29, v29, s75, -v161
 v_fma_f32 v30, v30, s75, -v161
 v_fma_f32 v31, v31, s75, -v161
 v_fma_f32 v32, v32, s75, -v161
 v_fma_f32 v33, v33, s75, -v161
 buffer_load_dwordx4 a[44:47], v4, s[8:11], s67 offen offset:3072 sc1
 v_fma_f32 v34, v34, s75, -v161
 v_fma_f32 v35, v35, s75, -v161
 v_fma_f32 v36, v36, s75, -v161
 v_fma_f32 v37, v37, s75, -v161
 v_exp_f32 v20, v20
 v_exp_f32 v21, v21
 v_exp_f32 v22, v22
 s_add_u32 s67, s67, 4096
 buffer_load_dwordx4 a[48:51], v4, s[8:11], s67 offen offset:0 sc1
 v_exp_f32 v23, v23
 v_exp_f32 v24, v24
 v_exp_f32 v25, v25
 v_exp_f32 v28, v28
 v_exp_f32 v29, v29
 v_exp_f32 v30, v30
 v_exp_f32 v31, v31
 buffer_load_dwordx4 a[52:55], v4, s[8:11], s67 offen offset:1024 sc1
 v_exp_f32 v32, v32
 v_exp_f32 v33, v33
 v_exp_f32 v34, v34
 v_exp_f32 v35, v35
 v_exp_f32 v36, v36
 v_exp_f32 v37, v37
 v_add_f32 v160, v20, v21
 buffer_load_dwordx4 a[56:59], v4, s[8:11], s67 offen offset:2048 sc1
 v_add_f32 v160, v160, v22
 v_add_f32 v160, v160, v23
 v_add_f32 v160, v160, v24
 v_add_f32 v160, v160, v25
 v_add_f32 v161, v28, v29
 v_add_f32 v161, v161, v30
 s_waitcnt vmcnt(15)
 s_cmp_eq_u32 s79, s61
 s_cbranch_scc1 Lfa_87
 s_waitcnt lgkmcnt(0)
 s_mov_b32 s79, s61
 s_atomic_umax s79, s[8:9], s78
Lfa_87:
 v_add_f32 v161, v161, v31
 buffer_load_dwordx4 a[60:63], v4, s[8:11], s67 offen offset:3072 sc1
 v_add_f32 v161, v161, v32
 v_add_f32 v161, v161, v33
 v_add_f32 v161, v161, v34
 v_add_f32 v161, v161, v35
 v_add_f32 v161, v161, v36
 v_add_f32 v161, v161, v37
 v_mov_b32 v162, v160
 s_add_u32 s67, s67, 4096
 buffer_load_dwordx4 a[64:67], v4, s[8:11], s67 offen offset:0 sc1
 v_mov_b32 v163, v161
 s_nop 0
 v_permlane16_swap_b32 v160, v162
 v_permlane16_swap_b32 v161, v163
 v_add_f32 v160, v160, v162
 v_add_f32 v161, v161, v163
 v_mov_b32 v162, v160
 buffer_load_dwordx4 a[68:71], v4, s[8:11], s67 offen offset:1024 sc1
 v_mov_b32 v163, v161
 s_nop 0
 v_permlane32_swap_b32 v160, v162
 v_permlane32_swap_b32 v161, v163
 v_add_f32 v160, v160, v162
 v_add_f32 v161, v161, v163
 v_rcp_f32 v160, v160
 buffer_load_dwordx4 a[72:75], v4, s[8:11], s67 offen offset:2048 sc1
 v_rcp_f32 v161, v161
 v_mul_f32 v20, v20, v160
 v_mul_f32 v21, v21, v160
 v_mul_f32 v22, v22, v160
 v_mul_f32 v23, v23, v160
 v_mul_f32 v24, v24, v160
 v_mul_f32 v25, v25, v160
 buffer_load_dwordx4 a[76:79], v4, s[8:11], s67 offen offset:3072 sc1
 v_mul_f32 v28, v28, v161
 v_mul_f32 v29, v29, v161
 v_mul_f32 v30, v30, v161
 v_mul_f32 v31, v31, v161
 v_mul_f32 v32, v32, v161
 v_mul_f32 v33, v33, v161
 v_mul_f32 v34, v34, v161
 s_add_u32 s67, s67, 4096
 buffer_load_dwordx4 a[80:83], v4, s[8:11], s67 offen offset:0 sc1
 v_mul_f32 v35, v35, v161
 v_mul_f32 v36, v36, v161
 v_mul_f32 v37, v37, v161
 v_cvt_pk_bf16_f32 v40, v20, v21
 v_cvt_pk_bf16_f32 v41, v22, v23
 v_cvt_pk_bf16_f32 v44, v28, v29
 v_cvt_pk_bf16_f32 v45, v30, v31
 buffer_load_dwordx4 a[84:87], v4, s[8:11], s67 offen offset:1024 sc1
 v_cvt_pk_bf16_f32 v46, v32, v33
 v_cvt_pk_bf16_f32 v47, v34, v35
 v_cvt_pk_bf16_f32 v48, v24, v25
 v_cvt_pk_bf16_f32 v51, v24, v25
 v_cvt_pk_bf16_f32 v52, v36, v37
 v_cvt_pk_bf16_f32 v55, v36, v37
 v_mfma_f32_16x16x32_bf16 v[64:67], a[192:195], v[40:43], 0
 buffer_load_dwordx4 a[88:91], v4, s[8:11], s67 offen offset:2048 sc1
 v_mfma_f32_16x16x32_bf16 v[68:71], a[196:199], v[40:43], 0
 v_mfma_f32_16x16x32_bf16 v[72:75], a[200:203], v[40:43], 0
 v_mfma_f32_16x16x32_bf16 v[76:79], a[204:207], v[40:43], 0
 buffer_load_dwordx4 a[92:95], v4, s[8:11], s67 offen offset:3072 sc1
 v_mfma_f32_16x16x32_bf16 v[80:83], a[208:211], v[40:43], 0
 v_mfma_f32_16x16x32_bf16 v[84:87], a[212:215], v[40:43], 0
 v_mfma_f32_16x16x32_bf16 v[88:91], a[216:219], v[40:43], 0
 s_mul_i32 s68, s64, 131072
 s_add_u32 s68, s68, s73
 buffer_load_dwordx4 a[96:99], v5, s[8:11], s68 offen offset:0 sc1
 v_mfma_f32_16x16x32_bf16 v[92:95], a[220:223], v[40:43], 0
 v_mfma_f32_16x16x32_bf16 v[96:99], a[192:195], v[44:47], 0
 v_mfma_f32_16x16x32_bf16 v[100:103], a[196:199], v[44:47], 0
 buffer_load_dwordx4 a[100:103], v5, s[8:11], s68 offen offset:512 sc1
 v_mfma_f32_16x16x32_bf16 v[104:107], a[200:203], v[44:47], 0
 v_mfma_f32_16x16x32_bf16 v[108:111], a[204:207], v[44:47], 0
 v_mfma_f32_16x16x32_bf16 v[112:115], a[208:211], v[44:47], 0
 buffer_load_dwordx4 a[104:107], v5, s[8:11], s68 offen offset:1024 sc1
 v_mfma_f32_16x16x32_bf16 v[116:119], a[212:215], v[44:47], 0
 v_mfma_f32_16x16x32_bf16 v[120:123], a[216:219], v[44:47], 0
 v_mfma_f32_16x16x32_bf16 v[124:127], a[220:223], v[44:47], 0
 buffer_load_dwordx4 a[108:111], v5, s[8:11], s68 offen offset:1536 sc1
 v_mfma_f32_16x16x16_bf16 v[64:67], a[240:241], v[48:49], v[64:67]
 v_mfma_f32_16x16x16_bf16 v[68:71], a[240:241], v[50:51], v[68:71]
 v_mfma_f32_16x16x16_bf16 v[72:75], a[242:243], v[48:49], v[72:75]
 buffer_load_dwordx2 a[112:113], v6, s[8:11], s68 offen offset:2048 sc1
 v_mfma_f32_16x16x16_bf16 v[76:79], a[242:243], v[50:51], v[76:79]
 v_mfma_f32_16x16x16_bf16 v[80:83], a[244:245], v[48:49], v[80:83]
 v_mfma_f32_16x16x16_bf16 v[84:87], a[244:245], v[50:51], v[84:87]
 buffer_load_dwordx2 a[114:115], v6, s[8:11], s68 offen offset:2560 sc1
 v_mfma_f32_16x16x16_bf16 v[88:91], a[246:247], v[48:49], v[88:91]
 v_mfma_f32_16x16x16_bf16 v[92:95], a[246:247], v[50:51], v[92:95]
 v_mfma_f32_16x16x16_bf16 v[96:99], a[240:241], v[52:53], v[96:99]
 buffer_load_dwordx2 a[116:117], v6, s[8:11], s68 offen offset:3072 sc1
 v_mfma_f32_16x16x16_bf16 v[100:103], a[240:241], v[54:55], v[100:103]
 v_mfma_f32_16x16x16_bf16 v[104:107], a[242:243], v[52:53], v[104:107]
 v_mfma_f32_16x16x16_bf16 v[108:111], a[242:243], v[54:55], v[108:111]
 buffer_load_dwordx2 a[118:119], v6, s[8:11], s68 offen offset:3584 sc1
 v_mfma_f32_16x16x16_bf16 v[112:115], a[244:245], v[52:53], v[112:115]
 v_mfma_f32_16x16x16_bf16 v[116:119], a[244:245], v[54:55], v[116:119]
 v_mfma_f32_16x16x16_bf16 v[120:123], a[246:247], v[52:53], v[120:123]
 v_mfma_f32_16x16x16_bf16 v[124:127], a[246:247], v[54:55], v[124:127]
L_a_e1:
 buffer_load_dword v8, v7, s[8:11], 0 offen sc1
 v_cvt_pk_bf16_f32 v128, v64, v65
 v_cvt_pk_bf16_f32 v129, v66, v67
 v_cvt_pk_bf16_f32 v130, v68, v69
 v_cvt_pk_bf16_f32 v131, v70, v71
 v_cvt_pk_bf16_f32 v132, v72, v73
 v_cvt_pk_bf16_f32 v133, v74, v75
 v_cvt_pk_bf16_f32 v134, v76, v77
 v_cvt_pk_bf16_f32 v135, v78, v79
 v_cvt_pk_bf16_f32 v136, v80, v81
 v_cvt_pk_bf16_f32 v137, v82, v83
 v_cvt_pk_bf16_f32 v138, v84, v85
 v_cvt_pk_bf16_f32 v139, v86, v87
 v_cvt_pk_bf16_f32 v140, v88, v89
 v_cvt_pk_bf16_f32 v141, v90, v91
 v_cvt_pk_bf16_f32 v142, v92, v93
 v_cvt_pk_bf16_f32 v143, v94, v95
 v_cvt_pk_bf16_f32 v144, v96, v97
 v_cvt_pk_bf16_f32 v145, v98, v99
 v_cvt_pk_bf16_f32 v146, v100, v101
 v_cvt_pk_bf16_f32 v147, v102, v103
 v_cvt_pk_bf16_f32 v148, v104, v105
 v_cvt_pk_bf16_f32 v149, v106, v107
 v_cvt_pk_bf16_f32 v150, v108, v109
 v_cvt_pk_bf16_f32 v151, v110, v111
 v_cvt_pk_bf16_f32 v152, v112, v113
 v_cvt_pk_bf16_f32 v153, v114, v115
 v_cvt_pk_bf16_f32 v154, v116, v117
 v_cvt_pk_bf16_f32 v155, v118, v119
 v_cvt_pk_bf16_f32 v156, v120, v121
 v_cvt_pk_bf16_f32 v157, v122, v123
 v_cvt_pk_bf16_f32 v158, v124, v125
 v_cvt_pk_bf16_f32 v159, v126, v127
 s_mul_i32 s67, s61, 262144
 s_add_u32 s67, s67, s74
 buffer_store_dwordx4 v[128:131], v4, s[8:11], s67 offen offset:0 sc1
 buffer_store_dwordx4 v[132:135], v4, s[8:11], s67 offen offset:1024 sc1
 buffer_store_dwordx4 v[136:139], v4, s[8:11], s67 offen offset:2048 sc1
 buffer_store_dwordx4 v[140:143], v4, s[8:11], s67 offen offset:3072 sc1
 s_add_u32 s67, s67, 32768
 buffer_store_dwordx4 v[144:147], v4, s[8:11], s67 offen offset:0 sc1
 buffer_store_dwordx4 v[148:151], v4, s[8:11], s67 offen offset:1024 sc1
 buffer_store_dwordx4 v[152:155], v4, s[8:11], s67 offen offset:2048 sc1
 buffer_store_dwordx4 v[156:159], v4, s[8:11], s67 offen offset:3072 sc1
 s_mov_b32 s61, s64
 s_waitcnt vmcnt(8)
 v_cmp_ge_u32 vcc, s61, v8
 s_cmp_eq_u32 s66, 3
 s_cbranch_scc1 L_a_top20
 s_cmp_eq_u32 s66, 0
 s_cbranch_scc1 L_a_idle1
 s_cmp_lg_u32 vcc_hi, 0
 s_cbranch_scc1 L_a_idle1
 s_mul_i32 s68, s61, 131072
 s_add_u32 s68, s68, s73
 buffer_load_dwordx4 a[96:99], v5, s[8:11], s68 offen offset:0 sc1
 buffer_load_dwordx4 a[100:103], v5, s[8:11], s68 offen offset:512 sc1
 buffer_load_dwordx4 a[104:107], v5, s[8:11], s68 offen offset:1024 sc1
 buffer_load_dwordx4 a[108:111], v5, s[8:11], s68 offen offset:1536 sc1
 buffer_load_dwordx2 a[112:113], v6, s[8:11], s68 offen offset:2048 sc1
 buffer_load_dwordx2 a[114:115], v6, s[8:11], s68 offen offset:2560 sc1
 buffer_load_dwordx2 a[116:117], v6, s[8:11], s68 offen offset:3072 sc1
 buffer_load_dwordx2 a[118:119], v6, s[8:11], s68 offen offset:3584 sc1
 s_branch L_a_topf0
L_a_idle1:
 buffer_load_dword v8, v7, s[8:11], 0 offen sc1
 s_waitcnt vmcnt(0)
 s_cmp_eq_u32 s79, s61
 s_cbranch_scc1 Lfa_88
 s_waitcnt lgkmcnt(0)
 s_mov_b32 s79, s61
 s_atomic_umax s79, s[8:9], s78
Lfa_88:
 s_cmp_ge_u32 s61, 64
 s_cbranch_scc1 L_a_done
 s_mov_b32 s62, 0
 s_branch L_a_chk0
L_a_done:
 s_waitcnt vmcnt(0) lgkmcnt(0)
 s_cmp_lg_u32 s80, 1000
 s_cbranch_scc1 L_a_done2
 s_mov_b32 s80, 0
 s_mov_b32 s78, s81
 s_mov_b32 s79, 46
 s_mov_b32 s61, 46
 s_mov_b32 s66, 0
 s_add_u32 s72, s72, 50331648
 s_add_u32 s73, s73, 8388608
 s_add_u32 s74, s74, 16777216
 v_add_u32 v7, 4096, v7
 s_branch L_a_wait0
L_a_done2:
 s_endpgm
L_red_b:
 s_cmp_lg_u32 s7, 0
 s_cbranch_scc1 Lln_89
 s_waitcnt vmcnt(3)
 v_lshlrev_b32 v52, 16, v40
 v_and_b32 v53, 0xffff0000, v40
 v_lshlrev_b32 v54, 16, v41
 v_and_b32 v55, 0xffff0000, v41
 v_lshlrev_b32 v56, 16, v42
 v_and_b32 v57, 0xffff0000, v42
 v_lshlrev_b32 v58, 16, v43
 v_and_b32 v59, 0xffff0000, v43
 v_lshlrev_b32 v60, 16, v44
 v_and_b32 v61, 0xffff0000, v44
 v_lshlrev_b32 v62, 16, v45
 v_and_b32 v63, 0xffff0000, v45
 v_lshlrev_b32 v64, 16, v46
 v_and_b32 v65, 0xffff0000, v46
 v_lshlrev_b32 v66, 16, v47
 v_and_b32 v67, 0xffff0000, v47
 v_lshlrev_b32 v68, 16, v48
 v_and_b32 v69, 0xffff0000, v48
 v_lshlrev_b32 v70, 16, v49
 v_and_b32 v71, 0xffff0000, v49
 v_lshlrev_b32 v72, 16, v50
 v_and_b32 v73, 0xffff0000, v50
 v_lshlrev_b32 v74, 16, v51
 v_and_b32 v75, 0xffff0000, v51
 v_pk_add_f32 v[20:21], v[52:53], v[54:55]
 v_pk_add_f32 v[20:21], v[20:21], v[56:57]
 v_pk_add_f32 v[20:21], v[20:21], v[58:59]
 v_pk_add_f32 v[20:21], v[20:21], v[60:61]
 v_pk_add_f32 v[20:21], v[20:21], v[62:63]
 v_pk_add_f32 v[20:21], v[20:21], v[64:65]
 v_pk_add_f32 v[20:21], v[20:21], v[66:67]
 v_pk_add_f32 v[20:21], v[20:21], v[68:69]
 v_pk_add_f32 v[20:21], v[20:21], v[70:71]
 v_pk_add_f32 v[20:21], v[20:21], v[72:73]
 v_pk_add_f32 v[20:21], v[20:21], v[74:75]
 v_add_f32 v20, v20, v21
 s_nop 1
 v_add_f32_dpp v20, v20, v20 quad_perm:[1,0,3,2] row_mask:0xf bank_mask:0xf
 s_nop 1
 v_add_f32_dpp v20, v20, v20 quad_perm:[2,3,0,1] row_mask:0xf bank_mask:0xf
 s_nop 1
 v_add_f32_dpp v20, v20, v20 row_half_mirror row_mask:0xf bank_mask:0xf
 s_nop 1
 v_add_f32_dpp v20, v20, v20 row_mirror row_mask:0xf bank_mask:0xf
 v_mov_b32 v21, v20
 s_nop 1
 v_permlane16_swap_b32 v20, v21
 v_add_f32 v20, v20, v21
 v_mul_f32 v20, v78, v20
 v_pk_add_f32 v[52:53], v[52:53], v[20:21] op_sel_hi:[1,0]
 v_pk_add_f32 v[54:55], v[54:55], v[20:21] op_sel_hi:[1,0]
 v_pk_add_f32 v[56:57], v[56:57], v[20:21] op_sel_hi:[1,0]
 v_pk_add_f32 v[58:59], v[58:59], v[20:21] op_sel_hi:[1,0]
 v_pk_add_f32 v[60:61], v[60:61], v[20:21] op_sel_hi:[1,0]
 v_pk_add_f32 v[62:63], v[62:63], v[20:21] op_sel_hi:[1,0]
 v_pk_add_f32 v[64:65], v[64:65], v[20:21] op_sel_hi:[1,0]
 v_pk_add_f32 v[66:67], v[66:67], v[20:21] op_sel_hi:[1,0]
 v_pk_add_f32 v[68:69], v[68:69], v[20:21] op_sel_hi:[1,0]
 v_pk_add_f32 v[70:71], v[70:71], v[20:21] op_sel_hi:[1,0]
 v_pk_add_f32 v[72:73], v[72:73], v[20:21] op_sel_hi:[1,0]
 v_pk_add_f32 v[74:75], v[74:75], v[20:21] op_sel_hi:[1,0]
 v_pk_mul_f32 v[22:23], v[52:53], v[52:53]
 v_pk_fma_f32 v[22:23], v[54:55], v[54:55], v[22:23]
 v_pk_fma_f32 v[22:23], v[56:57], v[56:57], v[22:23]
 v_pk_fma_f32 v[22:23], v[58:59], v[58:59], v[22:23]
 v_pk_fma_f32 v[22:23], v[60:61], v[60:61], v[22:23]
 v_pk_fma_f32 v[22:23], v[62:63], v[62:63], v[22:23]
 v_pk_fma_f32 v[22:23], v[64:65], v[64:65], v[22:23]
 v_pk_fma_f32 v[22:23], v[66:67], v[66:67], v[22:23]
 v_pk_fma_f32 v[22:23], v[68:69], v[68:69], v[22:23]
 v_pk_fma_f32 v[22:23], v[70:71], v[70:71], v[22:23]
 v_pk_fma_f32 v[22:23], v[72:73], v[72:73], v[22:23]
 v_pk_fma_f32 v[22:23], v[74:75], v[74:75], v[22:23]
 v_add_f32 v22, v22, v23
 s_nop 1
 v_add_f32_dpp v22, v22, v22 quad_perm:[1,0,3,2] row_mask:0xf bank_mask:0xf
 s_nop 1
 v_add_f32_dpp v22, v22, v22 quad_perm:[2,3,0,1] row_mask:0xf bank_mask:0xf
 s_nop 1
 v_add_f32_dpp v22, v22, v22 row_half_mirror row_mask:0xf bank_mask:0xf
 s_nop 1
 v_add_f32_dpp v22, v22, v22 row_mirror row_mask:0xf bank_mask:0xf
 v_mov_b32 v23, v22
 s_nop 1
 v_permlane16_swap_b32 v22, v23
 v_add_f32 v22, v22, v23
 v_mov_b32 v23, 0x3727c5ac
 v_fmac_f32 v23, 0x3ae38e39, v22
 v_rsq_f32 v22, v23
 v_sub_f32 v20, 0, v20
 v_mul_f32 v21, v23, v22
 v_lshrrev_b32 v76, 2, v0
 v_and_b32 v78, 31, v0
 v_cmp_eq_u32 vcc, 0, v78
 v_mov_b32 v78, 2147483632
 s_lshl_b32 s63, s2, 6
 v_cndmask_b32 v76, v78, v76, vcc
 s_add_u32 s63, s63, 12582912
 buffer_store_dwordx2 v[20:21], v76, s[8:11], s63 offen sc1
 s_add_u32 s63, s3, 3145728
 v_pk_mul_f32 v[52:53], v[52:53], v[22:23] op_sel_hi:[1,0]
 v_pk_mul_f32 v[54:55], v[54:55], v[22:23] op_sel_hi:[1,0]
 v_pk_mul_f32 v[56:57], v[56:57], v[22:23] op_sel_hi:[1,0]
 v_pk_mul_f32 v[58:59], v[58:59], v[22:23] op_sel_hi:[1,0]
 v_pk_mul_f32 v[60:61], v[60:61], v[22:23] op_sel_hi:[1,0]
 v_pk_mul_f32 v[62:63], v[62:63], v[22:23] op_sel_hi:[1,0]
 v_pk_mul_f32 v[64:65], v[64:65], v[22:23] op_sel_hi:[1,0]
 v_pk_mul_f32 v[66:67], v[66:67], v[22:23] op_sel_hi:[1,0]
 v_pk_mul_f32 v[68:69], v[68:69], v[22:23] op_sel_hi:[1,0]
 v_pk_mul_f32 v[70:71], v[70:71], v[22:23] op_sel_hi:[1,0]
 v_pk_mul_f32 v[72:73], v[72:73], v[22:23] op_sel_hi:[1,0]
 v_pk_mul_f32 v[74:75], v[74:75], v[22:23] op_sel_hi:[1,0]
 v_cvt_pk_bf16_f32 v40, v52, v53
 v_cvt_pk_bf16_f32 v41, v54, v55
 v_cvt_pk_bf16_f32 v42, v56, v57
 v_cvt_pk_bf16_f32 v43, v58, v59
 v_cvt_pk_bf16_f32 v44, v60, v61
 v_cvt_pk_bf16_f32 v45, v62, v63
 v_cvt_pk_bf16_f32 v46, v64, v65
 v_cvt_pk_bf16_f32 v47, v66, v67
 v_cvt_pk_bf16_f32 v48, v68, v69
 v_cvt_pk_bf16_f32 v49, v70, v71
 v_cvt_pk_bf16_f32 v50, v72, v73
 v_cvt_pk_bf16_f32 v51, v74, v75
 buffer_store_dwordx4 v[40:43], v77, s[8:11], s63 offen offset:0 sc1
 buffer_store_dwordx4 v[44:47], v77, s[8:11], s63 offen offset:384 sc1
 buffer_store_dwordx4 v[48:51], v77, s[8:11], s63 offen offset:768 sc1
Lln_89:
 s_waitcnt vmcnt(0)
 s_cmp_lg_u32 s7, 0
 s_cbranch_scc1 Lar_90
 s_or_b32 s63, s6, 0x80
 v_mov_b32 v20, s63
 s_barrier
 buffer_store_byte v20, v79, s[20:23], 0 offen sc1
Lar_90:
 s_cmp_eq_u32 s7, 1
 s_cbranch_scc1 Lvalok_93
 v_mbcnt_lo_u32_b32 v1, -1, 0
 v_mbcnt_hi_u32_b32 v1, -1, v1
 v_lshlrev_b32 v1, 2, v1
 s_mov_b32 s62, 0
 s_mov_b32 s63, 0x80808080
 s_cmp_lg_u32 s58, 0
 s_cbranch_scc1 Lvald_92
Lval_91:
 buffer_load_dword v2, v1, s[20:23], 0 offen sc1
 s_waitcnt vmcnt(0)
 v_and_b32 v3, s63, v2
 v_cmp_ne_u32 vcc, s63, v3
 s_cbranch_vccz Lvald_92
 s_add_u32 s62, s62, 1
 s_cmp_lt_u32 s62, 400000
 s_cbranch_scc1 Lval_91
Lvald_92:
 s_barrier
 buffer_load_dword v2, v1, s[20:23], 0 offen sc1
 s_waitcnt vmcnt(0)
 v_and_b32 v3, s63, v2
 v_cmp_ne_u32 vcc, s63, v3
 s_mov_b32 s63, 1
 s_cbranch_vccnz L_abort_b
 v_lshlrev_b32 v3, v2, 1
 v_lshrrev_b32 v4, 8, v2
 v_lshl_or_b32 v3, 1, v4, v3
 v_lshrrev_b32 v4, 16, v2
 v_lshl_or_b32 v3, 1, v4, v3
 v_lshrrev_b32 v4, 24, v2
 v_lshl_or_b32 v3, 1, v4, v3
 s_nop 1
 v_or_b32_dpp v3, v3, v3 quad_perm:[1,0,3,2] row_mask:0xf bank_mask:0xf
 v_cmp_ne_u32 vcc, 255, v3
 s_cbranch_vccnz L_rerank_b
 s_mov_b32 s7, 1
Lvalok_93:
 s_sub_u32 s63, s57, 24
 s_lshr_b32 s71, s63, 2
 s_and_b32 s70, s63, 3
 s_mul_i32 s72, s70, 9216
 s_lshr_b32 s63, s70, 1
 s_lshl_b32 s73, s63, 10
 s_lshl_b32 s74, s63, 9
 s_add_u32 s74, s74, 2048
 v_mbcnt_lo_u32_b32 v8, -1, 0
 v_mbcnt_hi_u32_b32 v8, -1, v8
 v_and_b32 v9, 7, v8
 v_bfe_u32 v10, v8, 3, 1
 v_lshrrev_b32 v11, 4, v8
 v_mul_u32_u24 v1, 36864, v11
 v_lshl_add_u32 v1, v10, 8, v1
 v_lshl_add_u32 v1, v9, 4, v1
 s_mul_i32 s63, s58, 9216
 s_and_b32 s64, s70, 1
 s_lshl_b32 s64, s64, 7
 s_add_u32 s63, s63, s64
 v_add_u32 v1, s63, v1
 v_lshrrev_b32 v22, 5, v8
 v_lshl_add_u32 v23, v22, 1, v10
 s_mul_i32 s63, s58, 18
 v_add_u32 v23, s63, v23
 v_mul_u32_u24 v32, 1152, v9
 v_and_b32 v33, 1, v11
 v_lshl_add_u32 v32, v33, 3, v32
 v_cmp_eq_u32 vcc, 0, v22
 v_mov_b32 v34, 2147483632
 v_mov_b32 v35, 12288
 v_mov_b64 v[40:41], 0
 ds_write_b64 v35, v[40:41] offset:49152
 v_add_u32 v38, 0x10000, v35
 ds_write_b64 v38, v[40:41] offset:49152
 v_cndmask_b32 v21, 0, 1.0, vcc
 s_and_b32 s63, s70, 1
 s_lshl_b32 s63, s63, 2
 v_lshrrev_b32 v36, 1, v9
 v_add_u32 v36, s63, v36
 v_add_u32 v37, 0, v23
 v_xor_b32 v37, v37, v36
 v_lshl_add_u32 v12, v37, 4, v32
 v_add_u32 v37, 4, v23
 v_xor_b32 v37, v37, v36
 v_lshl_add_u32 v13, v37, 4, v32
 v_add_u32 v37, 8, v23
 v_xor_b32 v37, v37, v36
 v_lshl_add_u32 v14, v37, 4, v32
 v_add_u32 v37, 12, v23
 v_xor_b32 v37, v37, v36
 v_lshl_add_u32 v15, v37, 4, v32
 v_add_u32 v37, 16, v23
 v_xor_b32 v37, v37, v36
 v_lshl_add_u32 v16, v37, 4, v32
 v_cndmask_b32 v16, v35, v16, vcc
 s_mul_i32 s63, s58, 2304
 s_add_u32 s75, s63, 49152
 v_lshl_add_u32 v17, v8, 4, s63
 v_cmp_gt_u32 vcc, 16, v8
 v_lshlrev_b32 v20, 5, v9
 v_add_u32 v20, 32768, v20
 v_cndmask_b32 v18, v34, v17, vcc
 s_and_b32 s63, s70, 1
 s_lshl_b32 s63, s63, 2
 s_add_u32 s63, s63, s58
 s_lshl_b32 s63, s63, 4
 v_xor_b32 v3, s63, v17
 s_lshl_b32 s63, s70, 6
 v_lshl_add_u32 v4, v9, 3, s63
 s_cmp_eq_u32 s58, 0
 s_cselect_b32 s63, 8, 0
 v_cmp_gt_u32 vcc, s63, v8
 s_nop 1
 v_cndmask_b32 v5, v34, v4, vcc
 s_lshl_b32 s63, s58, 3
 v_add_u32 v19, s63, v20
 v_and_b32 v33, 1, v8
 v_cmp_eq_u32 vcc, 0, v33
 v_mov_b32 v34, 0x3f80
 v_mov_b32 v35, 0x3f800000
 v_cndmask_b32 v34, v35, v34, vcc
 v_bfe_u32 v33, v8, 1, 3
 v_cmp_eq_u32 vcc, 0, v33
 s_nop 1
 v_cndmask_b32 v24, 0, v34, vcc
 v_cmp_eq_u32 vcc, 1, v33
 s_nop 1
 v_cndmask_b32 v25, 0, v34, vcc
 v_cmp_eq_u32 vcc, 2, v33
 s_nop 1
 v_cndmask_b32 v26, 0, v34, vcc
 v_cmp_eq_u32 vcc, 3, v33
 s_nop 1
 v_cndmask_b32 v27, 0, v34, vcc
 v_cmp_eq_u32 vcc, 4, v33
 s_nop 1
 v_cndmask_b32 v28, 0, v34, vcc
 v_cmp_eq_u32 vcc, 5, v33
 s_nop 1
 v_cndmask_b32 v29, 0, v34, vcc
 v_cmp_eq_u32 vcc, 6, v33
 s_nop 1
 v_cndmask_b32 v30, 0, v34, vcc
 v_cmp_eq_u32 vcc, 7, v33
 s_nop 1
 v_cndmask_b32 v31, 0, v34, vcc
 v_mov_b32 v11, 36864
 v_mov_b32 v23, 1
 ds_write_b32 v11, v40
 s_waitcnt lgkmcnt(0)
 s_barrier
 s_lshl_b32 s80, s60, 1
 s_add_u32 s80, s80, s71
 s_cmp_eq_u32 s80, 1
 s_cbranch_scc1 L_red_1
 s_cmp_eq_u32 s80, 2
 s_cbranch_scc1 L_red_2
 s_cmp_eq_u32 s80, 3
 s_cbranch_scc1 L_red_3
 v_mbcnt_lo_u32_b32 v22, -1, 0
 v_mbcnt_hi_u32_b32 v22, -1, v22
 v_min_u32 v22, 23, v22
 v_lshlrev_b32 v22, 2, v22
 v_add_u32 v22, 1024, v22
 s_lshl_b32 s63, s70, 2
 s_add_u32 s64, s63, 0
 v_mov_b32 v162, s64
 s_add_u32 s64, s63, 256
 v_mov_b32 v6, s64
 s_mov_b32 s83, s64
 s_add_u32 s63, s63, 512
 s_cmp_eq_u32 s58, 0
 s_cselect_b32 s63, s63, 2147483632
 v_mbcnt_lo_u32_b32 v9, -1, 0
 v_mbcnt_hi_u32_b32 v9, -1, v9
 v_cmp_eq_u32 vcc, 0, v9
 v_mov_b32 v8, s63
 v_mov_b32 v9, 2147483632
 v_cndmask_b32 v9, v9, v8, vcc
 s_mov_b32 s78, 0
 s_mov_b32 s77, 0
 s_mov_b32 s61, 0
 s_mov_b32 s65, 1
 s_mov_b32 s66, 0
Lpt_94:
 s_mul_i32 s67, s66, 128
 s_lshr_b32 s67, s67, 9
 s_mul_i32 s67, s67, 4
 s_sub_u32 s67, s66, s67
 s_mul_i32 s67, s67, 294912
 s_add_u32 s67, s67, 209715200
 s_add_u32 s68, s67, s74
 s_add_u32 s67, s67, s73
 s_add_u32 s69, s67, 0
 buffer_load_dwordx4 v[32:35], v1, s[8:11], s69 offen offset:0 sc1
 s_add_u32 s69, s67, 0
 buffer_load_dwordx4 v[36:39], v1, s[8:11], s69 offen offset:512 sc1
 s_add_u32 s69, s68, 0
 buffer_load_dwordx4 v[40:43], v1, s[8:11], s69 offen offset:0 sc1
 s_add_u32 s69, s67, 3072
 buffer_load_dwordx4 v[44:47], v1, s[8:11], s69 offen offset:0 sc1
 s_add_u32 s69, s67, 3072
 buffer_load_dwordx4 v[48:51], v1, s[8:11], s69 offen offset:512 sc1
 s_add_u32 s69, s68, 3072
 buffer_load_dwordx4 v[52:55], v1, s[8:11], s69 offen offset:0 sc1
 s_add_u32 s69, s67, 6144
 buffer_load_dwordx4 v[56:59], v1, s[8:11], s69 offen offset:0 sc1
 s_add_u32 s69, s67, 6144
 buffer_load_dwordx4 v[60:63], v1, s[8:11], s69 offen offset:512 sc1
 s_add_u32 s69, s68, 6144
 buffer_load_dwordx4 v[64:67], v1, s[8:11], s69 offen offset:0 sc1
 s_add_u32 s66, s66, 1
 s_cmp_lt_u32 s66, 4
 s_cbranch_scc1 Lpt_94
 s_mov_b32 s66, 0
 s_mul_i32 s67, s61, 36864
 s_add_u32 s67, s67, s72
 s_add_u32 s67, s67, 3145728
 s_mov_b32 m0, s75
 s_xor_b32 s75, s75, 0x10000
 buffer_load_dwordx4 v17, s[8:11], s67 offen sc1 lds
 buffer_load_dwordx4 v17, s[8:11], s67 offen offset:1024 sc1 lds
 s_mov_b64 exec, 0xffff
 buffer_load_dwordx4 v17, s[8:11], s67 offen offset:2048 sc1 lds
 s_mov_b64 exec, -1
 s_lshl_b32 s67, s61, 8
 s_add_u32 s67, s67, 12582912
 buffer_load_dwordx2 v[114:115], v4, s[8:11], s67 offen sc1
 s_waitcnt vmcnt(0)
 s_barrier
 v_mov_b64 v[164:165], v[114:115]
 s_mul_i32 s67, s61, 36864
 s_add_u32 s67, s67, s72
 s_add_u32 s67, s67, 3182592
 s_mov_b32 m0, s75
 s_xor_b32 s75, s75, 0x10000
 buffer_load_dwordx4 v17, s[8:11], s67 offen sc1 lds
 buffer_load_dwordx4 v17, s[8:11], s67 offen offset:1024 sc1 lds
 s_mov_b64 exec, 0xffff
 buffer_load_dwordx4 v17, s[8:11], s67 offen offset:2048 sc1 lds
 s_mov_b64 exec, -1
 s_lshl_b32 s67, s61, 8
 s_add_u32 s67, s67, 12583168
 buffer_load_dwordx2 v[114:115], v4, s[8:11], s67 offen sc1
 v_add_u32 v148, s77, v12
 v_add_u32 v149, s77, v13
 v_add_u32 v150, s77, v14
 v_add_u32 v151, s77, v15
 v_add_u32 v152, s77, v16
 s_xor_b32 s77, s77, 0x10000
 ds_read_b64 v[104:105], v148 offset:49152
 ds_read_b64 v[106:107], v149 offset:49152
 ds_read_b64 v[108:109], v150 offset:49152
 ds_read_b64 v[110:111], v151 offset:49152
 ds_read_b64 v[112:113], v152 offset:49152
 s_waitcnt lgkmcnt(4)
 v_lshlrev_b32 v116, 16, v104
 v_and_b32 v117, 0xffff0000, v104
 v_pk_mul_f32 v[116:117], v[116:117], v[164:165] op_sel:[0,1] op_sel_hi:[1,1]
 v_lshlrev_b32 v118, 16, v105
 v_and_b32 v119, 0xffff0000, v105
 v_pk_mul_f32 v[118:119], v[118:119], v[164:165] op_sel:[0,1] op_sel_hi:[1,1]
 s_waitcnt lgkmcnt(3)
 v_lshlrev_b32 v120, 16, v106
 v_and_b32 v121, 0xffff0000, v106
 v_pk_mul_f32 v[120:121], v[120:121], v[164:165] op_sel:[0,1] op_sel_hi:[1,1]
 v_lshlrev_b32 v122, 16, v107
 v_and_b32 v123, 0xffff0000, v107
 v_pk_mul_f32 v[122:123], v[122:123], v[164:165] op_sel:[0,1] op_sel_hi:[1,1]
 s_waitcnt lgkmcnt(2)
 v_lshlrev_b32 v124, 16, v108
 v_and_b32 v125, 0xffff0000, v108
 v_pk_mul_f32 v[124:125], v[124:125], v[164:165] op_sel:[0,1] op_sel_hi:[1,1]
 v_lshlrev_b32 v126, 16, v109
 v_and_b32 v127, 0xffff0000, v109
 v_pk_mul_f32 v[126:127], v[126:127], v[164:165] op_sel:[0,1] op_sel_hi:[1,1]
 s_waitcnt lgkmcnt(1)
 v_lshlrev_b32 v128, 16, v110
 v_and_b32 v129, 0xffff0000, v110
 v_pk_mul_f32 v[128:129], v[128:129], v[164:165] op_sel:[0,1] op_sel_hi:[1,1]
 v_lshlrev_b32 v130, 16, v111
 v_and_b32 v131, 0xffff0000, v111
 v_pk_mul_f32 v[130:131], v[130:131], v[164:165] op_sel:[0,1] op_sel_hi:[1,1]
 s_waitcnt lgkmcnt(0)
 v_lshlrev_b32 v132, 16, v112
 v_and_b32 v133, 0xffff0000, v112
 v_pk_mul_f32 v[132:133], v[132:133], v[164:165] op_sel:[0,1] op_sel_hi:[1,1]
 v_lshlrev_b32 v134, 16, v113
 v_and_b32 v135, 0xffff0000, v113
 v_pk_mul_f32 v[134:135], v[134:135], v[164:165] op_sel:[0,1] op_sel_hi:[1,1]
 v_mov_b64 v[148:149], 0
 v_mov_b64 v[150:151], 0
L_r10_spin:
 s_mov_b32 s62, 0
Lspin_95:
 buffer_load_dword v10, v22, s[8:11], 0 offen sc1
 s_waitcnt vmcnt(0)
 v_cmp_gt_u32 vcc, s65, v10
 s_cbranch_vccz Lspind_96
 s_add_u32 s62, s62, 1
 s_cmp_lt_u32 s62, 400000
 s_cbranch_scc1 Lspin_95
 s_mov_b32 s63, 10
 s_branch L_abort_b
Lspind_96:
L_r10_ld:
 s_mul_i32 s67, s65, 128
 s_lshr_b32 s67, s67, 9
 s_mul_i32 s67, s67, 4
 s_sub_u32 s67, s65, s67
 s_mul_i32 s67, s67, 294912
 s_add_u32 s67, s67, 209715200
 s_add_u32 s68, s67, s74
 s_add_u32 s67, s67, s73
 s_add_u32 s69, s67, 0
 buffer_load_dwordx4 v[32:35], v1, s[8:11], s69 offen offset:0 sc1
 s_add_u32 s69, s67, 0
 buffer_load_dwordx4 v[36:39], v1, s[8:11], s69 offen offset:512 sc1
 s_add_u32 s69, s68, 0
 buffer_load_dwordx4 v[40:43], v1, s[8:11], s69 offen offset:0 sc1
 s_add_u32 s69, s67, 3072
 buffer_load_dwordx4 v[44:47], v1, s[8:11], s69 offen offset:0 sc1
 s_add_u32 s69, s67, 3072
 buffer_load_dwordx4 v[48:51], v1, s[8:11], s69 offen offset:512 sc1
 s_add_u32 s69, s68, 3072
 buffer_load_dwordx4 v[52:55], v1, s[8:11], s69 offen offset:0 sc1
 s_cmp_eq_u32 s66, 0
 s_cbranch_scc1 Lnf_97
 s_waitcnt vmcnt(10)
 s_mov_b64 exec, 1
 ds_add_rtn_u32 v7, v11, v23
 s_waitcnt lgkmcnt(0)
 v_readfirstlane_b32 s63, v7
 v_mov_b32 v7, s61
 s_and_b32 s63, s63, 3
 s_cmp_lg_u32 s63, 3
 s_cbranch_scc1 Lf_98
 s_mov_b32 s85, s61
 s_atomic_umax s85, s[8:9], s83
Lf_98:
 s_mov_b64 exec, -1
Lnf_97:
 s_add_u32 s69, s67, 6144
 buffer_load_dwordx4 v[56:59], v1, s[8:11], s69 offen offset:0 sc1
 s_waitcnt vmcnt(6)
 v_mfma_f32_16x16x32_bf16 v[116:119], v[24:27], v[32:35], v[116:119]
 s_add_u32 s69, s67, 6144
 buffer_load_dwordx4 v[60:63], v1, s[8:11], s69 offen offset:512 sc1
 buffer_load_dword v10, v22, s[8:11], 0 offen sc1
 s_waitcnt vmcnt(7)
 v_mfma_f32_16x16x32_bf16 v[116:119], v[28:31], v[36:39], v[116:119]
 s_add_u32 s69, s68, 6144
 buffer_load_dwordx4 v[64:67], v1, s[8:11], s69 offen offset:0 sc1
 s_waitcnt vmcnt(7)
 v_mfma_f32_16x16x32_bf16 v[120:123], v[24:27], v[40:43], v[120:123]
 s_waitcnt vmcnt(6)
 v_mfma_f32_16x16x32_bf16 v[120:123], v[28:31], v[44:47], v[120:123]
 s_waitcnt vmcnt(5)
 v_mfma_f32_16x16x32_bf16 v[124:127], v[24:27], v[48:51], v[124:127]
 s_waitcnt vmcnt(4)
 v_mfma_f32_16x16x32_bf16 v[124:127], v[28:31], v[52:55], v[124:127]
 v_pk_add_f32 v[148:149], v[148:149], v[116:117]
 v_pk_fma_f32 v[150:151], v[116:117], v[116:117], v[150:151]
 v_pk_add_f32 v[148:149], v[148:149], v[118:119]
 v_pk_fma_f32 v[150:151], v[118:119], v[118:119], v[150:151]
 s_waitcnt vmcnt(3)
 v_mfma_f32_16x16x32_bf16 v[128:131], v[24:27], v[56:59], v[128:131]
 s_waitcnt vmcnt(2)
 v_mfma_f32_16x16x32_bf16 v[128:131], v[28:31], v[60:63], v[128:131]
 v_pk_add_f32 v[148:149], v[148:149], v[120:121]
 v_pk_fma_f32 v[150:151], v[120:121], v[120:121], v[150:151]
 v_pk_add_f32 v[148:149], v[148:149], v[122:123]
 v_pk_fma_f32 v[150:151], v[122:123], v[122:123], v[150:151]
 s_waitcnt vmcnt(0)
 v_mfma_f32_16x16x32_bf16 v[132:135], v[24:27], v[64:67], v[132:135]
 s_nop 1
 v_pk_add_f32 v[148:149], v[148:149], v[124:125]
 v_pk_fma_f32 v[150:151], v[124:125], v[124:125], v[150:151]
 v_pk_add_f32 v[148:149], v[148:149], v[126:127]
 v_pk_fma_f32 v[150:151], v[126:127], v[126:127], v[150:151]
L_r10_mid:
 s_add_u32 s66, s61, 2
 v_cmp_gt_u32 vcc, s66, v10
 s_cbranch_vccz L_r10_ov
 s_nop 3
 s_mul_i32 s67, s61, 36864
 s_add_u32 s67, s67, s72
 v_mov_b32 v8, s65
 v_pk_add_f32 v[148:149], v[148:149], v[128:129]
 v_pk_fma_f32 v[150:151], v[128:129], v[128:129], v[150:151]
 v_pk_add_f32 v[148:149], v[148:149], v[130:131]
 v_pk_fma_f32 v[150:151], v[130:131], v[130:131], v[150:151]
 v_pk_add_f32 v[148:149], v[148:149], v[132:133]
 v_pk_fma_f32 v[150:151], v[132:133], v[132:133], v[150:151]
 v_pk_add_f32 v[148:149], v[148:149], v[134:135]
 v_pk_fma_f32 v[150:151], v[134:135], v[134:135], v[150:151]
 v_add_f32 v148, v148, v149
 v_add_f32 v149, v150, v151
 s_nop 0
 v_add_f32_dpp v148, v148, v148 row_ror:8 row_mask:0xf bank_mask:0xf
 v_add_f32_dpp v149, v149, v149 row_ror:8 row_mask:0xf bank_mask:0xf
 v_mov_b32 v150, v148
 v_mov_b32 v151, v149
 s_nop 0
 v_permlane16_swap_b32 v148, v150
 v_permlane16_swap_b32 v149, v151
 v_add_f32 v148, v148, v150
 v_add_f32 v149, v149, v151
 v_mov_b32 v150, v148
 v_mov_b32 v151, v149
 s_nop 0
 v_permlane32_swap_b32 v148, v150
 v_permlane32_swap_b32 v149, v151
 v_add_f32 v148, v148, v150
 v_add_f32 v149, v149, v151
 ds_write_b64 v19, v[148:149]
 s_add_u32 s68, s67, 7864320
 s_lshl_b32 s67, s61, 8
 s_add_u32 s67, s67, 12615680
 s_waitcnt lgkmcnt(0)
 s_barrier
 ds_read_b128 v[152:155], v20
 ds_read_b128 v[156:159], v20 offset:16
 s_cmp_lg_u32 s59, 0
 s_cbranch_scc1 Lc_99
 buffer_store_dword v8, v9, s[8:11], 0 offen
 s_branch Lc_100
Lc_99:
 buffer_store_dword v8, v9, s[8:11], 0 offen sc1
Lc_100:
 s_waitcnt lgkmcnt(0)
 v_pk_add_f32 v[150:151], v[152:153], v[154:155]
 v_pk_add_f32 v[148:149], v[156:157], v[158:159]
 v_mov_b32 v155, 0x3727c5ac
 v_pk_add_f32 v[150:151], v[150:151], v[148:149]
 v_mul_f32 v150, 0x3ae38e39, v150
 v_mul_f32 v151, 0x3ae38e39, v151
 v_fma_f32 v151, -v150, v150, v151
 v_max_f32 v151, 0, v151
 v_add_f32 v155, v155, v151
 v_rsq_f32 v152, v155
 v_add_f32 v156, v150, v164
 v_mul_f32 v154, -v150, v152
 v_mul_f32 v157, v155, v152
 v_pk_fma_f32 v[116:117], v[116:117], v[152:153], v[154:155] op_sel_hi:[1,0,0]
 v_pk_fma_f32 v[118:119], v[118:119], v[152:153], v[154:155] op_sel_hi:[1,0,0]
 v_cvt_pk_bf16_f32 v116, v116, v117
 v_cvt_pk_bf16_f32 v117, v118, v119
 ds_write_b64 v12, v[116:117] offset:16384
 v_pk_fma_f32 v[120:121], v[120:121], v[152:153], v[154:155] op_sel_hi:[1,0,0]
 v_pk_fma_f32 v[122:123], v[122:123], v[152:153], v[154:155] op_sel_hi:[1,0,0]
 v_cvt_pk_bf16_f32 v120, v120, v121
 v_cvt_pk_bf16_f32 v121, v122, v123
 ds_write_b64 v13, v[120:121] offset:16384
 v_pk_fma_f32 v[124:125], v[124:125], v[152:153], v[154:155] op_sel_hi:[1,0,0]
 v_pk_fma_f32 v[126:127], v[126:127], v[152:153], v[154:155] op_sel_hi:[1,0,0]
 v_cvt_pk_bf16_f32 v124, v124, v125
 v_cvt_pk_bf16_f32 v125, v126, v127
 ds_write_b64 v14, v[124:125] offset:16384
 v_pk_fma_f32 v[128:129], v[128:129], v[152:153], v[154:155] op_sel_hi:[1,0,0]
 v_pk_fma_f32 v[130:131], v[130:131], v[152:153], v[154:155] op_sel_hi:[1,0,0]
 v_cvt_pk_bf16_f32 v128, v128, v129
 v_cvt_pk_bf16_f32 v129, v130, v131
 ds_write_b64 v15, v[128:129] offset:16384
 v_pk_fma_f32 v[132:133], v[132:133], v[152:153], v[154:155] op_sel_hi:[1,0,0]
 v_pk_fma_f32 v[134:135], v[134:135], v[152:153], v[154:155] op_sel_hi:[1,0,0]
 v_cvt_pk_bf16_f32 v132, v132, v133
 v_cvt_pk_bf16_f32 v133, v134, v135
 ds_write_b64 v16, v[132:133] offset:16384
 s_waitcnt lgkmcnt(0)
 s_barrier
 ds_read_b128 v[168:171], v17 offset:16384
 ds_read_b128 v[172:175], v17 offset:17408
 ds_read_b128 v[176:179], v17 offset:18432
 buffer_load_dword v10, v22, s[8:11], 0 offen sc1
 buffer_store_dwordx2 v[156:157], v5, s[8:11], s67 offen sc1
 s_waitcnt lgkmcnt(2)
 buffer_store_dwordx4 v[168:171], v17, s[8:11], s68 offen offset:0 sc1
 s_waitcnt lgkmcnt(1)
 buffer_store_dwordx4 v[172:175], v17, s[8:11], s68 offen offset:1024 sc1
 s_waitcnt lgkmcnt(0)
 s_mov_b64 exec, 0xffff
 buffer_store_dwordx4 v[176:179], v17, s[8:11], s68 offen offset:2048 sc1
 s_mov_b64 exec, -1
 s_add_u32 s61, s61, 1
 s_add_u32 s65, s61, 1
 s_cmp_ge_u32 s61, 64
 s_cbranch_scc1 L_r10_done
 s_waitcnt vmcnt(4)
 v_mov_b64 v[164:165], v[114:115]
 s_mul_i32 s67, s61, 36864
 s_add_u32 s67, s67, s72
 s_add_u32 s67, s67, 3182592
 s_mov_b32 m0, s75
 s_xor_b32 s75, s75, 0x10000
 buffer_load_dwordx4 v17, s[8:11], s67 offen sc1 lds
 buffer_load_dwordx4 v17, s[8:11], s67 offen offset:1024 sc1 lds
 s_mov_b64 exec, 0xffff
 buffer_load_dwordx4 v17, s[8:11], s67 offen offset:2048 sc1 lds
 s_mov_b64 exec, -1
 s_lshl_b32 s67, s61, 8
 s_add_u32 s67, s67, 12583168
 buffer_load_dwordx2 v[114:115], v4, s[8:11], s67 offen sc1
 v_add_u32 v148, s77, v12
 v_add_u32 v149, s77, v13
 v_add_u32 v150, s77, v14
 v_add_u32 v151, s77, v15
 v_add_u32 v152, s77, v16
 s_xor_b32 s77, s77, 0x10000
 ds_read_b64 v[104:105], v148 offset:49152
 ds_read_b64 v[106:107], v149 offset:49152
 ds_read_b64 v[108:109], v150 offset:49152
 ds_read_b64 v[110:111], v151 offset:49152
 ds_read_b64 v[112:113], v152 offset:49152
 s_waitcnt lgkmcnt(4)
 v_lshlrev_b32 v116, 16, v104
 v_and_b32 v117, 0xffff0000, v104
 v_pk_mul_f32 v[116:117], v[116:117], v[164:165] op_sel:[0,1] op_sel_hi:[1,1]
 v_lshlrev_b32 v118, 16, v105
 v_and_b32 v119, 0xffff0000, v105
 v_pk_mul_f32 v[118:119], v[118:119], v[164:165] op_sel:[0,1] op_sel_hi:[1,1]
 s_waitcnt lgkmcnt(3)
 v_lshlrev_b32 v120, 16, v106
 v_and_b32 v121, 0xffff0000, v106
 v_pk_mul_f32 v[120:121], v[120:121], v[164:165] op_sel:[0,1] op_sel_hi:[1,1]
 v_lshlrev_b32 v122, 16, v107
 v_and_b32 v123, 0xffff0000, v107
 v_pk_mul_f32 v[122:123], v[122:123], v[164:165] op_sel:[0,1] op_sel_hi:[1,1]
 s_waitcnt lgkmcnt(2)
 v_lshlrev_b32 v124, 16, v108
 v_and_b32 v125, 0xffff0000, v108
 v_pk_mul_f32 v[124:125], v[124:125], v[164:165] op_sel:[0,1] op_sel_hi:[1,1]
 v_lshlrev_b32 v126, 16, v109
 v_and_b32 v127, 0xffff0000, v109
 v_pk_mul_f32 v[126:127], v[126:127], v[164:165] op_sel:[0,1] op_sel_hi:[1,1]
 s_waitcnt lgkmcnt(1)
 v_lshlrev_b32 v128, 16, v110
 v_and_b32 v129, 0xffff0000, v110
 v_pk_mul_f32 v[128:129], v[128:129], v[164:165] op_sel:[0,1] op_sel_hi:[1,1]
 v_lshlrev_b32 v130, 16, v111
 v_and_b32 v131, 0xffff0000, v111
 v_pk_mul_f32 v[130:131], v[130:131], v[164:165] op_sel:[0,1] op_sel_hi:[1,1]
 s_waitcnt lgkmcnt(0)
 v_lshlrev_b32 v132, 16, v112
 v_and_b32 v133, 0xffff0000, v112
 v_pk_mul_f32 v[132:133], v[132:133], v[164:165] op_sel:[0,1] op_sel_hi:[1,1]
 v_lshlrev_b32 v134, 16, v113
 v_and_b32 v135, 0xffff0000, v113
 v_pk_mul_f32 v[134:135], v[134:135], v[164:165] op_sel:[0,1] op_sel_hi:[1,1]
 v_mov_b64 v[148:149], 0
 v_mov_b64 v[150:151], 0
 s_mov_b32 s66, 1
 v_cmp_gt_u32 vcc, s65, v10
 s_cbranch_vccz L_r10_ld
 s_mov_b32 s66, 0
 s_waitcnt vmcnt(4)
 s_mov_b64 exec, 1
 ds_add_rtn_u32 v7, v11, v23
 s_waitcnt lgkmcnt(0)
 v_readfirstlane_b32 s63, v7
 v_mov_b32 v7, s61
 s_and_b32 s63, s63, 3
 s_cmp_lg_u32 s63, 3
 s_cbranch_scc1 Lf_101
 s_mov_b32 s85, s61
 s_atomic_umax s85, s[8:9], s83
Lf_101:
 s_mov_b64 exec, -1
 s_branch L_r10_spin
L_r10_ov:
 s_mul_i32 s81, s66, 128
 s_lshr_b32 s81, s81, 9
 s_mul_i32 s81, s81, 4
 s_sub_u32 s81, s66, s81
 s_mul_i32 s81, s81, 294912
 s_add_u32 s81, s81, 209715200
 s_add_u32 s82, s81, s74
 s_add_u32 s81, s81, s73
 s_mul_i32 s67, s61, 36864
 s_add_u32 s67, s67, s72
 v_mov_b32 v8, s65
 s_add_u32 s69, s81, 0
 buffer_load_dwordx4 v[32:35], v1, s[8:11], s69 offen offset:0 sc1
 v_pk_add_f32 v[148:149], v[148:149], v[128:129]
 v_pk_fma_f32 v[150:151], v[128:129], v[128:129], v[150:151]
 v_pk_add_f32 v[148:149], v[148:149], v[130:131]
 v_pk_fma_f32 v[150:151], v[130:131], v[130:131], v[150:151]
 s_add_u32 s69, s81, 0
 buffer_load_dwordx4 v[36:39], v1, s[8:11], s69 offen offset:512 sc1
 v_pk_add_f32 v[148:149], v[148:149], v[132:133]
 v_pk_fma_f32 v[150:151], v[132:133], v[132:133], v[150:151]
 v_pk_add_f32 v[148:149], v[148:149], v[134:135]
 v_pk_fma_f32 v[150:151], v[134:135], v[134:135], v[150:151]
 s_add_u32 s69, s82, 0
 buffer_load_dwordx4 v[40:43], v1, s[8:11], s69 offen offset:0 sc1
 v_add_f32 v148, v148, v149
 v_add_f32 v149, v150, v151
 s_nop 0
 v_add_f32_dpp v148, v148, v148 row_ror:8 row_mask:0xf bank_mask:0xf
 s_add_u32 s69, s81, 3072
 buffer_load_dwordx4 v[44:47], v1, s[8:11], s69 offen offset:0 sc1
 v_add_f32_dpp v149, v149, v149 row_ror:8 row_mask:0xf bank_mask:0xf
 v_mov_b32 v150, v148
 v_mov_b32 v151, v149
 s_nop 0
 v_permlane16_swap_b32 v148, v150
 s_add_u32 s69, s81, 3072
 buffer_load_dwordx4 v[48:51], v1, s[8:11], s69 offen offset:512 sc1
 v_permlane16_swap_b32 v149, v151
 v_add_f32 v148, v148, v150
 v_add_f32 v149, v149, v151
 v_mov_b32 v150, v148
 s_add_u32 s69, s82, 3072
 buffer_load_dwordx4 v[52:55], v1, s[8:11], s69 offen offset:0 sc1
 v_mov_b32 v151, v149
 s_nop 0
 v_permlane32_swap_b32 v148, v150
 v_permlane32_swap_b32 v149, v151
 s_add_u32 s69, s81, 6144
 buffer_load_dwordx4 v[56:59], v1, s[8:11], s69 offen offset:0 sc1
 v_add_f32 v148, v148, v150
 v_add_f32 v149, v149, v151
 ds_write_b64 v19, v[148:149]
 s_add_u32 s68, s67, 7864320
 s_lshl_b32 s67, s61, 8
 s_add_u32 s67, s67, 12615680
 s_waitcnt lgkmcnt(0)
 s_barrier
 ds_read_b128 v[152:155], v20
 ds_read_b128 v[156:159], v20 offset:16
 s_cmp_lg_u32 s59, 0
 s_cbranch_scc1 Lc_99w
 buffer_store_dword v8, v9, s[8:11], 0 offen
 s_branch Lc_100w
Lc_99w:
 buffer_store_dword v8, v9, s[8:11], 0 offen sc1
Lc_100w:
 s_waitcnt lgkmcnt(0)
 v_pk_add_f32 v[150:151], v[152:153], v[154:155]
 s_add_u32 s69, s81, 6144
 buffer_load_dwordx4 v[60:63], v1, s[8:11], s69 offen offset:512 sc1
 v_pk_add_f32 v[148:149], v[156:157], v[158:159]
 v_mov_b32 v155, 0x3727c5ac
 v_pk_add_f32 v[150:151], v[150:151], v[148:149]
 v_mul_f32 v150, 0x3ae38e39, v150
 s_add_u32 s69, s82, 6144
 buffer_load_dwordx4 v[64:67], v1, s[8:11], s69 offen offset:0 sc1
 v_mul_f32 v151, 0x3ae38e39, v151
 v_fma_f32 v151, -v150, v150, v151
 v_max_f32 v151, 0, v151
 v_add_f32 v155, v155, v151
 v_rsq_f32 v152, v155
 v_add_f32 v156, v150, v164
 v_mul_f32 v154, -v150, v152
 v_mul_f32 v157, v155, v152
 v_pk_fma_f32 v[116:117], v[116:117], v[152:153], v[154:155] op_sel_hi:[1,0,0]
 v_pk_fma_f32 v[118:119], v[118:119], v[152:153], v[154:155] op_sel_hi:[1,0,0]
 v_cvt_pk_bf16_f32 v116, v116, v117
 v_cvt_pk_bf16_f32 v117, v118, v119
 ds_write_b64 v12, v[116:117] offset:16384
 v_pk_fma_f32 v[120:121], v[120:121], v[152:153], v[154:155] op_sel_hi:[1,0,0]
 v_pk_fma_f32 v[122:123], v[122:123], v[152:153], v[154:155] op_sel_hi:[1,0,0]
 v_cvt_pk_bf16_f32 v120, v120, v121
 v_cvt_pk_bf16_f32 v121, v122, v123
 ds_write_b64 v13, v[120:121] offset:16384
 v_pk_fma_f32 v[124:125], v[124:125], v[152:153], v[154:155] op_sel_hi:[1,0,0]
 v_pk_fma_f32 v[126:127], v[126:127], v[152:153], v[154:155] op_sel_hi:[1,0,0]
 v_cvt_pk_bf16_f32 v124, v124, v125
 v_cvt_pk_bf16_f32 v125, v126, v127
 ds_write_b64 v14, v[124:125] offset:16384
 v_pk_fma_f32 v[128:129], v[128:129], v[152:153], v[154:155] op_sel_hi:[1,0,0]
 v_pk_fma_f32 v[130:131], v[130:131], v[152:153], v[154:155] op_sel_hi:[1,0,0]
 v_cvt_pk_bf16_f32 v128, v128, v129
 v_cvt_pk_bf16_f32 v129, v130, v131
 ds_write_b64 v15, v[128:129] offset:16384
 v_pk_fma_f32 v[132:133], v[132:133], v[152:153], v[154:155] op_sel_hi:[1,0,0]
 v_pk_fma_f32 v[134:135], v[134:135], v[152:153], v[154:155] op_sel_hi:[1,0,0]
 v_cvt_pk_bf16_f32 v132, v132, v133
 v_cvt_pk_bf16_f32 v133, v134, v135
 ds_write_b64 v16, v[132:133] offset:16384
 s_waitcnt lgkmcnt(0)
 s_barrier
 ds_read_b128 v[168:171], v17 offset:16384
 ds_read_b128 v[172:175], v17 offset:17408
 ds_read_b128 v[176:179], v17 offset:18432
 buffer_load_dword v10, v22, s[8:11], 0 offen sc1
 buffer_store_dwordx2 v[156:157], v5, s[8:11], s67 offen sc1
 s_waitcnt lgkmcnt(2)
 buffer_store_dwordx4 v[168:171], v17, s[8:11], s68 offen offset:0 sc1
 s_waitcnt lgkmcnt(1)
 buffer_store_dwordx4 v[172:175], v17, s[8:11], s68 offen offset:1024 sc1
 s_waitcnt lgkmcnt(0)
 s_mov_b64 exec, 0xffff
 buffer_store_dwordx4 v[176:179], v17, s[8:11], s68 offen offset:2048 sc1
 s_mov_b64 exec, -1
 s_add_u32 s61, s61, 1
 s_add_u32 s65, s61, 1
 s_waitcnt vmcnt(4)
 v_mov_b64 v[164:165], v[114:115]
 s_mul_i32 s67, s61, 36864
 s_add_u32 s67, s67, s72
 s_add_u32 s67, s67, 3182592
 s_mov_b32 m0, s75
 s_xor_b32 s75, s75, 0x10000
 buffer_load_dwordx4 v17, s[8:11], s67 offen sc1 lds
 buffer_load_dwordx4 v17, s[8:11], s67 offen offset:1024 sc1 lds
 s_mov_b64 exec, 0xffff
 buffer_load_dwordx4 v17, s[8:11], s67 offen offset:2048 sc1 lds
 s_mov_b64 exec, -1
 s_lshl_b32 s67, s61, 8
 s_add_u32 s67, s67, 12583168
 buffer_load_dwordx2 v[114:115], v4, s[8:11], s67 offen sc1
 v_add_u32 v148, s77, v12
 v_add_u32 v149, s77, v13
 v_add_u32 v150, s77, v14
 v_add_u32 v151, s77, v15
 v_add_u32 v152, s77, v16
 s_xor_b32 s77, s77, 0x10000
 ds_read_b64 v[104:105], v148 offset:49152
 ds_read_b64 v[106:107], v149 offset:49152
 ds_read_b64 v[108:109], v150 offset:49152
 ds_read_b64 v[110:111], v151 offset:49152
 ds_read_b64 v[112:113], v152 offset:49152
 s_waitcnt lgkmcnt(4)
 v_lshlrev_b32 v116, 16, v104
 v_and_b32 v117, 0xffff0000, v104
 v_pk_mul_f32 v[116:117], v[116:117], v[164:165] op_sel:[0,1] op_sel_hi:[1,1]
 v_lshlrev_b32 v118, 16, v105
 v_and_b32 v119, 0xffff0000, v105
 v_pk_mul_f32 v[118:119], v[118:119], v[164:165] op_sel:[0,1] op_sel_hi:[1,1]
 s_waitcnt lgkmcnt(3)
 v_lshlrev_b32 v120, 16, v106
 v_and_b32 v121, 0xffff0000, v106
 v_pk_mul_f32 v[120:121], v[120:121], v[164:165] op_sel:[0,1] op_sel_hi:[1,1]
 v_lshlrev_b32 v122, 16, v107
 v_and_b32 v123, 0xffff0000, v107
 v_pk_mul_f32 v[122:123], v[122:123], v[164:165] op_sel:[0,1] op_sel_hi:[1,1]
 s_waitcnt lgkmcnt(2)
 v_lshlrev_b32 v124, 16, v108
 v_and_b32 v125, 0xffff0000, v108
 v_pk_mul_f32 v[124:125], v[124:125], v[164:165] op_sel:[0,1] op_sel_hi:[1,1]
 v_lshlrev_b32 v126, 16, v109
 v_and_b32 v127, 0xffff0000, v109
 v_pk_mul_f32 v[126:127], v[126:127], v[164:165] op_sel:[0,1] op_sel_hi:[1,1]
 s_waitcnt lgkmcnt(1)
 v_lshlrev_b32 v128, 16, v110
 v_and_b32 v129, 0xffff0000, v110
 v_pk_mul_f32 v[128:129], v[128:129], v[164:165] op_sel:[0,1] op_sel_hi:[1,1]
 v_lshlrev_b32 v130, 16, v111
 v_and_b32 v131, 0xffff0000, v111
 v_pk_mul_f32 v[130:131], v[130:131], v[164:165] op_sel:[0,1] op_sel_hi:[1,1]
 s_waitcnt lgkmcnt(0)
 v_lshlrev_b32 v132, 16, v112
 v_and_b32 v133, 0xffff0000, v112
 v_pk_mul_f32 v[132:133], v[132:133], v[164:165] op_sel:[0,1] op_sel_hi:[1,1]
 v_lshlrev_b32 v134, 16, v113
 v_and_b32 v135, 0xffff0000, v113
 v_pk_mul_f32 v[134:135], v[134:135], v[164:165] op_sel:[0,1] op_sel_hi:[1,1]
 v_mov_b64 v[148:149], 0
 v_mov_b64 v[150:151], 0
 v_mfma_f32_16x16x32_bf16 v[116:119], v[24:27], v[32:35], v[116:119]
 v_mfma_f32_16x16x32_bf16 v[116:119], v[28:31], v[36:39], v[116:119]
 v_mfma_f32_16x16x32_bf16 v[120:123], v[24:27], v[40:43], v[120:123]
 v_mfma_f32_16x16x32_bf16 v[120:123], v[28:31], v[44:47], v[120:123]
 v_mfma_f32_16x16x32_bf16 v[124:127], v[24:27], v[48:51], v[124:127]
 v_mfma_f32_16x16x32_bf16 v[124:127], v[28:31], v[52:55], v[124:127]
 v_mfma_f32_16x16x32_bf16 v[128:131], v[24:27], v[56:59], v[128:131]
 v_mfma_f32_16x16x32_bf16 v[128:131], v[28:31], v[60:63], v[128:131]
 v_mfma_f32_16x16x32_bf16 v[132:135], v[24:27], v[64:67], v[132:135]
 s_nop 0
 v_pk_add_f32 v[148:149], v[148:149], v[116:117]
 v_pk_fma_f32 v[150:151], v[116:117], v[116:117], v[150:151]
 v_pk_add_f32 v[148:149], v[148:149], v[118:119]
 v_pk_fma_f32 v[150:151], v[118:119], v[118:119], v[150:151]
 v_pk_add_f32 v[148:149], v[148:149], v[120:121]
 v_pk_fma_f32 v[150:151], v[120:121], v[120:121], v[150:151]
 v_pk_add_f32 v[148:149], v[148:149], v[122:123]
 v_pk_fma_f32 v[150:151], v[122:123], v[122:123], v[150:151]
 s_nop 1
 v_pk_add_f32 v[148:149], v[148:149], v[124:125]
 v_pk_fma_f32 v[150:151], v[124:125], v[124:125], v[150:151]
 v_pk_add_f32 v[148:149], v[148:149], v[126:127]
 v_pk_fma_f32 v[150:151], v[126:127], v[126:127], v[150:151]
 s_waitcnt vmcnt(4)
 s_mov_b64 exec, 1
 ds_add_rtn_u32 v7, v11, v23
 s_waitcnt lgkmcnt(0)
 v_readfirstlane_b32 s63, v7
 v_mov_b32 v7, s61
 s_and_b32 s63, s63, 3
 s_cmp_lg_u32 s63, 3
 s_cbranch_scc1 Lf_102
 s_mov_b32 s85, s61
 s_atomic_umax s85, s[8:9], s83
Lf_102:
 s_mov_b64 exec, -1
 s_waitcnt vmcnt(0)
 s_branch L_r10_mid
L_r10_done:
 s_waitcnt vmcnt(0)
 s_mov_b64 exec, 1
 ds_add_rtn_u32 v7, v11, v23
 s_waitcnt lgkmcnt(0)
 v_readfirstlane_b32 s63, v7
 v_mov_b32 v7, s61
 s_and_b32 s63, s63, 3
 s_cmp_lg_u32 s63, 3
 s_cbranch_scc1 Lf_103
 s_mov_b32 s85, s61
 s_atomic_umax s85, s[8:9], s83
Lf_103:
 s_mov_b64 exec, -1
 s_waitcnt vmcnt(0) lgkmcnt(0)
 s_endpgm
L_red_1:
 v_mbcnt_lo_u32_b32 v22, -1, 0
 v_mbcnt_hi_u32_b32 v22, -1, v22
 v_min_u32 v22, 23, v22
 v_lshlrev_b32 v22, 2, v22
 v_add_u32 v22, 1536, v22
 s_lshl_b32 s63, s70, 2
 s_add_u32 s64, s63, 128
 v_mov_b32 v162, s64
 s_add_u32 s64, s63, 384
 v_mov_b32 v6, s64
 s_mov_b32 s83, s64
 s_add_u32 s63, s63, 640
 s_cmp_eq_u32 s58, 0
 s_cselect_b32 s63, s63, 2147483632
 v_mbcnt_lo_u32_b32 v9, -1, 0
 v_mbcnt_hi_u32_b32 v9, -1, v9
 v_cmp_eq_u32 vcc, 0, v9
 v_mov_b32 v8, s63
 v_mov_b32 v9, 2147483632
 v_cndmask_b32 v9, v9, v8, vcc
 s_mov_b32 s78, 0
 s_mov_b32 s77, 0
 s_mov_b32 s61, 0
 s_mov_b32 s65, 1
 s_mov_b32 s66, 0
Lpt_104:
 s_mul_i32 s67, s66, 128
 s_lshr_b32 s67, s67, 9
 s_mul_i32 s67, s67, 4
 s_sub_u32 s67, s66, s67
 s_mul_i32 s67, s67, 294912
 s_add_u32 s67, s67, 210894848
 s_add_u32 s68, s67, s74
 s_add_u32 s67, s67, s73
 s_add_u32 s69, s67, 0
 buffer_load_dwordx4 v[32:35], v1, s[8:11], s69 offen offset:0 sc1
 s_add_u32 s69, s67, 0
 buffer_load_dwordx4 v[36:39], v1, s[8:11], s69 offen offset:512 sc1
 s_add_u32 s69, s68, 0
 buffer_load_dwordx4 v[40:43], v1, s[8:11], s69 offen offset:0 sc1
 s_add_u32 s69, s67, 3072
 buffer_load_dwordx4 v[44:47], v1, s[8:11], s69 offen offset:0 sc1
 s_add_u32 s69, s67, 3072
 buffer_load_dwordx4 v[48:51], v1, s[8:11], s69 offen offset:512 sc1
 s_add_u32 s69, s68, 3072
 buffer_load_dwordx4 v[52:55], v1, s[8:11], s69 offen offset:0 sc1
 s_add_u32 s69, s67, 6144
 buffer_load_dwordx4 v[56:59], v1, s[8:11], s69 offen offset:0 sc1
 s_add_u32 s69, s67, 6144
 buffer_load_dwordx4 v[60:63], v1, s[8:11], s69 offen offset:512 sc1
 s_add_u32 s69, s68, 6144
 buffer_load_dwordx4 v[64:67], v1, s[8:11], s69 offen offset:0 sc1
 s_add_u32 s66, s66, 1
 s_cmp_lt_u32 s66, 4
 s_cbranch_scc1 Lpt_104
 s_mov_b32 s66, 0
 s_add_u32 s79, s61, 1
 s_min_u32 s79, s79, 64
 s_cmp_ge_u32 s78, s79
 s_cbranch_scc1 Lr_105
 s_mov_b32 s62, 0
Lspin_106:
 buffer_load_dword v161, v162, s[8:11], 0 offen sc1
 s_waitcnt vmcnt(0)
 v_cmp_gt_u32 vcc, s79, v161
 s_cbranch_vccz Lspind_107
 s_add_u32 s62, s62, 1
 s_cmp_lt_u32 s62, 400000
 s_cbranch_scc1 Lspin_106
 s_mov_b32 s63, 111
 s_branch L_abort_b
Lspind_107:
 v_readfirstlane_b32 s78, v161
Lr_105:
 s_mul_i32 s67, s61, 36864
 s_add_u32 s67, s67, s72
 s_add_u32 s67, s67, 5505024
 s_mov_b32 m0, s75
 s_xor_b32 s75, s75, 0x10000
 buffer_load_dwordx4 v17, s[8:11], s67 offen sc1 lds
 buffer_load_dwordx4 v17, s[8:11], s67 offen offset:1024 sc1 lds
 s_mov_b64 exec, 0xffff
 buffer_load_dwordx4 v17, s[8:11], s67 offen offset:2048 sc1 lds
 s_mov_b64 exec, -1
 s_lshl_b32 s67, s61, 8
 s_add_u32 s67, s67, 12599296
 buffer_load_dwordx2 v[114:115], v4, s[8:11], s67 offen sc1
 s_waitcnt vmcnt(0)
 s_barrier
 v_mov_b64 v[164:165], v[114:115]
 s_add_u32 s79, s61, 2
 s_min_u32 s79, s79, 64
 s_cmp_ge_u32 s78, s79
 s_cbranch_scc1 Lr_108
 s_mov_b32 s62, 0
Lspin_109:
 buffer_load_dword v161, v162, s[8:11], 0 offen sc1
 s_waitcnt vmcnt(0)
 v_cmp_gt_u32 vcc, s79, v161
 s_cbranch_vccz Lspind_110
 s_add_u32 s62, s62, 1
 s_cmp_lt_u32 s62, 400000
 s_cbranch_scc1 Lspin_109
 s_mov_b32 s63, 111
 s_branch L_abort_b
Lspind_110:
 v_readfirstlane_b32 s78, v161
Lr_108:
 s_mul_i32 s67, s61, 36864
 s_add_u32 s67, s67, s72
 s_add_u32 s67, s67, 5541888
 s_mov_b32 m0, s75
 s_xor_b32 s75, s75, 0x10000
 buffer_load_dwordx4 v17, s[8:11], s67 offen sc1 lds
 buffer_load_dwordx4 v17, s[8:11], s67 offen offset:1024 sc1 lds
 s_mov_b64 exec, 0xffff
 buffer_load_dwordx4 v17, s[8:11], s67 offen offset:2048 sc1 lds
 s_mov_b64 exec, -1
 s_lshl_b32 s67, s61, 8
 s_add_u32 s67, s67, 12599552
 buffer_load_dwordx2 v[114:115], v4, s[8:11], s67 offen sc1
 v_add_u32 v148, s77, v12
 v_add_u32 v149, s77, v13
 v_add_u32 v150, s77, v14
 v_add_u32 v151, s77, v15
 v_add_u32 v152, s77, v16
 s_xor_b32 s77, s77, 0x10000
 ds_read_b64 v[104:105], v148 offset:49152
 ds_read_b64 v[106:107], v149 offset:49152
 ds_read_b64 v[108:109], v150 offset:49152
 ds_read_b64 v[110:111], v151 offset:49152
 ds_read_b64 v[112:113], v152 offset:49152
 s_waitcnt lgkmcnt(4)
 v_lshlrev_b32 v116, 16, v104
 v_and_b32 v117, 0xffff0000, v104
 v_pk_mul_f32 v[116:117], v[116:117], v[164:165] op_sel:[0,1] op_sel_hi:[1,1]
 v_lshlrev_b32 v118, 16, v105
 v_and_b32 v119, 0xffff0000, v105
 v_pk_mul_f32 v[118:119], v[118:119], v[164:165] op_sel:[0,1] op_sel_hi:[1,1]
 s_waitcnt lgkmcnt(3)
 v_lshlrev_b32 v120, 16, v106
 v_and_b32 v121, 0xffff0000, v106
 v_pk_mul_f32 v[120:121], v[120:121], v[164:165] op_sel:[0,1] op_sel_hi:[1,1]
 v_lshlrev_b32 v122, 16, v107
 v_and_b32 v123, 0xffff0000, v107
 v_pk_mul_f32 v[122:123], v[122:123], v[164:165] op_sel:[0,1] op_sel_hi:[1,1]
 s_waitcnt lgkmcnt(2)
 v_lshlrev_b32 v124, 16, v108
 v_and_b32 v125, 0xffff0000, v108
 v_pk_mul_f32 v[124:125], v[124:125], v[164:165] op_sel:[0,1] op_sel_hi:[1,1]
 v_lshlrev_b32 v126, 16, v109
 v_and_b32 v127, 0xffff0000, v109
 v_pk_mul_f32 v[126:127], v[126:127], v[164:165] op_sel:[0,1] op_sel_hi:[1,1]
 s_waitcnt lgkmcnt(1)
 v_lshlrev_b32 v128, 16, v110
 v_and_b32 v129, 0xffff0000, v110
 v_pk_mul_f32 v[128:129], v[128:129], v[164:165] op_sel:[0,1] op_sel_hi:[1,1]
 v_lshlrev_b32 v130, 16, v111
 v_and_b32 v131, 0xffff0000, v111
 v_pk_mul_f32 v[130:131], v[130:131], v[164:165] op_sel:[0,1] op_sel_hi:[1,1]
 s_waitcnt lgkmcnt(0)
 v_lshlrev_b32 v132, 16, v112
 v_and_b32 v133, 0xffff0000, v112
 v_pk_mul_f32 v[132:133], v[132:133], v[164:165] op_sel:[0,1] op_sel_hi:[1,1]
 v_lshlrev_b32 v134, 16, v113
 v_and_b32 v135, 0xffff0000, v113
 v_pk_mul_f32 v[134:135], v[134:135], v[164:165] op_sel:[0,1] op_sel_hi:[1,1]
 v_mov_b64 v[148:149], 0
 v_mov_b64 v[150:151], 0
L_r11_spin:
 s_mov_b32 s62, 0
Lspin_111:
 buffer_load_dword v10, v22, s[8:11], 0 offen sc1
 s_waitcnt vmcnt(0)
 v_cmp_gt_u32 vcc, s65, v10
 s_cbranch_vccz Lspind_112
 s_add_u32 s62, s62, 1
 s_cmp_lt_u32 s62, 400000
 s_cbranch_scc1 Lspin_111
 s_mov_b32 s63, 11
 s_branch L_abort_b
Lspind_112:
L_r11_ld:
 s_mul_i32 s67, s65, 128
 s_lshr_b32 s67, s67, 9
 s_mul_i32 s67, s67, 4
 s_sub_u32 s67, s65, s67
 s_mul_i32 s67, s67, 294912
 s_add_u32 s67, s67, 210894848
 s_add_u32 s68, s67, s74
 s_add_u32 s67, s67, s73
 s_add_u32 s69, s67, 0
 buffer_load_dwordx4 v[32:35], v1, s[8:11], s69 offen offset:0 sc1
 s_add_u32 s69, s67, 0
 buffer_load_dwordx4 v[36:39], v1, s[8:11], s69 offen offset:512 sc1
 s_add_u32 s69, s68, 0
 buffer_load_dwordx4 v[40:43], v1, s[8:11], s69 offen offset:0 sc1
 s_add_u32 s69, s67, 3072
 buffer_load_dwordx4 v[44:47], v1, s[8:11], s69 offen offset:0 sc1
 s_add_u32 s69, s67, 3072
 buffer_load_dwordx4 v[48:51], v1, s[8:11], s69 offen offset:512 sc1
 s_add_u32 s69, s68, 3072
 buffer_load_dwordx4 v[52:55], v1, s[8:11], s69 offen offset:0 sc1
 s_cmp_eq_u32 s66, 0
 s_cbranch_scc1 Lnf_113
 s_waitcnt vmcnt(10)
 s_mov_b64 exec, 1
 ds_add_rtn_u32 v7, v11, v23
 s_waitcnt lgkmcnt(0)
 v_readfirstlane_b32 s63, v7
 v_mov_b32 v7, s61
 s_and_b32 s63, s63, 3
 s_cmp_lg_u32 s63, 3
 s_cbranch_scc1 Lf_114
 s_mov_b32 s85, s61
 s_atomic_umax s85, s[8:9], s83
Lf_114:
 s_mov_b64 exec, -1
Lnf_113:
 s_add_u32 s69, s67, 6144
 buffer_load_dwordx4 v[56:59], v1, s[8:11], s69 offen offset:0 sc1
 s_waitcnt vmcnt(6)
 v_mfma_f32_16x16x32_bf16 v[116:119], v[24:27], v[32:35], v[116:119]
 s_add_u32 s69, s67, 6144
 buffer_load_dwordx4 v[60:63], v1, s[8:11], s69 offen offset:512 sc1
 buffer_load_dword v10, v22, s[8:11], 0 offen sc1
 s_waitcnt vmcnt(7)
 v_mfma_f32_16x16x32_bf16 v[116:119], v[28:31], v[36:39], v[116:119]
 s_add_u32 s69, s68, 6144
 buffer_load_dwordx4 v[64:67], v1, s[8:11], s69 offen offset:0 sc1
 s_waitcnt vmcnt(7)
 v_mfma_f32_16x16x32_bf16 v[120:123], v[24:27], v[40:43], v[120:123]
 s_waitcnt vmcnt(6)
 v_mfma_f32_16x16x32_bf16 v[120:123], v[28:31], v[44:47], v[120:123]
 s_waitcnt vmcnt(5)
 v_mfma_f32_16x16x32_bf16 v[124:127], v[24:27], v[48:51], v[124:127]
 s_waitcnt vmcnt(4)
 v_mfma_f32_16x16x32_bf16 v[124:127], v[28:31], v[52:55], v[124:127]
 v_pk_add_f32 v[148:149], v[148:149], v[116:117]
 v_pk_fma_f32 v[150:151], v[116:117], v[116:117], v[150:151]
 v_pk_add_f32 v[148:149], v[148:149], v[118:119]
 v_pk_fma_f32 v[150:151], v[118:119], v[118:119], v[150:151]
 s_waitcnt vmcnt(3)
 v_mfma_f32_16x16x32_bf16 v[128:131], v[24:27], v[56:59], v[128:131]
 s_waitcnt vmcnt(2)
 v_mfma_f32_16x16x32_bf16 v[128:131], v[28:31], v[60:63], v[128:131]
 v_pk_add_f32 v[148:149], v[148:149], v[120:121]
 v_pk_fma_f32 v[150:151], v[120:121], v[120:121], v[150:151]
 v_pk_add_f32 v[148:149], v[148:149], v[122:123]
 v_pk_fma_f32 v[150:151], v[122:123], v[122:123], v[150:151]
 s_waitcnt vmcnt(0)
 v_mfma_f32_16x16x32_bf16 v[132:135], v[24:27], v[64:67], v[132:135]
 s_nop 1
 v_pk_add_f32 v[148:149], v[148:149], v[124:125]
 v_pk_fma_f32 v[150:151], v[124:125], v[124:125], v[150:151]
 v_pk_add_f32 v[148:149], v[148:149], v[126:127]
 v_pk_fma_f32 v[150:151], v[126:127], v[126:127], v[150:151]
L_r11_mid:
 s_add_u32 s66, s61, 2
 v_cmp_gt_u32 vcc, s66, v10
 s_cbranch_vccz L_r11_ov
 s_nop 3
 s_mul_i32 s67, s61, 36864
 s_add_u32 s67, s67, s72
 v_mov_b32 v8, s65
 v_pk_add_f32 v[148:149], v[148:149], v[128:129]
 v_pk_fma_f32 v[150:151], v[128:129], v[128:129], v[150:151]
 v_pk_add_f32 v[148:149], v[148:149], v[130:131]
 v_pk_fma_f32 v[150:151], v[130:131], v[130:131], v[150:151]
 v_pk_add_f32 v[148:149], v[148:149], v[132:133]
 v_pk_fma_f32 v[150:151], v[132:133], v[132:133], v[150:151]
 v_pk_add_f32 v[148:149], v[148:149], v[134:135]
 v_pk_fma_f32 v[150:151], v[134:135], v[134:135], v[150:151]
 v_add_f32 v148, v148, v149
 v_add_f32 v149, v150, v151
 s_nop 0
 v_add_f32_dpp v148, v148, v148 row_ror:8 row_mask:0xf bank_mask:0xf
 v_add_f32_dpp v149, v149, v149 row_ror:8 row_mask:0xf bank_mask:0xf
 v_mov_b32 v150, v148
 v_mov_b32 v151, v149
 s_nop 0
 v_permlane16_swap_b32 v148, v150
 v_permlane16_swap_b32 v149, v151
 v_add_f32 v148, v148, v150
 v_add_f32 v149, v149, v151
 v_mov_b32 v150, v148
 v_mov_b32 v151, v149
 s_nop 0
 v_permlane32_swap_b32 v148, v150
 v_permlane32_swap_b32 v149, v151
 v_add_f32 v148, v148, v150
 v_add_f32 v149, v149, v151
 ds_write_b64 v19, v[148:149]
 s_add_u32 s68, s67, 10223616
 s_lshl_b32 s67, s61, 8
 s_add_u32 s67, s67, 12632064
 s_waitcnt lgkmcnt(0)
 s_barrier
 ds_read_b128 v[152:155], v20
 ds_read_b128 v[156:159], v20 offset:16
 s_cmp_lg_u32 s59, 0
 s_cbranch_scc1 Lc_115
 buffer_store_dword v8, v9, s[8:11], 0 offen
 s_branch Lc_116
Lc_115:
 buffer_store_dword v8, v9, s[8:11], 0 offen sc1
Lc_116:
 s_waitcnt lgkmcnt(0)
 v_pk_add_f32 v[150:151], v[152:153], v[154:155]
 v_pk_add_f32 v[148:149], v[156:157], v[158:159]
 v_mov_b32 v155, 0x3727c5ac
 v_pk_add_f32 v[150:151], v[150:151], v[148:149]
 v_mul_f32 v150, 0x3ae38e39, v150
 v_mul_f32 v151, 0x3ae38e39, v151
 v_fma_f32 v151, -v150, v150, v151
 v_max_f32 v151, 0, v151
 v_add_f32 v155, v155, v151
 v_rsq_f32 v152, v155
 v_add_f32 v156, v150, v164
 v_mul_f32 v154, -v150, v152
 v_mul_f32 v157, v155, v152
 v_pk_fma_f32 v[116:117], v[116:117], v[152:153], v[154:155] op_sel_hi:[1,0,0]
 v_pk_fma_f32 v[118:119], v[118:119], v[152:153], v[154:155] op_sel_hi:[1,0,0]
 v_cvt_pk_bf16_f32 v116, v116, v117
 v_cvt_pk_bf16_f32 v117, v118, v119
 ds_write_b64 v12, v[116:117] offset:16384
 v_pk_fma_f32 v[120:121], v[120:121], v[152:153], v[154:155] op_sel_hi:[1,0,0]
 v_pk_fma_f32 v[122:123], v[122:123], v[152:153], v[154:155] op_sel_hi:[1,0,0]
 v_cvt_pk_bf16_f32 v120, v120, v121
 v_cvt_pk_bf16_f32 v121, v122, v123
 ds_write_b64 v13, v[120:121] offset:16384
 v_pk_fma_f32 v[124:125], v[124:125], v[152:153], v[154:155] op_sel_hi:[1,0,0]
 v_pk_fma_f32 v[126:127], v[126:127], v[152:153], v[154:155] op_sel_hi:[1,0,0]
 v_cvt_pk_bf16_f32 v124, v124, v125
 v_cvt_pk_bf16_f32 v125, v126, v127
 ds_write_b64 v14, v[124:125] offset:16384
 v_pk_fma_f32 v[128:129], v[128:129], v[152:153], v[154:155] op_sel_hi:[1,0,0]
 v_pk_fma_f32 v[130:131], v[130:131], v[152:153], v[154:155] op_sel_hi:[1,0,0]
 v_cvt_pk_bf16_f32 v128, v128, v129
 v_cvt_pk_bf16_f32 v129, v130, v131
 ds_write_b64 v15, v[128:129] offset:16384
 v_pk_fma_f32 v[132:133], v[132:133], v[152:153], v[154:155] op_sel_hi:[1,0,0]
 v_pk_fma_f32 v[134:135], v[134:135], v[152:153], v[154:155] op_sel_hi:[1,0,0]
 v_cvt_pk_bf16_f32 v132, v132, v133
 v_cvt_pk_bf16_f32 v133, v134, v135
 ds_write_b64 v16, v[132:133] offset:16384
 s_waitcnt lgkmcnt(0)
 s_barrier
 ds_read_b128 v[168:171], v17 offset:16384
 ds_read_b128 v[172:175], v17 offset:17408
 ds_read_b128 v[176:179], v17 offset:18432
 buffer_load_dword v10, v22, s[8:11], 0 offen sc1
 buffer_store_dwordx2 v[156:157], v5, s[8:11], s67 offen sc1
 s_waitcnt lgkmcnt(2)
 buffer_store_dwordx4 v[168:171], v17, s[8:11], s68 offen offset:0 sc1
 s_waitcnt lgkmcnt(1)
 buffer_store_dwordx4 v[172:175], v17, s[8:11], s68 offen offset:1024 sc1
 s_waitcnt lgkmcnt(0)
 s_mov_b64 exec, 0xffff
 buffer_store_dwordx4 v[176:179], v17, s[8:11], s68 offen offset:2048 sc1
 s_mov_b64 exec, -1
 s_add_u32 s61, s61, 1
 s_add_u32 s65, s61, 1
 s_cmp_ge_u32 s61, 64
 s_cbranch_scc1 L_r11_done
 s_waitcnt vmcnt(4)
 v_mov_b64 v[164:165], v[114:115]
 s_add_u32 s79, s61, 2
 s_min_u32 s79, s79, 64
 s_cmp_ge_u32 s78, s79
 s_cbranch_scc1 Lr_117
 s_mov_b32 s62, 0
Lspin_118:
 buffer_load_dword v161, v162, s[8:11], 0 offen sc1
 s_waitcnt vmcnt(0)
 v_cmp_gt_u32 vcc, s79, v161
 s_cbranch_vccz Lspind_119
 s_add_u32 s62, s62, 1
 s_cmp_lt_u32 s62, 400000
 s_cbranch_scc1 Lspin_118
 s_mov_b32 s63, 111
 s_branch L_abort_b
Lspind_119:
 v_readfirstlane_b32 s78, v161
Lr_117:
 s_mul_i32 s67, s61, 36864
 s_add_u32 s67, s67, s72
 s_add_u32 s67, s67, 5541888
 s_mov_b32 m0, s75
 s_xor_b32 s75, s75, 0x10000
 buffer_load_dwordx4 v17, s[8:11], s67 offen sc1 lds
 buffer_load_dwordx4 v17, s[8:11], s67 offen offset:1024 sc1 lds
 s_mov_b64 exec, 0xffff
 buffer_load_dwordx4 v17, s[8:11], s67 offen offset:2048 sc1 lds
 s_mov_b64 exec, -1
 s_lshl_b32 s67, s61, 8
 s_add_u32 s67, s67, 12599552
 buffer_load_dwordx2 v[114:115], v4, s[8:11], s67 offen sc1
 v_add_u32 v148, s77, v12
 v_add_u32 v149, s77, v13
 v_add_u32 v150, s77, v14
 v_add_u32 v151, s77, v15
 v_add_u32 v152, s77, v16
 s_xor_b32 s77, s77, 0x10000
 ds_read_b64 v[104:105], v148 offset:49152
 ds_read_b64 v[106:107], v149 offset:49152
 ds_read_b64 v[108:109], v150 offset:49152
 ds_read_b64 v[110:111], v151 offset:49152
 ds_read_b64 v[112:113], v152 offset:49152
 s_waitcnt lgkmcnt(4)
 v_lshlrev_b32 v116, 16, v104
 v_and_b32 v117, 0xffff0000, v104
 v_pk_mul_f32 v[116:117], v[116:117], v[164:165] op_sel:[0,1] op_sel_hi:[1,1]
 v_lshlrev_b32 v118, 16, v105
 v_and_b32 v119, 0xffff0000, v105
 v_pk_mul_f32 v[118:119], v[118:119], v[164:165] op_sel:[0,1] op_sel_hi:[1,1]
 s_waitcnt lgkmcnt(3)
 v_lshlrev_b32 v120, 16, v106
 v_and_b32 v121, 0xffff0000, v106
 v_pk_mul_f32 v[120:121], v[120:121], v[164:165] op_sel:[0,1] op_sel_hi:[1,1]
 v_lshlrev_b32 v122, 16, v107
 v_and_b32 v123, 0xffff0000, v107
 v_pk_mul_f32 v[122:123], v[122:123], v[164:165] op_sel:[0,1] op_sel_hi:[1,1]
 s_waitcnt lgkmcnt(2)
 v_lshlrev_b32 v124, 16, v108
 v_and_b32 v125, 0xffff0000, v108
 v_pk_mul_f32 v[124:125], v[124:125], v[164:165] op_sel:[0,1] op_sel_hi:[1,1]
 v_lshlrev_b32 v126, 16, v109
 v_and_b32 v127, 0xffff0000, v109
 v_pk_mul_f32 v[126:127], v[126:127], v[164:165] op_sel:[0,1] op_sel_hi:[1,1]
 s_waitcnt lgkmcnt(1)
 v_lshlrev_b32 v128, 16, v110
 v_and_b32 v129, 0xffff0000, v110
 v_pk_mul_f32 v[128:129], v[128:129], v[164:165] op_sel:[0,1] op_sel_hi:[1,1]
 v_lshlrev_b32 v130, 16, v111
 v_and_b32 v131, 0xffff0000, v111
 v_pk_mul_f32 v[130:131], v[130:131], v[164:165] op_sel:[0,1] op_sel_hi:[1,1]
 s_waitcnt lgkmcnt(0)
 v_lshlrev_b32 v132, 16, v112
 v_and_b32 v133, 0xffff0000, v112
 v_pk_mul_f32 v[132:133], v[132:133], v[164:165] op_sel:[0,1] op_sel_hi:[1,1]
 v_lshlrev_b32 v134, 16, v113
 v_and_b32 v135, 0xffff0000, v113
 v_pk_mul_f32 v[134:135], v[134:135], v[164:165] op_sel:[0,1] op_sel_hi:[1,1]
 v_mov_b64 v[148:149], 0
 v_mov_b64 v[150:151], 0
 s_mov_b32 s66, 1
 v_cmp_gt_u32 vcc, s65, v10
 s_cbranch_vccz L_r11_ld
 s_mov_b32 s66, 0
 s_waitcnt vmcnt(4)
 s_mov_b64 exec, 1
 ds_add_rtn_u32 v7, v11, v23
 s_waitcnt lgkmcnt(0)
 v_readfirstlane_b32 s63, v7
 v_mov_b32 v7, s61
 s_and_b32 s63, s63, 3
 s_cmp_lg_u32 s63, 3
 s_cbranch_scc1 Lf_120
 s_mov_b32 s85, s61
 s_atomic_umax s85, s[8:9], s83
Lf_120:
 s_mov_b64 exec, -1
 s_branch L_r11_spin
L_r11_ov:
 s_mul_i32 s81, s66, 128
 s_lshr_b32 s81, s81, 9
 s_mul_i32 s81, s81, 4
 s_sub_u32 s81, s66, s81
 s_mul_i32 s81, s81, 294912
 s_add_u32 s81, s81, 210894848
 s_add_u32 s82, s81, s74
 s_add_u32 s81, s81, s73
 s_mul_i32 s67, s61, 36864
 s_add_u32 s67, s67, s72
 v_mov_b32 v8, s65
 s_add_u32 s69, s81, 0
 buffer_load_dwordx4 v[32:35], v1, s[8:11], s69 offen offset:0 sc1
 v_pk_add_f32 v[148:149], v[148:149], v[128:129]
 v_pk_fma_f32 v[150:151], v[128:129], v[128:129], v[150:151]
 v_pk_add_f32 v[148:149], v[148:149], v[130:131]
 v_pk_fma_f32 v[150:151], v[130:131], v[130:131], v[150:151]
 s_add_u32 s69, s81, 0
 buffer_load_dwordx4 v[36:39], v1, s[8:11], s69 offen offset:512 sc1
 v_pk_add_f32 v[148:149], v[148:149], v[132:133]
 v_pk_fma_f32 v[150:151], v[132:133], v[132:133], v[150:151]
 v_pk_add_f32 v[148:149], v[148:149], v[134:135]
 v_pk_fma_f32 v[150:151], v[134:135], v[134:135], v[150:151]
 s_add_u32 s69, s82, 0
 buffer_load_dwordx4 v[40:43], v1, s[8:11], s69 offen offset:0 sc1
 v_add_f32 v148, v148, v149
 v_add_f32 v149, v150, v151
 s_nop 0
 v_add_f32_dpp v148, v148, v148 row_ror:8 row_mask:0xf bank_mask:0xf
 s_add_u32 s69, s81, 3072
 buffer_load_dwordx4 v[44:47], v1, s[8:11], s69 offen offset:0 sc1
 v_add_f32_dpp v149, v149, v149 row_ror:8 row_mask:0xf bank_mask:0xf
 v_mov_b32 v150, v148
 v_mov_b32 v151, v149
 s_nop 0
 v_permlane16_swap_b32 v148, v150
 s_add_u32 s69, s81, 3072
 buffer_load_dwordx4 v[48:51], v1, s[8:11], s69 offen offset:512 sc1
 v_permlane16_swap_b32 v149, v151
 v_add_f32 v148, v148, v150
 v_add_f32 v149, v149, v151
 v_mov_b32 v150, v148
 s_add_u32 s69, s82, 3072
 buffer_load_dwordx4 v[52:55], v1, s[8:11], s69 offen offset:0 sc1
 v_mov_b32 v151, v149
 s_nop 0
 v_permlane32_swap_b32 v148, v150
 v_permlane32_swap_b32 v149, v151
 s_add_u32 s69, s81, 6144
 buffer_load_dwordx4 v[56:59], v1, s[8:11], s69 offen offset:0 sc1
 v_add_f32 v148, v148, v150
 v_add_f32 v149, v149, v151
 ds_write_b64 v19, v[148:149]
 s_add_u32 s68, s67, 10223616
 s_lshl_b32 s67, s61, 8
 s_add_u32 s67, s67, 12632064
 s_waitcnt lgkmcnt(0)
 s_barrier
 ds_read_b128 v[152:155], v20
 ds_read_b128 v[156:159], v20 offset:16
 s_cmp_lg_u32 s59, 0
 s_cbranch_scc1 Lc_115w
 buffer_store_dword v8, v9, s[8:11], 0 offen
 s_branch Lc_116w
Lc_115w:
 buffer_store_dword v8, v9, s[8:11], 0 offen sc1
Lc_116w:
 s_waitcnt lgkmcnt(0)
 v_pk_add_f32 v[150:151], v[152:153], v[154:155]
 s_add_u32 s69, s81, 6144
 buffer_load_dwordx4 v[60:63], v1, s[8:11], s69 offen offset:512 sc1
 v_pk_add_f32 v[148:149], v[156:157], v[158:159]
 v_mov_b32 v155, 0x3727c5ac
 v_pk_add_f32 v[150:151], v[150:151], v[148:149]
 v_mul_f32 v150, 0x3ae38e39, v150
 s_add_u32 s69, s82, 6144
 buffer_load_dwordx4 v[64:67], v1, s[8:11], s69 offen offset:0 sc1
 v_mul_f32 v151, 0x3ae38e39, v151
 v_fma_f32 v151, -v150, v150, v151
 v_max_f32 v151, 0, v151
 v_add_f32 v155, v155, v151
 v_rsq_f32 v152, v155
 v_add_f32 v156, v150, v164
 v_mul_f32 v154, -v150, v152
 v_mul_f32 v157, v155, v152
 v_pk_fma_f32 v[116:117], v[116:117], v[152:153], v[154:155] op_sel_hi:[1,0,0]
 v_pk_fma_f32 v[118:119], v[118:119], v[152:153], v[154:155] op_sel_hi:[1,0,0]
 v_cvt_pk_bf16_f32 v116, v116, v117
 v_cvt_pk_bf16_f32 v117, v118, v119
 ds_write_b64 v12, v[116:117] offset:16384
 v_pk_fma_f32 v[120:121], v[120:121], v[152:153], v[154:155] op_sel_hi:[1,0,0]
 v_pk_fma_f32 v[122:123], v[122:123], v[152:153], v[154:155] op_sel_hi:[1,0,0]
 v_cvt_pk_bf16_f32 v120, v120, v121
 v_cvt_pk_bf16_f32 v121, v122, v123
 ds_write_b64 v13, v[120:121] offset:16384
 v_pk_fma_f32 v[124:125], v[124:125], v[152:153], v[154:155] op_sel_hi:[1,0,0]
 v_pk_fma_f32 v[126:127], v[126:127], v[152:153], v[154:155] op_sel_hi:[1,0,0]
 v_cvt_pk_bf16_f32 v124, v124, v125
 v_cvt_pk_bf16_f32 v125, v126, v127
 ds_write_b64 v14, v[124:125] offset:16384
 v_pk_fma_f32 v[128:129], v[128:129], v[152:153], v[154:155] op_sel_hi:[1,0,0]
 v_pk_fma_f32 v[130:131], v[130:131], v[152:153], v[154:155] op_sel_hi:[1,0,0]
 v_cvt_pk_bf16_f32 v128, v128, v129
 v_cvt_pk_bf16_f32 v129, v130, v131
 ds_write_b64 v15, v[128:129] offset:16384
 v_pk_fma_f32 v[132:133], v[132:133], v[152:153], v[154:155] op_sel_hi:[1,0,0]
 v_pk_fma_f32 v[134:135], v[134:135], v[152:153], v[154:155] op_sel_hi:[1,0,0]
 v_cvt_pk_bf16_f32 v132, v132, v133
 v_cvt_pk_bf16_f32 v133, v134, v135
 ds_write_b64 v16, v[132:133] offset:16384
 s_waitcnt lgkmcnt(0)
 s_barrier
 ds_read_b128 v[168:171], v17 offset:16384
 ds_read_b128 v[172:175], v17 offset:17408
 ds_read_b128 v[176:179], v17 offset:18432
 buffer_load_dword v10, v22, s[8:11], 0 offen sc1
 buffer_store_dwordx2 v[156:157], v5, s[8:11], s67 offen sc1
 s_waitcnt lgkmcnt(2)
 buffer_store_dwordx4 v[168:171], v17, s[8:11], s68 offen offset:0 sc1
 s_waitcnt lgkmcnt(1)
 buffer_store_dwordx4 v[172:175], v17, s[8:11], s68 offen offset:1024 sc1
 s_waitcnt lgkmcnt(0)
 s_mov_b64 exec, 0xffff
 buffer_store_dwordx4 v[176:179], v17, s[8:11], s68 offen offset:2048 sc1
 s_mov_b64 exec, -1
 s_add_u32 s61, s61, 1
 s_add_u32 s65, s61, 1
 s_waitcnt vmcnt(4)
 v_mov_b64 v[164:165], v[114:115]
 s_add_u32 s79, s61, 2
 s_min_u32 s79, s79, 64
 s_cmp_ge_u32 s78, s79
 s_cbranch_scc1 Lr_121
 s_mov_b32 s62, 0
Lspin_122:
 buffer_load_dword v161, v162, s[8:11], 0 offen sc1
 s_waitcnt vmcnt(0)
 v_cmp_gt_u32 vcc, s79, v161
 s_cbranch_vccz Lspind_123
 s_add_u32 s62, s62, 1
 s_cmp_lt_u32 s62, 400000
 s_cbranch_scc1 Lspin_122
 s_mov_b32 s63, 111
 s_branch L_abort_b
Lspind_123:
 v_readfirstlane_b32 s78, v161
Lr_121:
 s_mul_i32 s67, s61, 36864
 s_add_u32 s67, s67, s72
 s_add_u32 s67, s67, 5541888
 s_mov_b32 m0, s75
 s_xor_b32 s75, s75, 0x10000
 buffer_load_dwordx4 v17, s[8:11], s67 offen sc1 lds
 buffer_load_dwordx4 v17, s[8:11], s67 offen offset:1024 sc1 lds
 s_mov_b64 exec, 0xffff
 buffer_load_dwordx4 v17, s[8:11], s67 offen offset:2048 sc1 lds
 s_mov_b64 exec, -1
 s_lshl_b32 s67, s61, 8
 s_add_u32 s67, s67, 12599552
 buffer_load_dwordx2 v[114:115], v4, s[8:11], s67 offen sc1
 v_add_u32 v148, s77, v12
 v_add_u32 v149, s77, v13
 v_add_u32 v150, s77, v14
 v_add_u32 v151, s77, v15
 v_add_u32 v152, s77, v16
 s_xor_b32 s77, s77, 0x10000
 ds_read_b64 v[104:105], v148 offset:49152
 ds_read_b64 v[106:107], v149 offset:49152
 ds_read_b64 v[108:109], v150 offset:49152
 ds_read_b64 v[110:111], v151 offset:49152
 ds_read_b64 v[112:113], v152 offset:49152
 s_waitcnt lgkmcnt(4)
 v_lshlrev_b32 v116, 16, v104
 v_and_b32 v117, 0xffff0000, v104
 v_pk_mul_f32 v[116:117], v[116:117], v[164:165] op_sel:[0,1] op_sel_hi:[1,1]
 v_lshlrev_b32 v118, 16, v105
 v_and_b32 v119, 0xffff0000, v105
 v_pk_mul_f32 v[118:119], v[118:119], v[164:165] op_sel:[0,1] op_sel_hi:[1,1]
 s_waitcnt lgkmcnt(3)
 v_lshlrev_b32 v120, 16, v106
 v_and_b32 v121, 0xffff0000, v106
 v_pk_mul_f32 v[120:121], v[120:121], v[164:165] op_sel:[0,1] op_sel_hi:[1,1]
 v_lshlrev_b32 v122, 16, v107
 v_and_b32 v123, 0xffff0000, v107
 v_pk_mul_f32 v[122:123], v[122:123], v[164:165] op_sel:[0,1] op_sel_hi:[1,1]
 s_waitcnt lgkmcnt(2)
 v_lshlrev_b32 v124, 16, v108
 v_and_b32 v125, 0xffff0000, v108
 v_pk_mul_f32 v[124:125], v[124:125], v[164:165] op_sel:[0,1] op_sel_hi:[1,1]
 v_lshlrev_b32 v126, 16, v109
 v_and_b32 v127, 0xffff0000, v109
 v_pk_mul_f32 v[126:127], v[126:127], v[164:165] op_sel:[0,1] op_sel_hi:[1,1]
 s_waitcnt lgkmcnt(1)
 v_lshlrev_b32 v128, 16, v110
 v_and_b32 v129, 0xffff0000, v110
 v_pk_mul_f32 v[128:129], v[128:129], v[164:165] op_sel:[0,1] op_sel_hi:[1,1]
 v_lshlrev_b32 v130, 16, v111
 v_and_b32 v131, 0xffff0000, v111
 v_pk_mul_f32 v[130:131], v[130:131], v[164:165] op_sel:[0,1] op_sel_hi:[1,1]
 s_waitcnt lgkmcnt(0)
 v_lshlrev_b32 v132, 16, v112
 v_and_b32 v133, 0xffff0000, v112
 v_pk_mul_f32 v[132:133], v[132:133], v[164:165] op_sel:[0,1] op_sel_hi:[1,1]
 v_lshlrev_b32 v134, 16, v113
 v_and_b32 v135, 0xffff0000, v113
 v_pk_mul_f32 v[134:135], v[134:135], v[164:165] op_sel:[0,1] op_sel_hi:[1,1]
 v_mov_b64 v[148:149], 0
 v_mov_b64 v[150:151], 0
 v_mfma_f32_16x16x32_bf16 v[116:119], v[24:27], v[32:35], v[116:119]
 v_mfma_f32_16x16x32_bf16 v[116:119], v[28:31], v[36:39], v[116:119]
 v_mfma_f32_16x16x32_bf16 v[120:123], v[24:27], v[40:43], v[120:123]
 v_mfma_f32_16x16x32_bf16 v[120:123], v[28:31], v[44:47], v[120:123]
 v_mfma_f32_16x16x32_bf16 v[124:127], v[24:27], v[48:51], v[124:127]
 v_mfma_f32_16x16x32_bf16 v[124:127], v[28:31], v[52:55], v[124:127]
 v_mfma_f32_16x16x32_bf16 v[128:131], v[24:27], v[56:59], v[128:131]
 v_mfma_f32_16x16x32_bf16 v[128:131], v[28:31], v[60:63], v[128:131]
 v_mfma_f32_16x16x32_bf16 v[132:135], v[24:27], v[64:67], v[132:135]
 s_nop 0
 v_pk_add_f32 v[148:149], v[148:149], v[116:117]
 v_pk_fma_f32 v[150:151], v[116:117], v[116:117], v[150:151]
 v_pk_add_f32 v[148:149], v[148:149], v[118:119]
 v_pk_fma_f32 v[150:151], v[118:119], v[118:119], v[150:151]
 v_pk_add_f32 v[148:149], v[148:149], v[120:121]
 v_pk_fma_f32 v[150:151], v[120:121], v[120:121], v[150:151]
 v_pk_add_f32 v[148:149], v[148:149], v[122:123]
 v_pk_fma_f32 v[150:151], v[122:123], v[122:123], v[150:151]
 s_nop 1
 v_pk_add_f32 v[148:149], v[148:149], v[124:125]
 v_pk_fma_f32 v[150:151], v[124:125], v[124:125], v[150:151]
 v_pk_add_f32 v[148:149], v[148:149], v[126:127]
 v_pk_fma_f32 v[150:151], v[126:127], v[126:127], v[150:151]
 s_waitcnt vmcnt(4)
 s_mov_b64 exec, 1
 ds_add_rtn_u32 v7, v11, v23
 s_waitcnt lgkmcnt(0)
 v_readfirstlane_b32 s63, v7
 v_mov_b32 v7, s61
 s_and_b32 s63, s63, 3
 s_cmp_lg_u32 s63, 3
 s_cbranch_scc1 Lf_124
 s_mov_b32 s85, s61
 s_atomic_umax s85, s[8:9], s83
Lf_124:
 s_mov_b64 exec, -1
 s_waitcnt vmcnt(0)
 s_branch L_r11_mid
L_r11_done:
 s_waitcnt vmcnt(0)
 s_mov_b64 exec, 1
 ds_add_rtn_u32 v7, v11, v23
 s_waitcnt lgkmcnt(0)
 v_readfirstlane_b32 s63, v7
 v_mov_b32 v7, s61
 s_and_b32 s63, s63, 3
 s_cmp_lg_u32 s63, 3
 s_cbranch_scc1 Lf_125
 s_mov_b32 s85, s61
 s_atomic_umax s85, s[8:9], s83
Lf_125:
 s_mov_b64 exec, -1
 s_waitcnt vmcnt(0) lgkmcnt(0)
 s_endpgm
L_red_2:
 v_mbcnt_lo_u32_b32 v22, -1, 0
 v_mbcnt_hi_u32_b32 v22, -1, v22
 v_min_u32 v22, 23, v22
 v_lshlrev_b32 v22, 2, v22
 v_add_u32 v22, 2048, v22
 s_lshl_b32 s63, s70, 2
 s_add_u32 s64, s63, 256
 v_mov_b32 v162, s64
 s_add_u32 s64, s63, 128
 v_mov_b32 v6, s64
 s_mov_b32 s83, s64
 s_add_u32 s63, s63, 768
 s_cmp_eq_u32 s58, 0
 s_cselect_b32 s63, s63, 2147483632
 v_mbcnt_lo_u32_b32 v9, -1, 0
 v_mbcnt_hi_u32_b32 v9, -1, v9
 v_cmp_eq_u32 vcc, 0, v9
 v_mov_b32 v8, s63
 v_mov_b32 v9, 2147483632
 v_cndmask_b32 v9, v9, v8, vcc
 s_mov_b32 s78, 0
 s_mov_b32 s77, 0
 s_mov_b32 s61, 0
 s_mov_b32 s65, 1
 s_mov_b32 s66, 0
Lpt_126:
 s_mul_i32 s67, s66, 128
 s_lshr_b32 s67, s67, 9
 s_mul_i32 s67, s67, 4
 s_sub_u32 s67, s66, s67
 s_mul_i32 s67, s67, 294912
 s_add_u32 s67, s67, 228589568
 s_add_u32 s68, s67, s74
 s_add_u32 s67, s67, s73
 s_add_u32 s69, s67, 0
 buffer_load_dwordx4 v[32:35], v1, s[8:11], s69 offen offset:0 sc1
 s_add_u32 s69, s67, 0
 buffer_load_dwordx4 v[36:39], v1, s[8:11], s69 offen offset:512 sc1
 s_add_u32 s69, s68, 0
 buffer_load_dwordx4 v[40:43], v1, s[8:11], s69 offen offset:0 sc1
 s_add_u32 s69, s67, 3072
 buffer_load_dwordx4 v[44:47], v1, s[8:11], s69 offen offset:0 sc1
 s_add_u32 s69, s67, 3072
 buffer_load_dwordx4 v[48:51], v1, s[8:11], s69 offen offset:512 sc1
 s_add_u32 s69, s68, 3072
 buffer_load_dwordx4 v[52:55], v1, s[8:11], s69 offen offset:0 sc1
 s_add_u32 s69, s67, 6144
 buffer_load_dwordx4 v[56:59], v1, s[8:11], s69 offen offset:0 sc1
 s_add_u32 s69, s67, 6144
 buffer_load_dwordx4 v[60:63], v1, s[8:11], s69 offen offset:512 sc1
 s_add_u32 s69, s68, 6144
 buffer_load_dwordx4 v[64:67], v1, s[8:11], s69 offen offset:0 sc1
 s_add_u32 s66, s66, 1
 s_cmp_lt_u32 s66, 4
 s_cbranch_scc1 Lpt_126
 s_mov_b32 s66, 0
 s_add_u32 s79, s61, 1
 s_min_u32 s79, s79, 64
 s_cmp_ge_u32 s78, s79
 s_cbranch_scc1 Lr_127
 s_mov_b32 s62, 0
Lspin_128:
 buffer_load_dword v161, v162, s[8:11], 0 offen sc1
 s_waitcnt vmcnt(0)
 v_cmp_gt_u32 vcc, s79, v161
 s_cbranch_vccz Lspind_129
 s_add_u32 s62, s62, 1
 s_cmp_lt_u32 s62, 400000
 s_cbranch_scc1 Lspin_128
 s_mov_b32 s63, 112
 s_branch L_abort_b
Lspind_129:
 v_readfirstlane_b32 s78, v161
Lr_127:
 s_mul_i32 s67, s61, 36864
 s_add_u32 s67, s67, s72
 s_add_u32 s67, s67, 7864320
 s_mov_b32 m0, s75
 s_xor_b32 s75, s75, 0x10000
 buffer_load_dwordx4 v17, s[8:11], s67 offen sc1 lds
 buffer_load_dwordx4 v17, s[8:11], s67 offen offset:1024 sc1 lds
 s_mov_b64 exec, 0xffff
 buffer_load_dwordx4 v17, s[8:11], s67 offen offset:2048 sc1 lds
 s_mov_b64 exec, -1
 s_lshl_b32 s67, s61, 8
 s_add_u32 s67, s67, 12615680
 buffer_load_dwordx2 v[114:115], v4, s[8:11], s67 offen sc1
 s_waitcnt vmcnt(0)
 s_barrier
 v_mov_b64 v[164:165], v[114:115]
 s_add_u32 s79, s61, 2
 s_min_u32 s79, s79, 64
 s_cmp_ge_u32 s78, s79
 s_cbranch_scc1 Lr_130
 s_mov_b32 s62, 0
Lspin_131:
 buffer_load_dword v161, v162, s[8:11], 0 offen sc1
 s_waitcnt vmcnt(0)
 v_cmp_gt_u32 vcc, s79, v161
 s_cbranch_vccz Lspind_132
 s_add_u32 s62, s62, 1
 s_cmp_lt_u32 s62, 400000
 s_cbranch_scc1 Lspin_131
 s_mov_b32 s63, 112
 s_branch L_abort_b
Lspind_132:
 v_readfirstlane_b32 s78, v161
Lr_130:
 s_mul_i32 s67, s61, 36864
 s_add_u32 s67, s67, s72
 s_add_u32 s67, s67, 7901184
 s_mov_b32 m0, s75
 s_xor_b32 s75, s75, 0x10000
 buffer_load_dwordx4 v17, s[8:11], s67 offen sc1 lds
 buffer_load_dwordx4 v17, s[8:11], s67 offen offset:1024 sc1 lds
 s_mov_b64 exec, 0xffff
 buffer_load_dwordx4 v17, s[8:11], s67 offen offset:2048 sc1 lds
 s_mov_b64 exec, -1
 s_lshl_b32 s67, s61, 8
 s_add_u32 s67, s67, 12615936
 buffer_load_dwordx2 v[114:115], v4, s[8:11], s67 offen sc1
 v_add_u32 v148, s77, v12
 v_add_u32 v149, s77, v13
 v_add_u32 v150, s77, v14
 v_add_u32 v151, s77, v15
 v_add_u32 v152, s77, v16
 s_xor_b32 s77, s77, 0x10000
 ds_read_b64 v[104:105], v148 offset:49152
 ds_read_b64 v[106:107], v149 offset:49152
 ds_read_b64 v[108:109], v150 offset:49152
 ds_read_b64 v[110:111], v151 offset:49152
 ds_read_b64 v[112:113], v152 offset:49152
 s_waitcnt lgkmcnt(4)
 v_lshlrev_b32 v116, 16, v104
 v_and_b32 v117, 0xffff0000, v104
 v_pk_mul_f32 v[116:117], v[116:117], v[164:165] op_sel:[0,1] op_sel_hi:[1,1]
 v_lshlrev_b32 v118, 16, v105
 v_and_b32 v119, 0xffff0000, v105
 v_pk_mul_f32 v[118:119], v[118:119], v[164:165] op_sel:[0,1] op_sel_hi:[1,1]
 s_waitcnt lgkmcnt(3)
 v_lshlrev_b32 v120, 16, v106
 v_and_b32 v121, 0xffff0000, v106
 v_pk_mul_f32 v[120:121], v[120:121], v[164:165] op_sel:[0,1] op_sel_hi:[1,1]
 v_lshlrev_b32 v122, 16, v107
 v_and_b32 v123, 0xffff0000, v107
 v_pk_mul_f32 v[122:123], v[122:123], v[164:165] op_sel:[0,1] op_sel_hi:[1,1]
 s_waitcnt lgkmcnt(2)
 v_lshlrev_b32 v124, 16, v108
 v_and_b32 v125, 0xffff0000, v108
 v_pk_mul_f32 v[124:125], v[124:125], v[164:165] op_sel:[0,1] op_sel_hi:[1,1]
 v_lshlrev_b32 v126, 16, v109
 v_and_b32 v127, 0xffff0000, v109
 v_pk_mul_f32 v[126:127], v[126:127], v[164:165] op_sel:[0,1] op_sel_hi:[1,1]
 s_waitcnt lgkmcnt(1)
 v_lshlrev_b32 v128, 16, v110
 v_and_b32 v129, 0xffff0000, v110
 v_pk_mul_f32 v[128:129], v[128:129], v[164:165] op_sel:[0,1] op_sel_hi:[1,1]
 v_lshlrev_b32 v130, 16, v111
 v_and_b32 v131, 0xffff0000, v111
 v_pk_mul_f32 v[130:131], v[130:131], v[164:165] op_sel:[0,1] op_sel_hi:[1,1]
 s_waitcnt lgkmcnt(0)
 v_lshlrev_b32 v132, 16, v112
 v_and_b32 v133, 0xffff0000, v112
 v_pk_mul_f32 v[132:133], v[132:133], v[164:165] op_sel:[0,1] op_sel_hi:[1,1]
 v_lshlrev_b32 v134, 16, v113
 v_and_b32 v135, 0xffff0000, v113
 v_pk_mul_f32 v[134:135], v[134:135], v[164:165] op_sel:[0,1] op_sel_hi:[1,1]
 v_mov_b64 v[148:149], 0
 v_mov_b64 v[150:151], 0
L_r20_spin:
 s_mov_b32 s62, 0
Lspin_133:
 buffer_load_dword v10, v22, s[8:11], 0 offen sc1
 s_waitcnt vmcnt(0)
 v_cmp_gt_u32 vcc, s65, v10
 s_cbranch_vccz Lspind_134
 s_add_u32 s62, s62, 1
 s_cmp_lt_u32 s62, 400000
 s_cbranch_scc1 Lspin_133
 s_mov_b32 s63, 12
 s_branch L_abort_b
Lspind_134:
L_r20_ld:
 s_mul_i32 s67, s65, 128
 s_lshr_b32 s67, s67, 9
 s_mul_i32 s67, s67, 4
 s_sub_u32 s67, s65, s67
 s_mul_i32 s67, s67, 294912
 s_add_u32 s67, s67, 228589568
 s_add_u32 s68, s67, s74
 s_add_u32 s67, s67, s73
 s_add_u32 s69, s67, 0
 buffer_load_dwordx4 v[32:35], v1, s[8:11], s69 offen offset:0 sc1
 s_add_u32 s69, s67, 0
 buffer_load_dwordx4 v[36:39], v1, s[8:11], s69 offen offset:512 sc1
 s_add_u32 s69, s68, 0
 buffer_load_dwordx4 v[40:43], v1, s[8:11], s69 offen offset:0 sc1
 s_add_u32 s69, s67, 3072
 buffer_load_dwordx4 v[44:47], v1, s[8:11], s69 offen offset:0 sc1
 s_add_u32 s69, s67, 3072
 buffer_load_dwordx4 v[48:51], v1, s[8:11], s69 offen offset:512 sc1
 s_add_u32 s69, s68, 3072
 buffer_load_dwordx4 v[52:55], v1, s[8:11], s69 offen offset:0 sc1
 s_cmp_eq_u32 s66, 0
 s_cbranch_scc1 Lnf_135
 s_waitcnt vmcnt(10)
 s_mov_b64 exec, 1
 ds_add_rtn_u32 v7, v11, v23
 s_waitcnt lgkmcnt(0)
 v_readfirstlane_b32 s63, v7
 v_mov_b32 v7, s61
 s_and_b32 s63, s63, 3
 s_cmp_lg_u32 s63, 3
 s_cbranch_scc1 Lf_136
 s_mov_b32 s85, s61
 s_atomic_umax s85, s[8:9], s83
Lf_136:
 s_mov_b64 exec, -1
Lnf_135:
 s_add_u32 s69, s67, 6144
 buffer_load_dwordx4 v[56:59], v1, s[8:11], s69 offen offset:0 sc1
 s_waitcnt vmcnt(6)
 v_mfma_f32_16x16x32_bf16 v[116:119], v[24:27], v[32:35], v[116:119]
 s_add_u32 s69, s67, 6144
 buffer_load_dwordx4 v[60:63], v1, s[8:11], s69 offen offset:512 sc1
 buffer_load_dword v10, v22, s[8:11], 0 offen sc1
 s_waitcnt vmcnt(7)
 v_mfma_f32_16x16x32_bf16 v[116:119], v[28:31], v[36:39], v[116:119]
 s_add_u32 s69, s68, 6144
 buffer_load_dwordx4 v[64:67], v1, s[8:11], s69 offen offset:0 sc1
 s_waitcnt vmcnt(7)
 v_mfma_f32_16x16x32_bf16 v[120:123], v[24:27], v[40:43], v[120:123]
 s_waitcnt vmcnt(6)
 v_mfma_f32_16x16x32_bf16 v[120:123], v[28:31], v[44:47], v[120:123]
 s_waitcnt vmcnt(5)
 v_mfma_f32_16x16x32_bf16 v[124:127], v[24:27], v[48:51], v[124:127]
 s_waitcnt vmcnt(4)
 v_mfma_f32_16x16x32_bf16 v[124:127], v[28:31], v[52:55], v[124:127]
 v_pk_add_f32 v[148:149], v[148:149], v[116:117]
 v_pk_fma_f32 v[150:151], v[116:117], v[116:117], v[150:151]
 v_pk_add_f32 v[148:149], v[148:149], v[118:119]
 v_pk_fma_f32 v[150:151], v[118:119], v[118:119], v[150:151]
 s_waitcnt vmcnt(3)
 v_mfma_f32_16x16x32_bf16 v[128:131], v[24:27], v[56:59], v[128:131]
 s_waitcnt vmcnt(2)
 v_mfma_f32_16x16x32_bf16 v[128:131], v[28:31], v[60:63], v[128:131]
 v_pk_add_f32 v[148:149], v[148:149], v[120:121]
 v_pk_fma_f32 v[150:151], v[120:121], v[120:121], v[150:151]
 v_pk_add_f32 v[148:149], v[148:149], v[122:123]
 v_pk_fma_f32 v[150:151], v[122:123], v[122:123], v[150:151]
 s_waitcnt vmcnt(0)
 v_mfma_f32_16x16x32_bf16 v[132:135], v[24:27], v[64:67], v[132:135]
 s_nop 1
 v_pk_add_f32 v[148:149], v[148:149], v[124:125]
 v_pk_fma_f32 v[150:151], v[124:125], v[124:125], v[150:151]
 v_pk_add_f32 v[148:149], v[148:149], v[126:127]
 v_pk_fma_f32 v[150:151], v[126:127], v[126:127], v[150:151]
L_r20_mid:
 s_add_u32 s66, s61, 2
 v_cmp_gt_u32 vcc, s66, v10
 s_cbranch_vccz L_r20_ov
 s_nop 3
 s_mul_i32 s67, s61, 36864
 s_add_u32 s67, s67, s72
 v_mov_b32 v8, s65
 v_pk_add_f32 v[148:149], v[148:149], v[128:129]
 v_pk_fma_f32 v[150:151], v[128:129], v[128:129], v[150:151]
 v_pk_add_f32 v[148:149], v[148:149], v[130:131]
 v_pk_fma_f32 v[150:151], v[130:131], v[130:131], v[150:151]
 v_pk_add_f32 v[148:149], v[148:149], v[132:133]
 v_pk_fma_f32 v[150:151], v[132:133], v[132:133], v[150:151]
 v_pk_add_f32 v[148:149], v[148:149], v[134:135]
 v_pk_fma_f32 v[150:151], v[134:135], v[134:135], v[150:151]
 v_add_f32 v148, v148, v149
 v_add_f32 v149, v150, v151
 s_nop 0
 v_add_f32_dpp v148, v148, v148 row_ror:8 row_mask:0xf bank_mask:0xf
 v_add_f32_dpp v149, v149, v149 row_ror:8 row_mask:0xf bank_mask:0xf
 v_mov_b32 v150, v148
 v_mov_b32 v151, v149
 s_nop 0
 v_permlane16_swap_b32 v148, v150
 v_permlane16_swap_b32 v149, v151
 v_add_f32 v148, v148, v150
 v_add_f32 v149, v149, v151
 v_mov_b32 v150, v148
 v_mov_b32 v151, v149
 s_nop 0
 v_permlane32_swap_b32 v148, v150
 v_permlane32_swap_b32 v149, v151
 v_add_f32 v148, v148, v150
 v_add_f32 v149, v149, v151
 ds_write_b64 v19, v[148:149]
 s_add_u32 s68, s67, 5505024
 s_lshl_b32 s67, s61, 8
 s_add_u32 s67, s67, 12599296
 s_waitcnt lgkmcnt(0)
 s_barrier
 ds_read_b128 v[152:155], v20
 ds_read_b128 v[156:159], v20 offset:16
 s_cmp_lg_u32 s59, 0
 s_cbranch_scc1 Lc_137
 buffer_store_dword v8, v9, s[8:11], 0 offen
 s_branch Lc_138
Lc_137:
 buffer_store_dword v8, v9, s[8:11], 0 offen sc1
Lc_138:
 s_waitcnt lgkmcnt(0)
 v_pk_add_f32 v[150:151], v[152:153], v[154:155]
 v_pk_add_f32 v[148:149], v[156:157], v[158:159]
 v_mov_b32 v155, 0x3727c5ac
 v_pk_add_f32 v[150:151], v[150:151], v[148:149]
 v_mul_f32 v150, 0x3ae38e39, v150
 v_mul_f32 v151, 0x3ae38e39, v151
 v_fma_f32 v151, -v150, v150, v151
 v_max_f32 v151, 0, v151
 v_add_f32 v155, v155, v151
 v_rsq_f32 v152, v155
 v_add_f32 v156, v150, v164
 v_mul_f32 v154, -v150, v152
 v_mul_f32 v157, v155, v152
 v_pk_fma_f32 v[116:117], v[116:117], v[152:153], v[154:155] op_sel_hi:[1,0,0]
 v_pk_fma_f32 v[118:119], v[118:119], v[152:153], v[154:155] op_sel_hi:[1,0,0]
 v_cvt_pk_bf16_f32 v116, v116, v117
 v_cvt_pk_bf16_f32 v117, v118, v119
 ds_write_b64 v12, v[116:117] offset:16384
 v_pk_fma_f32 v[120:121], v[120:121], v[152:153], v[154:155] op_sel_hi:[1,0,0]
 v_pk_fma_f32 v[122:123], v[122:123], v[152:153], v[154:155] op_sel_hi:[1,0,0]
 v_cvt_pk_bf16_f32 v120, v120, v121
 v_cvt_pk_bf16_f32 v121, v122, v123
 ds_write_b64 v13, v[120:121] offset:16384
 v_pk_fma_f32 v[124:125], v[124:125], v[152:153], v[154:155] op_sel_hi:[1,0,0]
 v_pk_fma_f32 v[126:127], v[126:127], v[152:153], v[154:155] op_sel_hi:[1,0,0]
 v_cvt_pk_bf16_f32 v124, v124, v125
 v_cvt_pk_bf16_f32 v125, v126, v127
 ds_write_b64 v14, v[124:125] offset:16384
 v_pk_fma_f32 v[128:129], v[128:129], v[152:153], v[154:155] op_sel_hi:[1,0,0]
 v_pk_fma_f32 v[130:131], v[130:131], v[152:153], v[154:155] op_sel_hi:[1,0,0]
 v_cvt_pk_bf16_f32 v128, v128, v129
 v_cvt_pk_bf16_f32 v129, v130, v131
 ds_write_b64 v15, v[128:129] offset:16384
 v_pk_fma_f32 v[132:133], v[132:133], v[152:153], v[154:155] op_sel_hi:[1,0,0]
 v_pk_fma_f32 v[134:135], v[134:135], v[152:153], v[154:155] op_sel_hi:[1,0,0]
 v_cvt_pk_bf16_f32 v132, v132, v133
 v_cvt_pk_bf16_f32 v133, v134, v135
 ds_write_b64 v16, v[132:133] offset:16384
 s_waitcnt lgkmcnt(0)
 s_barrier
 ds_read_b128 v[168:171], v17 offset:16384
 ds_read_b128 v[172:175], v17 offset:17408
 ds_read_b128 v[176:179], v17 offset:18432
 buffer_load_dword v10, v22, s[8:11], 0 offen sc1
 buffer_store_dwordx2 v[156:157], v5, s[8:11], s67 offen sc1
 s_waitcnt lgkmcnt(2)
 buffer_store_dwordx4 v[168:171], v17, s[8:11], s68 offen offset:0 sc1
 s_waitcnt lgkmcnt(1)
 buffer_store_dwordx4 v[172:175], v17, s[8:11], s68 offen offset:1024 sc1
 s_waitcnt lgkmcnt(0)
 s_mov_b64 exec, 0xffff
 buffer_store_dwordx4 v[176:179], v17, s[8:11], s68 offen offset:2048 sc1
 s_mov_b64 exec, -1
 s_add_u32 s61, s61, 1
 s_add_u32 s65, s61, 1
 s_cmp_ge_u32 s61, 64
 s_cbranch_scc1 L_r20_done
 s_waitcnt vmcnt(4)
 v_mov_b64 v[164:165], v[114:115]
 s_add_u32 s79, s61, 2
 s_min_u32 s79, s79, 64
 s_cmp_ge_u32 s78, s79
 s_cbranch_scc1 Lr_139
 s_mov_b32 s62, 0
Lspin_140:
 buffer_load_dword v161, v162, s[8:11], 0 offen sc1
 s_waitcnt vmcnt(0)
 v_cmp_gt_u32 vcc, s79, v161
 s_cbranch_vccz Lspind_141
 s_add_u32 s62, s62, 1
 s_cmp_lt_u32 s62, 400000
 s_cbranch_scc1 Lspin_140
 s_mov_b32 s63, 112
 s_branch L_abort_b
Lspind_141:
 v_readfirstlane_b32 s78, v161
Lr_139:
 s_mul_i32 s67, s61, 36864
 s_add_u32 s67, s67, s72
 s_add_u32 s67, s67, 7901184
 s_mov_b32 m0, s75
 s_xor_b32 s75, s75, 0x10000
 buffer_load_dwordx4 v17, s[8:11], s67 offen sc1 lds
 buffer_load_dwordx4 v17, s[8:11], s67 offen offset:1024 sc1 lds
 s_mov_b64 exec, 0xffff
 buffer_load_dwordx4 v17, s[8:11], s67 offen offset:2048 sc1 lds
 s_mov_b64 exec, -1
 s_lshl_b32 s67, s61, 8
 s_add_u32 s67, s67, 12615936
 buffer_load_dwordx2 v[114:115], v4, s[8:11], s67 offen sc1
 v_add_u32 v148, s77, v12
 v_add_u32 v149, s77, v13
 v_add_u32 v150, s77, v14
 v_add_u32 v151, s77, v15
 v_add_u32 v152, s77, v16
 s_xor_b32 s77, s77, 0x10000
 ds_read_b64 v[104:105], v148 offset:49152
 ds_read_b64 v[106:107], v149 offset:49152
 ds_read_b64 v[108:109], v150 offset:49152
 ds_read_b64 v[110:111], v151 offset:49152
 ds_read_b64 v[112:113], v152 offset:49152
 s_waitcnt lgkmcnt(4)
 v_lshlrev_b32 v116, 16, v104
 v_and_b32 v117, 0xffff0000, v104
 v_pk_mul_f32 v[116:117], v[116:117], v[164:165] op_sel:[0,1] op_sel_hi:[1,1]
 v_lshlrev_b32 v118, 16, v105
 v_and_b32 v119, 0xffff0000, v105
 v_pk_mul_f32 v[118:119], v[118:119], v[164:165] op_sel:[0,1] op_sel_hi:[1,1]
 s_waitcnt lgkmcnt(3)
 v_lshlrev_b32 v120, 16, v106
 v_and_b32 v121, 0xffff0000, v106
 v_pk_mul_f32 v[120:121], v[120:121], v[164:165] op_sel:[0,1] op_sel_hi:[1,1]
 v_lshlrev_b32 v122, 16, v107
 v_and_b32 v123, 0xffff0000, v107
 v_pk_mul_f32 v[122:123], v[122:123], v[164:165] op_sel:[0,1] op_sel_hi:[1,1]
 s_waitcnt lgkmcnt(2)
 v_lshlrev_b32 v124, 16, v108
 v_and_b32 v125, 0xffff0000, v108
 v_pk_mul_f32 v[124:125], v[124:125], v[164:165] op_sel:[0,1] op_sel_hi:[1,1]
 v_lshlrev_b32 v126, 16, v109
 v_and_b32 v127, 0xffff0000, v109
 v_pk_mul_f32 v[126:127], v[126:127], v[164:165] op_sel:[0,1] op_sel_hi:[1,1]
 s_waitcnt lgkmcnt(1)
 v_lshlrev_b32 v128, 16, v110
 v_and_b32 v129, 0xffff0000, v110
 v_pk_mul_f32 v[128:129], v[128:129], v[164:165] op_sel:[0,1] op_sel_hi:[1,1]
 v_lshlrev_b32 v130, 16, v111
 v_and_b32 v131, 0xffff0000, v111
 v_pk_mul_f32 v[130:131], v[130:131], v[164:165] op_sel:[0,1] op_sel_hi:[1,1]
 s_waitcnt lgkmcnt(0)
 v_lshlrev_b32 v132, 16, v112
 v_and_b32 v133, 0xffff0000, v112
 v_pk_mul_f32 v[132:133], v[132:133], v[164:165] op_sel:[0,1] op_sel_hi:[1,1]
 v_lshlrev_b32 v134, 16, v113
 v_and_b32 v135, 0xffff0000, v113
 v_pk_mul_f32 v[134:135], v[134:135], v[164:165] op_sel:[0,1] op_sel_hi:[1,1]
 v_mov_b64 v[148:149], 0
 v_mov_b64 v[150:151], 0
 s_mov_b32 s66, 1
 v_cmp_gt_u32 vcc, s65, v10
 s_cbranch_vccz L_r20_ld
 s_mov_b32 s66, 0
 s_waitcnt vmcnt(4)
 s_mov_b64 exec, 1
 ds_add_rtn_u32 v7, v11, v23
 s_waitcnt lgkmcnt(0)
 v_readfirstlane_b32 s63, v7
 v_mov_b32 v7, s61
 s_and_b32 s63, s63, 3
 s_cmp_lg_u32 s63, 3
 s_cbranch_scc1 Lf_142
 s_mov_b32 s85, s61
 s_atomic_umax s85, s[8:9], s83
Lf_142:
 s_mov_b64 exec, -1
 s_branch L_r20_spin
L_r20_ov:
 s_mul_i32 s81, s66, 128
 s_lshr_b32 s81, s81, 9
 s_mul_i32 s81, s81, 4
 s_sub_u32 s81, s66, s81
 s_mul_i32 s81, s81, 294912
 s_add_u32 s81, s81, 228589568
 s_add_u32 s82, s81, s74
 s_add_u32 s81, s81, s73
 s_mul_i32 s67, s61, 36864
 s_add_u32 s67, s67, s72
 v_mov_b32 v8, s65
 s_add_u32 s69, s81, 0
 buffer_load_dwordx4 v[32:35], v1, s[8:11], s69 offen offset:0 sc1
 v_pk_add_f32 v[148:149], v[148:149], v[128:129]
 v_pk_fma_f32 v[150:151], v[128:129], v[128:129], v[150:151]
 v_pk_add_f32 v[148:149], v[148:149], v[130:131]
 v_pk_fma_f32 v[150:151], v[130:131], v[130:131], v[150:151]
 s_add_u32 s69, s81, 0
 buffer_load_dwordx4 v[36:39], v1, s[8:11], s69 offen offset:512 sc1
 v_pk_add_f32 v[148:149], v[148:149], v[132:133]
 v_pk_fma_f32 v[150:151], v[132:133], v[132:133], v[150:151]
 v_pk_add_f32 v[148:149], v[148:149], v[134:135]
 v_pk_fma_f32 v[150:151], v[134:135], v[134:135], v[150:151]
 s_add_u32 s69, s82, 0
 buffer_load_dwordx4 v[40:43], v1, s[8:11], s69 offen offset:0 sc1
 v_add_f32 v148, v148, v149
 v_add_f32 v149, v150, v151
 s_nop 0
 v_add_f32_dpp v148, v148, v148 row_ror:8 row_mask:0xf bank_mask:0xf
 s_add_u32 s69, s81, 3072
 buffer_load_dwordx4 v[44:47], v1, s[8:11], s69 offen offset:0 sc1
 v_add_f32_dpp v149, v149, v149 row_ror:8 row_mask:0xf bank_mask:0xf
 v_mov_b32 v150, v148
 v_mov_b32 v151, v149
 s_nop 0
 v_permlane16_swap_b32 v148, v150
 s_add_u32 s69, s81, 3072
 buffer_load_dwordx4 v[48:51], v1, s[8:11], s69 offen offset:512 sc1
 v_permlane16_swap_b32 v149, v151
 v_add_f32 v148, v148, v150
 v_add_f32 v149, v149, v151
 v_mov_b32 v150, v148
 s_add_u32 s69, s82, 3072
 buffer_load_dwordx4 v[52:55], v1, s[8:11], s69 offen offset:0 sc1
 v_mov_b32 v151, v149
 s_nop 0
 v_permlane32_swap_b32 v148, v150
 v_permlane32_swap_b32 v149, v151
 s_add_u32 s69, s81, 6144
 buffer_load_dwordx4 v[56:59], v1, s[8:11], s69 offen offset:0 sc1
 v_add_f32 v148, v148, v150
 v_add_f32 v149, v149, v151
 ds_write_b64 v19, v[148:149]
 s_add_u32 s68, s67, 5505024
 s_lshl_b32 s67, s61, 8
 s_add_u32 s67, s67, 12599296
 s_waitcnt lgkmcnt(0)
 s_barrier
 ds_read_b128 v[152:155], v20
 ds_read_b128 v[156:159], v20 offset:16
 s_cmp_lg_u32 s59, 0
 s_cbranch_scc1 Lc_137w
 buffer_store_dword v8, v9, s[8:11], 0 offen
 s_branch Lc_138w
Lc_137w:
 buffer_store_dword v8, v9, s[8:11], 0 offen sc1
Lc_138w:
 s_waitcnt lgkmcnt(0)
 v_pk_add_f32 v[150:151], v[152:153], v[154:155]
 s_add_u32 s69, s81, 6144
 buffer_load_dwordx4 v[60:63], v1, s[8:11], s69 offen offset:512 sc1
 v_pk_add_f32 v[148:149], v[156:157], v[158:159]
 v_mov_b32 v155, 0x3727c5ac
 v_pk_add_f32 v[150:151], v[150:151], v[148:149]
 v_mul_f32 v150, 0x3ae38e39, v150
 s_add_u32 s69, s82, 6144
 buffer_load_dwordx4 v[64:67], v1, s[8:11], s69 offen offset:0 sc1
 v_mul_f32 v151, 0x3ae38e39, v151
 v_fma_f32 v151, -v150, v150, v151
 v_max_f32 v151, 0, v151
 v_add_f32 v155, v155, v151
 v_rsq_f32 v152, v155
 v_add_f32 v156, v150, v164
 v_mul_f32 v154, -v150, v152
 v_mul_f32 v157, v155, v152
 v_pk_fma_f32 v[116:117], v[116:117], v[152:153], v[154:155] op_sel_hi:[1,0,0]
 v_pk_fma_f32 v[118:119], v[118:119], v[152:153], v[154:155] op_sel_hi:[1,0,0]
 v_cvt_pk_bf16_f32 v116, v116, v117
 v_cvt_pk_bf16_f32 v117, v118, v119
 ds_write_b64 v12, v[116:117] offset:16384
 v_pk_fma_f32 v[120:121], v[120:121], v[152:153], v[154:155] op_sel_hi:[1,0,0]
 v_pk_fma_f32 v[122:123], v[122:123], v[152:153], v[154:155] op_sel_hi:[1,0,0]
 v_cvt_pk_bf16_f32 v120, v120, v121
 v_cvt_pk_bf16_f32 v121, v122, v123
 ds_write_b64 v13, v[120:121] offset:16384
 v_pk_fma_f32 v[124:125], v[124:125], v[152:153], v[154:155] op_sel_hi:[1,0,0]
 v_pk_fma_f32 v[126:127], v[126:127], v[152:153], v[154:155] op_sel_hi:[1,0,0]
 v_cvt_pk_bf16_f32 v124, v124, v125
 v_cvt_pk_bf16_f32 v125, v126, v127
 ds_write_b64 v14, v[124:125] offset:16384
 v_pk_fma_f32 v[128:129], v[128:129], v[152:153], v[154:155] op_sel_hi:[1,0,0]
 v_pk_fma_f32 v[130:131], v[130:131], v[152:153], v[154:155] op_sel_hi:[1,0,0]
 v_cvt_pk_bf16_f32 v128, v128, v129
 v_cvt_pk_bf16_f32 v129, v130, v131
 ds_write_b64 v15, v[128:129] offset:16384
 v_pk_fma_f32 v[132:133], v[132:133], v[152:153], v[154:155] op_sel_hi:[1,0,0]
 v_pk_fma_f32 v[134:135], v[134:135], v[152:153], v[154:155] op_sel_hi:[1,0,0]
 v_cvt_pk_bf16_f32 v132, v132, v133
 v_cvt_pk_bf16_f32 v133, v134, v135
 ds_write_b64 v16, v[132:133] offset:16384
 s_waitcnt lgkmcnt(0)
 s_barrier
 ds_read_b128 v[168:171], v17 offset:16384
 ds_read_b128 v[172:175], v17 offset:17408
 ds_read_b128 v[176:179], v17 offset:18432
 buffer_load_dword v10, v22, s[8:11], 0 offen sc1
 buffer_store_dwordx2 v[156:157], v5, s[8:11], s67 offen sc1
 s_waitcnt lgkmcnt(2)
 buffer_store_dwordx4 v[168:171], v17, s[8:11], s68 offen offset:0 sc1
 s_waitcnt lgkmcnt(1)
 buffer_store_dwordx4 v[172:175], v17, s[8:11], s68 offen offset:1024 sc1
 s_waitcnt lgkmcnt(0)
 s_mov_b64 exec, 0xffff
 buffer_store_dwordx4 v[176:179], v17, s[8:11], s68 offen offset:2048 sc1
 s_mov_b64 exec, -1
 s_add_u32 s61, s61, 1
 s_add_u32 s65, s61, 1
 s_waitcnt vmcnt(4)
 v_mov_b64 v[164:165], v[114:115]
 s_add_u32 s79, s61, 2
 s_min_u32 s79, s79, 64
 s_cmp_ge_u32 s78, s79
 s_cbranch_scc1 Lr_143
 s_mov_b32 s62, 0
Lspin_144:
 buffer_load_dword v161, v162, s[8:11], 0 offen sc1
 s_waitcnt vmcnt(0)
 v_cmp_gt_u32 vcc, s79, v161
 s_cbranch_vccz Lspind_145
 s_add_u32 s62, s62, 1
 s_cmp_lt_u32 s62, 400000
 s_cbranch_scc1 Lspin_144
 s_mov_b32 s63, 112
 s_branch L_abort_b
Lspind_145:
 v_readfirstlane_b32 s78, v161
Lr_143:
 s_mul_i32 s67, s61, 36864
 s_add_u32 s67, s67, s72
 s_add_u32 s67, s67, 7901184
 s_mov_b32 m0, s75
 s_xor_b32 s75, s75, 0x10000
 buffer_load_dwordx4 v17, s[8:11], s67 offen sc1 lds
 buffer_load_dwordx4 v17, s[8:11], s67 offen offset:1024 sc1 lds
 s_mov_b64 exec, 0xffff
 buffer_load_dwordx4 v17, s[8:11], s67 offen offset:2048 sc1 lds
 s_mov_b64 exec, -1
 s_lshl_b32 s67, s61, 8
 s_add_u32 s67, s67, 12615936
 buffer_load_dwordx2 v[114:115], v4, s[8:11], s67 offen sc1
 v_add_u32 v148, s77, v12
 v_add_u32 v149, s77, v13
 v_add_u32 v150, s77, v14
 v_add_u32 v151, s77, v15
 v_add_u32 v152, s77, v16
 s_xor_b32 s77, s77, 0x10000
 ds_read_b64 v[104:105], v148 offset:49152
 ds_read_b64 v[106:107], v149 offset:49152
 ds_read_b64 v[108:109], v150 offset:49152
 ds_read_b64 v[110:111], v151 offset:49152
 ds_read_b64 v[112:113], v152 offset:49152
 s_waitcnt lgkmcnt(4)
 v_lshlrev_b32 v116, 16, v104
 v_and_b32 v117, 0xffff0000, v104
 v_pk_mul_f32 v[116:117], v[116:117], v[164:165] op_sel:[0,1] op_sel_hi:[1,1]
 v_lshlrev_b32 v118, 16, v105
 v_and_b32 v119, 0xffff0000, v105
 v_pk_mul_f32 v[118:119], v[118:119], v[164:165] op_sel:[0,1] op_sel_hi:[1,1]
 s_waitcnt lgkmcnt(3)
 v_lshlrev_b32 v120, 16, v106
 v_and_b32 v121, 0xffff0000, v106
 v_pk_mul_f32 v[120:121], v[120:121], v[164:165] op_sel:[0,1] op_sel_hi:[1,1]
 v_lshlrev_b32 v122, 16, v107
 v_and_b32 v123, 0xffff0000, v107
 v_pk_mul_f32 v[122:123], v[122:123], v[164:165] op_sel:[0,1] op_sel_hi:[1,1]
 s_waitcnt lgkmcnt(2)
 v_lshlrev_b32 v124, 16, v108
 v_and_b32 v125, 0xffff0000, v108
 v_pk_mul_f32 v[124:125], v[124:125], v[164:165] op_sel:[0,1] op_sel_hi:[1,1]
 v_lshlrev_b32 v126, 16, v109
 v_and_b32 v127, 0xffff0000, v109
 v_pk_mul_f32 v[126:127], v[126:127], v[164:165] op_sel:[0,1] op_sel_hi:[1,1]
 s_waitcnt lgkmcnt(1)
 v_lshlrev_b32 v128, 16, v110
 v_and_b32 v129, 0xffff0000, v110
 v_pk_mul_f32 v[128:129], v[128:129], v[164:165] op_sel:[0,1] op_sel_hi:[1,1]
 v_lshlrev_b32 v130, 16, v111
 v_and_b32 v131, 0xffff0000, v111
 v_pk_mul_f32 v[130:131], v[130:131], v[164:165] op_sel:[0,1] op_sel_hi:[1,1]
 s_waitcnt lgkmcnt(0)
 v_lshlrev_b32 v132, 16, v112
 v_and_b32 v133, 0xffff0000, v112
 v_pk_mul_f32 v[132:133], v[132:133], v[164:165] op_sel:[0,1] op_sel_hi:[1,1]
 v_lshlrev_b32 v134, 16, v113
 v_and_b32 v135, 0xffff0000, v113
 v_pk_mul_f32 v[134:135], v[134:135], v[164:165] op_sel:[0,1] op_sel_hi:[1,1]
 v_mov_b64 v[148:149], 0
 v_mov_b64 v[150:151], 0
 v_mfma_f32_16x16x32_bf16 v[116:119], v[24:27], v[32:35], v[116:119]
 v_mfma_f32_16x16x32_bf16 v[116:119], v[28:31], v[36:39], v[116:119]
 v_mfma_f32_16x16x32_bf16 v[120:123], v[24:27], v[40:43], v[120:123]
 v_mfma_f32_16x16x32_bf16 v[120:123], v[28:31], v[44:47], v[120:123]
 v_mfma_f32_16x16x32_bf16 v[124:127], v[24:27], v[48:51], v[124:127]
 v_mfma_f32_16x16x32_bf16 v[124:127], v[28:31], v[52:55], v[124:127]
 v_mfma_f32_16x16x32_bf16 v[128:131], v[24:27], v[56:59], v[128:131]
 v_mfma_f32_16x16x32_bf16 v[128:131], v[28:31], v[60:63], v[128:131]
 v_mfma_f32_16x16x32_bf16 v[132:135], v[24:27], v[64:67], v[132:135]
 s_nop 0
 v_pk_add_f32 v[148:149], v[148:149], v[116:117]
 v_pk_fma_f32 v[150:151], v[116:117], v[116:117], v[150:151]
 v_pk_add_f32 v[148:149], v[148:149], v[118:119]
 v_pk_fma_f32 v[150:151], v[118:119], v[118:119], v[150:151]
 v_pk_add_f32 v[148:149], v[148:149], v[120:121]
 v_pk_fma_f32 v[150:151], v[120:121], v[120:121], v[150:151]
 v_pk_add_f32 v[148:149], v[148:149], v[122:123]
 v_pk_fma_f32 v[150:151], v[122:123], v[122:123], v[150:151]
 s_nop 1
 v_pk_add_f32 v[148:149], v[148:149], v[124:125]
 v_pk_fma_f32 v[150:151], v[124:125], v[124:125], v[150:151]
 v_pk_add_f32 v[148:149], v[148:149], v[126:127]
 v_pk_fma_f32 v[150:151], v[126:127], v[126:127], v[150:151]
 s_waitcnt vmcnt(4)
 s_mov_b64 exec, 1
 ds_add_rtn_u32 v7, v11, v23
 s_waitcnt lgkmcnt(0)
 v_readfirstlane_b32 s63, v7
 v_mov_b32 v7, s61
 s_and_b32 s63, s63, 3
 s_cmp_lg_u32 s63, 3
 s_cbranch_scc1 Lf_146
 s_mov_b32 s85, s61
 s_atomic_umax s85, s[8:9], s83
Lf_146:
 s_mov_b64 exec, -1
 s_waitcnt vmcnt(0)
 s_branch L_r20_mid
L_r20_done:
 s_waitcnt vmcnt(0)
 s_mov_b64 exec, 1
 ds_add_rtn_u32 v7, v11, v23
 s_waitcnt lgkmcnt(0)
 v_readfirstlane_b32 s63, v7
 v_mov_b32 v7, s61
 s_and_b32 s63, s63, 3
 s_cmp_lg_u32 s63, 3
 s_cbranch_scc1 Lf_147
 s_mov_b32 s85, s61
 s_atomic_umax s85, s[8:9], s83
Lf_147:
 s_mov_b64 exec, -1
 s_waitcnt vmcnt(0) lgkmcnt(0)
 s_endpgm
L_red_3:
 v_mbcnt_lo_u32_b32 v22, -1, 0
 v_mbcnt_hi_u32_b32 v22, -1, v22
 v_min_u32 v22, 23, v22
 v_lshlrev_b32 v22, 2, v22
 v_add_u32 v22, 2560, v22
 s_lshl_b32 s63, s70, 2
 s_add_u32 s64, s63, 384
 v_mov_b32 v162, s64
 s_add_u32 s64, s63, 0
 v_mov_b32 v6, s64
 s_mov_b32 s83, s64
 s_add_u32 s63, s63, 896
 s_cmp_eq_u32 s58, 0
 s_cselect_b32 s63, s63, 2147483632
 v_mbcnt_lo_u32_b32 v9, -1, 0
 v_mbcnt_hi_u32_b32 v9, -1, v9
 v_cmp_eq_u32 vcc, 0, v9
 v_mov_b32 v8, s63
 v_mov_b32 v9, 2147483632
 v_cndmask_b32 v9, v9, v8, vcc
 s_mov_b32 s78, 0
 s_mov_b32 s77, 0
 s_mov_b32 s61, 0
 s_mov_b32 s65, 1
 s_mov_b32 s66, 0
Lpt_148:
 s_mul_i32 s67, s66, 128
 s_lshr_b32 s67, s67, 9
 s_mul_i32 s67, s67, 4
 s_sub_u32 s67, s66, s67
 s_mul_i32 s67, s67, 294912
 s_add_u32 s67, s67, 229769216
 s_add_u32 s68, s67, s74
 s_add_u32 s67, s67, s73
 s_add_u32 s69, s67, 0
 buffer_load_dwordx4 v[32:35], v1, s[8:11], s69 offen offset:0 sc1
 s_add_u32 s69, s67, 0
 buffer_load_dwordx4 v[36:39], v1, s[8:11], s69 offen offset:512 sc1
 s_add_u32 s69, s68, 0
 buffer_load_dwordx4 v[40:43], v1, s[8:11], s69 offen offset:0 sc1
 s_add_u32 s69, s67, 3072
 buffer_load_dwordx4 v[44:47], v1, s[8:11], s69 offen offset:0 sc1
 s_add_u32 s69, s67, 3072
 buffer_load_dwordx4 v[48:51], v1, s[8:11], s69 offen offset:512 sc1
 s_add_u32 s69, s68, 3072
 buffer_load_dwordx4 v[52:55], v1, s[8:11], s69 offen offset:0 sc1
 s_add_u32 s69, s67, 6144
 buffer_load_dwordx4 v[56:59], v1, s[8:11], s69 offen offset:0 sc1
 s_add_u32 s69, s67, 6144
 buffer_load_dwordx4 v[60:63], v1, s[8:11], s69 offen offset:512 sc1
 s_add_u32 s69, s68, 6144
 buffer_load_dwordx4 v[64:67], v1, s[8:11], s69 offen offset:0 sc1
 s_add_u32 s66, s66, 1
 s_cmp_lt_u32 s66, 4
 s_cbranch_scc1 Lpt_148
 s_mov_b32 s66, 0
 s_add_u32 s79, s61, 1
 s_min_u32 s79, s79, 64
 s_cmp_ge_u32 s78, s79
 s_cbranch_scc1 Lr_149
 s_mov_b32 s62, 0
Lspin_150:
 buffer_load_dword v161, v162, s[8:11], 0 offen sc1
 s_waitcnt vmcnt(0)
 v_cmp_gt_u32 vcc, s79, v161
 s_cbranch_vccz Lspind_151
 s_add_u32 s62, s62, 1
 s_cmp_lt_u32 s62, 400000
 s_cbranch_scc1 Lspin_150
 s_mov_b32 s63, 114
 s_branch L_abort_b
Lspind_151:
 v_readfirstlane_b32 s78, v161
Lr_149:
 s_mul_i32 s67, s61, 36864
 s_add_u32 s67, s67, s72
 s_add_u32 s67, s67, 10223616
 s_mov_b32 m0, s75
 s_xor_b32 s75, s75, 0x10000
 buffer_load_dwordx4 v17, s[8:11], s67 offen sc1 lds
 buffer_load_dwordx4 v17, s[8:11], s67 offen offset:1024 sc1 lds
 s_mov_b64 exec, 0xffff
 buffer_load_dwordx4 v17, s[8:11], s67 offen offset:2048 sc1 lds
 s_mov_b64 exec, -1
 s_lshl_b32 s67, s61, 8
 s_add_u32 s67, s67, 12632064
 buffer_load_dwordx2 v[114:115], v4, s[8:11], s67 offen sc1
 s_waitcnt vmcnt(0)
 s_barrier
 v_mov_b64 v[164:165], v[114:115]
 s_add_u32 s79, s61, 2
 s_min_u32 s79, s79, 64
 s_cmp_ge_u32 s78, s79
 s_cbranch_scc1 Lr_152
 s_mov_b32 s62, 0
Lspin_153:
 buffer_load_dword v161, v162, s[8:11], 0 offen sc1
 s_waitcnt vmcnt(0)
 v_cmp_gt_u32 vcc, s79, v161
 s_cbranch_vccz Lspind_154
 s_add_u32 s62, s62, 1
 s_cmp_lt_u32 s62, 400000
 s_cbranch_scc1 Lspin_153
 s_mov_b32 s63, 114
 s_branch L_abort_b
Lspind_154:
 v_readfirstlane_b32 s78, v161
Lr_152:
 s_mul_i32 s67, s61, 36864
 s_add_u32 s67, s67, s72
 s_add_u32 s67, s67, 10260480
 s_mov_b32 m0, s75
 s_xor_b32 s75, s75, 0x10000
 buffer_load_dwordx4 v17, s[8:11], s67 offen sc1 lds
 buffer_load_dwordx4 v17, s[8:11], s67 offen offset:1024 sc1 lds
 s_mov_b64 exec, 0xffff
 buffer_load_dwordx4 v17, s[8:11], s67 offen offset:2048 sc1 lds
 s_mov_b64 exec, -1
 s_lshl_b32 s67, s61, 8
 s_add_u32 s67, s67, 12632320
 buffer_load_dwordx2 v[114:115], v4, s[8:11], s67 offen sc1
 v_add_u32 v148, s77, v12
 v_add_u32 v149, s77, v13
 v_add_u32 v150, s77, v14
 v_add_u32 v151, s77, v15
 v_add_u32 v152, s77, v16
 s_xor_b32 s77, s77, 0x10000
 ds_read_b64 v[104:105], v148 offset:49152
 ds_read_b64 v[106:107], v149 offset:49152
 ds_read_b64 v[108:109], v150 offset:49152
 ds_read_b64 v[110:111], v151 offset:49152
 ds_read_b64 v[112:113], v152 offset:49152
 s_waitcnt lgkmcnt(4)
 v_lshlrev_b32 v116, 16, v104
 v_and_b32 v117, 0xffff0000, v104
 v_pk_fma_f32 v[116:117], v[116:117], v[164:165], v[164:165] op_sel:[0,1,0] op_sel_hi:[1,1,0]
 v_lshlrev_b32 v118, 16, v105
 v_and_b32 v119, 0xffff0000, v105
 v_pk_fma_f32 v[118:119], v[118:119], v[164:165], v[164:165] op_sel:[0,1,0] op_sel_hi:[1,1,0]
 s_waitcnt lgkmcnt(3)
 v_lshlrev_b32 v120, 16, v106
 v_and_b32 v121, 0xffff0000, v106
 v_pk_fma_f32 v[120:121], v[120:121], v[164:165], v[164:165] op_sel:[0,1,0] op_sel_hi:[1,1,0]
 v_lshlrev_b32 v122, 16, v107
 v_and_b32 v123, 0xffff0000, v107
 v_pk_fma_f32 v[122:123], v[122:123], v[164:165], v[164:165] op_sel:[0,1,0] op_sel_hi:[1,1,0]
 s_waitcnt lgkmcnt(2)
 v_lshlrev_b32 v124, 16, v108
 v_and_b32 v125, 0xffff0000, v108
 v_pk_fma_f32 v[124:125], v[124:125], v[164:165], v[164:165] op_sel:[0,1,0] op_sel_hi:[1,1,0]
 v_lshlrev_b32 v126, 16, v109
 v_and_b32 v127, 0xffff0000, v109
 v_pk_fma_f32 v[126:127], v[126:127], v[164:165], v[164:165] op_sel:[0,1,0] op_sel_hi:[1,1,0]
 s_waitcnt lgkmcnt(1)
 v_lshlrev_b32 v128, 16, v110
 v_and_b32 v129, 0xffff0000, v110
 v_pk_fma_f32 v[128:129], v[128:129], v[164:165], v[164:165] op_sel:[0,1,0] op_sel_hi:[1,1,0]
 v_lshlrev_b32 v130, 16, v111
 v_and_b32 v131, 0xffff0000, v111
 v_pk_fma_f32 v[130:131], v[130:131], v[164:165], v[164:165] op_sel:[0,1,0] op_sel_hi:[1,1,0]
 s_waitcnt lgkmcnt(0)
 v_lshlrev_b32 v132, 16, v112
 v_and_b32 v133, 0xffff0000, v112
 v_pk_fma_f32 v[132:133], v[132:133], v[164:165], v[164:165] op_sel:[0,1,0] op_sel_hi:[1,1,0]
 v_lshlrev_b32 v134, 16, v113
 v_and_b32 v135, 0xffff0000, v113
 v_pk_fma_f32 v[134:135], v[134:135], v[164:165], v[164:165] op_sel:[0,1,0] op_sel_hi:[1,1,0]
 s_nop 0
L_r21_spin:
 s_mov_b32 s62, 0
Lspin_155:
 buffer_load_dword v10, v22, s[8:11], 0 offen sc1
 s_waitcnt vmcnt(0)
 v_cmp_gt_u32 vcc, s65, v10
 s_cbranch_vccz Lspind_156
 s_add_u32 s62, s62, 1
 s_cmp_lt_u32 s62, 400000
 s_cbranch_scc1 Lspin_155
 s_mov_b32 s63, 14
 s_branch L_abort_b
Lspind_156:
L_r21_ld:
 s_mul_i32 s67, s65, 128
 s_lshr_b32 s67, s67, 9
 s_mul_i32 s67, s67, 4
 s_sub_u32 s67, s65, s67
 s_mul_i32 s67, s67, 294912
 s_add_u32 s67, s67, 229769216
 s_add_u32 s68, s67, s74
 s_add_u32 s67, s67, s73
 s_add_u32 s69, s67, 0
 buffer_load_dwordx4 v[32:35], v1, s[8:11], s69 offen offset:0 sc1
 s_add_u32 s69, s67, 0
 buffer_load_dwordx4 v[36:39], v1, s[8:11], s69 offen offset:512 sc1
 s_add_u32 s69, s68, 0
 buffer_load_dwordx4 v[40:43], v1, s[8:11], s69 offen offset:0 sc1
 s_add_u32 s69, s67, 3072
 buffer_load_dwordx4 v[44:47], v1, s[8:11], s69 offen offset:0 sc1
 s_add_u32 s69, s67, 3072
 buffer_load_dwordx4 v[48:51], v1, s[8:11], s69 offen offset:512 sc1
 s_add_u32 s69, s68, 3072
 buffer_load_dwordx4 v[52:55], v1, s[8:11], s69 offen offset:0 sc1
 s_add_u32 s69, s67, 6144
 buffer_load_dwordx4 v[56:59], v1, s[8:11], s69 offen offset:0 sc1
 s_waitcnt vmcnt(6)
 v_mfma_f32_16x16x32_bf16 v[116:119], v[24:27], v[32:35], v[116:119]
 s_add_u32 s69, s67, 6144
 buffer_load_dwordx4 v[60:63], v1, s[8:11], s69 offen offset:512 sc1
 buffer_load_dword v10, v22, s[8:11], 0 offen sc1
 s_waitcnt vmcnt(7)
 v_mfma_f32_16x16x32_bf16 v[116:119], v[28:31], v[36:39], v[116:119]
 s_add_u32 s69, s68, 6144
 buffer_load_dwordx4 v[64:67], v1, s[8:11], s69 offen offset:0 sc1
 s_waitcnt vmcnt(7)
 v_mfma_f32_16x16x32_bf16 v[120:123], v[24:27], v[40:43], v[120:123]
 s_waitcnt vmcnt(6)
 v_mfma_f32_16x16x32_bf16 v[120:123], v[28:31], v[44:47], v[120:123]
 s_waitcnt vmcnt(5)
 v_mfma_f32_16x16x32_bf16 v[124:127], v[24:27], v[48:51], v[124:127]
 s_waitcnt vmcnt(4)
 v_mfma_f32_16x16x32_bf16 v[124:127], v[28:31], v[52:55], v[124:127]
 s_waitcnt vmcnt(3)
 v_mfma_f32_16x16x32_bf16 v[128:131], v[24:27], v[56:59], v[128:131]
 s_waitcnt vmcnt(2)
 v_mfma_f32_16x16x32_bf16 v[128:131], v[28:31], v[60:63], v[128:131]
 s_waitcnt vmcnt(0)
 v_mfma_f32_16x16x32_bf16 v[132:135], v[24:27], v[64:67], v[132:135]
 s_nop 1
L_r21_mid:
 s_add_u32 s66, s61, 2
 v_cmp_gt_u32 vcc, s66, v10
 s_cbranch_vccz L_r21_ov
 s_nop 3
 s_mul_i32 s67, s61, 36864
 s_add_u32 s67, s67, s72
 v_mov_b32 v8, s65
 s_barrier
 v_cvt_pk_bf16_f32 v136, v116, v117
 v_cvt_pk_bf16_f32 v137, v118, v119
 ds_write_b64 v12, v[136:137] offset:16384
 v_cvt_pk_bf16_f32 v138, v120, v121
 v_cvt_pk_bf16_f32 v139, v122, v123
 ds_write_b64 v13, v[138:139] offset:16384
 v_cvt_pk_bf16_f32 v140, v124, v125
 v_cvt_pk_bf16_f32 v141, v126, v127
 ds_write_b64 v14, v[140:141] offset:16384
 v_cvt_pk_bf16_f32 v142, v128, v129
 v_cvt_pk_bf16_f32 v143, v130, v131
 ds_write_b64 v15, v[142:143] offset:16384
 v_cvt_pk_bf16_f32 v144, v132, v133
 v_cvt_pk_bf16_f32 v145, v134, v135
 ds_write_b64 v16, v[144:145] offset:16384
 s_cmp_lg_u32 s59, 0
 s_cbranch_scc1 Lc_157
 buffer_store_dword v8, v9, s[8:11], 0 offen
 s_branch Lc_158
Lc_157:
 buffer_store_dword v8, v9, s[8:11], 0 offen sc1
Lc_158:
 s_waitcnt lgkmcnt(0)
 s_barrier
 ds_read_b128 v[168:171], v17 offset:16384
 ds_read_b128 v[172:175], v17 offset:17408
 ds_read_b128 v[176:179], v17 offset:18432
 buffer_load_dword v10, v22, s[8:11], 0 offen sc1
 s_waitcnt lgkmcnt(2)
 buffer_store_dwordx4 v[168:171], v3, s[16:19], s67 offen offset:0 sc1
 s_waitcnt lgkmcnt(1)
 buffer_store_dwordx4 v[172:175], v3, s[16:19], s67 offen offset:1024 sc1
 s_waitcnt lgkmcnt(0)
 s_mov_b64 exec, 0xffff
 buffer_store_dwordx4 v[176:179], v3, s[16:19], s67 offen offset:2048 sc1
 s_mov_b64 exec, -1
 s_add_u32 s61, s61, 1
 s_add_u32 s65, s61, 1
 s_cmp_ge_u32 s61, 64
 s_cbranch_scc1 L_r21_done
 s_waitcnt vmcnt(3)
 v_mov_b64 v[164:165], v[114:115]
 s_add_u32 s79, s61, 2
 s_min_u32 s79, s79, 64
 s_cmp_ge_u32 s78, s79
 s_cbranch_scc1 Lr_159
 s_mov_b32 s62, 0
Lspin_160:
 buffer_load_dword v161, v162, s[8:11], 0 offen sc1
 s_waitcnt vmcnt(0)
 v_cmp_gt_u32 vcc, s79, v161
 s_cbranch_vccz Lspind_161
 s_add_u32 s62, s62, 1
 s_cmp_lt_u32 s62, 400000
 s_cbranch_scc1 Lspin_160
 s_mov_b32 s63, 114
 s_branch L_abort_b
Lspind_161:
 v_readfirstlane_b32 s78, v161
Lr_159:
 s_mul_i32 s67, s61, 36864
 s_add_u32 s67, s67, s72
 s_add_u32 s67, s67, 10260480
 s_mov_b32 m0, s75
 s_xor_b32 s75, s75, 0x10000
 buffer_load_dwordx4 v17, s[8:11], s67 offen sc1 lds
 buffer_load_dwordx4 v17, s[8:11], s67 offen offset:1024 sc1 lds
 s_mov_b64 exec, 0xffff
 buffer_load_dwordx4 v17, s[8:11], s67 offen offset:2048 sc1 lds
 s_mov_b64 exec, -1
 s_lshl_b32 s67, s61, 8
 s_add_u32 s67, s67, 12632320
 buffer_load_dwordx2 v[114:115], v4, s[8:11], s67 offen sc1
 v_add_u32 v148, s77, v12
 v_add_u32 v149, s77, v13
 v_add_u32 v150, s77, v14
 v_add_u32 v151, s77, v15
 v_add_u32 v152, s77, v16
 s_xor_b32 s77, s77, 0x10000
 ds_read_b64 v[104:105], v148 offset:49152
 ds_read_b64 v[106:107], v149 offset:49152
 ds_read_b64 v[108:109], v150 offset:49152
 ds_read_b64 v[110:111], v151 offset:49152
 ds_read_b64 v[112:113], v152 offset:49152
 s_waitcnt lgkmcnt(4)
 v_lshlrev_b32 v116, 16, v104
 v_and_b32 v117, 0xffff0000, v104
 v_pk_fma_f32 v[116:117], v[116:117], v[164:165], v[164:165] op_sel:[0,1,0] op_sel_hi:[1,1,0]
 v_lshlrev_b32 v118, 16, v105
 v_and_b32 v119, 0xffff0000, v105
 v_pk_fma_f32 v[118:119], v[118:119], v[164:165], v[164:165] op_sel:[0,1,0] op_sel_hi:[1,1,0]
 s_waitcnt lgkmcnt(3)
 v_lshlrev_b32 v120, 16, v106
 v_and_b32 v121, 0xffff0000, v106
 v_pk_fma_f32 v[120:121], v[120:121], v[164:165], v[164:165] op_sel:[0,1,0] op_sel_hi:[1,1,0]
 v_lshlrev_b32 v122, 16, v107
 v_and_b32 v123, 0xffff0000, v107
 v_pk_fma_f32 v[122:123], v[122:123], v[164:165], v[164:165] op_sel:[0,1,0] op_sel_hi:[1,1,0]
 s_waitcnt lgkmcnt(2)
 v_lshlrev_b32 v124, 16, v108
 v_and_b32 v125, 0xffff0000, v108
 v_pk_fma_f32 v[124:125], v[124:125], v[164:165], v[164:165] op_sel:[0,1,0] op_sel_hi:[1,1,0]
 v_lshlrev_b32 v126, 16, v109
 v_and_b32 v127, 0xffff0000, v109
 v_pk_fma_f32 v[126:127], v[126:127], v[164:165], v[164:165] op_sel:[0,1,0] op_sel_hi:[1,1,0]
 s_waitcnt lgkmcnt(1)
 v_lshlrev_b32 v128, 16, v110
 v_and_b32 v129, 0xffff0000, v110
 v_pk_fma_f32 v[128:129], v[128:129], v[164:165], v[164:165] op_sel:[0,1,0] op_sel_hi:[1,1,0]
 v_lshlrev_b32 v130, 16, v111
 v_and_b32 v131, 0xffff0000, v111
 v_pk_fma_f32 v[130:131], v[130:131], v[164:165], v[164:165] op_sel:[0,1,0] op_sel_hi:[1,1,0]
 s_waitcnt lgkmcnt(0)
 v_lshlrev_b32 v132, 16, v112
 v_and_b32 v133, 0xffff0000, v112
 v_pk_fma_f32 v[132:133], v[132:133], v[164:165], v[164:165] op_sel:[0,1,0] op_sel_hi:[1,1,0]
 v_lshlrev_b32 v134, 16, v113
 v_and_b32 v135, 0xffff0000, v113
 v_pk_fma_f32 v[134:135], v[134:135], v[164:165], v[164:165] op_sel:[0,1,0] op_sel_hi:[1,1,0]
 s_nop 0
 s_mov_b32 s66, 1
 v_cmp_gt_u32 vcc, s65, v10
 s_cbranch_vccz L_r21_ld
 s_mov_b32 s66, 0
 s_waitcnt vmcnt(4)
 s_branch L_r21_spin
L_r21_ov:
 s_mul_i32 s81, s66, 128
 s_lshr_b32 s81, s81, 9
 s_mul_i32 s81, s81, 4
 s_sub_u32 s81, s66, s81
 s_mul_i32 s81, s81, 294912
 s_add_u32 s81, s81, 229769216
 s_add_u32 s82, s81, s74
 s_add_u32 s81, s81, s73
 s_mul_i32 s67, s61, 36864
 s_add_u32 s67, s67, s72
 v_mov_b32 v8, s65
 s_add_u32 s69, s81, 0
 buffer_load_dwordx4 v[32:35], v1, s[8:11], s69 offen offset:0 sc1
 s_barrier
 v_cvt_pk_bf16_f32 v136, v116, v117
 v_cvt_pk_bf16_f32 v137, v118, v119
 ds_write_b64 v12, v[136:137] offset:16384
 v_cvt_pk_bf16_f32 v138, v120, v121
 s_add_u32 s69, s81, 0
 buffer_load_dwordx4 v[36:39], v1, s[8:11], s69 offen offset:512 sc1
 v_cvt_pk_bf16_f32 v139, v122, v123
 ds_write_b64 v13, v[138:139] offset:16384
 v_cvt_pk_bf16_f32 v140, v124, v125
 v_cvt_pk_bf16_f32 v141, v126, v127
 s_add_u32 s69, s82, 0
 buffer_load_dwordx4 v[40:43], v1, s[8:11], s69 offen offset:0 sc1
 ds_write_b64 v14, v[140:141] offset:16384
 v_cvt_pk_bf16_f32 v142, v128, v129
 v_cvt_pk_bf16_f32 v143, v130, v131
 ds_write_b64 v15, v[142:143] offset:16384
 v_cvt_pk_bf16_f32 v144, v132, v133
 s_add_u32 s69, s81, 3072
 buffer_load_dwordx4 v[44:47], v1, s[8:11], s69 offen offset:0 sc1
 v_cvt_pk_bf16_f32 v145, v134, v135
 ds_write_b64 v16, v[144:145] offset:16384
 s_cmp_lg_u32 s59, 0
 s_cbranch_scc1 Lc_157w
 buffer_store_dword v8, v9, s[8:11], 0 offen
 s_branch Lc_158w
Lc_157w:
 buffer_store_dword v8, v9, s[8:11], 0 offen sc1
Lc_158w:
 s_waitcnt lgkmcnt(0)
 s_barrier
 ds_read_b128 v[168:171], v17 offset:16384
 ds_read_b128 v[172:175], v17 offset:17408
 ds_read_b128 v[176:179], v17 offset:18432
 s_add_u32 s69, s81, 3072
 buffer_load_dwordx4 v[48:51], v1, s[8:11], s69 offen offset:512 sc1
 s_add_u32 s69, s82, 3072
 buffer_load_dwordx4 v[52:55], v1, s[8:11], s69 offen offset:0 sc1
 s_add_u32 s69, s81, 6144
 buffer_load_dwordx4 v[56:59], v1, s[8:11], s69 offen offset:0 sc1
 s_add_u32 s69, s81, 6144
 buffer_load_dwordx4 v[60:63], v1, s[8:11], s69 offen offset:512 sc1
 s_add_u32 s69, s82, 6144
 buffer_load_dwordx4 v[64:67], v1, s[8:11], s69 offen offset:0 sc1
 buffer_load_dword v10, v22, s[8:11], 0 offen sc1
 s_waitcnt lgkmcnt(2)
 buffer_store_dwordx4 v[168:171], v3, s[16:19], s67 offen offset:0 sc1
 s_waitcnt lgkmcnt(1)
 buffer_store_dwordx4 v[172:175], v3, s[16:19], s67 offen offset:1024 sc1
 s_waitcnt lgkmcnt(0)
 s_mov_b64 exec, 0xffff
 buffer_store_dwordx4 v[176:179], v3, s[16:19], s67 offen offset:2048 sc1
 s_mov_b64 exec, -1
 s_add_u32 s61, s61, 1
 s_add_u32 s65, s61, 1
 s_waitcnt vmcnt(3)
 v_mov_b64 v[164:165], v[114:115]
 s_add_u32 s79, s61, 2
 s_min_u32 s79, s79, 64
 s_cmp_ge_u32 s78, s79
 s_cbranch_scc1 Lr_162
 s_mov_b32 s62, 0
Lspin_163:
 buffer_load_dword v161, v162, s[8:11], 0 offen sc1
 s_waitcnt vmcnt(0)
 v_cmp_gt_u32 vcc, s79, v161
 s_cbranch_vccz Lspind_164
 s_add_u32 s62, s62, 1
 s_cmp_lt_u32 s62, 400000
 s_cbranch_scc1 Lspin_163
 s_mov_b32 s63, 114
 s_branch L_abort_b
Lspind_164:
 v_readfirstlane_b32 s78, v161
Lr_162:
 s_mul_i32 s67, s61, 36864
 s_add_u32 s67, s67, s72
 s_add_u32 s67, s67, 10260480
 s_mov_b32 m0, s75
 s_xor_b32 s75, s75, 0x10000
 buffer_load_dwordx4 v17, s[8:11], s67 offen sc1 lds
 buffer_load_dwordx4 v17, s[8:11], s67 offen offset:1024 sc1 lds
 s_mov_b64 exec, 0xffff
 buffer_load_dwordx4 v17, s[8:11], s67 offen offset:2048 sc1 lds
 s_mov_b64 exec, -1
 s_lshl_b32 s67, s61, 8
 s_add_u32 s67, s67, 12632320
 buffer_load_dwordx2 v[114:115], v4, s[8:11], s67 offen sc1
 v_add_u32 v148, s77, v12
 v_add_u32 v149, s77, v13
 v_add_u32 v150, s77, v14
 v_add_u32 v151, s77, v15
 v_add_u32 v152, s77, v16
 s_xor_b32 s77, s77, 0x10000
 ds_read_b64 v[104:105], v148 offset:49152
 ds_read_b64 v[106:107], v149 offset:49152
 ds_read_b64 v[108:109], v150 offset:49152
 ds_read_b64 v[110:111], v151 offset:49152
 ds_read_b64 v[112:113], v152 offset:49152
 s_waitcnt lgkmcnt(4)
 v_lshlrev_b32 v116, 16, v104
 v_and_b32 v117, 0xffff0000, v104
 v_pk_fma_f32 v[116:117], v[116:117], v[164:165], v[164:165] op_sel:[0,1,0] op_sel_hi:[1,1,0]
 v_lshlrev_b32 v118, 16, v105
 v_and_b32 v119, 0xffff0000, v105
 v_pk_fma_f32 v[118:119], v[118:119], v[164:165], v[164:165] op_sel:[0,1,0] op_sel_hi:[1,1,0]
 s_waitcnt lgkmcnt(3)
 v_lshlrev_b32 v120, 16, v106
 v_and_b32 v121, 0xffff0000, v106
 v_pk_fma_f32 v[120:121], v[120:121], v[164:165], v[164:165] op_sel:[0,1,0] op_sel_hi:[1,1,0]
 v_lshlrev_b32 v122, 16, v107
 v_and_b32 v123, 0xffff0000, v107
 v_pk_fma_f32 v[122:123], v[122:123], v[164:165], v[164:165] op_sel:[0,1,0] op_sel_hi:[1,1,0]
 s_waitcnt lgkmcnt(2)
 v_lshlrev_b32 v124, 16, v108
 v_and_b32 v125, 0xffff0000, v108
 v_pk_fma_f32 v[124:125], v[124:125], v[164:165], v[164:165] op_sel:[0,1,0] op_sel_hi:[1,1,0]
 v_lshlrev_b32 v126, 16, v109
 v_and_b32 v127, 0xffff0000, v109
 v_pk_fma_f32 v[126:127], v[126:127], v[164:165], v[164:165] op_sel:[0,1,0] op_sel_hi:[1,1,0]
 s_waitcnt lgkmcnt(1)
 v_lshlrev_b32 v128, 16, v110
 v_and_b32 v129, 0xffff0000, v110
 v_pk_fma_f32 v[128:129], v[128:129], v[164:165], v[164:165] op_sel:[0,1,0] op_sel_hi:[1,1,0]
 v_lshlrev_b32 v130, 16, v111
 v_and_b32 v131, 0xffff0000, v111
 v_pk_fma_f32 v[130:131], v[130:131], v[164:165], v[164:165] op_sel:[0,1,0] op_sel_hi:[1,1,0]
 s_waitcnt lgkmcnt(0)
 v_lshlrev_b32 v132, 16, v112
 v_and_b32 v133, 0xffff0000, v112
 v_pk_fma_f32 v[132:133], v[132:133], v[164:165], v[164:165] op_sel:[0,1,0] op_sel_hi:[1,1,0]
 v_lshlrev_b32 v134, 16, v113
 v_and_b32 v135, 0xffff0000, v113
 v_pk_fma_f32 v[134:135], v[134:135], v[164:165], v[164:165] op_sel:[0,1,0] op_sel_hi:[1,1,0]
 s_nop 0
 v_mfma_f32_16x16x32_bf16 v[116:119], v[24:27], v[32:35], v[116:119]
 v_mfma_f32_16x16x32_bf16 v[116:119], v[28:31], v[36:39], v[116:119]
 v_mfma_f32_16x16x32_bf16 v[120:123], v[24:27], v[40:43], v[120:123]
 v_mfma_f32_16x16x32_bf16 v[120:123], v[28:31], v[44:47], v[120:123]
 v_mfma_f32_16x16x32_bf16 v[124:127], v[24:27], v[48:51], v[124:127]
 v_mfma_f32_16x16x32_bf16 v[124:127], v[28:31], v[52:55], v[124:127]
 v_mfma_f32_16x16x32_bf16 v[128:131], v[24:27], v[56:59], v[128:131]
 v_mfma_f32_16x16x32_bf16 v[128:131], v[28:31], v[60:63], v[128:131]
 v_mfma_f32_16x16x32_bf16 v[132:135], v[24:27], v[64:67], v[132:135]
 s_nop 0
 s_nop 1
 s_waitcnt vmcnt(0)
 s_branch L_r21_mid
L_r21_done:
 s_waitcnt vmcnt(0)
 s_waitcnt vmcnt(0) lgkmcnt(0)
 s_endpgm
 s_endpgm
L_code_end:
.section .rodata,"a"
.p2align 6
.amdhsa_kernel interleave_layers__memory_aug_recurrent_mem_tr__glu_gated_swiglu__prompt_kernel
  .amdhsa_next_free_vgpr 512
  .amdhsa_next_free_sgpr 102
  .amdhsa_accum_offset 256
  .amdhsa_group_segment_fixed_size 0
  .amdhsa_kernarg_size 112
  .amdhsa_user_sgpr_count 2
  .amdhsa_user_sgpr_kernarg_segment_ptr 1
  .amdhsa_system_sgpr_workgroup_id_x 1
  .amdhsa_float_denorm_mode_32 3
.end_amdhsa_kernel
```
